```python
import torch

def _softmax(x, axis=-1):
    return torch.softmax(x, dim=axis)

def _gelu(x):
    return torch.nn.functional.gelu(x, approximate='tanh')

def _silu(x):
    return torch.nn.functional.silu(x)

def _sigmoid(x):
    return torch.sigmoid(x)

def _layernorm(x, axis=-1, eps=1e-05):
    m = x.mean(dim=axis, keepdim=True)
    v = x.var(dim=axis, keepdim=True, unbiased=False)
    return (x - m) / torch.sqrt(v + eps)

def _scatter_add(tgt, idx, src, axis=0):
    return tgt.clone().index_add_(axis, idx, src)

def _segment_sum(src, seg, n):
    out = torch.zeros((n,) + src.shape[1:], dtype=src.dtype)
    return out.index_add_(0, seg, src)

def _pad(x, pw):
    flat = tuple((v for pair in reversed(pw) for v in pair))
    return torch.nn.functional.pad(x, flat)
kernel_name = 'interleave_layers__grouped_kv_mqa__memory_aug_recurrent_mem_tr__prompt'

def setup_inputs():

    _w = lambda a: (lambda t: t.to(torch.bfloat16) if t.is_floating_point() else t)(torch.as_tensor(a))

    def _A_setup():
        B, S, D, H = (1, 2048, 512, 32)
        Dh = D // H
        return {'x': _w((lambda *s: torch.randn(*s, dtype=torch.bfloat16) * 0.05)(B, S, D)), 'wq': _w((lambda *s: torch.randn(*s, dtype=torch.bfloat16) * 0.05)(D, H * Dh)), 'wk': _w((lambda *s: torch.randn(*s, dtype=torch.bfloat16) * 0.05)(D, Dh)), 'wv': _w((lambda *s: torch.randn(*s, dtype=torch.bfloat16) * 0.05)(D, Dh)), 'wo': _w((lambda *s: torch.randn(*s, dtype=torch.bfloat16) * 0.05)(H * Dh, D))}
    _A_in = _A_setup()

    def _B_setup():
        B, S, Dm = (1, 2048, 512)
        H, Dh = (32, 128)
        M, seg = (8, 32)
        seg = min(seg, S)
        S = S // seg * seg
        return {'x': _w((lambda *s: torch.randn(*s, dtype=torch.bfloat16) * 0.05)(B, S, Dm)), 'mem0': _w((lambda *s: torch.randn(*s, dtype=torch.bfloat16) * 0.8)(B, M, Dm)), 'Wq': _w((lambda *s: torch.randn(*s, dtype=torch.bfloat16) * 1.6)(Dm, H, Dh) * Dm ** (-0.5)), 'Wk': _w((lambda *s: torch.randn(*s, dtype=torch.bfloat16) * 1.6)(Dm, H, Dh) * Dm ** (-0.5)), 'Wv': _w((lambda *s: torch.randn(*s, dtype=torch.bfloat16) * 0.8)(Dm, H, Dh) * Dm ** (-0.5)), 'Wo': _w((lambda *s: torch.randn(*s, dtype=torch.bfloat16) * 0.8)(H, Dh, Dm) * (H * Dh) ** (-0.5)), 'seg_len': seg}
    _B_in = _B_setup()
    return {'A_x': _A_in['x'], 'A_wq': _A_in['wq'], 'A_wk': _A_in['wk'], 'A_wv': _A_in['wv'], 'A_wo': _A_in['wo'], 'B_x': _B_in['x'], 'B_mem0': _B_in['mem0'], 'B_Wq': _B_in['Wq'], 'B_Wk': _B_in['Wk'], 'B_Wv': _B_in['Wv'], 'B_Wo': _B_in['Wo'], 'B_seg_len': _B_in['seg_len']}

def reference(A_x, A_wq, A_wk, A_wv, A_wo, B_x, B_mem0, B_Wq, B_Wk, B_Wv, B_Wo, B_seg_len):

    def _A_ref(x, wq, wk, wv, wo):
        B, S, D = x.shape
        H = 32
        Dh = D // H
        q = (lambda x, *d: x.permute(*d))((x @ wq).reshape(B, S, H, Dh), 0, 2, 1, 3)
        k = x @ wk
        v = x @ wv
        scores = torch.einsum('bhqd,bkd->bhqk', q, k) * Dh ** (-0.5)
        p = _softmax(scores, axis=-1)
        o = torch.einsum('bhqk,bkd->bhqd', p, v)
        return (lambda x, *d: x.permute(*d))(o, 0, 2, 1, 3).reshape(B, S, H * Dh) @ wo

    def _B_ref(x, mem0, Wq, Wk, Wv, Wo, seg_len):
        B, S, Dm = x.shape
        H, Dh = (Wq.shape[1], Wq.shape[2])
        M = mem0.shape[1]
        scale = Dh ** (-0.5)
        n_seg = S // seg_len
        L = M + seg_len
        idx = torch.arange(L)
        mask = (idx[:, None] < M) | (idx[:, None] >= idx[None, :])
        mem = mem0
        outs = []
        for s in range(n_seg):
            xs = x[:, s * seg_len:(s + 1) * seg_len, :].clone()
            h = torch.concatenate([mem, xs], axis=1)
            q = torch.einsum('btd,dhe->bhte', h, Wq)
            k = torch.einsum('btd,dhe->bhte', h, Wk)
            v = torch.einsum('btd,dhe->bhte', h, Wv)
            scores = torch.einsum('bhqe,bhke->bhqk', q, k) * scale
            scores = torch.where(mask[None, None], scores, -1000000000.0)
            p = _softmax(scores, axis=-1)
            o = torch.einsum('bhqk,bhke->bhqe', p, v)
            o = torch.einsum('bhte,hed->btd', o, Wo)
            mem = o[:, :M, :].clone()
            outs.append(o[:, M:, :])
        return torch.concatenate(outs, axis=1)
    x = A_x
    x = x + _A_ref(_layernorm(x, axis=-1), A_wq, A_wk, A_wv, A_wo)
    x = x + _B_ref(_layernorm(x, axis=-1), B_mem0, B_Wq, B_Wk, B_Wv, B_Wo, B_seg_len)
    x = x + _A_ref(_layernorm(x, axis=-1), A_wq, A_wk, A_wv, A_wo)
    x = x + _B_ref(_layernorm(x, axis=-1), B_mem0, B_Wq, B_Wk, B_Wv, B_Wo, B_seg_len)
    return x
```

```asm
; @launch kernel=prep_kernel grid=(568,1,1) block=(256,1,1) lds=0
; @launch kernel=ka1_0_kernel grid=(128,1,1) block=(256,1,1) lds=16640
; @launch kernel=ka2_kernel grid=(256,1,1) block=(512,1,1) lds=131072
; @launch kernel=ka3_0_kernel grid=(128,1,1) block=(256,1,1) lds=16640
; @launch kernel=mega0_kernel grid=(256,1,1) block=(256,1,1) lds=159744
; @launch kernel=kb3_0_kernel grid=(512,1,1) block=(256,1,1) lds=0
; @launch kernel=kb4_0_kernel grid=(256,1,1) block=(256,1,1) lds=0
; @launch kernel=ka1_1_kernel grid=(128,1,1) block=(256,1,1) lds=16640
; @launch kernel=ka2_kernel grid=(256,1,1) block=(512,1,1) lds=131072
; @launch kernel=ka3_1_kernel grid=(128,1,1) block=(256,1,1) lds=16640
; @launch kernel=mega1_kernel grid=(256,1,1) block=(256,1,1) lds=159744
; @launch kernel=kb3_1_kernel grid=(512,1,1) block=(256,1,1) lds=0
; @launch kernel=kb4_1_kernel grid=(256,1,1) block=(256,1,1) lds=0
.amdgcn_target "amdgcn-amd-amdhsa--gfx950"
.text
.p2align 8
.globl prep_kernel
.type prep_kernel,@function
prep_kernel:
    s_cmp_ge_u32 s2, 568
    s_cbranch_scc1 L_prep_end_1
    s_load_dwordx2 s[4:5], s[0:1], 112
    s_load_dwordx4 s[24:27], s[0:1], 56
    s_load_dwordx4 s[28:31], s[0:1], 72
    s_load_dwordx4 s[32:35], s[0:1], 8
    s_load_dwordx4 s[36:39], s[0:1], 24
    v_and_b32 v1, 63, v0
    v_lshrrev_b32 v2, 6, v0
    s_nop 0
    v_readfirstlane_b32 s16, v2
    s_mov_b32 s20, 0x05040100
    s_mov_b32 s21, 0x07060302
    v_lshrrev_b32 v2, 4, v1
    v_and_b32 v3, 15, v1
    s_waitcnt lgkmcnt(0)
    s_mov_b32 s8, s4
    s_and_b32 s9, s5, 0xffff
    s_mov_b32 s10, 268435456
    s_mov_b32 s11, 0x00020000
    s_mov_b32 s40, s24
    s_and_b32 s41, s25, 0xffff
    s_mov_b32 s42, 4194304
    s_mov_b32 s43, 0x00020000
    s_mov_b32 s44, s26
    s_and_b32 s45, s27, 0xffff
    s_mov_b32 s46, 4194304
    s_mov_b32 s47, 0x00020000
    s_mov_b32 s48, s28
    s_and_b32 s49, s29, 0xffff
    s_mov_b32 s50, 4194304
    s_mov_b32 s51, 0x00020000
    s_mov_b32 s52, s30
    s_and_b32 s53, s31, 0xffff
    s_mov_b32 s54, 4194304
    s_mov_b32 s55, 0x00020000
    s_mov_b32 s56, s32
    s_and_b32 s57, s33, 0xffff
    s_mov_b32 s58, 524288
    s_mov_b32 s59, 0x00020000
    s_mov_b32 s60, s34
    s_and_b32 s61, s35, 0xffff
    s_mov_b32 s62, 16384
    s_mov_b32 s63, 0x00020000
    s_mov_b32 s64, s36
    s_and_b32 s65, s37, 0xffff
    s_mov_b32 s66, 16384
    s_mov_b32 s67, 0x00020000
    s_mov_b32 s68, s38
    s_and_b32 s69, s39, 0xffff
    s_mov_b32 s70, 524288
    s_mov_b32 s71, 0x00020000
    s_lshl_b32 s3, s2, 2
    s_add_u32 s3, s3, s16
    s_cmp_ge_u32 s2, 552
    s_cbranch_scc1 L_prep_z_6
    s_cmp_ge_u32 s2, 544
    s_cbranch_scc1 L_prep_akv_5
    s_cmp_ge_u32 s2, 528
    s_cbranch_scc1 L_prep_ao_4
    s_cmp_ge_u32 s2, 512
    s_cbranch_scc1 L_prep_aq_3
    s_cmp_ge_u32 s2, 384
    s_cbranch_scc1 L_prep_wo_2
    s_lshr_b32 s4, s3, 9
    s_bfe_u32 s5, s3, 0x40005
    s_and_b32 s6, s3, 31
    v_lshlrev_b32 v4, 16, v2
    v_lshl_add_u32 v4, v3, 4, v4
    s_lshl_b32 s7, s5, 18
    s_lshl_b32 s19, s6, 8
    s_add_u32 s7, s7, s19
    v_add_u32 v4, s7, v4
    s_cmp_eq_u32 s4, 0
    s_cselect_b32 s12, s40, s44
    s_cselect_b32 s13, s41, s45
    s_cselect_b32 s14, s42, s46
    s_cselect_b32 s15, s43, s47
    s_cmp_eq_u32 s4, 2
    s_cselect_b32 s12, s48, s12
    s_cselect_b32 s13, s49, s13
    s_cselect_b32 s14, s50, s14
    s_cselect_b32 s15, s51, s15
    s_mov_b32 s19, 0
    buffer_load_dwordx4 v[16:19], v4, s[12:15], s19 offen
    s_mov_b32 s19, 8192
    buffer_load_dwordx4 v[20:23], v4, s[12:15], s19 offen
    s_mov_b32 s19, 16384
    buffer_load_dwordx4 v[24:27], v4, s[12:15], s19 offen
    s_mov_b32 s19, 24576
    buffer_load_dwordx4 v[28:31], v4, s[12:15], s19 offen
    s_mov_b32 s19, 32768
    buffer_load_dwordx4 v[32:35], v4, s[12:15], s19 offen
    s_mov_b32 s19, 40960
    buffer_load_dwordx4 v[36:39], v4, s[12:15], s19 offen
    s_mov_b32 s19, 49152
    buffer_load_dwordx4 v[40:43], v4, s[12:15], s19 offen
    s_mov_b32 s19, 57344
    buffer_load_dwordx4 v[44:47], v4, s[12:15], s19 offen
    v_lshrrev_b32 v5, 1, v3
    v_lshlrev_b32 v5, 14, v5
    v_lshl_add_u32 v5, v2, 8, v5
    v_and_b32 v6, 1, v3
    v_lshl_add_u32 v5, v6, 7, v5
    s_lshl_b32 s7, s4, 22
    s_lshl_b32 s19, s6, 17
    s_add_u32 s7, s7, s19
    s_lshl_b32 s19, s5, 10
    s_add_u32 s7, s7, s19
    s_add_u32 s7, s7, 0
    s_waitcnt vmcnt(0)
    v_perm_b32 v48, v20, v16, s20
    v_perm_b32 v49, v28, v24, s20
    v_perm_b32 v50, v36, v32, s20
    v_perm_b32 v51, v44, v40, s20
    buffer_store_dwordx4 v[48:51], v5, s[8:11], s7 offen offset:0
    s_nop 1
    v_perm_b32 v52, v20, v16, s21
    v_perm_b32 v53, v28, v24, s21
    v_perm_b32 v54, v36, v32, s21
    v_perm_b32 v55, v44, v40, s21
    buffer_store_dwordx4 v[52:55], v5, s[8:11], s7 offen offset:16
    s_nop 1
    v_perm_b32 v48, v21, v17, s20
    v_perm_b32 v49, v29, v25, s20
    v_perm_b32 v50, v37, v33, s20
    v_perm_b32 v51, v45, v41, s20
    buffer_store_dwordx4 v[48:51], v5, s[8:11], s7 offen offset:32
    s_nop 1
    v_perm_b32 v52, v21, v17, s21
    v_perm_b32 v53, v29, v25, s21
    v_perm_b32 v54, v37, v33, s21
    v_perm_b32 v55, v45, v41, s21
    buffer_store_dwordx4 v[52:55], v5, s[8:11], s7 offen offset:48
    s_nop 1
    v_perm_b32 v48, v22, v18, s20
    v_perm_b32 v49, v30, v26, s20
    v_perm_b32 v50, v38, v34, s20
    v_perm_b32 v51, v46, v42, s20
    buffer_store_dwordx4 v[48:51], v5, s[8:11], s7 offen offset:64
    s_nop 1
    v_perm_b32 v52, v22, v18, s21
    v_perm_b32 v53, v30, v26, s21
    v_perm_b32 v54, v38, v34, s21
    v_perm_b32 v55, v46, v42, s21
    buffer_store_dwordx4 v[52:55], v5, s[8:11], s7 offen offset:80
    s_nop 1
    v_perm_b32 v48, v23, v19, s20
    v_perm_b32 v49, v31, v27, s20
    v_perm_b32 v50, v39, v35, s20
    v_perm_b32 v51, v47, v43, s20
    buffer_store_dwordx4 v[48:51], v5, s[8:11], s7 offen offset:96
    s_nop 1
    v_perm_b32 v52, v23, v19, s21
    v_perm_b32 v53, v31, v27, s21
    v_perm_b32 v54, v39, v35, s21
    v_perm_b32 v55, v47, v43, s21
    buffer_store_dwordx4 v[52:55], v5, s[8:11], s7 offen offset:112
    s_nop 1
    s_branch L_prep_end_1
L_prep_wo_2:
    s_sub_u32 s3, s3, 1536
    s_lshr_b32 s4, s3, 4
    s_bfe_u32 s5, s3, 0x20002
    s_and_b32 s6, s3, 3
    v_lshlrev_b32 v4, 12, v2
    v_lshl_add_u32 v4, v3, 4, v4
    s_lshl_b32 s7, s4, 17
    s_lshl_b32 s19, s5, 15
    s_add_u32 s7, s7, s19
    s_lshl_b32 s19, s6, 8
    s_add_u32 s7, s7, s19
    v_add_u32 v4, s7, v4
    s_mov_b32 s19, 0
    buffer_load_dwordx4 v[16:19], v4, s[52:55], s19 offen
    s_mov_b32 s19, 1024
    buffer_load_dwordx4 v[20:23], v4, s[52:55], s19 offen
    s_mov_b32 s19, 2048
    buffer_load_dwordx4 v[24:27], v4, s[52:55], s19 offen
    s_mov_b32 s19, 3072
    buffer_load_dwordx4 v[28:31], v4, s[52:55], s19 offen
    s_mov_b32 s19, 16384
    buffer_load_dwordx4 v[32:35], v4, s[52:55], s19 offen
    s_mov_b32 s19, 17408
    buffer_load_dwordx4 v[36:39], v4, s[52:55], s19 offen
    s_mov_b32 s19, 18432
    buffer_load_dwordx4 v[40:43], v4, s[52:55], s19 offen
    s_mov_b32 s19, 19456
    buffer_load_dwordx4 v[44:47], v4, s[52:55], s19 offen
    v_lshrrev_b32 v5, 1, v3
    v_lshlrev_b32 v5, 12, v5
    v_lshl_add_u32 v5, v2, 8, v5
    v_and_b32 v6, 1, v3
    v_lshl_add_u32 v5, v6, 7, v5
    s_lshl_b32 s7, s4, 17
    s_lshl_b32 s19, s6, 15
    s_add_u32 s7, s7, s19
    s_lshl_b32 s19, s5, 10
    s_add_u32 s7, s7, s19
    s_add_u32 s7, s7, 12582912
    s_waitcnt vmcnt(0)
    v_perm_b32 v48, v20, v16, s20
    v_perm_b32 v49, v28, v24, s20
    v_perm_b32 v50, v36, v32, s20
    v_perm_b32 v51, v44, v40, s20
    buffer_store_dwordx4 v[48:51], v5, s[8:11], s7 offen offset:0
    s_nop 1
    v_perm_b32 v52, v20, v16, s21
    v_perm_b32 v53, v28, v24, s21
    v_perm_b32 v54, v36, v32, s21
    v_perm_b32 v55, v44, v40, s21
    buffer_store_dwordx4 v[52:55], v5, s[8:11], s7 offen offset:16
    s_nop 1
    v_perm_b32 v48, v21, v17, s20
    v_perm_b32 v49, v29, v25, s20
    v_perm_b32 v50, v37, v33, s20
    v_perm_b32 v51, v45, v41, s20
    buffer_store_dwordx4 v[48:51], v5, s[8:11], s7 offen offset:32
    s_nop 1
    v_perm_b32 v52, v21, v17, s21
    v_perm_b32 v53, v29, v25, s21
    v_perm_b32 v54, v37, v33, s21
    v_perm_b32 v55, v45, v41, s21
    buffer_store_dwordx4 v[52:55], v5, s[8:11], s7 offen offset:48
    s_nop 1
    v_perm_b32 v48, v22, v18, s20
    v_perm_b32 v49, v30, v26, s20
    v_perm_b32 v50, v38, v34, s20
    v_perm_b32 v51, v46, v42, s20
    buffer_store_dwordx4 v[48:51], v5, s[8:11], s7 offen offset:64
    s_nop 1
    v_perm_b32 v52, v22, v18, s21
    v_perm_b32 v53, v30, v26, s21
    v_perm_b32 v54, v38, v34, s21
    v_perm_b32 v55, v46, v42, s21
    buffer_store_dwordx4 v[52:55], v5, s[8:11], s7 offen offset:80
    s_nop 1
    v_perm_b32 v48, v23, v19, s20
    v_perm_b32 v49, v31, v27, s20
    v_perm_b32 v50, v39, v35, s20
    v_perm_b32 v51, v47, v43, s20
    buffer_store_dwordx4 v[48:51], v5, s[8:11], s7 offen offset:96
    s_nop 1
    v_perm_b32 v52, v23, v19, s21
    v_perm_b32 v53, v31, v27, s21
    v_perm_b32 v54, v39, v35, s21
    v_perm_b32 v55, v47, v43, s21
    buffer_store_dwordx4 v[52:55], v5, s[8:11], s7 offen offset:112
    s_nop 1
    s_branch L_prep_end_1
L_prep_aq_3:
    s_sub_u32 s3, s3, 2048
    s_lshr_b32 s5, s3, 2
    s_and_b32 s6, s3, 3
    v_lshlrev_b32 v4, 13, v2
    v_lshl_add_u32 v4, v3, 4, v4
    s_lshl_b32 s7, s5, 15
    s_lshl_b32 s19, s6, 8
    s_add_u32 s7, s7, s19
    v_add_u32 v4, s7, v4
    s_mov_b32 s19, 0
    buffer_load_dwordx4 v[16:19], v4, s[56:59], s19 offen
    s_mov_b32 s19, 1024
    buffer_load_dwordx4 v[20:23], v4, s[56:59], s19 offen
    s_mov_b32 s19, 2048
    buffer_load_dwordx4 v[24:27], v4, s[56:59], s19 offen
    s_mov_b32 s19, 3072
    buffer_load_dwordx4 v[28:31], v4, s[56:59], s19 offen
    s_mov_b32 s19, 4096
    buffer_load_dwordx4 v[32:35], v4, s[56:59], s19 offen
    s_mov_b32 s19, 5120
    buffer_load_dwordx4 v[36:39], v4, s[56:59], s19 offen
    s_mov_b32 s19, 6144
    buffer_load_dwordx4 v[40:43], v4, s[56:59], s19 offen
    s_mov_b32 s19, 7168
    buffer_load_dwordx4 v[44:47], v4, s[56:59], s19 offen
    v_lshrrev_b32 v5, 1, v3
    v_lshlrev_b32 v5, 14, v5
    v_lshl_add_u32 v5, v2, 8, v5
    v_and_b32 v6, 1, v3
    v_lshl_add_u32 v5, v6, 7, v5
    s_lshl_b32 s7, s6, 17
    s_lshl_b32 s19, s5, 10
    s_add_u32 s7, s7, s19
    s_add_u32 s7, s7, 16777216
    s_waitcnt vmcnt(0)
    v_perm_b32 v48, v20, v16, s20
    v_perm_b32 v49, v28, v24, s20
    v_perm_b32 v50, v36, v32, s20
    v_perm_b32 v51, v44, v40, s20
    buffer_store_dwordx4 v[48:51], v5, s[8:11], s7 offen offset:0
    s_nop 1
    v_perm_b32 v52, v20, v16, s21
    v_perm_b32 v53, v28, v24, s21
    v_perm_b32 v54, v36, v32, s21
    v_perm_b32 v55, v44, v40, s21
    buffer_store_dwordx4 v[52:55], v5, s[8:11], s7 offen offset:16
    s_nop 1
    v_perm_b32 v48, v21, v17, s20
    v_perm_b32 v49, v29, v25, s20
    v_perm_b32 v50, v37, v33, s20
    v_perm_b32 v51, v45, v41, s20
    buffer_store_dwordx4 v[48:51], v5, s[8:11], s7 offen offset:32
    s_nop 1
    v_perm_b32 v52, v21, v17, s21
    v_perm_b32 v53, v29, v25, s21
    v_perm_b32 v54, v37, v33, s21
    v_perm_b32 v55, v45, v41, s21
    buffer_store_dwordx4 v[52:55], v5, s[8:11], s7 offen offset:48
    s_nop 1
    v_perm_b32 v48, v22, v18, s20
    v_perm_b32 v49, v30, v26, s20
    v_perm_b32 v50, v38, v34, s20
    v_perm_b32 v51, v46, v42, s20
    buffer_store_dwordx4 v[48:51], v5, s[8:11], s7 offen offset:64
    s_nop 1
    v_perm_b32 v52, v22, v18, s21
    v_perm_b32 v53, v30, v26, s21
    v_perm_b32 v54, v38, v34, s21
    v_perm_b32 v55, v46, v42, s21
    buffer_store_dwordx4 v[52:55], v5, s[8:11], s7 offen offset:80
    s_nop 1
    v_perm_b32 v48, v23, v19, s20
    v_perm_b32 v49, v31, v27, s20
    v_perm_b32 v50, v39, v35, s20
    v_perm_b32 v51, v47, v43, s20
    buffer_store_dwordx4 v[48:51], v5, s[8:11], s7 offen offset:96
    s_nop 1
    v_perm_b32 v52, v23, v19, s21
    v_perm_b32 v53, v31, v27, s21
    v_perm_b32 v54, v39, v35, s21
    v_perm_b32 v55, v47, v43, s21
    buffer_store_dwordx4 v[52:55], v5, s[8:11], s7 offen offset:112
    s_nop 1
    s_branch L_prep_end_1
L_prep_ao_4:
    s_sub_u32 s3, s3, 2112
    s_lshr_b32 s5, s3, 2
    s_and_b32 s6, s3, 3
    v_lshlrev_b32 v4, 13, v2
    v_lshl_add_u32 v4, v3, 4, v4
    s_lshl_b32 s7, s5, 15
    s_lshl_b32 s19, s6, 8
    s_add_u32 s7, s7, s19
    v_add_u32 v4, s7, v4
    s_mov_b32 s19, 0
    buffer_load_dwordx4 v[16:19], v4, s[68:71], s19 offen
    s_mov_b32 s19, 1024
    buffer_load_dwordx4 v[20:23], v4, s[68:71], s19 offen
    s_mov_b32 s19, 2048
    buffer_load_dwordx4 v[24:27], v4, s[68:71], s19 offen
    s_mov_b32 s19, 3072
    buffer_load_dwordx4 v[28:31], v4, s[68:71], s19 offen
    s_mov_b32 s19, 4096
    buffer_load_dwordx4 v[32:35], v4, s[68:71], s19 offen
    s_mov_b32 s19, 5120
    buffer_load_dwordx4 v[36:39], v4, s[68:71], s19 offen
    s_mov_b32 s19, 6144
    buffer_load_dwordx4 v[40:43], v4, s[68:71], s19 offen
    s_mov_b32 s19, 7168
    buffer_load_dwordx4 v[44:47], v4, s[68:71], s19 offen
    v_lshrrev_b32 v5, 1, v3
    v_lshlrev_b32 v5, 14, v5
    v_lshl_add_u32 v5, v2, 8, v5
    v_and_b32 v6, 1, v3
    v_lshl_add_u32 v5, v6, 7, v5
    s_lshl_b32 s7, s6, 17
    s_lshl_b32 s19, s5, 10
    s_add_u32 s7, s7, s19
    s_add_u32 s7, s7, 17334272
    s_waitcnt vmcnt(0)
    v_perm_b32 v48, v20, v16, s20
    v_perm_b32 v49, v28, v24, s20
    v_perm_b32 v50, v36, v32, s20
    v_perm_b32 v51, v44, v40, s20
    buffer_store_dwordx4 v[48:51], v5, s[8:11], s7 offen offset:0
    s_nop 1
    v_perm_b32 v52, v20, v16, s21
    v_perm_b32 v53, v28, v24, s21
    v_perm_b32 v54, v36, v32, s21
    v_perm_b32 v55, v44, v40, s21
    buffer_store_dwordx4 v[52:55], v5, s[8:11], s7 offen offset:16
    s_nop 1
    v_perm_b32 v48, v21, v17, s20
    v_perm_b32 v49, v29, v25, s20
    v_perm_b32 v50, v37, v33, s20
    v_perm_b32 v51, v45, v41, s20
    buffer_store_dwordx4 v[48:51], v5, s[8:11], s7 offen offset:32
    s_nop 1
    v_perm_b32 v52, v21, v17, s21
    v_perm_b32 v53, v29, v25, s21
    v_perm_b32 v54, v37, v33, s21
    v_perm_b32 v55, v45, v41, s21
    buffer_store_dwordx4 v[52:55], v5, s[8:11], s7 offen offset:48
    s_nop 1
    v_perm_b32 v48, v22, v18, s20
    v_perm_b32 v49, v30, v26, s20
    v_perm_b32 v50, v38, v34, s20
    v_perm_b32 v51, v46, v42, s20
    buffer_store_dwordx4 v[48:51], v5, s[8:11], s7 offen offset:64
    s_nop 1
    v_perm_b32 v52, v22, v18, s21
    v_perm_b32 v53, v30, v26, s21
    v_perm_b32 v54, v38, v34, s21
    v_perm_b32 v55, v46, v42, s21
    buffer_store_dwordx4 v[52:55], v5, s[8:11], s7 offen offset:80
    s_nop 1
    v_perm_b32 v48, v23, v19, s20
    v_perm_b32 v49, v31, v27, s20
    v_perm_b32 v50, v39, v35, s20
    v_perm_b32 v51, v47, v43, s20
    buffer_store_dwordx4 v[48:51], v5, s[8:11], s7 offen offset:96
    s_nop 1
    v_perm_b32 v52, v23, v19, s21
    v_perm_b32 v53, v31, v27, s21
    v_perm_b32 v54, v39, v35, s21
    v_perm_b32 v55, v47, v43, s21
    buffer_store_dwordx4 v[52:55], v5, s[8:11], s7 offen offset:112
    s_nop 1
    s_branch L_prep_end_1
L_prep_akv_5:
    s_sub_u32 s3, s3, 2176
    s_lshr_b32 s4, s3, 4
    s_and_b32 s5, s3, 15
    s_cmp_eq_u32 s4, 0
    s_cselect_b32 s12, s60, s64
    s_cselect_b32 s13, s61, s65
    s_cselect_b32 s14, s62, s66
    s_cselect_b32 s15, s63, s67
    v_lshlrev_b32 v4, 8, v2
    v_lshl_add_u32 v4, v3, 4, v4
    s_lshl_b32 s7, s5, 10
    v_add_u32 v4, s7, v4
    v_mov_b32 v7, 0x40000000
    v_cmp_gt_u32 vcc, 2, v3
    s_nop 1
    v_cndmask_b32 v4, v7, v4, vcc
    s_mov_b32 s19, 0
    buffer_load_dwordx4 v[16:19], v4, s[12:15], s19 offen
    s_mov_b32 s19, 32
    buffer_load_dwordx4 v[20:23], v4, s[12:15], s19 offen
    s_mov_b32 s19, 64
    buffer_load_dwordx4 v[24:27], v4, s[12:15], s19 offen
    s_mov_b32 s19, 96
    buffer_load_dwordx4 v[28:31], v4, s[12:15], s19 offen
    s_mov_b32 s19, 128
    buffer_load_dwordx4 v[32:35], v4, s[12:15], s19 offen
    s_mov_b32 s19, 160
    buffer_load_dwordx4 v[36:39], v4, s[12:15], s19 offen
    s_mov_b32 s19, 192
    buffer_load_dwordx4 v[40:43], v4, s[12:15], s19 offen
    s_mov_b32 s19, 224
    buffer_load_dwordx4 v[44:47], v4, s[12:15], s19 offen
    v_lshlrev_b32 v5, 8, v2
    v_lshl_add_u32 v5, v3, 7, v5
    v_cndmask_b32 v5, v7, v5, vcc
    s_lshl_b32 s7, s4, 14
    s_lshl_b32 s19, s5, 10
    s_add_u32 s7, s7, s19
    s_add_u32 s7, s7, 17301504
    s_waitcnt vmcnt(0)
    v_perm_b32 v48, v20, v16, s20
    v_perm_b32 v49, v28, v24, s20
    v_perm_b32 v50, v36, v32, s20
    v_perm_b32 v51, v44, v40, s20
    buffer_store_dwordx4 v[48:51], v5, s[8:11], s7 offen offset:0
    s_nop 1
    v_perm_b32 v52, v20, v16, s21
    v_perm_b32 v53, v28, v24, s21
    v_perm_b32 v54, v36, v32, s21
    v_perm_b32 v55, v44, v40, s21
    buffer_store_dwordx4 v[52:55], v5, s[8:11], s7 offen offset:16
    s_nop 1
    v_perm_b32 v48, v21, v17, s20
    v_perm_b32 v49, v29, v25, s20
    v_perm_b32 v50, v37, v33, s20
    v_perm_b32 v51, v45, v41, s20
    buffer_store_dwordx4 v[48:51], v5, s[8:11], s7 offen offset:32
    s_nop 1
    v_perm_b32 v52, v21, v17, s21
    v_perm_b32 v53, v29, v25, s21
    v_perm_b32 v54, v37, v33, s21
    v_perm_b32 v55, v45, v41, s21
    buffer_store_dwordx4 v[52:55], v5, s[8:11], s7 offen offset:48
    s_nop 1
    v_perm_b32 v48, v22, v18, s20
    v_perm_b32 v49, v30, v26, s20
    v_perm_b32 v50, v38, v34, s20
    v_perm_b32 v51, v46, v42, s20
    buffer_store_dwordx4 v[48:51], v5, s[8:11], s7 offen offset:64
    s_nop 1
    v_perm_b32 v52, v22, v18, s21
    v_perm_b32 v53, v30, v26, s21
    v_perm_b32 v54, v38, v34, s21
    v_perm_b32 v55, v46, v42, s21
    buffer_store_dwordx4 v[52:55], v5, s[8:11], s7 offen offset:80
    s_nop 1
    v_perm_b32 v48, v23, v19, s20
    v_perm_b32 v49, v31, v27, s20
    v_perm_b32 v50, v39, v35, s20
    v_perm_b32 v51, v47, v43, s20
    buffer_store_dwordx4 v[48:51], v5, s[8:11], s7 offen offset:96
    s_nop 1
    v_perm_b32 v52, v23, v19, s21
    v_perm_b32 v53, v31, v27, s21
    v_perm_b32 v54, v39, v35, s21
    v_perm_b32 v55, v47, v43, s21
    buffer_store_dwordx4 v[52:55], v5, s[8:11], s7 offen offset:112
    s_nop 1
    s_branch L_prep_end_1
L_prep_z_6:
    s_sub_u32 s3, s2, 552
    s_lshr_b32 s4, s3, 3
    s_and_b32 s5, s3, 7
    s_mul_i32 s5, s5, 73728
    s_lshl_b32 s4, s4, 20
    s_add_u32 s7, s4, s5
    s_add_u32 s7, s7, 18874368
    v_lshlrev_b32 v4, 4, v0
    v_mov_b32 v8, 0
    v_mov_b32 v9, 0
    v_mov_b32 v10, 0
    v_mov_b32 v11, 0
    s_add_u32 s19, s7, 0
    buffer_store_dwordx4 v[8:11], v4, s[8:11], s19 offen
    s_add_u32 s19, s7, 4096
    buffer_store_dwordx4 v[8:11], v4, s[8:11], s19 offen
    s_add_u32 s19, s7, 8192
    buffer_store_dwordx4 v[8:11], v4, s[8:11], s19 offen
    s_add_u32 s19, s7, 12288
    buffer_store_dwordx4 v[8:11], v4, s[8:11], s19 offen
    s_add_u32 s19, s7, 16384
    buffer_store_dwordx4 v[8:11], v4, s[8:11], s19 offen
    s_add_u32 s19, s7, 20480
    buffer_store_dwordx4 v[8:11], v4, s[8:11], s19 offen
    s_add_u32 s19, s7, 24576
    buffer_store_dwordx4 v[8:11], v4, s[8:11], s19 offen
    s_add_u32 s19, s7, 28672
    buffer_store_dwordx4 v[8:11], v4, s[8:11], s19 offen
    s_add_u32 s19, s7, 32768
    buffer_store_dwordx4 v[8:11], v4, s[8:11], s19 offen
    s_add_u32 s19, s7, 36864
    buffer_store_dwordx4 v[8:11], v4, s[8:11], s19 offen
    s_add_u32 s19, s7, 40960
    buffer_store_dwordx4 v[8:11], v4, s[8:11], s19 offen
    s_add_u32 s19, s7, 45056
    buffer_store_dwordx4 v[8:11], v4, s[8:11], s19 offen
    s_add_u32 s19, s7, 49152
    buffer_store_dwordx4 v[8:11], v4, s[8:11], s19 offen
    s_add_u32 s19, s7, 53248
    buffer_store_dwordx4 v[8:11], v4, s[8:11], s19 offen
    s_add_u32 s19, s7, 57344
    buffer_store_dwordx4 v[8:11], v4, s[8:11], s19 offen
    s_add_u32 s19, s7, 61440
    buffer_store_dwordx4 v[8:11], v4, s[8:11], s19 offen
    s_add_u32 s19, s7, 65536
    buffer_store_dwordx4 v[8:11], v4, s[8:11], s19 offen
    s_add_u32 s19, s7, 69632
    buffer_store_dwordx4 v[8:11], v4, s[8:11], s19 offen
    s_add_u32 s19, s7, 73728
    buffer_store_dwordx4 v[8:11], v4, s[8:11], s19 offen
L_prep_end_1:
    s_endpgm
.section .rodata,"a"
.p2align 6
.amdhsa_kernel prep_kernel
  .amdhsa_next_free_vgpr 64
  .amdhsa_next_free_sgpr 102
  .amdhsa_accum_offset 64
  .amdhsa_group_segment_fixed_size 0
  .amdhsa_kernarg_size 120
  .amdhsa_user_sgpr_count 2
  .amdhsa_user_sgpr_kernarg_segment_ptr 1
  .amdhsa_system_sgpr_workgroup_id_x 1
.end_amdhsa_kernel
.text

.p2align 8
.globl ka1_0_kernel
.type ka1_0_kernel,@function
ka1_0_kernel:
    s_cmp_ge_u32 s2, 128
    s_cbranch_scc1 L_ka1_end_7
    s_load_dwordx2 s[4:5], s[0:1], 112
    s_load_dwordx2 s[6:7], s[0:1], 0
    v_and_b32 v1, 63, v0
    v_lshrrev_b32 v2, 6, v0
    s_nop 0
    v_readfirstlane_b32 s16, v2
    v_lshrrev_b32 v2, 4, v1
    v_and_b32 v3, 15, v1
    s_waitcnt lgkmcnt(0)
    s_mov_b32 s8, s4
    s_and_b32 s9, s5, 0xffff
    s_mov_b32 s10, 268435456
    s_mov_b32 s11, 0x00020000
    s_mov_b32 s12, s6
    s_and_b32 s13, s7, 0xffff
    s_mov_b32 s14, 2097152
    s_mov_b32 s15, 0x00020000
    s_lshl_b32 s3, s2, 14
    s_lshl_b32 s19, s16, 12
    s_add_u32 s3, s3, s19
    v_lshlrev_b32 v4, 10, v2
    v_lshl_add_u32 v4, v3, 6, v4
    buffer_load_dwordx4 v[16:19], v4, s[12:15], s3 offen offset:0
    buffer_load_dwordx4 v[20:23], v4, s[12:15], s3 offen offset:16
    buffer_load_dwordx4 v[24:27], v4, s[12:15], s3 offen offset:32
    buffer_load_dwordx4 v[28:31], v4, s[12:15], s3 offen offset:48
    s_waitcnt vmcnt(0)
    v_lshlrev_b32 v64, 16, v16
    v_and_b32 v65, 0xffff0000, v16
    v_lshlrev_b32 v66, 16, v17
    v_and_b32 v67, 0xffff0000, v17
    v_lshlrev_b32 v68, 16, v18
    v_and_b32 v69, 0xffff0000, v18
    v_lshlrev_b32 v70, 16, v19
    v_and_b32 v71, 0xffff0000, v19
    v_lshlrev_b32 v72, 16, v20
    v_and_b32 v73, 0xffff0000, v20
    v_lshlrev_b32 v74, 16, v21
    v_and_b32 v75, 0xffff0000, v21
    v_lshlrev_b32 v76, 16, v22
    v_and_b32 v77, 0xffff0000, v22
    v_lshlrev_b32 v78, 16, v23
    v_and_b32 v79, 0xffff0000, v23
    v_lshlrev_b32 v80, 16, v24
    v_and_b32 v81, 0xffff0000, v24
    v_lshlrev_b32 v82, 16, v25
    v_and_b32 v83, 0xffff0000, v25
    v_lshlrev_b32 v84, 16, v26
    v_and_b32 v85, 0xffff0000, v26
    v_lshlrev_b32 v86, 16, v27
    v_and_b32 v87, 0xffff0000, v27
    v_lshlrev_b32 v88, 16, v28
    v_and_b32 v89, 0xffff0000, v28
    v_lshlrev_b32 v90, 16, v29
    v_and_b32 v91, 0xffff0000, v29
    v_lshlrev_b32 v92, 16, v30
    v_and_b32 v93, 0xffff0000, v30
    v_lshlrev_b32 v94, 16, v31
    v_and_b32 v95, 0xffff0000, v31
    v_add_f32 v96, v64, v65
    v_add_f32 v96, v96, v66
    v_add_f32 v96, v96, v67
    v_add_f32 v96, v96, v68
    v_add_f32 v96, v96, v69
    v_add_f32 v96, v96, v70
    v_add_f32 v96, v96, v71
    v_add_f32 v96, v96, v72
    v_add_f32 v96, v96, v73
    v_add_f32 v96, v96, v74
    v_add_f32 v96, v96, v75
    v_add_f32 v96, v96, v76
    v_add_f32 v96, v96, v77
    v_add_f32 v96, v96, v78
    v_add_f32 v96, v96, v79
    v_add_f32 v96, v96, v80
    v_add_f32 v96, v96, v81
    v_add_f32 v96, v96, v82
    v_add_f32 v96, v96, v83
    v_add_f32 v96, v96, v84
    v_add_f32 v96, v96, v85
    v_add_f32 v96, v96, v86
    v_add_f32 v96, v96, v87
    v_add_f32 v96, v96, v88
    v_add_f32 v96, v96, v89
    v_add_f32 v96, v96, v90
    v_add_f32 v96, v96, v91
    v_add_f32 v96, v96, v92
    v_add_f32 v96, v96, v93
    v_add_f32 v96, v96, v94
    v_add_f32 v96, v96, v95
    s_nop 1
    v_add_f32_dpp v96, v96, v96 row_ror:8 row_mask:0xf bank_mask:0xf
    s_nop 1
    v_add_f32_dpp v96, v96, v96 row_ror:4 row_mask:0xf bank_mask:0xf
    s_nop 1
    v_add_f32_dpp v96, v96, v96 row_ror:2 row_mask:0xf bank_mask:0xf
    s_nop 1
    v_add_f32_dpp v96, v96, v96 row_ror:1 row_mask:0xf bank_mask:0xf
    v_mul_f32 v97, 0x3b000000, v96
    v_mov_b32 v99, 0
    v_sub_f32 v98, v64, v97
    v_fmac_f32 v99, v98, v98
    v_sub_f32 v98, v65, v97
    v_fmac_f32 v99, v98, v98
    v_sub_f32 v98, v66, v97
    v_fmac_f32 v99, v98, v98
    v_sub_f32 v98, v67, v97
    v_fmac_f32 v99, v98, v98
    v_sub_f32 v98, v68, v97
    v_fmac_f32 v99, v98, v98
    v_sub_f32 v98, v69, v97
    v_fmac_f32 v99, v98, v98
    v_sub_f32 v98, v70, v97
    v_fmac_f32 v99, v98, v98
    v_sub_f32 v98, v71, v97
    v_fmac_f32 v99, v98, v98
    v_sub_f32 v98, v72, v97
    v_fmac_f32 v99, v98, v98
    v_sub_f32 v98, v73, v97
    v_fmac_f32 v99, v98, v98
    v_sub_f32 v98, v74, v97
    v_fmac_f32 v99, v98, v98
    v_sub_f32 v98, v75, v97
    v_fmac_f32 v99, v98, v98
    v_sub_f32 v98, v76, v97
    v_fmac_f32 v99, v98, v98
    v_sub_f32 v98, v77, v97
    v_fmac_f32 v99, v98, v98
    v_sub_f32 v98, v78, v97
    v_fmac_f32 v99, v98, v98
    v_sub_f32 v98, v79, v97
    v_fmac_f32 v99, v98, v98
    v_sub_f32 v98, v80, v97
    v_fmac_f32 v99, v98, v98
    v_sub_f32 v98, v81, v97
    v_fmac_f32 v99, v98, v98
    v_sub_f32 v98, v82, v97
    v_fmac_f32 v99, v98, v98
    v_sub_f32 v98, v83, v97
    v_fmac_f32 v99, v98, v98
    v_sub_f32 v98, v84, v97
    v_fmac_f32 v99, v98, v98
    v_sub_f32 v98, v85, v97
    v_fmac_f32 v99, v98, v98
    v_sub_f32 v98, v86, v97
    v_fmac_f32 v99, v98, v98
    v_sub_f32 v98, v87, v97
    v_fmac_f32 v99, v98, v98
    v_sub_f32 v98, v88, v97
    v_fmac_f32 v99, v98, v98
    v_sub_f32 v98, v89, v97
    v_fmac_f32 v99, v98, v98
    v_sub_f32 v98, v90, v97
    v_fmac_f32 v99, v98, v98
    v_sub_f32 v98, v91, v97
    v_fmac_f32 v99, v98, v98
    v_sub_f32 v98, v92, v97
    v_fmac_f32 v99, v98, v98
    v_sub_f32 v98, v93, v97
    v_fmac_f32 v99, v98, v98
    v_sub_f32 v98, v94, v97
    v_fmac_f32 v99, v98, v98
    v_sub_f32 v98, v95, v97
    v_fmac_f32 v99, v98, v98
    s_nop 1
    v_add_f32_dpp v99, v99, v99 row_ror:8 row_mask:0xf bank_mask:0xf
    s_nop 1
    v_add_f32_dpp v99, v99, v99 row_ror:4 row_mask:0xf bank_mask:0xf
    s_nop 1
    v_add_f32_dpp v99, v99, v99 row_ror:2 row_mask:0xf bank_mask:0xf
    s_nop 1
    v_add_f32_dpp v99, v99, v99 row_ror:1 row_mask:0xf bank_mask:0xf
    v_mul_f32 v99, 0x3b000000, v99
    v_cvt_pk_bf16_f32 v100, v97, v99
    v_lshlrev_b32 v97, 16, v100
    v_and_b32 v99, 0xffff0000, v100
    v_add_f32 v99, 0x3727c5ac, v99
    v_cvt_pk_bf16_f32 v100, v99, v99
    v_lshlrev_b32 v99, 16, v100
    v_sqrt_f32 v99, v99
    s_nop 0
    v_cvt_pk_bf16_f32 v100, v99, v99
    v_lshlrev_b32 v99, 16, v100
    v_rcp_f32 v99, v99
    s_nop 0
    v_sub_f32 v100, v64, v97
    v_sub_f32 v101, v65, v97
    v_cvt_pk_bf16_f32 v102, v100, v101
    v_lshlrev_b32 v100, 16, v102
    v_and_b32 v101, 0xffff0000, v102
    v_mul_f32 v100, v99, v100
    v_mul_f32 v101, v99, v101
    v_cvt_pk_bf16_f32 v16, v100, v101
    v_sub_f32 v100, v66, v97
    v_sub_f32 v101, v67, v97
    v_cvt_pk_bf16_f32 v102, v100, v101
    v_lshlrev_b32 v100, 16, v102
    v_and_b32 v101, 0xffff0000, v102
    v_mul_f32 v100, v99, v100
    v_mul_f32 v101, v99, v101
    v_cvt_pk_bf16_f32 v17, v100, v101
    v_sub_f32 v100, v68, v97
    v_sub_f32 v101, v69, v97
    v_cvt_pk_bf16_f32 v102, v100, v101
    v_lshlrev_b32 v100, 16, v102
    v_and_b32 v101, 0xffff0000, v102
    v_mul_f32 v100, v99, v100
    v_mul_f32 v101, v99, v101
    v_cvt_pk_bf16_f32 v18, v100, v101
    v_sub_f32 v100, v70, v97
    v_sub_f32 v101, v71, v97
    v_cvt_pk_bf16_f32 v102, v100, v101
    v_lshlrev_b32 v100, 16, v102
    v_and_b32 v101, 0xffff0000, v102
    v_mul_f32 v100, v99, v100
    v_mul_f32 v101, v99, v101
    v_cvt_pk_bf16_f32 v19, v100, v101
    v_sub_f32 v100, v72, v97
    v_sub_f32 v101, v73, v97
    v_cvt_pk_bf16_f32 v102, v100, v101
    v_lshlrev_b32 v100, 16, v102
    v_and_b32 v101, 0xffff0000, v102
    v_mul_f32 v100, v99, v100
    v_mul_f32 v101, v99, v101
    v_cvt_pk_bf16_f32 v20, v100, v101
    v_sub_f32 v100, v74, v97
    v_sub_f32 v101, v75, v97
    v_cvt_pk_bf16_f32 v102, v100, v101
    v_lshlrev_b32 v100, 16, v102
    v_and_b32 v101, 0xffff0000, v102
    v_mul_f32 v100, v99, v100
    v_mul_f32 v101, v99, v101
    v_cvt_pk_bf16_f32 v21, v100, v101
    v_sub_f32 v100, v76, v97
    v_sub_f32 v101, v77, v97
    v_cvt_pk_bf16_f32 v102, v100, v101
    v_lshlrev_b32 v100, 16, v102
    v_and_b32 v101, 0xffff0000, v102
    v_mul_f32 v100, v99, v100
    v_mul_f32 v101, v99, v101
    v_cvt_pk_bf16_f32 v22, v100, v101
    v_sub_f32 v100, v78, v97
    v_sub_f32 v101, v79, v97
    v_cvt_pk_bf16_f32 v102, v100, v101
    v_lshlrev_b32 v100, 16, v102
    v_and_b32 v101, 0xffff0000, v102
    v_mul_f32 v100, v99, v100
    v_mul_f32 v101, v99, v101
    v_cvt_pk_bf16_f32 v23, v100, v101
    v_sub_f32 v100, v80, v97
    v_sub_f32 v101, v81, v97
    v_cvt_pk_bf16_f32 v102, v100, v101
    v_lshlrev_b32 v100, 16, v102
    v_and_b32 v101, 0xffff0000, v102
    v_mul_f32 v100, v99, v100
    v_mul_f32 v101, v99, v101
    v_cvt_pk_bf16_f32 v24, v100, v101
    v_sub_f32 v100, v82, v97
    v_sub_f32 v101, v83, v97
    v_cvt_pk_bf16_f32 v102, v100, v101
    v_lshlrev_b32 v100, 16, v102
    v_and_b32 v101, 0xffff0000, v102
    v_mul_f32 v100, v99, v100
    v_mul_f32 v101, v99, v101
    v_cvt_pk_bf16_f32 v25, v100, v101
    v_sub_f32 v100, v84, v97
    v_sub_f32 v101, v85, v97
    v_cvt_pk_bf16_f32 v102, v100, v101
    v_lshlrev_b32 v100, 16, v102
    v_and_b32 v101, 0xffff0000, v102
    v_mul_f32 v100, v99, v100
    v_mul_f32 v101, v99, v101
    v_cvt_pk_bf16_f32 v26, v100, v101
    v_sub_f32 v100, v86, v97
    v_sub_f32 v101, v87, v97
    v_cvt_pk_bf16_f32 v102, v100, v101
    v_lshlrev_b32 v100, 16, v102
    v_and_b32 v101, 0xffff0000, v102
    v_mul_f32 v100, v99, v100
    v_mul_f32 v101, v99, v101
    v_cvt_pk_bf16_f32 v27, v100, v101
    v_sub_f32 v100, v88, v97
    v_sub_f32 v101, v89, v97
    v_cvt_pk_bf16_f32 v102, v100, v101
    v_lshlrev_b32 v100, 16, v102
    v_and_b32 v101, 0xffff0000, v102
    v_mul_f32 v100, v99, v100
    v_mul_f32 v101, v99, v101
    v_cvt_pk_bf16_f32 v28, v100, v101
    v_sub_f32 v100, v90, v97
    v_sub_f32 v101, v91, v97
    v_cvt_pk_bf16_f32 v102, v100, v101
    v_lshlrev_b32 v100, 16, v102
    v_and_b32 v101, 0xffff0000, v102
    v_mul_f32 v100, v99, v100
    v_mul_f32 v101, v99, v101
    v_cvt_pk_bf16_f32 v29, v100, v101
    v_sub_f32 v100, v92, v97
    v_sub_f32 v101, v93, v97
    v_cvt_pk_bf16_f32 v102, v100, v101
    v_lshlrev_b32 v100, 16, v102
    v_and_b32 v101, 0xffff0000, v102
    v_mul_f32 v100, v99, v100
    v_mul_f32 v101, v99, v101
    v_cvt_pk_bf16_f32 v30, v100, v101
    v_sub_f32 v100, v94, v97
    v_sub_f32 v101, v95, v97
    v_cvt_pk_bf16_f32 v102, v100, v101
    v_lshlrev_b32 v100, 16, v102
    v_and_b32 v101, 0xffff0000, v102
    v_mul_f32 v100, v99, v100
    v_mul_f32 v101, v99, v101
    v_cvt_pk_bf16_f32 v31, v100, v101
    s_lshl_b32 s19, s16, 2
    v_add_u32 v5, s19, v2
    v_mul_u32_u24 v5, 1040, v5
    v_lshl_add_u32 v5, v3, 6, v5
    ds_write_b128 v5, v[16:19] offset:0
    ds_write_b128 v5, v[20:23] offset:16
    ds_write_b128 v5, v[24:27] offset:32
    ds_write_b128 v5, v[28:31] offset:48
    s_waitcnt lgkmcnt(0)
    s_barrier
    v_mul_u32_u24 v6, 1040, v3
    v_lshl_add_u32 v6, v2, 4, v6
    v_lshlrev_b32 v7, 4, v1
    s_lshl_b32 s22, s16, 17
    s_add_u32 s22, s22, 16777216
    s_lshl_b32 s23, s16, 14
    s_add_u32 s23, s23, 17301504
    s_add_u32 s19, s22, 0
    buffer_load_dwordx4 v[52:55], v7, s[8:11], s19 offen
    s_add_u32 s19, s22, 16384
    buffer_load_dwordx4 v[56:59], v7, s[8:11], s19 offen
    s_add_u32 s19, s22, 32768
    buffer_load_dwordx4 v[60:63], v7, s[8:11], s19 offen
    s_add_u32 s19, s22, 49152
    buffer_load_dwordx4 v[64:67], v7, s[8:11], s19 offen
    s_add_u32 s19, s22, 65536
    buffer_load_dwordx4 v[68:71], v7, s[8:11], s19 offen
    s_add_u32 s19, s22, 81920
    buffer_load_dwordx4 v[72:75], v7, s[8:11], s19 offen
    s_add_u32 s19, s22, 98304
    buffer_load_dwordx4 v[76:79], v7, s[8:11], s19 offen
    s_add_u32 s19, s22, 114688
    buffer_load_dwordx4 v[80:83], v7, s[8:11], s19 offen
    s_add_u32 s19, s23, 0
    buffer_load_dwordx4 v[84:87], v7, s[8:11], s19 offen
    ds_read_b128 v[124:127], v6
    s_add_u32 s19, s22, 1024
    buffer_load_dwordx4 v[88:91], v7, s[8:11], s19 offen
    s_add_u32 s19, s22, 17408
    buffer_load_dwordx4 v[92:95], v7, s[8:11], s19 offen
    s_add_u32 s19, s22, 33792
    buffer_load_dwordx4 v[96:99], v7, s[8:11], s19 offen
    s_add_u32 s19, s22, 50176
    buffer_load_dwordx4 v[100:103], v7, s[8:11], s19 offen
    s_add_u32 s19, s22, 66560
    buffer_load_dwordx4 v[104:107], v7, s[8:11], s19 offen
    s_add_u32 s19, s22, 82944
    buffer_load_dwordx4 v[108:111], v7, s[8:11], s19 offen
    s_add_u32 s19, s22, 99328
    buffer_load_dwordx4 v[112:115], v7, s[8:11], s19 offen
    s_add_u32 s19, s22, 115712
    buffer_load_dwordx4 v[116:119], v7, s[8:11], s19 offen
    s_add_u32 s19, s23, 1024
    buffer_load_dwordx4 v[120:123], v7, s[8:11], s19 offen
    ds_read_b128 v[128:131], v6 offset:64
    s_waitcnt vmcnt(9) lgkmcnt(1)
    v_mfma_f32_16x16x32_bf16 v[16:19], v[52:55], v[124:127], 0
    v_mfma_f32_16x16x32_bf16 v[20:23], v[56:59], v[124:127], 0
    v_mfma_f32_16x16x32_bf16 v[24:27], v[60:63], v[124:127], 0
    v_mfma_f32_16x16x32_bf16 v[28:31], v[64:67], v[124:127], 0
    v_mfma_f32_16x16x32_bf16 v[32:35], v[68:71], v[124:127], 0
    v_mfma_f32_16x16x32_bf16 v[36:39], v[72:75], v[124:127], 0
    v_mfma_f32_16x16x32_bf16 v[40:43], v[76:79], v[124:127], 0
    v_mfma_f32_16x16x32_bf16 v[44:47], v[80:83], v[124:127], 0
    v_mfma_f32_16x16x32_bf16 v[48:51], v[84:87], v[124:127], 0
    v_mfma_f32_16x16x32_bf16 v[132:135], v[124:127], v[84:87], 0
    s_add_u32 s19, s22, 2048
    buffer_load_dwordx4 v[52:55], v7, s[8:11], s19 offen
    s_add_u32 s19, s22, 18432
    buffer_load_dwordx4 v[56:59], v7, s[8:11], s19 offen
    s_add_u32 s19, s22, 34816
    buffer_load_dwordx4 v[60:63], v7, s[8:11], s19 offen
    s_add_u32 s19, s22, 51200
    buffer_load_dwordx4 v[64:67], v7, s[8:11], s19 offen
    s_add_u32 s19, s22, 67584
    buffer_load_dwordx4 v[68:71], v7, s[8:11], s19 offen
    s_add_u32 s19, s22, 83968
    buffer_load_dwordx4 v[72:75], v7, s[8:11], s19 offen
    s_add_u32 s19, s22, 100352
    buffer_load_dwordx4 v[76:79], v7, s[8:11], s19 offen
    s_add_u32 s19, s22, 116736
    buffer_load_dwordx4 v[80:83], v7, s[8:11], s19 offen
    s_add_u32 s19, s23, 2048
    buffer_load_dwordx4 v[84:87], v7, s[8:11], s19 offen
    ds_read_b128 v[124:127], v6 offset:128
    s_waitcnt vmcnt(9) lgkmcnt(1)
    v_mfma_f32_16x16x32_bf16 v[16:19], v[88:91], v[128:131], v[16:19]
    v_mfma_f32_16x16x32_bf16 v[20:23], v[92:95], v[128:131], v[20:23]
    v_mfma_f32_16x16x32_bf16 v[24:27], v[96:99], v[128:131], v[24:27]
    v_mfma_f32_16x16x32_bf16 v[28:31], v[100:103], v[128:131], v[28:31]
    v_mfma_f32_16x16x32_bf16 v[32:35], v[104:107], v[128:131], v[32:35]
    v_mfma_f32_16x16x32_bf16 v[36:39], v[108:111], v[128:131], v[36:39]
    v_mfma_f32_16x16x32_bf16 v[40:43], v[112:115], v[128:131], v[40:43]
    v_mfma_f32_16x16x32_bf16 v[44:47], v[116:119], v[128:131], v[44:47]
    v_mfma_f32_16x16x32_bf16 v[48:51], v[120:123], v[128:131], v[48:51]
    v_mfma_f32_16x16x32_bf16 v[132:135], v[128:131], v[120:123], v[132:135]
    s_add_u32 s19, s22, 3072
    buffer_load_dwordx4 v[88:91], v7, s[8:11], s19 offen
    s_add_u32 s19, s22, 19456
    buffer_load_dwordx4 v[92:95], v7, s[8:11], s19 offen
    s_add_u32 s19, s22, 35840
    buffer_load_dwordx4 v[96:99], v7, s[8:11], s19 offen
    s_add_u32 s19, s22, 52224
    buffer_load_dwordx4 v[100:103], v7, s[8:11], s19 offen
    s_add_u32 s19, s22, 68608
    buffer_load_dwordx4 v[104:107], v7, s[8:11], s19 offen
    s_add_u32 s19, s22, 84992
    buffer_load_dwordx4 v[108:111], v7, s[8:11], s19 offen
    s_add_u32 s19, s22, 101376
    buffer_load_dwordx4 v[112:115], v7, s[8:11], s19 offen
    s_add_u32 s19, s22, 117760
    buffer_load_dwordx4 v[116:119], v7, s[8:11], s19 offen
    s_add_u32 s19, s23, 3072
    buffer_load_dwordx4 v[120:123], v7, s[8:11], s19 offen
    ds_read_b128 v[128:131], v6 offset:192
    s_waitcnt vmcnt(9) lgkmcnt(1)
    v_mfma_f32_16x16x32_bf16 v[16:19], v[52:55], v[124:127], v[16:19]
    v_mfma_f32_16x16x32_bf16 v[20:23], v[56:59], v[124:127], v[20:23]
    v_mfma_f32_16x16x32_bf16 v[24:27], v[60:63], v[124:127], v[24:27]
    v_mfma_f32_16x16x32_bf16 v[28:31], v[64:67], v[124:127], v[28:31]
    v_mfma_f32_16x16x32_bf16 v[32:35], v[68:71], v[124:127], v[32:35]
    v_mfma_f32_16x16x32_bf16 v[36:39], v[72:75], v[124:127], v[36:39]
    v_mfma_f32_16x16x32_bf16 v[40:43], v[76:79], v[124:127], v[40:43]
    v_mfma_f32_16x16x32_bf16 v[44:47], v[80:83], v[124:127], v[44:47]
    v_mfma_f32_16x16x32_bf16 v[48:51], v[84:87], v[124:127], v[48:51]
    v_mfma_f32_16x16x32_bf16 v[132:135], v[124:127], v[84:87], v[132:135]
    s_add_u32 s19, s22, 4096
    buffer_load_dwordx4 v[52:55], v7, s[8:11], s19 offen
    s_add_u32 s19, s22, 20480
    buffer_load_dwordx4 v[56:59], v7, s[8:11], s19 offen
    s_add_u32 s19, s22, 36864
    buffer_load_dwordx4 v[60:63], v7, s[8:11], s19 offen
    s_add_u32 s19, s22, 53248
    buffer_load_dwordx4 v[64:67], v7, s[8:11], s19 offen
    s_add_u32 s19, s22, 69632
    buffer_load_dwordx4 v[68:71], v7, s[8:11], s19 offen
    s_add_u32 s19, s22, 86016
    buffer_load_dwordx4 v[72:75], v7, s[8:11], s19 offen
    s_add_u32 s19, s22, 102400
    buffer_load_dwordx4 v[76:79], v7, s[8:11], s19 offen
    s_add_u32 s19, s22, 118784
    buffer_load_dwordx4 v[80:83], v7, s[8:11], s19 offen
    s_add_u32 s19, s23, 4096
    buffer_load_dwordx4 v[84:87], v7, s[8:11], s19 offen
    ds_read_b128 v[124:127], v6 offset:256
    s_waitcnt vmcnt(9) lgkmcnt(1)
    v_mfma_f32_16x16x32_bf16 v[16:19], v[88:91], v[128:131], v[16:19]
    v_mfma_f32_16x16x32_bf16 v[20:23], v[92:95], v[128:131], v[20:23]
    v_mfma_f32_16x16x32_bf16 v[24:27], v[96:99], v[128:131], v[24:27]
    v_mfma_f32_16x16x32_bf16 v[28:31], v[100:103], v[128:131], v[28:31]
    v_mfma_f32_16x16x32_bf16 v[32:35], v[104:107], v[128:131], v[32:35]
    v_mfma_f32_16x16x32_bf16 v[36:39], v[108:111], v[128:131], v[36:39]
    v_mfma_f32_16x16x32_bf16 v[40:43], v[112:115], v[128:131], v[40:43]
    v_mfma_f32_16x16x32_bf16 v[44:47], v[116:119], v[128:131], v[44:47]
    v_mfma_f32_16x16x32_bf16 v[48:51], v[120:123], v[128:131], v[48:51]
    v_mfma_f32_16x16x32_bf16 v[132:135], v[128:131], v[120:123], v[132:135]
    s_add_u32 s19, s22, 5120
    buffer_load_dwordx4 v[88:91], v7, s[8:11], s19 offen
    s_add_u32 s19, s22, 21504
    buffer_load_dwordx4 v[92:95], v7, s[8:11], s19 offen
    s_add_u32 s19, s22, 37888
    buffer_load_dwordx4 v[96:99], v7, s[8:11], s19 offen
    s_add_u32 s19, s22, 54272
    buffer_load_dwordx4 v[100:103], v7, s[8:11], s19 offen
    s_add_u32 s19, s22, 70656
    buffer_load_dwordx4 v[104:107], v7, s[8:11], s19 offen
    s_add_u32 s19, s22, 87040
    buffer_load_dwordx4 v[108:111], v7, s[8:11], s19 offen
    s_add_u32 s19, s22, 103424
    buffer_load_dwordx4 v[112:115], v7, s[8:11], s19 offen
    s_add_u32 s19, s22, 119808
    buffer_load_dwordx4 v[116:119], v7, s[8:11], s19 offen
    s_add_u32 s19, s23, 5120
    buffer_load_dwordx4 v[120:123], v7, s[8:11], s19 offen
    ds_read_b128 v[128:131], v6 offset:320
    s_waitcnt vmcnt(9) lgkmcnt(1)
    v_mfma_f32_16x16x32_bf16 v[16:19], v[52:55], v[124:127], v[16:19]
    v_mfma_f32_16x16x32_bf16 v[20:23], v[56:59], v[124:127], v[20:23]
    v_mfma_f32_16x16x32_bf16 v[24:27], v[60:63], v[124:127], v[24:27]
    v_mfma_f32_16x16x32_bf16 v[28:31], v[64:67], v[124:127], v[28:31]
    v_mfma_f32_16x16x32_bf16 v[32:35], v[68:71], v[124:127], v[32:35]
    v_mfma_f32_16x16x32_bf16 v[36:39], v[72:75], v[124:127], v[36:39]
    v_mfma_f32_16x16x32_bf16 v[40:43], v[76:79], v[124:127], v[40:43]
    v_mfma_f32_16x16x32_bf16 v[44:47], v[80:83], v[124:127], v[44:47]
    v_mfma_f32_16x16x32_bf16 v[48:51], v[84:87], v[124:127], v[48:51]
    v_mfma_f32_16x16x32_bf16 v[132:135], v[124:127], v[84:87], v[132:135]
    s_add_u32 s19, s22, 6144
    buffer_load_dwordx4 v[52:55], v7, s[8:11], s19 offen
    s_add_u32 s19, s22, 22528
    buffer_load_dwordx4 v[56:59], v7, s[8:11], s19 offen
    s_add_u32 s19, s22, 38912
    buffer_load_dwordx4 v[60:63], v7, s[8:11], s19 offen
    s_add_u32 s19, s22, 55296
    buffer_load_dwordx4 v[64:67], v7, s[8:11], s19 offen
    s_add_u32 s19, s22, 71680
    buffer_load_dwordx4 v[68:71], v7, s[8:11], s19 offen
    s_add_u32 s19, s22, 88064
    buffer_load_dwordx4 v[72:75], v7, s[8:11], s19 offen
    s_add_u32 s19, s22, 104448
    buffer_load_dwordx4 v[76:79], v7, s[8:11], s19 offen
    s_add_u32 s19, s22, 120832
    buffer_load_dwordx4 v[80:83], v7, s[8:11], s19 offen
    s_add_u32 s19, s23, 6144
    buffer_load_dwordx4 v[84:87], v7, s[8:11], s19 offen
    ds_read_b128 v[124:127], v6 offset:384
    s_waitcnt vmcnt(9) lgkmcnt(1)
    v_mfma_f32_16x16x32_bf16 v[16:19], v[88:91], v[128:131], v[16:19]
    v_mfma_f32_16x16x32_bf16 v[20:23], v[92:95], v[128:131], v[20:23]
    v_mfma_f32_16x16x32_bf16 v[24:27], v[96:99], v[128:131], v[24:27]
    v_mfma_f32_16x16x32_bf16 v[28:31], v[100:103], v[128:131], v[28:31]
    v_mfma_f32_16x16x32_bf16 v[32:35], v[104:107], v[128:131], v[32:35]
    v_mfma_f32_16x16x32_bf16 v[36:39], v[108:111], v[128:131], v[36:39]
    v_mfma_f32_16x16x32_bf16 v[40:43], v[112:115], v[128:131], v[40:43]
    v_mfma_f32_16x16x32_bf16 v[44:47], v[116:119], v[128:131], v[44:47]
    v_mfma_f32_16x16x32_bf16 v[48:51], v[120:123], v[128:131], v[48:51]
    v_mfma_f32_16x16x32_bf16 v[132:135], v[128:131], v[120:123], v[132:135]
    s_add_u32 s19, s22, 7168
    buffer_load_dwordx4 v[88:91], v7, s[8:11], s19 offen
    s_add_u32 s19, s22, 23552
    buffer_load_dwordx4 v[92:95], v7, s[8:11], s19 offen
    s_add_u32 s19, s22, 39936
    buffer_load_dwordx4 v[96:99], v7, s[8:11], s19 offen
    s_add_u32 s19, s22, 56320
    buffer_load_dwordx4 v[100:103], v7, s[8:11], s19 offen
    s_add_u32 s19, s22, 72704
    buffer_load_dwordx4 v[104:107], v7, s[8:11], s19 offen
    s_add_u32 s19, s22, 89088
    buffer_load_dwordx4 v[108:111], v7, s[8:11], s19 offen
    s_add_u32 s19, s22, 105472
    buffer_load_dwordx4 v[112:115], v7, s[8:11], s19 offen
    s_add_u32 s19, s22, 121856
    buffer_load_dwordx4 v[116:119], v7, s[8:11], s19 offen
    s_add_u32 s19, s23, 7168
    buffer_load_dwordx4 v[120:123], v7, s[8:11], s19 offen
    ds_read_b128 v[128:131], v6 offset:448
    s_waitcnt vmcnt(9) lgkmcnt(1)
    v_mfma_f32_16x16x32_bf16 v[16:19], v[52:55], v[124:127], v[16:19]
    v_mfma_f32_16x16x32_bf16 v[20:23], v[56:59], v[124:127], v[20:23]
    v_mfma_f32_16x16x32_bf16 v[24:27], v[60:63], v[124:127], v[24:27]
    v_mfma_f32_16x16x32_bf16 v[28:31], v[64:67], v[124:127], v[28:31]
    v_mfma_f32_16x16x32_bf16 v[32:35], v[68:71], v[124:127], v[32:35]
    v_mfma_f32_16x16x32_bf16 v[36:39], v[72:75], v[124:127], v[36:39]
    v_mfma_f32_16x16x32_bf16 v[40:43], v[76:79], v[124:127], v[40:43]
    v_mfma_f32_16x16x32_bf16 v[44:47], v[80:83], v[124:127], v[44:47]
    v_mfma_f32_16x16x32_bf16 v[48:51], v[84:87], v[124:127], v[48:51]
    v_mfma_f32_16x16x32_bf16 v[132:135], v[124:127], v[84:87], v[132:135]
    s_add_u32 s19, s22, 8192
    buffer_load_dwordx4 v[52:55], v7, s[8:11], s19 offen
    s_add_u32 s19, s22, 24576
    buffer_load_dwordx4 v[56:59], v7, s[8:11], s19 offen
    s_add_u32 s19, s22, 40960
    buffer_load_dwordx4 v[60:63], v7, s[8:11], s19 offen
    s_add_u32 s19, s22, 57344
    buffer_load_dwordx4 v[64:67], v7, s[8:11], s19 offen
    s_add_u32 s19, s22, 73728
    buffer_load_dwordx4 v[68:71], v7, s[8:11], s19 offen
    s_add_u32 s19, s22, 90112
    buffer_load_dwordx4 v[72:75], v7, s[8:11], s19 offen
    s_add_u32 s19, s22, 106496
    buffer_load_dwordx4 v[76:79], v7, s[8:11], s19 offen
    s_add_u32 s19, s22, 122880
    buffer_load_dwordx4 v[80:83], v7, s[8:11], s19 offen
    s_add_u32 s19, s23, 8192
    buffer_load_dwordx4 v[84:87], v7, s[8:11], s19 offen
    ds_read_b128 v[124:127], v6 offset:512
    s_waitcnt vmcnt(9) lgkmcnt(1)
    v_mfma_f32_16x16x32_bf16 v[16:19], v[88:91], v[128:131], v[16:19]
    v_mfma_f32_16x16x32_bf16 v[20:23], v[92:95], v[128:131], v[20:23]
    v_mfma_f32_16x16x32_bf16 v[24:27], v[96:99], v[128:131], v[24:27]
    v_mfma_f32_16x16x32_bf16 v[28:31], v[100:103], v[128:131], v[28:31]
    v_mfma_f32_16x16x32_bf16 v[32:35], v[104:107], v[128:131], v[32:35]
    v_mfma_f32_16x16x32_bf16 v[36:39], v[108:111], v[128:131], v[36:39]
    v_mfma_f32_16x16x32_bf16 v[40:43], v[112:115], v[128:131], v[40:43]
    v_mfma_f32_16x16x32_bf16 v[44:47], v[116:119], v[128:131], v[44:47]
    v_mfma_f32_16x16x32_bf16 v[48:51], v[120:123], v[128:131], v[48:51]
    v_mfma_f32_16x16x32_bf16 v[132:135], v[128:131], v[120:123], v[132:135]
    s_add_u32 s19, s22, 9216
    buffer_load_dwordx4 v[88:91], v7, s[8:11], s19 offen
    s_add_u32 s19, s22, 25600
    buffer_load_dwordx4 v[92:95], v7, s[8:11], s19 offen
    s_add_u32 s19, s22, 41984
    buffer_load_dwordx4 v[96:99], v7, s[8:11], s19 offen
    s_add_u32 s19, s22, 58368
    buffer_load_dwordx4 v[100:103], v7, s[8:11], s19 offen
    s_add_u32 s19, s22, 74752
    buffer_load_dwordx4 v[104:107], v7, s[8:11], s19 offen
    s_add_u32 s19, s22, 91136
    buffer_load_dwordx4 v[108:111], v7, s[8:11], s19 offen
    s_add_u32 s19, s22, 107520
    buffer_load_dwordx4 v[112:115], v7, s[8:11], s19 offen
    s_add_u32 s19, s22, 123904
    buffer_load_dwordx4 v[116:119], v7, s[8:11], s19 offen
    s_add_u32 s19, s23, 9216
    buffer_load_dwordx4 v[120:123], v7, s[8:11], s19 offen
    ds_read_b128 v[128:131], v6 offset:576
    s_waitcnt vmcnt(9) lgkmcnt(1)
    v_mfma_f32_16x16x32_bf16 v[16:19], v[52:55], v[124:127], v[16:19]
    v_mfma_f32_16x16x32_bf16 v[20:23], v[56:59], v[124:127], v[20:23]
    v_mfma_f32_16x16x32_bf16 v[24:27], v[60:63], v[124:127], v[24:27]
    v_mfma_f32_16x16x32_bf16 v[28:31], v[64:67], v[124:127], v[28:31]
    v_mfma_f32_16x16x32_bf16 v[32:35], v[68:71], v[124:127], v[32:35]
    v_mfma_f32_16x16x32_bf16 v[36:39], v[72:75], v[124:127], v[36:39]
    v_mfma_f32_16x16x32_bf16 v[40:43], v[76:79], v[124:127], v[40:43]
    v_mfma_f32_16x16x32_bf16 v[44:47], v[80:83], v[124:127], v[44:47]
    v_mfma_f32_16x16x32_bf16 v[48:51], v[84:87], v[124:127], v[48:51]
    v_mfma_f32_16x16x32_bf16 v[132:135], v[124:127], v[84:87], v[132:135]
    s_add_u32 s19, s22, 10240
    buffer_load_dwordx4 v[52:55], v7, s[8:11], s19 offen
    s_add_u32 s19, s22, 26624
    buffer_load_dwordx4 v[56:59], v7, s[8:11], s19 offen
    s_add_u32 s19, s22, 43008
    buffer_load_dwordx4 v[60:63], v7, s[8:11], s19 offen
    s_add_u32 s19, s22, 59392
    buffer_load_dwordx4 v[64:67], v7, s[8:11], s19 offen
    s_add_u32 s19, s22, 75776
    buffer_load_dwordx4 v[68:71], v7, s[8:11], s19 offen
    s_add_u32 s19, s22, 92160
    buffer_load_dwordx4 v[72:75], v7, s[8:11], s19 offen
    s_add_u32 s19, s22, 108544
    buffer_load_dwordx4 v[76:79], v7, s[8:11], s19 offen
    s_add_u32 s19, s22, 124928
    buffer_load_dwordx4 v[80:83], v7, s[8:11], s19 offen
    s_add_u32 s19, s23, 10240
    buffer_load_dwordx4 v[84:87], v7, s[8:11], s19 offen
    ds_read_b128 v[124:127], v6 offset:640
    s_waitcnt vmcnt(9) lgkmcnt(1)
    v_mfma_f32_16x16x32_bf16 v[16:19], v[88:91], v[128:131], v[16:19]
    v_mfma_f32_16x16x32_bf16 v[20:23], v[92:95], v[128:131], v[20:23]
    v_mfma_f32_16x16x32_bf16 v[24:27], v[96:99], v[128:131], v[24:27]
    v_mfma_f32_16x16x32_bf16 v[28:31], v[100:103], v[128:131], v[28:31]
    v_mfma_f32_16x16x32_bf16 v[32:35], v[104:107], v[128:131], v[32:35]
    v_mfma_f32_16x16x32_bf16 v[36:39], v[108:111], v[128:131], v[36:39]
    v_mfma_f32_16x16x32_bf16 v[40:43], v[112:115], v[128:131], v[40:43]
    v_mfma_f32_16x16x32_bf16 v[44:47], v[116:119], v[128:131], v[44:47]
    v_mfma_f32_16x16x32_bf16 v[48:51], v[120:123], v[128:131], v[48:51]
    v_mfma_f32_16x16x32_bf16 v[132:135], v[128:131], v[120:123], v[132:135]
    s_add_u32 s19, s22, 11264
    buffer_load_dwordx4 v[88:91], v7, s[8:11], s19 offen
    s_add_u32 s19, s22, 27648
    buffer_load_dwordx4 v[92:95], v7, s[8:11], s19 offen
    s_add_u32 s19, s22, 44032
    buffer_load_dwordx4 v[96:99], v7, s[8:11], s19 offen
    s_add_u32 s19, s22, 60416
    buffer_load_dwordx4 v[100:103], v7, s[8:11], s19 offen
    s_add_u32 s19, s22, 76800
    buffer_load_dwordx4 v[104:107], v7, s[8:11], s19 offen
    s_add_u32 s19, s22, 93184
    buffer_load_dwordx4 v[108:111], v7, s[8:11], s19 offen
    s_add_u32 s19, s22, 109568
    buffer_load_dwordx4 v[112:115], v7, s[8:11], s19 offen
    s_add_u32 s19, s22, 125952
    buffer_load_dwordx4 v[116:119], v7, s[8:11], s19 offen
    s_add_u32 s19, s23, 11264
    buffer_load_dwordx4 v[120:123], v7, s[8:11], s19 offen
    ds_read_b128 v[128:131], v6 offset:704
    s_waitcnt vmcnt(9) lgkmcnt(1)
    v_mfma_f32_16x16x32_bf16 v[16:19], v[52:55], v[124:127], v[16:19]
    v_mfma_f32_16x16x32_bf16 v[20:23], v[56:59], v[124:127], v[20:23]
    v_mfma_f32_16x16x32_bf16 v[24:27], v[60:63], v[124:127], v[24:27]
    v_mfma_f32_16x16x32_bf16 v[28:31], v[64:67], v[124:127], v[28:31]
    v_mfma_f32_16x16x32_bf16 v[32:35], v[68:71], v[124:127], v[32:35]
    v_mfma_f32_16x16x32_bf16 v[36:39], v[72:75], v[124:127], v[36:39]
    v_mfma_f32_16x16x32_bf16 v[40:43], v[76:79], v[124:127], v[40:43]
    v_mfma_f32_16x16x32_bf16 v[44:47], v[80:83], v[124:127], v[44:47]
    v_mfma_f32_16x16x32_bf16 v[48:51], v[84:87], v[124:127], v[48:51]
    v_mfma_f32_16x16x32_bf16 v[132:135], v[124:127], v[84:87], v[132:135]
    s_add_u32 s19, s22, 12288
    buffer_load_dwordx4 v[52:55], v7, s[8:11], s19 offen
    s_add_u32 s19, s22, 28672
    buffer_load_dwordx4 v[56:59], v7, s[8:11], s19 offen
    s_add_u32 s19, s22, 45056
    buffer_load_dwordx4 v[60:63], v7, s[8:11], s19 offen
    s_add_u32 s19, s22, 61440
    buffer_load_dwordx4 v[64:67], v7, s[8:11], s19 offen
    s_add_u32 s19, s22, 77824
    buffer_load_dwordx4 v[68:71], v7, s[8:11], s19 offen
    s_add_u32 s19, s22, 94208
    buffer_load_dwordx4 v[72:75], v7, s[8:11], s19 offen
    s_add_u32 s19, s22, 110592
    buffer_load_dwordx4 v[76:79], v7, s[8:11], s19 offen
    s_add_u32 s19, s22, 126976
    buffer_load_dwordx4 v[80:83], v7, s[8:11], s19 offen
    s_add_u32 s19, s23, 12288
    buffer_load_dwordx4 v[84:87], v7, s[8:11], s19 offen
    ds_read_b128 v[124:127], v6 offset:768
    s_waitcnt vmcnt(9) lgkmcnt(1)
    v_mfma_f32_16x16x32_bf16 v[16:19], v[88:91], v[128:131], v[16:19]
    v_mfma_f32_16x16x32_bf16 v[20:23], v[92:95], v[128:131], v[20:23]
    v_mfma_f32_16x16x32_bf16 v[24:27], v[96:99], v[128:131], v[24:27]
    v_mfma_f32_16x16x32_bf16 v[28:31], v[100:103], v[128:131], v[28:31]
    v_mfma_f32_16x16x32_bf16 v[32:35], v[104:107], v[128:131], v[32:35]
    v_mfma_f32_16x16x32_bf16 v[36:39], v[108:111], v[128:131], v[36:39]
    v_mfma_f32_16x16x32_bf16 v[40:43], v[112:115], v[128:131], v[40:43]
    v_mfma_f32_16x16x32_bf16 v[44:47], v[116:119], v[128:131], v[44:47]
    v_mfma_f32_16x16x32_bf16 v[48:51], v[120:123], v[128:131], v[48:51]
    v_mfma_f32_16x16x32_bf16 v[132:135], v[128:131], v[120:123], v[132:135]
    s_add_u32 s19, s22, 13312
    buffer_load_dwordx4 v[88:91], v7, s[8:11], s19 offen
    s_add_u32 s19, s22, 29696
    buffer_load_dwordx4 v[92:95], v7, s[8:11], s19 offen
    s_add_u32 s19, s22, 46080
    buffer_load_dwordx4 v[96:99], v7, s[8:11], s19 offen
    s_add_u32 s19, s22, 62464
    buffer_load_dwordx4 v[100:103], v7, s[8:11], s19 offen
    s_add_u32 s19, s22, 78848
    buffer_load_dwordx4 v[104:107], v7, s[8:11], s19 offen
    s_add_u32 s19, s22, 95232
    buffer_load_dwordx4 v[108:111], v7, s[8:11], s19 offen
    s_add_u32 s19, s22, 111616
    buffer_load_dwordx4 v[112:115], v7, s[8:11], s19 offen
    s_add_u32 s19, s22, 128000
    buffer_load_dwordx4 v[116:119], v7, s[8:11], s19 offen
    s_add_u32 s19, s23, 13312
    buffer_load_dwordx4 v[120:123], v7, s[8:11], s19 offen
    ds_read_b128 v[128:131], v6 offset:832
    s_waitcnt vmcnt(9) lgkmcnt(1)
    v_mfma_f32_16x16x32_bf16 v[16:19], v[52:55], v[124:127], v[16:19]
    v_mfma_f32_16x16x32_bf16 v[20:23], v[56:59], v[124:127], v[20:23]
    v_mfma_f32_16x16x32_bf16 v[24:27], v[60:63], v[124:127], v[24:27]
    v_mfma_f32_16x16x32_bf16 v[28:31], v[64:67], v[124:127], v[28:31]
    v_mfma_f32_16x16x32_bf16 v[32:35], v[68:71], v[124:127], v[32:35]
    v_mfma_f32_16x16x32_bf16 v[36:39], v[72:75], v[124:127], v[36:39]
    v_mfma_f32_16x16x32_bf16 v[40:43], v[76:79], v[124:127], v[40:43]
    v_mfma_f32_16x16x32_bf16 v[44:47], v[80:83], v[124:127], v[44:47]
    v_mfma_f32_16x16x32_bf16 v[48:51], v[84:87], v[124:127], v[48:51]
    v_mfma_f32_16x16x32_bf16 v[132:135], v[124:127], v[84:87], v[132:135]
    s_add_u32 s19, s22, 14336
    buffer_load_dwordx4 v[52:55], v7, s[8:11], s19 offen
    s_add_u32 s19, s22, 30720
    buffer_load_dwordx4 v[56:59], v7, s[8:11], s19 offen
    s_add_u32 s19, s22, 47104
    buffer_load_dwordx4 v[60:63], v7, s[8:11], s19 offen
    s_add_u32 s19, s22, 63488
    buffer_load_dwordx4 v[64:67], v7, s[8:11], s19 offen
    s_add_u32 s19, s22, 79872
    buffer_load_dwordx4 v[68:71], v7, s[8:11], s19 offen
    s_add_u32 s19, s22, 96256
    buffer_load_dwordx4 v[72:75], v7, s[8:11], s19 offen
    s_add_u32 s19, s22, 112640
    buffer_load_dwordx4 v[76:79], v7, s[8:11], s19 offen
    s_add_u32 s19, s22, 129024
    buffer_load_dwordx4 v[80:83], v7, s[8:11], s19 offen
    s_add_u32 s19, s23, 14336
    buffer_load_dwordx4 v[84:87], v7, s[8:11], s19 offen
    ds_read_b128 v[124:127], v6 offset:896
    s_waitcnt vmcnt(9) lgkmcnt(1)
    v_mfma_f32_16x16x32_bf16 v[16:19], v[88:91], v[128:131], v[16:19]
    v_mfma_f32_16x16x32_bf16 v[20:23], v[92:95], v[128:131], v[20:23]
    v_mfma_f32_16x16x32_bf16 v[24:27], v[96:99], v[128:131], v[24:27]
    v_mfma_f32_16x16x32_bf16 v[28:31], v[100:103], v[128:131], v[28:31]
    v_mfma_f32_16x16x32_bf16 v[32:35], v[104:107], v[128:131], v[32:35]
    v_mfma_f32_16x16x32_bf16 v[36:39], v[108:111], v[128:131], v[36:39]
    v_mfma_f32_16x16x32_bf16 v[40:43], v[112:115], v[128:131], v[40:43]
    v_mfma_f32_16x16x32_bf16 v[44:47], v[116:119], v[128:131], v[44:47]
    v_mfma_f32_16x16x32_bf16 v[48:51], v[120:123], v[128:131], v[48:51]
    v_mfma_f32_16x16x32_bf16 v[132:135], v[128:131], v[120:123], v[132:135]
    s_add_u32 s19, s22, 15360
    buffer_load_dwordx4 v[88:91], v7, s[8:11], s19 offen
    s_add_u32 s19, s22, 31744
    buffer_load_dwordx4 v[92:95], v7, s[8:11], s19 offen
    s_add_u32 s19, s22, 48128
    buffer_load_dwordx4 v[96:99], v7, s[8:11], s19 offen
    s_add_u32 s19, s22, 64512
    buffer_load_dwordx4 v[100:103], v7, s[8:11], s19 offen
    s_add_u32 s19, s22, 80896
    buffer_load_dwordx4 v[104:107], v7, s[8:11], s19 offen
    s_add_u32 s19, s22, 97280
    buffer_load_dwordx4 v[108:111], v7, s[8:11], s19 offen
    s_add_u32 s19, s22, 113664
    buffer_load_dwordx4 v[112:115], v7, s[8:11], s19 offen
    s_add_u32 s19, s22, 130048
    buffer_load_dwordx4 v[116:119], v7, s[8:11], s19 offen
    s_add_u32 s19, s23, 15360
    buffer_load_dwordx4 v[120:123], v7, s[8:11], s19 offen
    ds_read_b128 v[128:131], v6 offset:960
    s_waitcnt vmcnt(9) lgkmcnt(1)
    v_mfma_f32_16x16x32_bf16 v[16:19], v[52:55], v[124:127], v[16:19]
    v_mfma_f32_16x16x32_bf16 v[20:23], v[56:59], v[124:127], v[20:23]
    v_mfma_f32_16x16x32_bf16 v[24:27], v[60:63], v[124:127], v[24:27]
    v_mfma_f32_16x16x32_bf16 v[28:31], v[64:67], v[124:127], v[28:31]
    v_mfma_f32_16x16x32_bf16 v[32:35], v[68:71], v[124:127], v[32:35]
    v_mfma_f32_16x16x32_bf16 v[36:39], v[72:75], v[124:127], v[36:39]
    v_mfma_f32_16x16x32_bf16 v[40:43], v[76:79], v[124:127], v[40:43]
    v_mfma_f32_16x16x32_bf16 v[44:47], v[80:83], v[124:127], v[44:47]
    v_mfma_f32_16x16x32_bf16 v[48:51], v[84:87], v[124:127], v[48:51]
    v_mfma_f32_16x16x32_bf16 v[132:135], v[124:127], v[84:87], v[132:135]
    s_waitcnt vmcnt(0) lgkmcnt(0)
    v_mfma_f32_16x16x32_bf16 v[16:19], v[88:91], v[128:131], v[16:19]
    v_mfma_f32_16x16x32_bf16 v[20:23], v[92:95], v[128:131], v[20:23]
    v_mfma_f32_16x16x32_bf16 v[24:27], v[96:99], v[128:131], v[24:27]
    v_mfma_f32_16x16x32_bf16 v[28:31], v[100:103], v[128:131], v[28:31]
    v_mfma_f32_16x16x32_bf16 v[32:35], v[104:107], v[128:131], v[32:35]
    v_mfma_f32_16x16x32_bf16 v[36:39], v[108:111], v[128:131], v[36:39]
    v_mfma_f32_16x16x32_bf16 v[40:43], v[112:115], v[128:131], v[40:43]
    v_mfma_f32_16x16x32_bf16 v[44:47], v[116:119], v[128:131], v[44:47]
    v_mfma_f32_16x16x32_bf16 v[48:51], v[120:123], v[128:131], v[48:51]
    v_mfma_f32_16x16x32_bf16 v[132:135], v[128:131], v[120:123], v[132:135]
    s_nop 7
    s_mov_b32 s21, 0x3eb8aa3b
    v_lshlrev_b32 v8, 10, v3
    v_lshl_add_u32 v8, v2, 3, v8
    s_lshl_b32 s3, s2, 14
    s_lshl_b32 s19, s16, 8
    s_add_u32 s3, s3, s19
    s_add_u32 s3, s3, 29360128
    v_mul_f32 v16, s21, v16
    v_mul_f32 v17, s21, v17
    v_mul_f32 v18, s21, v18
    v_mul_f32 v19, s21, v19
    v_cvt_pk_bf16_f32 v16, v16, v17
    v_cvt_pk_bf16_f32 v17, v18, v19
    buffer_store_dwordx2 v[16:17], v8, s[8:11], s3 offen offset:0
    v_mul_f32 v20, s21, v20
    v_mul_f32 v21, s21, v21
    v_mul_f32 v22, s21, v22
    v_mul_f32 v23, s21, v23
    v_cvt_pk_bf16_f32 v20, v20, v21
    v_cvt_pk_bf16_f32 v21, v22, v23
    buffer_store_dwordx2 v[20:21], v8, s[8:11], s3 offen offset:32
    v_mul_f32 v24, s21, v24
    v_mul_f32 v25, s21, v25
    v_mul_f32 v26, s21, v26
    v_mul_f32 v27, s21, v27
    v_cvt_pk_bf16_f32 v24, v24, v25
    v_cvt_pk_bf16_f32 v25, v26, v27
    buffer_store_dwordx2 v[24:25], v8, s[8:11], s3 offen offset:64
    v_mul_f32 v28, s21, v28
    v_mul_f32 v29, s21, v29
    v_mul_f32 v30, s21, v30
    v_mul_f32 v31, s21, v31
    v_cvt_pk_bf16_f32 v28, v28, v29
    v_cvt_pk_bf16_f32 v29, v30, v31
    buffer_store_dwordx2 v[28:29], v8, s[8:11], s3 offen offset:96
    v_mul_f32 v32, s21, v32
    v_mul_f32 v33, s21, v33
    v_mul_f32 v34, s21, v34
    v_mul_f32 v35, s21, v35
    v_cvt_pk_bf16_f32 v32, v32, v33
    v_cvt_pk_bf16_f32 v33, v34, v35
    buffer_store_dwordx2 v[32:33], v8, s[8:11], s3 offen offset:128
    v_mul_f32 v36, s21, v36
    v_mul_f32 v37, s21, v37
    v_mul_f32 v38, s21, v38
    v_mul_f32 v39, s21, v39
    v_cvt_pk_bf16_f32 v36, v36, v37
    v_cvt_pk_bf16_f32 v37, v38, v39
    buffer_store_dwordx2 v[36:37], v8, s[8:11], s3 offen offset:160
    v_mul_f32 v40, s21, v40
    v_mul_f32 v41, s21, v41
    v_mul_f32 v42, s21, v42
    v_mul_f32 v43, s21, v43
    v_cvt_pk_bf16_f32 v40, v40, v41
    v_cvt_pk_bf16_f32 v41, v42, v43
    buffer_store_dwordx2 v[40:41], v8, s[8:11], s3 offen offset:192
    v_mul_f32 v44, s21, v44
    v_mul_f32 v45, s21, v45
    v_mul_f32 v46, s21, v46
    v_mul_f32 v47, s21, v47
    v_cvt_pk_bf16_f32 v44, v44, v45
    v_cvt_pk_bf16_f32 v45, v46, v47
    buffer_store_dwordx2 v[44:45], v8, s[8:11], s3 offen offset:224
    s_cmp_eq_u32 s16, 1
    s_cbranch_scc1 L_ka1_v_8
    s_cmp_lg_u32 s16, 0
    s_cbranch_scc1 L_ka1_end_7
    v_cvt_pk_bf16_f32 v48, v48, v49
    v_cvt_pk_bf16_f32 v49, v50, v51
    v_lshlrev_b32 v8, 5, v3
    v_lshl_add_u32 v8, v2, 3, v8
    s_lshl_b32 s3, s2, 9
    s_add_u32 s3, s3, 33554432
    buffer_store_dwordx2 v[48:49], v8, s[8:11], s3 offen
    s_branch L_ka1_end_7
L_ka1_v_8:
    v_cvt_pk_bf16_f32 v132, v132, v133
    v_cvt_pk_bf16_f32 v133, v134, v135
    v_and_b32 v8, 1, v2
    v_lshlrev_b32 v8, 8, v8
    v_lshl_add_u32 v8, v3, 4, v8
    v_lshrrev_b32 v9, 1, v2
    v_lshl_add_u32 v8, v9, 3, v8
    s_lshl_b32 s3, s2, 9
    s_add_u32 s3, s3, 33619968
    buffer_store_dwordx2 v[132:133], v8, s[8:11], s3 offen
L_ka1_end_7:
    s_endpgm
.section .rodata,"a"
.p2align 6
.amdhsa_kernel ka1_0_kernel
  .amdhsa_next_free_vgpr 136
  .amdhsa_next_free_sgpr 102
  .amdhsa_accum_offset 136
  .amdhsa_group_segment_fixed_size 0
  .amdhsa_kernarg_size 120
  .amdhsa_user_sgpr_count 2
  .amdhsa_user_sgpr_kernarg_segment_ptr 1
  .amdhsa_system_sgpr_workgroup_id_x 1
.end_amdhsa_kernel
.text

.p2align 8
.globl ka1_1_kernel
.type ka1_1_kernel,@function
ka1_1_kernel:
    s_cmp_ge_u32 s2, 128
    s_cbranch_scc1 L_ka1_end_9
    s_load_dwordx2 s[4:5], s[0:1], 112
    s_load_dwordx2 s[6:7], s[0:1], 0
    v_and_b32 v1, 63, v0
    v_lshrrev_b32 v2, 6, v0
    s_nop 0
    v_readfirstlane_b32 s16, v2
    v_lshrrev_b32 v2, 4, v1
    v_and_b32 v3, 15, v1
    s_waitcnt lgkmcnt(0)
    s_mov_b32 s8, s4
    s_and_b32 s9, s5, 0xffff
    s_mov_b32 s10, 268435456
    s_mov_b32 s11, 0x00020000
    s_mov_b32 s12, s6
    s_and_b32 s13, s7, 0xffff
    s_mov_b32 s14, 2097152
    s_mov_b32 s15, 0x00020000
    s_lshl_b32 s3, s2, 14
    s_lshl_b32 s19, s16, 12
    s_add_u32 s3, s3, s19
    v_lshlrev_b32 v4, 10, v2
    v_lshl_add_u32 v4, v3, 6, v4
    s_add_u32 s3, s3, 23068672
    buffer_load_dwordx4 v[16:19], v4, s[8:11], s3 offen offset:0
    buffer_load_dwordx4 v[20:23], v4, s[8:11], s3 offen offset:16
    buffer_load_dwordx4 v[24:27], v4, s[8:11], s3 offen offset:32
    buffer_load_dwordx4 v[28:31], v4, s[8:11], s3 offen offset:48
    s_waitcnt vmcnt(0)
    v_lshlrev_b32 v64, 16, v16
    v_and_b32 v65, 0xffff0000, v16
    v_lshlrev_b32 v66, 16, v17
    v_and_b32 v67, 0xffff0000, v17
    v_lshlrev_b32 v68, 16, v18
    v_and_b32 v69, 0xffff0000, v18
    v_lshlrev_b32 v70, 16, v19
    v_and_b32 v71, 0xffff0000, v19
    v_lshlrev_b32 v72, 16, v20
    v_and_b32 v73, 0xffff0000, v20
    v_lshlrev_b32 v74, 16, v21
    v_and_b32 v75, 0xffff0000, v21
    v_lshlrev_b32 v76, 16, v22
    v_and_b32 v77, 0xffff0000, v22
    v_lshlrev_b32 v78, 16, v23
    v_and_b32 v79, 0xffff0000, v23
    v_lshlrev_b32 v80, 16, v24
    v_and_b32 v81, 0xffff0000, v24
    v_lshlrev_b32 v82, 16, v25
    v_and_b32 v83, 0xffff0000, v25
    v_lshlrev_b32 v84, 16, v26
    v_and_b32 v85, 0xffff0000, v26
    v_lshlrev_b32 v86, 16, v27
    v_and_b32 v87, 0xffff0000, v27
    v_lshlrev_b32 v88, 16, v28
    v_and_b32 v89, 0xffff0000, v28
    v_lshlrev_b32 v90, 16, v29
    v_and_b32 v91, 0xffff0000, v29
    v_lshlrev_b32 v92, 16, v30
    v_and_b32 v93, 0xffff0000, v30
    v_lshlrev_b32 v94, 16, v31
    v_and_b32 v95, 0xffff0000, v31
    v_add_f32 v96, v64, v65
    v_add_f32 v96, v96, v66
    v_add_f32 v96, v96, v67
    v_add_f32 v96, v96, v68
    v_add_f32 v96, v96, v69
    v_add_f32 v96, v96, v70
    v_add_f32 v96, v96, v71
    v_add_f32 v96, v96, v72
    v_add_f32 v96, v96, v73
    v_add_f32 v96, v96, v74
    v_add_f32 v96, v96, v75
    v_add_f32 v96, v96, v76
    v_add_f32 v96, v96, v77
    v_add_f32 v96, v96, v78
    v_add_f32 v96, v96, v79
    v_add_f32 v96, v96, v80
    v_add_f32 v96, v96, v81
    v_add_f32 v96, v96, v82
    v_add_f32 v96, v96, v83
    v_add_f32 v96, v96, v84
    v_add_f32 v96, v96, v85
    v_add_f32 v96, v96, v86
    v_add_f32 v96, v96, v87
    v_add_f32 v96, v96, v88
    v_add_f32 v96, v96, v89
    v_add_f32 v96, v96, v90
    v_add_f32 v96, v96, v91
    v_add_f32 v96, v96, v92
    v_add_f32 v96, v96, v93
    v_add_f32 v96, v96, v94
    v_add_f32 v96, v96, v95
    s_nop 1
    v_add_f32_dpp v96, v96, v96 row_ror:8 row_mask:0xf bank_mask:0xf
    s_nop 1
    v_add_f32_dpp v96, v96, v96 row_ror:4 row_mask:0xf bank_mask:0xf
    s_nop 1
    v_add_f32_dpp v96, v96, v96 row_ror:2 row_mask:0xf bank_mask:0xf
    s_nop 1
    v_add_f32_dpp v96, v96, v96 row_ror:1 row_mask:0xf bank_mask:0xf
    v_mul_f32 v97, 0x3b000000, v96
    v_mov_b32 v99, 0
    v_sub_f32 v98, v64, v97
    v_fmac_f32 v99, v98, v98
    v_sub_f32 v98, v65, v97
    v_fmac_f32 v99, v98, v98
    v_sub_f32 v98, v66, v97
    v_fmac_f32 v99, v98, v98
    v_sub_f32 v98, v67, v97
    v_fmac_f32 v99, v98, v98
    v_sub_f32 v98, v68, v97
    v_fmac_f32 v99, v98, v98
    v_sub_f32 v98, v69, v97
    v_fmac_f32 v99, v98, v98
    v_sub_f32 v98, v70, v97
    v_fmac_f32 v99, v98, v98
    v_sub_f32 v98, v71, v97
    v_fmac_f32 v99, v98, v98
    v_sub_f32 v98, v72, v97
    v_fmac_f32 v99, v98, v98
    v_sub_f32 v98, v73, v97
    v_fmac_f32 v99, v98, v98
    v_sub_f32 v98, v74, v97
    v_fmac_f32 v99, v98, v98
    v_sub_f32 v98, v75, v97
    v_fmac_f32 v99, v98, v98
    v_sub_f32 v98, v76, v97
    v_fmac_f32 v99, v98, v98
    v_sub_f32 v98, v77, v97
    v_fmac_f32 v99, v98, v98
    v_sub_f32 v98, v78, v97
    v_fmac_f32 v99, v98, v98
    v_sub_f32 v98, v79, v97
    v_fmac_f32 v99, v98, v98
    v_sub_f32 v98, v80, v97
    v_fmac_f32 v99, v98, v98
    v_sub_f32 v98, v81, v97
    v_fmac_f32 v99, v98, v98
    v_sub_f32 v98, v82, v97
    v_fmac_f32 v99, v98, v98
    v_sub_f32 v98, v83, v97
    v_fmac_f32 v99, v98, v98
    v_sub_f32 v98, v84, v97
    v_fmac_f32 v99, v98, v98
    v_sub_f32 v98, v85, v97
    v_fmac_f32 v99, v98, v98
    v_sub_f32 v98, v86, v97
    v_fmac_f32 v99, v98, v98
    v_sub_f32 v98, v87, v97
    v_fmac_f32 v99, v98, v98
    v_sub_f32 v98, v88, v97
    v_fmac_f32 v99, v98, v98
    v_sub_f32 v98, v89, v97
    v_fmac_f32 v99, v98, v98
    v_sub_f32 v98, v90, v97
    v_fmac_f32 v99, v98, v98
    v_sub_f32 v98, v91, v97
    v_fmac_f32 v99, v98, v98
    v_sub_f32 v98, v92, v97
    v_fmac_f32 v99, v98, v98
    v_sub_f32 v98, v93, v97
    v_fmac_f32 v99, v98, v98
    v_sub_f32 v98, v94, v97
    v_fmac_f32 v99, v98, v98
    v_sub_f32 v98, v95, v97
    v_fmac_f32 v99, v98, v98
    s_nop 1
    v_add_f32_dpp v99, v99, v99 row_ror:8 row_mask:0xf bank_mask:0xf
    s_nop 1
    v_add_f32_dpp v99, v99, v99 row_ror:4 row_mask:0xf bank_mask:0xf
    s_nop 1
    v_add_f32_dpp v99, v99, v99 row_ror:2 row_mask:0xf bank_mask:0xf
    s_nop 1
    v_add_f32_dpp v99, v99, v99 row_ror:1 row_mask:0xf bank_mask:0xf
    v_mul_f32 v99, 0x3b000000, v99
    v_cvt_pk_bf16_f32 v100, v97, v99
    v_lshlrev_b32 v97, 16, v100
    v_and_b32 v99, 0xffff0000, v100
    v_add_f32 v99, 0x3727c5ac, v99
    v_cvt_pk_bf16_f32 v100, v99, v99
    v_lshlrev_b32 v99, 16, v100
    v_sqrt_f32 v99, v99
    s_nop 0
    v_cvt_pk_bf16_f32 v100, v99, v99
    v_lshlrev_b32 v99, 16, v100
    v_rcp_f32 v99, v99
    s_nop 0
    v_sub_f32 v100, v64, v97
    v_sub_f32 v101, v65, v97
    v_cvt_pk_bf16_f32 v102, v100, v101
    v_lshlrev_b32 v100, 16, v102
    v_and_b32 v101, 0xffff0000, v102
    v_mul_f32 v100, v99, v100
    v_mul_f32 v101, v99, v101
    v_cvt_pk_bf16_f32 v16, v100, v101
    v_sub_f32 v100, v66, v97
    v_sub_f32 v101, v67, v97
    v_cvt_pk_bf16_f32 v102, v100, v101
    v_lshlrev_b32 v100, 16, v102
    v_and_b32 v101, 0xffff0000, v102
    v_mul_f32 v100, v99, v100
    v_mul_f32 v101, v99, v101
    v_cvt_pk_bf16_f32 v17, v100, v101
    v_sub_f32 v100, v68, v97
    v_sub_f32 v101, v69, v97
    v_cvt_pk_bf16_f32 v102, v100, v101
    v_lshlrev_b32 v100, 16, v102
    v_and_b32 v101, 0xffff0000, v102
    v_mul_f32 v100, v99, v100
    v_mul_f32 v101, v99, v101
    v_cvt_pk_bf16_f32 v18, v100, v101
    v_sub_f32 v100, v70, v97
    v_sub_f32 v101, v71, v97
    v_cvt_pk_bf16_f32 v102, v100, v101
    v_lshlrev_b32 v100, 16, v102
    v_and_b32 v101, 0xffff0000, v102
    v_mul_f32 v100, v99, v100
    v_mul_f32 v101, v99, v101
    v_cvt_pk_bf16_f32 v19, v100, v101
    v_sub_f32 v100, v72, v97
    v_sub_f32 v101, v73, v97
    v_cvt_pk_bf16_f32 v102, v100, v101
    v_lshlrev_b32 v100, 16, v102
    v_and_b32 v101, 0xffff0000, v102
    v_mul_f32 v100, v99, v100
    v_mul_f32 v101, v99, v101
    v_cvt_pk_bf16_f32 v20, v100, v101
    v_sub_f32 v100, v74, v97
    v_sub_f32 v101, v75, v97
    v_cvt_pk_bf16_f32 v102, v100, v101
    v_lshlrev_b32 v100, 16, v102
    v_and_b32 v101, 0xffff0000, v102
    v_mul_f32 v100, v99, v100
    v_mul_f32 v101, v99, v101
    v_cvt_pk_bf16_f32 v21, v100, v101
    v_sub_f32 v100, v76, v97
    v_sub_f32 v101, v77, v97
    v_cvt_pk_bf16_f32 v102, v100, v101
    v_lshlrev_b32 v100, 16, v102
    v_and_b32 v101, 0xffff0000, v102
    v_mul_f32 v100, v99, v100
    v_mul_f32 v101, v99, v101
    v_cvt_pk_bf16_f32 v22, v100, v101
    v_sub_f32 v100, v78, v97
    v_sub_f32 v101, v79, v97
    v_cvt_pk_bf16_f32 v102, v100, v101
    v_lshlrev_b32 v100, 16, v102
    v_and_b32 v101, 0xffff0000, v102
    v_mul_f32 v100, v99, v100
    v_mul_f32 v101, v99, v101
    v_cvt_pk_bf16_f32 v23, v100, v101
    v_sub_f32 v100, v80, v97
    v_sub_f32 v101, v81, v97
    v_cvt_pk_bf16_f32 v102, v100, v101
    v_lshlrev_b32 v100, 16, v102
    v_and_b32 v101, 0xffff0000, v102
    v_mul_f32 v100, v99, v100
    v_mul_f32 v101, v99, v101
    v_cvt_pk_bf16_f32 v24, v100, v101
    v_sub_f32 v100, v82, v97
    v_sub_f32 v101, v83, v97
    v_cvt_pk_bf16_f32 v102, v100, v101
    v_lshlrev_b32 v100, 16, v102
    v_and_b32 v101, 0xffff0000, v102
    v_mul_f32 v100, v99, v100
    v_mul_f32 v101, v99, v101
    v_cvt_pk_bf16_f32 v25, v100, v101
    v_sub_f32 v100, v84, v97
    v_sub_f32 v101, v85, v97
    v_cvt_pk_bf16_f32 v102, v100, v101
    v_lshlrev_b32 v100, 16, v102
    v_and_b32 v101, 0xffff0000, v102
    v_mul_f32 v100, v99, v100
    v_mul_f32 v101, v99, v101
    v_cvt_pk_bf16_f32 v26, v100, v101
    v_sub_f32 v100, v86, v97
    v_sub_f32 v101, v87, v97
    v_cvt_pk_bf16_f32 v102, v100, v101
    v_lshlrev_b32 v100, 16, v102
    v_and_b32 v101, 0xffff0000, v102
    v_mul_f32 v100, v99, v100
    v_mul_f32 v101, v99, v101
    v_cvt_pk_bf16_f32 v27, v100, v101
    v_sub_f32 v100, v88, v97
    v_sub_f32 v101, v89, v97
    v_cvt_pk_bf16_f32 v102, v100, v101
    v_lshlrev_b32 v100, 16, v102
    v_and_b32 v101, 0xffff0000, v102
    v_mul_f32 v100, v99, v100
    v_mul_f32 v101, v99, v101
    v_cvt_pk_bf16_f32 v28, v100, v101
    v_sub_f32 v100, v90, v97
    v_sub_f32 v101, v91, v97
    v_cvt_pk_bf16_f32 v102, v100, v101
    v_lshlrev_b32 v100, 16, v102
    v_and_b32 v101, 0xffff0000, v102
    v_mul_f32 v100, v99, v100
    v_mul_f32 v101, v99, v101
    v_cvt_pk_bf16_f32 v29, v100, v101
    v_sub_f32 v100, v92, v97
    v_sub_f32 v101, v93, v97
    v_cvt_pk_bf16_f32 v102, v100, v101
    v_lshlrev_b32 v100, 16, v102
    v_and_b32 v101, 0xffff0000, v102
    v_mul_f32 v100, v99, v100
    v_mul_f32 v101, v99, v101
    v_cvt_pk_bf16_f32 v30, v100, v101
    v_sub_f32 v100, v94, v97
    v_sub_f32 v101, v95, v97
    v_cvt_pk_bf16_f32 v102, v100, v101
    v_lshlrev_b32 v100, 16, v102
    v_and_b32 v101, 0xffff0000, v102
    v_mul_f32 v100, v99, v100
    v_mul_f32 v101, v99, v101
    v_cvt_pk_bf16_f32 v31, v100, v101
    s_lshl_b32 s19, s16, 2
    v_add_u32 v5, s19, v2
    v_mul_u32_u24 v5, 1040, v5
    v_lshl_add_u32 v5, v3, 6, v5
    ds_write_b128 v5, v[16:19] offset:0
    ds_write_b128 v5, v[20:23] offset:16
    ds_write_b128 v5, v[24:27] offset:32
    ds_write_b128 v5, v[28:31] offset:48
    s_waitcnt lgkmcnt(0)
    s_barrier
    v_mul_u32_u24 v6, 1040, v3
    v_lshl_add_u32 v6, v2, 4, v6
    v_lshlrev_b32 v7, 4, v1
    s_lshl_b32 s22, s16, 17
    s_add_u32 s22, s22, 16777216
    s_lshl_b32 s23, s16, 14
    s_add_u32 s23, s23, 17301504
    s_add_u32 s19, s22, 0
    buffer_load_dwordx4 v[52:55], v7, s[8:11], s19 offen
    s_add_u32 s19, s22, 16384
    buffer_load_dwordx4 v[56:59], v7, s[8:11], s19 offen
    s_add_u32 s19, s22, 32768
    buffer_load_dwordx4 v[60:63], v7, s[8:11], s19 offen
    s_add_u32 s19, s22, 49152
    buffer_load_dwordx4 v[64:67], v7, s[8:11], s19 offen
    s_add_u32 s19, s22, 65536
    buffer_load_dwordx4 v[68:71], v7, s[8:11], s19 offen
    s_add_u32 s19, s22, 81920
    buffer_load_dwordx4 v[72:75], v7, s[8:11], s19 offen
    s_add_u32 s19, s22, 98304
    buffer_load_dwordx4 v[76:79], v7, s[8:11], s19 offen
    s_add_u32 s19, s22, 114688
    buffer_load_dwordx4 v[80:83], v7, s[8:11], s19 offen
    s_add_u32 s19, s23, 0
    buffer_load_dwordx4 v[84:87], v7, s[8:11], s19 offen
    ds_read_b128 v[124:127], v6
    s_add_u32 s19, s22, 1024
    buffer_load_dwordx4 v[88:91], v7, s[8:11], s19 offen
    s_add_u32 s19, s22, 17408
    buffer_load_dwordx4 v[92:95], v7, s[8:11], s19 offen
    s_add_u32 s19, s22, 33792
    buffer_load_dwordx4 v[96:99], v7, s[8:11], s19 offen
    s_add_u32 s19, s22, 50176
    buffer_load_dwordx4 v[100:103], v7, s[8:11], s19 offen
    s_add_u32 s19, s22, 66560
    buffer_load_dwordx4 v[104:107], v7, s[8:11], s19 offen
    s_add_u32 s19, s22, 82944
    buffer_load_dwordx4 v[108:111], v7, s[8:11], s19 offen
    s_add_u32 s19, s22, 99328
    buffer_load_dwordx4 v[112:115], v7, s[8:11], s19 offen
    s_add_u32 s19, s22, 115712
    buffer_load_dwordx4 v[116:119], v7, s[8:11], s19 offen
    s_add_u32 s19, s23, 1024
    buffer_load_dwordx4 v[120:123], v7, s[8:11], s19 offen
    ds_read_b128 v[128:131], v6 offset:64
    s_waitcnt vmcnt(9) lgkmcnt(1)
    v_mfma_f32_16x16x32_bf16 v[16:19], v[52:55], v[124:127], 0
    v_mfma_f32_16x16x32_bf16 v[20:23], v[56:59], v[124:127], 0
    v_mfma_f32_16x16x32_bf16 v[24:27], v[60:63], v[124:127], 0
    v_mfma_f32_16x16x32_bf16 v[28:31], v[64:67], v[124:127], 0
    v_mfma_f32_16x16x32_bf16 v[32:35], v[68:71], v[124:127], 0
    v_mfma_f32_16x16x32_bf16 v[36:39], v[72:75], v[124:127], 0
    v_mfma_f32_16x16x32_bf16 v[40:43], v[76:79], v[124:127], 0
    v_mfma_f32_16x16x32_bf16 v[44:47], v[80:83], v[124:127], 0
    v_mfma_f32_16x16x32_bf16 v[48:51], v[84:87], v[124:127], 0
    v_mfma_f32_16x16x32_bf16 v[132:135], v[124:127], v[84:87], 0
    s_add_u32 s19, s22, 2048
    buffer_load_dwordx4 v[52:55], v7, s[8:11], s19 offen
    s_add_u32 s19, s22, 18432
    buffer_load_dwordx4 v[56:59], v7, s[8:11], s19 offen
    s_add_u32 s19, s22, 34816
    buffer_load_dwordx4 v[60:63], v7, s[8:11], s19 offen
    s_add_u32 s19, s22, 51200
    buffer_load_dwordx4 v[64:67], v7, s[8:11], s19 offen
    s_add_u32 s19, s22, 67584
    buffer_load_dwordx4 v[68:71], v7, s[8:11], s19 offen
    s_add_u32 s19, s22, 83968
    buffer_load_dwordx4 v[72:75], v7, s[8:11], s19 offen
    s_add_u32 s19, s22, 100352
    buffer_load_dwordx4 v[76:79], v7, s[8:11], s19 offen
    s_add_u32 s19, s22, 116736
    buffer_load_dwordx4 v[80:83], v7, s[8:11], s19 offen
    s_add_u32 s19, s23, 2048
    buffer_load_dwordx4 v[84:87], v7, s[8:11], s19 offen
    ds_read_b128 v[124:127], v6 offset:128
    s_waitcnt vmcnt(9) lgkmcnt(1)
    v_mfma_f32_16x16x32_bf16 v[16:19], v[88:91], v[128:131], v[16:19]
    v_mfma_f32_16x16x32_bf16 v[20:23], v[92:95], v[128:131], v[20:23]
    v_mfma_f32_16x16x32_bf16 v[24:27], v[96:99], v[128:131], v[24:27]
    v_mfma_f32_16x16x32_bf16 v[28:31], v[100:103], v[128:131], v[28:31]
    v_mfma_f32_16x16x32_bf16 v[32:35], v[104:107], v[128:131], v[32:35]
    v_mfma_f32_16x16x32_bf16 v[36:39], v[108:111], v[128:131], v[36:39]
    v_mfma_f32_16x16x32_bf16 v[40:43], v[112:115], v[128:131], v[40:43]
    v_mfma_f32_16x16x32_bf16 v[44:47], v[116:119], v[128:131], v[44:47]
    v_mfma_f32_16x16x32_bf16 v[48:51], v[120:123], v[128:131], v[48:51]
    v_mfma_f32_16x16x32_bf16 v[132:135], v[128:131], v[120:123], v[132:135]
    s_add_u32 s19, s22, 3072
    buffer_load_dwordx4 v[88:91], v7, s[8:11], s19 offen
    s_add_u32 s19, s22, 19456
    buffer_load_dwordx4 v[92:95], v7, s[8:11], s19 offen
    s_add_u32 s19, s22, 35840
    buffer_load_dwordx4 v[96:99], v7, s[8:11], s19 offen
    s_add_u32 s19, s22, 52224
    buffer_load_dwordx4 v[100:103], v7, s[8:11], s19 offen
    s_add_u32 s19, s22, 68608
    buffer_load_dwordx4 v[104:107], v7, s[8:11], s19 offen
    s_add_u32 s19, s22, 84992
    buffer_load_dwordx4 v[108:111], v7, s[8:11], s19 offen
    s_add_u32 s19, s22, 101376
    buffer_load_dwordx4 v[112:115], v7, s[8:11], s19 offen
    s_add_u32 s19, s22, 117760
    buffer_load_dwordx4 v[116:119], v7, s[8:11], s19 offen
    s_add_u32 s19, s23, 3072
    buffer_load_dwordx4 v[120:123], v7, s[8:11], s19 offen
    ds_read_b128 v[128:131], v6 offset:192
    s_waitcnt vmcnt(9) lgkmcnt(1)
    v_mfma_f32_16x16x32_bf16 v[16:19], v[52:55], v[124:127], v[16:19]
    v_mfma_f32_16x16x32_bf16 v[20:23], v[56:59], v[124:127], v[20:23]
    v_mfma_f32_16x16x32_bf16 v[24:27], v[60:63], v[124:127], v[24:27]
    v_mfma_f32_16x16x32_bf16 v[28:31], v[64:67], v[124:127], v[28:31]
    v_mfma_f32_16x16x32_bf16 v[32:35], v[68:71], v[124:127], v[32:35]
    v_mfma_f32_16x16x32_bf16 v[36:39], v[72:75], v[124:127], v[36:39]
    v_mfma_f32_16x16x32_bf16 v[40:43], v[76:79], v[124:127], v[40:43]
    v_mfma_f32_16x16x32_bf16 v[44:47], v[80:83], v[124:127], v[44:47]
    v_mfma_f32_16x16x32_bf16 v[48:51], v[84:87], v[124:127], v[48:51]
    v_mfma_f32_16x16x32_bf16 v[132:135], v[124:127], v[84:87], v[132:135]
    s_add_u32 s19, s22, 4096
    buffer_load_dwordx4 v[52:55], v7, s[8:11], s19 offen
    s_add_u32 s19, s22, 20480
    buffer_load_dwordx4 v[56:59], v7, s[8:11], s19 offen
    s_add_u32 s19, s22, 36864
    buffer_load_dwordx4 v[60:63], v7, s[8:11], s19 offen
    s_add_u32 s19, s22, 53248
    buffer_load_dwordx4 v[64:67], v7, s[8:11], s19 offen
    s_add_u32 s19, s22, 69632
    buffer_load_dwordx4 v[68:71], v7, s[8:11], s19 offen
    s_add_u32 s19, s22, 86016
    buffer_load_dwordx4 v[72:75], v7, s[8:11], s19 offen
    s_add_u32 s19, s22, 102400
    buffer_load_dwordx4 v[76:79], v7, s[8:11], s19 offen
    s_add_u32 s19, s22, 118784
    buffer_load_dwordx4 v[80:83], v7, s[8:11], s19 offen
    s_add_u32 s19, s23, 4096
    buffer_load_dwordx4 v[84:87], v7, s[8:11], s19 offen
    ds_read_b128 v[124:127], v6 offset:256
    s_waitcnt vmcnt(9) lgkmcnt(1)
    v_mfma_f32_16x16x32_bf16 v[16:19], v[88:91], v[128:131], v[16:19]
    v_mfma_f32_16x16x32_bf16 v[20:23], v[92:95], v[128:131], v[20:23]
    v_mfma_f32_16x16x32_bf16 v[24:27], v[96:99], v[128:131], v[24:27]
    v_mfma_f32_16x16x32_bf16 v[28:31], v[100:103], v[128:131], v[28:31]
    v_mfma_f32_16x16x32_bf16 v[32:35], v[104:107], v[128:131], v[32:35]
    v_mfma_f32_16x16x32_bf16 v[36:39], v[108:111], v[128:131], v[36:39]
    v_mfma_f32_16x16x32_bf16 v[40:43], v[112:115], v[128:131], v[40:43]
    v_mfma_f32_16x16x32_bf16 v[44:47], v[116:119], v[128:131], v[44:47]
    v_mfma_f32_16x16x32_bf16 v[48:51], v[120:123], v[128:131], v[48:51]
    v_mfma_f32_16x16x32_bf16 v[132:135], v[128:131], v[120:123], v[132:135]
    s_add_u32 s19, s22, 5120
    buffer_load_dwordx4 v[88:91], v7, s[8:11], s19 offen
    s_add_u32 s19, s22, 21504
    buffer_load_dwordx4 v[92:95], v7, s[8:11], s19 offen
    s_add_u32 s19, s22, 37888
    buffer_load_dwordx4 v[96:99], v7, s[8:11], s19 offen
    s_add_u32 s19, s22, 54272
    buffer_load_dwordx4 v[100:103], v7, s[8:11], s19 offen
    s_add_u32 s19, s22, 70656
    buffer_load_dwordx4 v[104:107], v7, s[8:11], s19 offen
    s_add_u32 s19, s22, 87040
    buffer_load_dwordx4 v[108:111], v7, s[8:11], s19 offen
    s_add_u32 s19, s22, 103424
    buffer_load_dwordx4 v[112:115], v7, s[8:11], s19 offen
    s_add_u32 s19, s22, 119808
    buffer_load_dwordx4 v[116:119], v7, s[8:11], s19 offen
    s_add_u32 s19, s23, 5120
    buffer_load_dwordx4 v[120:123], v7, s[8:11], s19 offen
    ds_read_b128 v[128:131], v6 offset:320
    s_waitcnt vmcnt(9) lgkmcnt(1)
    v_mfma_f32_16x16x32_bf16 v[16:19], v[52:55], v[124:127], v[16:19]
    v_mfma_f32_16x16x32_bf16 v[20:23], v[56:59], v[124:127], v[20:23]
    v_mfma_f32_16x16x32_bf16 v[24:27], v[60:63], v[124:127], v[24:27]
    v_mfma_f32_16x16x32_bf16 v[28:31], v[64:67], v[124:127], v[28:31]
    v_mfma_f32_16x16x32_bf16 v[32:35], v[68:71], v[124:127], v[32:35]
    v_mfma_f32_16x16x32_bf16 v[36:39], v[72:75], v[124:127], v[36:39]
    v_mfma_f32_16x16x32_bf16 v[40:43], v[76:79], v[124:127], v[40:43]
    v_mfma_f32_16x16x32_bf16 v[44:47], v[80:83], v[124:127], v[44:47]
    v_mfma_f32_16x16x32_bf16 v[48:51], v[84:87], v[124:127], v[48:51]
    v_mfma_f32_16x16x32_bf16 v[132:135], v[124:127], v[84:87], v[132:135]
    s_add_u32 s19, s22, 6144
    buffer_load_dwordx4 v[52:55], v7, s[8:11], s19 offen
    s_add_u32 s19, s22, 22528
    buffer_load_dwordx4 v[56:59], v7, s[8:11], s19 offen
    s_add_u32 s19, s22, 38912
    buffer_load_dwordx4 v[60:63], v7, s[8:11], s19 offen
    s_add_u32 s19, s22, 55296
    buffer_load_dwordx4 v[64:67], v7, s[8:11], s19 offen
    s_add_u32 s19, s22, 71680
    buffer_load_dwordx4 v[68:71], v7, s[8:11], s19 offen
    s_add_u32 s19, s22, 88064
    buffer_load_dwordx4 v[72:75], v7, s[8:11], s19 offen
    s_add_u32 s19, s22, 104448
    buffer_load_dwordx4 v[76:79], v7, s[8:11], s19 offen
    s_add_u32 s19, s22, 120832
    buffer_load_dwordx4 v[80:83], v7, s[8:11], s19 offen
    s_add_u32 s19, s23, 6144
    buffer_load_dwordx4 v[84:87], v7, s[8:11], s19 offen
    ds_read_b128 v[124:127], v6 offset:384
    s_waitcnt vmcnt(9) lgkmcnt(1)
    v_mfma_f32_16x16x32_bf16 v[16:19], v[88:91], v[128:131], v[16:19]
    v_mfma_f32_16x16x32_bf16 v[20:23], v[92:95], v[128:131], v[20:23]
    v_mfma_f32_16x16x32_bf16 v[24:27], v[96:99], v[128:131], v[24:27]
    v_mfma_f32_16x16x32_bf16 v[28:31], v[100:103], v[128:131], v[28:31]
    v_mfma_f32_16x16x32_bf16 v[32:35], v[104:107], v[128:131], v[32:35]
    v_mfma_f32_16x16x32_bf16 v[36:39], v[108:111], v[128:131], v[36:39]
    v_mfma_f32_16x16x32_bf16 v[40:43], v[112:115], v[128:131], v[40:43]
    v_mfma_f32_16x16x32_bf16 v[44:47], v[116:119], v[128:131], v[44:47]
    v_mfma_f32_16x16x32_bf16 v[48:51], v[120:123], v[128:131], v[48:51]
    v_mfma_f32_16x16x32_bf16 v[132:135], v[128:131], v[120:123], v[132:135]
    s_add_u32 s19, s22, 7168
    buffer_load_dwordx4 v[88:91], v7, s[8:11], s19 offen
    s_add_u32 s19, s22, 23552
    buffer_load_dwordx4 v[92:95], v7, s[8:11], s19 offen
    s_add_u32 s19, s22, 39936
    buffer_load_dwordx4 v[96:99], v7, s[8:11], s19 offen
    s_add_u32 s19, s22, 56320
    buffer_load_dwordx4 v[100:103], v7, s[8:11], s19 offen
    s_add_u32 s19, s22, 72704
    buffer_load_dwordx4 v[104:107], v7, s[8:11], s19 offen
    s_add_u32 s19, s22, 89088
    buffer_load_dwordx4 v[108:111], v7, s[8:11], s19 offen
    s_add_u32 s19, s22, 105472
    buffer_load_dwordx4 v[112:115], v7, s[8:11], s19 offen
    s_add_u32 s19, s22, 121856
    buffer_load_dwordx4 v[116:119], v7, s[8:11], s19 offen
    s_add_u32 s19, s23, 7168
    buffer_load_dwordx4 v[120:123], v7, s[8:11], s19 offen
    ds_read_b128 v[128:131], v6 offset:448
    s_waitcnt vmcnt(9) lgkmcnt(1)
    v_mfma_f32_16x16x32_bf16 v[16:19], v[52:55], v[124:127], v[16:19]
    v_mfma_f32_16x16x32_bf16 v[20:23], v[56:59], v[124:127], v[20:23]
    v_mfma_f32_16x16x32_bf16 v[24:27], v[60:63], v[124:127], v[24:27]
    v_mfma_f32_16x16x32_bf16 v[28:31], v[64:67], v[124:127], v[28:31]
    v_mfma_f32_16x16x32_bf16 v[32:35], v[68:71], v[124:127], v[32:35]
    v_mfma_f32_16x16x32_bf16 v[36:39], v[72:75], v[124:127], v[36:39]
    v_mfma_f32_16x16x32_bf16 v[40:43], v[76:79], v[124:127], v[40:43]
    v_mfma_f32_16x16x32_bf16 v[44:47], v[80:83], v[124:127], v[44:47]
    v_mfma_f32_16x16x32_bf16 v[48:51], v[84:87], v[124:127], v[48:51]
    v_mfma_f32_16x16x32_bf16 v[132:135], v[124:127], v[84:87], v[132:135]
    s_add_u32 s19, s22, 8192
    buffer_load_dwordx4 v[52:55], v7, s[8:11], s19 offen
    s_add_u32 s19, s22, 24576
    buffer_load_dwordx4 v[56:59], v7, s[8:11], s19 offen
    s_add_u32 s19, s22, 40960
    buffer_load_dwordx4 v[60:63], v7, s[8:11], s19 offen
    s_add_u32 s19, s22, 57344
    buffer_load_dwordx4 v[64:67], v7, s[8:11], s19 offen
    s_add_u32 s19, s22, 73728
    buffer_load_dwordx4 v[68:71], v7, s[8:11], s19 offen
    s_add_u32 s19, s22, 90112
    buffer_load_dwordx4 v[72:75], v7, s[8:11], s19 offen
    s_add_u32 s19, s22, 106496
    buffer_load_dwordx4 v[76:79], v7, s[8:11], s19 offen
    s_add_u32 s19, s22, 122880
    buffer_load_dwordx4 v[80:83], v7, s[8:11], s19 offen
    s_add_u32 s19, s23, 8192
    buffer_load_dwordx4 v[84:87], v7, s[8:11], s19 offen
    ds_read_b128 v[124:127], v6 offset:512
    s_waitcnt vmcnt(9) lgkmcnt(1)
    v_mfma_f32_16x16x32_bf16 v[16:19], v[88:91], v[128:131], v[16:19]
    v_mfma_f32_16x16x32_bf16 v[20:23], v[92:95], v[128:131], v[20:23]
    v_mfma_f32_16x16x32_bf16 v[24:27], v[96:99], v[128:131], v[24:27]
    v_mfma_f32_16x16x32_bf16 v[28:31], v[100:103], v[128:131], v[28:31]
    v_mfma_f32_16x16x32_bf16 v[32:35], v[104:107], v[128:131], v[32:35]
    v_mfma_f32_16x16x32_bf16 v[36:39], v[108:111], v[128:131], v[36:39]
    v_mfma_f32_16x16x32_bf16 v[40:43], v[112:115], v[128:131], v[40:43]
    v_mfma_f32_16x16x32_bf16 v[44:47], v[116:119], v[128:131], v[44:47]
    v_mfma_f32_16x16x32_bf16 v[48:51], v[120:123], v[128:131], v[48:51]
    v_mfma_f32_16x16x32_bf16 v[132:135], v[128:131], v[120:123], v[132:135]
    s_add_u32 s19, s22, 9216
    buffer_load_dwordx4 v[88:91], v7, s[8:11], s19 offen
    s_add_u32 s19, s22, 25600
    buffer_load_dwordx4 v[92:95], v7, s[8:11], s19 offen
    s_add_u32 s19, s22, 41984
    buffer_load_dwordx4 v[96:99], v7, s[8:11], s19 offen
    s_add_u32 s19, s22, 58368
    buffer_load_dwordx4 v[100:103], v7, s[8:11], s19 offen
    s_add_u32 s19, s22, 74752
    buffer_load_dwordx4 v[104:107], v7, s[8:11], s19 offen
    s_add_u32 s19, s22, 91136
    buffer_load_dwordx4 v[108:111], v7, s[8:11], s19 offen
    s_add_u32 s19, s22, 107520
    buffer_load_dwordx4 v[112:115], v7, s[8:11], s19 offen
    s_add_u32 s19, s22, 123904
    buffer_load_dwordx4 v[116:119], v7, s[8:11], s19 offen
    s_add_u32 s19, s23, 9216
    buffer_load_dwordx4 v[120:123], v7, s[8:11], s19 offen
    ds_read_b128 v[128:131], v6 offset:576
    s_waitcnt vmcnt(9) lgkmcnt(1)
    v_mfma_f32_16x16x32_bf16 v[16:19], v[52:55], v[124:127], v[16:19]
    v_mfma_f32_16x16x32_bf16 v[20:23], v[56:59], v[124:127], v[20:23]
    v_mfma_f32_16x16x32_bf16 v[24:27], v[60:63], v[124:127], v[24:27]
    v_mfma_f32_16x16x32_bf16 v[28:31], v[64:67], v[124:127], v[28:31]
    v_mfma_f32_16x16x32_bf16 v[32:35], v[68:71], v[124:127], v[32:35]
    v_mfma_f32_16x16x32_bf16 v[36:39], v[72:75], v[124:127], v[36:39]
    v_mfma_f32_16x16x32_bf16 v[40:43], v[76:79], v[124:127], v[40:43]
    v_mfma_f32_16x16x32_bf16 v[44:47], v[80:83], v[124:127], v[44:47]
    v_mfma_f32_16x16x32_bf16 v[48:51], v[84:87], v[124:127], v[48:51]
    v_mfma_f32_16x16x32_bf16 v[132:135], v[124:127], v[84:87], v[132:135]
    s_add_u32 s19, s22, 10240
    buffer_load_dwordx4 v[52:55], v7, s[8:11], s19 offen
    s_add_u32 s19, s22, 26624
    buffer_load_dwordx4 v[56:59], v7, s[8:11], s19 offen
    s_add_u32 s19, s22, 43008
    buffer_load_dwordx4 v[60:63], v7, s[8:11], s19 offen
    s_add_u32 s19, s22, 59392
    buffer_load_dwordx4 v[64:67], v7, s[8:11], s19 offen
    s_add_u32 s19, s22, 75776
    buffer_load_dwordx4 v[68:71], v7, s[8:11], s19 offen
    s_add_u32 s19, s22, 92160
    buffer_load_dwordx4 v[72:75], v7, s[8:11], s19 offen
    s_add_u32 s19, s22, 108544
    buffer_load_dwordx4 v[76:79], v7, s[8:11], s19 offen
    s_add_u32 s19, s22, 124928
    buffer_load_dwordx4 v[80:83], v7, s[8:11], s19 offen
    s_add_u32 s19, s23, 10240
    buffer_load_dwordx4 v[84:87], v7, s[8:11], s19 offen
    ds_read_b128 v[124:127], v6 offset:640
    s_waitcnt vmcnt(9) lgkmcnt(1)
    v_mfma_f32_16x16x32_bf16 v[16:19], v[88:91], v[128:131], v[16:19]
    v_mfma_f32_16x16x32_bf16 v[20:23], v[92:95], v[128:131], v[20:23]
    v_mfma_f32_16x16x32_bf16 v[24:27], v[96:99], v[128:131], v[24:27]
    v_mfma_f32_16x16x32_bf16 v[28:31], v[100:103], v[128:131], v[28:31]
    v_mfma_f32_16x16x32_bf16 v[32:35], v[104:107], v[128:131], v[32:35]
    v_mfma_f32_16x16x32_bf16 v[36:39], v[108:111], v[128:131], v[36:39]
    v_mfma_f32_16x16x32_bf16 v[40:43], v[112:115], v[128:131], v[40:43]
    v_mfma_f32_16x16x32_bf16 v[44:47], v[116:119], v[128:131], v[44:47]
    v_mfma_f32_16x16x32_bf16 v[48:51], v[120:123], v[128:131], v[48:51]
    v_mfma_f32_16x16x32_bf16 v[132:135], v[128:131], v[120:123], v[132:135]
    s_add_u32 s19, s22, 11264
    buffer_load_dwordx4 v[88:91], v7, s[8:11], s19 offen
    s_add_u32 s19, s22, 27648
    buffer_load_dwordx4 v[92:95], v7, s[8:11], s19 offen
    s_add_u32 s19, s22, 44032
    buffer_load_dwordx4 v[96:99], v7, s[8:11], s19 offen
    s_add_u32 s19, s22, 60416
    buffer_load_dwordx4 v[100:103], v7, s[8:11], s19 offen
    s_add_u32 s19, s22, 76800
    buffer_load_dwordx4 v[104:107], v7, s[8:11], s19 offen
    s_add_u32 s19, s22, 93184
    buffer_load_dwordx4 v[108:111], v7, s[8:11], s19 offen
    s_add_u32 s19, s22, 109568
    buffer_load_dwordx4 v[112:115], v7, s[8:11], s19 offen
    s_add_u32 s19, s22, 125952
    buffer_load_dwordx4 v[116:119], v7, s[8:11], s19 offen
    s_add_u32 s19, s23, 11264
    buffer_load_dwordx4 v[120:123], v7, s[8:11], s19 offen
    ds_read_b128 v[128:131], v6 offset:704
    s_waitcnt vmcnt(9) lgkmcnt(1)
    v_mfma_f32_16x16x32_bf16 v[16:19], v[52:55], v[124:127], v[16:19]
    v_mfma_f32_16x16x32_bf16 v[20:23], v[56:59], v[124:127], v[20:23]
    v_mfma_f32_16x16x32_bf16 v[24:27], v[60:63], v[124:127], v[24:27]
    v_mfma_f32_16x16x32_bf16 v[28:31], v[64:67], v[124:127], v[28:31]
    v_mfma_f32_16x16x32_bf16 v[32:35], v[68:71], v[124:127], v[32:35]
    v_mfma_f32_16x16x32_bf16 v[36:39], v[72:75], v[124:127], v[36:39]
    v_mfma_f32_16x16x32_bf16 v[40:43], v[76:79], v[124:127], v[40:43]
    v_mfma_f32_16x16x32_bf16 v[44:47], v[80:83], v[124:127], v[44:47]
    v_mfma_f32_16x16x32_bf16 v[48:51], v[84:87], v[124:127], v[48:51]
    v_mfma_f32_16x16x32_bf16 v[132:135], v[124:127], v[84:87], v[132:135]
    s_add_u32 s19, s22, 12288
    buffer_load_dwordx4 v[52:55], v7, s[8:11], s19 offen
    s_add_u32 s19, s22, 28672
    buffer_load_dwordx4 v[56:59], v7, s[8:11], s19 offen
    s_add_u32 s19, s22, 45056
    buffer_load_dwordx4 v[60:63], v7, s[8:11], s19 offen
    s_add_u32 s19, s22, 61440
    buffer_load_dwordx4 v[64:67], v7, s[8:11], s19 offen
    s_add_u32 s19, s22, 77824
    buffer_load_dwordx4 v[68:71], v7, s[8:11], s19 offen
    s_add_u32 s19, s22, 94208
    buffer_load_dwordx4 v[72:75], v7, s[8:11], s19 offen
    s_add_u32 s19, s22, 110592
    buffer_load_dwordx4 v[76:79], v7, s[8:11], s19 offen
    s_add_u32 s19, s22, 126976
    buffer_load_dwordx4 v[80:83], v7, s[8:11], s19 offen
    s_add_u32 s19, s23, 12288
    buffer_load_dwordx4 v[84:87], v7, s[8:11], s19 offen
    ds_read_b128 v[124:127], v6 offset:768
    s_waitcnt vmcnt(9) lgkmcnt(1)
    v_mfma_f32_16x16x32_bf16 v[16:19], v[88:91], v[128:131], v[16:19]
    v_mfma_f32_16x16x32_bf16 v[20:23], v[92:95], v[128:131], v[20:23]
    v_mfma_f32_16x16x32_bf16 v[24:27], v[96:99], v[128:131], v[24:27]
    v_mfma_f32_16x16x32_bf16 v[28:31], v[100:103], v[128:131], v[28:31]
    v_mfma_f32_16x16x32_bf16 v[32:35], v[104:107], v[128:131], v[32:35]
    v_mfma_f32_16x16x32_bf16 v[36:39], v[108:111], v[128:131], v[36:39]
    v_mfma_f32_16x16x32_bf16 v[40:43], v[112:115], v[128:131], v[40:43]
    v_mfma_f32_16x16x32_bf16 v[44:47], v[116:119], v[128:131], v[44:47]
    v_mfma_f32_16x16x32_bf16 v[48:51], v[120:123], v[128:131], v[48:51]
    v_mfma_f32_16x16x32_bf16 v[132:135], v[128:131], v[120:123], v[132:135]
    s_add_u32 s19, s22, 13312
    buffer_load_dwordx4 v[88:91], v7, s[8:11], s19 offen
    s_add_u32 s19, s22, 29696
    buffer_load_dwordx4 v[92:95], v7, s[8:11], s19 offen
    s_add_u32 s19, s22, 46080
    buffer_load_dwordx4 v[96:99], v7, s[8:11], s19 offen
    s_add_u32 s19, s22, 62464
    buffer_load_dwordx4 v[100:103], v7, s[8:11], s19 offen
    s_add_u32 s19, s22, 78848
    buffer_load_dwordx4 v[104:107], v7, s[8:11], s19 offen
    s_add_u32 s19, s22, 95232
    buffer_load_dwordx4 v[108:111], v7, s[8:11], s19 offen
    s_add_u32 s19, s22, 111616
    buffer_load_dwordx4 v[112:115], v7, s[8:11], s19 offen
    s_add_u32 s19, s22, 128000
    buffer_load_dwordx4 v[116:119], v7, s[8:11], s19 offen
    s_add_u32 s19, s23, 13312
    buffer_load_dwordx4 v[120:123], v7, s[8:11], s19 offen
    ds_read_b128 v[128:131], v6 offset:832
    s_waitcnt vmcnt(9) lgkmcnt(1)
    v_mfma_f32_16x16x32_bf16 v[16:19], v[52:55], v[124:127], v[16:19]
    v_mfma_f32_16x16x32_bf16 v[20:23], v[56:59], v[124:127], v[20:23]
    v_mfma_f32_16x16x32_bf16 v[24:27], v[60:63], v[124:127], v[24:27]
    v_mfma_f32_16x16x32_bf16 v[28:31], v[64:67], v[124:127], v[28:31]
    v_mfma_f32_16x16x32_bf16 v[32:35], v[68:71], v[124:127], v[32:35]
    v_mfma_f32_16x16x32_bf16 v[36:39], v[72:75], v[124:127], v[36:39]
    v_mfma_f32_16x16x32_bf16 v[40:43], v[76:79], v[124:127], v[40:43]
    v_mfma_f32_16x16x32_bf16 v[44:47], v[80:83], v[124:127], v[44:47]
    v_mfma_f32_16x16x32_bf16 v[48:51], v[84:87], v[124:127], v[48:51]
    v_mfma_f32_16x16x32_bf16 v[132:135], v[124:127], v[84:87], v[132:135]
    s_add_u32 s19, s22, 14336
    buffer_load_dwordx4 v[52:55], v7, s[8:11], s19 offen
    s_add_u32 s19, s22, 30720
    buffer_load_dwordx4 v[56:59], v7, s[8:11], s19 offen
    s_add_u32 s19, s22, 47104
    buffer_load_dwordx4 v[60:63], v7, s[8:11], s19 offen
    s_add_u32 s19, s22, 63488
    buffer_load_dwordx4 v[64:67], v7, s[8:11], s19 offen
    s_add_u32 s19, s22, 79872
    buffer_load_dwordx4 v[68:71], v7, s[8:11], s19 offen
    s_add_u32 s19, s22, 96256
    buffer_load_dwordx4 v[72:75], v7, s[8:11], s19 offen
    s_add_u32 s19, s22, 112640
    buffer_load_dwordx4 v[76:79], v7, s[8:11], s19 offen
    s_add_u32 s19, s22, 129024
    buffer_load_dwordx4 v[80:83], v7, s[8:11], s19 offen
    s_add_u32 s19, s23, 14336
    buffer_load_dwordx4 v[84:87], v7, s[8:11], s19 offen
    ds_read_b128 v[124:127], v6 offset:896
    s_waitcnt vmcnt(9) lgkmcnt(1)
    v_mfma_f32_16x16x32_bf16 v[16:19], v[88:91], v[128:131], v[16:19]
    v_mfma_f32_16x16x32_bf16 v[20:23], v[92:95], v[128:131], v[20:23]
    v_mfma_f32_16x16x32_bf16 v[24:27], v[96:99], v[128:131], v[24:27]
    v_mfma_f32_16x16x32_bf16 v[28:31], v[100:103], v[128:131], v[28:31]
    v_mfma_f32_16x16x32_bf16 v[32:35], v[104:107], v[128:131], v[32:35]
    v_mfma_f32_16x16x32_bf16 v[36:39], v[108:111], v[128:131], v[36:39]
    v_mfma_f32_16x16x32_bf16 v[40:43], v[112:115], v[128:131], v[40:43]
    v_mfma_f32_16x16x32_bf16 v[44:47], v[116:119], v[128:131], v[44:47]
    v_mfma_f32_16x16x32_bf16 v[48:51], v[120:123], v[128:131], v[48:51]
    v_mfma_f32_16x16x32_bf16 v[132:135], v[128:131], v[120:123], v[132:135]
    s_add_u32 s19, s22, 15360
    buffer_load_dwordx4 v[88:91], v7, s[8:11], s19 offen
    s_add_u32 s19, s22, 31744
    buffer_load_dwordx4 v[92:95], v7, s[8:11], s19 offen
    s_add_u32 s19, s22, 48128
    buffer_load_dwordx4 v[96:99], v7, s[8:11], s19 offen
    s_add_u32 s19, s22, 64512
    buffer_load_dwordx4 v[100:103], v7, s[8:11], s19 offen
    s_add_u32 s19, s22, 80896
    buffer_load_dwordx4 v[104:107], v7, s[8:11], s19 offen
    s_add_u32 s19, s22, 97280
    buffer_load_dwordx4 v[108:111], v7, s[8:11], s19 offen
    s_add_u32 s19, s22, 113664
    buffer_load_dwordx4 v[112:115], v7, s[8:11], s19 offen
    s_add_u32 s19, s22, 130048
    buffer_load_dwordx4 v[116:119], v7, s[8:11], s19 offen
    s_add_u32 s19, s23, 15360
    buffer_load_dwordx4 v[120:123], v7, s[8:11], s19 offen
    ds_read_b128 v[128:131], v6 offset:960
    s_waitcnt vmcnt(9) lgkmcnt(1)
    v_mfma_f32_16x16x32_bf16 v[16:19], v[52:55], v[124:127], v[16:19]
    v_mfma_f32_16x16x32_bf16 v[20:23], v[56:59], v[124:127], v[20:23]
    v_mfma_f32_16x16x32_bf16 v[24:27], v[60:63], v[124:127], v[24:27]
    v_mfma_f32_16x16x32_bf16 v[28:31], v[64:67], v[124:127], v[28:31]
    v_mfma_f32_16x16x32_bf16 v[32:35], v[68:71], v[124:127], v[32:35]
    v_mfma_f32_16x16x32_bf16 v[36:39], v[72:75], v[124:127], v[36:39]
    v_mfma_f32_16x16x32_bf16 v[40:43], v[76:79], v[124:127], v[40:43]
    v_mfma_f32_16x16x32_bf16 v[44:47], v[80:83], v[124:127], v[44:47]
    v_mfma_f32_16x16x32_bf16 v[48:51], v[84:87], v[124:127], v[48:51]
    v_mfma_f32_16x16x32_bf16 v[132:135], v[124:127], v[84:87], v[132:135]
    s_waitcnt vmcnt(0) lgkmcnt(0)
    v_mfma_f32_16x16x32_bf16 v[16:19], v[88:91], v[128:131], v[16:19]
    v_mfma_f32_16x16x32_bf16 v[20:23], v[92:95], v[128:131], v[20:23]
    v_mfma_f32_16x16x32_bf16 v[24:27], v[96:99], v[128:131], v[24:27]
    v_mfma_f32_16x16x32_bf16 v[28:31], v[100:103], v[128:131], v[28:31]
    v_mfma_f32_16x16x32_bf16 v[32:35], v[104:107], v[128:131], v[32:35]
    v_mfma_f32_16x16x32_bf16 v[36:39], v[108:111], v[128:131], v[36:39]
    v_mfma_f32_16x16x32_bf16 v[40:43], v[112:115], v[128:131], v[40:43]
    v_mfma_f32_16x16x32_bf16 v[44:47], v[116:119], v[128:131], v[44:47]
    v_mfma_f32_16x16x32_bf16 v[48:51], v[120:123], v[128:131], v[48:51]
    v_mfma_f32_16x16x32_bf16 v[132:135], v[128:131], v[120:123], v[132:135]
    s_nop 7
    s_mov_b32 s21, 0x3eb8aa3b
    v_lshlrev_b32 v8, 10, v3
    v_lshl_add_u32 v8, v2, 3, v8
    s_lshl_b32 s3, s2, 14
    s_lshl_b32 s19, s16, 8
    s_add_u32 s3, s3, s19
    s_add_u32 s3, s3, 29360128
    v_mul_f32 v16, s21, v16
    v_mul_f32 v17, s21, v17
    v_mul_f32 v18, s21, v18
    v_mul_f32 v19, s21, v19
    v_cvt_pk_bf16_f32 v16, v16, v17
    v_cvt_pk_bf16_f32 v17, v18, v19
    buffer_store_dwordx2 v[16:17], v8, s[8:11], s3 offen offset:0
    v_mul_f32 v20, s21, v20
    v_mul_f32 v21, s21, v21
    v_mul_f32 v22, s21, v22
    v_mul_f32 v23, s21, v23
    v_cvt_pk_bf16_f32 v20, v20, v21
    v_cvt_pk_bf16_f32 v21, v22, v23
    buffer_store_dwordx2 v[20:21], v8, s[8:11], s3 offen offset:32
    v_mul_f32 v24, s21, v24
    v_mul_f32 v25, s21, v25
    v_mul_f32 v26, s21, v26
    v_mul_f32 v27, s21, v27
    v_cvt_pk_bf16_f32 v24, v24, v25
    v_cvt_pk_bf16_f32 v25, v26, v27
    buffer_store_dwordx2 v[24:25], v8, s[8:11], s3 offen offset:64
    v_mul_f32 v28, s21, v28
    v_mul_f32 v29, s21, v29
    v_mul_f32 v30, s21, v30
    v_mul_f32 v31, s21, v31
    v_cvt_pk_bf16_f32 v28, v28, v29
    v_cvt_pk_bf16_f32 v29, v30, v31
    buffer_store_dwordx2 v[28:29], v8, s[8:11], s3 offen offset:96
    v_mul_f32 v32, s21, v32
    v_mul_f32 v33, s21, v33
    v_mul_f32 v34, s21, v34
    v_mul_f32 v35, s21, v35
    v_cvt_pk_bf16_f32 v32, v32, v33
    v_cvt_pk_bf16_f32 v33, v34, v35
    buffer_store_dwordx2 v[32:33], v8, s[8:11], s3 offen offset:128
    v_mul_f32 v36, s21, v36
    v_mul_f32 v37, s21, v37
    v_mul_f32 v38, s21, v38
    v_mul_f32 v39, s21, v39
    v_cvt_pk_bf16_f32 v36, v36, v37
    v_cvt_pk_bf16_f32 v37, v38, v39
    buffer_store_dwordx2 v[36:37], v8, s[8:11], s3 offen offset:160
    v_mul_f32 v40, s21, v40
    v_mul_f32 v41, s21, v41
    v_mul_f32 v42, s21, v42
    v_mul_f32 v43, s21, v43
    v_cvt_pk_bf16_f32 v40, v40, v41
    v_cvt_pk_bf16_f32 v41, v42, v43
    buffer_store_dwordx2 v[40:41], v8, s[8:11], s3 offen offset:192
    v_mul_f32 v44, s21, v44
    v_mul_f32 v45, s21, v45
    v_mul_f32 v46, s21, v46
    v_mul_f32 v47, s21, v47
    v_cvt_pk_bf16_f32 v44, v44, v45
    v_cvt_pk_bf16_f32 v45, v46, v47
    buffer_store_dwordx2 v[44:45], v8, s[8:11], s3 offen offset:224
    s_cmp_eq_u32 s16, 1
    s_cbranch_scc1 L_ka1_v_10
    s_cmp_lg_u32 s16, 0
    s_cbranch_scc1 L_ka1_end_9
    v_cvt_pk_bf16_f32 v48, v48, v49
    v_cvt_pk_bf16_f32 v49, v50, v51
    v_lshlrev_b32 v8, 5, v3
    v_lshl_add_u32 v8, v2, 3, v8
    s_lshl_b32 s3, s2, 9
    s_add_u32 s3, s3, 33554432
    buffer_store_dwordx2 v[48:49], v8, s[8:11], s3 offen
    s_branch L_ka1_end_9
L_ka1_v_10:
    v_cvt_pk_bf16_f32 v132, v132, v133
    v_cvt_pk_bf16_f32 v133, v134, v135
    v_and_b32 v8, 1, v2
    v_lshlrev_b32 v8, 8, v8
    v_lshl_add_u32 v8, v3, 4, v8
    v_lshrrev_b32 v9, 1, v2
    v_lshl_add_u32 v8, v9, 3, v8
    s_lshl_b32 s3, s2, 9
    s_add_u32 s3, s3, 33619968
    buffer_store_dwordx2 v[132:133], v8, s[8:11], s3 offen
L_ka1_end_9:
    s_endpgm
.section .rodata,"a"
.p2align 6
.amdhsa_kernel ka1_1_kernel
  .amdhsa_next_free_vgpr 136
  .amdhsa_next_free_sgpr 102
  .amdhsa_accum_offset 136
  .amdhsa_group_segment_fixed_size 0
  .amdhsa_kernarg_size 120
  .amdhsa_user_sgpr_count 2
  .amdhsa_user_sgpr_kernarg_segment_ptr 1
  .amdhsa_system_sgpr_workgroup_id_x 1
.end_amdhsa_kernel
.text

.p2align 8
.globl ka2_kernel
.type ka2_kernel,@function
ka2_kernel:
    s_cmp_ge_u32 s2, 256
    s_cbranch_scc1 L_ka2_end_11
    s_load_dwordx2 s[4:5], s[0:1], 112
    v_and_b32 v1, 63, v0
    v_lshrrev_b32 v2, 6, v0
    s_nop 0
    v_readfirstlane_b32 s16, v2
    s_waitcnt lgkmcnt(0)
    s_mov_b32 s8, s4
    s_and_b32 s9, s5, 0xffff
    s_mov_b32 s10, 268435456
    s_mov_b32 s11, 0x00020000
    v_lshlrev_b32 v2, 4, v0
    s_mov_b32 s19, 33554432
    buffer_load_dwordx4 v[16:19], v2, s[8:11], s19 offen
    s_mov_b32 s19, 33562624
    buffer_load_dwordx4 v[20:23], v2, s[8:11], s19 offen
    s_mov_b32 s19, 33570816
    buffer_load_dwordx4 v[24:27], v2, s[8:11], s19 offen
    s_mov_b32 s19, 33579008
    buffer_load_dwordx4 v[28:31], v2, s[8:11], s19 offen
    s_mov_b32 s19, 33587200
    buffer_load_dwordx4 v[32:35], v2, s[8:11], s19 offen
    s_mov_b32 s19, 33595392
    buffer_load_dwordx4 v[36:39], v2, s[8:11], s19 offen
    s_mov_b32 s19, 33603584
    buffer_load_dwordx4 v[40:43], v2, s[8:11], s19 offen
    s_mov_b32 s19, 33611776
    buffer_load_dwordx4 v[44:47], v2, s[8:11], s19 offen
    v_add_u32 v3, 0, v2
    s_waitcnt vmcnt(7)
    ds_write_b128 v3, v[16:19] offset:0
    s_waitcnt vmcnt(6)
    ds_write_b128 v3, v[20:23] offset:8192
    s_waitcnt vmcnt(5)
    ds_write_b128 v3, v[24:27] offset:16384
    s_waitcnt vmcnt(4)
    ds_write_b128 v3, v[28:31] offset:24576
    s_waitcnt vmcnt(3)
    ds_write_b128 v3, v[32:35] offset:32768
    s_waitcnt vmcnt(2)
    ds_write_b128 v3, v[36:39] offset:40960
    s_waitcnt vmcnt(1)
    ds_write_b128 v3, v[40:43] offset:49152
    s_waitcnt vmcnt(0)
    ds_write_b128 v3, v[44:47] offset:57344
    s_mov_b32 s19, 33619968
    buffer_load_dwordx4 v[16:19], v2, s[8:11], s19 offen
    s_mov_b32 s19, 33628160
    buffer_load_dwordx4 v[20:23], v2, s[8:11], s19 offen
    s_mov_b32 s19, 33636352
    buffer_load_dwordx4 v[24:27], v2, s[8:11], s19 offen
    s_mov_b32 s19, 33644544
    buffer_load_dwordx4 v[28:31], v2, s[8:11], s19 offen
    s_mov_b32 s19, 33652736
    buffer_load_dwordx4 v[32:35], v2, s[8:11], s19 offen
    s_mov_b32 s19, 33660928
    buffer_load_dwordx4 v[36:39], v2, s[8:11], s19 offen
    s_mov_b32 s19, 33669120
    buffer_load_dwordx4 v[40:43], v2, s[8:11], s19 offen
    s_mov_b32 s19, 33677312
    buffer_load_dwordx4 v[44:47], v2, s[8:11], s19 offen
    v_add_u32 v3, 65536, v2
    s_waitcnt vmcnt(7)
    ds_write_b128 v3, v[16:19] offset:0
    s_waitcnt vmcnt(6)
    ds_write_b128 v3, v[20:23] offset:8192
    s_waitcnt vmcnt(5)
    ds_write_b128 v3, v[24:27] offset:16384
    s_waitcnt vmcnt(4)
    ds_write_b128 v3, v[28:31] offset:24576
    s_waitcnt vmcnt(3)
    ds_write_b128 v3, v[32:35] offset:32768
    s_waitcnt vmcnt(2)
    ds_write_b128 v3, v[36:39] offset:40960
    s_waitcnt vmcnt(1)
    ds_write_b128 v3, v[40:43] offset:49152
    s_waitcnt vmcnt(0)
    ds_write_b128 v3, v[44:47] offset:57344
    v_and_b32 v4, 31, v1
    v_lshrrev_b32 v5, 5, v1
    v_lshlrev_b32 v6, 5, v4
    v_lshl_add_u32 v6, v5, 4, v6
    s_lshl_b32 s3, s2, 3
    s_add_u32 s3, s3, s16
    s_lshl_b32 s17, s3, 10
    s_add_u32 s19, s17, 29360128
    buffer_load_dwordx4 v[8:11], v6, s[8:11], s19 offen
    v_lshlrev_b32 v7, 8, v5
    v_lshl_add_u32 v7, v4, 4, v7
    v_add_u32 v7, 65536, v7
    v_mov_b32 v12, 0x3f803f80
    v_cmp_eq_u32 vcc, 16, v4
    s_nop 1
    v_cndmask_b32 v12, 0, v12, vcc
    v_mov_b32 v16, v12
    v_mov_b32 v17, v12
    v_mov_b32 v18, v12
    v_mov_b32 v19, v12
    v_mov_b32 v20, v12
    v_mov_b32 v21, v12
    v_mov_b32 v22, v12
    v_mov_b32 v23, v12
    v_mov_b32 v24, v12
    v_mov_b32 v25, v12
    v_mov_b32 v26, v12
    v_mov_b32 v27, v12
    v_mov_b32 v28, v12
    v_mov_b32 v29, v12
    v_mov_b32 v30, v12
    v_mov_b32 v31, v12
    s_mov_b32 s30, 0x0000ffff
    s_mov_b32 s31, 0x0000ffff
    s_waitcnt vmcnt(0) lgkmcnt(0)
    s_barrier
    v_mov_b32 v112, 0xff800000
    v_mov_b32 v113, 0xff800000
    v_mov_b32 v114, 0xff800000
    v_mov_b32 v115, 0xff800000
    v_mov_b32 v13, v6
    ds_read_b128 v[32:35], v13
    ds_read_b128 v[36:39], v13 offset:1024
    s_mov_b32 s18, 0
L_ka2_p1_12:
    s_waitcnt lgkmcnt(1)
    v_mfma_f32_32x32x16_bf16 v[48:63], v[32:35], v[8:11], 0
    ds_read_b128 v[32:35], v13 offset:2048
    s_waitcnt lgkmcnt(1)
    v_mfma_f32_32x32x16_bf16 v[64:79], v[36:39], v[8:11], 0
    ds_read_b128 v[36:39], v13 offset:3072
    v_add_u32 v13, 2048, v13
    s_nop 8
    v_max3_f32 v112, v112, v48, v49
    v_max3_f32 v112, v112, v50, v51
    v_max3_f32 v113, v113, v52, v53
    v_max3_f32 v113, v113, v54, v55
    v_max3_f32 v114, v114, v56, v57
    v_max3_f32 v114, v114, v58, v59
    v_max3_f32 v115, v115, v60, v61
    v_max3_f32 v115, v115, v62, v63
    s_nop 3
    v_max3_f32 v112, v112, v64, v65
    v_max3_f32 v112, v112, v66, v67
    v_max3_f32 v113, v113, v68, v69
    v_max3_f32 v113, v113, v70, v71
    v_max3_f32 v114, v114, v72, v73
    v_max3_f32 v114, v114, v74, v75
    v_max3_f32 v115, v115, v76, v77
    v_max3_f32 v115, v115, v78, v79
    s_add_u32 s18, s18, 2
    s_cmp_lt_u32 s18, 64
    s_cbranch_scc1 L_ka2_p1_12
    v_max3_f32 v112, v112, v113, v114
    v_max_f32 v112, v112, v115
    v_mov_b32 v113, v112
    s_nop 1
    v_permlane32_swap_b32 v112, v113
    s_nop 0
    v_max_f32 v112, v112, v113
    v_sub_f32 v112, 0, v112
    v_mov_b32 v80, v112
    v_mov_b32 v81, v112
    v_mov_b32 v82, v112
    v_mov_b32 v83, v112
    v_mov_b32 v84, v112
    v_mov_b32 v85, v112
    v_mov_b32 v86, v112
    v_mov_b32 v87, v112
    v_mov_b32 v88, v112
    v_mov_b32 v89, v112
    v_mov_b32 v90, v112
    v_mov_b32 v91, v112
    v_mov_b32 v92, v112
    v_mov_b32 v93, v112
    v_mov_b32 v94, v112
    v_mov_b32 v95, v112
    v_mov_b32 v96, 0
    v_mov_b32 v97, 0
    v_mov_b32 v98, 0
    v_mov_b32 v99, 0
    v_mov_b32 v100, 0
    v_mov_b32 v101, 0
    v_mov_b32 v102, 0
    v_mov_b32 v103, 0
    v_mov_b32 v104, 0
    v_mov_b32 v105, 0
    v_mov_b32 v106, 0
    v_mov_b32 v107, 0
    v_mov_b32 v108, 0
    v_mov_b32 v109, 0
    v_mov_b32 v110, 0
    v_mov_b32 v111, 0
    v_mov_b32 v13, v6
    v_mov_b32 v14, v7
    ds_read_b128 v[32:35], v13
    s_mov_b64 exec, s[30:31]
    ds_read_b128 v[16:19], v14
    ds_read_b128 v[20:23], v14 offset:512
    s_mov_b64 exec, -1
    s_mov_b32 s18, 0
L_ka2_p2_13:
    s_waitcnt lgkmcnt(2)
    v_mfma_f32_32x32x16_bf16 v[48:63], v[32:35], v[8:11], v[80:95]
    ds_read_b128 v[32:35], v13 offset:1024
    v_add_u32 v13, 1024, v13
    s_nop 9
    v_exp_f32 v48, v48
    v_exp_f32 v49, v49
    v_exp_f32 v50, v50
    v_exp_f32 v51, v51
    v_exp_f32 v52, v52
    v_exp_f32 v53, v53
    v_exp_f32 v54, v54
    v_exp_f32 v55, v55
    v_exp_f32 v56, v56
    v_exp_f32 v57, v57
    v_exp_f32 v58, v58
    v_exp_f32 v59, v59
    v_exp_f32 v60, v60
    v_exp_f32 v61, v61
    v_exp_f32 v62, v62
    v_exp_f32 v63, v63
    s_nop 0
    v_cvt_pk_bf16_f32 v40, v48, v49
    v_cvt_pk_bf16_f32 v41, v50, v51
    v_cvt_pk_bf16_f32 v42, v52, v53
    v_cvt_pk_bf16_f32 v43, v54, v55
    v_cvt_pk_bf16_f32 v44, v56, v57
    v_cvt_pk_bf16_f32 v45, v58, v59
    v_cvt_pk_bf16_f32 v46, v60, v61
    v_cvt_pk_bf16_f32 v47, v62, v63
    s_waitcnt lgkmcnt(1)
    s_nop 0
    v_mfma_f32_32x32x16_bf16 v[96:111], v[16:19], v[40:43], v[96:111]
    v_mfma_f32_32x32x16_bf16 v[96:111], v[20:23], v[44:47], v[96:111]
    v_add_u32 v14, 1024, v14
    s_add_u32 s18, s18, 1
    s_cmp_lt_u32 s18, 64
    s_cbranch_scc0 L_ka2_done_14
    s_mov_b64 exec, s[30:31]
    ds_read_b128 v[16:19], v14
    ds_read_b128 v[20:23], v14 offset:512
    s_mov_b64 exec, -1
    s_branch L_ka2_p2_13
L_ka2_done_14:
    s_waitcnt lgkmcnt(0)
    s_nop 15
    v_mov_b32 v112, v104
    v_mov_b32 v113, v104
    s_nop 1
    v_permlane32_swap_b32 v112, v113
    s_nop 0
    v_rcp_f32 v112, v112
    s_nop 0
    v_mul_f32 v96, v112, v96
    v_mul_f32 v97, v112, v97
    v_mul_f32 v98, v112, v98
    v_mul_f32 v99, v112, v99
    v_mul_f32 v100, v112, v100
    v_mul_f32 v101, v112, v101
    v_mul_f32 v102, v112, v102
    v_mul_f32 v103, v112, v103
    v_cvt_pk_bf16_f32 v96, v96, v97
    v_cvt_pk_bf16_f32 v97, v98, v99
    v_cvt_pk_bf16_f32 v98, v100, v101
    v_cvt_pk_bf16_f32 v99, v102, v103
    v_lshlrev_b32 v6, 5, v4
    v_lshl_add_u32 v6, v5, 3, v6
    s_add_u32 s19, s17, 31457280
    buffer_store_dwordx2 v[96:97], v6, s[8:11], s19 offen
    buffer_store_dwordx2 v[98:99], v6, s[8:11], s19 offen offset:16
L_ka2_end_11:
    s_endpgm
.section .rodata,"a"
.p2align 6
.amdhsa_kernel ka2_kernel
  .amdhsa_next_free_vgpr 128
  .amdhsa_next_free_sgpr 102
  .amdhsa_accum_offset 128
  .amdhsa_group_segment_fixed_size 0
  .amdhsa_kernarg_size 120
  .amdhsa_user_sgpr_count 2
  .amdhsa_user_sgpr_kernarg_segment_ptr 1
  .amdhsa_system_sgpr_workgroup_id_x 1
.end_amdhsa_kernel
.text

.p2align 8
.globl ka3_0_kernel
.type ka3_0_kernel,@function
ka3_0_kernel:
    s_cmp_ge_u32 s2, 128
    s_cbranch_scc1 L_ka3_end_15
    s_load_dwordx2 s[4:5], s[0:1], 112
    s_load_dwordx2 s[6:7], s[0:1], 0
    v_and_b32 v1, 63, v0
    v_lshrrev_b32 v2, 6, v0
    s_nop 0
    v_readfirstlane_b32 s16, v2
    v_lshrrev_b32 v2, 4, v1
    v_and_b32 v3, 15, v1
    s_waitcnt lgkmcnt(0)
    s_mov_b32 s8, s4
    s_and_b32 s9, s5, 0xffff
    s_mov_b32 s10, 268435456
    s_mov_b32 s11, 0x00020000
    s_mov_b32 s12, s6
    s_and_b32 s13, s7, 0xffff
    s_mov_b32 s14, 2097152
    s_mov_b32 s15, 0x00020000
    v_lshlrev_b32 v6, 10, v3
    v_lshl_add_u32 v6, v2, 4, v6
    s_lshl_b32 s3, s2, 14
    s_add_u32 s24, s3, 31457280
    v_lshlrev_b32 v7, 4, v1
    s_lshl_b32 s22, s16, 17
    s_add_u32 s22, s22, 17334272
    s_add_u32 s19, s22, 0
    buffer_load_dwordx4 v[48:51], v7, s[8:11], s19 offen
    s_add_u32 s19, s22, 16384
    buffer_load_dwordx4 v[52:55], v7, s[8:11], s19 offen
    s_add_u32 s19, s22, 32768
    buffer_load_dwordx4 v[56:59], v7, s[8:11], s19 offen
    s_add_u32 s19, s22, 49152
    buffer_load_dwordx4 v[60:63], v7, s[8:11], s19 offen
    s_add_u32 s19, s22, 65536
    buffer_load_dwordx4 v[64:67], v7, s[8:11], s19 offen
    s_add_u32 s19, s22, 81920
    buffer_load_dwordx4 v[68:71], v7, s[8:11], s19 offen
    s_add_u32 s19, s22, 98304
    buffer_load_dwordx4 v[72:75], v7, s[8:11], s19 offen
    s_add_u32 s19, s22, 114688
    buffer_load_dwordx4 v[76:79], v7, s[8:11], s19 offen
    buffer_load_dwordx4 v[112:115], v6, s[8:11], s24 offen offset:0
    s_add_u32 s19, s22, 1024
    buffer_load_dwordx4 v[80:83], v7, s[8:11], s19 offen
    s_add_u32 s19, s22, 17408
    buffer_load_dwordx4 v[84:87], v7, s[8:11], s19 offen
    s_add_u32 s19, s22, 33792
    buffer_load_dwordx4 v[88:91], v7, s[8:11], s19 offen
    s_add_u32 s19, s22, 50176
    buffer_load_dwordx4 v[92:95], v7, s[8:11], s19 offen
    s_add_u32 s19, s22, 66560
    buffer_load_dwordx4 v[96:99], v7, s[8:11], s19 offen
    s_add_u32 s19, s22, 82944
    buffer_load_dwordx4 v[100:103], v7, s[8:11], s19 offen
    s_add_u32 s19, s22, 99328
    buffer_load_dwordx4 v[104:107], v7, s[8:11], s19 offen
    s_add_u32 s19, s22, 115712
    buffer_load_dwordx4 v[108:111], v7, s[8:11], s19 offen
    buffer_load_dwordx4 v[116:119], v6, s[8:11], s24 offen offset:64
    s_waitcnt vmcnt(9)
    v_mfma_f32_16x16x32_bf16 v[16:19], v[48:51], v[112:115], 0
    v_mfma_f32_16x16x32_bf16 v[20:23], v[52:55], v[112:115], 0
    v_mfma_f32_16x16x32_bf16 v[24:27], v[56:59], v[112:115], 0
    v_mfma_f32_16x16x32_bf16 v[28:31], v[60:63], v[112:115], 0
    v_mfma_f32_16x16x32_bf16 v[32:35], v[64:67], v[112:115], 0
    v_mfma_f32_16x16x32_bf16 v[36:39], v[68:71], v[112:115], 0
    v_mfma_f32_16x16x32_bf16 v[40:43], v[72:75], v[112:115], 0
    v_mfma_f32_16x16x32_bf16 v[44:47], v[76:79], v[112:115], 0
    s_add_u32 s19, s22, 2048
    buffer_load_dwordx4 v[48:51], v7, s[8:11], s19 offen
    s_add_u32 s19, s22, 18432
    buffer_load_dwordx4 v[52:55], v7, s[8:11], s19 offen
    s_add_u32 s19, s22, 34816
    buffer_load_dwordx4 v[56:59], v7, s[8:11], s19 offen
    s_add_u32 s19, s22, 51200
    buffer_load_dwordx4 v[60:63], v7, s[8:11], s19 offen
    s_add_u32 s19, s22, 67584
    buffer_load_dwordx4 v[64:67], v7, s[8:11], s19 offen
    s_add_u32 s19, s22, 83968
    buffer_load_dwordx4 v[68:71], v7, s[8:11], s19 offen
    s_add_u32 s19, s22, 100352
    buffer_load_dwordx4 v[72:75], v7, s[8:11], s19 offen
    s_add_u32 s19, s22, 116736
    buffer_load_dwordx4 v[76:79], v7, s[8:11], s19 offen
    buffer_load_dwordx4 v[112:115], v6, s[8:11], s24 offen offset:128
    s_waitcnt vmcnt(9)
    v_mfma_f32_16x16x32_bf16 v[16:19], v[80:83], v[116:119], v[16:19]
    v_mfma_f32_16x16x32_bf16 v[20:23], v[84:87], v[116:119], v[20:23]
    v_mfma_f32_16x16x32_bf16 v[24:27], v[88:91], v[116:119], v[24:27]
    v_mfma_f32_16x16x32_bf16 v[28:31], v[92:95], v[116:119], v[28:31]
    v_mfma_f32_16x16x32_bf16 v[32:35], v[96:99], v[116:119], v[32:35]
    v_mfma_f32_16x16x32_bf16 v[36:39], v[100:103], v[116:119], v[36:39]
    v_mfma_f32_16x16x32_bf16 v[40:43], v[104:107], v[116:119], v[40:43]
    v_mfma_f32_16x16x32_bf16 v[44:47], v[108:111], v[116:119], v[44:47]
    s_add_u32 s19, s22, 3072
    buffer_load_dwordx4 v[80:83], v7, s[8:11], s19 offen
    s_add_u32 s19, s22, 19456
    buffer_load_dwordx4 v[84:87], v7, s[8:11], s19 offen
    s_add_u32 s19, s22, 35840
    buffer_load_dwordx4 v[88:91], v7, s[8:11], s19 offen
    s_add_u32 s19, s22, 52224
    buffer_load_dwordx4 v[92:95], v7, s[8:11], s19 offen
    s_add_u32 s19, s22, 68608
    buffer_load_dwordx4 v[96:99], v7, s[8:11], s19 offen
    s_add_u32 s19, s22, 84992
    buffer_load_dwordx4 v[100:103], v7, s[8:11], s19 offen
    s_add_u32 s19, s22, 101376
    buffer_load_dwordx4 v[104:107], v7, s[8:11], s19 offen
    s_add_u32 s19, s22, 117760
    buffer_load_dwordx4 v[108:111], v7, s[8:11], s19 offen
    buffer_load_dwordx4 v[116:119], v6, s[8:11], s24 offen offset:192
    s_waitcnt vmcnt(9)
    v_mfma_f32_16x16x32_bf16 v[16:19], v[48:51], v[112:115], v[16:19]
    v_mfma_f32_16x16x32_bf16 v[20:23], v[52:55], v[112:115], v[20:23]
    v_mfma_f32_16x16x32_bf16 v[24:27], v[56:59], v[112:115], v[24:27]
    v_mfma_f32_16x16x32_bf16 v[28:31], v[60:63], v[112:115], v[28:31]
    v_mfma_f32_16x16x32_bf16 v[32:35], v[64:67], v[112:115], v[32:35]
    v_mfma_f32_16x16x32_bf16 v[36:39], v[68:71], v[112:115], v[36:39]
    v_mfma_f32_16x16x32_bf16 v[40:43], v[72:75], v[112:115], v[40:43]
    v_mfma_f32_16x16x32_bf16 v[44:47], v[76:79], v[112:115], v[44:47]
    s_add_u32 s19, s22, 4096
    buffer_load_dwordx4 v[48:51], v7, s[8:11], s19 offen
    s_add_u32 s19, s22, 20480
    buffer_load_dwordx4 v[52:55], v7, s[8:11], s19 offen
    s_add_u32 s19, s22, 36864
    buffer_load_dwordx4 v[56:59], v7, s[8:11], s19 offen
    s_add_u32 s19, s22, 53248
    buffer_load_dwordx4 v[60:63], v7, s[8:11], s19 offen
    s_add_u32 s19, s22, 69632
    buffer_load_dwordx4 v[64:67], v7, s[8:11], s19 offen
    s_add_u32 s19, s22, 86016
    buffer_load_dwordx4 v[68:71], v7, s[8:11], s19 offen
    s_add_u32 s19, s22, 102400
    buffer_load_dwordx4 v[72:75], v7, s[8:11], s19 offen
    s_add_u32 s19, s22, 118784
    buffer_load_dwordx4 v[76:79], v7, s[8:11], s19 offen
    buffer_load_dwordx4 v[112:115], v6, s[8:11], s24 offen offset:256
    s_waitcnt vmcnt(9)
    v_mfma_f32_16x16x32_bf16 v[16:19], v[80:83], v[116:119], v[16:19]
    v_mfma_f32_16x16x32_bf16 v[20:23], v[84:87], v[116:119], v[20:23]
    v_mfma_f32_16x16x32_bf16 v[24:27], v[88:91], v[116:119], v[24:27]
    v_mfma_f32_16x16x32_bf16 v[28:31], v[92:95], v[116:119], v[28:31]
    v_mfma_f32_16x16x32_bf16 v[32:35], v[96:99], v[116:119], v[32:35]
    v_mfma_f32_16x16x32_bf16 v[36:39], v[100:103], v[116:119], v[36:39]
    v_mfma_f32_16x16x32_bf16 v[40:43], v[104:107], v[116:119], v[40:43]
    v_mfma_f32_16x16x32_bf16 v[44:47], v[108:111], v[116:119], v[44:47]
    s_add_u32 s19, s22, 5120
    buffer_load_dwordx4 v[80:83], v7, s[8:11], s19 offen
    s_add_u32 s19, s22, 21504
    buffer_load_dwordx4 v[84:87], v7, s[8:11], s19 offen
    s_add_u32 s19, s22, 37888
    buffer_load_dwordx4 v[88:91], v7, s[8:11], s19 offen
    s_add_u32 s19, s22, 54272
    buffer_load_dwordx4 v[92:95], v7, s[8:11], s19 offen
    s_add_u32 s19, s22, 70656
    buffer_load_dwordx4 v[96:99], v7, s[8:11], s19 offen
    s_add_u32 s19, s22, 87040
    buffer_load_dwordx4 v[100:103], v7, s[8:11], s19 offen
    s_add_u32 s19, s22, 103424
    buffer_load_dwordx4 v[104:107], v7, s[8:11], s19 offen
    s_add_u32 s19, s22, 119808
    buffer_load_dwordx4 v[108:111], v7, s[8:11], s19 offen
    buffer_load_dwordx4 v[116:119], v6, s[8:11], s24 offen offset:320
    s_waitcnt vmcnt(9)
    v_mfma_f32_16x16x32_bf16 v[16:19], v[48:51], v[112:115], v[16:19]
    v_mfma_f32_16x16x32_bf16 v[20:23], v[52:55], v[112:115], v[20:23]
    v_mfma_f32_16x16x32_bf16 v[24:27], v[56:59], v[112:115], v[24:27]
    v_mfma_f32_16x16x32_bf16 v[28:31], v[60:63], v[112:115], v[28:31]
    v_mfma_f32_16x16x32_bf16 v[32:35], v[64:67], v[112:115], v[32:35]
    v_mfma_f32_16x16x32_bf16 v[36:39], v[68:71], v[112:115], v[36:39]
    v_mfma_f32_16x16x32_bf16 v[40:43], v[72:75], v[112:115], v[40:43]
    v_mfma_f32_16x16x32_bf16 v[44:47], v[76:79], v[112:115], v[44:47]
    s_add_u32 s19, s22, 6144
    buffer_load_dwordx4 v[48:51], v7, s[8:11], s19 offen
    s_add_u32 s19, s22, 22528
    buffer_load_dwordx4 v[52:55], v7, s[8:11], s19 offen
    s_add_u32 s19, s22, 38912
    buffer_load_dwordx4 v[56:59], v7, s[8:11], s19 offen
    s_add_u32 s19, s22, 55296
    buffer_load_dwordx4 v[60:63], v7, s[8:11], s19 offen
    s_add_u32 s19, s22, 71680
    buffer_load_dwordx4 v[64:67], v7, s[8:11], s19 offen
    s_add_u32 s19, s22, 88064
    buffer_load_dwordx4 v[68:71], v7, s[8:11], s19 offen
    s_add_u32 s19, s22, 104448
    buffer_load_dwordx4 v[72:75], v7, s[8:11], s19 offen
    s_add_u32 s19, s22, 120832
    buffer_load_dwordx4 v[76:79], v7, s[8:11], s19 offen
    buffer_load_dwordx4 v[112:115], v6, s[8:11], s24 offen offset:384
    s_waitcnt vmcnt(9)
    v_mfma_f32_16x16x32_bf16 v[16:19], v[80:83], v[116:119], v[16:19]
    v_mfma_f32_16x16x32_bf16 v[20:23], v[84:87], v[116:119], v[20:23]
    v_mfma_f32_16x16x32_bf16 v[24:27], v[88:91], v[116:119], v[24:27]
    v_mfma_f32_16x16x32_bf16 v[28:31], v[92:95], v[116:119], v[28:31]
    v_mfma_f32_16x16x32_bf16 v[32:35], v[96:99], v[116:119], v[32:35]
    v_mfma_f32_16x16x32_bf16 v[36:39], v[100:103], v[116:119], v[36:39]
    v_mfma_f32_16x16x32_bf16 v[40:43], v[104:107], v[116:119], v[40:43]
    v_mfma_f32_16x16x32_bf16 v[44:47], v[108:111], v[116:119], v[44:47]
    s_add_u32 s19, s22, 7168
    buffer_load_dwordx4 v[80:83], v7, s[8:11], s19 offen
    s_add_u32 s19, s22, 23552
    buffer_load_dwordx4 v[84:87], v7, s[8:11], s19 offen
    s_add_u32 s19, s22, 39936
    buffer_load_dwordx4 v[88:91], v7, s[8:11], s19 offen
    s_add_u32 s19, s22, 56320
    buffer_load_dwordx4 v[92:95], v7, s[8:11], s19 offen
    s_add_u32 s19, s22, 72704
    buffer_load_dwordx4 v[96:99], v7, s[8:11], s19 offen
    s_add_u32 s19, s22, 89088
    buffer_load_dwordx4 v[100:103], v7, s[8:11], s19 offen
    s_add_u32 s19, s22, 105472
    buffer_load_dwordx4 v[104:107], v7, s[8:11], s19 offen
    s_add_u32 s19, s22, 121856
    buffer_load_dwordx4 v[108:111], v7, s[8:11], s19 offen
    buffer_load_dwordx4 v[116:119], v6, s[8:11], s24 offen offset:448
    s_waitcnt vmcnt(9)
    v_mfma_f32_16x16x32_bf16 v[16:19], v[48:51], v[112:115], v[16:19]
    v_mfma_f32_16x16x32_bf16 v[20:23], v[52:55], v[112:115], v[20:23]
    v_mfma_f32_16x16x32_bf16 v[24:27], v[56:59], v[112:115], v[24:27]
    v_mfma_f32_16x16x32_bf16 v[28:31], v[60:63], v[112:115], v[28:31]
    v_mfma_f32_16x16x32_bf16 v[32:35], v[64:67], v[112:115], v[32:35]
    v_mfma_f32_16x16x32_bf16 v[36:39], v[68:71], v[112:115], v[36:39]
    v_mfma_f32_16x16x32_bf16 v[40:43], v[72:75], v[112:115], v[40:43]
    v_mfma_f32_16x16x32_bf16 v[44:47], v[76:79], v[112:115], v[44:47]
    s_add_u32 s19, s22, 8192
    buffer_load_dwordx4 v[48:51], v7, s[8:11], s19 offen
    s_add_u32 s19, s22, 24576
    buffer_load_dwordx4 v[52:55], v7, s[8:11], s19 offen
    s_add_u32 s19, s22, 40960
    buffer_load_dwordx4 v[56:59], v7, s[8:11], s19 offen
    s_add_u32 s19, s22, 57344
    buffer_load_dwordx4 v[60:63], v7, s[8:11], s19 offen
    s_add_u32 s19, s22, 73728
    buffer_load_dwordx4 v[64:67], v7, s[8:11], s19 offen
    s_add_u32 s19, s22, 90112
    buffer_load_dwordx4 v[68:71], v7, s[8:11], s19 offen
    s_add_u32 s19, s22, 106496
    buffer_load_dwordx4 v[72:75], v7, s[8:11], s19 offen
    s_add_u32 s19, s22, 122880
    buffer_load_dwordx4 v[76:79], v7, s[8:11], s19 offen
    buffer_load_dwordx4 v[112:115], v6, s[8:11], s24 offen offset:512
    s_waitcnt vmcnt(9)
    v_mfma_f32_16x16x32_bf16 v[16:19], v[80:83], v[116:119], v[16:19]
    v_mfma_f32_16x16x32_bf16 v[20:23], v[84:87], v[116:119], v[20:23]
    v_mfma_f32_16x16x32_bf16 v[24:27], v[88:91], v[116:119], v[24:27]
    v_mfma_f32_16x16x32_bf16 v[28:31], v[92:95], v[116:119], v[28:31]
    v_mfma_f32_16x16x32_bf16 v[32:35], v[96:99], v[116:119], v[32:35]
    v_mfma_f32_16x16x32_bf16 v[36:39], v[100:103], v[116:119], v[36:39]
    v_mfma_f32_16x16x32_bf16 v[40:43], v[104:107], v[116:119], v[40:43]
    v_mfma_f32_16x16x32_bf16 v[44:47], v[108:111], v[116:119], v[44:47]
    s_add_u32 s19, s22, 9216
    buffer_load_dwordx4 v[80:83], v7, s[8:11], s19 offen
    s_add_u32 s19, s22, 25600
    buffer_load_dwordx4 v[84:87], v7, s[8:11], s19 offen
    s_add_u32 s19, s22, 41984
    buffer_load_dwordx4 v[88:91], v7, s[8:11], s19 offen
    s_add_u32 s19, s22, 58368
    buffer_load_dwordx4 v[92:95], v7, s[8:11], s19 offen
    s_add_u32 s19, s22, 74752
    buffer_load_dwordx4 v[96:99], v7, s[8:11], s19 offen
    s_add_u32 s19, s22, 91136
    buffer_load_dwordx4 v[100:103], v7, s[8:11], s19 offen
    s_add_u32 s19, s22, 107520
    buffer_load_dwordx4 v[104:107], v7, s[8:11], s19 offen
    s_add_u32 s19, s22, 123904
    buffer_load_dwordx4 v[108:111], v7, s[8:11], s19 offen
    buffer_load_dwordx4 v[116:119], v6, s[8:11], s24 offen offset:576
    s_waitcnt vmcnt(9)
    v_mfma_f32_16x16x32_bf16 v[16:19], v[48:51], v[112:115], v[16:19]
    v_mfma_f32_16x16x32_bf16 v[20:23], v[52:55], v[112:115], v[20:23]
    v_mfma_f32_16x16x32_bf16 v[24:27], v[56:59], v[112:115], v[24:27]
    v_mfma_f32_16x16x32_bf16 v[28:31], v[60:63], v[112:115], v[28:31]
    v_mfma_f32_16x16x32_bf16 v[32:35], v[64:67], v[112:115], v[32:35]
    v_mfma_f32_16x16x32_bf16 v[36:39], v[68:71], v[112:115], v[36:39]
    v_mfma_f32_16x16x32_bf16 v[40:43], v[72:75], v[112:115], v[40:43]
    v_mfma_f32_16x16x32_bf16 v[44:47], v[76:79], v[112:115], v[44:47]
    s_add_u32 s19, s22, 10240
    buffer_load_dwordx4 v[48:51], v7, s[8:11], s19 offen
    s_add_u32 s19, s22, 26624
    buffer_load_dwordx4 v[52:55], v7, s[8:11], s19 offen
    s_add_u32 s19, s22, 43008
    buffer_load_dwordx4 v[56:59], v7, s[8:11], s19 offen
    s_add_u32 s19, s22, 59392
    buffer_load_dwordx4 v[60:63], v7, s[8:11], s19 offen
    s_add_u32 s19, s22, 75776
    buffer_load_dwordx4 v[64:67], v7, s[8:11], s19 offen
    s_add_u32 s19, s22, 92160
    buffer_load_dwordx4 v[68:71], v7, s[8:11], s19 offen
    s_add_u32 s19, s22, 108544
    buffer_load_dwordx4 v[72:75], v7, s[8:11], s19 offen
    s_add_u32 s19, s22, 124928
    buffer_load_dwordx4 v[76:79], v7, s[8:11], s19 offen
    buffer_load_dwordx4 v[112:115], v6, s[8:11], s24 offen offset:640
    s_waitcnt vmcnt(9)
    v_mfma_f32_16x16x32_bf16 v[16:19], v[80:83], v[116:119], v[16:19]
    v_mfma_f32_16x16x32_bf16 v[20:23], v[84:87], v[116:119], v[20:23]
    v_mfma_f32_16x16x32_bf16 v[24:27], v[88:91], v[116:119], v[24:27]
    v_mfma_f32_16x16x32_bf16 v[28:31], v[92:95], v[116:119], v[28:31]
    v_mfma_f32_16x16x32_bf16 v[32:35], v[96:99], v[116:119], v[32:35]
    v_mfma_f32_16x16x32_bf16 v[36:39], v[100:103], v[116:119], v[36:39]
    v_mfma_f32_16x16x32_bf16 v[40:43], v[104:107], v[116:119], v[40:43]
    v_mfma_f32_16x16x32_bf16 v[44:47], v[108:111], v[116:119], v[44:47]
    s_add_u32 s19, s22, 11264
    buffer_load_dwordx4 v[80:83], v7, s[8:11], s19 offen
    s_add_u32 s19, s22, 27648
    buffer_load_dwordx4 v[84:87], v7, s[8:11], s19 offen
    s_add_u32 s19, s22, 44032
    buffer_load_dwordx4 v[88:91], v7, s[8:11], s19 offen
    s_add_u32 s19, s22, 60416
    buffer_load_dwordx4 v[92:95], v7, s[8:11], s19 offen
    s_add_u32 s19, s22, 76800
    buffer_load_dwordx4 v[96:99], v7, s[8:11], s19 offen
    s_add_u32 s19, s22, 93184
    buffer_load_dwordx4 v[100:103], v7, s[8:11], s19 offen
    s_add_u32 s19, s22, 109568
    buffer_load_dwordx4 v[104:107], v7, s[8:11], s19 offen
    s_add_u32 s19, s22, 125952
    buffer_load_dwordx4 v[108:111], v7, s[8:11], s19 offen
    buffer_load_dwordx4 v[116:119], v6, s[8:11], s24 offen offset:704
    s_waitcnt vmcnt(9)
    v_mfma_f32_16x16x32_bf16 v[16:19], v[48:51], v[112:115], v[16:19]
    v_mfma_f32_16x16x32_bf16 v[20:23], v[52:55], v[112:115], v[20:23]
    v_mfma_f32_16x16x32_bf16 v[24:27], v[56:59], v[112:115], v[24:27]
    v_mfma_f32_16x16x32_bf16 v[28:31], v[60:63], v[112:115], v[28:31]
    v_mfma_f32_16x16x32_bf16 v[32:35], v[64:67], v[112:115], v[32:35]
    v_mfma_f32_16x16x32_bf16 v[36:39], v[68:71], v[112:115], v[36:39]
    v_mfma_f32_16x16x32_bf16 v[40:43], v[72:75], v[112:115], v[40:43]
    v_mfma_f32_16x16x32_bf16 v[44:47], v[76:79], v[112:115], v[44:47]
    s_add_u32 s19, s22, 12288
    buffer_load_dwordx4 v[48:51], v7, s[8:11], s19 offen
    s_add_u32 s19, s22, 28672
    buffer_load_dwordx4 v[52:55], v7, s[8:11], s19 offen
    s_add_u32 s19, s22, 45056
    buffer_load_dwordx4 v[56:59], v7, s[8:11], s19 offen
    s_add_u32 s19, s22, 61440
    buffer_load_dwordx4 v[60:63], v7, s[8:11], s19 offen
    s_add_u32 s19, s22, 77824
    buffer_load_dwordx4 v[64:67], v7, s[8:11], s19 offen
    s_add_u32 s19, s22, 94208
    buffer_load_dwordx4 v[68:71], v7, s[8:11], s19 offen
    s_add_u32 s19, s22, 110592
    buffer_load_dwordx4 v[72:75], v7, s[8:11], s19 offen
    s_add_u32 s19, s22, 126976
    buffer_load_dwordx4 v[76:79], v7, s[8:11], s19 offen
    buffer_load_dwordx4 v[112:115], v6, s[8:11], s24 offen offset:768
    s_waitcnt vmcnt(9)
    v_mfma_f32_16x16x32_bf16 v[16:19], v[80:83], v[116:119], v[16:19]
    v_mfma_f32_16x16x32_bf16 v[20:23], v[84:87], v[116:119], v[20:23]
    v_mfma_f32_16x16x32_bf16 v[24:27], v[88:91], v[116:119], v[24:27]
    v_mfma_f32_16x16x32_bf16 v[28:31], v[92:95], v[116:119], v[28:31]
    v_mfma_f32_16x16x32_bf16 v[32:35], v[96:99], v[116:119], v[32:35]
    v_mfma_f32_16x16x32_bf16 v[36:39], v[100:103], v[116:119], v[36:39]
    v_mfma_f32_16x16x32_bf16 v[40:43], v[104:107], v[116:119], v[40:43]
    v_mfma_f32_16x16x32_bf16 v[44:47], v[108:111], v[116:119], v[44:47]
    s_add_u32 s19, s22, 13312
    buffer_load_dwordx4 v[80:83], v7, s[8:11], s19 offen
    s_add_u32 s19, s22, 29696
    buffer_load_dwordx4 v[84:87], v7, s[8:11], s19 offen
    s_add_u32 s19, s22, 46080
    buffer_load_dwordx4 v[88:91], v7, s[8:11], s19 offen
    s_add_u32 s19, s22, 62464
    buffer_load_dwordx4 v[92:95], v7, s[8:11], s19 offen
    s_add_u32 s19, s22, 78848
    buffer_load_dwordx4 v[96:99], v7, s[8:11], s19 offen
    s_add_u32 s19, s22, 95232
    buffer_load_dwordx4 v[100:103], v7, s[8:11], s19 offen
    s_add_u32 s19, s22, 111616
    buffer_load_dwordx4 v[104:107], v7, s[8:11], s19 offen
    s_add_u32 s19, s22, 128000
    buffer_load_dwordx4 v[108:111], v7, s[8:11], s19 offen
    buffer_load_dwordx4 v[116:119], v6, s[8:11], s24 offen offset:832
    s_waitcnt vmcnt(9)
    v_mfma_f32_16x16x32_bf16 v[16:19], v[48:51], v[112:115], v[16:19]
    v_mfma_f32_16x16x32_bf16 v[20:23], v[52:55], v[112:115], v[20:23]
    v_mfma_f32_16x16x32_bf16 v[24:27], v[56:59], v[112:115], v[24:27]
    v_mfma_f32_16x16x32_bf16 v[28:31], v[60:63], v[112:115], v[28:31]
    v_mfma_f32_16x16x32_bf16 v[32:35], v[64:67], v[112:115], v[32:35]
    v_mfma_f32_16x16x32_bf16 v[36:39], v[68:71], v[112:115], v[36:39]
    v_mfma_f32_16x16x32_bf16 v[40:43], v[72:75], v[112:115], v[40:43]
    v_mfma_f32_16x16x32_bf16 v[44:47], v[76:79], v[112:115], v[44:47]
    s_add_u32 s19, s22, 14336
    buffer_load_dwordx4 v[48:51], v7, s[8:11], s19 offen
    s_add_u32 s19, s22, 30720
    buffer_load_dwordx4 v[52:55], v7, s[8:11], s19 offen
    s_add_u32 s19, s22, 47104
    buffer_load_dwordx4 v[56:59], v7, s[8:11], s19 offen
    s_add_u32 s19, s22, 63488
    buffer_load_dwordx4 v[60:63], v7, s[8:11], s19 offen
    s_add_u32 s19, s22, 79872
    buffer_load_dwordx4 v[64:67], v7, s[8:11], s19 offen
    s_add_u32 s19, s22, 96256
    buffer_load_dwordx4 v[68:71], v7, s[8:11], s19 offen
    s_add_u32 s19, s22, 112640
    buffer_load_dwordx4 v[72:75], v7, s[8:11], s19 offen
    s_add_u32 s19, s22, 129024
    buffer_load_dwordx4 v[76:79], v7, s[8:11], s19 offen
    buffer_load_dwordx4 v[112:115], v6, s[8:11], s24 offen offset:896
    s_waitcnt vmcnt(9)
    v_mfma_f32_16x16x32_bf16 v[16:19], v[80:83], v[116:119], v[16:19]
    v_mfma_f32_16x16x32_bf16 v[20:23], v[84:87], v[116:119], v[20:23]
    v_mfma_f32_16x16x32_bf16 v[24:27], v[88:91], v[116:119], v[24:27]
    v_mfma_f32_16x16x32_bf16 v[28:31], v[92:95], v[116:119], v[28:31]
    v_mfma_f32_16x16x32_bf16 v[32:35], v[96:99], v[116:119], v[32:35]
    v_mfma_f32_16x16x32_bf16 v[36:39], v[100:103], v[116:119], v[36:39]
    v_mfma_f32_16x16x32_bf16 v[40:43], v[104:107], v[116:119], v[40:43]
    v_mfma_f32_16x16x32_bf16 v[44:47], v[108:111], v[116:119], v[44:47]
    s_add_u32 s19, s22, 15360
    buffer_load_dwordx4 v[80:83], v7, s[8:11], s19 offen
    s_add_u32 s19, s22, 31744
    buffer_load_dwordx4 v[84:87], v7, s[8:11], s19 offen
    s_add_u32 s19, s22, 48128
    buffer_load_dwordx4 v[88:91], v7, s[8:11], s19 offen
    s_add_u32 s19, s22, 64512
    buffer_load_dwordx4 v[92:95], v7, s[8:11], s19 offen
    s_add_u32 s19, s22, 80896
    buffer_load_dwordx4 v[96:99], v7, s[8:11], s19 offen
    s_add_u32 s19, s22, 97280
    buffer_load_dwordx4 v[100:103], v7, s[8:11], s19 offen
    s_add_u32 s19, s22, 113664
    buffer_load_dwordx4 v[104:107], v7, s[8:11], s19 offen
    s_add_u32 s19, s22, 130048
    buffer_load_dwordx4 v[108:111], v7, s[8:11], s19 offen
    buffer_load_dwordx4 v[116:119], v6, s[8:11], s24 offen offset:960
    s_waitcnt vmcnt(9)
    v_mfma_f32_16x16x32_bf16 v[16:19], v[48:51], v[112:115], v[16:19]
    v_mfma_f32_16x16x32_bf16 v[20:23], v[52:55], v[112:115], v[20:23]
    v_mfma_f32_16x16x32_bf16 v[24:27], v[56:59], v[112:115], v[24:27]
    v_mfma_f32_16x16x32_bf16 v[28:31], v[60:63], v[112:115], v[28:31]
    v_mfma_f32_16x16x32_bf16 v[32:35], v[64:67], v[112:115], v[32:35]
    v_mfma_f32_16x16x32_bf16 v[36:39], v[68:71], v[112:115], v[36:39]
    v_mfma_f32_16x16x32_bf16 v[40:43], v[72:75], v[112:115], v[40:43]
    v_mfma_f32_16x16x32_bf16 v[44:47], v[76:79], v[112:115], v[44:47]
    s_waitcnt vmcnt(0)
    v_mfma_f32_16x16x32_bf16 v[16:19], v[80:83], v[116:119], v[16:19]
    v_mfma_f32_16x16x32_bf16 v[20:23], v[84:87], v[116:119], v[20:23]
    v_mfma_f32_16x16x32_bf16 v[24:27], v[88:91], v[116:119], v[24:27]
    v_mfma_f32_16x16x32_bf16 v[28:31], v[92:95], v[116:119], v[28:31]
    v_mfma_f32_16x16x32_bf16 v[32:35], v[96:99], v[116:119], v[32:35]
    v_mfma_f32_16x16x32_bf16 v[36:39], v[100:103], v[116:119], v[36:39]
    v_mfma_f32_16x16x32_bf16 v[40:43], v[104:107], v[116:119], v[40:43]
    v_mfma_f32_16x16x32_bf16 v[44:47], v[108:111], v[116:119], v[44:47]
    v_lshlrev_b32 v8, 10, v3
    v_lshl_add_u32 v8, v2, 3, v8
    s_lshl_b32 s19, s16, 8
    s_add_u32 s3, s3, s19
    buffer_load_dwordx2 v[48:49], v8, s[12:15], s3 offen offset:0
    buffer_load_dwordx2 v[50:51], v8, s[12:15], s3 offen offset:32
    buffer_load_dwordx2 v[52:53], v8, s[12:15], s3 offen offset:64
    buffer_load_dwordx2 v[54:55], v8, s[12:15], s3 offen offset:96
    buffer_load_dwordx2 v[56:57], v8, s[12:15], s3 offen offset:128
    buffer_load_dwordx2 v[58:59], v8, s[12:15], s3 offen offset:160
    buffer_load_dwordx2 v[60:61], v8, s[12:15], s3 offen offset:192
    buffer_load_dwordx2 v[62:63], v8, s[12:15], s3 offen offset:224
    v_mul_u32_u24 v9, 1040, v3
    v_lshl_add_u32 v9, v2, 3, v9
    v_add_u32 v9, s19, v9
    s_waitcnt vmcnt(0)
    v_cvt_pk_bf16_f32 v16, v16, v17
    v_cvt_pk_bf16_f32 v18, v18, v19
    v_lshlrev_b32 v100, 16, v16
    v_and_b32 v101, 0xffff0000, v16
    v_lshlrev_b32 v102, 16, v18
    v_and_b32 v103, 0xffff0000, v18
    v_lshlrev_b32 v104, 16, v48
    v_and_b32 v105, 0xffff0000, v48
    v_lshlrev_b32 v106, 16, v49
    v_and_b32 v107, 0xffff0000, v49
    v_add_f32 v100, v100, v104
    v_add_f32 v101, v101, v105
    v_add_f32 v102, v102, v106
    v_add_f32 v103, v103, v107
    v_cvt_pk_bf16_f32 v16, v100, v101
    v_cvt_pk_bf16_f32 v17, v102, v103
    ds_write_b64 v9, v[16:17] offset:0
    v_cvt_pk_bf16_f32 v20, v20, v21
    v_cvt_pk_bf16_f32 v22, v22, v23
    v_lshlrev_b32 v100, 16, v20
    v_and_b32 v101, 0xffff0000, v20
    v_lshlrev_b32 v102, 16, v22
    v_and_b32 v103, 0xffff0000, v22
    v_lshlrev_b32 v104, 16, v50
    v_and_b32 v105, 0xffff0000, v50
    v_lshlrev_b32 v106, 16, v51
    v_and_b32 v107, 0xffff0000, v51
    v_add_f32 v100, v100, v104
    v_add_f32 v101, v101, v105
    v_add_f32 v102, v102, v106
    v_add_f32 v103, v103, v107
    v_cvt_pk_bf16_f32 v20, v100, v101
    v_cvt_pk_bf16_f32 v21, v102, v103
    ds_write_b64 v9, v[20:21] offset:32
    v_cvt_pk_bf16_f32 v24, v24, v25
    v_cvt_pk_bf16_f32 v26, v26, v27
    v_lshlrev_b32 v100, 16, v24
    v_and_b32 v101, 0xffff0000, v24
    v_lshlrev_b32 v102, 16, v26
    v_and_b32 v103, 0xffff0000, v26
    v_lshlrev_b32 v104, 16, v52
    v_and_b32 v105, 0xffff0000, v52
    v_lshlrev_b32 v106, 16, v53
    v_and_b32 v107, 0xffff0000, v53
    v_add_f32 v100, v100, v104
    v_add_f32 v101, v101, v105
    v_add_f32 v102, v102, v106
    v_add_f32 v103, v103, v107
    v_cvt_pk_bf16_f32 v24, v100, v101
    v_cvt_pk_bf16_f32 v25, v102, v103
    ds_write_b64 v9, v[24:25] offset:64
    v_cvt_pk_bf16_f32 v28, v28, v29
    v_cvt_pk_bf16_f32 v30, v30, v31
    v_lshlrev_b32 v100, 16, v28
    v_and_b32 v101, 0xffff0000, v28
    v_lshlrev_b32 v102, 16, v30
    v_and_b32 v103, 0xffff0000, v30
    v_lshlrev_b32 v104, 16, v54
    v_and_b32 v105, 0xffff0000, v54
    v_lshlrev_b32 v106, 16, v55
    v_and_b32 v107, 0xffff0000, v55
    v_add_f32 v100, v100, v104
    v_add_f32 v101, v101, v105
    v_add_f32 v102, v102, v106
    v_add_f32 v103, v103, v107
    v_cvt_pk_bf16_f32 v28, v100, v101
    v_cvt_pk_bf16_f32 v29, v102, v103
    ds_write_b64 v9, v[28:29] offset:96
    v_cvt_pk_bf16_f32 v32, v32, v33
    v_cvt_pk_bf16_f32 v34, v34, v35
    v_lshlrev_b32 v100, 16, v32
    v_and_b32 v101, 0xffff0000, v32
    v_lshlrev_b32 v102, 16, v34
    v_and_b32 v103, 0xffff0000, v34
    v_lshlrev_b32 v104, 16, v56
    v_and_b32 v105, 0xffff0000, v56
    v_lshlrev_b32 v106, 16, v57
    v_and_b32 v107, 0xffff0000, v57
    v_add_f32 v100, v100, v104
    v_add_f32 v101, v101, v105
    v_add_f32 v102, v102, v106
    v_add_f32 v103, v103, v107
    v_cvt_pk_bf16_f32 v32, v100, v101
    v_cvt_pk_bf16_f32 v33, v102, v103
    ds_write_b64 v9, v[32:33] offset:128
    v_cvt_pk_bf16_f32 v36, v36, v37
    v_cvt_pk_bf16_f32 v38, v38, v39
    v_lshlrev_b32 v100, 16, v36
    v_and_b32 v101, 0xffff0000, v36
    v_lshlrev_b32 v102, 16, v38
    v_and_b32 v103, 0xffff0000, v38
    v_lshlrev_b32 v104, 16, v58
    v_and_b32 v105, 0xffff0000, v58
    v_lshlrev_b32 v106, 16, v59
    v_and_b32 v107, 0xffff0000, v59
    v_add_f32 v100, v100, v104
    v_add_f32 v101, v101, v105
    v_add_f32 v102, v102, v106
    v_add_f32 v103, v103, v107
    v_cvt_pk_bf16_f32 v36, v100, v101
    v_cvt_pk_bf16_f32 v37, v102, v103
    ds_write_b64 v9, v[36:37] offset:160
    v_cvt_pk_bf16_f32 v40, v40, v41
    v_cvt_pk_bf16_f32 v42, v42, v43
    v_lshlrev_b32 v100, 16, v40
    v_and_b32 v101, 0xffff0000, v40
    v_lshlrev_b32 v102, 16, v42
    v_and_b32 v103, 0xffff0000, v42
    v_lshlrev_b32 v104, 16, v60
    v_and_b32 v105, 0xffff0000, v60
    v_lshlrev_b32 v106, 16, v61
    v_and_b32 v107, 0xffff0000, v61
    v_add_f32 v100, v100, v104
    v_add_f32 v101, v101, v105
    v_add_f32 v102, v102, v106
    v_add_f32 v103, v103, v107
    v_cvt_pk_bf16_f32 v40, v100, v101
    v_cvt_pk_bf16_f32 v41, v102, v103
    ds_write_b64 v9, v[40:41] offset:192
    v_cvt_pk_bf16_f32 v44, v44, v45
    v_cvt_pk_bf16_f32 v46, v46, v47
    v_lshlrev_b32 v100, 16, v44
    v_and_b32 v101, 0xffff0000, v44
    v_lshlrev_b32 v102, 16, v46
    v_and_b32 v103, 0xffff0000, v46
    v_lshlrev_b32 v104, 16, v62
    v_and_b32 v105, 0xffff0000, v62
    v_lshlrev_b32 v106, 16, v63
    v_and_b32 v107, 0xffff0000, v63
    v_add_f32 v100, v100, v104
    v_add_f32 v101, v101, v105
    v_add_f32 v102, v102, v106
    v_add_f32 v103, v103, v107
    v_cvt_pk_bf16_f32 v44, v100, v101
    v_cvt_pk_bf16_f32 v45, v102, v103
    ds_write_b64 v9, v[44:45] offset:224
    s_waitcnt lgkmcnt(0)
    s_barrier
    s_lshl_b32 s19, s16, 2
    v_add_u32 v5, s19, v2
    v_mul_u32_u24 v10, 1040, v5
    v_lshl_add_u32 v10, v3, 6, v10
    ds_read_b128 v[16:19], v10 offset:0
    ds_read_b128 v[20:23], v10 offset:16
    ds_read_b128 v[24:27], v10 offset:32
    ds_read_b128 v[28:31], v10 offset:48
    v_lshlrev_b32 v11, 10, v5
    v_lshl_add_u32 v11, v3, 6, v11
    s_lshl_b32 s3, s2, 14
    s_add_u32 s24, s3, 20971520
    s_add_u32 s25, s3, 27262976
    s_waitcnt lgkmcnt(0)
    buffer_store_dwordx4 v[16:19], v11, s[8:11], s24 offen offset:0
    buffer_store_dwordx4 v[20:23], v11, s[8:11], s24 offen offset:16
    buffer_store_dwordx4 v[24:27], v11, s[8:11], s24 offen offset:32
    buffer_store_dwordx4 v[28:31], v11, s[8:11], s24 offen offset:48
    s_nop 1
    v_lshlrev_b32 v64, 16, v16
    v_and_b32 v65, 0xffff0000, v16
    v_lshlrev_b32 v66, 16, v17
    v_and_b32 v67, 0xffff0000, v17
    v_lshlrev_b32 v68, 16, v18
    v_and_b32 v69, 0xffff0000, v18
    v_lshlrev_b32 v70, 16, v19
    v_and_b32 v71, 0xffff0000, v19
    v_lshlrev_b32 v72, 16, v20
    v_and_b32 v73, 0xffff0000, v20
    v_lshlrev_b32 v74, 16, v21
    v_and_b32 v75, 0xffff0000, v21
    v_lshlrev_b32 v76, 16, v22
    v_and_b32 v77, 0xffff0000, v22
    v_lshlrev_b32 v78, 16, v23
    v_and_b32 v79, 0xffff0000, v23
    v_lshlrev_b32 v80, 16, v24
    v_and_b32 v81, 0xffff0000, v24
    v_lshlrev_b32 v82, 16, v25
    v_and_b32 v83, 0xffff0000, v25
    v_lshlrev_b32 v84, 16, v26
    v_and_b32 v85, 0xffff0000, v26
    v_lshlrev_b32 v86, 16, v27
    v_and_b32 v87, 0xffff0000, v27
    v_lshlrev_b32 v88, 16, v28
    v_and_b32 v89, 0xffff0000, v28
    v_lshlrev_b32 v90, 16, v29
    v_and_b32 v91, 0xffff0000, v29
    v_lshlrev_b32 v92, 16, v30
    v_and_b32 v93, 0xffff0000, v30
    v_lshlrev_b32 v94, 16, v31
    v_and_b32 v95, 0xffff0000, v31
    v_add_f32 v96, v64, v65
    v_add_f32 v96, v96, v66
    v_add_f32 v96, v96, v67
    v_add_f32 v96, v96, v68
    v_add_f32 v96, v96, v69
    v_add_f32 v96, v96, v70
    v_add_f32 v96, v96, v71
    v_add_f32 v96, v96, v72
    v_add_f32 v96, v96, v73
    v_add_f32 v96, v96, v74
    v_add_f32 v96, v96, v75
    v_add_f32 v96, v96, v76
    v_add_f32 v96, v96, v77
    v_add_f32 v96, v96, v78
    v_add_f32 v96, v96, v79
    v_add_f32 v96, v96, v80
    v_add_f32 v96, v96, v81
    v_add_f32 v96, v96, v82
    v_add_f32 v96, v96, v83
    v_add_f32 v96, v96, v84
    v_add_f32 v96, v96, v85
    v_add_f32 v96, v96, v86
    v_add_f32 v96, v96, v87
    v_add_f32 v96, v96, v88
    v_add_f32 v96, v96, v89
    v_add_f32 v96, v96, v90
    v_add_f32 v96, v96, v91
    v_add_f32 v96, v96, v92
    v_add_f32 v96, v96, v93
    v_add_f32 v96, v96, v94
    v_add_f32 v96, v96, v95
    s_nop 1
    v_add_f32_dpp v96, v96, v96 row_ror:8 row_mask:0xf bank_mask:0xf
    s_nop 1
    v_add_f32_dpp v96, v96, v96 row_ror:4 row_mask:0xf bank_mask:0xf
    s_nop 1
    v_add_f32_dpp v96, v96, v96 row_ror:2 row_mask:0xf bank_mask:0xf
    s_nop 1
    v_add_f32_dpp v96, v96, v96 row_ror:1 row_mask:0xf bank_mask:0xf
    v_mul_f32 v97, 0x3b000000, v96
    v_mov_b32 v99, 0
    v_sub_f32 v98, v64, v97
    v_fmac_f32 v99, v98, v98
    v_sub_f32 v98, v65, v97
    v_fmac_f32 v99, v98, v98
    v_sub_f32 v98, v66, v97
    v_fmac_f32 v99, v98, v98
    v_sub_f32 v98, v67, v97
    v_fmac_f32 v99, v98, v98
    v_sub_f32 v98, v68, v97
    v_fmac_f32 v99, v98, v98
    v_sub_f32 v98, v69, v97
    v_fmac_f32 v99, v98, v98
    v_sub_f32 v98, v70, v97
    v_fmac_f32 v99, v98, v98
    v_sub_f32 v98, v71, v97
    v_fmac_f32 v99, v98, v98
    v_sub_f32 v98, v72, v97
    v_fmac_f32 v99, v98, v98
    v_sub_f32 v98, v73, v97
    v_fmac_f32 v99, v98, v98
    v_sub_f32 v98, v74, v97
    v_fmac_f32 v99, v98, v98
    v_sub_f32 v98, v75, v97
    v_fmac_f32 v99, v98, v98
    v_sub_f32 v98, v76, v97
    v_fmac_f32 v99, v98, v98
    v_sub_f32 v98, v77, v97
    v_fmac_f32 v99, v98, v98
    v_sub_f32 v98, v78, v97
    v_fmac_f32 v99, v98, v98
    v_sub_f32 v98, v79, v97
    v_fmac_f32 v99, v98, v98
    v_sub_f32 v98, v80, v97
    v_fmac_f32 v99, v98, v98
    v_sub_f32 v98, v81, v97
    v_fmac_f32 v99, v98, v98
    v_sub_f32 v98, v82, v97
    v_fmac_f32 v99, v98, v98
    v_sub_f32 v98, v83, v97
    v_fmac_f32 v99, v98, v98
    v_sub_f32 v98, v84, v97
    v_fmac_f32 v99, v98, v98
    v_sub_f32 v98, v85, v97
    v_fmac_f32 v99, v98, v98
    v_sub_f32 v98, v86, v97
    v_fmac_f32 v99, v98, v98
    v_sub_f32 v98, v87, v97
    v_fmac_f32 v99, v98, v98
    v_sub_f32 v98, v88, v97
    v_fmac_f32 v99, v98, v98
    v_sub_f32 v98, v89, v97
    v_fmac_f32 v99, v98, v98
    v_sub_f32 v98, v90, v97
    v_fmac_f32 v99, v98, v98
    v_sub_f32 v98, v91, v97
    v_fmac_f32 v99, v98, v98
    v_sub_f32 v98, v92, v97
    v_fmac_f32 v99, v98, v98
    v_sub_f32 v98, v93, v97
    v_fmac_f32 v99, v98, v98
    v_sub_f32 v98, v94, v97
    v_fmac_f32 v99, v98, v98
    v_sub_f32 v98, v95, v97
    v_fmac_f32 v99, v98, v98
    s_nop 1
    v_add_f32_dpp v99, v99, v99 row_ror:8 row_mask:0xf bank_mask:0xf
    s_nop 1
    v_add_f32_dpp v99, v99, v99 row_ror:4 row_mask:0xf bank_mask:0xf
    s_nop 1
    v_add_f32_dpp v99, v99, v99 row_ror:2 row_mask:0xf bank_mask:0xf
    s_nop 1
    v_add_f32_dpp v99, v99, v99 row_ror:1 row_mask:0xf bank_mask:0xf
    v_mul_f32 v99, 0x3b000000, v99
    v_cvt_pk_bf16_f32 v100, v97, v99
    v_lshlrev_b32 v97, 16, v100
    v_and_b32 v99, 0xffff0000, v100
    v_add_f32 v99, 0x3727c5ac, v99
    v_cvt_pk_bf16_f32 v100, v99, v99
    v_lshlrev_b32 v99, 16, v100
    v_sqrt_f32 v99, v99
    s_nop 0
    v_cvt_pk_bf16_f32 v100, v99, v99
    v_lshlrev_b32 v99, 16, v100
    v_rcp_f32 v99, v99
    s_nop 0
    v_sub_f32 v100, v64, v97
    v_sub_f32 v101, v65, v97
    v_cvt_pk_bf16_f32 v102, v100, v101
    v_lshlrev_b32 v100, 16, v102
    v_and_b32 v101, 0xffff0000, v102
    v_mul_f32 v100, v99, v100
    v_mul_f32 v101, v99, v101
    v_cvt_pk_bf16_f32 v16, v100, v101
    v_sub_f32 v100, v66, v97
    v_sub_f32 v101, v67, v97
    v_cvt_pk_bf16_f32 v102, v100, v101
    v_lshlrev_b32 v100, 16, v102
    v_and_b32 v101, 0xffff0000, v102
    v_mul_f32 v100, v99, v100
    v_mul_f32 v101, v99, v101
    v_cvt_pk_bf16_f32 v17, v100, v101
    v_sub_f32 v100, v68, v97
    v_sub_f32 v101, v69, v97
    v_cvt_pk_bf16_f32 v102, v100, v101
    v_lshlrev_b32 v100, 16, v102
    v_and_b32 v101, 0xffff0000, v102
    v_mul_f32 v100, v99, v100
    v_mul_f32 v101, v99, v101
    v_cvt_pk_bf16_f32 v18, v100, v101
    v_sub_f32 v100, v70, v97
    v_sub_f32 v101, v71, v97
    v_cvt_pk_bf16_f32 v102, v100, v101
    v_lshlrev_b32 v100, 16, v102
    v_and_b32 v101, 0xffff0000, v102
    v_mul_f32 v100, v99, v100
    v_mul_f32 v101, v99, v101
    v_cvt_pk_bf16_f32 v19, v100, v101
    v_sub_f32 v100, v72, v97
    v_sub_f32 v101, v73, v97
    v_cvt_pk_bf16_f32 v102, v100, v101
    v_lshlrev_b32 v100, 16, v102
    v_and_b32 v101, 0xffff0000, v102
    v_mul_f32 v100, v99, v100
    v_mul_f32 v101, v99, v101
    v_cvt_pk_bf16_f32 v20, v100, v101
    v_sub_f32 v100, v74, v97
    v_sub_f32 v101, v75, v97
    v_cvt_pk_bf16_f32 v102, v100, v101
    v_lshlrev_b32 v100, 16, v102
    v_and_b32 v101, 0xffff0000, v102
    v_mul_f32 v100, v99, v100
    v_mul_f32 v101, v99, v101
    v_cvt_pk_bf16_f32 v21, v100, v101
    v_sub_f32 v100, v76, v97
    v_sub_f32 v101, v77, v97
    v_cvt_pk_bf16_f32 v102, v100, v101
    v_lshlrev_b32 v100, 16, v102
    v_and_b32 v101, 0xffff0000, v102
    v_mul_f32 v100, v99, v100
    v_mul_f32 v101, v99, v101
    v_cvt_pk_bf16_f32 v22, v100, v101
    v_sub_f32 v100, v78, v97
    v_sub_f32 v101, v79, v97
    v_cvt_pk_bf16_f32 v102, v100, v101
    v_lshlrev_b32 v100, 16, v102
    v_and_b32 v101, 0xffff0000, v102
    v_mul_f32 v100, v99, v100
    v_mul_f32 v101, v99, v101
    v_cvt_pk_bf16_f32 v23, v100, v101
    v_sub_f32 v100, v80, v97
    v_sub_f32 v101, v81, v97
    v_cvt_pk_bf16_f32 v102, v100, v101
    v_lshlrev_b32 v100, 16, v102
    v_and_b32 v101, 0xffff0000, v102
    v_mul_f32 v100, v99, v100
    v_mul_f32 v101, v99, v101
    v_cvt_pk_bf16_f32 v24, v100, v101
    v_sub_f32 v100, v82, v97
    v_sub_f32 v101, v83, v97
    v_cvt_pk_bf16_f32 v102, v100, v101
    v_lshlrev_b32 v100, 16, v102
    v_and_b32 v101, 0xffff0000, v102
    v_mul_f32 v100, v99, v100
    v_mul_f32 v101, v99, v101
    v_cvt_pk_bf16_f32 v25, v100, v101
    v_sub_f32 v100, v84, v97
    v_sub_f32 v101, v85, v97
    v_cvt_pk_bf16_f32 v102, v100, v101
    v_lshlrev_b32 v100, 16, v102
    v_and_b32 v101, 0xffff0000, v102
    v_mul_f32 v100, v99, v100
    v_mul_f32 v101, v99, v101
    v_cvt_pk_bf16_f32 v26, v100, v101
    v_sub_f32 v100, v86, v97
    v_sub_f32 v101, v87, v97
    v_cvt_pk_bf16_f32 v102, v100, v101
    v_lshlrev_b32 v100, 16, v102
    v_and_b32 v101, 0xffff0000, v102
    v_mul_f32 v100, v99, v100
    v_mul_f32 v101, v99, v101
    v_cvt_pk_bf16_f32 v27, v100, v101
    v_sub_f32 v100, v88, v97
    v_sub_f32 v101, v89, v97
    v_cvt_pk_bf16_f32 v102, v100, v101
    v_lshlrev_b32 v100, 16, v102
    v_and_b32 v101, 0xffff0000, v102
    v_mul_f32 v100, v99, v100
    v_mul_f32 v101, v99, v101
    v_cvt_pk_bf16_f32 v28, v100, v101
    v_sub_f32 v100, v90, v97
    v_sub_f32 v101, v91, v97
    v_cvt_pk_bf16_f32 v102, v100, v101
    v_lshlrev_b32 v100, 16, v102
    v_and_b32 v101, 0xffff0000, v102
    v_mul_f32 v100, v99, v100
    v_mul_f32 v101, v99, v101
    v_cvt_pk_bf16_f32 v29, v100, v101
    v_sub_f32 v100, v92, v97
    v_sub_f32 v101, v93, v97
    v_cvt_pk_bf16_f32 v102, v100, v101
    v_lshlrev_b32 v100, 16, v102
    v_and_b32 v101, 0xffff0000, v102
    v_mul_f32 v100, v99, v100
    v_mul_f32 v101, v99, v101
    v_cvt_pk_bf16_f32 v30, v100, v101
    v_sub_f32 v100, v94, v97
    v_sub_f32 v101, v95, v97
    v_cvt_pk_bf16_f32 v102, v100, v101
    v_lshlrev_b32 v100, 16, v102
    v_and_b32 v101, 0xffff0000, v102
    v_mul_f32 v100, v99, v100
    v_mul_f32 v101, v99, v101
    v_cvt_pk_bf16_f32 v31, v100, v101
    buffer_store_dwordx4 v[16:19], v11, s[8:11], s25 offen offset:0
    buffer_store_dwordx4 v[20:23], v11, s[8:11], s25 offen offset:16
    buffer_store_dwordx4 v[24:27], v11, s[8:11], s25 offen offset:32
    buffer_store_dwordx4 v[28:31], v11, s[8:11], s25 offen offset:48
L_ka3_end_15:
    s_endpgm
.section .rodata,"a"
.p2align 6
.amdhsa_kernel ka3_0_kernel
  .amdhsa_next_free_vgpr 120
  .amdhsa_next_free_sgpr 102
  .amdhsa_accum_offset 120
  .amdhsa_group_segment_fixed_size 0
  .amdhsa_kernarg_size 120
  .amdhsa_user_sgpr_count 2
  .amdhsa_user_sgpr_kernarg_segment_ptr 1
  .amdhsa_system_sgpr_workgroup_id_x 1
.end_amdhsa_kernel
.text

.p2align 8
.globl ka3_1_kernel
.type ka3_1_kernel,@function
ka3_1_kernel:
    s_cmp_ge_u32 s2, 128
    s_cbranch_scc1 L_ka3_end_16
    s_load_dwordx2 s[4:5], s[0:1], 112
    s_load_dwordx2 s[6:7], s[0:1], 0
    v_and_b32 v1, 63, v0
    v_lshrrev_b32 v2, 6, v0
    s_nop 0
    v_readfirstlane_b32 s16, v2
    v_lshrrev_b32 v2, 4, v1
    v_and_b32 v3, 15, v1
    s_waitcnt lgkmcnt(0)
    s_mov_b32 s8, s4
    s_and_b32 s9, s5, 0xffff
    s_mov_b32 s10, 268435456
    s_mov_b32 s11, 0x00020000
    s_mov_b32 s12, s6
    s_and_b32 s13, s7, 0xffff
    s_mov_b32 s14, 2097152
    s_mov_b32 s15, 0x00020000
    v_lshlrev_b32 v6, 10, v3
    v_lshl_add_u32 v6, v2, 4, v6
    s_lshl_b32 s3, s2, 14
    s_add_u32 s24, s3, 31457280
    v_lshlrev_b32 v7, 4, v1
    s_lshl_b32 s22, s16, 17
    s_add_u32 s22, s22, 17334272
    s_add_u32 s19, s22, 0
    buffer_load_dwordx4 v[48:51], v7, s[8:11], s19 offen
    s_add_u32 s19, s22, 16384
    buffer_load_dwordx4 v[52:55], v7, s[8:11], s19 offen
    s_add_u32 s19, s22, 32768
    buffer_load_dwordx4 v[56:59], v7, s[8:11], s19 offen
    s_add_u32 s19, s22, 49152
    buffer_load_dwordx4 v[60:63], v7, s[8:11], s19 offen
    s_add_u32 s19, s22, 65536
    buffer_load_dwordx4 v[64:67], v7, s[8:11], s19 offen
    s_add_u32 s19, s22, 81920
    buffer_load_dwordx4 v[68:71], v7, s[8:11], s19 offen
    s_add_u32 s19, s22, 98304
    buffer_load_dwordx4 v[72:75], v7, s[8:11], s19 offen
    s_add_u32 s19, s22, 114688
    buffer_load_dwordx4 v[76:79], v7, s[8:11], s19 offen
    buffer_load_dwordx4 v[112:115], v6, s[8:11], s24 offen offset:0
    s_add_u32 s19, s22, 1024
    buffer_load_dwordx4 v[80:83], v7, s[8:11], s19 offen
    s_add_u32 s19, s22, 17408
    buffer_load_dwordx4 v[84:87], v7, s[8:11], s19 offen
    s_add_u32 s19, s22, 33792
    buffer_load_dwordx4 v[88:91], v7, s[8:11], s19 offen
    s_add_u32 s19, s22, 50176
    buffer_load_dwordx4 v[92:95], v7, s[8:11], s19 offen
    s_add_u32 s19, s22, 66560
    buffer_load_dwordx4 v[96:99], v7, s[8:11], s19 offen
    s_add_u32 s19, s22, 82944
    buffer_load_dwordx4 v[100:103], v7, s[8:11], s19 offen
    s_add_u32 s19, s22, 99328
    buffer_load_dwordx4 v[104:107], v7, s[8:11], s19 offen
    s_add_u32 s19, s22, 115712
    buffer_load_dwordx4 v[108:111], v7, s[8:11], s19 offen
    buffer_load_dwordx4 v[116:119], v6, s[8:11], s24 offen offset:64
    s_waitcnt vmcnt(9)
    v_mfma_f32_16x16x32_bf16 v[16:19], v[48:51], v[112:115], 0
    v_mfma_f32_16x16x32_bf16 v[20:23], v[52:55], v[112:115], 0
    v_mfma_f32_16x16x32_bf16 v[24:27], v[56:59], v[112:115], 0
    v_mfma_f32_16x16x32_bf16 v[28:31], v[60:63], v[112:115], 0
    v_mfma_f32_16x16x32_bf16 v[32:35], v[64:67], v[112:115], 0
    v_mfma_f32_16x16x32_bf16 v[36:39], v[68:71], v[112:115], 0
    v_mfma_f32_16x16x32_bf16 v[40:43], v[72:75], v[112:115], 0
    v_mfma_f32_16x16x32_bf16 v[44:47], v[76:79], v[112:115], 0
    s_add_u32 s19, s22, 2048
    buffer_load_dwordx4 v[48:51], v7, s[8:11], s19 offen
    s_add_u32 s19, s22, 18432
    buffer_load_dwordx4 v[52:55], v7, s[8:11], s19 offen
    s_add_u32 s19, s22, 34816
    buffer_load_dwordx4 v[56:59], v7, s[8:11], s19 offen
    s_add_u32 s19, s22, 51200
    buffer_load_dwordx4 v[60:63], v7, s[8:11], s19 offen
    s_add_u32 s19, s22, 67584
    buffer_load_dwordx4 v[64:67], v7, s[8:11], s19 offen
    s_add_u32 s19, s22, 83968
    buffer_load_dwordx4 v[68:71], v7, s[8:11], s19 offen
    s_add_u32 s19, s22, 100352
    buffer_load_dwordx4 v[72:75], v7, s[8:11], s19 offen
    s_add_u32 s19, s22, 116736
    buffer_load_dwordx4 v[76:79], v7, s[8:11], s19 offen
    buffer_load_dwordx4 v[112:115], v6, s[8:11], s24 offen offset:128
    s_waitcnt vmcnt(9)
    v_mfma_f32_16x16x32_bf16 v[16:19], v[80:83], v[116:119], v[16:19]
    v_mfma_f32_16x16x32_bf16 v[20:23], v[84:87], v[116:119], v[20:23]
    v_mfma_f32_16x16x32_bf16 v[24:27], v[88:91], v[116:119], v[24:27]
    v_mfma_f32_16x16x32_bf16 v[28:31], v[92:95], v[116:119], v[28:31]
    v_mfma_f32_16x16x32_bf16 v[32:35], v[96:99], v[116:119], v[32:35]
    v_mfma_f32_16x16x32_bf16 v[36:39], v[100:103], v[116:119], v[36:39]
    v_mfma_f32_16x16x32_bf16 v[40:43], v[104:107], v[116:119], v[40:43]
    v_mfma_f32_16x16x32_bf16 v[44:47], v[108:111], v[116:119], v[44:47]
    s_add_u32 s19, s22, 3072
    buffer_load_dwordx4 v[80:83], v7, s[8:11], s19 offen
    s_add_u32 s19, s22, 19456
    buffer_load_dwordx4 v[84:87], v7, s[8:11], s19 offen
    s_add_u32 s19, s22, 35840
    buffer_load_dwordx4 v[88:91], v7, s[8:11], s19 offen
    s_add_u32 s19, s22, 52224
    buffer_load_dwordx4 v[92:95], v7, s[8:11], s19 offen
    s_add_u32 s19, s22, 68608
    buffer_load_dwordx4 v[96:99], v7, s[8:11], s19 offen
    s_add_u32 s19, s22, 84992
    buffer_load_dwordx4 v[100:103], v7, s[8:11], s19 offen
    s_add_u32 s19, s22, 101376
    buffer_load_dwordx4 v[104:107], v7, s[8:11], s19 offen
    s_add_u32 s19, s22, 117760
    buffer_load_dwordx4 v[108:111], v7, s[8:11], s19 offen
    buffer_load_dwordx4 v[116:119], v6, s[8:11], s24 offen offset:192
    s_waitcnt vmcnt(9)
    v_mfma_f32_16x16x32_bf16 v[16:19], v[48:51], v[112:115], v[16:19]
    v_mfma_f32_16x16x32_bf16 v[20:23], v[52:55], v[112:115], v[20:23]
    v_mfma_f32_16x16x32_bf16 v[24:27], v[56:59], v[112:115], v[24:27]
    v_mfma_f32_16x16x32_bf16 v[28:31], v[60:63], v[112:115], v[28:31]
    v_mfma_f32_16x16x32_bf16 v[32:35], v[64:67], v[112:115], v[32:35]
    v_mfma_f32_16x16x32_bf16 v[36:39], v[68:71], v[112:115], v[36:39]
    v_mfma_f32_16x16x32_bf16 v[40:43], v[72:75], v[112:115], v[40:43]
    v_mfma_f32_16x16x32_bf16 v[44:47], v[76:79], v[112:115], v[44:47]
    s_add_u32 s19, s22, 4096
    buffer_load_dwordx4 v[48:51], v7, s[8:11], s19 offen
    s_add_u32 s19, s22, 20480
    buffer_load_dwordx4 v[52:55], v7, s[8:11], s19 offen
    s_add_u32 s19, s22, 36864
    buffer_load_dwordx4 v[56:59], v7, s[8:11], s19 offen
    s_add_u32 s19, s22, 53248
    buffer_load_dwordx4 v[60:63], v7, s[8:11], s19 offen
    s_add_u32 s19, s22, 69632
    buffer_load_dwordx4 v[64:67], v7, s[8:11], s19 offen
    s_add_u32 s19, s22, 86016
    buffer_load_dwordx4 v[68:71], v7, s[8:11], s19 offen
    s_add_u32 s19, s22, 102400
    buffer_load_dwordx4 v[72:75], v7, s[8:11], s19 offen
    s_add_u32 s19, s22, 118784
    buffer_load_dwordx4 v[76:79], v7, s[8:11], s19 offen
    buffer_load_dwordx4 v[112:115], v6, s[8:11], s24 offen offset:256
    s_waitcnt vmcnt(9)
    v_mfma_f32_16x16x32_bf16 v[16:19], v[80:83], v[116:119], v[16:19]
    v_mfma_f32_16x16x32_bf16 v[20:23], v[84:87], v[116:119], v[20:23]
    v_mfma_f32_16x16x32_bf16 v[24:27], v[88:91], v[116:119], v[24:27]
    v_mfma_f32_16x16x32_bf16 v[28:31], v[92:95], v[116:119], v[28:31]
    v_mfma_f32_16x16x32_bf16 v[32:35], v[96:99], v[116:119], v[32:35]
    v_mfma_f32_16x16x32_bf16 v[36:39], v[100:103], v[116:119], v[36:39]
    v_mfma_f32_16x16x32_bf16 v[40:43], v[104:107], v[116:119], v[40:43]
    v_mfma_f32_16x16x32_bf16 v[44:47], v[108:111], v[116:119], v[44:47]
    s_add_u32 s19, s22, 5120
    buffer_load_dwordx4 v[80:83], v7, s[8:11], s19 offen
    s_add_u32 s19, s22, 21504
    buffer_load_dwordx4 v[84:87], v7, s[8:11], s19 offen
    s_add_u32 s19, s22, 37888
    buffer_load_dwordx4 v[88:91], v7, s[8:11], s19 offen
    s_add_u32 s19, s22, 54272
    buffer_load_dwordx4 v[92:95], v7, s[8:11], s19 offen
    s_add_u32 s19, s22, 70656
    buffer_load_dwordx4 v[96:99], v7, s[8:11], s19 offen
    s_add_u32 s19, s22, 87040
    buffer_load_dwordx4 v[100:103], v7, s[8:11], s19 offen
    s_add_u32 s19, s22, 103424
    buffer_load_dwordx4 v[104:107], v7, s[8:11], s19 offen
    s_add_u32 s19, s22, 119808
    buffer_load_dwordx4 v[108:111], v7, s[8:11], s19 offen
    buffer_load_dwordx4 v[116:119], v6, s[8:11], s24 offen offset:320
    s_waitcnt vmcnt(9)
    v_mfma_f32_16x16x32_bf16 v[16:19], v[48:51], v[112:115], v[16:19]
    v_mfma_f32_16x16x32_bf16 v[20:23], v[52:55], v[112:115], v[20:23]
    v_mfma_f32_16x16x32_bf16 v[24:27], v[56:59], v[112:115], v[24:27]
    v_mfma_f32_16x16x32_bf16 v[28:31], v[60:63], v[112:115], v[28:31]
    v_mfma_f32_16x16x32_bf16 v[32:35], v[64:67], v[112:115], v[32:35]
    v_mfma_f32_16x16x32_bf16 v[36:39], v[68:71], v[112:115], v[36:39]
    v_mfma_f32_16x16x32_bf16 v[40:43], v[72:75], v[112:115], v[40:43]
    v_mfma_f32_16x16x32_bf16 v[44:47], v[76:79], v[112:115], v[44:47]
    s_add_u32 s19, s22, 6144
    buffer_load_dwordx4 v[48:51], v7, s[8:11], s19 offen
    s_add_u32 s19, s22, 22528
    buffer_load_dwordx4 v[52:55], v7, s[8:11], s19 offen
    s_add_u32 s19, s22, 38912
    buffer_load_dwordx4 v[56:59], v7, s[8:11], s19 offen
    s_add_u32 s19, s22, 55296
    buffer_load_dwordx4 v[60:63], v7, s[8:11], s19 offen
    s_add_u32 s19, s22, 71680
    buffer_load_dwordx4 v[64:67], v7, s[8:11], s19 offen
    s_add_u32 s19, s22, 88064
    buffer_load_dwordx4 v[68:71], v7, s[8:11], s19 offen
    s_add_u32 s19, s22, 104448
    buffer_load_dwordx4 v[72:75], v7, s[8:11], s19 offen
    s_add_u32 s19, s22, 120832
    buffer_load_dwordx4 v[76:79], v7, s[8:11], s19 offen
    buffer_load_dwordx4 v[112:115], v6, s[8:11], s24 offen offset:384
    s_waitcnt vmcnt(9)
    v_mfma_f32_16x16x32_bf16 v[16:19], v[80:83], v[116:119], v[16:19]
    v_mfma_f32_16x16x32_bf16 v[20:23], v[84:87], v[116:119], v[20:23]
    v_mfma_f32_16x16x32_bf16 v[24:27], v[88:91], v[116:119], v[24:27]
    v_mfma_f32_16x16x32_bf16 v[28:31], v[92:95], v[116:119], v[28:31]
    v_mfma_f32_16x16x32_bf16 v[32:35], v[96:99], v[116:119], v[32:35]
    v_mfma_f32_16x16x32_bf16 v[36:39], v[100:103], v[116:119], v[36:39]
    v_mfma_f32_16x16x32_bf16 v[40:43], v[104:107], v[116:119], v[40:43]
    v_mfma_f32_16x16x32_bf16 v[44:47], v[108:111], v[116:119], v[44:47]
    s_add_u32 s19, s22, 7168
    buffer_load_dwordx4 v[80:83], v7, s[8:11], s19 offen
    s_add_u32 s19, s22, 23552
    buffer_load_dwordx4 v[84:87], v7, s[8:11], s19 offen
    s_add_u32 s19, s22, 39936
    buffer_load_dwordx4 v[88:91], v7, s[8:11], s19 offen
    s_add_u32 s19, s22, 56320
    buffer_load_dwordx4 v[92:95], v7, s[8:11], s19 offen
    s_add_u32 s19, s22, 72704
    buffer_load_dwordx4 v[96:99], v7, s[8:11], s19 offen
    s_add_u32 s19, s22, 89088
    buffer_load_dwordx4 v[100:103], v7, s[8:11], s19 offen
    s_add_u32 s19, s22, 105472
    buffer_load_dwordx4 v[104:107], v7, s[8:11], s19 offen
    s_add_u32 s19, s22, 121856
    buffer_load_dwordx4 v[108:111], v7, s[8:11], s19 offen
    buffer_load_dwordx4 v[116:119], v6, s[8:11], s24 offen offset:448
    s_waitcnt vmcnt(9)
    v_mfma_f32_16x16x32_bf16 v[16:19], v[48:51], v[112:115], v[16:19]
    v_mfma_f32_16x16x32_bf16 v[20:23], v[52:55], v[112:115], v[20:23]
    v_mfma_f32_16x16x32_bf16 v[24:27], v[56:59], v[112:115], v[24:27]
    v_mfma_f32_16x16x32_bf16 v[28:31], v[60:63], v[112:115], v[28:31]
    v_mfma_f32_16x16x32_bf16 v[32:35], v[64:67], v[112:115], v[32:35]
    v_mfma_f32_16x16x32_bf16 v[36:39], v[68:71], v[112:115], v[36:39]
    v_mfma_f32_16x16x32_bf16 v[40:43], v[72:75], v[112:115], v[40:43]
    v_mfma_f32_16x16x32_bf16 v[44:47], v[76:79], v[112:115], v[44:47]
    s_add_u32 s19, s22, 8192
    buffer_load_dwordx4 v[48:51], v7, s[8:11], s19 offen
    s_add_u32 s19, s22, 24576
    buffer_load_dwordx4 v[52:55], v7, s[8:11], s19 offen
    s_add_u32 s19, s22, 40960
    buffer_load_dwordx4 v[56:59], v7, s[8:11], s19 offen
    s_add_u32 s19, s22, 57344
    buffer_load_dwordx4 v[60:63], v7, s[8:11], s19 offen
    s_add_u32 s19, s22, 73728
    buffer_load_dwordx4 v[64:67], v7, s[8:11], s19 offen
    s_add_u32 s19, s22, 90112
    buffer_load_dwordx4 v[68:71], v7, s[8:11], s19 offen
    s_add_u32 s19, s22, 106496
    buffer_load_dwordx4 v[72:75], v7, s[8:11], s19 offen
    s_add_u32 s19, s22, 122880
    buffer_load_dwordx4 v[76:79], v7, s[8:11], s19 offen
    buffer_load_dwordx4 v[112:115], v6, s[8:11], s24 offen offset:512
    s_waitcnt vmcnt(9)
    v_mfma_f32_16x16x32_bf16 v[16:19], v[80:83], v[116:119], v[16:19]
    v_mfma_f32_16x16x32_bf16 v[20:23], v[84:87], v[116:119], v[20:23]
    v_mfma_f32_16x16x32_bf16 v[24:27], v[88:91], v[116:119], v[24:27]
    v_mfma_f32_16x16x32_bf16 v[28:31], v[92:95], v[116:119], v[28:31]
    v_mfma_f32_16x16x32_bf16 v[32:35], v[96:99], v[116:119], v[32:35]
    v_mfma_f32_16x16x32_bf16 v[36:39], v[100:103], v[116:119], v[36:39]
    v_mfma_f32_16x16x32_bf16 v[40:43], v[104:107], v[116:119], v[40:43]
    v_mfma_f32_16x16x32_bf16 v[44:47], v[108:111], v[116:119], v[44:47]
    s_add_u32 s19, s22, 9216
    buffer_load_dwordx4 v[80:83], v7, s[8:11], s19 offen
    s_add_u32 s19, s22, 25600
    buffer_load_dwordx4 v[84:87], v7, s[8:11], s19 offen
    s_add_u32 s19, s22, 41984
    buffer_load_dwordx4 v[88:91], v7, s[8:11], s19 offen
    s_add_u32 s19, s22, 58368
    buffer_load_dwordx4 v[92:95], v7, s[8:11], s19 offen
    s_add_u32 s19, s22, 74752
    buffer_load_dwordx4 v[96:99], v7, s[8:11], s19 offen
    s_add_u32 s19, s22, 91136
    buffer_load_dwordx4 v[100:103], v7, s[8:11], s19 offen
    s_add_u32 s19, s22, 107520
    buffer_load_dwordx4 v[104:107], v7, s[8:11], s19 offen
    s_add_u32 s19, s22, 123904
    buffer_load_dwordx4 v[108:111], v7, s[8:11], s19 offen
    buffer_load_dwordx4 v[116:119], v6, s[8:11], s24 offen offset:576
    s_waitcnt vmcnt(9)
    v_mfma_f32_16x16x32_bf16 v[16:19], v[48:51], v[112:115], v[16:19]
    v_mfma_f32_16x16x32_bf16 v[20:23], v[52:55], v[112:115], v[20:23]
    v_mfma_f32_16x16x32_bf16 v[24:27], v[56:59], v[112:115], v[24:27]
    v_mfma_f32_16x16x32_bf16 v[28:31], v[60:63], v[112:115], v[28:31]
    v_mfma_f32_16x16x32_bf16 v[32:35], v[64:67], v[112:115], v[32:35]
    v_mfma_f32_16x16x32_bf16 v[36:39], v[68:71], v[112:115], v[36:39]
    v_mfma_f32_16x16x32_bf16 v[40:43], v[72:75], v[112:115], v[40:43]
    v_mfma_f32_16x16x32_bf16 v[44:47], v[76:79], v[112:115], v[44:47]
    s_add_u32 s19, s22, 10240
    buffer_load_dwordx4 v[48:51], v7, s[8:11], s19 offen
    s_add_u32 s19, s22, 26624
    buffer_load_dwordx4 v[52:55], v7, s[8:11], s19 offen
    s_add_u32 s19, s22, 43008
    buffer_load_dwordx4 v[56:59], v7, s[8:11], s19 offen
    s_add_u32 s19, s22, 59392
    buffer_load_dwordx4 v[60:63], v7, s[8:11], s19 offen
    s_add_u32 s19, s22, 75776
    buffer_load_dwordx4 v[64:67], v7, s[8:11], s19 offen
    s_add_u32 s19, s22, 92160
    buffer_load_dwordx4 v[68:71], v7, s[8:11], s19 offen
    s_add_u32 s19, s22, 108544
    buffer_load_dwordx4 v[72:75], v7, s[8:11], s19 offen
    s_add_u32 s19, s22, 124928
    buffer_load_dwordx4 v[76:79], v7, s[8:11], s19 offen
    buffer_load_dwordx4 v[112:115], v6, s[8:11], s24 offen offset:640
    s_waitcnt vmcnt(9)
    v_mfma_f32_16x16x32_bf16 v[16:19], v[80:83], v[116:119], v[16:19]
    v_mfma_f32_16x16x32_bf16 v[20:23], v[84:87], v[116:119], v[20:23]
    v_mfma_f32_16x16x32_bf16 v[24:27], v[88:91], v[116:119], v[24:27]
    v_mfma_f32_16x16x32_bf16 v[28:31], v[92:95], v[116:119], v[28:31]
    v_mfma_f32_16x16x32_bf16 v[32:35], v[96:99], v[116:119], v[32:35]
    v_mfma_f32_16x16x32_bf16 v[36:39], v[100:103], v[116:119], v[36:39]
    v_mfma_f32_16x16x32_bf16 v[40:43], v[104:107], v[116:119], v[40:43]
    v_mfma_f32_16x16x32_bf16 v[44:47], v[108:111], v[116:119], v[44:47]
    s_add_u32 s19, s22, 11264
    buffer_load_dwordx4 v[80:83], v7, s[8:11], s19 offen
    s_add_u32 s19, s22, 27648
    buffer_load_dwordx4 v[84:87], v7, s[8:11], s19 offen
    s_add_u32 s19, s22, 44032
    buffer_load_dwordx4 v[88:91], v7, s[8:11], s19 offen
    s_add_u32 s19, s22, 60416
    buffer_load_dwordx4 v[92:95], v7, s[8:11], s19 offen
    s_add_u32 s19, s22, 76800
    buffer_load_dwordx4 v[96:99], v7, s[8:11], s19 offen
    s_add_u32 s19, s22, 93184
    buffer_load_dwordx4 v[100:103], v7, s[8:11], s19 offen
    s_add_u32 s19, s22, 109568
    buffer_load_dwordx4 v[104:107], v7, s[8:11], s19 offen
    s_add_u32 s19, s22, 125952
    buffer_load_dwordx4 v[108:111], v7, s[8:11], s19 offen
    buffer_load_dwordx4 v[116:119], v6, s[8:11], s24 offen offset:704
    s_waitcnt vmcnt(9)
    v_mfma_f32_16x16x32_bf16 v[16:19], v[48:51], v[112:115], v[16:19]
    v_mfma_f32_16x16x32_bf16 v[20:23], v[52:55], v[112:115], v[20:23]
    v_mfma_f32_16x16x32_bf16 v[24:27], v[56:59], v[112:115], v[24:27]
    v_mfma_f32_16x16x32_bf16 v[28:31], v[60:63], v[112:115], v[28:31]
    v_mfma_f32_16x16x32_bf16 v[32:35], v[64:67], v[112:115], v[32:35]
    v_mfma_f32_16x16x32_bf16 v[36:39], v[68:71], v[112:115], v[36:39]
    v_mfma_f32_16x16x32_bf16 v[40:43], v[72:75], v[112:115], v[40:43]
    v_mfma_f32_16x16x32_bf16 v[44:47], v[76:79], v[112:115], v[44:47]
    s_add_u32 s19, s22, 12288
    buffer_load_dwordx4 v[48:51], v7, s[8:11], s19 offen
    s_add_u32 s19, s22, 28672
    buffer_load_dwordx4 v[52:55], v7, s[8:11], s19 offen
    s_add_u32 s19, s22, 45056
    buffer_load_dwordx4 v[56:59], v7, s[8:11], s19 offen
    s_add_u32 s19, s22, 61440
    buffer_load_dwordx4 v[60:63], v7, s[8:11], s19 offen
    s_add_u32 s19, s22, 77824
    buffer_load_dwordx4 v[64:67], v7, s[8:11], s19 offen
    s_add_u32 s19, s22, 94208
    buffer_load_dwordx4 v[68:71], v7, s[8:11], s19 offen
    s_add_u32 s19, s22, 110592
    buffer_load_dwordx4 v[72:75], v7, s[8:11], s19 offen
    s_add_u32 s19, s22, 126976
    buffer_load_dwordx4 v[76:79], v7, s[8:11], s19 offen
    buffer_load_dwordx4 v[112:115], v6, s[8:11], s24 offen offset:768
    s_waitcnt vmcnt(9)
    v_mfma_f32_16x16x32_bf16 v[16:19], v[80:83], v[116:119], v[16:19]
    v_mfma_f32_16x16x32_bf16 v[20:23], v[84:87], v[116:119], v[20:23]
    v_mfma_f32_16x16x32_bf16 v[24:27], v[88:91], v[116:119], v[24:27]
    v_mfma_f32_16x16x32_bf16 v[28:31], v[92:95], v[116:119], v[28:31]
    v_mfma_f32_16x16x32_bf16 v[32:35], v[96:99], v[116:119], v[32:35]
    v_mfma_f32_16x16x32_bf16 v[36:39], v[100:103], v[116:119], v[36:39]
    v_mfma_f32_16x16x32_bf16 v[40:43], v[104:107], v[116:119], v[40:43]
    v_mfma_f32_16x16x32_bf16 v[44:47], v[108:111], v[116:119], v[44:47]
    s_add_u32 s19, s22, 13312
    buffer_load_dwordx4 v[80:83], v7, s[8:11], s19 offen
    s_add_u32 s19, s22, 29696
    buffer_load_dwordx4 v[84:87], v7, s[8:11], s19 offen
    s_add_u32 s19, s22, 46080
    buffer_load_dwordx4 v[88:91], v7, s[8:11], s19 offen
    s_add_u32 s19, s22, 62464
    buffer_load_dwordx4 v[92:95], v7, s[8:11], s19 offen
    s_add_u32 s19, s22, 78848
    buffer_load_dwordx4 v[96:99], v7, s[8:11], s19 offen
    s_add_u32 s19, s22, 95232
    buffer_load_dwordx4 v[100:103], v7, s[8:11], s19 offen
    s_add_u32 s19, s22, 111616
    buffer_load_dwordx4 v[104:107], v7, s[8:11], s19 offen
    s_add_u32 s19, s22, 128000
    buffer_load_dwordx4 v[108:111], v7, s[8:11], s19 offen
    buffer_load_dwordx4 v[116:119], v6, s[8:11], s24 offen offset:832
    s_waitcnt vmcnt(9)
    v_mfma_f32_16x16x32_bf16 v[16:19], v[48:51], v[112:115], v[16:19]
    v_mfma_f32_16x16x32_bf16 v[20:23], v[52:55], v[112:115], v[20:23]
    v_mfma_f32_16x16x32_bf16 v[24:27], v[56:59], v[112:115], v[24:27]
    v_mfma_f32_16x16x32_bf16 v[28:31], v[60:63], v[112:115], v[28:31]
    v_mfma_f32_16x16x32_bf16 v[32:35], v[64:67], v[112:115], v[32:35]
    v_mfma_f32_16x16x32_bf16 v[36:39], v[68:71], v[112:115], v[36:39]
    v_mfma_f32_16x16x32_bf16 v[40:43], v[72:75], v[112:115], v[40:43]
    v_mfma_f32_16x16x32_bf16 v[44:47], v[76:79], v[112:115], v[44:47]
    s_add_u32 s19, s22, 14336
    buffer_load_dwordx4 v[48:51], v7, s[8:11], s19 offen
    s_add_u32 s19, s22, 30720
    buffer_load_dwordx4 v[52:55], v7, s[8:11], s19 offen
    s_add_u32 s19, s22, 47104
    buffer_load_dwordx4 v[56:59], v7, s[8:11], s19 offen
    s_add_u32 s19, s22, 63488
    buffer_load_dwordx4 v[60:63], v7, s[8:11], s19 offen
    s_add_u32 s19, s22, 79872
    buffer_load_dwordx4 v[64:67], v7, s[8:11], s19 offen
    s_add_u32 s19, s22, 96256
    buffer_load_dwordx4 v[68:71], v7, s[8:11], s19 offen
    s_add_u32 s19, s22, 112640
    buffer_load_dwordx4 v[72:75], v7, s[8:11], s19 offen
    s_add_u32 s19, s22, 129024
    buffer_load_dwordx4 v[76:79], v7, s[8:11], s19 offen
    buffer_load_dwordx4 v[112:115], v6, s[8:11], s24 offen offset:896
    s_waitcnt vmcnt(9)
    v_mfma_f32_16x16x32_bf16 v[16:19], v[80:83], v[116:119], v[16:19]
    v_mfma_f32_16x16x32_bf16 v[20:23], v[84:87], v[116:119], v[20:23]
    v_mfma_f32_16x16x32_bf16 v[24:27], v[88:91], v[116:119], v[24:27]
    v_mfma_f32_16x16x32_bf16 v[28:31], v[92:95], v[116:119], v[28:31]
    v_mfma_f32_16x16x32_bf16 v[32:35], v[96:99], v[116:119], v[32:35]
    v_mfma_f32_16x16x32_bf16 v[36:39], v[100:103], v[116:119], v[36:39]
    v_mfma_f32_16x16x32_bf16 v[40:43], v[104:107], v[116:119], v[40:43]
    v_mfma_f32_16x16x32_bf16 v[44:47], v[108:111], v[116:119], v[44:47]
    s_add_u32 s19, s22, 15360
    buffer_load_dwordx4 v[80:83], v7, s[8:11], s19 offen
    s_add_u32 s19, s22, 31744
    buffer_load_dwordx4 v[84:87], v7, s[8:11], s19 offen
    s_add_u32 s19, s22, 48128
    buffer_load_dwordx4 v[88:91], v7, s[8:11], s19 offen
    s_add_u32 s19, s22, 64512
    buffer_load_dwordx4 v[92:95], v7, s[8:11], s19 offen
    s_add_u32 s19, s22, 80896
    buffer_load_dwordx4 v[96:99], v7, s[8:11], s19 offen
    s_add_u32 s19, s22, 97280
    buffer_load_dwordx4 v[100:103], v7, s[8:11], s19 offen
    s_add_u32 s19, s22, 113664
    buffer_load_dwordx4 v[104:107], v7, s[8:11], s19 offen
    s_add_u32 s19, s22, 130048
    buffer_load_dwordx4 v[108:111], v7, s[8:11], s19 offen
    buffer_load_dwordx4 v[116:119], v6, s[8:11], s24 offen offset:960
    s_waitcnt vmcnt(9)
    v_mfma_f32_16x16x32_bf16 v[16:19], v[48:51], v[112:115], v[16:19]
    v_mfma_f32_16x16x32_bf16 v[20:23], v[52:55], v[112:115], v[20:23]
    v_mfma_f32_16x16x32_bf16 v[24:27], v[56:59], v[112:115], v[24:27]
    v_mfma_f32_16x16x32_bf16 v[28:31], v[60:63], v[112:115], v[28:31]
    v_mfma_f32_16x16x32_bf16 v[32:35], v[64:67], v[112:115], v[32:35]
    v_mfma_f32_16x16x32_bf16 v[36:39], v[68:71], v[112:115], v[36:39]
    v_mfma_f32_16x16x32_bf16 v[40:43], v[72:75], v[112:115], v[40:43]
    v_mfma_f32_16x16x32_bf16 v[44:47], v[76:79], v[112:115], v[44:47]
    s_waitcnt vmcnt(0)
    v_mfma_f32_16x16x32_bf16 v[16:19], v[80:83], v[116:119], v[16:19]
    v_mfma_f32_16x16x32_bf16 v[20:23], v[84:87], v[116:119], v[20:23]
    v_mfma_f32_16x16x32_bf16 v[24:27], v[88:91], v[116:119], v[24:27]
    v_mfma_f32_16x16x32_bf16 v[28:31], v[92:95], v[116:119], v[28:31]
    v_mfma_f32_16x16x32_bf16 v[32:35], v[96:99], v[116:119], v[32:35]
    v_mfma_f32_16x16x32_bf16 v[36:39], v[100:103], v[116:119], v[36:39]
    v_mfma_f32_16x16x32_bf16 v[40:43], v[104:107], v[116:119], v[40:43]
    v_mfma_f32_16x16x32_bf16 v[44:47], v[108:111], v[116:119], v[44:47]
    v_lshlrev_b32 v8, 10, v3
    v_lshl_add_u32 v8, v2, 3, v8
    s_lshl_b32 s19, s16, 8
    s_add_u32 s3, s3, s19
    s_add_u32 s3, s3, 23068672
    buffer_load_dwordx2 v[48:49], v8, s[8:11], s3 offen offset:0
    buffer_load_dwordx2 v[50:51], v8, s[8:11], s3 offen offset:32
    buffer_load_dwordx2 v[52:53], v8, s[8:11], s3 offen offset:64
    buffer_load_dwordx2 v[54:55], v8, s[8:11], s3 offen offset:96
    buffer_load_dwordx2 v[56:57], v8, s[8:11], s3 offen offset:128
    buffer_load_dwordx2 v[58:59], v8, s[8:11], s3 offen offset:160
    buffer_load_dwordx2 v[60:61], v8, s[8:11], s3 offen offset:192
    buffer_load_dwordx2 v[62:63], v8, s[8:11], s3 offen offset:224
    v_mul_u32_u24 v9, 1040, v3
    v_lshl_add_u32 v9, v2, 3, v9
    v_add_u32 v9, s19, v9
    s_waitcnt vmcnt(0)
    v_cvt_pk_bf16_f32 v16, v16, v17
    v_cvt_pk_bf16_f32 v18, v18, v19
    v_lshlrev_b32 v100, 16, v16
    v_and_b32 v101, 0xffff0000, v16
    v_lshlrev_b32 v102, 16, v18
    v_and_b32 v103, 0xffff0000, v18
    v_lshlrev_b32 v104, 16, v48
    v_and_b32 v105, 0xffff0000, v48
    v_lshlrev_b32 v106, 16, v49
    v_and_b32 v107, 0xffff0000, v49
    v_add_f32 v100, v100, v104
    v_add_f32 v101, v101, v105
    v_add_f32 v102, v102, v106
    v_add_f32 v103, v103, v107
    v_cvt_pk_bf16_f32 v16, v100, v101
    v_cvt_pk_bf16_f32 v17, v102, v103
    ds_write_b64 v9, v[16:17] offset:0
    v_cvt_pk_bf16_f32 v20, v20, v21
    v_cvt_pk_bf16_f32 v22, v22, v23
    v_lshlrev_b32 v100, 16, v20
    v_and_b32 v101, 0xffff0000, v20
    v_lshlrev_b32 v102, 16, v22
    v_and_b32 v103, 0xffff0000, v22
    v_lshlrev_b32 v104, 16, v50
    v_and_b32 v105, 0xffff0000, v50
    v_lshlrev_b32 v106, 16, v51
    v_and_b32 v107, 0xffff0000, v51
    v_add_f32 v100, v100, v104
    v_add_f32 v101, v101, v105
    v_add_f32 v102, v102, v106
    v_add_f32 v103, v103, v107
    v_cvt_pk_bf16_f32 v20, v100, v101
    v_cvt_pk_bf16_f32 v21, v102, v103
    ds_write_b64 v9, v[20:21] offset:32
    v_cvt_pk_bf16_f32 v24, v24, v25
    v_cvt_pk_bf16_f32 v26, v26, v27
    v_lshlrev_b32 v100, 16, v24
    v_and_b32 v101, 0xffff0000, v24
    v_lshlrev_b32 v102, 16, v26
    v_and_b32 v103, 0xffff0000, v26
    v_lshlrev_b32 v104, 16, v52
    v_and_b32 v105, 0xffff0000, v52
    v_lshlrev_b32 v106, 16, v53
    v_and_b32 v107, 0xffff0000, v53
    v_add_f32 v100, v100, v104
    v_add_f32 v101, v101, v105
    v_add_f32 v102, v102, v106
    v_add_f32 v103, v103, v107
    v_cvt_pk_bf16_f32 v24, v100, v101
    v_cvt_pk_bf16_f32 v25, v102, v103
    ds_write_b64 v9, v[24:25] offset:64
    v_cvt_pk_bf16_f32 v28, v28, v29
    v_cvt_pk_bf16_f32 v30, v30, v31
    v_lshlrev_b32 v100, 16, v28
    v_and_b32 v101, 0xffff0000, v28
    v_lshlrev_b32 v102, 16, v30
    v_and_b32 v103, 0xffff0000, v30
    v_lshlrev_b32 v104, 16, v54
    v_and_b32 v105, 0xffff0000, v54
    v_lshlrev_b32 v106, 16, v55
    v_and_b32 v107, 0xffff0000, v55
    v_add_f32 v100, v100, v104
    v_add_f32 v101, v101, v105
    v_add_f32 v102, v102, v106
    v_add_f32 v103, v103, v107
    v_cvt_pk_bf16_f32 v28, v100, v101
    v_cvt_pk_bf16_f32 v29, v102, v103
    ds_write_b64 v9, v[28:29] offset:96
    v_cvt_pk_bf16_f32 v32, v32, v33
    v_cvt_pk_bf16_f32 v34, v34, v35
    v_lshlrev_b32 v100, 16, v32
    v_and_b32 v101, 0xffff0000, v32
    v_lshlrev_b32 v102, 16, v34
    v_and_b32 v103, 0xffff0000, v34
    v_lshlrev_b32 v104, 16, v56
    v_and_b32 v105, 0xffff0000, v56
    v_lshlrev_b32 v106, 16, v57
    v_and_b32 v107, 0xffff0000, v57
    v_add_f32 v100, v100, v104
    v_add_f32 v101, v101, v105
    v_add_f32 v102, v102, v106
    v_add_f32 v103, v103, v107
    v_cvt_pk_bf16_f32 v32, v100, v101
    v_cvt_pk_bf16_f32 v33, v102, v103
    ds_write_b64 v9, v[32:33] offset:128
    v_cvt_pk_bf16_f32 v36, v36, v37
    v_cvt_pk_bf16_f32 v38, v38, v39
    v_lshlrev_b32 v100, 16, v36
    v_and_b32 v101, 0xffff0000, v36
    v_lshlrev_b32 v102, 16, v38
    v_and_b32 v103, 0xffff0000, v38
    v_lshlrev_b32 v104, 16, v58
    v_and_b32 v105, 0xffff0000, v58
    v_lshlrev_b32 v106, 16, v59
    v_and_b32 v107, 0xffff0000, v59
    v_add_f32 v100, v100, v104
    v_add_f32 v101, v101, v105
    v_add_f32 v102, v102, v106
    v_add_f32 v103, v103, v107
    v_cvt_pk_bf16_f32 v36, v100, v101
    v_cvt_pk_bf16_f32 v37, v102, v103
    ds_write_b64 v9, v[36:37] offset:160
    v_cvt_pk_bf16_f32 v40, v40, v41
    v_cvt_pk_bf16_f32 v42, v42, v43
    v_lshlrev_b32 v100, 16, v40
    v_and_b32 v101, 0xffff0000, v40
    v_lshlrev_b32 v102, 16, v42
    v_and_b32 v103, 0xffff0000, v42
    v_lshlrev_b32 v104, 16, v60
    v_and_b32 v105, 0xffff0000, v60
    v_lshlrev_b32 v106, 16, v61
    v_and_b32 v107, 0xffff0000, v61
    v_add_f32 v100, v100, v104
    v_add_f32 v101, v101, v105
    v_add_f32 v102, v102, v106
    v_add_f32 v103, v103, v107
    v_cvt_pk_bf16_f32 v40, v100, v101
    v_cvt_pk_bf16_f32 v41, v102, v103
    ds_write_b64 v9, v[40:41] offset:192
    v_cvt_pk_bf16_f32 v44, v44, v45
    v_cvt_pk_bf16_f32 v46, v46, v47
    v_lshlrev_b32 v100, 16, v44
    v_and_b32 v101, 0xffff0000, v44
    v_lshlrev_b32 v102, 16, v46
    v_and_b32 v103, 0xffff0000, v46
    v_lshlrev_b32 v104, 16, v62
    v_and_b32 v105, 0xffff0000, v62
    v_lshlrev_b32 v106, 16, v63
    v_and_b32 v107, 0xffff0000, v63
    v_add_f32 v100, v100, v104
    v_add_f32 v101, v101, v105
    v_add_f32 v102, v102, v106
    v_add_f32 v103, v103, v107
    v_cvt_pk_bf16_f32 v44, v100, v101
    v_cvt_pk_bf16_f32 v45, v102, v103
    ds_write_b64 v9, v[44:45] offset:224
    s_waitcnt lgkmcnt(0)
    s_barrier
    s_lshl_b32 s19, s16, 2
    v_add_u32 v5, s19, v2
    v_mul_u32_u24 v10, 1040, v5
    v_lshl_add_u32 v10, v3, 6, v10
    ds_read_b128 v[16:19], v10 offset:0
    ds_read_b128 v[20:23], v10 offset:16
    ds_read_b128 v[24:27], v10 offset:32
    ds_read_b128 v[28:31], v10 offset:48
    v_lshlrev_b32 v11, 10, v5
    v_lshl_add_u32 v11, v3, 6, v11
    s_lshl_b32 s3, s2, 14
    s_add_u32 s24, s3, 25165824
    s_add_u32 s25, s3, 27262976
    s_waitcnt lgkmcnt(0)
    buffer_store_dwordx4 v[16:19], v11, s[8:11], s24 offen offset:0
    buffer_store_dwordx4 v[20:23], v11, s[8:11], s24 offen offset:16
    buffer_store_dwordx4 v[24:27], v11, s[8:11], s24 offen offset:32
    buffer_store_dwordx4 v[28:31], v11, s[8:11], s24 offen offset:48
    s_nop 1
    v_lshlrev_b32 v64, 16, v16
    v_and_b32 v65, 0xffff0000, v16
    v_lshlrev_b32 v66, 16, v17
    v_and_b32 v67, 0xffff0000, v17
    v_lshlrev_b32 v68, 16, v18
    v_and_b32 v69, 0xffff0000, v18
    v_lshlrev_b32 v70, 16, v19
    v_and_b32 v71, 0xffff0000, v19
    v_lshlrev_b32 v72, 16, v20
    v_and_b32 v73, 0xffff0000, v20
    v_lshlrev_b32 v74, 16, v21
    v_and_b32 v75, 0xffff0000, v21
    v_lshlrev_b32 v76, 16, v22
    v_and_b32 v77, 0xffff0000, v22
    v_lshlrev_b32 v78, 16, v23
    v_and_b32 v79, 0xffff0000, v23
    v_lshlrev_b32 v80, 16, v24
    v_and_b32 v81, 0xffff0000, v24
    v_lshlrev_b32 v82, 16, v25
    v_and_b32 v83, 0xffff0000, v25
    v_lshlrev_b32 v84, 16, v26
    v_and_b32 v85, 0xffff0000, v26
    v_lshlrev_b32 v86, 16, v27
    v_and_b32 v87, 0xffff0000, v27
    v_lshlrev_b32 v88, 16, v28
    v_and_b32 v89, 0xffff0000, v28
    v_lshlrev_b32 v90, 16, v29
    v_and_b32 v91, 0xffff0000, v29
    v_lshlrev_b32 v92, 16, v30
    v_and_b32 v93, 0xffff0000, v30
    v_lshlrev_b32 v94, 16, v31
    v_and_b32 v95, 0xffff0000, v31
    v_add_f32 v96, v64, v65
    v_add_f32 v96, v96, v66
    v_add_f32 v96, v96, v67
    v_add_f32 v96, v96, v68
    v_add_f32 v96, v96, v69
    v_add_f32 v96, v96, v70
    v_add_f32 v96, v96, v71
    v_add_f32 v96, v96, v72
    v_add_f32 v96, v96, v73
    v_add_f32 v96, v96, v74
    v_add_f32 v96, v96, v75
    v_add_f32 v96, v96, v76
    v_add_f32 v96, v96, v77
    v_add_f32 v96, v96, v78
    v_add_f32 v96, v96, v79
    v_add_f32 v96, v96, v80
    v_add_f32 v96, v96, v81
    v_add_f32 v96, v96, v82
    v_add_f32 v96, v96, v83
    v_add_f32 v96, v96, v84
    v_add_f32 v96, v96, v85
    v_add_f32 v96, v96, v86
    v_add_f32 v96, v96, v87
    v_add_f32 v96, v96, v88
    v_add_f32 v96, v96, v89
    v_add_f32 v96, v96, v90
    v_add_f32 v96, v96, v91
    v_add_f32 v96, v96, v92
    v_add_f32 v96, v96, v93
    v_add_f32 v96, v96, v94
    v_add_f32 v96, v96, v95
    s_nop 1
    v_add_f32_dpp v96, v96, v96 row_ror:8 row_mask:0xf bank_mask:0xf
    s_nop 1
    v_add_f32_dpp v96, v96, v96 row_ror:4 row_mask:0xf bank_mask:0xf
    s_nop 1
    v_add_f32_dpp v96, v96, v96 row_ror:2 row_mask:0xf bank_mask:0xf
    s_nop 1
    v_add_f32_dpp v96, v96, v96 row_ror:1 row_mask:0xf bank_mask:0xf
    v_mul_f32 v97, 0x3b000000, v96
    v_mov_b32 v99, 0
    v_sub_f32 v98, v64, v97
    v_fmac_f32 v99, v98, v98
    v_sub_f32 v98, v65, v97
    v_fmac_f32 v99, v98, v98
    v_sub_f32 v98, v66, v97
    v_fmac_f32 v99, v98, v98
    v_sub_f32 v98, v67, v97
    v_fmac_f32 v99, v98, v98
    v_sub_f32 v98, v68, v97
    v_fmac_f32 v99, v98, v98
    v_sub_f32 v98, v69, v97
    v_fmac_f32 v99, v98, v98
    v_sub_f32 v98, v70, v97
    v_fmac_f32 v99, v98, v98
    v_sub_f32 v98, v71, v97
    v_fmac_f32 v99, v98, v98
    v_sub_f32 v98, v72, v97
    v_fmac_f32 v99, v98, v98
    v_sub_f32 v98, v73, v97
    v_fmac_f32 v99, v98, v98
    v_sub_f32 v98, v74, v97
    v_fmac_f32 v99, v98, v98
    v_sub_f32 v98, v75, v97
    v_fmac_f32 v99, v98, v98
    v_sub_f32 v98, v76, v97
    v_fmac_f32 v99, v98, v98
    v_sub_f32 v98, v77, v97
    v_fmac_f32 v99, v98, v98
    v_sub_f32 v98, v78, v97
    v_fmac_f32 v99, v98, v98
    v_sub_f32 v98, v79, v97
    v_fmac_f32 v99, v98, v98
    v_sub_f32 v98, v80, v97
    v_fmac_f32 v99, v98, v98
    v_sub_f32 v98, v81, v97
    v_fmac_f32 v99, v98, v98
    v_sub_f32 v98, v82, v97
    v_fmac_f32 v99, v98, v98
    v_sub_f32 v98, v83, v97
    v_fmac_f32 v99, v98, v98
    v_sub_f32 v98, v84, v97
    v_fmac_f32 v99, v98, v98
    v_sub_f32 v98, v85, v97
    v_fmac_f32 v99, v98, v98
    v_sub_f32 v98, v86, v97
    v_fmac_f32 v99, v98, v98
    v_sub_f32 v98, v87, v97
    v_fmac_f32 v99, v98, v98
    v_sub_f32 v98, v88, v97
    v_fmac_f32 v99, v98, v98
    v_sub_f32 v98, v89, v97
    v_fmac_f32 v99, v98, v98
    v_sub_f32 v98, v90, v97
    v_fmac_f32 v99, v98, v98
    v_sub_f32 v98, v91, v97
    v_fmac_f32 v99, v98, v98
    v_sub_f32 v98, v92, v97
    v_fmac_f32 v99, v98, v98
    v_sub_f32 v98, v93, v97
    v_fmac_f32 v99, v98, v98
    v_sub_f32 v98, v94, v97
    v_fmac_f32 v99, v98, v98
    v_sub_f32 v98, v95, v97
    v_fmac_f32 v99, v98, v98
    s_nop 1
    v_add_f32_dpp v99, v99, v99 row_ror:8 row_mask:0xf bank_mask:0xf
    s_nop 1
    v_add_f32_dpp v99, v99, v99 row_ror:4 row_mask:0xf bank_mask:0xf
    s_nop 1
    v_add_f32_dpp v99, v99, v99 row_ror:2 row_mask:0xf bank_mask:0xf
    s_nop 1
    v_add_f32_dpp v99, v99, v99 row_ror:1 row_mask:0xf bank_mask:0xf
    v_mul_f32 v99, 0x3b000000, v99
    v_cvt_pk_bf16_f32 v100, v97, v99
    v_lshlrev_b32 v97, 16, v100
    v_and_b32 v99, 0xffff0000, v100
    v_add_f32 v99, 0x3727c5ac, v99
    v_cvt_pk_bf16_f32 v100, v99, v99
    v_lshlrev_b32 v99, 16, v100
    v_sqrt_f32 v99, v99
    s_nop 0
    v_cvt_pk_bf16_f32 v100, v99, v99
    v_lshlrev_b32 v99, 16, v100
    v_rcp_f32 v99, v99
    s_nop 0
    v_sub_f32 v100, v64, v97
    v_sub_f32 v101, v65, v97
    v_cvt_pk_bf16_f32 v102, v100, v101
    v_lshlrev_b32 v100, 16, v102
    v_and_b32 v101, 0xffff0000, v102
    v_mul_f32 v100, v99, v100
    v_mul_f32 v101, v99, v101
    v_cvt_pk_bf16_f32 v16, v100, v101
    v_sub_f32 v100, v66, v97
    v_sub_f32 v101, v67, v97
    v_cvt_pk_bf16_f32 v102, v100, v101
    v_lshlrev_b32 v100, 16, v102
    v_and_b32 v101, 0xffff0000, v102
    v_mul_f32 v100, v99, v100
    v_mul_f32 v101, v99, v101
    v_cvt_pk_bf16_f32 v17, v100, v101
    v_sub_f32 v100, v68, v97
    v_sub_f32 v101, v69, v97
    v_cvt_pk_bf16_f32 v102, v100, v101
    v_lshlrev_b32 v100, 16, v102
    v_and_b32 v101, 0xffff0000, v102
    v_mul_f32 v100, v99, v100
    v_mul_f32 v101, v99, v101
    v_cvt_pk_bf16_f32 v18, v100, v101
    v_sub_f32 v100, v70, v97
    v_sub_f32 v101, v71, v97
    v_cvt_pk_bf16_f32 v102, v100, v101
    v_lshlrev_b32 v100, 16, v102
    v_and_b32 v101, 0xffff0000, v102
    v_mul_f32 v100, v99, v100
    v_mul_f32 v101, v99, v101
    v_cvt_pk_bf16_f32 v19, v100, v101
    v_sub_f32 v100, v72, v97
    v_sub_f32 v101, v73, v97
    v_cvt_pk_bf16_f32 v102, v100, v101
    v_lshlrev_b32 v100, 16, v102
    v_and_b32 v101, 0xffff0000, v102
    v_mul_f32 v100, v99, v100
    v_mul_f32 v101, v99, v101
    v_cvt_pk_bf16_f32 v20, v100, v101
    v_sub_f32 v100, v74, v97
    v_sub_f32 v101, v75, v97
    v_cvt_pk_bf16_f32 v102, v100, v101
    v_lshlrev_b32 v100, 16, v102
    v_and_b32 v101, 0xffff0000, v102
    v_mul_f32 v100, v99, v100
    v_mul_f32 v101, v99, v101
    v_cvt_pk_bf16_f32 v21, v100, v101
    v_sub_f32 v100, v76, v97
    v_sub_f32 v101, v77, v97
    v_cvt_pk_bf16_f32 v102, v100, v101
    v_lshlrev_b32 v100, 16, v102
    v_and_b32 v101, 0xffff0000, v102
    v_mul_f32 v100, v99, v100
    v_mul_f32 v101, v99, v101
    v_cvt_pk_bf16_f32 v22, v100, v101
    v_sub_f32 v100, v78, v97
    v_sub_f32 v101, v79, v97
    v_cvt_pk_bf16_f32 v102, v100, v101
    v_lshlrev_b32 v100, 16, v102
    v_and_b32 v101, 0xffff0000, v102
    v_mul_f32 v100, v99, v100
    v_mul_f32 v101, v99, v101
    v_cvt_pk_bf16_f32 v23, v100, v101
    v_sub_f32 v100, v80, v97
    v_sub_f32 v101, v81, v97
    v_cvt_pk_bf16_f32 v102, v100, v101
    v_lshlrev_b32 v100, 16, v102
    v_and_b32 v101, 0xffff0000, v102
    v_mul_f32 v100, v99, v100
    v_mul_f32 v101, v99, v101
    v_cvt_pk_bf16_f32 v24, v100, v101
    v_sub_f32 v100, v82, v97
    v_sub_f32 v101, v83, v97
    v_cvt_pk_bf16_f32 v102, v100, v101
    v_lshlrev_b32 v100, 16, v102
    v_and_b32 v101, 0xffff0000, v102
    v_mul_f32 v100, v99, v100
    v_mul_f32 v101, v99, v101
    v_cvt_pk_bf16_f32 v25, v100, v101
    v_sub_f32 v100, v84, v97
    v_sub_f32 v101, v85, v97
    v_cvt_pk_bf16_f32 v102, v100, v101
    v_lshlrev_b32 v100, 16, v102
    v_and_b32 v101, 0xffff0000, v102
    v_mul_f32 v100, v99, v100
    v_mul_f32 v101, v99, v101
    v_cvt_pk_bf16_f32 v26, v100, v101
    v_sub_f32 v100, v86, v97
    v_sub_f32 v101, v87, v97
    v_cvt_pk_bf16_f32 v102, v100, v101
    v_lshlrev_b32 v100, 16, v102
    v_and_b32 v101, 0xffff0000, v102
    v_mul_f32 v100, v99, v100
    v_mul_f32 v101, v99, v101
    v_cvt_pk_bf16_f32 v27, v100, v101
    v_sub_f32 v100, v88, v97
    v_sub_f32 v101, v89, v97
    v_cvt_pk_bf16_f32 v102, v100, v101
    v_lshlrev_b32 v100, 16, v102
    v_and_b32 v101, 0xffff0000, v102
    v_mul_f32 v100, v99, v100
    v_mul_f32 v101, v99, v101
    v_cvt_pk_bf16_f32 v28, v100, v101
    v_sub_f32 v100, v90, v97
    v_sub_f32 v101, v91, v97
    v_cvt_pk_bf16_f32 v102, v100, v101
    v_lshlrev_b32 v100, 16, v102
    v_and_b32 v101, 0xffff0000, v102
    v_mul_f32 v100, v99, v100
    v_mul_f32 v101, v99, v101
    v_cvt_pk_bf16_f32 v29, v100, v101
    v_sub_f32 v100, v92, v97
    v_sub_f32 v101, v93, v97
    v_cvt_pk_bf16_f32 v102, v100, v101
    v_lshlrev_b32 v100, 16, v102
    v_and_b32 v101, 0xffff0000, v102
    v_mul_f32 v100, v99, v100
    v_mul_f32 v101, v99, v101
    v_cvt_pk_bf16_f32 v30, v100, v101
    v_sub_f32 v100, v94, v97
    v_sub_f32 v101, v95, v97
    v_cvt_pk_bf16_f32 v102, v100, v101
    v_lshlrev_b32 v100, 16, v102
    v_and_b32 v101, 0xffff0000, v102
    v_mul_f32 v100, v99, v100
    v_mul_f32 v101, v99, v101
    v_cvt_pk_bf16_f32 v31, v100, v101
    buffer_store_dwordx4 v[16:19], v11, s[8:11], s25 offen offset:0
    buffer_store_dwordx4 v[20:23], v11, s[8:11], s25 offen offset:16
    buffer_store_dwordx4 v[24:27], v11, s[8:11], s25 offen offset:32
    buffer_store_dwordx4 v[28:31], v11, s[8:11], s25 offen offset:48
L_ka3_end_16:
    s_endpgm
.section .rodata,"a"
.p2align 6
.amdhsa_kernel ka3_1_kernel
  .amdhsa_next_free_vgpr 120
  .amdhsa_next_free_sgpr 102
  .amdhsa_accum_offset 120
  .amdhsa_group_segment_fixed_size 0
  .amdhsa_kernarg_size 120
  .amdhsa_user_sgpr_count 2
  .amdhsa_user_sgpr_kernarg_segment_ptr 1
  .amdhsa_system_sgpr_workgroup_id_x 1
.end_amdhsa_kernel
.text

.p2align 8
.globl kb3_0_kernel
.type kb3_0_kernel,@function
kb3_0_kernel:
    s_cmp_ge_u32 s2, 512
    s_cbranch_scc1 L_kb3_end_17
    s_load_dwordx2 s[4:5], s[0:1], 112
    v_and_b32 v1, 63, v0
    v_lshrrev_b32 v2, 6, v0
    s_nop 0
    v_readfirstlane_b32 s16, v2
    v_lshrrev_b32 v2, 4, v1
    v_and_b32 v3, 15, v1
    s_lshl_b32 s3, s2, 2
    s_add_u32 s3, s3, s16
    s_waitcnt lgkmcnt(0)
    s_mov_b32 s8, s4
    s_and_b32 s9, s5, 0xffff
    s_mov_b32 s10, 268435456
    s_mov_b32 s11, 0x00020000
    v_lshlrev_b32 v7, 4, v1
    s_lshl_b32 s6, s3, 13
    s_lshl_b32 s7, s3, 12
    s_add_u32 s19, s6, 83886080
    s_add_u32 s22, s19, 4096
    buffer_load_dwordx4 v[16:19], v7, s[8:11], s19 offen offset:0
    buffer_load_dwordx4 v[20:23], v7, s[8:11], s19 offen offset:1024
    buffer_load_dwordx4 v[24:27], v7, s[8:11], s19 offen offset:2048
    buffer_load_dwordx4 v[28:31], v7, s[8:11], s19 offen offset:3072
    buffer_load_dwordx4 v[32:35], v7, s[8:11], s22 offen offset:0
    buffer_load_dwordx4 v[36:39], v7, s[8:11], s22 offen offset:1024
    buffer_load_dwordx4 v[40:43], v7, s[8:11], s22 offen offset:2048
    buffer_load_dwordx4 v[44:47], v7, s[8:11], s22 offen offset:3072
    s_add_u32 s19, s6, 50331648
    s_add_u32 s22, s19, 4096
    buffer_load_dwordx4 v[48:51], v7, s[8:11], s19 offen offset:0
    buffer_load_dwordx4 v[52:55], v7, s[8:11], s19 offen offset:1024
    buffer_load_dwordx4 v[56:59], v7, s[8:11], s19 offen offset:2048
    buffer_load_dwordx4 v[60:63], v7, s[8:11], s19 offen offset:3072
    buffer_load_dwordx4 v[64:67], v7, s[8:11], s22 offen offset:0
    buffer_load_dwordx4 v[68:71], v7, s[8:11], s22 offen offset:1024
    buffer_load_dwordx4 v[72:75], v7, s[8:11], s22 offen offset:2048
    buffer_load_dwordx4 v[76:79], v7, s[8:11], s22 offen offset:3072
    s_add_u32 s19, s7, 100663296
    buffer_load_dwordx4 v[80:83], v7, s[8:11], s19 offen offset:0
    buffer_load_dwordx4 v[84:87], v7, s[8:11], s19 offen offset:1024
    buffer_load_dwordx4 v[88:91], v7, s[8:11], s19 offen offset:2048
    buffer_load_dwordx4 v[92:95], v7, s[8:11], s19 offen offset:3072
    s_add_u32 s19, s6, 67108864
    s_add_u32 s22, s19, 4096
    buffer_load_dwordx4 v[96:99], v7, s[8:11], s19 offen offset:0
    buffer_load_dwordx4 v[100:103], v7, s[8:11], s19 offen offset:1024
    buffer_load_dwordx4 v[104:107], v7, s[8:11], s19 offen offset:2048
    buffer_load_dwordx4 v[108:111], v7, s[8:11], s19 offen offset:3072
    buffer_load_dwordx4 v[112:115], v7, s[8:11], s22 offen offset:0
    buffer_load_dwordx4 v[116:119], v7, s[8:11], s22 offen offset:1024
    buffer_load_dwordx4 v[120:123], v7, s[8:11], s22 offen offset:2048
    buffer_load_dwordx4 v[124:127], v7, s[8:11], s22 offen offset:3072
    s_add_u32 s19, s6, 109051904
    s_add_u32 s22, s19, 4096
    buffer_load_dwordx4 v[128:131], v7, s[8:11], s19 offen offset:0
    buffer_load_dwordx4 v[132:135], v7, s[8:11], s19 offen offset:1024
    buffer_load_dwordx4 v[136:139], v7, s[8:11], s19 offen offset:2048
    buffer_load_dwordx4 v[140:143], v7, s[8:11], s19 offen offset:3072
    buffer_load_dwordx4 v[144:147], v7, s[8:11], s22 offen offset:0
    buffer_load_dwordx4 v[148:151], v7, s[8:11], s22 offen offset:1024
    buffer_load_dwordx4 v[152:155], v7, s[8:11], s22 offen offset:2048
    buffer_load_dwordx4 v[156:159], v7, s[8:11], s22 offen offset:3072
    v_mov_b32 v10, 0xf149f2ca
    v_cmp_le_u32 vcc, 2, v2
    s_nop 1
    v_cndmask_b32 v160, 0, v10, vcc
    v_mov_b32 v161, v160
    v_mov_b32 v162, v160
    v_mov_b32 v163, v160
    v_lshlrev_b32 v11, 2, v2
    v_add_u32 v12, 0, v11
    v_cmp_gt_u32 vcc, v12, v3
    s_nop 1
    v_cndmask_b32 v164, 0, v10, vcc
    v_add_u32 v12, 1, v11
    v_cmp_gt_u32 vcc, v12, v3
    s_nop 1
    v_cndmask_b32 v165, 0, v10, vcc
    v_add_u32 v12, 2, v11
    v_cmp_gt_u32 vcc, v12, v3
    s_nop 1
    v_cndmask_b32 v166, 0, v10, vcc
    v_add_u32 v12, 3, v11
    v_cmp_gt_u32 vcc, v12, v3
    s_nop 1
    v_cndmask_b32 v167, 0, v10, vcc
    s_mov_b32 s21, 0x3e0293ee
    s_waitcnt vmcnt(0)
    v_mfma_f32_16x16x32_bf16 v[168:171], v[80:83], v[16:19], v[160:163]
    v_mfma_f32_16x16x32_bf16 v[172:175], v[48:51], v[16:19], v[164:167]
    v_mfma_f32_16x16x32_bf16 v[168:171], v[84:87], v[24:27], v[168:171]
    v_mfma_f32_16x16x32_bf16 v[172:175], v[56:59], v[24:27], v[172:175]
    v_mfma_f32_16x16x32_bf16 v[168:171], v[88:91], v[32:35], v[168:171]
    v_mfma_f32_16x16x32_bf16 v[172:175], v[64:67], v[32:35], v[172:175]
    v_mfma_f32_16x16x32_bf16 v[168:171], v[92:95], v[40:43], v[168:171]
    v_mfma_f32_16x16x32_bf16 v[172:175], v[72:75], v[40:43], v[172:175]
    v_mfma_f32_16x16x32_bf16 v[180:183], v[80:83], v[20:23], v[160:163]
    v_mfma_f32_16x16x32_bf16 v[184:187], v[48:51], v[20:23], 0
    v_mfma_f32_16x16x32_bf16 v[188:191], v[52:55], v[20:23], v[164:167]
    v_mfma_f32_16x16x32_bf16 v[180:183], v[84:87], v[28:31], v[180:183]
    v_mfma_f32_16x16x32_bf16 v[184:187], v[56:59], v[28:31], v[184:187]
    v_mfma_f32_16x16x32_bf16 v[188:191], v[60:63], v[28:31], v[188:191]
    v_mfma_f32_16x16x32_bf16 v[180:183], v[88:91], v[36:39], v[180:183]
    v_mfma_f32_16x16x32_bf16 v[184:187], v[64:67], v[36:39], v[184:187]
    v_mfma_f32_16x16x32_bf16 v[188:191], v[68:71], v[36:39], v[188:191]
    v_mfma_f32_16x16x32_bf16 v[180:183], v[92:95], v[44:47], v[180:183]
    v_mfma_f32_16x16x32_bf16 v[184:187], v[72:75], v[44:47], v[184:187]
    v_mfma_f32_16x16x32_bf16 v[188:191], v[76:79], v[44:47], v[188:191]
    s_nop 7
    v_max3_f32 v4, v168, v169, v170
    v_max3_f32 v4, v4, v171, v172
    v_max3_f32 v4, v4, v173, v174
    v_max_f32 v4, v4, v175
    v_mov_b32 v5, v4
    s_nop 1
    v_permlane16_swap_b32 v4, v5
    s_nop 0
    v_max_f32 v4, v4, v5
    v_mov_b32 v5, v4
    s_nop 1
    v_permlane32_swap_b32 v4, v5
    s_nop 0
    v_max_f32 v4, v4, v5
    v_mul_f32 v4, s21, v4
    v_fma_f32 v168, v168, s21, -v4
    v_fma_f32 v169, v169, s21, -v4
    v_fma_f32 v170, v170, s21, -v4
    v_fma_f32 v171, v171, s21, -v4
    v_fma_f32 v172, v172, s21, -v4
    v_fma_f32 v173, v173, s21, -v4
    v_fma_f32 v174, v174, s21, -v4
    v_fma_f32 v175, v175, s21, -v4
    v_exp_f32 v168, v168
    v_exp_f32 v169, v169
    v_exp_f32 v170, v170
    v_exp_f32 v171, v171
    v_exp_f32 v172, v172
    v_exp_f32 v173, v173
    v_exp_f32 v174, v174
    v_exp_f32 v175, v175
    s_nop 0
    v_add_f32 v5, v168, v169
    v_add_f32 v5, v5, v170
    v_add_f32 v5, v5, v171
    v_add_f32 v5, v5, v172
    v_add_f32 v5, v5, v173
    v_add_f32 v5, v5, v174
    v_add_f32 v5, v5, v175
    v_mov_b32 v6, v5
    s_nop 1
    v_permlane16_swap_b32 v5, v6
    s_nop 0
    v_add_f32 v5, v5, v6
    v_mov_b32 v6, v5
    s_nop 1
    v_permlane32_swap_b32 v5, v6
    s_nop 0
    v_add_f32 v5, v5, v6
    v_rcp_f32 v5, v5
    s_nop 0
    v_mul_f32 v168, v5, v168
    v_mul_f32 v169, v5, v169
    v_mul_f32 v170, v5, v170
    v_mul_f32 v171, v5, v171
    v_mul_f32 v172, v5, v172
    v_mul_f32 v173, v5, v173
    v_mul_f32 v174, v5, v174
    v_mul_f32 v175, v5, v175
    v_cvt_pk_bf16_f32 v192, v168, v169
    v_cvt_pk_bf16_f32 v193, v170, v171
    v_mov_b32 v194, 0
    v_mov_b32 v195, 0
    v_cvt_pk_bf16_f32 v196, v172, v173
    v_cvt_pk_bf16_f32 v197, v174, v175
    v_mov_b32 v198, 0
    v_mov_b32 v199, 0
    v_max3_f32 v4, v180, v181, v182
    v_max3_f32 v4, v4, v183, v184
    v_max3_f32 v4, v4, v185, v186
    v_max3_f32 v4, v4, v187, v188
    v_max3_f32 v4, v4, v189, v190
    v_max_f32 v4, v4, v191
    v_mov_b32 v5, v4
    s_nop 1
    v_permlane16_swap_b32 v4, v5
    s_nop 0
    v_max_f32 v4, v4, v5
    v_mov_b32 v5, v4
    s_nop 1
    v_permlane32_swap_b32 v4, v5
    s_nop 0
    v_max_f32 v4, v4, v5
    v_mul_f32 v4, s21, v4
    v_fma_f32 v180, v180, s21, -v4
    v_fma_f32 v181, v181, s21, -v4
    v_fma_f32 v182, v182, s21, -v4
    v_fma_f32 v183, v183, s21, -v4
    v_fma_f32 v184, v184, s21, -v4
    v_fma_f32 v185, v185, s21, -v4
    v_fma_f32 v186, v186, s21, -v4
    v_fma_f32 v187, v187, s21, -v4
    v_fma_f32 v188, v188, s21, -v4
    v_fma_f32 v189, v189, s21, -v4
    v_fma_f32 v190, v190, s21, -v4
    v_fma_f32 v191, v191, s21, -v4
    v_exp_f32 v180, v180
    v_exp_f32 v181, v181
    v_exp_f32 v182, v182
    v_exp_f32 v183, v183
    v_exp_f32 v184, v184
    v_exp_f32 v185, v185
    v_exp_f32 v186, v186
    v_exp_f32 v187, v187
    v_exp_f32 v188, v188
    v_exp_f32 v189, v189
    v_exp_f32 v190, v190
    v_exp_f32 v191, v191
    s_nop 0
    v_add_f32 v5, v180, v181
    v_add_f32 v5, v5, v182
    v_add_f32 v5, v5, v183
    v_add_f32 v5, v5, v184
    v_add_f32 v5, v5, v185
    v_add_f32 v5, v5, v186
    v_add_f32 v5, v5, v187
    v_add_f32 v5, v5, v188
    v_add_f32 v5, v5, v189
    v_add_f32 v5, v5, v190
    v_add_f32 v5, v5, v191
    v_mov_b32 v6, v5
    s_nop 1
    v_permlane16_swap_b32 v5, v6
    s_nop 0
    v_add_f32 v5, v5, v6
    v_mov_b32 v6, v5
    s_nop 1
    v_permlane32_swap_b32 v5, v6
    s_nop 0
    v_add_f32 v5, v5, v6
    v_rcp_f32 v5, v5
    s_nop 0
    v_mul_f32 v180, v5, v180
    v_mul_f32 v181, v5, v181
    v_mul_f32 v182, v5, v182
    v_mul_f32 v183, v5, v183
    v_mul_f32 v184, v5, v184
    v_mul_f32 v185, v5, v185
    v_mul_f32 v186, v5, v186
    v_mul_f32 v187, v5, v187
    v_mul_f32 v188, v5, v188
    v_mul_f32 v189, v5, v189
    v_mul_f32 v190, v5, v190
    v_mul_f32 v191, v5, v191
    v_cvt_pk_bf16_f32 v200, v180, v181
    v_cvt_pk_bf16_f32 v201, v182, v183
    v_mov_b32 v202, 0
    v_mov_b32 v203, 0
    v_cvt_pk_bf16_f32 v204, v184, v185
    v_cvt_pk_bf16_f32 v205, v186, v187
    v_cvt_pk_bf16_f32 v206, v188, v189
    v_cvt_pk_bf16_f32 v207, v190, v191
    s_nop 1
    v_mfma_f32_16x16x32_bf16 v[16:19], v[96:99], v[196:199], 0
    v_mfma_f32_16x16x32_bf16 v[16:19], v[128:131], v[192:195], v[16:19]
    v_mfma_f32_16x16x32_bf16 v[20:23], v[96:99], v[204:207], 0
    v_mfma_f32_16x16x32_bf16 v[20:23], v[128:131], v[200:203], v[20:23]
    v_mfma_f32_16x16x32_bf16 v[24:27], v[100:103], v[196:199], 0
    v_mfma_f32_16x16x32_bf16 v[24:27], v[132:135], v[192:195], v[24:27]
    v_mfma_f32_16x16x32_bf16 v[28:31], v[100:103], v[204:207], 0
    v_mfma_f32_16x16x32_bf16 v[28:31], v[132:135], v[200:203], v[28:31]
    v_mfma_f32_16x16x32_bf16 v[32:35], v[104:107], v[196:199], 0
    v_mfma_f32_16x16x32_bf16 v[32:35], v[136:139], v[192:195], v[32:35]
    v_mfma_f32_16x16x32_bf16 v[36:39], v[104:107], v[204:207], 0
    v_mfma_f32_16x16x32_bf16 v[36:39], v[136:139], v[200:203], v[36:39]
    v_mfma_f32_16x16x32_bf16 v[40:43], v[108:111], v[196:199], 0
    v_mfma_f32_16x16x32_bf16 v[40:43], v[140:143], v[192:195], v[40:43]
    v_mfma_f32_16x16x32_bf16 v[44:47], v[108:111], v[204:207], 0
    v_mfma_f32_16x16x32_bf16 v[44:47], v[140:143], v[200:203], v[44:47]
    v_mfma_f32_16x16x32_bf16 v[48:51], v[112:115], v[196:199], 0
    v_mfma_f32_16x16x32_bf16 v[48:51], v[144:147], v[192:195], v[48:51]
    v_mfma_f32_16x16x32_bf16 v[52:55], v[112:115], v[204:207], 0
    v_mfma_f32_16x16x32_bf16 v[52:55], v[144:147], v[200:203], v[52:55]
    v_mfma_f32_16x16x32_bf16 v[56:59], v[116:119], v[196:199], 0
    v_mfma_f32_16x16x32_bf16 v[56:59], v[148:151], v[192:195], v[56:59]
    v_mfma_f32_16x16x32_bf16 v[60:63], v[116:119], v[204:207], 0
    v_mfma_f32_16x16x32_bf16 v[60:63], v[148:151], v[200:203], v[60:63]
    v_mfma_f32_16x16x32_bf16 v[64:67], v[120:123], v[196:199], 0
    v_mfma_f32_16x16x32_bf16 v[64:67], v[152:155], v[192:195], v[64:67]
    v_mfma_f32_16x16x32_bf16 v[68:71], v[120:123], v[204:207], 0
    v_mfma_f32_16x16x32_bf16 v[68:71], v[152:155], v[200:203], v[68:71]
    v_mfma_f32_16x16x32_bf16 v[72:75], v[124:127], v[196:199], 0
    v_mfma_f32_16x16x32_bf16 v[72:75], v[156:159], v[192:195], v[72:75]
    v_mfma_f32_16x16x32_bf16 v[76:79], v[124:127], v[204:207], 0
    v_mfma_f32_16x16x32_bf16 v[76:79], v[156:159], v[200:203], v[76:79]
    s_nop 7
    s_add_u32 s19, s6, 125829120
    s_add_u32 s22, s19, 4096
    v_cvt_pk_bf16_f32 v208, v16, v17
    v_cvt_pk_bf16_f32 v209, v18, v19
    v_cvt_pk_bf16_f32 v210, v24, v25
    v_cvt_pk_bf16_f32 v211, v26, v27
    buffer_store_dwordx4 v[208:211], v7, s[8:11], s19 offen offset:0
    s_nop 1
    v_cvt_pk_bf16_f32 v212, v20, v21
    v_cvt_pk_bf16_f32 v213, v22, v23
    v_cvt_pk_bf16_f32 v214, v28, v29
    v_cvt_pk_bf16_f32 v215, v30, v31
    buffer_store_dwordx4 v[212:215], v7, s[8:11], s19 offen offset:1024
    s_nop 1
    v_cvt_pk_bf16_f32 v208, v32, v33
    v_cvt_pk_bf16_f32 v209, v34, v35
    v_cvt_pk_bf16_f32 v210, v40, v41
    v_cvt_pk_bf16_f32 v211, v42, v43
    buffer_store_dwordx4 v[208:211], v7, s[8:11], s19 offen offset:2048
    s_nop 1
    v_cvt_pk_bf16_f32 v212, v36, v37
    v_cvt_pk_bf16_f32 v213, v38, v39
    v_cvt_pk_bf16_f32 v214, v44, v45
    v_cvt_pk_bf16_f32 v215, v46, v47
    buffer_store_dwordx4 v[212:215], v7, s[8:11], s19 offen offset:3072
    s_nop 1
    v_cvt_pk_bf16_f32 v208, v48, v49
    v_cvt_pk_bf16_f32 v209, v50, v51
    v_cvt_pk_bf16_f32 v210, v56, v57
    v_cvt_pk_bf16_f32 v211, v58, v59
    buffer_store_dwordx4 v[208:211], v7, s[8:11], s22 offen offset:0
    s_nop 1
    v_cvt_pk_bf16_f32 v212, v52, v53
    v_cvt_pk_bf16_f32 v213, v54, v55
    v_cvt_pk_bf16_f32 v214, v60, v61
    v_cvt_pk_bf16_f32 v215, v62, v63
    buffer_store_dwordx4 v[212:215], v7, s[8:11], s22 offen offset:1024
    s_nop 1
    v_cvt_pk_bf16_f32 v208, v64, v65
    v_cvt_pk_bf16_f32 v209, v66, v67
    v_cvt_pk_bf16_f32 v210, v72, v73
    v_cvt_pk_bf16_f32 v211, v74, v75
    buffer_store_dwordx4 v[208:211], v7, s[8:11], s22 offen offset:2048
    s_nop 1
    v_cvt_pk_bf16_f32 v212, v68, v69
    v_cvt_pk_bf16_f32 v213, v70, v71
    v_cvt_pk_bf16_f32 v214, v76, v77
    v_cvt_pk_bf16_f32 v215, v78, v79
    buffer_store_dwordx4 v[212:215], v7, s[8:11], s22 offen offset:3072
    s_nop 1
L_kb3_end_17:
    s_endpgm
.section .rodata,"a"
.p2align 6
.amdhsa_kernel kb3_0_kernel
  .amdhsa_next_free_vgpr 216
  .amdhsa_next_free_sgpr 102
  .amdhsa_accum_offset 216
  .amdhsa_group_segment_fixed_size 0
  .amdhsa_kernarg_size 120
  .amdhsa_user_sgpr_count 2
  .amdhsa_user_sgpr_kernarg_segment_ptr 1
  .amdhsa_system_sgpr_workgroup_id_x 1
.end_amdhsa_kernel
.text

.p2align 8
.globl kb3_1_kernel
.type kb3_1_kernel,@function
kb3_1_kernel:
    s_cmp_ge_u32 s2, 512
    s_cbranch_scc1 L_kb3_end_18
    s_load_dwordx2 s[4:5], s[0:1], 112
    v_and_b32 v1, 63, v0
    v_lshrrev_b32 v2, 6, v0
    s_nop 0
    v_readfirstlane_b32 s16, v2
    v_lshrrev_b32 v2, 4, v1
    v_and_b32 v3, 15, v1
    s_lshl_b32 s3, s2, 2
    s_add_u32 s3, s3, s16
    s_waitcnt lgkmcnt(0)
    s_mov_b32 s8, s4
    s_and_b32 s9, s5, 0xffff
    s_mov_b32 s10, 268435456
    s_mov_b32 s11, 0x00020000
    v_lshlrev_b32 v7, 4, v1
    s_lshl_b32 s6, s3, 13
    s_lshl_b32 s7, s3, 12
    s_add_u32 s19, s6, 176160768
    s_add_u32 s22, s19, 4096
    buffer_load_dwordx4 v[16:19], v7, s[8:11], s19 offen offset:0
    buffer_load_dwordx4 v[20:23], v7, s[8:11], s19 offen offset:1024
    buffer_load_dwordx4 v[24:27], v7, s[8:11], s19 offen offset:2048
    buffer_load_dwordx4 v[28:31], v7, s[8:11], s19 offen offset:3072
    buffer_load_dwordx4 v[32:35], v7, s[8:11], s22 offen offset:0
    buffer_load_dwordx4 v[36:39], v7, s[8:11], s22 offen offset:1024
    buffer_load_dwordx4 v[40:43], v7, s[8:11], s22 offen offset:2048
    buffer_load_dwordx4 v[44:47], v7, s[8:11], s22 offen offset:3072
    s_add_u32 s19, s6, 142606336
    s_add_u32 s22, s19, 4096
    buffer_load_dwordx4 v[48:51], v7, s[8:11], s19 offen offset:0
    buffer_load_dwordx4 v[52:55], v7, s[8:11], s19 offen offset:1024
    buffer_load_dwordx4 v[56:59], v7, s[8:11], s19 offen offset:2048
    buffer_load_dwordx4 v[60:63], v7, s[8:11], s19 offen offset:3072
    buffer_load_dwordx4 v[64:67], v7, s[8:11], s22 offen offset:0
    buffer_load_dwordx4 v[68:71], v7, s[8:11], s22 offen offset:1024
    buffer_load_dwordx4 v[72:75], v7, s[8:11], s22 offen offset:2048
    buffer_load_dwordx4 v[76:79], v7, s[8:11], s22 offen offset:3072
    s_add_u32 s19, s7, 192937984
    buffer_load_dwordx4 v[80:83], v7, s[8:11], s19 offen offset:0
    buffer_load_dwordx4 v[84:87], v7, s[8:11], s19 offen offset:1024
    buffer_load_dwordx4 v[88:91], v7, s[8:11], s19 offen offset:2048
    buffer_load_dwordx4 v[92:95], v7, s[8:11], s19 offen offset:3072
    s_add_u32 s19, s6, 159383552
    s_add_u32 s22, s19, 4096
    buffer_load_dwordx4 v[96:99], v7, s[8:11], s19 offen offset:0
    buffer_load_dwordx4 v[100:103], v7, s[8:11], s19 offen offset:1024
    buffer_load_dwordx4 v[104:107], v7, s[8:11], s19 offen offset:2048
    buffer_load_dwordx4 v[108:111], v7, s[8:11], s19 offen offset:3072
    buffer_load_dwordx4 v[112:115], v7, s[8:11], s22 offen offset:0
    buffer_load_dwordx4 v[116:119], v7, s[8:11], s22 offen offset:1024
    buffer_load_dwordx4 v[120:123], v7, s[8:11], s22 offen offset:2048
    buffer_load_dwordx4 v[124:127], v7, s[8:11], s22 offen offset:3072
    s_add_u32 s19, s6, 201326592
    s_add_u32 s22, s19, 4096
    buffer_load_dwordx4 v[128:131], v7, s[8:11], s19 offen offset:0
    buffer_load_dwordx4 v[132:135], v7, s[8:11], s19 offen offset:1024
    buffer_load_dwordx4 v[136:139], v7, s[8:11], s19 offen offset:2048
    buffer_load_dwordx4 v[140:143], v7, s[8:11], s19 offen offset:3072
    buffer_load_dwordx4 v[144:147], v7, s[8:11], s22 offen offset:0
    buffer_load_dwordx4 v[148:151], v7, s[8:11], s22 offen offset:1024
    buffer_load_dwordx4 v[152:155], v7, s[8:11], s22 offen offset:2048
    buffer_load_dwordx4 v[156:159], v7, s[8:11], s22 offen offset:3072
    v_mov_b32 v10, 0xf149f2ca
    v_cmp_le_u32 vcc, 2, v2
    s_nop 1
    v_cndmask_b32 v160, 0, v10, vcc
    v_mov_b32 v161, v160
    v_mov_b32 v162, v160
    v_mov_b32 v163, v160
    v_lshlrev_b32 v11, 2, v2
    v_add_u32 v12, 0, v11
    v_cmp_gt_u32 vcc, v12, v3
    s_nop 1
    v_cndmask_b32 v164, 0, v10, vcc
    v_add_u32 v12, 1, v11
    v_cmp_gt_u32 vcc, v12, v3
    s_nop 1
    v_cndmask_b32 v165, 0, v10, vcc
    v_add_u32 v12, 2, v11
    v_cmp_gt_u32 vcc, v12, v3
    s_nop 1
    v_cndmask_b32 v166, 0, v10, vcc
    v_add_u32 v12, 3, v11
    v_cmp_gt_u32 vcc, v12, v3
    s_nop 1
    v_cndmask_b32 v167, 0, v10, vcc
    s_mov_b32 s21, 0x3e0293ee
    s_waitcnt vmcnt(0)
    v_mfma_f32_16x16x32_bf16 v[168:171], v[80:83], v[16:19], v[160:163]
    v_mfma_f32_16x16x32_bf16 v[172:175], v[48:51], v[16:19], v[164:167]
    v_mfma_f32_16x16x32_bf16 v[168:171], v[84:87], v[24:27], v[168:171]
    v_mfma_f32_16x16x32_bf16 v[172:175], v[56:59], v[24:27], v[172:175]
    v_mfma_f32_16x16x32_bf16 v[168:171], v[88:91], v[32:35], v[168:171]
    v_mfma_f32_16x16x32_bf16 v[172:175], v[64:67], v[32:35], v[172:175]
    v_mfma_f32_16x16x32_bf16 v[168:171], v[92:95], v[40:43], v[168:171]
    v_mfma_f32_16x16x32_bf16 v[172:175], v[72:75], v[40:43], v[172:175]
    v_mfma_f32_16x16x32_bf16 v[180:183], v[80:83], v[20:23], v[160:163]
    v_mfma_f32_16x16x32_bf16 v[184:187], v[48:51], v[20:23], 0
    v_mfma_f32_16x16x32_bf16 v[188:191], v[52:55], v[20:23], v[164:167]
    v_mfma_f32_16x16x32_bf16 v[180:183], v[84:87], v[28:31], v[180:183]
    v_mfma_f32_16x16x32_bf16 v[184:187], v[56:59], v[28:31], v[184:187]
    v_mfma_f32_16x16x32_bf16 v[188:191], v[60:63], v[28:31], v[188:191]
    v_mfma_f32_16x16x32_bf16 v[180:183], v[88:91], v[36:39], v[180:183]
    v_mfma_f32_16x16x32_bf16 v[184:187], v[64:67], v[36:39], v[184:187]
    v_mfma_f32_16x16x32_bf16 v[188:191], v[68:71], v[36:39], v[188:191]
    v_mfma_f32_16x16x32_bf16 v[180:183], v[92:95], v[44:47], v[180:183]
    v_mfma_f32_16x16x32_bf16 v[184:187], v[72:75], v[44:47], v[184:187]
    v_mfma_f32_16x16x32_bf16 v[188:191], v[76:79], v[44:47], v[188:191]
    s_nop 7
    v_max3_f32 v4, v168, v169, v170
    v_max3_f32 v4, v4, v171, v172
    v_max3_f32 v4, v4, v173, v174
    v_max_f32 v4, v4, v175
    v_mov_b32 v5, v4
    s_nop 1
    v_permlane16_swap_b32 v4, v5
    s_nop 0
    v_max_f32 v4, v4, v5
    v_mov_b32 v5, v4
    s_nop 1
    v_permlane32_swap_b32 v4, v5
    s_nop 0
    v_max_f32 v4, v4, v5
    v_mul_f32 v4, s21, v4
    v_fma_f32 v168, v168, s21, -v4
    v_fma_f32 v169, v169, s21, -v4
    v_fma_f32 v170, v170, s21, -v4
    v_fma_f32 v171, v171, s21, -v4
    v_fma_f32 v172, v172, s21, -v4
    v_fma_f32 v173, v173, s21, -v4
    v_fma_f32 v174, v174, s21, -v4
    v_fma_f32 v175, v175, s21, -v4
    v_exp_f32 v168, v168
    v_exp_f32 v169, v169
    v_exp_f32 v170, v170
    v_exp_f32 v171, v171
    v_exp_f32 v172, v172
    v_exp_f32 v173, v173
    v_exp_f32 v174, v174
    v_exp_f32 v175, v175
    s_nop 0
    v_add_f32 v5, v168, v169
    v_add_f32 v5, v5, v170
    v_add_f32 v5, v5, v171
    v_add_f32 v5, v5, v172
    v_add_f32 v5, v5, v173
    v_add_f32 v5, v5, v174
    v_add_f32 v5, v5, v175
    v_mov_b32 v6, v5
    s_nop 1
    v_permlane16_swap_b32 v5, v6
    s_nop 0
    v_add_f32 v5, v5, v6
    v_mov_b32 v6, v5
    s_nop 1
    v_permlane32_swap_b32 v5, v6
    s_nop 0
    v_add_f32 v5, v5, v6
    v_rcp_f32 v5, v5
    s_nop 0
    v_mul_f32 v168, v5, v168
    v_mul_f32 v169, v5, v169
    v_mul_f32 v170, v5, v170
    v_mul_f32 v171, v5, v171
    v_mul_f32 v172, v5, v172
    v_mul_f32 v173, v5, v173
    v_mul_f32 v174, v5, v174
    v_mul_f32 v175, v5, v175
    v_cvt_pk_bf16_f32 v192, v168, v169
    v_cvt_pk_bf16_f32 v193, v170, v171
    v_mov_b32 v194, 0
    v_mov_b32 v195, 0
    v_cvt_pk_bf16_f32 v196, v172, v173
    v_cvt_pk_bf16_f32 v197, v174, v175
    v_mov_b32 v198, 0
    v_mov_b32 v199, 0
    v_max3_f32 v4, v180, v181, v182
    v_max3_f32 v4, v4, v183, v184
    v_max3_f32 v4, v4, v185, v186
    v_max3_f32 v4, v4, v187, v188
    v_max3_f32 v4, v4, v189, v190
    v_max_f32 v4, v4, v191
    v_mov_b32 v5, v4
    s_nop 1
    v_permlane16_swap_b32 v4, v5
    s_nop 0
    v_max_f32 v4, v4, v5
    v_mov_b32 v5, v4
    s_nop 1
    v_permlane32_swap_b32 v4, v5
    s_nop 0
    v_max_f32 v4, v4, v5
    v_mul_f32 v4, s21, v4
    v_fma_f32 v180, v180, s21, -v4
    v_fma_f32 v181, v181, s21, -v4
    v_fma_f32 v182, v182, s21, -v4
    v_fma_f32 v183, v183, s21, -v4
    v_fma_f32 v184, v184, s21, -v4
    v_fma_f32 v185, v185, s21, -v4
    v_fma_f32 v186, v186, s21, -v4
    v_fma_f32 v187, v187, s21, -v4
    v_fma_f32 v188, v188, s21, -v4
    v_fma_f32 v189, v189, s21, -v4
    v_fma_f32 v190, v190, s21, -v4
    v_fma_f32 v191, v191, s21, -v4
    v_exp_f32 v180, v180
    v_exp_f32 v181, v181
    v_exp_f32 v182, v182
    v_exp_f32 v183, v183
    v_exp_f32 v184, v184
    v_exp_f32 v185, v185
    v_exp_f32 v186, v186
    v_exp_f32 v187, v187
    v_exp_f32 v188, v188
    v_exp_f32 v189, v189
    v_exp_f32 v190, v190
    v_exp_f32 v191, v191
    s_nop 0
    v_add_f32 v5, v180, v181
    v_add_f32 v5, v5, v182
    v_add_f32 v5, v5, v183
    v_add_f32 v5, v5, v184
    v_add_f32 v5, v5, v185
    v_add_f32 v5, v5, v186
    v_add_f32 v5, v5, v187
    v_add_f32 v5, v5, v188
    v_add_f32 v5, v5, v189
    v_add_f32 v5, v5, v190
    v_add_f32 v5, v5, v191
    v_mov_b32 v6, v5
    s_nop 1
    v_permlane16_swap_b32 v5, v6
    s_nop 0
    v_add_f32 v5, v5, v6
    v_mov_b32 v6, v5
    s_nop 1
    v_permlane32_swap_b32 v5, v6
    s_nop 0
    v_add_f32 v5, v5, v6
    v_rcp_f32 v5, v5
    s_nop 0
    v_mul_f32 v180, v5, v180
    v_mul_f32 v181, v5, v181
    v_mul_f32 v182, v5, v182
    v_mul_f32 v183, v5, v183
    v_mul_f32 v184, v5, v184
    v_mul_f32 v185, v5, v185
    v_mul_f32 v186, v5, v186
    v_mul_f32 v187, v5, v187
    v_mul_f32 v188, v5, v188
    v_mul_f32 v189, v5, v189
    v_mul_f32 v190, v5, v190
    v_mul_f32 v191, v5, v191
    v_cvt_pk_bf16_f32 v200, v180, v181
    v_cvt_pk_bf16_f32 v201, v182, v183
    v_mov_b32 v202, 0
    v_mov_b32 v203, 0
    v_cvt_pk_bf16_f32 v204, v184, v185
    v_cvt_pk_bf16_f32 v205, v186, v187
    v_cvt_pk_bf16_f32 v206, v188, v189
    v_cvt_pk_bf16_f32 v207, v190, v191
    s_nop 1
    v_mfma_f32_16x16x32_bf16 v[16:19], v[96:99], v[196:199], 0
    v_mfma_f32_16x16x32_bf16 v[16:19], v[128:131], v[192:195], v[16:19]
    v_mfma_f32_16x16x32_bf16 v[20:23], v[96:99], v[204:207], 0
    v_mfma_f32_16x16x32_bf16 v[20:23], v[128:131], v[200:203], v[20:23]
    v_mfma_f32_16x16x32_bf16 v[24:27], v[100:103], v[196:199], 0
    v_mfma_f32_16x16x32_bf16 v[24:27], v[132:135], v[192:195], v[24:27]
    v_mfma_f32_16x16x32_bf16 v[28:31], v[100:103], v[204:207], 0
    v_mfma_f32_16x16x32_bf16 v[28:31], v[132:135], v[200:203], v[28:31]
    v_mfma_f32_16x16x32_bf16 v[32:35], v[104:107], v[196:199], 0
    v_mfma_f32_16x16x32_bf16 v[32:35], v[136:139], v[192:195], v[32:35]
    v_mfma_f32_16x16x32_bf16 v[36:39], v[104:107], v[204:207], 0
    v_mfma_f32_16x16x32_bf16 v[36:39], v[136:139], v[200:203], v[36:39]
    v_mfma_f32_16x16x32_bf16 v[40:43], v[108:111], v[196:199], 0
    v_mfma_f32_16x16x32_bf16 v[40:43], v[140:143], v[192:195], v[40:43]
    v_mfma_f32_16x16x32_bf16 v[44:47], v[108:111], v[204:207], 0
    v_mfma_f32_16x16x32_bf16 v[44:47], v[140:143], v[200:203], v[44:47]
    v_mfma_f32_16x16x32_bf16 v[48:51], v[112:115], v[196:199], 0
    v_mfma_f32_16x16x32_bf16 v[48:51], v[144:147], v[192:195], v[48:51]
    v_mfma_f32_16x16x32_bf16 v[52:55], v[112:115], v[204:207], 0
    v_mfma_f32_16x16x32_bf16 v[52:55], v[144:147], v[200:203], v[52:55]
    v_mfma_f32_16x16x32_bf16 v[56:59], v[116:119], v[196:199], 0
    v_mfma_f32_16x16x32_bf16 v[56:59], v[148:151], v[192:195], v[56:59]
    v_mfma_f32_16x16x32_bf16 v[60:63], v[116:119], v[204:207], 0
    v_mfma_f32_16x16x32_bf16 v[60:63], v[148:151], v[200:203], v[60:63]
    v_mfma_f32_16x16x32_bf16 v[64:67], v[120:123], v[196:199], 0
    v_mfma_f32_16x16x32_bf16 v[64:67], v[152:155], v[192:195], v[64:67]
    v_mfma_f32_16x16x32_bf16 v[68:71], v[120:123], v[204:207], 0
    v_mfma_f32_16x16x32_bf16 v[68:71], v[152:155], v[200:203], v[68:71]
    v_mfma_f32_16x16x32_bf16 v[72:75], v[124:127], v[196:199], 0
    v_mfma_f32_16x16x32_bf16 v[72:75], v[156:159], v[192:195], v[72:75]
    v_mfma_f32_16x16x32_bf16 v[76:79], v[124:127], v[204:207], 0
    v_mfma_f32_16x16x32_bf16 v[76:79], v[156:159], v[200:203], v[76:79]
    s_nop 7
    s_add_u32 s19, s6, 218103808
    s_add_u32 s22, s19, 4096
    v_cvt_pk_bf16_f32 v208, v16, v17
    v_cvt_pk_bf16_f32 v209, v18, v19
    v_cvt_pk_bf16_f32 v210, v24, v25
    v_cvt_pk_bf16_f32 v211, v26, v27
    buffer_store_dwordx4 v[208:211], v7, s[8:11], s19 offen offset:0
    s_nop 1
    v_cvt_pk_bf16_f32 v212, v20, v21
    v_cvt_pk_bf16_f32 v213, v22, v23
    v_cvt_pk_bf16_f32 v214, v28, v29
    v_cvt_pk_bf16_f32 v215, v30, v31
    buffer_store_dwordx4 v[212:215], v7, s[8:11], s19 offen offset:1024
    s_nop 1
    v_cvt_pk_bf16_f32 v208, v32, v33
    v_cvt_pk_bf16_f32 v209, v34, v35
    v_cvt_pk_bf16_f32 v210, v40, v41
    v_cvt_pk_bf16_f32 v211, v42, v43
    buffer_store_dwordx4 v[208:211], v7, s[8:11], s19 offen offset:2048
    s_nop 1
    v_cvt_pk_bf16_f32 v212, v36, v37
    v_cvt_pk_bf16_f32 v213, v38, v39
    v_cvt_pk_bf16_f32 v214, v44, v45
    v_cvt_pk_bf16_f32 v215, v46, v47
    buffer_store_dwordx4 v[212:215], v7, s[8:11], s19 offen offset:3072
    s_nop 1
    v_cvt_pk_bf16_f32 v208, v48, v49
    v_cvt_pk_bf16_f32 v209, v50, v51
    v_cvt_pk_bf16_f32 v210, v56, v57
    v_cvt_pk_bf16_f32 v211, v58, v59
    buffer_store_dwordx4 v[208:211], v7, s[8:11], s22 offen offset:0
    s_nop 1
    v_cvt_pk_bf16_f32 v212, v52, v53
    v_cvt_pk_bf16_f32 v213, v54, v55
    v_cvt_pk_bf16_f32 v214, v60, v61
    v_cvt_pk_bf16_f32 v215, v62, v63
    buffer_store_dwordx4 v[212:215], v7, s[8:11], s22 offen offset:1024
    s_nop 1
    v_cvt_pk_bf16_f32 v208, v64, v65
    v_cvt_pk_bf16_f32 v209, v66, v67
    v_cvt_pk_bf16_f32 v210, v72, v73
    v_cvt_pk_bf16_f32 v211, v74, v75
    buffer_store_dwordx4 v[208:211], v7, s[8:11], s22 offen offset:2048
    s_nop 1
    v_cvt_pk_bf16_f32 v212, v68, v69
    v_cvt_pk_bf16_f32 v213, v70, v71
    v_cvt_pk_bf16_f32 v214, v76, v77
    v_cvt_pk_bf16_f32 v215, v78, v79
    buffer_store_dwordx4 v[212:215], v7, s[8:11], s22 offen offset:3072
    s_nop 1
L_kb3_end_18:
    s_endpgm
.section .rodata,"a"
.p2align 6
.amdhsa_kernel kb3_1_kernel
  .amdhsa_next_free_vgpr 216
  .amdhsa_next_free_sgpr 102
  .amdhsa_accum_offset 216
  .amdhsa_group_segment_fixed_size 0
  .amdhsa_kernarg_size 120
  .amdhsa_user_sgpr_count 2
  .amdhsa_user_sgpr_kernarg_segment_ptr 1
  .amdhsa_system_sgpr_workgroup_id_x 1
.end_amdhsa_kernel
.text

.p2align 8
.globl mega0_kernel
.type mega0_kernel,@function
mega0_kernel:
    s_cmp_ge_u32 s2, 256
    s_cbranch_scc1 L_mega_exit_19
    s_and_b32 s3, s2, 7
    s_cmp_lg_u32 s3, 0
    s_cbranch_scc1 L_mega_work_20
    s_lshr_b32 s3, s2, 3
    s_load_dwordx2 s[4:5], s[0:1], 48
    s_load_dwordx2 s[6:7], s[0:1], 112
    v_and_b32 v12, 63, v0
    v_lshrrev_b32 v13, 6, v0
    s_nop 0
    v_readfirstlane_b32 s16, v13
    s_waitcnt lgkmcnt(0)
    s_mov_b32 s8, s6
    s_and_b32 s9, s7, 0xffff
    s_mov_b32 s10, 268435456
    s_mov_b32 s11, 0x00020000
    s_mov_b32 s12, s4
    s_and_b32 s13, s5, 0xffff
    s_mov_b32 s14, 8192
    s_mov_b32 s15, 0x00020000
    s_getreg_b32 s19, hwreg(HW_REG_XCC_ID)
    s_and_b32 s19, s19, 0xf
    s_add_u32 s19, s19, 1
    v_mov_b32 v11, s19
    v_mov_b32 v12, 0
    s_lshl_b32 s19, s3, 2
    s_add_u32 s19, s19, 19415040
    s_cmp_lg_u32 s16, 0
    s_cbranch_scc1 L_chain_skipx_24
    buffer_store_dword v11, v12, s[8:11], s19 offen sc1
L_chain_skipx_24:
    v_and_b32 v12, 63, v0
    s_mov_b32 s20, 0x07060302
    s_mov_b32 s21, 0x3e0293ee
    s_mov_b32 s29, 4194304
    v_lshlrev_b32 v1, 4, v12
    v_lshrrev_b32 v13, 4, v12
    v_and_b32 v14, 15, v12
    v_lshlrev_b32 v2, 8, v13
    v_lshl_add_u32 v2, v14, 4, v2
    v_add_u32 v2, 131072, v2
    s_lshl_b32 s19, s16, 10
    s_add_u32 s19, s19, 147456
    v_add_u32 v3, s19, v1
    v_add_u32 v15, 147456, v1
    s_lshl_b32 s19, s16, 15
    v_add_u32 v4, s19, v1
    v_and_b32 v16, 7, v12
    v_bfe_u32 v17, v12, 3, 1
    v_lshlrev_b32 v5, 8, v13
    v_lshl_add_u32 v5, v16, 4, v5
    v_lshl_add_u32 v5, v17, 3, v5
    s_lshl_b32 s19, s16, 12
    s_add_u32 s19, s19, 131072
    v_add_u32 v5, s19, v5
    v_lshlrev_b32 v6, 6, v16
    v_lshrrev_b32 v18, 1, v13
    v_lshl_add_u32 v6, v18, 9, v6
    v_and_b32 v18, 1, v13
    v_lshl_add_u32 v6, v18, 5, v6
    v_lshl_add_u32 v6, v17, 4, v6
    s_lshl_b32 s19, s16, 12
    s_add_u32 s19, s19, 19398656
    v_add_u32 v6, s19, v6
    v_lshlrev_b32 v18, 10, v16
    v_lshl_add_u32 v18, v13, 4, v18
    v_lshl_add_u32 v18, v17, 3, v18
    s_lshl_b32 s19, s16, 8
    v_add_u32 v18, s19, v18
    v_lshlrev_b32 v7, 6, v14
    v_lshl_add_u32 v7, v13, 4, v7
    s_lshl_b32 s19, s16, 17
    s_lshl_b32 s22, s3, 9
    s_add_u32 s19, s19, s22
    s_add_u32 s19, s19, 18874368
    v_add_u32 v7, s19, v7
    v_mov_b32 v19, 1073741824
    v_cmp_gt_u32 vcc, 8, v14
    s_nop 1
    v_cndmask_b32 v7, v19, v7, vcc
    v_lshrrev_b32 v8, 3, v12
    v_lshlrev_b32 v8, 9, v8
    v_and_b32 v9, 7, v12
    v_lshl_add_u32 v8, v9, 4, v8
    s_lshl_b32 s19, s3, 14
    s_lshl_b32 s22, s16, 7
    s_add_u32 s19, s19, s22
    s_add_u32 s19, s19, 18874368
    v_add_u32 v8, s19, v8
    s_mov_b32 s32, 0
    s_mov_b32 s33, 4096
    s_mov_b32 s34, 8192
    s_mov_b32 s35, 12288
    v_lshlrev_b32 v10, 4, v9
    s_lshl_b32 s19, s3, 9
    s_lshl_b32 s22, s16, 7
    s_add_u32 s19, s19, s22
    s_add_u32 s19, s19, 19398656
    v_add_u32 v10, s19, v10
    v_cmp_gt_u32 vcc, 8, v12
    s_nop 1
    v_cndmask_b32 v10, v19, v10, vcc
    v_mov_b32 v11, 0xf149f2ca
    v_cmp_le_u32 vcc, 2, v13
    s_nop 1
    v_cndmask_b32 v16, 0, v11, vcc
    v_mov_b32 v17, v16
    v_mov_b32 v18, v18
    v_mov_b32 v20, 0
    v_mov_b32 v21, 0
    v_mov_b32 v22, 0
    v_mov_b32 v23, 0
    v_lshlrev_b32 v11, 4, v0
    v_add_u32 v11, 131072, v11
    ds_write_b128 v11, v[20:23] offset:0
    ds_write_b128 v11, v[20:23] offset:4096
    ds_write_b128 v11, v[20:23] offset:8192
    ds_write_b128 v11, v[20:23] offset:12288
    buffer_load_dwordx2 v[96:97], v18, s[12:15], 0 offen offset:0
    buffer_load_dwordx2 v[98:99], v18, s[12:15], 0 offen offset:64
    buffer_load_dwordx2 v[100:101], v18, s[12:15], 0 offen offset:128
    buffer_load_dwordx2 v[102:103], v18, s[12:15], 0 offen offset:192
    v_lshlrev_b32 v11, 4, v0
    s_lshl_b32 s22, s3, 17
    s_add_u32 s22, s22, 8388608
    s_add_u32 s19, s22, 0
    buffer_load_dwordx4 v[32:35], v11, s[8:11], s19 offen
    s_add_u32 s19, s22, 4096
    buffer_load_dwordx4 v[36:39], v11, s[8:11], s19 offen
    s_add_u32 s19, s22, 8192
    buffer_load_dwordx4 v[40:43], v11, s[8:11], s19 offen
    s_add_u32 s19, s22, 12288
    buffer_load_dwordx4 v[44:47], v11, s[8:11], s19 offen
    s_add_u32 s19, s22, 16384
    buffer_load_dwordx4 v[48:51], v11, s[8:11], s19 offen
    s_add_u32 s19, s22, 20480
    buffer_load_dwordx4 v[52:55], v11, s[8:11], s19 offen
    s_add_u32 s19, s22, 24576
    buffer_load_dwordx4 v[56:59], v11, s[8:11], s19 offen
    s_add_u32 s19, s22, 28672
    buffer_load_dwordx4 v[60:63], v11, s[8:11], s19 offen
    v_add_u32 v12, 0, v11
    s_waitcnt vmcnt(7)
    ds_write_b128 v12, v[32:35] offset:0
    s_waitcnt vmcnt(6)
    ds_write_b128 v12, v[36:39] offset:4096
    s_waitcnt vmcnt(5)
    ds_write_b128 v12, v[40:43] offset:8192
    s_waitcnt vmcnt(4)
    ds_write_b128 v12, v[44:47] offset:12288
    s_waitcnt vmcnt(3)
    ds_write_b128 v12, v[48:51] offset:16384
    s_waitcnt vmcnt(2)
    ds_write_b128 v12, v[52:55] offset:20480
    s_waitcnt vmcnt(1)
    ds_write_b128 v12, v[56:59] offset:24576
    s_waitcnt vmcnt(0)
    ds_write_b128 v12, v[60:63] offset:28672
    s_add_u32 s19, s22, 32768
    buffer_load_dwordx4 v[32:35], v11, s[8:11], s19 offen
    s_add_u32 s19, s22, 36864
    buffer_load_dwordx4 v[36:39], v11, s[8:11], s19 offen
    s_add_u32 s19, s22, 40960
    buffer_load_dwordx4 v[40:43], v11, s[8:11], s19 offen
    s_add_u32 s19, s22, 45056
    buffer_load_dwordx4 v[44:47], v11, s[8:11], s19 offen
    s_add_u32 s19, s22, 49152
    buffer_load_dwordx4 v[48:51], v11, s[8:11], s19 offen
    s_add_u32 s19, s22, 53248
    buffer_load_dwordx4 v[52:55], v11, s[8:11], s19 offen
    s_add_u32 s19, s22, 57344
    buffer_load_dwordx4 v[56:59], v11, s[8:11], s19 offen
    s_add_u32 s19, s22, 61440
    buffer_load_dwordx4 v[60:63], v11, s[8:11], s19 offen
    v_add_u32 v12, 32768, v11
    s_waitcnt vmcnt(7)
    ds_write_b128 v12, v[32:35] offset:0
    s_waitcnt vmcnt(6)
    ds_write_b128 v12, v[36:39] offset:4096
    s_waitcnt vmcnt(5)
    ds_write_b128 v12, v[40:43] offset:8192
    s_waitcnt vmcnt(4)
    ds_write_b128 v12, v[44:47] offset:12288
    s_waitcnt vmcnt(3)
    ds_write_b128 v12, v[48:51] offset:16384
    s_waitcnt vmcnt(2)
    ds_write_b128 v12, v[52:55] offset:20480
    s_waitcnt vmcnt(1)
    ds_write_b128 v12, v[56:59] offset:24576
    s_waitcnt vmcnt(0)
    ds_write_b128 v12, v[60:63] offset:28672
    s_add_u32 s19, s22, 65536
    buffer_load_dwordx4 v[32:35], v11, s[8:11], s19 offen
    s_add_u32 s19, s22, 69632
    buffer_load_dwordx4 v[36:39], v11, s[8:11], s19 offen
    s_add_u32 s19, s22, 73728
    buffer_load_dwordx4 v[40:43], v11, s[8:11], s19 offen
    s_add_u32 s19, s22, 77824
    buffer_load_dwordx4 v[44:47], v11, s[8:11], s19 offen
    s_add_u32 s19, s22, 81920
    buffer_load_dwordx4 v[48:51], v11, s[8:11], s19 offen
    s_add_u32 s19, s22, 86016
    buffer_load_dwordx4 v[52:55], v11, s[8:11], s19 offen
    s_add_u32 s19, s22, 90112
    buffer_load_dwordx4 v[56:59], v11, s[8:11], s19 offen
    s_add_u32 s19, s22, 94208
    buffer_load_dwordx4 v[60:63], v11, s[8:11], s19 offen
    v_add_u32 v12, 65536, v11
    s_waitcnt vmcnt(7)
    ds_write_b128 v12, v[32:35] offset:0
    s_waitcnt vmcnt(6)
    ds_write_b128 v12, v[36:39] offset:4096
    s_waitcnt vmcnt(5)
    ds_write_b128 v12, v[40:43] offset:8192
    s_waitcnt vmcnt(4)
    ds_write_b128 v12, v[44:47] offset:12288
    s_waitcnt vmcnt(3)
    ds_write_b128 v12, v[48:51] offset:16384
    s_waitcnt vmcnt(2)
    ds_write_b128 v12, v[52:55] offset:20480
    s_waitcnt vmcnt(1)
    ds_write_b128 v12, v[56:59] offset:24576
    s_waitcnt vmcnt(0)
    ds_write_b128 v12, v[60:63] offset:28672
    s_add_u32 s19, s22, 98304
    buffer_load_dwordx4 v[32:35], v11, s[8:11], s19 offen
    s_add_u32 s19, s22, 102400
    buffer_load_dwordx4 v[36:39], v11, s[8:11], s19 offen
    s_add_u32 s19, s22, 106496
    buffer_load_dwordx4 v[40:43], v11, s[8:11], s19 offen
    s_add_u32 s19, s22, 110592
    buffer_load_dwordx4 v[44:47], v11, s[8:11], s19 offen
    s_add_u32 s19, s22, 114688
    buffer_load_dwordx4 v[48:51], v11, s[8:11], s19 offen
    s_add_u32 s19, s22, 118784
    buffer_load_dwordx4 v[52:55], v11, s[8:11], s19 offen
    s_add_u32 s19, s22, 122880
    buffer_load_dwordx4 v[56:59], v11, s[8:11], s19 offen
    s_add_u32 s19, s22, 126976
    buffer_load_dwordx4 v[60:63], v11, s[8:11], s19 offen
    v_add_u32 v12, 98304, v11
    s_waitcnt vmcnt(7)
    ds_write_b128 v12, v[32:35] offset:0
    s_waitcnt vmcnt(6)
    ds_write_b128 v12, v[36:39] offset:4096
    s_waitcnt vmcnt(5)
    ds_write_b128 v12, v[40:43] offset:8192
    s_waitcnt vmcnt(4)
    ds_write_b128 v12, v[44:47] offset:12288
    s_waitcnt vmcnt(3)
    ds_write_b128 v12, v[48:51] offset:16384
    s_waitcnt vmcnt(2)
    ds_write_b128 v12, v[52:55] offset:20480
    s_waitcnt vmcnt(1)
    ds_write_b128 v12, v[56:59] offset:24576
    s_waitcnt vmcnt(0)
    ds_write_b128 v12, v[60:63] offset:28672
    s_waitcnt vmcnt(0)
    ds_write_b64 v5, v[96:97] offset:0
    ds_write_b64 v5, v[98:99] offset:1024
    ds_write_b64 v5, v[100:101] offset:2048
    ds_write_b64 v5, v[102:103] offset:3072
    s_lshl_b32 s22, s3, 17
    s_lshl_b32 s19, s16, 15
    s_add_u32 s22, s22, s19
    s_add_u32 s19, s22, 0
    buffer_load_dwordx4 a[0:3], v1, s[8:11], s19 offen offset:0
    buffer_load_dwordx4 a[4:7], v1, s[8:11], s19 offen offset:1024
    buffer_load_dwordx4 a[8:11], v1, s[8:11], s19 offen offset:2048
    buffer_load_dwordx4 a[12:15], v1, s[8:11], s19 offen offset:3072
    s_add_u32 s19, s22, 4096
    buffer_load_dwordx4 a[16:19], v1, s[8:11], s19 offen offset:0
    buffer_load_dwordx4 a[20:23], v1, s[8:11], s19 offen offset:1024
    buffer_load_dwordx4 a[24:27], v1, s[8:11], s19 offen offset:2048
    buffer_load_dwordx4 a[28:31], v1, s[8:11], s19 offen offset:3072
    s_add_u32 s19, s22, 8192
    buffer_load_dwordx4 a[32:35], v1, s[8:11], s19 offen offset:0
    buffer_load_dwordx4 a[36:39], v1, s[8:11], s19 offen offset:1024
    buffer_load_dwordx4 a[40:43], v1, s[8:11], s19 offen offset:2048
    buffer_load_dwordx4 a[44:47], v1, s[8:11], s19 offen offset:3072
    s_add_u32 s19, s22, 12288
    buffer_load_dwordx4 a[48:51], v1, s[8:11], s19 offen offset:0
    buffer_load_dwordx4 a[52:55], v1, s[8:11], s19 offen offset:1024
    buffer_load_dwordx4 a[56:59], v1, s[8:11], s19 offen offset:2048
    buffer_load_dwordx4 a[60:63], v1, s[8:11], s19 offen offset:3072
    s_add_u32 s19, s22, 16384
    buffer_load_dwordx4 a[64:67], v1, s[8:11], s19 offen offset:0
    buffer_load_dwordx4 a[68:71], v1, s[8:11], s19 offen offset:1024
    buffer_load_dwordx4 a[72:75], v1, s[8:11], s19 offen offset:2048
    buffer_load_dwordx4 a[76:79], v1, s[8:11], s19 offen offset:3072
    s_add_u32 s19, s22, 20480
    buffer_load_dwordx4 a[80:83], v1, s[8:11], s19 offen offset:0
    buffer_load_dwordx4 a[84:87], v1, s[8:11], s19 offen offset:1024
    buffer_load_dwordx4 a[88:91], v1, s[8:11], s19 offen offset:2048
    buffer_load_dwordx4 a[92:95], v1, s[8:11], s19 offen offset:3072
    s_add_u32 s19, s22, 24576
    buffer_load_dwordx4 a[96:99], v1, s[8:11], s19 offen offset:0
    buffer_load_dwordx4 a[100:103], v1, s[8:11], s19 offen offset:1024
    buffer_load_dwordx4 a[104:107], v1, s[8:11], s19 offen offset:2048
    buffer_load_dwordx4 a[108:111], v1, s[8:11], s19 offen offset:3072
    s_add_u32 s19, s22, 28672
    buffer_load_dwordx4 a[112:115], v1, s[8:11], s19 offen offset:0
    buffer_load_dwordx4 a[116:119], v1, s[8:11], s19 offen offset:1024
    buffer_load_dwordx4 a[120:123], v1, s[8:11], s19 offen offset:2048
    buffer_load_dwordx4 a[124:127], v1, s[8:11], s19 offen offset:3072
    s_add_u32 s19, s22, 4194304
    buffer_load_dwordx4 a[128:131], v1, s[8:11], s19 offen offset:0
    buffer_load_dwordx4 a[132:135], v1, s[8:11], s19 offen offset:1024
    buffer_load_dwordx4 a[136:139], v1, s[8:11], s19 offen offset:2048
    buffer_load_dwordx4 a[140:143], v1, s[8:11], s19 offen offset:3072
    s_add_u32 s19, s22, 4198400
    buffer_load_dwordx4 a[144:147], v1, s[8:11], s19 offen offset:0
    buffer_load_dwordx4 a[148:151], v1, s[8:11], s19 offen offset:1024
    buffer_load_dwordx4 a[152:155], v1, s[8:11], s19 offen offset:2048
    buffer_load_dwordx4 a[156:159], v1, s[8:11], s19 offen offset:3072
    s_add_u32 s19, s22, 4202496
    buffer_load_dwordx4 a[160:163], v1, s[8:11], s19 offen offset:0
    buffer_load_dwordx4 a[164:167], v1, s[8:11], s19 offen offset:1024
    buffer_load_dwordx4 a[168:171], v1, s[8:11], s19 offen offset:2048
    buffer_load_dwordx4 a[172:175], v1, s[8:11], s19 offen offset:3072
    s_add_u32 s19, s22, 4206592
    buffer_load_dwordx4 a[176:179], v1, s[8:11], s19 offen offset:0
    buffer_load_dwordx4 a[180:183], v1, s[8:11], s19 offen offset:1024
    buffer_load_dwordx4 a[184:187], v1, s[8:11], s19 offen offset:2048
    buffer_load_dwordx4 a[188:191], v1, s[8:11], s19 offen offset:3072
    s_add_u32 s19, s22, 4210688
    buffer_load_dwordx4 a[192:195], v1, s[8:11], s19 offen offset:0
    buffer_load_dwordx4 a[196:199], v1, s[8:11], s19 offen offset:1024
    buffer_load_dwordx4 a[200:203], v1, s[8:11], s19 offen offset:2048
    buffer_load_dwordx4 a[204:207], v1, s[8:11], s19 offen offset:3072
    s_add_u32 s19, s22, 4214784
    buffer_load_dwordx4 a[208:211], v1, s[8:11], s19 offen offset:0
    buffer_load_dwordx4 a[212:215], v1, s[8:11], s19 offen offset:1024
    buffer_load_dwordx4 a[216:219], v1, s[8:11], s19 offen offset:2048
    buffer_load_dwordx4 a[220:223], v1, s[8:11], s19 offen offset:3072
    s_add_u32 s19, s22, 4218880
    buffer_load_dwordx4 a[224:227], v1, s[8:11], s19 offen offset:0
    buffer_load_dwordx4 a[228:231], v1, s[8:11], s19 offen offset:1024
    buffer_load_dwordx4 a[232:235], v1, s[8:11], s19 offen offset:2048
    buffer_load_dwordx4 a[236:239], v1, s[8:11], s19 offen offset:3072
    s_add_u32 s19, s22, 4222976
    buffer_load_dwordx4 a[240:243], v1, s[8:11], s19 offen offset:0
    buffer_load_dwordx4 a[244:247], v1, s[8:11], s19 offen offset:1024
    buffer_load_dwordx4 a[248:251], v1, s[8:11], s19 offen offset:2048
    buffer_load_dwordx4 a[252:255], v1, s[8:11], s19 offen offset:3072
    s_add_u32 s19, s22, 8388608
    s_add_u32 s19, s22, 8392704
    s_add_u32 s19, s22, 8396800
    s_add_u32 s19, s22, 8400896
    s_add_u32 s19, s22, 8404992
    s_add_u32 s19, s22, 8409088
    s_add_u32 s19, s22, 8413184
    s_add_u32 s19, s22, 8417280
    s_lshl_b32 s22, s3, 17
    s_lshl_b32 s19, s16, 15
    s_add_u32 s22, s22, s19
    s_add_u32 s22, s22, 12582912
    s_add_u32 s19, s22, 0
    buffer_load_dwordx4 v[128:131], v1, s[8:11], s19 offen offset:0
    buffer_load_dwordx4 v[132:135], v1, s[8:11], s19 offen offset:1024
    buffer_load_dwordx4 v[136:139], v1, s[8:11], s19 offen offset:2048
    buffer_load_dwordx4 v[140:143], v1, s[8:11], s19 offen offset:3072
    s_add_u32 s19, s22, 4096
    buffer_load_dwordx4 v[144:147], v1, s[8:11], s19 offen offset:0
    buffer_load_dwordx4 v[148:151], v1, s[8:11], s19 offen offset:1024
    buffer_load_dwordx4 v[152:155], v1, s[8:11], s19 offen offset:2048
    buffer_load_dwordx4 v[156:159], v1, s[8:11], s19 offen offset:3072
    s_add_u32 s19, s22, 8192
    buffer_load_dwordx4 v[160:163], v1, s[8:11], s19 offen offset:0
    buffer_load_dwordx4 v[164:167], v1, s[8:11], s19 offen offset:1024
    buffer_load_dwordx4 v[168:171], v1, s[8:11], s19 offen offset:2048
    buffer_load_dwordx4 v[172:175], v1, s[8:11], s19 offen offset:3072
    s_add_u32 s19, s22, 12288
    buffer_load_dwordx4 v[176:179], v1, s[8:11], s19 offen offset:0
    buffer_load_dwordx4 v[180:183], v1, s[8:11], s19 offen offset:1024
    buffer_load_dwordx4 v[184:187], v1, s[8:11], s19 offen offset:2048
    buffer_load_dwordx4 v[188:191], v1, s[8:11], s19 offen offset:3072
    s_add_u32 s19, s22, 16384
    buffer_load_dwordx4 v[192:195], v1, s[8:11], s19 offen offset:0
    buffer_load_dwordx4 v[196:199], v1, s[8:11], s19 offen offset:1024
    buffer_load_dwordx4 v[200:203], v1, s[8:11], s19 offen offset:2048
    buffer_load_dwordx4 v[204:207], v1, s[8:11], s19 offen offset:3072
    s_add_u32 s19, s22, 20480
    buffer_load_dwordx4 v[208:211], v1, s[8:11], s19 offen offset:0
    buffer_load_dwordx4 v[212:215], v1, s[8:11], s19 offen offset:1024
    buffer_load_dwordx4 v[216:219], v1, s[8:11], s19 offen offset:2048
    buffer_load_dwordx4 v[220:223], v1, s[8:11], s19 offen offset:3072
    s_add_u32 s19, s22, 24576
    buffer_load_dwordx4 v[224:227], v1, s[8:11], s19 offen offset:0
    buffer_load_dwordx4 v[228:231], v1, s[8:11], s19 offen offset:1024
    buffer_load_dwordx4 v[232:235], v1, s[8:11], s19 offen offset:2048
    buffer_load_dwordx4 v[236:239], v1, s[8:11], s19 offen offset:3072
    s_add_u32 s19, s22, 28672
    buffer_load_dwordx4 v[240:243], v1, s[8:11], s19 offen offset:0
    buffer_load_dwordx4 v[244:247], v1, s[8:11], s19 offen offset:1024
    buffer_load_dwordx4 v[248:251], v1, s[8:11], s19 offen offset:2048
    buffer_load_dwordx4 v[252:255], v1, s[8:11], s19 offen offset:3072
    v_mov_b32 v18, v16
    v_mov_b32 v19, v16
    v_mov_b32 v22, 0
    v_mov_b32 v23, 0
    v_mov_b32 v26, 0
    v_mov_b32 v27, 0
    v_mov_b32 v30, 0
    v_mov_b32 v31, 0
    s_mov_b32 s17, 0
    s_and_b32 s25, s17, 3
    s_cmp_lg_u32 s25, 0
    s_cbranch_scc1 L_chain_t1skip_25
    s_lshr_b32 s25, s17, 2
    s_lshl_b32 s25, s25, 6
    s_lshr_b32 s26, s3, 1
    s_lshl_b32 s26, s26, 2
    s_add_u32 s25, s25, s26
    s_add_u32 s25, s25, 19415296
    v_mov_b32 v124, 0
L_chain_t1wait_26:
    s_sub_u32 s29, s29, 1
    s_cbranch_scc1 L_chain_bail_23
    buffer_load_dword v125, v124, s[8:11], s25 offen sc1
    s_waitcnt vmcnt(0)
    v_cmp_eq_u32 vcc, 0, v125
    s_cbranch_vccnz L_chain_t1wait_26
L_chain_t1skip_25:
    s_lshl_b32 s23, s3, 13
    s_add_u32 s19, s23, 50331648
    s_add_u32 s22, s19, 4096
    buffer_load_dwordx4 v[32:35], v1, s[8:11], s19 offen offset:0 sc1
    buffer_load_dwordx4 v[36:39], v1, s[8:11], s19 offen offset:1024 sc1
    buffer_load_dwordx4 v[40:43], v1, s[8:11], s19 offen offset:2048 sc1
    buffer_load_dwordx4 v[44:47], v1, s[8:11], s19 offen offset:3072 sc1
    buffer_load_dwordx4 v[48:51], v1, s[8:11], s22 offen offset:0 sc1
    buffer_load_dwordx4 v[52:55], v1, s[8:11], s22 offen offset:1024 sc1
    buffer_load_dwordx4 v[56:59], v1, s[8:11], s22 offen offset:2048 sc1
    buffer_load_dwordx4 v[60:63], v1, s[8:11], s22 offen offset:3072 sc1
    s_lshl_b32 s19, s16, 11
    s_add_u32 s19, s19, s23
    s_add_u32 s19, s19, 67108864
    buffer_load_dwordx4 v[64:67], v1, s[8:11], s19 offen offset:0 sc1
    buffer_load_dwordx4 v[68:71], v1, s[8:11], s19 offen offset:1024 sc1
    v_lshrrev_b32 v11, 0, v1
    v_and_b32 v11, 0x1f0, v1
    v_lshrrev_b32 v11, 2, v11
    v_add_u32 v11, 19415040, v11
L_chain_xpoll_27:
    s_sub_u32 s29, s29, 1
    s_cbranch_scc1 L_chain_bail_23
    buffer_load_dword v12, v11, s[8:11], 0 offen sc1
    s_waitcnt vmcnt(0)
    v_cmp_eq_u32 vcc, 0, v12
    s_cbranch_vccnz L_chain_xpoll_27
    v_readfirstlane_b32 s19, v12
    s_nop 3
    v_cmp_ne_u32 vcc, s19, v12
    s_mov_b32 s28, 1
    s_cbranch_vccz L_chain_xq_28
    s_mov_b32 s28, 0
L_chain_xq_28:
    s_waitcnt vmcnt(0) lgkmcnt(0)
    s_barrier
L_chain_step_29:
    s_add_u32 s18, s17, 1
    s_and_b32 s18, s18, 3
    v_mov_b32 v11, s18
    ds_read_b128 v[96:99], v2 offset:0
    ds_read_b128 v[100:103], v2 offset:1024
    ds_read_b128 v[104:107], v2 offset:2048
    s_waitcnt lgkmcnt(2)
    v_mfma_f32_16x16x32_bf16 v[72:75], a[0:3], v[96:99], 0
    v_mfma_f32_16x16x32_bf16 v[76:79], a[64:67], v[96:99], 0
    v_mfma_f32_16x16x32_bf16 v[80:83], a[128:131], v[96:99], 0
    v_mfma_f32_16x16x32_bf16 v[84:87], a[192:195], v[96:99], 0
    ds_read_b128 v[96:99], v2 offset:3072
    s_waitcnt lgkmcnt(2)
    v_mfma_f32_16x16x32_bf16 v[72:75], a[4:7], v[100:103], v[72:75]
    v_mfma_f32_16x16x32_bf16 v[76:79], a[68:71], v[100:103], v[76:79]
    v_mfma_f32_16x16x32_bf16 v[80:83], a[132:135], v[100:103], v[80:83]
    v_mfma_f32_16x16x32_bf16 v[84:87], a[196:199], v[100:103], v[84:87]
    ds_read_b128 v[100:103], v2 offset:4096
    s_waitcnt lgkmcnt(2)
    v_mfma_f32_16x16x32_bf16 v[72:75], a[8:11], v[104:107], v[72:75]
    v_mfma_f32_16x16x32_bf16 v[76:79], a[72:75], v[104:107], v[76:79]
    v_mfma_f32_16x16x32_bf16 v[80:83], a[136:139], v[104:107], v[80:83]
    v_mfma_f32_16x16x32_bf16 v[84:87], a[200:203], v[104:107], v[84:87]
    ds_read_b128 v[104:107], v2 offset:5120
    s_waitcnt lgkmcnt(2)
    v_mfma_f32_16x16x32_bf16 v[72:75], a[12:15], v[96:99], v[72:75]
    v_mfma_f32_16x16x32_bf16 v[76:79], a[76:79], v[96:99], v[76:79]
    v_mfma_f32_16x16x32_bf16 v[80:83], a[140:143], v[96:99], v[80:83]
    v_mfma_f32_16x16x32_bf16 v[84:87], a[204:207], v[96:99], v[84:87]
    ds_read_b128 v[96:99], v2 offset:6144
    s_waitcnt lgkmcnt(2)
    v_mfma_f32_16x16x32_bf16 v[72:75], a[16:19], v[100:103], v[72:75]
    v_mfma_f32_16x16x32_bf16 v[76:79], a[80:83], v[100:103], v[76:79]
    v_mfma_f32_16x16x32_bf16 v[80:83], a[144:147], v[100:103], v[80:83]
    v_mfma_f32_16x16x32_bf16 v[84:87], a[208:211], v[100:103], v[84:87]
    ds_read_b128 v[100:103], v2 offset:7168
    s_waitcnt lgkmcnt(2)
    v_mfma_f32_16x16x32_bf16 v[72:75], a[20:23], v[104:107], v[72:75]
    v_mfma_f32_16x16x32_bf16 v[76:79], a[84:87], v[104:107], v[76:79]
    v_mfma_f32_16x16x32_bf16 v[80:83], a[148:151], v[104:107], v[80:83]
    v_mfma_f32_16x16x32_bf16 v[84:87], a[212:215], v[104:107], v[84:87]
    ds_read_b128 v[104:107], v2 offset:8192
    s_waitcnt lgkmcnt(2)
    v_mfma_f32_16x16x32_bf16 v[72:75], a[24:27], v[96:99], v[72:75]
    v_mfma_f32_16x16x32_bf16 v[76:79], a[88:91], v[96:99], v[76:79]
    v_mfma_f32_16x16x32_bf16 v[80:83], a[152:155], v[96:99], v[80:83]
    v_mfma_f32_16x16x32_bf16 v[84:87], a[216:219], v[96:99], v[84:87]
    ds_read_b128 v[96:99], v2 offset:9216
    s_waitcnt lgkmcnt(2)
    v_mfma_f32_16x16x32_bf16 v[72:75], a[28:31], v[100:103], v[72:75]
    v_mfma_f32_16x16x32_bf16 v[76:79], a[92:95], v[100:103], v[76:79]
    v_mfma_f32_16x16x32_bf16 v[80:83], a[156:159], v[100:103], v[80:83]
    v_mfma_f32_16x16x32_bf16 v[84:87], a[220:223], v[100:103], v[84:87]
    ds_read_b128 v[100:103], v2 offset:10240
    s_waitcnt lgkmcnt(2)
    v_mfma_f32_16x16x32_bf16 v[72:75], a[32:35], v[104:107], v[72:75]
    v_mfma_f32_16x16x32_bf16 v[76:79], a[96:99], v[104:107], v[76:79]
    v_mfma_f32_16x16x32_bf16 v[80:83], a[160:163], v[104:107], v[80:83]
    v_mfma_f32_16x16x32_bf16 v[84:87], a[224:227], v[104:107], v[84:87]
    ds_read_b128 v[104:107], v2 offset:11264
    s_waitcnt lgkmcnt(2)
    v_mfma_f32_16x16x32_bf16 v[72:75], a[36:39], v[96:99], v[72:75]
    v_mfma_f32_16x16x32_bf16 v[76:79], a[100:103], v[96:99], v[76:79]
    v_mfma_f32_16x16x32_bf16 v[80:83], a[164:167], v[96:99], v[80:83]
    v_mfma_f32_16x16x32_bf16 v[84:87], a[228:231], v[96:99], v[84:87]
    ds_read_b128 v[96:99], v2 offset:12288
    s_waitcnt lgkmcnt(2)
    v_mfma_f32_16x16x32_bf16 v[72:75], a[40:43], v[100:103], v[72:75]
    v_mfma_f32_16x16x32_bf16 v[76:79], a[104:107], v[100:103], v[76:79]
    v_mfma_f32_16x16x32_bf16 v[80:83], a[168:171], v[100:103], v[80:83]
    v_mfma_f32_16x16x32_bf16 v[84:87], a[232:235], v[100:103], v[84:87]
    ds_read_b128 v[100:103], v2 offset:13312
    s_waitcnt lgkmcnt(2)
    v_mfma_f32_16x16x32_bf16 v[72:75], a[44:47], v[104:107], v[72:75]
    v_mfma_f32_16x16x32_bf16 v[76:79], a[108:111], v[104:107], v[76:79]
    v_mfma_f32_16x16x32_bf16 v[80:83], a[172:175], v[104:107], v[80:83]
    v_mfma_f32_16x16x32_bf16 v[84:87], a[236:239], v[104:107], v[84:87]
    ds_read_b128 v[104:107], v2 offset:14336
    s_waitcnt lgkmcnt(2)
    v_mfma_f32_16x16x32_bf16 v[72:75], a[48:51], v[96:99], v[72:75]
    v_mfma_f32_16x16x32_bf16 v[76:79], a[112:115], v[96:99], v[76:79]
    v_mfma_f32_16x16x32_bf16 v[80:83], a[176:179], v[96:99], v[80:83]
    v_mfma_f32_16x16x32_bf16 v[84:87], a[240:243], v[96:99], v[84:87]
    ds_read_b128 v[96:99], v2 offset:15360
    s_waitcnt lgkmcnt(2)
    v_mfma_f32_16x16x32_bf16 v[72:75], a[52:55], v[100:103], v[72:75]
    v_mfma_f32_16x16x32_bf16 v[76:79], a[116:119], v[100:103], v[76:79]
    v_mfma_f32_16x16x32_bf16 v[80:83], a[180:183], v[100:103], v[80:83]
    v_mfma_f32_16x16x32_bf16 v[84:87], a[244:247], v[100:103], v[84:87]
    s_waitcnt lgkmcnt(1)
    v_mfma_f32_16x16x32_bf16 v[72:75], a[56:59], v[104:107], v[72:75]
    v_mfma_f32_16x16x32_bf16 v[76:79], a[120:123], v[104:107], v[76:79]
    v_mfma_f32_16x16x32_bf16 v[80:83], a[184:187], v[104:107], v[80:83]
    v_mfma_f32_16x16x32_bf16 v[84:87], a[248:251], v[104:107], v[84:87]
    s_waitcnt lgkmcnt(0)
    v_mfma_f32_16x16x32_bf16 v[72:75], a[60:63], v[96:99], v[72:75]
    v_mfma_f32_16x16x32_bf16 v[76:79], a[124:127], v[96:99], v[76:79]
    v_mfma_f32_16x16x32_bf16 v[80:83], a[188:191], v[96:99], v[80:83]
    v_mfma_f32_16x16x32_bf16 v[84:87], a[252:255], v[96:99], v[84:87]
    s_nop 7
    v_cvt_pk_bf16_f32 v108, v72, v73
    v_cvt_pk_bf16_f32 v109, v74, v75
    v_cvt_pk_bf16_f32 v110, v76, v77
    v_cvt_pk_bf16_f32 v111, v78, v79
    v_cvt_pk_bf16_f32 v112, v80, v81
    v_cvt_pk_bf16_f32 v113, v82, v83
    v_cvt_pk_bf16_f32 v114, v84, v85
    v_cvt_pk_bf16_f32 v115, v86, v87
    ds_write_b128 v3, v[108:111]
    ds_write_b128 v3, v[112:115] offset:4096
    s_lshl_b32 s23, s17, 5
    s_add_u32 s23, s23, s3
    s_lshl_b32 s19, s23, 12
    s_lshl_b32 s22, s16, 10
    s_add_u32 s19, s19, s22
    s_add_u32 s19, s19, 100663296
    buffer_store_dwordx4 v[112:115], v1, s[8:11], s19 offen sc1
    s_waitcnt lgkmcnt(0)
    s_barrier
    ds_read_b128 v[72:75], v15 offset:4096
    ds_read_b128 v[76:79], v15 offset:0
    ds_read_b128 v[96:99], v2 offset:0
    ds_read_b128 v[80:83], v15 offset:5120
    ds_read_b128 v[84:87], v15 offset:1024
    ds_read_b128 v[100:103], v2 offset:1024
    ds_read_b128 v[104:107], v2 offset:2048
    s_waitcnt lgkmcnt(5)
    v_mfma_f32_16x16x32_bf16 v[112:115], v[72:75], v[76:79], v[16:19]
    v_mfma_f32_16x16x32_bf16 v[116:119], v[32:35], v[76:79], 0
    v_mfma_f32_16x16x32_bf16 v[120:123], v[36:39], v[76:79], 0
    ds_read_b128 v[72:75], v15 offset:6144
    ds_read_b128 v[76:79], v15 offset:2048
    s_waitcnt lgkmcnt(4)
    v_mfma_f32_16x16x32_bf16 v[112:115], v[80:83], v[84:87], v[112:115]
    v_mfma_f32_16x16x32_bf16 v[116:119], v[40:43], v[84:87], v[116:119]
    v_mfma_f32_16x16x32_bf16 v[120:123], v[44:47], v[84:87], v[120:123]
    ds_read_b128 v[80:83], v15 offset:7168
    ds_read_b128 v[84:87], v15 offset:3072
    s_waitcnt lgkmcnt(2)
    v_mfma_f32_16x16x32_bf16 v[112:115], v[72:75], v[76:79], v[112:115]
    v_mfma_f32_16x16x32_bf16 v[116:119], v[48:51], v[76:79], v[116:119]
    v_mfma_f32_16x16x32_bf16 v[120:123], v[52:55], v[76:79], v[120:123]
    s_waitcnt lgkmcnt(0)
    v_mfma_f32_16x16x32_bf16 v[112:115], v[80:83], v[84:87], v[112:115]
    v_mfma_f32_16x16x32_bf16 v[116:119], v[56:59], v[84:87], v[116:119]
    v_mfma_f32_16x16x32_bf16 v[120:123], v[60:63], v[84:87], v[120:123]
    ds_read_b128 v[32:35], v4 offset:0
    ds_read_b128 v[36:39], v4 offset:16384
    ds_read_b128 v[40:43], v4 offset:1024
    ds_read_b128 v[44:47], v4 offset:17408
    ds_read_b128 v[48:51], v4 offset:2048
    ds_read_b128 v[52:55], v4 offset:18432
    s_nop 3
    v_max3_f32 v124, v112, v113, v114
    v_max3_f32 v125, v115, v116, v117
    v_max3_f32 v126, v118, v119, v120
    v_max3_f32 v127, v121, v122, v123
    v_max3_f32 v124, v124, v125, v126
    v_max_f32 v124, v124, v127
    s_waitcnt lgkmcnt(4)
    v_mfma_f32_16x16x32_bf16 v[88:91], v[96:99], v[32:35], 0
    v_mfma_f32_16x16x32_bf16 v[92:95], v[96:99], v[36:39], 0
    ds_read_b128 v[96:99], v2 offset:3072
    ds_read_b128 v[32:35], v4 offset:3072
    ds_read_b128 v[36:39], v4 offset:19456
    v_mov_b32 v125, v124
    s_nop 1
    v_permlane16_swap_b32 v124, v125
    s_nop 0
    v_max_f32 v124, v124, v125
    s_waitcnt lgkmcnt(5)
    v_mfma_f32_16x16x32_bf16 v[88:91], v[100:103], v[40:43], v[88:91]
    v_mfma_f32_16x16x32_bf16 v[92:95], v[100:103], v[44:47], v[92:95]
    ds_read_b128 v[100:103], v2 offset:4096
    ds_read_b128 v[40:43], v4 offset:4096
    ds_read_b128 v[44:47], v4 offset:20480
    v_mov_b32 v125, v124
    s_nop 1
    v_permlane32_swap_b32 v124, v125
    s_nop 0
    v_max_f32 v124, v124, v125
    s_waitcnt lgkmcnt(6)
    v_mfma_f32_16x16x32_bf16 v[88:91], v[104:107], v[48:51], v[88:91]
    v_mfma_f32_16x16x32_bf16 v[92:95], v[104:107], v[52:55], v[92:95]
    ds_read_b128 v[104:107], v2 offset:5120
    ds_read_b128 v[48:51], v4 offset:5120
    ds_read_b128 v[52:55], v4 offset:21504
    v_mul_f32 v124, s21, v124
    s_waitcnt lgkmcnt(8)
    s_waitcnt lgkmcnt(6)
    v_mfma_f32_16x16x32_bf16 v[88:91], v[96:99], v[32:35], v[88:91]
    v_mfma_f32_16x16x32_bf16 v[92:95], v[96:99], v[36:39], v[92:95]
    ds_read_b128 v[96:99], v2 offset:6144
    ds_read_b128 v[32:35], v4 offset:6144
    ds_read_b128 v[36:39], v4 offset:22528
    v_fma_f32 v112, v112, s21, -v124
    v_fma_f32 v113, v113, s21, -v124
    v_fma_f32 v114, v114, s21, -v124
    v_fma_f32 v115, v115, s21, -v124
    s_waitcnt lgkmcnt(8)
    s_waitcnt lgkmcnt(6)
    v_mfma_f32_16x16x32_bf16 v[88:91], v[100:103], v[40:43], v[88:91]
    v_mfma_f32_16x16x32_bf16 v[92:95], v[100:103], v[44:47], v[92:95]
    ds_read_b128 v[100:103], v2 offset:7168
    ds_read_b128 v[40:43], v4 offset:7168
    ds_read_b128 v[44:47], v4 offset:23552
    v_fma_f32 v116, v116, s21, -v124
    v_fma_f32 v117, v117, s21, -v124
    v_fma_f32 v118, v118, s21, -v124
    v_fma_f32 v119, v119, s21, -v124
    s_waitcnt lgkmcnt(8)
    s_waitcnt lgkmcnt(6)
    v_mfma_f32_16x16x32_bf16 v[88:91], v[104:107], v[48:51], v[88:91]
    v_mfma_f32_16x16x32_bf16 v[92:95], v[104:107], v[52:55], v[92:95]
    ds_read_b128 v[104:107], v2 offset:8192
    ds_read_b128 v[48:51], v4 offset:8192
    ds_read_b128 v[52:55], v4 offset:24576
    v_fma_f32 v120, v120, s21, -v124
    v_fma_f32 v121, v121, s21, -v124
    v_fma_f32 v122, v122, s21, -v124
    v_fma_f32 v123, v123, s21, -v124
    s_waitcnt lgkmcnt(8)
    s_waitcnt lgkmcnt(6)
    v_mfma_f32_16x16x32_bf16 v[88:91], v[96:99], v[32:35], v[88:91]
    v_mfma_f32_16x16x32_bf16 v[92:95], v[96:99], v[36:39], v[92:95]
    ds_read_b128 v[96:99], v2 offset:9216
    ds_read_b128 v[32:35], v4 offset:9216
    ds_read_b128 v[36:39], v4 offset:25600
    v_exp_f32 v112, v112
    v_exp_f32 v113, v113
    v_exp_f32 v114, v114
    s_waitcnt lgkmcnt(8)
    s_waitcnt lgkmcnt(6)
    v_mfma_f32_16x16x32_bf16 v[88:91], v[100:103], v[40:43], v[88:91]
    v_mfma_f32_16x16x32_bf16 v[92:95], v[100:103], v[44:47], v[92:95]
    ds_read_b128 v[100:103], v2 offset:10240
    ds_read_b128 v[40:43], v4 offset:10240
    ds_read_b128 v[44:47], v4 offset:26624
    v_exp_f32 v115, v115
    v_exp_f32 v116, v116
    v_exp_f32 v117, v117
    s_waitcnt lgkmcnt(8)
    s_waitcnt lgkmcnt(6)
    v_mfma_f32_16x16x32_bf16 v[88:91], v[104:107], v[48:51], v[88:91]
    v_mfma_f32_16x16x32_bf16 v[92:95], v[104:107], v[52:55], v[92:95]
    ds_read_b128 v[104:107], v2 offset:11264
    ds_read_b128 v[48:51], v4 offset:11264
    ds_read_b128 v[52:55], v4 offset:27648
    v_exp_f32 v118, v118
    v_exp_f32 v119, v119
    v_exp_f32 v120, v120
    s_waitcnt lgkmcnt(8)
    s_waitcnt lgkmcnt(6)
    v_mfma_f32_16x16x32_bf16 v[88:91], v[96:99], v[32:35], v[88:91]
    v_mfma_f32_16x16x32_bf16 v[92:95], v[96:99], v[36:39], v[92:95]
    ds_read_b128 v[96:99], v2 offset:12288
    ds_read_b128 v[32:35], v4 offset:12288
    ds_read_b128 v[36:39], v4 offset:28672
    v_exp_f32 v121, v121
    v_exp_f32 v122, v122
    v_exp_f32 v123, v123
    s_waitcnt lgkmcnt(8)
    s_waitcnt lgkmcnt(6)
    v_mfma_f32_16x16x32_bf16 v[88:91], v[100:103], v[40:43], v[88:91]
    v_mfma_f32_16x16x32_bf16 v[92:95], v[100:103], v[44:47], v[92:95]
    ds_read_b128 v[100:103], v2 offset:13312
    ds_read_b128 v[40:43], v4 offset:13312
    ds_read_b128 v[44:47], v4 offset:29696
    s_nop 0
    v_add_f32 v125, v112, v113
    v_add_f32 v126, v114, v115
    v_add_f32 v127, v116, v117
    v_add_f32 v108, v118, v119
    v_add_f32 v109, v120, v121
    v_add_f32 v110, v122, v123
    s_waitcnt lgkmcnt(8)
    s_waitcnt lgkmcnt(6)
    v_mfma_f32_16x16x32_bf16 v[88:91], v[104:107], v[48:51], v[88:91]
    v_mfma_f32_16x16x32_bf16 v[92:95], v[104:107], v[52:55], v[92:95]
    ds_read_b128 v[104:107], v2 offset:14336
    ds_read_b128 v[48:51], v4 offset:14336
    ds_read_b128 v[52:55], v4 offset:30720
    v_add_f32 v125, v125, v126
    v_add_f32 v127, v127, v108
    v_add_f32 v109, v109, v110
    v_add_f32 v125, v125, v127
    v_add_f32 v125, v125, v109
    s_waitcnt lgkmcnt(8)
    s_waitcnt lgkmcnt(6)
    v_mfma_f32_16x16x32_bf16 v[88:91], v[96:99], v[32:35], v[88:91]
    v_mfma_f32_16x16x32_bf16 v[92:95], v[96:99], v[36:39], v[92:95]
    ds_read_b128 v[96:99], v2 offset:15360
    ds_read_b128 v[32:35], v4 offset:15360
    ds_read_b128 v[36:39], v4 offset:31744
    v_mov_b32 v126, v125
    s_nop 1
    v_permlane16_swap_b32 v125, v126
    s_nop 0
    v_add_f32 v125, v125, v126
    s_waitcnt lgkmcnt(8)
    s_waitcnt lgkmcnt(6)
    v_mfma_f32_16x16x32_bf16 v[88:91], v[100:103], v[40:43], v[88:91]
    v_mfma_f32_16x16x32_bf16 v[92:95], v[100:103], v[44:47], v[92:95]
    v_mov_b32 v126, v125
    s_nop 1
    v_permlane32_swap_b32 v125, v126
    s_nop 0
    v_add_f32 v125, v125, v126
    s_waitcnt lgkmcnt(5)
    s_waitcnt lgkmcnt(3)
    v_mfma_f32_16x16x32_bf16 v[88:91], v[104:107], v[48:51], v[88:91]
    v_mfma_f32_16x16x32_bf16 v[92:95], v[104:107], v[52:55], v[92:95]
    v_rcp_f32 v125, v125
    s_nop 0
    s_waitcnt lgkmcnt(2)
    s_waitcnt lgkmcnt(0)
    v_mfma_f32_16x16x32_bf16 v[88:91], v[96:99], v[32:35], v[88:91]
    v_mfma_f32_16x16x32_bf16 v[92:95], v[96:99], v[36:39], v[92:95]
    v_mul_f32 v112, v125, v112
    v_mul_f32 v113, v125, v113
    v_mul_f32 v114, v125, v114
    v_mul_f32 v115, v125, v115
    v_mul_f32 v116, v125, v116
    v_mul_f32 v117, v125, v117
    v_mul_f32 v118, v125, v118
    v_mul_f32 v119, v125, v119
    v_mul_f32 v120, v125, v120
    v_mul_f32 v121, v125, v121
    v_mul_f32 v122, v125, v122
    v_mul_f32 v123, v125, v123
    v_cvt_pk_bf16_f32 v28, v112, v113
    v_cvt_pk_bf16_f32 v29, v114, v115
    v_cvt_pk_bf16_f32 v108, v116, v117
    v_cvt_pk_bf16_f32 v109, v118, v119
    v_cvt_pk_bf16_f32 v110, v120, v121
    v_cvt_pk_bf16_f32 v111, v122, v123
    s_add_u32 s23, s17, 1
    s_lshl_b32 s23, s23, 5
    s_add_u32 s23, s23, s3
    s_lshl_b32 s23, s23, 13
    s_add_u32 s19, s23, 50331648
    s_add_u32 s22, s19, 4096
    s_cmp_eq_u32 s17, 63
    s_cbranch_scc1 L_chain_nopf_30
    s_add_u32 s24, s17, 1
    s_and_b32 s25, s24, 3
    s_cmp_lg_u32 s25, 0
    s_cbranch_scc1 L_chain_t1skip_31
    s_lshr_b32 s25, s24, 2
    s_lshl_b32 s25, s25, 6
    s_lshr_b32 s26, s3, 1
    s_lshl_b32 s26, s26, 2
    s_add_u32 s25, s25, s26
    s_add_u32 s25, s25, 19415296
    v_mov_b32 v124, 0
L_chain_t1wait_32:
    s_sub_u32 s29, s29, 1
    s_cbranch_scc1 L_chain_bail_23
    buffer_load_dword v125, v124, s[8:11], s25 offen sc1
    s_waitcnt vmcnt(0)
    v_cmp_eq_u32 vcc, 0, v125
    s_cbranch_vccnz L_chain_t1wait_32
L_chain_t1skip_31:
    buffer_load_dwordx4 v[32:35], v1, s[8:11], s19 offen offset:0 sc1
    buffer_load_dwordx4 v[36:39], v1, s[8:11], s19 offen offset:1024 sc1
    buffer_load_dwordx4 v[40:43], v1, s[8:11], s19 offen offset:2048 sc1
    buffer_load_dwordx4 v[44:47], v1, s[8:11], s19 offen offset:3072 sc1
    buffer_load_dwordx4 v[48:51], v1, s[8:11], s22 offen offset:0 sc1
    buffer_load_dwordx4 v[52:55], v1, s[8:11], s22 offen offset:1024 sc1
    buffer_load_dwordx4 v[56:59], v1, s[8:11], s22 offen offset:2048 sc1
    buffer_load_dwordx4 v[60:63], v1, s[8:11], s22 offen offset:3072 sc1
L_chain_nopf_30:
    s_nop 7
    v_cvt_pk_bf16_f32 v20, v88, v89
    v_cvt_pk_bf16_f32 v21, v90, v91
    v_cvt_pk_bf16_f32 v24, v92, v93
    v_cvt_pk_bf16_f32 v25, v94, v95
    s_lshl_b32 s22, s17, 5
    s_add_u32 s22, s22, s3
    s_lshl_b32 s19, s22, 13
    s_lshl_b32 s22, s16, 11
    s_add_u32 s19, s19, s22
    s_add_u32 s19, s19, 109051904
    buffer_store_dwordx4 v[20:23], v1, s[8:11], s19 offen sc1
    buffer_store_dwordx4 v[24:27], v1, s[8:11], s19 offen offset:1024 sc1
    s_cmp_eq_u32 s17, 63
    s_cbranch_scc1 L_chain_end_21
    v_mfma_f32_16x16x32_bf16 v[72:75], v[64:67], v[108:111], 0
    v_mfma_f32_16x16x32_bf16 v[76:79], v[68:71], v[108:111], 0
    v_mfma_f32_16x16x32_bf16 v[72:75], v[20:23], v[28:31], v[72:75]
    v_mfma_f32_16x16x32_bf16 v[76:79], v[24:27], v[28:31], v[76:79]
    s_lshl_b32 s19, s16, 11
    s_add_u32 s19, s19, s23
    s_add_u32 s19, s19, 67108864
    buffer_load_dwordx4 v[64:67], v1, s[8:11], s19 offen offset:0 sc1
    buffer_load_dwordx4 v[68:71], v1, s[8:11], s19 offen offset:1024 sc1
    s_nop 5
    v_cvt_pk_bf16_f32 v92, v72, v73
    v_cvt_pk_bf16_f32 v93, v74, v75
    v_cvt_pk_bf16_f32 v94, v76, v77
    v_cvt_pk_bf16_f32 v95, v78, v79
    ds_write_b128 v3, v[92:95] offset:8192
    s_waitcnt lgkmcnt(0)
    s_barrier
    ds_read_b128 v[96:99], v15 offset:8192
    ds_read_b128 v[100:103], v15 offset:9216
    ds_read_b128 v[104:107], v15 offset:10240
    ds_read_b128 v[108:111], v15 offset:11264
    s_waitcnt lgkmcnt(0)
    v_mfma_f32_16x16x32_bf16 v[112:115], v[128:131], v[96:99], 0
    v_mfma_f32_16x16x32_bf16 v[116:119], v[144:147], v[96:99], 0
    v_mfma_f32_16x16x32_bf16 v[120:123], v[160:163], v[96:99], 0
    v_mfma_f32_16x16x32_bf16 v[124:127], v[176:179], v[96:99], 0
    v_mfma_f32_16x16x32_bf16 v[112:115], v[132:135], v[100:103], v[112:115]
    v_mfma_f32_16x16x32_bf16 v[116:119], v[148:151], v[100:103], v[116:119]
    v_mfma_f32_16x16x32_bf16 v[120:123], v[164:167], v[100:103], v[120:123]
    v_mfma_f32_16x16x32_bf16 v[124:127], v[180:183], v[100:103], v[124:127]
    v_mfma_f32_16x16x32_bf16 v[112:115], v[136:139], v[104:107], v[112:115]
    v_mfma_f32_16x16x32_bf16 v[116:119], v[152:155], v[104:107], v[116:119]
    v_mfma_f32_16x16x32_bf16 v[120:123], v[168:171], v[104:107], v[120:123]
    v_mfma_f32_16x16x32_bf16 v[124:127], v[184:187], v[104:107], v[124:127]
    v_mfma_f32_16x16x32_bf16 v[112:115], v[140:143], v[108:111], v[112:115]
    v_mfma_f32_16x16x32_bf16 v[116:119], v[156:159], v[108:111], v[116:119]
    v_mfma_f32_16x16x32_bf16 v[120:123], v[172:175], v[108:111], v[120:123]
    v_mfma_f32_16x16x32_bf16 v[124:127], v[188:191], v[108:111], v[124:127]
    s_nop 7
    v_and_or_b32 v112, v112, -4, v11
    v_and_or_b32 v113, v113, -4, v11
    v_and_or_b32 v114, v114, -4, v11
    v_and_or_b32 v115, v115, -4, v11
    s_mov_b32 s19, 0
    s_cmp_eq_u32 s28, 1
    s_cbranch_scc1 L_chain_plain_33
    buffer_store_dwordx4 v[112:115], v7, s[8:11], s19 offen sc1
    s_branch L_chain_sdone_34
L_chain_plain_33:
    buffer_store_dwordx4 v[112:115], v7, s[8:11], s19 offen
L_chain_sdone_34:
    v_and_or_b32 v116, v116, -4, v11
    v_and_or_b32 v117, v117, -4, v11
    v_and_or_b32 v118, v118, -4, v11
    v_and_or_b32 v119, v119, -4, v11
    s_mov_b32 s19, 16384
    s_cmp_eq_u32 s28, 1
    s_cbranch_scc1 L_chain_plain_35
    buffer_store_dwordx4 v[116:119], v7, s[8:11], s19 offen sc1
    s_branch L_chain_sdone_36
L_chain_plain_35:
    buffer_store_dwordx4 v[116:119], v7, s[8:11], s19 offen
L_chain_sdone_36:
    v_and_or_b32 v120, v120, -4, v11
    v_and_or_b32 v121, v121, -4, v11
    v_and_or_b32 v122, v122, -4, v11
    v_and_or_b32 v123, v123, -4, v11
    s_mov_b32 s19, 32768
    s_cmp_eq_u32 s28, 1
    s_cbranch_scc1 L_chain_plain_37
    buffer_store_dwordx4 v[120:123], v7, s[8:11], s19 offen sc1
    s_branch L_chain_sdone_38
L_chain_plain_37:
    buffer_store_dwordx4 v[120:123], v7, s[8:11], s19 offen
L_chain_sdone_38:
    v_and_or_b32 v124, v124, -4, v11
    v_and_or_b32 v125, v125, -4, v11
    v_and_or_b32 v126, v126, -4, v11
    v_and_or_b32 v127, v127, -4, v11
    s_mov_b32 s19, 49152
    s_cmp_eq_u32 s28, 1
    s_cbranch_scc1 L_chain_plain_39
    buffer_store_dwordx4 v[124:127], v7, s[8:11], s19 offen sc1
    s_branch L_chain_sdone_40
L_chain_plain_39:
    buffer_store_dwordx4 v[124:127], v7, s[8:11], s19 offen
L_chain_sdone_40:
    s_nop 1
    v_mfma_f32_16x16x32_bf16 v[112:115], v[192:195], v[96:99], 0
    v_mfma_f32_16x16x32_bf16 v[116:119], v[208:211], v[96:99], 0
    v_mfma_f32_16x16x32_bf16 v[120:123], v[224:227], v[96:99], 0
    v_mfma_f32_16x16x32_bf16 v[124:127], v[240:243], v[96:99], 0
    v_mfma_f32_16x16x32_bf16 v[112:115], v[196:199], v[100:103], v[112:115]
    v_mfma_f32_16x16x32_bf16 v[116:119], v[212:215], v[100:103], v[116:119]
    v_mfma_f32_16x16x32_bf16 v[120:123], v[228:231], v[100:103], v[120:123]
    v_mfma_f32_16x16x32_bf16 v[124:127], v[244:247], v[100:103], v[124:127]
    v_mfma_f32_16x16x32_bf16 v[112:115], v[200:203], v[104:107], v[112:115]
    v_mfma_f32_16x16x32_bf16 v[116:119], v[216:219], v[104:107], v[116:119]
    v_mfma_f32_16x16x32_bf16 v[120:123], v[232:235], v[104:107], v[120:123]
    v_mfma_f32_16x16x32_bf16 v[124:127], v[248:251], v[104:107], v[124:127]
    v_mfma_f32_16x16x32_bf16 v[112:115], v[204:207], v[108:111], v[112:115]
    v_mfma_f32_16x16x32_bf16 v[116:119], v[220:223], v[108:111], v[116:119]
    v_mfma_f32_16x16x32_bf16 v[120:123], v[236:239], v[108:111], v[120:123]
    v_mfma_f32_16x16x32_bf16 v[124:127], v[252:255], v[108:111], v[124:127]
    s_nop 7
    v_and_or_b32 v112, v112, -4, v11
    v_and_or_b32 v113, v113, -4, v11
    v_and_or_b32 v114, v114, -4, v11
    v_and_or_b32 v115, v115, -4, v11
    s_mov_b32 s19, 65536
    s_cmp_eq_u32 s28, 1
    s_cbranch_scc1 L_chain_plain_41
    buffer_store_dwordx4 v[112:115], v7, s[8:11], s19 offen sc1
    s_branch L_chain_sdone_42
L_chain_plain_41:
    buffer_store_dwordx4 v[112:115], v7, s[8:11], s19 offen
L_chain_sdone_42:
    v_and_or_b32 v116, v116, -4, v11
    v_and_or_b32 v117, v117, -4, v11
    v_and_or_b32 v118, v118, -4, v11
    v_and_or_b32 v119, v119, -4, v11
    s_mov_b32 s19, 81920
    s_cmp_eq_u32 s28, 1
    s_cbranch_scc1 L_chain_plain_43
    buffer_store_dwordx4 v[116:119], v7, s[8:11], s19 offen sc1
    s_branch L_chain_sdone_44
L_chain_plain_43:
    buffer_store_dwordx4 v[116:119], v7, s[8:11], s19 offen
L_chain_sdone_44:
    v_and_or_b32 v120, v120, -4, v11
    v_and_or_b32 v121, v121, -4, v11
    v_and_or_b32 v122, v122, -4, v11
    v_and_or_b32 v123, v123, -4, v11
    s_mov_b32 s19, 98304
    s_cmp_eq_u32 s28, 1
    s_cbranch_scc1 L_chain_plain_45
    buffer_store_dwordx4 v[120:123], v7, s[8:11], s19 offen sc1
    s_branch L_chain_sdone_46
L_chain_plain_45:
    buffer_store_dwordx4 v[120:123], v7, s[8:11], s19 offen
L_chain_sdone_46:
    s_nop 1
    v_and_or_b32 v124, v124, -4, v11
    v_and_or_b32 v125, v125, -4, v11
    v_and_or_b32 v126, v126, -4, v11
    v_and_or_b32 v127, v127, -4, v11
    s_mov_b32 s19, 114688
    s_cmp_eq_u32 s28, 1
    s_cbranch_scc1 L_chain_plain_47
    buffer_store_dwordx4 v[124:127], v7, s[8:11], s19 offen sc1
    s_branch L_chain_sdone_48
L_chain_plain_47:
    buffer_store_dwordx4 v[124:127], v7, s[8:11], s19 offen
L_chain_sdone_48:
L_chain_poll1_49:
    s_sub_u32 s29, s29, 1
    s_cbranch_scc1 L_chain_bail_23
    buffer_load_dwordx4 v[72:75], v8, s[8:11], s32 offen sc1
    buffer_load_dwordx4 v[76:79], v8, s[8:11], s33 offen sc1
    buffer_load_dwordx4 v[80:83], v8, s[8:11], s34 offen sc1
    buffer_load_dwordx4 v[84:87], v8, s[8:11], s35 offen sc1
    s_waitcnt vmcnt(0)
    v_xor_b32 v124, v72, v11
    v_xor_b32 v125, v73, v11
    v_xor_b32 v126, v74, v11
    v_or3_b32 v124, v124, v125, v126
    v_xor_b32 v125, v75, v11
    v_xor_b32 v126, v76, v11
    v_or3_b32 v124, v124, v125, v126
    v_xor_b32 v125, v77, v11
    v_xor_b32 v126, v78, v11
    v_or3_b32 v124, v124, v125, v126
    v_xor_b32 v125, v79, v11
    v_xor_b32 v126, v80, v11
    v_or3_b32 v124, v124, v125, v126
    v_xor_b32 v125, v81, v11
    v_xor_b32 v126, v82, v11
    v_or3_b32 v124, v124, v125, v126
    v_xor_b32 v125, v83, v11
    v_xor_b32 v126, v84, v11
    v_or3_b32 v124, v124, v125, v126
    v_xor_b32 v125, v85, v11
    v_xor_b32 v126, v86, v11
    v_or3_b32 v124, v124, v125, v126
    v_xor_b32 v125, v87, v11
    v_or_b32 v124, v124, v125
    v_and_b32 v124, 3, v124
    v_cmp_ne_u32 vcc, 0, v124
    s_cbranch_vccnz L_chain_poll1_49
    v_add_f32 v88, v72, v76
    v_add_f32 v92, v80, v84
    v_add_f32 v89, v73, v77
    v_add_f32 v93, v81, v85
    v_add_f32 v90, v74, v78
    v_add_f32 v94, v82, v86
    v_add_f32 v91, v75, v79
    v_add_f32 v95, v83, v87
    v_add_f32 v88, v88, v92
    v_add_f32 v89, v89, v93
    v_add_f32 v90, v90, v94
    v_add_f32 v91, v91, v95
    s_nop 1
    v_add_f32_dpp v88, v88, v88 row_ror:8 row_mask:0xf bank_mask:0xf
    v_add_f32_dpp v89, v89, v89 row_ror:8 row_mask:0xf bank_mask:0xf
    v_add_f32_dpp v90, v90, v90 row_ror:8 row_mask:0xf bank_mask:0xf
    v_add_f32_dpp v91, v91, v91 row_ror:8 row_mask:0xf bank_mask:0xf
    v_mov_b32 v92, v88
    v_mov_b32 v93, v89
    v_mov_b32 v94, v90
    v_mov_b32 v95, v91
    s_nop 0
    v_permlane16_swap_b32 v88, v92
    v_permlane16_swap_b32 v89, v93
    v_permlane16_swap_b32 v90, v94
    v_permlane16_swap_b32 v91, v95
    s_nop 0
    v_add_f32 v88, v88, v92
    v_add_f32 v89, v89, v93
    v_add_f32 v90, v90, v94
    v_add_f32 v91, v91, v95
    v_mov_b32 v92, v88
    v_mov_b32 v93, v89
    v_mov_b32 v94, v90
    v_mov_b32 v95, v91
    s_nop 0
    v_permlane32_swap_b32 v88, v92
    v_permlane32_swap_b32 v89, v93
    v_permlane32_swap_b32 v90, v94
    v_permlane32_swap_b32 v91, v95
    s_nop 0
    v_add_f32 v88, v88, v92
    v_add_f32 v89, v89, v93
    v_add_f32 v90, v90, v94
    v_add_f32 v91, v91, v95
    v_cvt_pk_bf16_f32 v92, v88, v89
    v_cvt_pk_bf16_f32 v93, v90, v91
    s_mov_b32 s19, 0xffff0000
    v_lshl_or_b32 v112, v92, 16, v11
    v_and_or_b32 v113, v92, s19, v11
    v_lshl_or_b32 v114, v93, 16, v11
    v_and_or_b32 v115, v93, s19, v11
    s_cmp_eq_u32 s28, 1
    s_cbranch_scc1 L_chain_plain_50
    buffer_store_dwordx4 v[112:115], v10, s[8:11], 0 offen sc1
    s_branch L_chain_sdone_51
L_chain_plain_50:
    buffer_store_dwordx4 v[112:115], v10, s[8:11], 0 offen
L_chain_sdone_51:
L_chain_pollm_52:
    s_sub_u32 s29, s29, 1
    s_cbranch_scc1 L_chain_bail_23
    buffer_load_dwordx4 v[72:75], v6, s[8:11], 0 offen offset:0 sc1
    buffer_load_dwordx4 v[76:79], v6, s[8:11], 0 offen offset:1024 sc1
    buffer_load_dwordx4 v[80:83], v6, s[8:11], 0 offen offset:2048 sc1
    buffer_load_dwordx4 v[84:87], v6, s[8:11], 0 offen offset:3072 sc1
    s_waitcnt vmcnt(0)
    v_xor_b32 v124, v72, v11
    v_xor_b32 v125, v73, v11
    v_xor_b32 v126, v74, v11
    v_or3_b32 v124, v124, v125, v126
    v_xor_b32 v125, v75, v11
    v_xor_b32 v126, v76, v11
    v_or3_b32 v124, v124, v125, v126
    v_xor_b32 v125, v77, v11
    v_xor_b32 v126, v78, v11
    v_or3_b32 v124, v124, v125, v126
    v_xor_b32 v125, v79, v11
    v_xor_b32 v126, v80, v11
    v_or3_b32 v124, v124, v125, v126
    v_xor_b32 v125, v81, v11
    v_xor_b32 v126, v82, v11
    v_or3_b32 v124, v124, v125, v126
    v_xor_b32 v125, v83, v11
    v_xor_b32 v126, v84, v11
    v_or3_b32 v124, v124, v125, v126
    v_xor_b32 v125, v85, v11
    v_xor_b32 v126, v86, v11
    v_or3_b32 v124, v124, v125, v126
    v_xor_b32 v125, v87, v11
    v_or_b32 v124, v124, v125
    v_and_b32 v124, 3, v124
    v_cmp_ne_u32 vcc, 0, v124
    s_cbranch_vccnz L_chain_pollm_52
    v_perm_b32 v88, v73, v72, s20
    v_perm_b32 v89, v75, v74, s20
    v_perm_b32 v90, v77, v76, s20
    v_perm_b32 v91, v79, v78, s20
    v_perm_b32 v92, v81, v80, s20
    v_perm_b32 v93, v83, v82, s20
    v_perm_b32 v94, v85, v84, s20
    v_perm_b32 v95, v87, v86, s20
    ds_write_b64 v5, v[88:89] offset:0
    ds_write_b64 v5, v[90:91] offset:1024
    ds_write_b64 v5, v[92:93] offset:2048
    ds_write_b64 v5, v[94:95] offset:3072
    s_waitcnt lgkmcnt(0)
    s_barrier
    s_add_u32 s17, s17, 1
    s_branch L_chain_step_29
L_chain_bail_23:
L_chain_end_21:
L_chain_exit_22:
    s_endpgm
L_mega_work_20:
    s_lshr_b32 s3, s2, 3
    s_sub_u32 s27, s2, s3
    s_sub_u32 s27, s27, 1
    s_mov_b32 s36, s27
L_mega_tloop_53:
    s_load_dwordx2 s[4:5], s[0:1], 112
    v_and_b32 v1, 63, v0
    v_lshrrev_b32 v2, 6, v0
    s_nop 0
    v_readfirstlane_b32 s16, v2
    v_lshrrev_b32 v2, 4, v1
    v_and_b32 v3, 15, v1
    s_lshr_b32 s3, s27, 4
    s_and_b32 s26, s27, 15
    s_waitcnt lgkmcnt(0)
    s_mov_b32 s8, s4
    s_and_b32 s9, s5, 0xffff
    s_mov_b32 s10, 268435456
    s_mov_b32 s11, 0x00020000
    v_lshlrev_b32 v7, 4, v1
    s_lshl_b32 s5, s3, 17
    s_lshl_b32 s19, s16, 10
    s_add_u32 s5, s5, s19
    s_add_u32 s5, s5, 27262976
    s_mul_i32 s19, s16, 1040
    v_add_u32 v4, s19, v7
    v_add_u32 v5, 66560, v4
    s_add_u32 s19, s5, 0
    buffer_load_dwordx4 v[16:19], v7, s[8:11], s19 offen
    s_add_u32 s19, s5, 4096
    buffer_load_dwordx4 v[20:23], v7, s[8:11], s19 offen
    s_add_u32 s19, s5, 8192
    buffer_load_dwordx4 v[24:27], v7, s[8:11], s19 offen
    s_add_u32 s19, s5, 12288
    buffer_load_dwordx4 v[28:31], v7, s[8:11], s19 offen
    s_add_u32 s19, s5, 16384
    buffer_load_dwordx4 v[32:35], v7, s[8:11], s19 offen
    s_add_u32 s19, s5, 20480
    buffer_load_dwordx4 v[36:39], v7, s[8:11], s19 offen
    s_add_u32 s19, s5, 24576
    buffer_load_dwordx4 v[40:43], v7, s[8:11], s19 offen
    s_add_u32 s19, s5, 28672
    buffer_load_dwordx4 v[44:47], v7, s[8:11], s19 offen
    s_waitcnt vmcnt(7)
    ds_write_b128 v4, v[16:19] offset:0
    s_waitcnt vmcnt(6)
    ds_write_b128 v4, v[20:23] offset:4160
    s_waitcnt vmcnt(5)
    ds_write_b128 v4, v[24:27] offset:8320
    s_waitcnt vmcnt(4)
    ds_write_b128 v4, v[28:31] offset:12480
    s_waitcnt vmcnt(3)
    ds_write_b128 v4, v[32:35] offset:16640
    s_waitcnt vmcnt(2)
    ds_write_b128 v4, v[36:39] offset:20800
    s_waitcnt vmcnt(1)
    ds_write_b128 v4, v[40:43] offset:24960
    s_waitcnt vmcnt(0)
    ds_write_b128 v4, v[44:47] offset:29120
    s_add_u32 s19, s5, 32768
    buffer_load_dwordx4 v[16:19], v7, s[8:11], s19 offen
    s_add_u32 s19, s5, 36864
    buffer_load_dwordx4 v[20:23], v7, s[8:11], s19 offen
    s_add_u32 s19, s5, 40960
    buffer_load_dwordx4 v[24:27], v7, s[8:11], s19 offen
    s_add_u32 s19, s5, 45056
    buffer_load_dwordx4 v[28:31], v7, s[8:11], s19 offen
    s_add_u32 s19, s5, 49152
    buffer_load_dwordx4 v[32:35], v7, s[8:11], s19 offen
    s_add_u32 s19, s5, 53248
    buffer_load_dwordx4 v[36:39], v7, s[8:11], s19 offen
    s_add_u32 s19, s5, 57344
    buffer_load_dwordx4 v[40:43], v7, s[8:11], s19 offen
    s_add_u32 s19, s5, 61440
    buffer_load_dwordx4 v[44:47], v7, s[8:11], s19 offen
    s_waitcnt vmcnt(7)
    ds_write_b128 v4, v[16:19] offset:33280
    s_waitcnt vmcnt(6)
    ds_write_b128 v4, v[20:23] offset:37440
    s_waitcnt vmcnt(5)
    ds_write_b128 v4, v[24:27] offset:41600
    s_waitcnt vmcnt(4)
    ds_write_b128 v4, v[28:31] offset:45760
    s_waitcnt vmcnt(3)
    ds_write_b128 v4, v[32:35] offset:49920
    s_waitcnt vmcnt(2)
    ds_write_b128 v4, v[36:39] offset:54080
    s_waitcnt vmcnt(1)
    ds_write_b128 v4, v[40:43] offset:58240
    s_waitcnt vmcnt(0)
    ds_write_b128 v4, v[44:47] offset:62400
    s_add_u32 s19, s5, 65536
    buffer_load_dwordx4 v[16:19], v7, s[8:11], s19 offen
    s_add_u32 s19, s5, 69632
    buffer_load_dwordx4 v[20:23], v7, s[8:11], s19 offen
    s_add_u32 s19, s5, 73728
    buffer_load_dwordx4 v[24:27], v7, s[8:11], s19 offen
    s_add_u32 s19, s5, 77824
    buffer_load_dwordx4 v[28:31], v7, s[8:11], s19 offen
    s_add_u32 s19, s5, 81920
    buffer_load_dwordx4 v[32:35], v7, s[8:11], s19 offen
    s_add_u32 s19, s5, 86016
    buffer_load_dwordx4 v[36:39], v7, s[8:11], s19 offen
    s_add_u32 s19, s5, 90112
    buffer_load_dwordx4 v[40:43], v7, s[8:11], s19 offen
    s_add_u32 s19, s5, 94208
    buffer_load_dwordx4 v[44:47], v7, s[8:11], s19 offen
    s_waitcnt vmcnt(7)
    ds_write_b128 v5, v[16:19] offset:0
    s_waitcnt vmcnt(6)
    ds_write_b128 v5, v[20:23] offset:4160
    s_waitcnt vmcnt(5)
    ds_write_b128 v5, v[24:27] offset:8320
    s_waitcnt vmcnt(4)
    ds_write_b128 v5, v[28:31] offset:12480
    s_waitcnt vmcnt(3)
    ds_write_b128 v5, v[32:35] offset:16640
    s_waitcnt vmcnt(2)
    ds_write_b128 v5, v[36:39] offset:20800
    s_waitcnt vmcnt(1)
    ds_write_b128 v5, v[40:43] offset:24960
    s_waitcnt vmcnt(0)
    ds_write_b128 v5, v[44:47] offset:29120
    s_add_u32 s19, s5, 98304
    buffer_load_dwordx4 v[16:19], v7, s[8:11], s19 offen
    s_add_u32 s19, s5, 102400
    buffer_load_dwordx4 v[20:23], v7, s[8:11], s19 offen
    s_add_u32 s19, s5, 106496
    buffer_load_dwordx4 v[24:27], v7, s[8:11], s19 offen
    s_add_u32 s19, s5, 110592
    buffer_load_dwordx4 v[28:31], v7, s[8:11], s19 offen
    s_add_u32 s19, s5, 114688
    buffer_load_dwordx4 v[32:35], v7, s[8:11], s19 offen
    s_add_u32 s19, s5, 118784
    buffer_load_dwordx4 v[36:39], v7, s[8:11], s19 offen
    s_add_u32 s19, s5, 122880
    buffer_load_dwordx4 v[40:43], v7, s[8:11], s19 offen
    s_add_u32 s19, s5, 126976
    buffer_load_dwordx4 v[44:47], v7, s[8:11], s19 offen
    s_waitcnt vmcnt(7)
    ds_write_b128 v5, v[16:19] offset:33280
    s_waitcnt vmcnt(6)
    ds_write_b128 v5, v[20:23] offset:37440
    s_waitcnt vmcnt(5)
    ds_write_b128 v5, v[24:27] offset:41600
    s_waitcnt vmcnt(4)
    ds_write_b128 v5, v[28:31] offset:45760
    s_waitcnt vmcnt(3)
    ds_write_b128 v5, v[32:35] offset:49920
    s_waitcnt vmcnt(2)
    ds_write_b128 v5, v[36:39] offset:54080
    s_waitcnt vmcnt(1)
    ds_write_b128 v5, v[40:43] offset:58240
    s_waitcnt vmcnt(0)
    ds_write_b128 v5, v[44:47] offset:62400
    v_mul_u32_u24 v8, 1040, v3
    v_lshl_add_u32 v8, v2, 4, v8
    v_add_u32 v9, 66560, v8
    s_waitcnt lgkmcnt(0)
    s_barrier
    s_lshl_b32 s6, s26, 1
    s_add_u32 s6, s6, 0
    s_lshl_b32 s22, s6, 17
    s_lshl_b32 s19, s16, 15
    s_add_u32 s22, s22, s19
    s_add_u32 s22, s22, 0
    s_add_u32 s19, s22, 0
    buffer_load_dwordx4 v[144:147], v7, s[8:11], s19 offen
    s_add_u32 s19, s22, 16384
    buffer_load_dwordx4 v[148:151], v7, s[8:11], s19 offen
    ds_read_b128 v[80:83], v8 offset:0
    ds_read_b128 v[84:87], v8 offset:16640
    ds_read_b128 v[88:91], v8 offset:33280
    ds_read_b128 v[92:95], v8 offset:49920
    ds_read_b128 v[96:99], v9 offset:0
    ds_read_b128 v[100:103], v9 offset:16640
    ds_read_b128 v[104:107], v9 offset:33280
    ds_read_b128 v[108:111], v9 offset:49920
    s_add_u32 s19, s22, 1024
    buffer_load_dwordx4 v[152:155], v7, s[8:11], s19 offen
    s_add_u32 s19, s22, 17408
    buffer_load_dwordx4 v[156:159], v7, s[8:11], s19 offen
    ds_read_b128 v[112:115], v8 offset:64
    ds_read_b128 v[116:119], v8 offset:16704
    ds_read_b128 v[120:123], v8 offset:33344
    ds_read_b128 v[124:127], v8 offset:49984
    ds_read_b128 v[128:131], v9 offset:64
    ds_read_b128 v[132:135], v9 offset:16704
    ds_read_b128 v[136:139], v9 offset:33344
    ds_read_b128 v[140:143], v9 offset:49984
    s_waitcnt vmcnt(2) lgkmcnt(8)
    v_mfma_f32_16x16x32_bf16 v[16:19], v[144:147], v[80:83], 0
    v_mfma_f32_16x16x32_bf16 v[48:51], v[148:151], v[80:83], 0
    v_mfma_f32_16x16x32_bf16 v[20:23], v[144:147], v[84:87], 0
    v_mfma_f32_16x16x32_bf16 v[52:55], v[148:151], v[84:87], 0
    v_mfma_f32_16x16x32_bf16 v[24:27], v[144:147], v[88:91], 0
    v_mfma_f32_16x16x32_bf16 v[56:59], v[148:151], v[88:91], 0
    v_mfma_f32_16x16x32_bf16 v[28:31], v[144:147], v[92:95], 0
    v_mfma_f32_16x16x32_bf16 v[60:63], v[148:151], v[92:95], 0
    v_mfma_f32_16x16x32_bf16 v[32:35], v[144:147], v[96:99], 0
    v_mfma_f32_16x16x32_bf16 v[64:67], v[148:151], v[96:99], 0
    v_mfma_f32_16x16x32_bf16 v[36:39], v[144:147], v[100:103], 0
    v_mfma_f32_16x16x32_bf16 v[68:71], v[148:151], v[100:103], 0
    v_mfma_f32_16x16x32_bf16 v[40:43], v[144:147], v[104:107], 0
    v_mfma_f32_16x16x32_bf16 v[72:75], v[148:151], v[104:107], 0
    v_mfma_f32_16x16x32_bf16 v[44:47], v[144:147], v[108:111], 0
    v_mfma_f32_16x16x32_bf16 v[76:79], v[148:151], v[108:111], 0
    s_add_u32 s19, s22, 2048
    buffer_load_dwordx4 v[144:147], v7, s[8:11], s19 offen
    s_add_u32 s19, s22, 18432
    buffer_load_dwordx4 v[148:151], v7, s[8:11], s19 offen
    ds_read_b128 v[80:83], v8 offset:128
    ds_read_b128 v[84:87], v8 offset:16768
    ds_read_b128 v[88:91], v8 offset:33408
    ds_read_b128 v[92:95], v8 offset:50048
    ds_read_b128 v[96:99], v9 offset:128
    ds_read_b128 v[100:103], v9 offset:16768
    ds_read_b128 v[104:107], v9 offset:33408
    ds_read_b128 v[108:111], v9 offset:50048
    s_waitcnt vmcnt(2) lgkmcnt(8)
    v_mfma_f32_16x16x32_bf16 v[16:19], v[152:155], v[112:115], v[16:19]
    v_mfma_f32_16x16x32_bf16 v[48:51], v[156:159], v[112:115], v[48:51]
    v_mfma_f32_16x16x32_bf16 v[20:23], v[152:155], v[116:119], v[20:23]
    v_mfma_f32_16x16x32_bf16 v[52:55], v[156:159], v[116:119], v[52:55]
    v_mfma_f32_16x16x32_bf16 v[24:27], v[152:155], v[120:123], v[24:27]
    v_mfma_f32_16x16x32_bf16 v[56:59], v[156:159], v[120:123], v[56:59]
    v_mfma_f32_16x16x32_bf16 v[28:31], v[152:155], v[124:127], v[28:31]
    v_mfma_f32_16x16x32_bf16 v[60:63], v[156:159], v[124:127], v[60:63]
    v_mfma_f32_16x16x32_bf16 v[32:35], v[152:155], v[128:131], v[32:35]
    v_mfma_f32_16x16x32_bf16 v[64:67], v[156:159], v[128:131], v[64:67]
    v_mfma_f32_16x16x32_bf16 v[36:39], v[152:155], v[132:135], v[36:39]
    v_mfma_f32_16x16x32_bf16 v[68:71], v[156:159], v[132:135], v[68:71]
    v_mfma_f32_16x16x32_bf16 v[40:43], v[152:155], v[136:139], v[40:43]
    v_mfma_f32_16x16x32_bf16 v[72:75], v[156:159], v[136:139], v[72:75]
    v_mfma_f32_16x16x32_bf16 v[44:47], v[152:155], v[140:143], v[44:47]
    v_mfma_f32_16x16x32_bf16 v[76:79], v[156:159], v[140:143], v[76:79]
    s_add_u32 s19, s22, 3072
    buffer_load_dwordx4 v[152:155], v7, s[8:11], s19 offen
    s_add_u32 s19, s22, 19456
    buffer_load_dwordx4 v[156:159], v7, s[8:11], s19 offen
    ds_read_b128 v[112:115], v8 offset:192
    ds_read_b128 v[116:119], v8 offset:16832
    ds_read_b128 v[120:123], v8 offset:33472
    ds_read_b128 v[124:127], v8 offset:50112
    ds_read_b128 v[128:131], v9 offset:192
    ds_read_b128 v[132:135], v9 offset:16832
    ds_read_b128 v[136:139], v9 offset:33472
    ds_read_b128 v[140:143], v9 offset:50112
    s_waitcnt vmcnt(2) lgkmcnt(8)
    v_mfma_f32_16x16x32_bf16 v[16:19], v[144:147], v[80:83], v[16:19]
    v_mfma_f32_16x16x32_bf16 v[48:51], v[148:151], v[80:83], v[48:51]
    v_mfma_f32_16x16x32_bf16 v[20:23], v[144:147], v[84:87], v[20:23]
    v_mfma_f32_16x16x32_bf16 v[52:55], v[148:151], v[84:87], v[52:55]
    v_mfma_f32_16x16x32_bf16 v[24:27], v[144:147], v[88:91], v[24:27]
    v_mfma_f32_16x16x32_bf16 v[56:59], v[148:151], v[88:91], v[56:59]
    v_mfma_f32_16x16x32_bf16 v[28:31], v[144:147], v[92:95], v[28:31]
    v_mfma_f32_16x16x32_bf16 v[60:63], v[148:151], v[92:95], v[60:63]
    v_mfma_f32_16x16x32_bf16 v[32:35], v[144:147], v[96:99], v[32:35]
    v_mfma_f32_16x16x32_bf16 v[64:67], v[148:151], v[96:99], v[64:67]
    v_mfma_f32_16x16x32_bf16 v[36:39], v[144:147], v[100:103], v[36:39]
    v_mfma_f32_16x16x32_bf16 v[68:71], v[148:151], v[100:103], v[68:71]
    v_mfma_f32_16x16x32_bf16 v[40:43], v[144:147], v[104:107], v[40:43]
    v_mfma_f32_16x16x32_bf16 v[72:75], v[148:151], v[104:107], v[72:75]
    v_mfma_f32_16x16x32_bf16 v[44:47], v[144:147], v[108:111], v[44:47]
    v_mfma_f32_16x16x32_bf16 v[76:79], v[148:151], v[108:111], v[76:79]
    s_add_u32 s19, s22, 4096
    buffer_load_dwordx4 v[144:147], v7, s[8:11], s19 offen
    s_add_u32 s19, s22, 20480
    buffer_load_dwordx4 v[148:151], v7, s[8:11], s19 offen
    ds_read_b128 v[80:83], v8 offset:256
    ds_read_b128 v[84:87], v8 offset:16896
    ds_read_b128 v[88:91], v8 offset:33536
    ds_read_b128 v[92:95], v8 offset:50176
    ds_read_b128 v[96:99], v9 offset:256
    ds_read_b128 v[100:103], v9 offset:16896
    ds_read_b128 v[104:107], v9 offset:33536
    ds_read_b128 v[108:111], v9 offset:50176
    s_waitcnt vmcnt(2) lgkmcnt(8)
    v_mfma_f32_16x16x32_bf16 v[16:19], v[152:155], v[112:115], v[16:19]
    v_mfma_f32_16x16x32_bf16 v[48:51], v[156:159], v[112:115], v[48:51]
    v_mfma_f32_16x16x32_bf16 v[20:23], v[152:155], v[116:119], v[20:23]
    v_mfma_f32_16x16x32_bf16 v[52:55], v[156:159], v[116:119], v[52:55]
    v_mfma_f32_16x16x32_bf16 v[24:27], v[152:155], v[120:123], v[24:27]
    v_mfma_f32_16x16x32_bf16 v[56:59], v[156:159], v[120:123], v[56:59]
    v_mfma_f32_16x16x32_bf16 v[28:31], v[152:155], v[124:127], v[28:31]
    v_mfma_f32_16x16x32_bf16 v[60:63], v[156:159], v[124:127], v[60:63]
    v_mfma_f32_16x16x32_bf16 v[32:35], v[152:155], v[128:131], v[32:35]
    v_mfma_f32_16x16x32_bf16 v[64:67], v[156:159], v[128:131], v[64:67]
    v_mfma_f32_16x16x32_bf16 v[36:39], v[152:155], v[132:135], v[36:39]
    v_mfma_f32_16x16x32_bf16 v[68:71], v[156:159], v[132:135], v[68:71]
    v_mfma_f32_16x16x32_bf16 v[40:43], v[152:155], v[136:139], v[40:43]
    v_mfma_f32_16x16x32_bf16 v[72:75], v[156:159], v[136:139], v[72:75]
    v_mfma_f32_16x16x32_bf16 v[44:47], v[152:155], v[140:143], v[44:47]
    v_mfma_f32_16x16x32_bf16 v[76:79], v[156:159], v[140:143], v[76:79]
    s_add_u32 s19, s22, 5120
    buffer_load_dwordx4 v[152:155], v7, s[8:11], s19 offen
    s_add_u32 s19, s22, 21504
    buffer_load_dwordx4 v[156:159], v7, s[8:11], s19 offen
    ds_read_b128 v[112:115], v8 offset:320
    ds_read_b128 v[116:119], v8 offset:16960
    ds_read_b128 v[120:123], v8 offset:33600
    ds_read_b128 v[124:127], v8 offset:50240
    ds_read_b128 v[128:131], v9 offset:320
    ds_read_b128 v[132:135], v9 offset:16960
    ds_read_b128 v[136:139], v9 offset:33600
    ds_read_b128 v[140:143], v9 offset:50240
    s_waitcnt vmcnt(2) lgkmcnt(8)
    v_mfma_f32_16x16x32_bf16 v[16:19], v[144:147], v[80:83], v[16:19]
    v_mfma_f32_16x16x32_bf16 v[48:51], v[148:151], v[80:83], v[48:51]
    v_mfma_f32_16x16x32_bf16 v[20:23], v[144:147], v[84:87], v[20:23]
    v_mfma_f32_16x16x32_bf16 v[52:55], v[148:151], v[84:87], v[52:55]
    v_mfma_f32_16x16x32_bf16 v[24:27], v[144:147], v[88:91], v[24:27]
    v_mfma_f32_16x16x32_bf16 v[56:59], v[148:151], v[88:91], v[56:59]
    v_mfma_f32_16x16x32_bf16 v[28:31], v[144:147], v[92:95], v[28:31]
    v_mfma_f32_16x16x32_bf16 v[60:63], v[148:151], v[92:95], v[60:63]
    v_mfma_f32_16x16x32_bf16 v[32:35], v[144:147], v[96:99], v[32:35]
    v_mfma_f32_16x16x32_bf16 v[64:67], v[148:151], v[96:99], v[64:67]
    v_mfma_f32_16x16x32_bf16 v[36:39], v[144:147], v[100:103], v[36:39]
    v_mfma_f32_16x16x32_bf16 v[68:71], v[148:151], v[100:103], v[68:71]
    v_mfma_f32_16x16x32_bf16 v[40:43], v[144:147], v[104:107], v[40:43]
    v_mfma_f32_16x16x32_bf16 v[72:75], v[148:151], v[104:107], v[72:75]
    v_mfma_f32_16x16x32_bf16 v[44:47], v[144:147], v[108:111], v[44:47]
    v_mfma_f32_16x16x32_bf16 v[76:79], v[148:151], v[108:111], v[76:79]
    s_add_u32 s19, s22, 6144
    buffer_load_dwordx4 v[144:147], v7, s[8:11], s19 offen
    s_add_u32 s19, s22, 22528
    buffer_load_dwordx4 v[148:151], v7, s[8:11], s19 offen
    ds_read_b128 v[80:83], v8 offset:384
    ds_read_b128 v[84:87], v8 offset:17024
    ds_read_b128 v[88:91], v8 offset:33664
    ds_read_b128 v[92:95], v8 offset:50304
    ds_read_b128 v[96:99], v9 offset:384
    ds_read_b128 v[100:103], v9 offset:17024
    ds_read_b128 v[104:107], v9 offset:33664
    ds_read_b128 v[108:111], v9 offset:50304
    s_waitcnt vmcnt(2) lgkmcnt(8)
    v_mfma_f32_16x16x32_bf16 v[16:19], v[152:155], v[112:115], v[16:19]
    v_mfma_f32_16x16x32_bf16 v[48:51], v[156:159], v[112:115], v[48:51]
    v_mfma_f32_16x16x32_bf16 v[20:23], v[152:155], v[116:119], v[20:23]
    v_mfma_f32_16x16x32_bf16 v[52:55], v[156:159], v[116:119], v[52:55]
    v_mfma_f32_16x16x32_bf16 v[24:27], v[152:155], v[120:123], v[24:27]
    v_mfma_f32_16x16x32_bf16 v[56:59], v[156:159], v[120:123], v[56:59]
    v_mfma_f32_16x16x32_bf16 v[28:31], v[152:155], v[124:127], v[28:31]
    v_mfma_f32_16x16x32_bf16 v[60:63], v[156:159], v[124:127], v[60:63]
    v_mfma_f32_16x16x32_bf16 v[32:35], v[152:155], v[128:131], v[32:35]
    v_mfma_f32_16x16x32_bf16 v[64:67], v[156:159], v[128:131], v[64:67]
    v_mfma_f32_16x16x32_bf16 v[36:39], v[152:155], v[132:135], v[36:39]
    v_mfma_f32_16x16x32_bf16 v[68:71], v[156:159], v[132:135], v[68:71]
    v_mfma_f32_16x16x32_bf16 v[40:43], v[152:155], v[136:139], v[40:43]
    v_mfma_f32_16x16x32_bf16 v[72:75], v[156:159], v[136:139], v[72:75]
    v_mfma_f32_16x16x32_bf16 v[44:47], v[152:155], v[140:143], v[44:47]
    v_mfma_f32_16x16x32_bf16 v[76:79], v[156:159], v[140:143], v[76:79]
    s_add_u32 s19, s22, 7168
    buffer_load_dwordx4 v[152:155], v7, s[8:11], s19 offen
    s_add_u32 s19, s22, 23552
    buffer_load_dwordx4 v[156:159], v7, s[8:11], s19 offen
    ds_read_b128 v[112:115], v8 offset:448
    ds_read_b128 v[116:119], v8 offset:17088
    ds_read_b128 v[120:123], v8 offset:33728
    ds_read_b128 v[124:127], v8 offset:50368
    ds_read_b128 v[128:131], v9 offset:448
    ds_read_b128 v[132:135], v9 offset:17088
    ds_read_b128 v[136:139], v9 offset:33728
    ds_read_b128 v[140:143], v9 offset:50368
    s_waitcnt vmcnt(2) lgkmcnt(8)
    v_mfma_f32_16x16x32_bf16 v[16:19], v[144:147], v[80:83], v[16:19]
    v_mfma_f32_16x16x32_bf16 v[48:51], v[148:151], v[80:83], v[48:51]
    v_mfma_f32_16x16x32_bf16 v[20:23], v[144:147], v[84:87], v[20:23]
    v_mfma_f32_16x16x32_bf16 v[52:55], v[148:151], v[84:87], v[52:55]
    v_mfma_f32_16x16x32_bf16 v[24:27], v[144:147], v[88:91], v[24:27]
    v_mfma_f32_16x16x32_bf16 v[56:59], v[148:151], v[88:91], v[56:59]
    v_mfma_f32_16x16x32_bf16 v[28:31], v[144:147], v[92:95], v[28:31]
    v_mfma_f32_16x16x32_bf16 v[60:63], v[148:151], v[92:95], v[60:63]
    v_mfma_f32_16x16x32_bf16 v[32:35], v[144:147], v[96:99], v[32:35]
    v_mfma_f32_16x16x32_bf16 v[64:67], v[148:151], v[96:99], v[64:67]
    v_mfma_f32_16x16x32_bf16 v[36:39], v[144:147], v[100:103], v[36:39]
    v_mfma_f32_16x16x32_bf16 v[68:71], v[148:151], v[100:103], v[68:71]
    v_mfma_f32_16x16x32_bf16 v[40:43], v[144:147], v[104:107], v[40:43]
    v_mfma_f32_16x16x32_bf16 v[72:75], v[148:151], v[104:107], v[72:75]
    v_mfma_f32_16x16x32_bf16 v[44:47], v[144:147], v[108:111], v[44:47]
    v_mfma_f32_16x16x32_bf16 v[76:79], v[148:151], v[108:111], v[76:79]
    s_add_u32 s19, s22, 8192
    buffer_load_dwordx4 v[144:147], v7, s[8:11], s19 offen
    s_add_u32 s19, s22, 24576
    buffer_load_dwordx4 v[148:151], v7, s[8:11], s19 offen
    ds_read_b128 v[80:83], v8 offset:512
    ds_read_b128 v[84:87], v8 offset:17152
    ds_read_b128 v[88:91], v8 offset:33792
    ds_read_b128 v[92:95], v8 offset:50432
    ds_read_b128 v[96:99], v9 offset:512
    ds_read_b128 v[100:103], v9 offset:17152
    ds_read_b128 v[104:107], v9 offset:33792
    ds_read_b128 v[108:111], v9 offset:50432
    s_waitcnt vmcnt(2) lgkmcnt(8)
    v_mfma_f32_16x16x32_bf16 v[16:19], v[152:155], v[112:115], v[16:19]
    v_mfma_f32_16x16x32_bf16 v[48:51], v[156:159], v[112:115], v[48:51]
    v_mfma_f32_16x16x32_bf16 v[20:23], v[152:155], v[116:119], v[20:23]
    v_mfma_f32_16x16x32_bf16 v[52:55], v[156:159], v[116:119], v[52:55]
    v_mfma_f32_16x16x32_bf16 v[24:27], v[152:155], v[120:123], v[24:27]
    v_mfma_f32_16x16x32_bf16 v[56:59], v[156:159], v[120:123], v[56:59]
    v_mfma_f32_16x16x32_bf16 v[28:31], v[152:155], v[124:127], v[28:31]
    v_mfma_f32_16x16x32_bf16 v[60:63], v[156:159], v[124:127], v[60:63]
    v_mfma_f32_16x16x32_bf16 v[32:35], v[152:155], v[128:131], v[32:35]
    v_mfma_f32_16x16x32_bf16 v[64:67], v[156:159], v[128:131], v[64:67]
    v_mfma_f32_16x16x32_bf16 v[36:39], v[152:155], v[132:135], v[36:39]
    v_mfma_f32_16x16x32_bf16 v[68:71], v[156:159], v[132:135], v[68:71]
    v_mfma_f32_16x16x32_bf16 v[40:43], v[152:155], v[136:139], v[40:43]
    v_mfma_f32_16x16x32_bf16 v[72:75], v[156:159], v[136:139], v[72:75]
    v_mfma_f32_16x16x32_bf16 v[44:47], v[152:155], v[140:143], v[44:47]
    v_mfma_f32_16x16x32_bf16 v[76:79], v[156:159], v[140:143], v[76:79]
    s_add_u32 s19, s22, 9216
    buffer_load_dwordx4 v[152:155], v7, s[8:11], s19 offen
    s_add_u32 s19, s22, 25600
    buffer_load_dwordx4 v[156:159], v7, s[8:11], s19 offen
    ds_read_b128 v[112:115], v8 offset:576
    ds_read_b128 v[116:119], v8 offset:17216
    ds_read_b128 v[120:123], v8 offset:33856
    ds_read_b128 v[124:127], v8 offset:50496
    ds_read_b128 v[128:131], v9 offset:576
    ds_read_b128 v[132:135], v9 offset:17216
    ds_read_b128 v[136:139], v9 offset:33856
    ds_read_b128 v[140:143], v9 offset:50496
    s_waitcnt vmcnt(2) lgkmcnt(8)
    v_mfma_f32_16x16x32_bf16 v[16:19], v[144:147], v[80:83], v[16:19]
    v_mfma_f32_16x16x32_bf16 v[48:51], v[148:151], v[80:83], v[48:51]
    v_mfma_f32_16x16x32_bf16 v[20:23], v[144:147], v[84:87], v[20:23]
    v_mfma_f32_16x16x32_bf16 v[52:55], v[148:151], v[84:87], v[52:55]
    v_mfma_f32_16x16x32_bf16 v[24:27], v[144:147], v[88:91], v[24:27]
    v_mfma_f32_16x16x32_bf16 v[56:59], v[148:151], v[88:91], v[56:59]
    v_mfma_f32_16x16x32_bf16 v[28:31], v[144:147], v[92:95], v[28:31]
    v_mfma_f32_16x16x32_bf16 v[60:63], v[148:151], v[92:95], v[60:63]
    v_mfma_f32_16x16x32_bf16 v[32:35], v[144:147], v[96:99], v[32:35]
    v_mfma_f32_16x16x32_bf16 v[64:67], v[148:151], v[96:99], v[64:67]
    v_mfma_f32_16x16x32_bf16 v[36:39], v[144:147], v[100:103], v[36:39]
    v_mfma_f32_16x16x32_bf16 v[68:71], v[148:151], v[100:103], v[68:71]
    v_mfma_f32_16x16x32_bf16 v[40:43], v[144:147], v[104:107], v[40:43]
    v_mfma_f32_16x16x32_bf16 v[72:75], v[148:151], v[104:107], v[72:75]
    v_mfma_f32_16x16x32_bf16 v[44:47], v[144:147], v[108:111], v[44:47]
    v_mfma_f32_16x16x32_bf16 v[76:79], v[148:151], v[108:111], v[76:79]
    s_add_u32 s19, s22, 10240
    buffer_load_dwordx4 v[144:147], v7, s[8:11], s19 offen
    s_add_u32 s19, s22, 26624
    buffer_load_dwordx4 v[148:151], v7, s[8:11], s19 offen
    ds_read_b128 v[80:83], v8 offset:640
    ds_read_b128 v[84:87], v8 offset:17280
    ds_read_b128 v[88:91], v8 offset:33920
    ds_read_b128 v[92:95], v8 offset:50560
    ds_read_b128 v[96:99], v9 offset:640
    ds_read_b128 v[100:103], v9 offset:17280
    ds_read_b128 v[104:107], v9 offset:33920
    ds_read_b128 v[108:111], v9 offset:50560
    s_waitcnt vmcnt(2) lgkmcnt(8)
    v_mfma_f32_16x16x32_bf16 v[16:19], v[152:155], v[112:115], v[16:19]
    v_mfma_f32_16x16x32_bf16 v[48:51], v[156:159], v[112:115], v[48:51]
    v_mfma_f32_16x16x32_bf16 v[20:23], v[152:155], v[116:119], v[20:23]
    v_mfma_f32_16x16x32_bf16 v[52:55], v[156:159], v[116:119], v[52:55]
    v_mfma_f32_16x16x32_bf16 v[24:27], v[152:155], v[120:123], v[24:27]
    v_mfma_f32_16x16x32_bf16 v[56:59], v[156:159], v[120:123], v[56:59]
    v_mfma_f32_16x16x32_bf16 v[28:31], v[152:155], v[124:127], v[28:31]
    v_mfma_f32_16x16x32_bf16 v[60:63], v[156:159], v[124:127], v[60:63]
    v_mfma_f32_16x16x32_bf16 v[32:35], v[152:155], v[128:131], v[32:35]
    v_mfma_f32_16x16x32_bf16 v[64:67], v[156:159], v[128:131], v[64:67]
    v_mfma_f32_16x16x32_bf16 v[36:39], v[152:155], v[132:135], v[36:39]
    v_mfma_f32_16x16x32_bf16 v[68:71], v[156:159], v[132:135], v[68:71]
    v_mfma_f32_16x16x32_bf16 v[40:43], v[152:155], v[136:139], v[40:43]
    v_mfma_f32_16x16x32_bf16 v[72:75], v[156:159], v[136:139], v[72:75]
    v_mfma_f32_16x16x32_bf16 v[44:47], v[152:155], v[140:143], v[44:47]
    v_mfma_f32_16x16x32_bf16 v[76:79], v[156:159], v[140:143], v[76:79]
    s_add_u32 s19, s22, 11264
    buffer_load_dwordx4 v[152:155], v7, s[8:11], s19 offen
    s_add_u32 s19, s22, 27648
    buffer_load_dwordx4 v[156:159], v7, s[8:11], s19 offen
    ds_read_b128 v[112:115], v8 offset:704
    ds_read_b128 v[116:119], v8 offset:17344
    ds_read_b128 v[120:123], v8 offset:33984
    ds_read_b128 v[124:127], v8 offset:50624
    ds_read_b128 v[128:131], v9 offset:704
    ds_read_b128 v[132:135], v9 offset:17344
    ds_read_b128 v[136:139], v9 offset:33984
    ds_read_b128 v[140:143], v9 offset:50624
    s_waitcnt vmcnt(2) lgkmcnt(8)
    v_mfma_f32_16x16x32_bf16 v[16:19], v[144:147], v[80:83], v[16:19]
    v_mfma_f32_16x16x32_bf16 v[48:51], v[148:151], v[80:83], v[48:51]
    v_mfma_f32_16x16x32_bf16 v[20:23], v[144:147], v[84:87], v[20:23]
    v_mfma_f32_16x16x32_bf16 v[52:55], v[148:151], v[84:87], v[52:55]
    v_mfma_f32_16x16x32_bf16 v[24:27], v[144:147], v[88:91], v[24:27]
    v_mfma_f32_16x16x32_bf16 v[56:59], v[148:151], v[88:91], v[56:59]
    v_mfma_f32_16x16x32_bf16 v[28:31], v[144:147], v[92:95], v[28:31]
    v_mfma_f32_16x16x32_bf16 v[60:63], v[148:151], v[92:95], v[60:63]
    v_mfma_f32_16x16x32_bf16 v[32:35], v[144:147], v[96:99], v[32:35]
    v_mfma_f32_16x16x32_bf16 v[64:67], v[148:151], v[96:99], v[64:67]
    v_mfma_f32_16x16x32_bf16 v[36:39], v[144:147], v[100:103], v[36:39]
    v_mfma_f32_16x16x32_bf16 v[68:71], v[148:151], v[100:103], v[68:71]
    v_mfma_f32_16x16x32_bf16 v[40:43], v[144:147], v[104:107], v[40:43]
    v_mfma_f32_16x16x32_bf16 v[72:75], v[148:151], v[104:107], v[72:75]
    v_mfma_f32_16x16x32_bf16 v[44:47], v[144:147], v[108:111], v[44:47]
    v_mfma_f32_16x16x32_bf16 v[76:79], v[148:151], v[108:111], v[76:79]
    s_add_u32 s19, s22, 12288
    buffer_load_dwordx4 v[144:147], v7, s[8:11], s19 offen
    s_add_u32 s19, s22, 28672
    buffer_load_dwordx4 v[148:151], v7, s[8:11], s19 offen
    ds_read_b128 v[80:83], v8 offset:768
    ds_read_b128 v[84:87], v8 offset:17408
    ds_read_b128 v[88:91], v8 offset:34048
    ds_read_b128 v[92:95], v8 offset:50688
    ds_read_b128 v[96:99], v9 offset:768
    ds_read_b128 v[100:103], v9 offset:17408
    ds_read_b128 v[104:107], v9 offset:34048
    ds_read_b128 v[108:111], v9 offset:50688
    s_waitcnt vmcnt(2) lgkmcnt(8)
    v_mfma_f32_16x16x32_bf16 v[16:19], v[152:155], v[112:115], v[16:19]
    v_mfma_f32_16x16x32_bf16 v[48:51], v[156:159], v[112:115], v[48:51]
    v_mfma_f32_16x16x32_bf16 v[20:23], v[152:155], v[116:119], v[20:23]
    v_mfma_f32_16x16x32_bf16 v[52:55], v[156:159], v[116:119], v[52:55]
    v_mfma_f32_16x16x32_bf16 v[24:27], v[152:155], v[120:123], v[24:27]
    v_mfma_f32_16x16x32_bf16 v[56:59], v[156:159], v[120:123], v[56:59]
    v_mfma_f32_16x16x32_bf16 v[28:31], v[152:155], v[124:127], v[28:31]
    v_mfma_f32_16x16x32_bf16 v[60:63], v[156:159], v[124:127], v[60:63]
    v_mfma_f32_16x16x32_bf16 v[32:35], v[152:155], v[128:131], v[32:35]
    v_mfma_f32_16x16x32_bf16 v[64:67], v[156:159], v[128:131], v[64:67]
    v_mfma_f32_16x16x32_bf16 v[36:39], v[152:155], v[132:135], v[36:39]
    v_mfma_f32_16x16x32_bf16 v[68:71], v[156:159], v[132:135], v[68:71]
    v_mfma_f32_16x16x32_bf16 v[40:43], v[152:155], v[136:139], v[40:43]
    v_mfma_f32_16x16x32_bf16 v[72:75], v[156:159], v[136:139], v[72:75]
    v_mfma_f32_16x16x32_bf16 v[44:47], v[152:155], v[140:143], v[44:47]
    v_mfma_f32_16x16x32_bf16 v[76:79], v[156:159], v[140:143], v[76:79]
    s_add_u32 s19, s22, 13312
    buffer_load_dwordx4 v[152:155], v7, s[8:11], s19 offen
    s_add_u32 s19, s22, 29696
    buffer_load_dwordx4 v[156:159], v7, s[8:11], s19 offen
    ds_read_b128 v[112:115], v8 offset:832
    ds_read_b128 v[116:119], v8 offset:17472
    ds_read_b128 v[120:123], v8 offset:34112
    ds_read_b128 v[124:127], v8 offset:50752
    ds_read_b128 v[128:131], v9 offset:832
    ds_read_b128 v[132:135], v9 offset:17472
    ds_read_b128 v[136:139], v9 offset:34112
    ds_read_b128 v[140:143], v9 offset:50752
    s_waitcnt vmcnt(2) lgkmcnt(8)
    v_mfma_f32_16x16x32_bf16 v[16:19], v[144:147], v[80:83], v[16:19]
    v_mfma_f32_16x16x32_bf16 v[48:51], v[148:151], v[80:83], v[48:51]
    v_mfma_f32_16x16x32_bf16 v[20:23], v[144:147], v[84:87], v[20:23]
    v_mfma_f32_16x16x32_bf16 v[52:55], v[148:151], v[84:87], v[52:55]
    v_mfma_f32_16x16x32_bf16 v[24:27], v[144:147], v[88:91], v[24:27]
    v_mfma_f32_16x16x32_bf16 v[56:59], v[148:151], v[88:91], v[56:59]
    v_mfma_f32_16x16x32_bf16 v[28:31], v[144:147], v[92:95], v[28:31]
    v_mfma_f32_16x16x32_bf16 v[60:63], v[148:151], v[92:95], v[60:63]
    v_mfma_f32_16x16x32_bf16 v[32:35], v[144:147], v[96:99], v[32:35]
    v_mfma_f32_16x16x32_bf16 v[64:67], v[148:151], v[96:99], v[64:67]
    v_mfma_f32_16x16x32_bf16 v[36:39], v[144:147], v[100:103], v[36:39]
    v_mfma_f32_16x16x32_bf16 v[68:71], v[148:151], v[100:103], v[68:71]
    v_mfma_f32_16x16x32_bf16 v[40:43], v[144:147], v[104:107], v[40:43]
    v_mfma_f32_16x16x32_bf16 v[72:75], v[148:151], v[104:107], v[72:75]
    v_mfma_f32_16x16x32_bf16 v[44:47], v[144:147], v[108:111], v[44:47]
    v_mfma_f32_16x16x32_bf16 v[76:79], v[148:151], v[108:111], v[76:79]
    s_add_u32 s19, s22, 14336
    buffer_load_dwordx4 v[144:147], v7, s[8:11], s19 offen
    s_add_u32 s19, s22, 30720
    buffer_load_dwordx4 v[148:151], v7, s[8:11], s19 offen
    ds_read_b128 v[80:83], v8 offset:896
    ds_read_b128 v[84:87], v8 offset:17536
    ds_read_b128 v[88:91], v8 offset:34176
    ds_read_b128 v[92:95], v8 offset:50816
    ds_read_b128 v[96:99], v9 offset:896
    ds_read_b128 v[100:103], v9 offset:17536
    ds_read_b128 v[104:107], v9 offset:34176
    ds_read_b128 v[108:111], v9 offset:50816
    s_waitcnt vmcnt(2) lgkmcnt(8)
    v_mfma_f32_16x16x32_bf16 v[16:19], v[152:155], v[112:115], v[16:19]
    v_mfma_f32_16x16x32_bf16 v[48:51], v[156:159], v[112:115], v[48:51]
    v_mfma_f32_16x16x32_bf16 v[20:23], v[152:155], v[116:119], v[20:23]
    v_mfma_f32_16x16x32_bf16 v[52:55], v[156:159], v[116:119], v[52:55]
    v_mfma_f32_16x16x32_bf16 v[24:27], v[152:155], v[120:123], v[24:27]
    v_mfma_f32_16x16x32_bf16 v[56:59], v[156:159], v[120:123], v[56:59]
    v_mfma_f32_16x16x32_bf16 v[28:31], v[152:155], v[124:127], v[28:31]
    v_mfma_f32_16x16x32_bf16 v[60:63], v[156:159], v[124:127], v[60:63]
    v_mfma_f32_16x16x32_bf16 v[32:35], v[152:155], v[128:131], v[32:35]
    v_mfma_f32_16x16x32_bf16 v[64:67], v[156:159], v[128:131], v[64:67]
    v_mfma_f32_16x16x32_bf16 v[36:39], v[152:155], v[132:135], v[36:39]
    v_mfma_f32_16x16x32_bf16 v[68:71], v[156:159], v[132:135], v[68:71]
    v_mfma_f32_16x16x32_bf16 v[40:43], v[152:155], v[136:139], v[40:43]
    v_mfma_f32_16x16x32_bf16 v[72:75], v[156:159], v[136:139], v[72:75]
    v_mfma_f32_16x16x32_bf16 v[44:47], v[152:155], v[140:143], v[44:47]
    v_mfma_f32_16x16x32_bf16 v[76:79], v[156:159], v[140:143], v[76:79]
    s_add_u32 s19, s22, 15360
    buffer_load_dwordx4 v[152:155], v7, s[8:11], s19 offen
    s_add_u32 s19, s22, 31744
    buffer_load_dwordx4 v[156:159], v7, s[8:11], s19 offen
    ds_read_b128 v[112:115], v8 offset:960
    ds_read_b128 v[116:119], v8 offset:17600
    ds_read_b128 v[120:123], v8 offset:34240
    ds_read_b128 v[124:127], v8 offset:50880
    ds_read_b128 v[128:131], v9 offset:960
    ds_read_b128 v[132:135], v9 offset:17600
    ds_read_b128 v[136:139], v9 offset:34240
    ds_read_b128 v[140:143], v9 offset:50880
    s_waitcnt vmcnt(2) lgkmcnt(8)
    v_mfma_f32_16x16x32_bf16 v[16:19], v[144:147], v[80:83], v[16:19]
    v_mfma_f32_16x16x32_bf16 v[48:51], v[148:151], v[80:83], v[48:51]
    v_mfma_f32_16x16x32_bf16 v[20:23], v[144:147], v[84:87], v[20:23]
    v_mfma_f32_16x16x32_bf16 v[52:55], v[148:151], v[84:87], v[52:55]
    v_mfma_f32_16x16x32_bf16 v[24:27], v[144:147], v[88:91], v[24:27]
    v_mfma_f32_16x16x32_bf16 v[56:59], v[148:151], v[88:91], v[56:59]
    v_mfma_f32_16x16x32_bf16 v[28:31], v[144:147], v[92:95], v[28:31]
    v_mfma_f32_16x16x32_bf16 v[60:63], v[148:151], v[92:95], v[60:63]
    v_mfma_f32_16x16x32_bf16 v[32:35], v[144:147], v[96:99], v[32:35]
    v_mfma_f32_16x16x32_bf16 v[64:67], v[148:151], v[96:99], v[64:67]
    v_mfma_f32_16x16x32_bf16 v[36:39], v[144:147], v[100:103], v[36:39]
    v_mfma_f32_16x16x32_bf16 v[68:71], v[148:151], v[100:103], v[68:71]
    v_mfma_f32_16x16x32_bf16 v[40:43], v[144:147], v[104:107], v[40:43]
    v_mfma_f32_16x16x32_bf16 v[72:75], v[148:151], v[104:107], v[72:75]
    v_mfma_f32_16x16x32_bf16 v[44:47], v[144:147], v[108:111], v[44:47]
    v_mfma_f32_16x16x32_bf16 v[76:79], v[148:151], v[108:111], v[76:79]
    s_waitcnt vmcnt(0) lgkmcnt(0)
    v_mfma_f32_16x16x32_bf16 v[16:19], v[152:155], v[112:115], v[16:19]
    v_mfma_f32_16x16x32_bf16 v[48:51], v[156:159], v[112:115], v[48:51]
    v_mfma_f32_16x16x32_bf16 v[20:23], v[152:155], v[116:119], v[20:23]
    v_mfma_f32_16x16x32_bf16 v[52:55], v[156:159], v[116:119], v[52:55]
    v_mfma_f32_16x16x32_bf16 v[24:27], v[152:155], v[120:123], v[24:27]
    v_mfma_f32_16x16x32_bf16 v[56:59], v[156:159], v[120:123], v[56:59]
    v_mfma_f32_16x16x32_bf16 v[28:31], v[152:155], v[124:127], v[28:31]
    v_mfma_f32_16x16x32_bf16 v[60:63], v[156:159], v[124:127], v[60:63]
    v_mfma_f32_16x16x32_bf16 v[32:35], v[152:155], v[128:131], v[32:35]
    v_mfma_f32_16x16x32_bf16 v[64:67], v[156:159], v[128:131], v[64:67]
    v_mfma_f32_16x16x32_bf16 v[36:39], v[152:155], v[132:135], v[36:39]
    v_mfma_f32_16x16x32_bf16 v[68:71], v[156:159], v[132:135], v[68:71]
    v_mfma_f32_16x16x32_bf16 v[40:43], v[152:155], v[136:139], v[40:43]
    v_mfma_f32_16x16x32_bf16 v[72:75], v[156:159], v[136:139], v[72:75]
    v_mfma_f32_16x16x32_bf16 v[44:47], v[152:155], v[140:143], v[44:47]
    v_mfma_f32_16x16x32_bf16 v[76:79], v[156:159], v[140:143], v[76:79]
    s_nop 7
    s_lshl_b32 s23, s3, 2
    s_lshl_b32 s23, s23, 5
    s_add_u32 s23, s23, s6
    s_lshl_b32 s23, s23, 13
    s_lshl_b32 s19, s16, 11
    s_add_u32 s23, s23, s19
    s_add_u32 s23, s23, 83886080
    v_cvt_pk_bf16_f32 v80, v16, v17
    v_cvt_pk_bf16_f32 v81, v18, v19
    v_cvt_pk_bf16_f32 v82, v48, v49
    v_cvt_pk_bf16_f32 v83, v50, v51
    s_add_u32 s19, s23, 0
    buffer_store_dwordx4 v[80:83], v7, s[8:11], s19 offen sc1
    s_nop 1
    v_cvt_pk_bf16_f32 v84, v20, v21
    v_cvt_pk_bf16_f32 v85, v22, v23
    v_cvt_pk_bf16_f32 v86, v52, v53
    v_cvt_pk_bf16_f32 v87, v54, v55
    s_add_u32 s19, s23, 1024
    buffer_store_dwordx4 v[84:87], v7, s[8:11], s19 offen sc1
    s_nop 1
    v_cvt_pk_bf16_f32 v80, v24, v25
    v_cvt_pk_bf16_f32 v81, v26, v27
    v_cvt_pk_bf16_f32 v82, v56, v57
    v_cvt_pk_bf16_f32 v83, v58, v59
    s_add_u32 s19, s23, 262144
    buffer_store_dwordx4 v[80:83], v7, s[8:11], s19 offen sc1
    s_nop 1
    v_cvt_pk_bf16_f32 v84, v28, v29
    v_cvt_pk_bf16_f32 v85, v30, v31
    v_cvt_pk_bf16_f32 v86, v60, v61
    v_cvt_pk_bf16_f32 v87, v62, v63
    s_add_u32 s19, s23, 263168
    buffer_store_dwordx4 v[84:87], v7, s[8:11], s19 offen sc1
    s_nop 1
    v_cvt_pk_bf16_f32 v80, v32, v33
    v_cvt_pk_bf16_f32 v81, v34, v35
    v_cvt_pk_bf16_f32 v82, v64, v65
    v_cvt_pk_bf16_f32 v83, v66, v67
    s_add_u32 s19, s23, 524288
    buffer_store_dwordx4 v[80:83], v7, s[8:11], s19 offen sc1
    s_nop 1
    v_cvt_pk_bf16_f32 v84, v36, v37
    v_cvt_pk_bf16_f32 v85, v38, v39
    v_cvt_pk_bf16_f32 v86, v68, v69
    v_cvt_pk_bf16_f32 v87, v70, v71
    s_add_u32 s19, s23, 525312
    buffer_store_dwordx4 v[84:87], v7, s[8:11], s19 offen sc1
    s_nop 1
    v_cvt_pk_bf16_f32 v80, v40, v41
    v_cvt_pk_bf16_f32 v81, v42, v43
    v_cvt_pk_bf16_f32 v82, v72, v73
    v_cvt_pk_bf16_f32 v83, v74, v75
    s_add_u32 s19, s23, 786432
    buffer_store_dwordx4 v[80:83], v7, s[8:11], s19 offen sc1
    s_nop 1
    v_cvt_pk_bf16_f32 v84, v44, v45
    v_cvt_pk_bf16_f32 v85, v46, v47
    v_cvt_pk_bf16_f32 v86, v76, v77
    v_cvt_pk_bf16_f32 v87, v78, v79
    s_add_u32 s19, s23, 787456
    buffer_store_dwordx4 v[84:87], v7, s[8:11], s19 offen sc1
    s_nop 1
    s_lshl_b32 s6, s26, 1
    s_add_u32 s6, s6, 0
    s_lshl_b32 s22, s6, 17
    s_lshl_b32 s19, s16, 15
    s_add_u32 s22, s22, s19
    s_add_u32 s22, s22, 4194304
    s_add_u32 s19, s22, 0
    buffer_load_dwordx4 v[144:147], v7, s[8:11], s19 offen
    s_add_u32 s19, s22, 16384
    buffer_load_dwordx4 v[148:151], v7, s[8:11], s19 offen
    ds_read_b128 v[80:83], v8 offset:0
    ds_read_b128 v[84:87], v8 offset:16640
    ds_read_b128 v[88:91], v8 offset:33280
    ds_read_b128 v[92:95], v8 offset:49920
    ds_read_b128 v[96:99], v9 offset:0
    ds_read_b128 v[100:103], v9 offset:16640
    ds_read_b128 v[104:107], v9 offset:33280
    ds_read_b128 v[108:111], v9 offset:49920
    s_add_u32 s19, s22, 1024
    buffer_load_dwordx4 v[152:155], v7, s[8:11], s19 offen
    s_add_u32 s19, s22, 17408
    buffer_load_dwordx4 v[156:159], v7, s[8:11], s19 offen
    ds_read_b128 v[112:115], v8 offset:64
    ds_read_b128 v[116:119], v8 offset:16704
    ds_read_b128 v[120:123], v8 offset:33344
    ds_read_b128 v[124:127], v8 offset:49984
    ds_read_b128 v[128:131], v9 offset:64
    ds_read_b128 v[132:135], v9 offset:16704
    ds_read_b128 v[136:139], v9 offset:33344
    ds_read_b128 v[140:143], v9 offset:49984
    s_waitcnt vmcnt(2) lgkmcnt(8)
    v_mfma_f32_16x16x32_bf16 v[16:19], v[144:147], v[80:83], 0
    v_mfma_f32_16x16x32_bf16 v[48:51], v[148:151], v[80:83], 0
    v_mfma_f32_16x16x32_bf16 v[20:23], v[144:147], v[84:87], 0
    v_mfma_f32_16x16x32_bf16 v[52:55], v[148:151], v[84:87], 0
    v_mfma_f32_16x16x32_bf16 v[24:27], v[144:147], v[88:91], 0
    v_mfma_f32_16x16x32_bf16 v[56:59], v[148:151], v[88:91], 0
    v_mfma_f32_16x16x32_bf16 v[28:31], v[144:147], v[92:95], 0
    v_mfma_f32_16x16x32_bf16 v[60:63], v[148:151], v[92:95], 0
    v_mfma_f32_16x16x32_bf16 v[32:35], v[144:147], v[96:99], 0
    v_mfma_f32_16x16x32_bf16 v[64:67], v[148:151], v[96:99], 0
    v_mfma_f32_16x16x32_bf16 v[36:39], v[144:147], v[100:103], 0
    v_mfma_f32_16x16x32_bf16 v[68:71], v[148:151], v[100:103], 0
    v_mfma_f32_16x16x32_bf16 v[40:43], v[144:147], v[104:107], 0
    v_mfma_f32_16x16x32_bf16 v[72:75], v[148:151], v[104:107], 0
    v_mfma_f32_16x16x32_bf16 v[44:47], v[144:147], v[108:111], 0
    v_mfma_f32_16x16x32_bf16 v[76:79], v[148:151], v[108:111], 0
    s_add_u32 s19, s22, 2048
    buffer_load_dwordx4 v[144:147], v7, s[8:11], s19 offen
    s_add_u32 s19, s22, 18432
    buffer_load_dwordx4 v[148:151], v7, s[8:11], s19 offen
    ds_read_b128 v[80:83], v8 offset:128
    ds_read_b128 v[84:87], v8 offset:16768
    ds_read_b128 v[88:91], v8 offset:33408
    ds_read_b128 v[92:95], v8 offset:50048
    ds_read_b128 v[96:99], v9 offset:128
    ds_read_b128 v[100:103], v9 offset:16768
    ds_read_b128 v[104:107], v9 offset:33408
    ds_read_b128 v[108:111], v9 offset:50048
    s_waitcnt vmcnt(2) lgkmcnt(8)
    v_mfma_f32_16x16x32_bf16 v[16:19], v[152:155], v[112:115], v[16:19]
    v_mfma_f32_16x16x32_bf16 v[48:51], v[156:159], v[112:115], v[48:51]
    v_mfma_f32_16x16x32_bf16 v[20:23], v[152:155], v[116:119], v[20:23]
    v_mfma_f32_16x16x32_bf16 v[52:55], v[156:159], v[116:119], v[52:55]
    v_mfma_f32_16x16x32_bf16 v[24:27], v[152:155], v[120:123], v[24:27]
    v_mfma_f32_16x16x32_bf16 v[56:59], v[156:159], v[120:123], v[56:59]
    v_mfma_f32_16x16x32_bf16 v[28:31], v[152:155], v[124:127], v[28:31]
    v_mfma_f32_16x16x32_bf16 v[60:63], v[156:159], v[124:127], v[60:63]
    v_mfma_f32_16x16x32_bf16 v[32:35], v[152:155], v[128:131], v[32:35]
    v_mfma_f32_16x16x32_bf16 v[64:67], v[156:159], v[128:131], v[64:67]
    v_mfma_f32_16x16x32_bf16 v[36:39], v[152:155], v[132:135], v[36:39]
    v_mfma_f32_16x16x32_bf16 v[68:71], v[156:159], v[132:135], v[68:71]
    v_mfma_f32_16x16x32_bf16 v[40:43], v[152:155], v[136:139], v[40:43]
    v_mfma_f32_16x16x32_bf16 v[72:75], v[156:159], v[136:139], v[72:75]
    v_mfma_f32_16x16x32_bf16 v[44:47], v[152:155], v[140:143], v[44:47]
    v_mfma_f32_16x16x32_bf16 v[76:79], v[156:159], v[140:143], v[76:79]
    s_add_u32 s19, s22, 3072
    buffer_load_dwordx4 v[152:155], v7, s[8:11], s19 offen
    s_add_u32 s19, s22, 19456
    buffer_load_dwordx4 v[156:159], v7, s[8:11], s19 offen
    ds_read_b128 v[112:115], v8 offset:192
    ds_read_b128 v[116:119], v8 offset:16832
    ds_read_b128 v[120:123], v8 offset:33472
    ds_read_b128 v[124:127], v8 offset:50112
    ds_read_b128 v[128:131], v9 offset:192
    ds_read_b128 v[132:135], v9 offset:16832
    ds_read_b128 v[136:139], v9 offset:33472
    ds_read_b128 v[140:143], v9 offset:50112
    s_waitcnt vmcnt(2) lgkmcnt(8)
    v_mfma_f32_16x16x32_bf16 v[16:19], v[144:147], v[80:83], v[16:19]
    v_mfma_f32_16x16x32_bf16 v[48:51], v[148:151], v[80:83], v[48:51]
    v_mfma_f32_16x16x32_bf16 v[20:23], v[144:147], v[84:87], v[20:23]
    v_mfma_f32_16x16x32_bf16 v[52:55], v[148:151], v[84:87], v[52:55]
    v_mfma_f32_16x16x32_bf16 v[24:27], v[144:147], v[88:91], v[24:27]
    v_mfma_f32_16x16x32_bf16 v[56:59], v[148:151], v[88:91], v[56:59]
    v_mfma_f32_16x16x32_bf16 v[28:31], v[144:147], v[92:95], v[28:31]
    v_mfma_f32_16x16x32_bf16 v[60:63], v[148:151], v[92:95], v[60:63]
    v_mfma_f32_16x16x32_bf16 v[32:35], v[144:147], v[96:99], v[32:35]
    v_mfma_f32_16x16x32_bf16 v[64:67], v[148:151], v[96:99], v[64:67]
    v_mfma_f32_16x16x32_bf16 v[36:39], v[144:147], v[100:103], v[36:39]
    v_mfma_f32_16x16x32_bf16 v[68:71], v[148:151], v[100:103], v[68:71]
    v_mfma_f32_16x16x32_bf16 v[40:43], v[144:147], v[104:107], v[40:43]
    v_mfma_f32_16x16x32_bf16 v[72:75], v[148:151], v[104:107], v[72:75]
    v_mfma_f32_16x16x32_bf16 v[44:47], v[144:147], v[108:111], v[44:47]
    v_mfma_f32_16x16x32_bf16 v[76:79], v[148:151], v[108:111], v[76:79]
    s_add_u32 s19, s22, 4096
    buffer_load_dwordx4 v[144:147], v7, s[8:11], s19 offen
    s_add_u32 s19, s22, 20480
    buffer_load_dwordx4 v[148:151], v7, s[8:11], s19 offen
    ds_read_b128 v[80:83], v8 offset:256
    ds_read_b128 v[84:87], v8 offset:16896
    ds_read_b128 v[88:91], v8 offset:33536
    ds_read_b128 v[92:95], v8 offset:50176
    ds_read_b128 v[96:99], v9 offset:256
    ds_read_b128 v[100:103], v9 offset:16896
    ds_read_b128 v[104:107], v9 offset:33536
    ds_read_b128 v[108:111], v9 offset:50176
    s_waitcnt vmcnt(2) lgkmcnt(8)
    v_mfma_f32_16x16x32_bf16 v[16:19], v[152:155], v[112:115], v[16:19]
    v_mfma_f32_16x16x32_bf16 v[48:51], v[156:159], v[112:115], v[48:51]
    v_mfma_f32_16x16x32_bf16 v[20:23], v[152:155], v[116:119], v[20:23]
    v_mfma_f32_16x16x32_bf16 v[52:55], v[156:159], v[116:119], v[52:55]
    v_mfma_f32_16x16x32_bf16 v[24:27], v[152:155], v[120:123], v[24:27]
    v_mfma_f32_16x16x32_bf16 v[56:59], v[156:159], v[120:123], v[56:59]
    v_mfma_f32_16x16x32_bf16 v[28:31], v[152:155], v[124:127], v[28:31]
    v_mfma_f32_16x16x32_bf16 v[60:63], v[156:159], v[124:127], v[60:63]
    v_mfma_f32_16x16x32_bf16 v[32:35], v[152:155], v[128:131], v[32:35]
    v_mfma_f32_16x16x32_bf16 v[64:67], v[156:159], v[128:131], v[64:67]
    v_mfma_f32_16x16x32_bf16 v[36:39], v[152:155], v[132:135], v[36:39]
    v_mfma_f32_16x16x32_bf16 v[68:71], v[156:159], v[132:135], v[68:71]
    v_mfma_f32_16x16x32_bf16 v[40:43], v[152:155], v[136:139], v[40:43]
    v_mfma_f32_16x16x32_bf16 v[72:75], v[156:159], v[136:139], v[72:75]
    v_mfma_f32_16x16x32_bf16 v[44:47], v[152:155], v[140:143], v[44:47]
    v_mfma_f32_16x16x32_bf16 v[76:79], v[156:159], v[140:143], v[76:79]
    s_add_u32 s19, s22, 5120
    buffer_load_dwordx4 v[152:155], v7, s[8:11], s19 offen
    s_add_u32 s19, s22, 21504
    buffer_load_dwordx4 v[156:159], v7, s[8:11], s19 offen
    ds_read_b128 v[112:115], v8 offset:320
    ds_read_b128 v[116:119], v8 offset:16960
    ds_read_b128 v[120:123], v8 offset:33600
    ds_read_b128 v[124:127], v8 offset:50240
    ds_read_b128 v[128:131], v9 offset:320
    ds_read_b128 v[132:135], v9 offset:16960
    ds_read_b128 v[136:139], v9 offset:33600
    ds_read_b128 v[140:143], v9 offset:50240
    s_waitcnt vmcnt(2) lgkmcnt(8)
    v_mfma_f32_16x16x32_bf16 v[16:19], v[144:147], v[80:83], v[16:19]
    v_mfma_f32_16x16x32_bf16 v[48:51], v[148:151], v[80:83], v[48:51]
    v_mfma_f32_16x16x32_bf16 v[20:23], v[144:147], v[84:87], v[20:23]
    v_mfma_f32_16x16x32_bf16 v[52:55], v[148:151], v[84:87], v[52:55]
    v_mfma_f32_16x16x32_bf16 v[24:27], v[144:147], v[88:91], v[24:27]
    v_mfma_f32_16x16x32_bf16 v[56:59], v[148:151], v[88:91], v[56:59]
    v_mfma_f32_16x16x32_bf16 v[28:31], v[144:147], v[92:95], v[28:31]
    v_mfma_f32_16x16x32_bf16 v[60:63], v[148:151], v[92:95], v[60:63]
    v_mfma_f32_16x16x32_bf16 v[32:35], v[144:147], v[96:99], v[32:35]
    v_mfma_f32_16x16x32_bf16 v[64:67], v[148:151], v[96:99], v[64:67]
    v_mfma_f32_16x16x32_bf16 v[36:39], v[144:147], v[100:103], v[36:39]
    v_mfma_f32_16x16x32_bf16 v[68:71], v[148:151], v[100:103], v[68:71]
    v_mfma_f32_16x16x32_bf16 v[40:43], v[144:147], v[104:107], v[40:43]
    v_mfma_f32_16x16x32_bf16 v[72:75], v[148:151], v[104:107], v[72:75]
    v_mfma_f32_16x16x32_bf16 v[44:47], v[144:147], v[108:111], v[44:47]
    v_mfma_f32_16x16x32_bf16 v[76:79], v[148:151], v[108:111], v[76:79]
    s_add_u32 s19, s22, 6144
    buffer_load_dwordx4 v[144:147], v7, s[8:11], s19 offen
    s_add_u32 s19, s22, 22528
    buffer_load_dwordx4 v[148:151], v7, s[8:11], s19 offen
    ds_read_b128 v[80:83], v8 offset:384
    ds_read_b128 v[84:87], v8 offset:17024
    ds_read_b128 v[88:91], v8 offset:33664
    ds_read_b128 v[92:95], v8 offset:50304
    ds_read_b128 v[96:99], v9 offset:384
    ds_read_b128 v[100:103], v9 offset:17024
    ds_read_b128 v[104:107], v9 offset:33664
    ds_read_b128 v[108:111], v9 offset:50304
    s_waitcnt vmcnt(2) lgkmcnt(8)
    v_mfma_f32_16x16x32_bf16 v[16:19], v[152:155], v[112:115], v[16:19]
    v_mfma_f32_16x16x32_bf16 v[48:51], v[156:159], v[112:115], v[48:51]
    v_mfma_f32_16x16x32_bf16 v[20:23], v[152:155], v[116:119], v[20:23]
    v_mfma_f32_16x16x32_bf16 v[52:55], v[156:159], v[116:119], v[52:55]
    v_mfma_f32_16x16x32_bf16 v[24:27], v[152:155], v[120:123], v[24:27]
    v_mfma_f32_16x16x32_bf16 v[56:59], v[156:159], v[120:123], v[56:59]
    v_mfma_f32_16x16x32_bf16 v[28:31], v[152:155], v[124:127], v[28:31]
    v_mfma_f32_16x16x32_bf16 v[60:63], v[156:159], v[124:127], v[60:63]
    v_mfma_f32_16x16x32_bf16 v[32:35], v[152:155], v[128:131], v[32:35]
    v_mfma_f32_16x16x32_bf16 v[64:67], v[156:159], v[128:131], v[64:67]
    v_mfma_f32_16x16x32_bf16 v[36:39], v[152:155], v[132:135], v[36:39]
    v_mfma_f32_16x16x32_bf16 v[68:71], v[156:159], v[132:135], v[68:71]
    v_mfma_f32_16x16x32_bf16 v[40:43], v[152:155], v[136:139], v[40:43]
    v_mfma_f32_16x16x32_bf16 v[72:75], v[156:159], v[136:139], v[72:75]
    v_mfma_f32_16x16x32_bf16 v[44:47], v[152:155], v[140:143], v[44:47]
    v_mfma_f32_16x16x32_bf16 v[76:79], v[156:159], v[140:143], v[76:79]
    s_add_u32 s19, s22, 7168
    buffer_load_dwordx4 v[152:155], v7, s[8:11], s19 offen
    s_add_u32 s19, s22, 23552
    buffer_load_dwordx4 v[156:159], v7, s[8:11], s19 offen
    ds_read_b128 v[112:115], v8 offset:448
    ds_read_b128 v[116:119], v8 offset:17088
    ds_read_b128 v[120:123], v8 offset:33728
    ds_read_b128 v[124:127], v8 offset:50368
    ds_read_b128 v[128:131], v9 offset:448
    ds_read_b128 v[132:135], v9 offset:17088
    ds_read_b128 v[136:139], v9 offset:33728
    ds_read_b128 v[140:143], v9 offset:50368
    s_waitcnt vmcnt(2) lgkmcnt(8)
    v_mfma_f32_16x16x32_bf16 v[16:19], v[144:147], v[80:83], v[16:19]
    v_mfma_f32_16x16x32_bf16 v[48:51], v[148:151], v[80:83], v[48:51]
    v_mfma_f32_16x16x32_bf16 v[20:23], v[144:147], v[84:87], v[20:23]
    v_mfma_f32_16x16x32_bf16 v[52:55], v[148:151], v[84:87], v[52:55]
    v_mfma_f32_16x16x32_bf16 v[24:27], v[144:147], v[88:91], v[24:27]
    v_mfma_f32_16x16x32_bf16 v[56:59], v[148:151], v[88:91], v[56:59]
    v_mfma_f32_16x16x32_bf16 v[28:31], v[144:147], v[92:95], v[28:31]
    v_mfma_f32_16x16x32_bf16 v[60:63], v[148:151], v[92:95], v[60:63]
    v_mfma_f32_16x16x32_bf16 v[32:35], v[144:147], v[96:99], v[32:35]
    v_mfma_f32_16x16x32_bf16 v[64:67], v[148:151], v[96:99], v[64:67]
    v_mfma_f32_16x16x32_bf16 v[36:39], v[144:147], v[100:103], v[36:39]
    v_mfma_f32_16x16x32_bf16 v[68:71], v[148:151], v[100:103], v[68:71]
    v_mfma_f32_16x16x32_bf16 v[40:43], v[144:147], v[104:107], v[40:43]
    v_mfma_f32_16x16x32_bf16 v[72:75], v[148:151], v[104:107], v[72:75]
    v_mfma_f32_16x16x32_bf16 v[44:47], v[144:147], v[108:111], v[44:47]
    v_mfma_f32_16x16x32_bf16 v[76:79], v[148:151], v[108:111], v[76:79]
    s_add_u32 s19, s22, 8192
    buffer_load_dwordx4 v[144:147], v7, s[8:11], s19 offen
    s_add_u32 s19, s22, 24576
    buffer_load_dwordx4 v[148:151], v7, s[8:11], s19 offen
    ds_read_b128 v[80:83], v8 offset:512
    ds_read_b128 v[84:87], v8 offset:17152
    ds_read_b128 v[88:91], v8 offset:33792
    ds_read_b128 v[92:95], v8 offset:50432
    ds_read_b128 v[96:99], v9 offset:512
    ds_read_b128 v[100:103], v9 offset:17152
    ds_read_b128 v[104:107], v9 offset:33792
    ds_read_b128 v[108:111], v9 offset:50432
    s_waitcnt vmcnt(2) lgkmcnt(8)
    v_mfma_f32_16x16x32_bf16 v[16:19], v[152:155], v[112:115], v[16:19]
    v_mfma_f32_16x16x32_bf16 v[48:51], v[156:159], v[112:115], v[48:51]
    v_mfma_f32_16x16x32_bf16 v[20:23], v[152:155], v[116:119], v[20:23]
    v_mfma_f32_16x16x32_bf16 v[52:55], v[156:159], v[116:119], v[52:55]
    v_mfma_f32_16x16x32_bf16 v[24:27], v[152:155], v[120:123], v[24:27]
    v_mfma_f32_16x16x32_bf16 v[56:59], v[156:159], v[120:123], v[56:59]
    v_mfma_f32_16x16x32_bf16 v[28:31], v[152:155], v[124:127], v[28:31]
    v_mfma_f32_16x16x32_bf16 v[60:63], v[156:159], v[124:127], v[60:63]
    v_mfma_f32_16x16x32_bf16 v[32:35], v[152:155], v[128:131], v[32:35]
    v_mfma_f32_16x16x32_bf16 v[64:67], v[156:159], v[128:131], v[64:67]
    v_mfma_f32_16x16x32_bf16 v[36:39], v[152:155], v[132:135], v[36:39]
    v_mfma_f32_16x16x32_bf16 v[68:71], v[156:159], v[132:135], v[68:71]
    v_mfma_f32_16x16x32_bf16 v[40:43], v[152:155], v[136:139], v[40:43]
    v_mfma_f32_16x16x32_bf16 v[72:75], v[156:159], v[136:139], v[72:75]
    v_mfma_f32_16x16x32_bf16 v[44:47], v[152:155], v[140:143], v[44:47]
    v_mfma_f32_16x16x32_bf16 v[76:79], v[156:159], v[140:143], v[76:79]
    s_add_u32 s19, s22, 9216
    buffer_load_dwordx4 v[152:155], v7, s[8:11], s19 offen
    s_add_u32 s19, s22, 25600
    buffer_load_dwordx4 v[156:159], v7, s[8:11], s19 offen
    ds_read_b128 v[112:115], v8 offset:576
    ds_read_b128 v[116:119], v8 offset:17216
    ds_read_b128 v[120:123], v8 offset:33856
    ds_read_b128 v[124:127], v8 offset:50496
    ds_read_b128 v[128:131], v9 offset:576
    ds_read_b128 v[132:135], v9 offset:17216
    ds_read_b128 v[136:139], v9 offset:33856
    ds_read_b128 v[140:143], v9 offset:50496
    s_waitcnt vmcnt(2) lgkmcnt(8)
    v_mfma_f32_16x16x32_bf16 v[16:19], v[144:147], v[80:83], v[16:19]
    v_mfma_f32_16x16x32_bf16 v[48:51], v[148:151], v[80:83], v[48:51]
    v_mfma_f32_16x16x32_bf16 v[20:23], v[144:147], v[84:87], v[20:23]
    v_mfma_f32_16x16x32_bf16 v[52:55], v[148:151], v[84:87], v[52:55]
    v_mfma_f32_16x16x32_bf16 v[24:27], v[144:147], v[88:91], v[24:27]
    v_mfma_f32_16x16x32_bf16 v[56:59], v[148:151], v[88:91], v[56:59]
    v_mfma_f32_16x16x32_bf16 v[28:31], v[144:147], v[92:95], v[28:31]
    v_mfma_f32_16x16x32_bf16 v[60:63], v[148:151], v[92:95], v[60:63]
    v_mfma_f32_16x16x32_bf16 v[32:35], v[144:147], v[96:99], v[32:35]
    v_mfma_f32_16x16x32_bf16 v[64:67], v[148:151], v[96:99], v[64:67]
    v_mfma_f32_16x16x32_bf16 v[36:39], v[144:147], v[100:103], v[36:39]
    v_mfma_f32_16x16x32_bf16 v[68:71], v[148:151], v[100:103], v[68:71]
    v_mfma_f32_16x16x32_bf16 v[40:43], v[144:147], v[104:107], v[40:43]
    v_mfma_f32_16x16x32_bf16 v[72:75], v[148:151], v[104:107], v[72:75]
    v_mfma_f32_16x16x32_bf16 v[44:47], v[144:147], v[108:111], v[44:47]
    v_mfma_f32_16x16x32_bf16 v[76:79], v[148:151], v[108:111], v[76:79]
    s_add_u32 s19, s22, 10240
    buffer_load_dwordx4 v[144:147], v7, s[8:11], s19 offen
    s_add_u32 s19, s22, 26624
    buffer_load_dwordx4 v[148:151], v7, s[8:11], s19 offen
    ds_read_b128 v[80:83], v8 offset:640
    ds_read_b128 v[84:87], v8 offset:17280
    ds_read_b128 v[88:91], v8 offset:33920
    ds_read_b128 v[92:95], v8 offset:50560
    ds_read_b128 v[96:99], v9 offset:640
    ds_read_b128 v[100:103], v9 offset:17280
    ds_read_b128 v[104:107], v9 offset:33920
    ds_read_b128 v[108:111], v9 offset:50560
    s_waitcnt vmcnt(2) lgkmcnt(8)
    v_mfma_f32_16x16x32_bf16 v[16:19], v[152:155], v[112:115], v[16:19]
    v_mfma_f32_16x16x32_bf16 v[48:51], v[156:159], v[112:115], v[48:51]
    v_mfma_f32_16x16x32_bf16 v[20:23], v[152:155], v[116:119], v[20:23]
    v_mfma_f32_16x16x32_bf16 v[52:55], v[156:159], v[116:119], v[52:55]
    v_mfma_f32_16x16x32_bf16 v[24:27], v[152:155], v[120:123], v[24:27]
    v_mfma_f32_16x16x32_bf16 v[56:59], v[156:159], v[120:123], v[56:59]
    v_mfma_f32_16x16x32_bf16 v[28:31], v[152:155], v[124:127], v[28:31]
    v_mfma_f32_16x16x32_bf16 v[60:63], v[156:159], v[124:127], v[60:63]
    v_mfma_f32_16x16x32_bf16 v[32:35], v[152:155], v[128:131], v[32:35]
    v_mfma_f32_16x16x32_bf16 v[64:67], v[156:159], v[128:131], v[64:67]
    v_mfma_f32_16x16x32_bf16 v[36:39], v[152:155], v[132:135], v[36:39]
    v_mfma_f32_16x16x32_bf16 v[68:71], v[156:159], v[132:135], v[68:71]
    v_mfma_f32_16x16x32_bf16 v[40:43], v[152:155], v[136:139], v[40:43]
    v_mfma_f32_16x16x32_bf16 v[72:75], v[156:159], v[136:139], v[72:75]
    v_mfma_f32_16x16x32_bf16 v[44:47], v[152:155], v[140:143], v[44:47]
    v_mfma_f32_16x16x32_bf16 v[76:79], v[156:159], v[140:143], v[76:79]
    s_add_u32 s19, s22, 11264
    buffer_load_dwordx4 v[152:155], v7, s[8:11], s19 offen
    s_add_u32 s19, s22, 27648
    buffer_load_dwordx4 v[156:159], v7, s[8:11], s19 offen
    ds_read_b128 v[112:115], v8 offset:704
    ds_read_b128 v[116:119], v8 offset:17344
    ds_read_b128 v[120:123], v8 offset:33984
    ds_read_b128 v[124:127], v8 offset:50624
    ds_read_b128 v[128:131], v9 offset:704
    ds_read_b128 v[132:135], v9 offset:17344
    ds_read_b128 v[136:139], v9 offset:33984
    ds_read_b128 v[140:143], v9 offset:50624
    s_waitcnt vmcnt(2) lgkmcnt(8)
    v_mfma_f32_16x16x32_bf16 v[16:19], v[144:147], v[80:83], v[16:19]
    v_mfma_f32_16x16x32_bf16 v[48:51], v[148:151], v[80:83], v[48:51]
    v_mfma_f32_16x16x32_bf16 v[20:23], v[144:147], v[84:87], v[20:23]
    v_mfma_f32_16x16x32_bf16 v[52:55], v[148:151], v[84:87], v[52:55]
    v_mfma_f32_16x16x32_bf16 v[24:27], v[144:147], v[88:91], v[24:27]
    v_mfma_f32_16x16x32_bf16 v[56:59], v[148:151], v[88:91], v[56:59]
    v_mfma_f32_16x16x32_bf16 v[28:31], v[144:147], v[92:95], v[28:31]
    v_mfma_f32_16x16x32_bf16 v[60:63], v[148:151], v[92:95], v[60:63]
    v_mfma_f32_16x16x32_bf16 v[32:35], v[144:147], v[96:99], v[32:35]
    v_mfma_f32_16x16x32_bf16 v[64:67], v[148:151], v[96:99], v[64:67]
    v_mfma_f32_16x16x32_bf16 v[36:39], v[144:147], v[100:103], v[36:39]
    v_mfma_f32_16x16x32_bf16 v[68:71], v[148:151], v[100:103], v[68:71]
    v_mfma_f32_16x16x32_bf16 v[40:43], v[144:147], v[104:107], v[40:43]
    v_mfma_f32_16x16x32_bf16 v[72:75], v[148:151], v[104:107], v[72:75]
    v_mfma_f32_16x16x32_bf16 v[44:47], v[144:147], v[108:111], v[44:47]
    v_mfma_f32_16x16x32_bf16 v[76:79], v[148:151], v[108:111], v[76:79]
    s_add_u32 s19, s22, 12288
    buffer_load_dwordx4 v[144:147], v7, s[8:11], s19 offen
    s_add_u32 s19, s22, 28672
    buffer_load_dwordx4 v[148:151], v7, s[8:11], s19 offen
    ds_read_b128 v[80:83], v8 offset:768
    ds_read_b128 v[84:87], v8 offset:17408
    ds_read_b128 v[88:91], v8 offset:34048
    ds_read_b128 v[92:95], v8 offset:50688
    ds_read_b128 v[96:99], v9 offset:768
    ds_read_b128 v[100:103], v9 offset:17408
    ds_read_b128 v[104:107], v9 offset:34048
    ds_read_b128 v[108:111], v9 offset:50688
    s_waitcnt vmcnt(2) lgkmcnt(8)
    v_mfma_f32_16x16x32_bf16 v[16:19], v[152:155], v[112:115], v[16:19]
    v_mfma_f32_16x16x32_bf16 v[48:51], v[156:159], v[112:115], v[48:51]
    v_mfma_f32_16x16x32_bf16 v[20:23], v[152:155], v[116:119], v[20:23]
    v_mfma_f32_16x16x32_bf16 v[52:55], v[156:159], v[116:119], v[52:55]
    v_mfma_f32_16x16x32_bf16 v[24:27], v[152:155], v[120:123], v[24:27]
    v_mfma_f32_16x16x32_bf16 v[56:59], v[156:159], v[120:123], v[56:59]
    v_mfma_f32_16x16x32_bf16 v[28:31], v[152:155], v[124:127], v[28:31]
    v_mfma_f32_16x16x32_bf16 v[60:63], v[156:159], v[124:127], v[60:63]
    v_mfma_f32_16x16x32_bf16 v[32:35], v[152:155], v[128:131], v[32:35]
    v_mfma_f32_16x16x32_bf16 v[64:67], v[156:159], v[128:131], v[64:67]
    v_mfma_f32_16x16x32_bf16 v[36:39], v[152:155], v[132:135], v[36:39]
    v_mfma_f32_16x16x32_bf16 v[68:71], v[156:159], v[132:135], v[68:71]
    v_mfma_f32_16x16x32_bf16 v[40:43], v[152:155], v[136:139], v[40:43]
    v_mfma_f32_16x16x32_bf16 v[72:75], v[156:159], v[136:139], v[72:75]
    v_mfma_f32_16x16x32_bf16 v[44:47], v[152:155], v[140:143], v[44:47]
    v_mfma_f32_16x16x32_bf16 v[76:79], v[156:159], v[140:143], v[76:79]
    s_add_u32 s19, s22, 13312
    buffer_load_dwordx4 v[152:155], v7, s[8:11], s19 offen
    s_add_u32 s19, s22, 29696
    buffer_load_dwordx4 v[156:159], v7, s[8:11], s19 offen
    ds_read_b128 v[112:115], v8 offset:832
    ds_read_b128 v[116:119], v8 offset:17472
    ds_read_b128 v[120:123], v8 offset:34112
    ds_read_b128 v[124:127], v8 offset:50752
    ds_read_b128 v[128:131], v9 offset:832
    ds_read_b128 v[132:135], v9 offset:17472
    ds_read_b128 v[136:139], v9 offset:34112
    ds_read_b128 v[140:143], v9 offset:50752
    s_waitcnt vmcnt(2) lgkmcnt(8)
    v_mfma_f32_16x16x32_bf16 v[16:19], v[144:147], v[80:83], v[16:19]
    v_mfma_f32_16x16x32_bf16 v[48:51], v[148:151], v[80:83], v[48:51]
    v_mfma_f32_16x16x32_bf16 v[20:23], v[144:147], v[84:87], v[20:23]
    v_mfma_f32_16x16x32_bf16 v[52:55], v[148:151], v[84:87], v[52:55]
    v_mfma_f32_16x16x32_bf16 v[24:27], v[144:147], v[88:91], v[24:27]
    v_mfma_f32_16x16x32_bf16 v[56:59], v[148:151], v[88:91], v[56:59]
    v_mfma_f32_16x16x32_bf16 v[28:31], v[144:147], v[92:95], v[28:31]
    v_mfma_f32_16x16x32_bf16 v[60:63], v[148:151], v[92:95], v[60:63]
    v_mfma_f32_16x16x32_bf16 v[32:35], v[144:147], v[96:99], v[32:35]
    v_mfma_f32_16x16x32_bf16 v[64:67], v[148:151], v[96:99], v[64:67]
    v_mfma_f32_16x16x32_bf16 v[36:39], v[144:147], v[100:103], v[36:39]
    v_mfma_f32_16x16x32_bf16 v[68:71], v[148:151], v[100:103], v[68:71]
    v_mfma_f32_16x16x32_bf16 v[40:43], v[144:147], v[104:107], v[40:43]
    v_mfma_f32_16x16x32_bf16 v[72:75], v[148:151], v[104:107], v[72:75]
    v_mfma_f32_16x16x32_bf16 v[44:47], v[144:147], v[108:111], v[44:47]
    v_mfma_f32_16x16x32_bf16 v[76:79], v[148:151], v[108:111], v[76:79]
    s_add_u32 s19, s22, 14336
    buffer_load_dwordx4 v[144:147], v7, s[8:11], s19 offen
    s_add_u32 s19, s22, 30720
    buffer_load_dwordx4 v[148:151], v7, s[8:11], s19 offen
    ds_read_b128 v[80:83], v8 offset:896
    ds_read_b128 v[84:87], v8 offset:17536
    ds_read_b128 v[88:91], v8 offset:34176
    ds_read_b128 v[92:95], v8 offset:50816
    ds_read_b128 v[96:99], v9 offset:896
    ds_read_b128 v[100:103], v9 offset:17536
    ds_read_b128 v[104:107], v9 offset:34176
    ds_read_b128 v[108:111], v9 offset:50816
    s_waitcnt vmcnt(2) lgkmcnt(8)
    v_mfma_f32_16x16x32_bf16 v[16:19], v[152:155], v[112:115], v[16:19]
    v_mfma_f32_16x16x32_bf16 v[48:51], v[156:159], v[112:115], v[48:51]
    v_mfma_f32_16x16x32_bf16 v[20:23], v[152:155], v[116:119], v[20:23]
    v_mfma_f32_16x16x32_bf16 v[52:55], v[156:159], v[116:119], v[52:55]
    v_mfma_f32_16x16x32_bf16 v[24:27], v[152:155], v[120:123], v[24:27]
    v_mfma_f32_16x16x32_bf16 v[56:59], v[156:159], v[120:123], v[56:59]
    v_mfma_f32_16x16x32_bf16 v[28:31], v[152:155], v[124:127], v[28:31]
    v_mfma_f32_16x16x32_bf16 v[60:63], v[156:159], v[124:127], v[60:63]
    v_mfma_f32_16x16x32_bf16 v[32:35], v[152:155], v[128:131], v[32:35]
    v_mfma_f32_16x16x32_bf16 v[64:67], v[156:159], v[128:131], v[64:67]
    v_mfma_f32_16x16x32_bf16 v[36:39], v[152:155], v[132:135], v[36:39]
    v_mfma_f32_16x16x32_bf16 v[68:71], v[156:159], v[132:135], v[68:71]
    v_mfma_f32_16x16x32_bf16 v[40:43], v[152:155], v[136:139], v[40:43]
    v_mfma_f32_16x16x32_bf16 v[72:75], v[156:159], v[136:139], v[72:75]
    v_mfma_f32_16x16x32_bf16 v[44:47], v[152:155], v[140:143], v[44:47]
    v_mfma_f32_16x16x32_bf16 v[76:79], v[156:159], v[140:143], v[76:79]
    s_add_u32 s19, s22, 15360
    buffer_load_dwordx4 v[152:155], v7, s[8:11], s19 offen
    s_add_u32 s19, s22, 31744
    buffer_load_dwordx4 v[156:159], v7, s[8:11], s19 offen
    ds_read_b128 v[112:115], v8 offset:960
    ds_read_b128 v[116:119], v8 offset:17600
    ds_read_b128 v[120:123], v8 offset:34240
    ds_read_b128 v[124:127], v8 offset:50880
    ds_read_b128 v[128:131], v9 offset:960
    ds_read_b128 v[132:135], v9 offset:17600
    ds_read_b128 v[136:139], v9 offset:34240
    ds_read_b128 v[140:143], v9 offset:50880
    s_waitcnt vmcnt(2) lgkmcnt(8)
    v_mfma_f32_16x16x32_bf16 v[16:19], v[144:147], v[80:83], v[16:19]
    v_mfma_f32_16x16x32_bf16 v[48:51], v[148:151], v[80:83], v[48:51]
    v_mfma_f32_16x16x32_bf16 v[20:23], v[144:147], v[84:87], v[20:23]
    v_mfma_f32_16x16x32_bf16 v[52:55], v[148:151], v[84:87], v[52:55]
    v_mfma_f32_16x16x32_bf16 v[24:27], v[144:147], v[88:91], v[24:27]
    v_mfma_f32_16x16x32_bf16 v[56:59], v[148:151], v[88:91], v[56:59]
    v_mfma_f32_16x16x32_bf16 v[28:31], v[144:147], v[92:95], v[28:31]
    v_mfma_f32_16x16x32_bf16 v[60:63], v[148:151], v[92:95], v[60:63]
    v_mfma_f32_16x16x32_bf16 v[32:35], v[144:147], v[96:99], v[32:35]
    v_mfma_f32_16x16x32_bf16 v[64:67], v[148:151], v[96:99], v[64:67]
    v_mfma_f32_16x16x32_bf16 v[36:39], v[144:147], v[100:103], v[36:39]
    v_mfma_f32_16x16x32_bf16 v[68:71], v[148:151], v[100:103], v[68:71]
    v_mfma_f32_16x16x32_bf16 v[40:43], v[144:147], v[104:107], v[40:43]
    v_mfma_f32_16x16x32_bf16 v[72:75], v[148:151], v[104:107], v[72:75]
    v_mfma_f32_16x16x32_bf16 v[44:47], v[144:147], v[108:111], v[44:47]
    v_mfma_f32_16x16x32_bf16 v[76:79], v[148:151], v[108:111], v[76:79]
    s_waitcnt vmcnt(0) lgkmcnt(0)
    v_mfma_f32_16x16x32_bf16 v[16:19], v[152:155], v[112:115], v[16:19]
    v_mfma_f32_16x16x32_bf16 v[48:51], v[156:159], v[112:115], v[48:51]
    v_mfma_f32_16x16x32_bf16 v[20:23], v[152:155], v[116:119], v[20:23]
    v_mfma_f32_16x16x32_bf16 v[52:55], v[156:159], v[116:119], v[52:55]
    v_mfma_f32_16x16x32_bf16 v[24:27], v[152:155], v[120:123], v[24:27]
    v_mfma_f32_16x16x32_bf16 v[56:59], v[156:159], v[120:123], v[56:59]
    v_mfma_f32_16x16x32_bf16 v[28:31], v[152:155], v[124:127], v[28:31]
    v_mfma_f32_16x16x32_bf16 v[60:63], v[156:159], v[124:127], v[60:63]
    v_mfma_f32_16x16x32_bf16 v[32:35], v[152:155], v[128:131], v[32:35]
    v_mfma_f32_16x16x32_bf16 v[64:67], v[156:159], v[128:131], v[64:67]
    v_mfma_f32_16x16x32_bf16 v[36:39], v[152:155], v[132:135], v[36:39]
    v_mfma_f32_16x16x32_bf16 v[68:71], v[156:159], v[132:135], v[68:71]
    v_mfma_f32_16x16x32_bf16 v[40:43], v[152:155], v[136:139], v[40:43]
    v_mfma_f32_16x16x32_bf16 v[72:75], v[156:159], v[136:139], v[72:75]
    v_mfma_f32_16x16x32_bf16 v[44:47], v[152:155], v[140:143], v[44:47]
    v_mfma_f32_16x16x32_bf16 v[76:79], v[156:159], v[140:143], v[76:79]
    s_nop 7
    s_lshl_b32 s23, s3, 2
    s_lshl_b32 s23, s23, 5
    s_add_u32 s23, s23, s6
    s_lshl_b32 s23, s23, 13
    s_lshl_b32 s19, s16, 11
    s_add_u32 s23, s23, s19
    s_add_u32 s23, s23, 50331648
    v_cvt_pk_bf16_f32 v80, v16, v17
    v_cvt_pk_bf16_f32 v81, v18, v19
    v_cvt_pk_bf16_f32 v82, v48, v49
    v_cvt_pk_bf16_f32 v83, v50, v51
    s_add_u32 s19, s23, 0
    buffer_store_dwordx4 v[80:83], v7, s[8:11], s19 offen sc1
    s_nop 1
    v_cvt_pk_bf16_f32 v84, v20, v21
    v_cvt_pk_bf16_f32 v85, v22, v23
    v_cvt_pk_bf16_f32 v86, v52, v53
    v_cvt_pk_bf16_f32 v87, v54, v55
    s_add_u32 s19, s23, 1024
    buffer_store_dwordx4 v[84:87], v7, s[8:11], s19 offen sc1
    s_nop 1
    v_cvt_pk_bf16_f32 v80, v24, v25
    v_cvt_pk_bf16_f32 v81, v26, v27
    v_cvt_pk_bf16_f32 v82, v56, v57
    v_cvt_pk_bf16_f32 v83, v58, v59
    s_add_u32 s19, s23, 262144
    buffer_store_dwordx4 v[80:83], v7, s[8:11], s19 offen sc1
    s_nop 1
    v_cvt_pk_bf16_f32 v84, v28, v29
    v_cvt_pk_bf16_f32 v85, v30, v31
    v_cvt_pk_bf16_f32 v86, v60, v61
    v_cvt_pk_bf16_f32 v87, v62, v63
    s_add_u32 s19, s23, 263168
    buffer_store_dwordx4 v[84:87], v7, s[8:11], s19 offen sc1
    s_nop 1
    v_cvt_pk_bf16_f32 v80, v32, v33
    v_cvt_pk_bf16_f32 v81, v34, v35
    v_cvt_pk_bf16_f32 v82, v64, v65
    v_cvt_pk_bf16_f32 v83, v66, v67
    s_add_u32 s19, s23, 524288
    buffer_store_dwordx4 v[80:83], v7, s[8:11], s19 offen sc1
    s_nop 1
    v_cvt_pk_bf16_f32 v84, v36, v37
    v_cvt_pk_bf16_f32 v85, v38, v39
    v_cvt_pk_bf16_f32 v86, v68, v69
    v_cvt_pk_bf16_f32 v87, v70, v71
    s_add_u32 s19, s23, 525312
    buffer_store_dwordx4 v[84:87], v7, s[8:11], s19 offen sc1
    s_nop 1
    v_cvt_pk_bf16_f32 v80, v40, v41
    v_cvt_pk_bf16_f32 v81, v42, v43
    v_cvt_pk_bf16_f32 v82, v72, v73
    v_cvt_pk_bf16_f32 v83, v74, v75
    s_add_u32 s19, s23, 786432
    buffer_store_dwordx4 v[80:83], v7, s[8:11], s19 offen sc1
    s_nop 1
    v_cvt_pk_bf16_f32 v84, v44, v45
    v_cvt_pk_bf16_f32 v85, v46, v47
    v_cvt_pk_bf16_f32 v86, v76, v77
    v_cvt_pk_bf16_f32 v87, v78, v79
    s_add_u32 s19, s23, 787456
    buffer_store_dwordx4 v[84:87], v7, s[8:11], s19 offen sc1
    s_nop 1
    s_lshl_b32 s6, s26, 1
    s_add_u32 s6, s6, 0
    s_lshl_b32 s22, s6, 17
    s_lshl_b32 s19, s16, 15
    s_add_u32 s22, s22, s19
    s_add_u32 s22, s22, 8388608
    s_add_u32 s19, s22, 0
    buffer_load_dwordx4 v[144:147], v7, s[8:11], s19 offen
    s_add_u32 s19, s22, 16384
    buffer_load_dwordx4 v[148:151], v7, s[8:11], s19 offen
    ds_read_b128 v[80:83], v8 offset:0
    ds_read_b128 v[84:87], v8 offset:16640
    ds_read_b128 v[88:91], v8 offset:33280
    ds_read_b128 v[92:95], v8 offset:49920
    ds_read_b128 v[96:99], v9 offset:0
    ds_read_b128 v[100:103], v9 offset:16640
    ds_read_b128 v[104:107], v9 offset:33280
    ds_read_b128 v[108:111], v9 offset:49920
    s_add_u32 s19, s22, 1024
    buffer_load_dwordx4 v[152:155], v7, s[8:11], s19 offen
    s_add_u32 s19, s22, 17408
    buffer_load_dwordx4 v[156:159], v7, s[8:11], s19 offen
    ds_read_b128 v[112:115], v8 offset:64
    ds_read_b128 v[116:119], v8 offset:16704
    ds_read_b128 v[120:123], v8 offset:33344
    ds_read_b128 v[124:127], v8 offset:49984
    ds_read_b128 v[128:131], v9 offset:64
    ds_read_b128 v[132:135], v9 offset:16704
    ds_read_b128 v[136:139], v9 offset:33344
    ds_read_b128 v[140:143], v9 offset:49984
    s_waitcnt vmcnt(2) lgkmcnt(8)
    v_mfma_f32_16x16x32_bf16 v[16:19], v[80:83], v[144:147], 0
    v_mfma_f32_16x16x32_bf16 v[48:51], v[80:83], v[148:151], 0
    v_mfma_f32_16x16x32_bf16 v[20:23], v[84:87], v[144:147], 0
    v_mfma_f32_16x16x32_bf16 v[52:55], v[84:87], v[148:151], 0
    v_mfma_f32_16x16x32_bf16 v[24:27], v[88:91], v[144:147], 0
    v_mfma_f32_16x16x32_bf16 v[56:59], v[88:91], v[148:151], 0
    v_mfma_f32_16x16x32_bf16 v[28:31], v[92:95], v[144:147], 0
    v_mfma_f32_16x16x32_bf16 v[60:63], v[92:95], v[148:151], 0
    v_mfma_f32_16x16x32_bf16 v[32:35], v[96:99], v[144:147], 0
    v_mfma_f32_16x16x32_bf16 v[64:67], v[96:99], v[148:151], 0
    v_mfma_f32_16x16x32_bf16 v[36:39], v[100:103], v[144:147], 0
    v_mfma_f32_16x16x32_bf16 v[68:71], v[100:103], v[148:151], 0
    v_mfma_f32_16x16x32_bf16 v[40:43], v[104:107], v[144:147], 0
    v_mfma_f32_16x16x32_bf16 v[72:75], v[104:107], v[148:151], 0
    v_mfma_f32_16x16x32_bf16 v[44:47], v[108:111], v[144:147], 0
    v_mfma_f32_16x16x32_bf16 v[76:79], v[108:111], v[148:151], 0
    s_add_u32 s19, s22, 2048
    buffer_load_dwordx4 v[144:147], v7, s[8:11], s19 offen
    s_add_u32 s19, s22, 18432
    buffer_load_dwordx4 v[148:151], v7, s[8:11], s19 offen
    ds_read_b128 v[80:83], v8 offset:128
    ds_read_b128 v[84:87], v8 offset:16768
    ds_read_b128 v[88:91], v8 offset:33408
    ds_read_b128 v[92:95], v8 offset:50048
    ds_read_b128 v[96:99], v9 offset:128
    ds_read_b128 v[100:103], v9 offset:16768
    ds_read_b128 v[104:107], v9 offset:33408
    ds_read_b128 v[108:111], v9 offset:50048
    s_waitcnt vmcnt(2) lgkmcnt(8)
    v_mfma_f32_16x16x32_bf16 v[16:19], v[112:115], v[152:155], v[16:19]
    v_mfma_f32_16x16x32_bf16 v[48:51], v[112:115], v[156:159], v[48:51]
    v_mfma_f32_16x16x32_bf16 v[20:23], v[116:119], v[152:155], v[20:23]
    v_mfma_f32_16x16x32_bf16 v[52:55], v[116:119], v[156:159], v[52:55]
    v_mfma_f32_16x16x32_bf16 v[24:27], v[120:123], v[152:155], v[24:27]
    v_mfma_f32_16x16x32_bf16 v[56:59], v[120:123], v[156:159], v[56:59]
    v_mfma_f32_16x16x32_bf16 v[28:31], v[124:127], v[152:155], v[28:31]
    v_mfma_f32_16x16x32_bf16 v[60:63], v[124:127], v[156:159], v[60:63]
    v_mfma_f32_16x16x32_bf16 v[32:35], v[128:131], v[152:155], v[32:35]
    v_mfma_f32_16x16x32_bf16 v[64:67], v[128:131], v[156:159], v[64:67]
    v_mfma_f32_16x16x32_bf16 v[36:39], v[132:135], v[152:155], v[36:39]
    v_mfma_f32_16x16x32_bf16 v[68:71], v[132:135], v[156:159], v[68:71]
    v_mfma_f32_16x16x32_bf16 v[40:43], v[136:139], v[152:155], v[40:43]
    v_mfma_f32_16x16x32_bf16 v[72:75], v[136:139], v[156:159], v[72:75]
    v_mfma_f32_16x16x32_bf16 v[44:47], v[140:143], v[152:155], v[44:47]
    v_mfma_f32_16x16x32_bf16 v[76:79], v[140:143], v[156:159], v[76:79]
    s_add_u32 s19, s22, 3072
    buffer_load_dwordx4 v[152:155], v7, s[8:11], s19 offen
    s_add_u32 s19, s22, 19456
    buffer_load_dwordx4 v[156:159], v7, s[8:11], s19 offen
    ds_read_b128 v[112:115], v8 offset:192
    ds_read_b128 v[116:119], v8 offset:16832
    ds_read_b128 v[120:123], v8 offset:33472
    ds_read_b128 v[124:127], v8 offset:50112
    ds_read_b128 v[128:131], v9 offset:192
    ds_read_b128 v[132:135], v9 offset:16832
    ds_read_b128 v[136:139], v9 offset:33472
    ds_read_b128 v[140:143], v9 offset:50112
    s_waitcnt vmcnt(2) lgkmcnt(8)
    v_mfma_f32_16x16x32_bf16 v[16:19], v[80:83], v[144:147], v[16:19]
    v_mfma_f32_16x16x32_bf16 v[48:51], v[80:83], v[148:151], v[48:51]
    v_mfma_f32_16x16x32_bf16 v[20:23], v[84:87], v[144:147], v[20:23]
    v_mfma_f32_16x16x32_bf16 v[52:55], v[84:87], v[148:151], v[52:55]
    v_mfma_f32_16x16x32_bf16 v[24:27], v[88:91], v[144:147], v[24:27]
    v_mfma_f32_16x16x32_bf16 v[56:59], v[88:91], v[148:151], v[56:59]
    v_mfma_f32_16x16x32_bf16 v[28:31], v[92:95], v[144:147], v[28:31]
    v_mfma_f32_16x16x32_bf16 v[60:63], v[92:95], v[148:151], v[60:63]
    v_mfma_f32_16x16x32_bf16 v[32:35], v[96:99], v[144:147], v[32:35]
    v_mfma_f32_16x16x32_bf16 v[64:67], v[96:99], v[148:151], v[64:67]
    v_mfma_f32_16x16x32_bf16 v[36:39], v[100:103], v[144:147], v[36:39]
    v_mfma_f32_16x16x32_bf16 v[68:71], v[100:103], v[148:151], v[68:71]
    v_mfma_f32_16x16x32_bf16 v[40:43], v[104:107], v[144:147], v[40:43]
    v_mfma_f32_16x16x32_bf16 v[72:75], v[104:107], v[148:151], v[72:75]
    v_mfma_f32_16x16x32_bf16 v[44:47], v[108:111], v[144:147], v[44:47]
    v_mfma_f32_16x16x32_bf16 v[76:79], v[108:111], v[148:151], v[76:79]
    s_add_u32 s19, s22, 4096
    buffer_load_dwordx4 v[144:147], v7, s[8:11], s19 offen
    s_add_u32 s19, s22, 20480
    buffer_load_dwordx4 v[148:151], v7, s[8:11], s19 offen
    ds_read_b128 v[80:83], v8 offset:256
    ds_read_b128 v[84:87], v8 offset:16896
    ds_read_b128 v[88:91], v8 offset:33536
    ds_read_b128 v[92:95], v8 offset:50176
    ds_read_b128 v[96:99], v9 offset:256
    ds_read_b128 v[100:103], v9 offset:16896
    ds_read_b128 v[104:107], v9 offset:33536
    ds_read_b128 v[108:111], v9 offset:50176
    s_waitcnt vmcnt(2) lgkmcnt(8)
    v_mfma_f32_16x16x32_bf16 v[16:19], v[112:115], v[152:155], v[16:19]
    v_mfma_f32_16x16x32_bf16 v[48:51], v[112:115], v[156:159], v[48:51]
    v_mfma_f32_16x16x32_bf16 v[20:23], v[116:119], v[152:155], v[20:23]
    v_mfma_f32_16x16x32_bf16 v[52:55], v[116:119], v[156:159], v[52:55]
    v_mfma_f32_16x16x32_bf16 v[24:27], v[120:123], v[152:155], v[24:27]
    v_mfma_f32_16x16x32_bf16 v[56:59], v[120:123], v[156:159], v[56:59]
    v_mfma_f32_16x16x32_bf16 v[28:31], v[124:127], v[152:155], v[28:31]
    v_mfma_f32_16x16x32_bf16 v[60:63], v[124:127], v[156:159], v[60:63]
    v_mfma_f32_16x16x32_bf16 v[32:35], v[128:131], v[152:155], v[32:35]
    v_mfma_f32_16x16x32_bf16 v[64:67], v[128:131], v[156:159], v[64:67]
    v_mfma_f32_16x16x32_bf16 v[36:39], v[132:135], v[152:155], v[36:39]
    v_mfma_f32_16x16x32_bf16 v[68:71], v[132:135], v[156:159], v[68:71]
    v_mfma_f32_16x16x32_bf16 v[40:43], v[136:139], v[152:155], v[40:43]
    v_mfma_f32_16x16x32_bf16 v[72:75], v[136:139], v[156:159], v[72:75]
    v_mfma_f32_16x16x32_bf16 v[44:47], v[140:143], v[152:155], v[44:47]
    v_mfma_f32_16x16x32_bf16 v[76:79], v[140:143], v[156:159], v[76:79]
    s_add_u32 s19, s22, 5120
    buffer_load_dwordx4 v[152:155], v7, s[8:11], s19 offen
    s_add_u32 s19, s22, 21504
    buffer_load_dwordx4 v[156:159], v7, s[8:11], s19 offen
    ds_read_b128 v[112:115], v8 offset:320
    ds_read_b128 v[116:119], v8 offset:16960
    ds_read_b128 v[120:123], v8 offset:33600
    ds_read_b128 v[124:127], v8 offset:50240
    ds_read_b128 v[128:131], v9 offset:320
    ds_read_b128 v[132:135], v9 offset:16960
    ds_read_b128 v[136:139], v9 offset:33600
    ds_read_b128 v[140:143], v9 offset:50240
    s_waitcnt vmcnt(2) lgkmcnt(8)
    v_mfma_f32_16x16x32_bf16 v[16:19], v[80:83], v[144:147], v[16:19]
    v_mfma_f32_16x16x32_bf16 v[48:51], v[80:83], v[148:151], v[48:51]
    v_mfma_f32_16x16x32_bf16 v[20:23], v[84:87], v[144:147], v[20:23]
    v_mfma_f32_16x16x32_bf16 v[52:55], v[84:87], v[148:151], v[52:55]
    v_mfma_f32_16x16x32_bf16 v[24:27], v[88:91], v[144:147], v[24:27]
    v_mfma_f32_16x16x32_bf16 v[56:59], v[88:91], v[148:151], v[56:59]
    v_mfma_f32_16x16x32_bf16 v[28:31], v[92:95], v[144:147], v[28:31]
    v_mfma_f32_16x16x32_bf16 v[60:63], v[92:95], v[148:151], v[60:63]
    v_mfma_f32_16x16x32_bf16 v[32:35], v[96:99], v[144:147], v[32:35]
    v_mfma_f32_16x16x32_bf16 v[64:67], v[96:99], v[148:151], v[64:67]
    v_mfma_f32_16x16x32_bf16 v[36:39], v[100:103], v[144:147], v[36:39]
    v_mfma_f32_16x16x32_bf16 v[68:71], v[100:103], v[148:151], v[68:71]
    v_mfma_f32_16x16x32_bf16 v[40:43], v[104:107], v[144:147], v[40:43]
    v_mfma_f32_16x16x32_bf16 v[72:75], v[104:107], v[148:151], v[72:75]
    v_mfma_f32_16x16x32_bf16 v[44:47], v[108:111], v[144:147], v[44:47]
    v_mfma_f32_16x16x32_bf16 v[76:79], v[108:111], v[148:151], v[76:79]
    s_add_u32 s19, s22, 6144
    buffer_load_dwordx4 v[144:147], v7, s[8:11], s19 offen
    s_add_u32 s19, s22, 22528
    buffer_load_dwordx4 v[148:151], v7, s[8:11], s19 offen
    ds_read_b128 v[80:83], v8 offset:384
    ds_read_b128 v[84:87], v8 offset:17024
    ds_read_b128 v[88:91], v8 offset:33664
    ds_read_b128 v[92:95], v8 offset:50304
    ds_read_b128 v[96:99], v9 offset:384
    ds_read_b128 v[100:103], v9 offset:17024
    ds_read_b128 v[104:107], v9 offset:33664
    ds_read_b128 v[108:111], v9 offset:50304
    s_waitcnt vmcnt(2) lgkmcnt(8)
    v_mfma_f32_16x16x32_bf16 v[16:19], v[112:115], v[152:155], v[16:19]
    v_mfma_f32_16x16x32_bf16 v[48:51], v[112:115], v[156:159], v[48:51]
    v_mfma_f32_16x16x32_bf16 v[20:23], v[116:119], v[152:155], v[20:23]
    v_mfma_f32_16x16x32_bf16 v[52:55], v[116:119], v[156:159], v[52:55]
    v_mfma_f32_16x16x32_bf16 v[24:27], v[120:123], v[152:155], v[24:27]
    v_mfma_f32_16x16x32_bf16 v[56:59], v[120:123], v[156:159], v[56:59]
    v_mfma_f32_16x16x32_bf16 v[28:31], v[124:127], v[152:155], v[28:31]
    v_mfma_f32_16x16x32_bf16 v[60:63], v[124:127], v[156:159], v[60:63]
    v_mfma_f32_16x16x32_bf16 v[32:35], v[128:131], v[152:155], v[32:35]
    v_mfma_f32_16x16x32_bf16 v[64:67], v[128:131], v[156:159], v[64:67]
    v_mfma_f32_16x16x32_bf16 v[36:39], v[132:135], v[152:155], v[36:39]
    v_mfma_f32_16x16x32_bf16 v[68:71], v[132:135], v[156:159], v[68:71]
    v_mfma_f32_16x16x32_bf16 v[40:43], v[136:139], v[152:155], v[40:43]
    v_mfma_f32_16x16x32_bf16 v[72:75], v[136:139], v[156:159], v[72:75]
    v_mfma_f32_16x16x32_bf16 v[44:47], v[140:143], v[152:155], v[44:47]
    v_mfma_f32_16x16x32_bf16 v[76:79], v[140:143], v[156:159], v[76:79]
    s_add_u32 s19, s22, 7168
    buffer_load_dwordx4 v[152:155], v7, s[8:11], s19 offen
    s_add_u32 s19, s22, 23552
    buffer_load_dwordx4 v[156:159], v7, s[8:11], s19 offen
    ds_read_b128 v[112:115], v8 offset:448
    ds_read_b128 v[116:119], v8 offset:17088
    ds_read_b128 v[120:123], v8 offset:33728
    ds_read_b128 v[124:127], v8 offset:50368
    ds_read_b128 v[128:131], v9 offset:448
    ds_read_b128 v[132:135], v9 offset:17088
    ds_read_b128 v[136:139], v9 offset:33728
    ds_read_b128 v[140:143], v9 offset:50368
    s_waitcnt vmcnt(2) lgkmcnt(8)
    v_mfma_f32_16x16x32_bf16 v[16:19], v[80:83], v[144:147], v[16:19]
    v_mfma_f32_16x16x32_bf16 v[48:51], v[80:83], v[148:151], v[48:51]
    v_mfma_f32_16x16x32_bf16 v[20:23], v[84:87], v[144:147], v[20:23]
    v_mfma_f32_16x16x32_bf16 v[52:55], v[84:87], v[148:151], v[52:55]
    v_mfma_f32_16x16x32_bf16 v[24:27], v[88:91], v[144:147], v[24:27]
    v_mfma_f32_16x16x32_bf16 v[56:59], v[88:91], v[148:151], v[56:59]
    v_mfma_f32_16x16x32_bf16 v[28:31], v[92:95], v[144:147], v[28:31]
    v_mfma_f32_16x16x32_bf16 v[60:63], v[92:95], v[148:151], v[60:63]
    v_mfma_f32_16x16x32_bf16 v[32:35], v[96:99], v[144:147], v[32:35]
    v_mfma_f32_16x16x32_bf16 v[64:67], v[96:99], v[148:151], v[64:67]
    v_mfma_f32_16x16x32_bf16 v[36:39], v[100:103], v[144:147], v[36:39]
    v_mfma_f32_16x16x32_bf16 v[68:71], v[100:103], v[148:151], v[68:71]
    v_mfma_f32_16x16x32_bf16 v[40:43], v[104:107], v[144:147], v[40:43]
    v_mfma_f32_16x16x32_bf16 v[72:75], v[104:107], v[148:151], v[72:75]
    v_mfma_f32_16x16x32_bf16 v[44:47], v[108:111], v[144:147], v[44:47]
    v_mfma_f32_16x16x32_bf16 v[76:79], v[108:111], v[148:151], v[76:79]
    s_add_u32 s19, s22, 8192
    buffer_load_dwordx4 v[144:147], v7, s[8:11], s19 offen
    s_add_u32 s19, s22, 24576
    buffer_load_dwordx4 v[148:151], v7, s[8:11], s19 offen
    ds_read_b128 v[80:83], v8 offset:512
    ds_read_b128 v[84:87], v8 offset:17152
    ds_read_b128 v[88:91], v8 offset:33792
    ds_read_b128 v[92:95], v8 offset:50432
    ds_read_b128 v[96:99], v9 offset:512
    ds_read_b128 v[100:103], v9 offset:17152
    ds_read_b128 v[104:107], v9 offset:33792
    ds_read_b128 v[108:111], v9 offset:50432
    s_waitcnt vmcnt(2) lgkmcnt(8)
    v_mfma_f32_16x16x32_bf16 v[16:19], v[112:115], v[152:155], v[16:19]
    v_mfma_f32_16x16x32_bf16 v[48:51], v[112:115], v[156:159], v[48:51]
    v_mfma_f32_16x16x32_bf16 v[20:23], v[116:119], v[152:155], v[20:23]
    v_mfma_f32_16x16x32_bf16 v[52:55], v[116:119], v[156:159], v[52:55]
    v_mfma_f32_16x16x32_bf16 v[24:27], v[120:123], v[152:155], v[24:27]
    v_mfma_f32_16x16x32_bf16 v[56:59], v[120:123], v[156:159], v[56:59]
    v_mfma_f32_16x16x32_bf16 v[28:31], v[124:127], v[152:155], v[28:31]
    v_mfma_f32_16x16x32_bf16 v[60:63], v[124:127], v[156:159], v[60:63]
    v_mfma_f32_16x16x32_bf16 v[32:35], v[128:131], v[152:155], v[32:35]
    v_mfma_f32_16x16x32_bf16 v[64:67], v[128:131], v[156:159], v[64:67]
    v_mfma_f32_16x16x32_bf16 v[36:39], v[132:135], v[152:155], v[36:39]
    v_mfma_f32_16x16x32_bf16 v[68:71], v[132:135], v[156:159], v[68:71]
    v_mfma_f32_16x16x32_bf16 v[40:43], v[136:139], v[152:155], v[40:43]
    v_mfma_f32_16x16x32_bf16 v[72:75], v[136:139], v[156:159], v[72:75]
    v_mfma_f32_16x16x32_bf16 v[44:47], v[140:143], v[152:155], v[44:47]
    v_mfma_f32_16x16x32_bf16 v[76:79], v[140:143], v[156:159], v[76:79]
    s_add_u32 s19, s22, 9216
    buffer_load_dwordx4 v[152:155], v7, s[8:11], s19 offen
    s_add_u32 s19, s22, 25600
    buffer_load_dwordx4 v[156:159], v7, s[8:11], s19 offen
    ds_read_b128 v[112:115], v8 offset:576
    ds_read_b128 v[116:119], v8 offset:17216
    ds_read_b128 v[120:123], v8 offset:33856
    ds_read_b128 v[124:127], v8 offset:50496
    ds_read_b128 v[128:131], v9 offset:576
    ds_read_b128 v[132:135], v9 offset:17216
    ds_read_b128 v[136:139], v9 offset:33856
    ds_read_b128 v[140:143], v9 offset:50496
    s_waitcnt vmcnt(2) lgkmcnt(8)
    v_mfma_f32_16x16x32_bf16 v[16:19], v[80:83], v[144:147], v[16:19]
    v_mfma_f32_16x16x32_bf16 v[48:51], v[80:83], v[148:151], v[48:51]
    v_mfma_f32_16x16x32_bf16 v[20:23], v[84:87], v[144:147], v[20:23]
    v_mfma_f32_16x16x32_bf16 v[52:55], v[84:87], v[148:151], v[52:55]
    v_mfma_f32_16x16x32_bf16 v[24:27], v[88:91], v[144:147], v[24:27]
    v_mfma_f32_16x16x32_bf16 v[56:59], v[88:91], v[148:151], v[56:59]
    v_mfma_f32_16x16x32_bf16 v[28:31], v[92:95], v[144:147], v[28:31]
    v_mfma_f32_16x16x32_bf16 v[60:63], v[92:95], v[148:151], v[60:63]
    v_mfma_f32_16x16x32_bf16 v[32:35], v[96:99], v[144:147], v[32:35]
    v_mfma_f32_16x16x32_bf16 v[64:67], v[96:99], v[148:151], v[64:67]
    v_mfma_f32_16x16x32_bf16 v[36:39], v[100:103], v[144:147], v[36:39]
    v_mfma_f32_16x16x32_bf16 v[68:71], v[100:103], v[148:151], v[68:71]
    v_mfma_f32_16x16x32_bf16 v[40:43], v[104:107], v[144:147], v[40:43]
    v_mfma_f32_16x16x32_bf16 v[72:75], v[104:107], v[148:151], v[72:75]
    v_mfma_f32_16x16x32_bf16 v[44:47], v[108:111], v[144:147], v[44:47]
    v_mfma_f32_16x16x32_bf16 v[76:79], v[108:111], v[148:151], v[76:79]
    s_add_u32 s19, s22, 10240
    buffer_load_dwordx4 v[144:147], v7, s[8:11], s19 offen
    s_add_u32 s19, s22, 26624
    buffer_load_dwordx4 v[148:151], v7, s[8:11], s19 offen
    ds_read_b128 v[80:83], v8 offset:640
    ds_read_b128 v[84:87], v8 offset:17280
    ds_read_b128 v[88:91], v8 offset:33920
    ds_read_b128 v[92:95], v8 offset:50560
    ds_read_b128 v[96:99], v9 offset:640
    ds_read_b128 v[100:103], v9 offset:17280
    ds_read_b128 v[104:107], v9 offset:33920
    ds_read_b128 v[108:111], v9 offset:50560
    s_waitcnt vmcnt(2) lgkmcnt(8)
    v_mfma_f32_16x16x32_bf16 v[16:19], v[112:115], v[152:155], v[16:19]
    v_mfma_f32_16x16x32_bf16 v[48:51], v[112:115], v[156:159], v[48:51]
    v_mfma_f32_16x16x32_bf16 v[20:23], v[116:119], v[152:155], v[20:23]
    v_mfma_f32_16x16x32_bf16 v[52:55], v[116:119], v[156:159], v[52:55]
    v_mfma_f32_16x16x32_bf16 v[24:27], v[120:123], v[152:155], v[24:27]
    v_mfma_f32_16x16x32_bf16 v[56:59], v[120:123], v[156:159], v[56:59]
    v_mfma_f32_16x16x32_bf16 v[28:31], v[124:127], v[152:155], v[28:31]
    v_mfma_f32_16x16x32_bf16 v[60:63], v[124:127], v[156:159], v[60:63]
    v_mfma_f32_16x16x32_bf16 v[32:35], v[128:131], v[152:155], v[32:35]
    v_mfma_f32_16x16x32_bf16 v[64:67], v[128:131], v[156:159], v[64:67]
    v_mfma_f32_16x16x32_bf16 v[36:39], v[132:135], v[152:155], v[36:39]
    v_mfma_f32_16x16x32_bf16 v[68:71], v[132:135], v[156:159], v[68:71]
    v_mfma_f32_16x16x32_bf16 v[40:43], v[136:139], v[152:155], v[40:43]
    v_mfma_f32_16x16x32_bf16 v[72:75], v[136:139], v[156:159], v[72:75]
    v_mfma_f32_16x16x32_bf16 v[44:47], v[140:143], v[152:155], v[44:47]
    v_mfma_f32_16x16x32_bf16 v[76:79], v[140:143], v[156:159], v[76:79]
    s_add_u32 s19, s22, 11264
    buffer_load_dwordx4 v[152:155], v7, s[8:11], s19 offen
    s_add_u32 s19, s22, 27648
    buffer_load_dwordx4 v[156:159], v7, s[8:11], s19 offen
    ds_read_b128 v[112:115], v8 offset:704
    ds_read_b128 v[116:119], v8 offset:17344
    ds_read_b128 v[120:123], v8 offset:33984
    ds_read_b128 v[124:127], v8 offset:50624
    ds_read_b128 v[128:131], v9 offset:704
    ds_read_b128 v[132:135], v9 offset:17344
    ds_read_b128 v[136:139], v9 offset:33984
    ds_read_b128 v[140:143], v9 offset:50624
    s_waitcnt vmcnt(2) lgkmcnt(8)
    v_mfma_f32_16x16x32_bf16 v[16:19], v[80:83], v[144:147], v[16:19]
    v_mfma_f32_16x16x32_bf16 v[48:51], v[80:83], v[148:151], v[48:51]
    v_mfma_f32_16x16x32_bf16 v[20:23], v[84:87], v[144:147], v[20:23]
    v_mfma_f32_16x16x32_bf16 v[52:55], v[84:87], v[148:151], v[52:55]
    v_mfma_f32_16x16x32_bf16 v[24:27], v[88:91], v[144:147], v[24:27]
    v_mfma_f32_16x16x32_bf16 v[56:59], v[88:91], v[148:151], v[56:59]
    v_mfma_f32_16x16x32_bf16 v[28:31], v[92:95], v[144:147], v[28:31]
    v_mfma_f32_16x16x32_bf16 v[60:63], v[92:95], v[148:151], v[60:63]
    v_mfma_f32_16x16x32_bf16 v[32:35], v[96:99], v[144:147], v[32:35]
    v_mfma_f32_16x16x32_bf16 v[64:67], v[96:99], v[148:151], v[64:67]
    v_mfma_f32_16x16x32_bf16 v[36:39], v[100:103], v[144:147], v[36:39]
    v_mfma_f32_16x16x32_bf16 v[68:71], v[100:103], v[148:151], v[68:71]
    v_mfma_f32_16x16x32_bf16 v[40:43], v[104:107], v[144:147], v[40:43]
    v_mfma_f32_16x16x32_bf16 v[72:75], v[104:107], v[148:151], v[72:75]
    v_mfma_f32_16x16x32_bf16 v[44:47], v[108:111], v[144:147], v[44:47]
    v_mfma_f32_16x16x32_bf16 v[76:79], v[108:111], v[148:151], v[76:79]
    s_add_u32 s19, s22, 12288
    buffer_load_dwordx4 v[144:147], v7, s[8:11], s19 offen
    s_add_u32 s19, s22, 28672
    buffer_load_dwordx4 v[148:151], v7, s[8:11], s19 offen
    ds_read_b128 v[80:83], v8 offset:768
    ds_read_b128 v[84:87], v8 offset:17408
    ds_read_b128 v[88:91], v8 offset:34048
    ds_read_b128 v[92:95], v8 offset:50688
    ds_read_b128 v[96:99], v9 offset:768
    ds_read_b128 v[100:103], v9 offset:17408
    ds_read_b128 v[104:107], v9 offset:34048
    ds_read_b128 v[108:111], v9 offset:50688
    s_waitcnt vmcnt(2) lgkmcnt(8)
    v_mfma_f32_16x16x32_bf16 v[16:19], v[112:115], v[152:155], v[16:19]
    v_mfma_f32_16x16x32_bf16 v[48:51], v[112:115], v[156:159], v[48:51]
    v_mfma_f32_16x16x32_bf16 v[20:23], v[116:119], v[152:155], v[20:23]
    v_mfma_f32_16x16x32_bf16 v[52:55], v[116:119], v[156:159], v[52:55]
    v_mfma_f32_16x16x32_bf16 v[24:27], v[120:123], v[152:155], v[24:27]
    v_mfma_f32_16x16x32_bf16 v[56:59], v[120:123], v[156:159], v[56:59]
    v_mfma_f32_16x16x32_bf16 v[28:31], v[124:127], v[152:155], v[28:31]
    v_mfma_f32_16x16x32_bf16 v[60:63], v[124:127], v[156:159], v[60:63]
    v_mfma_f32_16x16x32_bf16 v[32:35], v[128:131], v[152:155], v[32:35]
    v_mfma_f32_16x16x32_bf16 v[64:67], v[128:131], v[156:159], v[64:67]
    v_mfma_f32_16x16x32_bf16 v[36:39], v[132:135], v[152:155], v[36:39]
    v_mfma_f32_16x16x32_bf16 v[68:71], v[132:135], v[156:159], v[68:71]
    v_mfma_f32_16x16x32_bf16 v[40:43], v[136:139], v[152:155], v[40:43]
    v_mfma_f32_16x16x32_bf16 v[72:75], v[136:139], v[156:159], v[72:75]
    v_mfma_f32_16x16x32_bf16 v[44:47], v[140:143], v[152:155], v[44:47]
    v_mfma_f32_16x16x32_bf16 v[76:79], v[140:143], v[156:159], v[76:79]
    s_add_u32 s19, s22, 13312
    buffer_load_dwordx4 v[152:155], v7, s[8:11], s19 offen
    s_add_u32 s19, s22, 29696
    buffer_load_dwordx4 v[156:159], v7, s[8:11], s19 offen
    ds_read_b128 v[112:115], v8 offset:832
    ds_read_b128 v[116:119], v8 offset:17472
    ds_read_b128 v[120:123], v8 offset:34112
    ds_read_b128 v[124:127], v8 offset:50752
    ds_read_b128 v[128:131], v9 offset:832
    ds_read_b128 v[132:135], v9 offset:17472
    ds_read_b128 v[136:139], v9 offset:34112
    ds_read_b128 v[140:143], v9 offset:50752
    s_waitcnt vmcnt(2) lgkmcnt(8)
    v_mfma_f32_16x16x32_bf16 v[16:19], v[80:83], v[144:147], v[16:19]
    v_mfma_f32_16x16x32_bf16 v[48:51], v[80:83], v[148:151], v[48:51]
    v_mfma_f32_16x16x32_bf16 v[20:23], v[84:87], v[144:147], v[20:23]
    v_mfma_f32_16x16x32_bf16 v[52:55], v[84:87], v[148:151], v[52:55]
    v_mfma_f32_16x16x32_bf16 v[24:27], v[88:91], v[144:147], v[24:27]
    v_mfma_f32_16x16x32_bf16 v[56:59], v[88:91], v[148:151], v[56:59]
    v_mfma_f32_16x16x32_bf16 v[28:31], v[92:95], v[144:147], v[28:31]
    v_mfma_f32_16x16x32_bf16 v[60:63], v[92:95], v[148:151], v[60:63]
    v_mfma_f32_16x16x32_bf16 v[32:35], v[96:99], v[144:147], v[32:35]
    v_mfma_f32_16x16x32_bf16 v[64:67], v[96:99], v[148:151], v[64:67]
    v_mfma_f32_16x16x32_bf16 v[36:39], v[100:103], v[144:147], v[36:39]
    v_mfma_f32_16x16x32_bf16 v[68:71], v[100:103], v[148:151], v[68:71]
    v_mfma_f32_16x16x32_bf16 v[40:43], v[104:107], v[144:147], v[40:43]
    v_mfma_f32_16x16x32_bf16 v[72:75], v[104:107], v[148:151], v[72:75]
    v_mfma_f32_16x16x32_bf16 v[44:47], v[108:111], v[144:147], v[44:47]
    v_mfma_f32_16x16x32_bf16 v[76:79], v[108:111], v[148:151], v[76:79]
    s_add_u32 s19, s22, 14336
    buffer_load_dwordx4 v[144:147], v7, s[8:11], s19 offen
    s_add_u32 s19, s22, 30720
    buffer_load_dwordx4 v[148:151], v7, s[8:11], s19 offen
    ds_read_b128 v[80:83], v8 offset:896
    ds_read_b128 v[84:87], v8 offset:17536
    ds_read_b128 v[88:91], v8 offset:34176
    ds_read_b128 v[92:95], v8 offset:50816
    ds_read_b128 v[96:99], v9 offset:896
    ds_read_b128 v[100:103], v9 offset:17536
    ds_read_b128 v[104:107], v9 offset:34176
    ds_read_b128 v[108:111], v9 offset:50816
    s_waitcnt vmcnt(2) lgkmcnt(8)
    v_mfma_f32_16x16x32_bf16 v[16:19], v[112:115], v[152:155], v[16:19]
    v_mfma_f32_16x16x32_bf16 v[48:51], v[112:115], v[156:159], v[48:51]
    v_mfma_f32_16x16x32_bf16 v[20:23], v[116:119], v[152:155], v[20:23]
    v_mfma_f32_16x16x32_bf16 v[52:55], v[116:119], v[156:159], v[52:55]
    v_mfma_f32_16x16x32_bf16 v[24:27], v[120:123], v[152:155], v[24:27]
    v_mfma_f32_16x16x32_bf16 v[56:59], v[120:123], v[156:159], v[56:59]
    v_mfma_f32_16x16x32_bf16 v[28:31], v[124:127], v[152:155], v[28:31]
    v_mfma_f32_16x16x32_bf16 v[60:63], v[124:127], v[156:159], v[60:63]
    v_mfma_f32_16x16x32_bf16 v[32:35], v[128:131], v[152:155], v[32:35]
    v_mfma_f32_16x16x32_bf16 v[64:67], v[128:131], v[156:159], v[64:67]
    v_mfma_f32_16x16x32_bf16 v[36:39], v[132:135], v[152:155], v[36:39]
    v_mfma_f32_16x16x32_bf16 v[68:71], v[132:135], v[156:159], v[68:71]
    v_mfma_f32_16x16x32_bf16 v[40:43], v[136:139], v[152:155], v[40:43]
    v_mfma_f32_16x16x32_bf16 v[72:75], v[136:139], v[156:159], v[72:75]
    v_mfma_f32_16x16x32_bf16 v[44:47], v[140:143], v[152:155], v[44:47]
    v_mfma_f32_16x16x32_bf16 v[76:79], v[140:143], v[156:159], v[76:79]
    s_add_u32 s19, s22, 15360
    buffer_load_dwordx4 v[152:155], v7, s[8:11], s19 offen
    s_add_u32 s19, s22, 31744
    buffer_load_dwordx4 v[156:159], v7, s[8:11], s19 offen
    ds_read_b128 v[112:115], v8 offset:960
    ds_read_b128 v[116:119], v8 offset:17600
    ds_read_b128 v[120:123], v8 offset:34240
    ds_read_b128 v[124:127], v8 offset:50880
    ds_read_b128 v[128:131], v9 offset:960
    ds_read_b128 v[132:135], v9 offset:17600
    ds_read_b128 v[136:139], v9 offset:34240
    ds_read_b128 v[140:143], v9 offset:50880
    s_waitcnt vmcnt(2) lgkmcnt(8)
    v_mfma_f32_16x16x32_bf16 v[16:19], v[80:83], v[144:147], v[16:19]
    v_mfma_f32_16x16x32_bf16 v[48:51], v[80:83], v[148:151], v[48:51]
    v_mfma_f32_16x16x32_bf16 v[20:23], v[84:87], v[144:147], v[20:23]
    v_mfma_f32_16x16x32_bf16 v[52:55], v[84:87], v[148:151], v[52:55]
    v_mfma_f32_16x16x32_bf16 v[24:27], v[88:91], v[144:147], v[24:27]
    v_mfma_f32_16x16x32_bf16 v[56:59], v[88:91], v[148:151], v[56:59]
    v_mfma_f32_16x16x32_bf16 v[28:31], v[92:95], v[144:147], v[28:31]
    v_mfma_f32_16x16x32_bf16 v[60:63], v[92:95], v[148:151], v[60:63]
    v_mfma_f32_16x16x32_bf16 v[32:35], v[96:99], v[144:147], v[32:35]
    v_mfma_f32_16x16x32_bf16 v[64:67], v[96:99], v[148:151], v[64:67]
    v_mfma_f32_16x16x32_bf16 v[36:39], v[100:103], v[144:147], v[36:39]
    v_mfma_f32_16x16x32_bf16 v[68:71], v[100:103], v[148:151], v[68:71]
    v_mfma_f32_16x16x32_bf16 v[40:43], v[104:107], v[144:147], v[40:43]
    v_mfma_f32_16x16x32_bf16 v[72:75], v[104:107], v[148:151], v[72:75]
    v_mfma_f32_16x16x32_bf16 v[44:47], v[108:111], v[144:147], v[44:47]
    v_mfma_f32_16x16x32_bf16 v[76:79], v[108:111], v[148:151], v[76:79]
    s_waitcnt vmcnt(0) lgkmcnt(0)
    v_mfma_f32_16x16x32_bf16 v[16:19], v[112:115], v[152:155], v[16:19]
    v_mfma_f32_16x16x32_bf16 v[48:51], v[112:115], v[156:159], v[48:51]
    v_mfma_f32_16x16x32_bf16 v[20:23], v[116:119], v[152:155], v[20:23]
    v_mfma_f32_16x16x32_bf16 v[52:55], v[116:119], v[156:159], v[52:55]
    v_mfma_f32_16x16x32_bf16 v[24:27], v[120:123], v[152:155], v[24:27]
    v_mfma_f32_16x16x32_bf16 v[56:59], v[120:123], v[156:159], v[56:59]
    v_mfma_f32_16x16x32_bf16 v[28:31], v[124:127], v[152:155], v[28:31]
    v_mfma_f32_16x16x32_bf16 v[60:63], v[124:127], v[156:159], v[60:63]
    v_mfma_f32_16x16x32_bf16 v[32:35], v[128:131], v[152:155], v[32:35]
    v_mfma_f32_16x16x32_bf16 v[64:67], v[128:131], v[156:159], v[64:67]
    v_mfma_f32_16x16x32_bf16 v[36:39], v[132:135], v[152:155], v[36:39]
    v_mfma_f32_16x16x32_bf16 v[68:71], v[132:135], v[156:159], v[68:71]
    v_mfma_f32_16x16x32_bf16 v[40:43], v[136:139], v[152:155], v[40:43]
    v_mfma_f32_16x16x32_bf16 v[72:75], v[136:139], v[156:159], v[72:75]
    v_mfma_f32_16x16x32_bf16 v[44:47], v[140:143], v[152:155], v[44:47]
    v_mfma_f32_16x16x32_bf16 v[76:79], v[140:143], v[156:159], v[76:79]
    s_nop 7
    s_lshl_b32 s23, s3, 2
    s_lshl_b32 s23, s23, 5
    s_add_u32 s23, s23, s6
    s_lshl_b32 s23, s23, 13
    s_lshl_b32 s19, s16, 11
    s_add_u32 s23, s23, s19
    s_add_u32 s23, s23, 67108864
    v_cvt_pk_bf16_f32 v80, v16, v17
    v_cvt_pk_bf16_f32 v81, v18, v19
    v_cvt_pk_bf16_f32 v82, v20, v21
    v_cvt_pk_bf16_f32 v83, v22, v23
    s_add_u32 s19, s23, 0
    buffer_store_dwordx4 v[80:83], v7, s[8:11], s19 offen sc1
    s_nop 1
    v_cvt_pk_bf16_f32 v84, v48, v49
    v_cvt_pk_bf16_f32 v85, v50, v51
    v_cvt_pk_bf16_f32 v86, v52, v53
    v_cvt_pk_bf16_f32 v87, v54, v55
    s_add_u32 s19, s23, 1024
    buffer_store_dwordx4 v[84:87], v7, s[8:11], s19 offen sc1
    s_nop 1
    v_cvt_pk_bf16_f32 v80, v24, v25
    v_cvt_pk_bf16_f32 v81, v26, v27
    v_cvt_pk_bf16_f32 v82, v28, v29
    v_cvt_pk_bf16_f32 v83, v30, v31
    s_add_u32 s19, s23, 262144
    buffer_store_dwordx4 v[80:83], v7, s[8:11], s19 offen sc1
    s_nop 1
    v_cvt_pk_bf16_f32 v84, v56, v57
    v_cvt_pk_bf16_f32 v85, v58, v59
    v_cvt_pk_bf16_f32 v86, v60, v61
    v_cvt_pk_bf16_f32 v87, v62, v63
    s_add_u32 s19, s23, 263168
    buffer_store_dwordx4 v[84:87], v7, s[8:11], s19 offen sc1
    s_nop 1
    v_cvt_pk_bf16_f32 v80, v32, v33
    v_cvt_pk_bf16_f32 v81, v34, v35
    v_cvt_pk_bf16_f32 v82, v36, v37
    v_cvt_pk_bf16_f32 v83, v38, v39
    s_add_u32 s19, s23, 524288
    buffer_store_dwordx4 v[80:83], v7, s[8:11], s19 offen sc1
    s_nop 1
    v_cvt_pk_bf16_f32 v84, v64, v65
    v_cvt_pk_bf16_f32 v85, v66, v67
    v_cvt_pk_bf16_f32 v86, v68, v69
    v_cvt_pk_bf16_f32 v87, v70, v71
    s_add_u32 s19, s23, 525312
    buffer_store_dwordx4 v[84:87], v7, s[8:11], s19 offen sc1
    s_nop 1
    v_cvt_pk_bf16_f32 v80, v40, v41
    v_cvt_pk_bf16_f32 v81, v42, v43
    v_cvt_pk_bf16_f32 v82, v44, v45
    v_cvt_pk_bf16_f32 v83, v46, v47
    s_add_u32 s19, s23, 786432
    buffer_store_dwordx4 v[80:83], v7, s[8:11], s19 offen sc1
    s_nop 1
    v_cvt_pk_bf16_f32 v84, v72, v73
    v_cvt_pk_bf16_f32 v85, v74, v75
    v_cvt_pk_bf16_f32 v86, v76, v77
    v_cvt_pk_bf16_f32 v87, v78, v79
    s_add_u32 s19, s23, 787456
    buffer_store_dwordx4 v[84:87], v7, s[8:11], s19 offen sc1
    s_nop 1
    s_lshl_b32 s6, s26, 1
    s_add_u32 s6, s6, 1
    s_lshl_b32 s22, s6, 17
    s_lshl_b32 s19, s16, 15
    s_add_u32 s22, s22, s19
    s_add_u32 s22, s22, 0
    s_add_u32 s19, s22, 0
    buffer_load_dwordx4 v[144:147], v7, s[8:11], s19 offen
    s_add_u32 s19, s22, 16384
    buffer_load_dwordx4 v[148:151], v7, s[8:11], s19 offen
    ds_read_b128 v[80:83], v8 offset:0
    ds_read_b128 v[84:87], v8 offset:16640
    ds_read_b128 v[88:91], v8 offset:33280
    ds_read_b128 v[92:95], v8 offset:49920
    ds_read_b128 v[96:99], v9 offset:0
    ds_read_b128 v[100:103], v9 offset:16640
    ds_read_b128 v[104:107], v9 offset:33280
    ds_read_b128 v[108:111], v9 offset:49920
    s_add_u32 s19, s22, 1024
    buffer_load_dwordx4 v[152:155], v7, s[8:11], s19 offen
    s_add_u32 s19, s22, 17408
    buffer_load_dwordx4 v[156:159], v7, s[8:11], s19 offen
    ds_read_b128 v[112:115], v8 offset:64
    ds_read_b128 v[116:119], v8 offset:16704
    ds_read_b128 v[120:123], v8 offset:33344
    ds_read_b128 v[124:127], v8 offset:49984
    ds_read_b128 v[128:131], v9 offset:64
    ds_read_b128 v[132:135], v9 offset:16704
    ds_read_b128 v[136:139], v9 offset:33344
    ds_read_b128 v[140:143], v9 offset:49984
    s_waitcnt vmcnt(2) lgkmcnt(8)
    v_mfma_f32_16x16x32_bf16 v[16:19], v[144:147], v[80:83], 0
    v_mfma_f32_16x16x32_bf16 v[48:51], v[148:151], v[80:83], 0
    v_mfma_f32_16x16x32_bf16 v[20:23], v[144:147], v[84:87], 0
    v_mfma_f32_16x16x32_bf16 v[52:55], v[148:151], v[84:87], 0
    v_mfma_f32_16x16x32_bf16 v[24:27], v[144:147], v[88:91], 0
    v_mfma_f32_16x16x32_bf16 v[56:59], v[148:151], v[88:91], 0
    v_mfma_f32_16x16x32_bf16 v[28:31], v[144:147], v[92:95], 0
    v_mfma_f32_16x16x32_bf16 v[60:63], v[148:151], v[92:95], 0
    v_mfma_f32_16x16x32_bf16 v[32:35], v[144:147], v[96:99], 0
    v_mfma_f32_16x16x32_bf16 v[64:67], v[148:151], v[96:99], 0
    v_mfma_f32_16x16x32_bf16 v[36:39], v[144:147], v[100:103], 0
    v_mfma_f32_16x16x32_bf16 v[68:71], v[148:151], v[100:103], 0
    v_mfma_f32_16x16x32_bf16 v[40:43], v[144:147], v[104:107], 0
    v_mfma_f32_16x16x32_bf16 v[72:75], v[148:151], v[104:107], 0
    v_mfma_f32_16x16x32_bf16 v[44:47], v[144:147], v[108:111], 0
    v_mfma_f32_16x16x32_bf16 v[76:79], v[148:151], v[108:111], 0
    s_add_u32 s19, s22, 2048
    buffer_load_dwordx4 v[144:147], v7, s[8:11], s19 offen
    s_add_u32 s19, s22, 18432
    buffer_load_dwordx4 v[148:151], v7, s[8:11], s19 offen
    ds_read_b128 v[80:83], v8 offset:128
    ds_read_b128 v[84:87], v8 offset:16768
    ds_read_b128 v[88:91], v8 offset:33408
    ds_read_b128 v[92:95], v8 offset:50048
    ds_read_b128 v[96:99], v9 offset:128
    ds_read_b128 v[100:103], v9 offset:16768
    ds_read_b128 v[104:107], v9 offset:33408
    ds_read_b128 v[108:111], v9 offset:50048
    s_waitcnt vmcnt(2) lgkmcnt(8)
    v_mfma_f32_16x16x32_bf16 v[16:19], v[152:155], v[112:115], v[16:19]
    v_mfma_f32_16x16x32_bf16 v[48:51], v[156:159], v[112:115], v[48:51]
    v_mfma_f32_16x16x32_bf16 v[20:23], v[152:155], v[116:119], v[20:23]
    v_mfma_f32_16x16x32_bf16 v[52:55], v[156:159], v[116:119], v[52:55]
    v_mfma_f32_16x16x32_bf16 v[24:27], v[152:155], v[120:123], v[24:27]
    v_mfma_f32_16x16x32_bf16 v[56:59], v[156:159], v[120:123], v[56:59]
    v_mfma_f32_16x16x32_bf16 v[28:31], v[152:155], v[124:127], v[28:31]
    v_mfma_f32_16x16x32_bf16 v[60:63], v[156:159], v[124:127], v[60:63]
    v_mfma_f32_16x16x32_bf16 v[32:35], v[152:155], v[128:131], v[32:35]
    v_mfma_f32_16x16x32_bf16 v[64:67], v[156:159], v[128:131], v[64:67]
    v_mfma_f32_16x16x32_bf16 v[36:39], v[152:155], v[132:135], v[36:39]
    v_mfma_f32_16x16x32_bf16 v[68:71], v[156:159], v[132:135], v[68:71]
    v_mfma_f32_16x16x32_bf16 v[40:43], v[152:155], v[136:139], v[40:43]
    v_mfma_f32_16x16x32_bf16 v[72:75], v[156:159], v[136:139], v[72:75]
    v_mfma_f32_16x16x32_bf16 v[44:47], v[152:155], v[140:143], v[44:47]
    v_mfma_f32_16x16x32_bf16 v[76:79], v[156:159], v[140:143], v[76:79]
    s_add_u32 s19, s22, 3072
    buffer_load_dwordx4 v[152:155], v7, s[8:11], s19 offen
    s_add_u32 s19, s22, 19456
    buffer_load_dwordx4 v[156:159], v7, s[8:11], s19 offen
    ds_read_b128 v[112:115], v8 offset:192
    ds_read_b128 v[116:119], v8 offset:16832
    ds_read_b128 v[120:123], v8 offset:33472
    ds_read_b128 v[124:127], v8 offset:50112
    ds_read_b128 v[128:131], v9 offset:192
    ds_read_b128 v[132:135], v9 offset:16832
    ds_read_b128 v[136:139], v9 offset:33472
    ds_read_b128 v[140:143], v9 offset:50112
    s_waitcnt vmcnt(2) lgkmcnt(8)
    v_mfma_f32_16x16x32_bf16 v[16:19], v[144:147], v[80:83], v[16:19]
    v_mfma_f32_16x16x32_bf16 v[48:51], v[148:151], v[80:83], v[48:51]
    v_mfma_f32_16x16x32_bf16 v[20:23], v[144:147], v[84:87], v[20:23]
    v_mfma_f32_16x16x32_bf16 v[52:55], v[148:151], v[84:87], v[52:55]
    v_mfma_f32_16x16x32_bf16 v[24:27], v[144:147], v[88:91], v[24:27]
    v_mfma_f32_16x16x32_bf16 v[56:59], v[148:151], v[88:91], v[56:59]
    v_mfma_f32_16x16x32_bf16 v[28:31], v[144:147], v[92:95], v[28:31]
    v_mfma_f32_16x16x32_bf16 v[60:63], v[148:151], v[92:95], v[60:63]
    v_mfma_f32_16x16x32_bf16 v[32:35], v[144:147], v[96:99], v[32:35]
    v_mfma_f32_16x16x32_bf16 v[64:67], v[148:151], v[96:99], v[64:67]
    v_mfma_f32_16x16x32_bf16 v[36:39], v[144:147], v[100:103], v[36:39]
    v_mfma_f32_16x16x32_bf16 v[68:71], v[148:151], v[100:103], v[68:71]
    v_mfma_f32_16x16x32_bf16 v[40:43], v[144:147], v[104:107], v[40:43]
    v_mfma_f32_16x16x32_bf16 v[72:75], v[148:151], v[104:107], v[72:75]
    v_mfma_f32_16x16x32_bf16 v[44:47], v[144:147], v[108:111], v[44:47]
    v_mfma_f32_16x16x32_bf16 v[76:79], v[148:151], v[108:111], v[76:79]
    s_add_u32 s19, s22, 4096
    buffer_load_dwordx4 v[144:147], v7, s[8:11], s19 offen
    s_add_u32 s19, s22, 20480
    buffer_load_dwordx4 v[148:151], v7, s[8:11], s19 offen
    ds_read_b128 v[80:83], v8 offset:256
    ds_read_b128 v[84:87], v8 offset:16896
    ds_read_b128 v[88:91], v8 offset:33536
    ds_read_b128 v[92:95], v8 offset:50176
    ds_read_b128 v[96:99], v9 offset:256
    ds_read_b128 v[100:103], v9 offset:16896
    ds_read_b128 v[104:107], v9 offset:33536
    ds_read_b128 v[108:111], v9 offset:50176
    s_waitcnt vmcnt(2) lgkmcnt(8)
    v_mfma_f32_16x16x32_bf16 v[16:19], v[152:155], v[112:115], v[16:19]
    v_mfma_f32_16x16x32_bf16 v[48:51], v[156:159], v[112:115], v[48:51]
    v_mfma_f32_16x16x32_bf16 v[20:23], v[152:155], v[116:119], v[20:23]
    v_mfma_f32_16x16x32_bf16 v[52:55], v[156:159], v[116:119], v[52:55]
    v_mfma_f32_16x16x32_bf16 v[24:27], v[152:155], v[120:123], v[24:27]
    v_mfma_f32_16x16x32_bf16 v[56:59], v[156:159], v[120:123], v[56:59]
    v_mfma_f32_16x16x32_bf16 v[28:31], v[152:155], v[124:127], v[28:31]
    v_mfma_f32_16x16x32_bf16 v[60:63], v[156:159], v[124:127], v[60:63]
    v_mfma_f32_16x16x32_bf16 v[32:35], v[152:155], v[128:131], v[32:35]
    v_mfma_f32_16x16x32_bf16 v[64:67], v[156:159], v[128:131], v[64:67]
    v_mfma_f32_16x16x32_bf16 v[36:39], v[152:155], v[132:135], v[36:39]
    v_mfma_f32_16x16x32_bf16 v[68:71], v[156:159], v[132:135], v[68:71]
    v_mfma_f32_16x16x32_bf16 v[40:43], v[152:155], v[136:139], v[40:43]
    v_mfma_f32_16x16x32_bf16 v[72:75], v[156:159], v[136:139], v[72:75]
    v_mfma_f32_16x16x32_bf16 v[44:47], v[152:155], v[140:143], v[44:47]
    v_mfma_f32_16x16x32_bf16 v[76:79], v[156:159], v[140:143], v[76:79]
    s_add_u32 s19, s22, 5120
    buffer_load_dwordx4 v[152:155], v7, s[8:11], s19 offen
    s_add_u32 s19, s22, 21504
    buffer_load_dwordx4 v[156:159], v7, s[8:11], s19 offen
    ds_read_b128 v[112:115], v8 offset:320
    ds_read_b128 v[116:119], v8 offset:16960
    ds_read_b128 v[120:123], v8 offset:33600
    ds_read_b128 v[124:127], v8 offset:50240
    ds_read_b128 v[128:131], v9 offset:320
    ds_read_b128 v[132:135], v9 offset:16960
    ds_read_b128 v[136:139], v9 offset:33600
    ds_read_b128 v[140:143], v9 offset:50240
    s_waitcnt vmcnt(2) lgkmcnt(8)
    v_mfma_f32_16x16x32_bf16 v[16:19], v[144:147], v[80:83], v[16:19]
    v_mfma_f32_16x16x32_bf16 v[48:51], v[148:151], v[80:83], v[48:51]
    v_mfma_f32_16x16x32_bf16 v[20:23], v[144:147], v[84:87], v[20:23]
    v_mfma_f32_16x16x32_bf16 v[52:55], v[148:151], v[84:87], v[52:55]
    v_mfma_f32_16x16x32_bf16 v[24:27], v[144:147], v[88:91], v[24:27]
    v_mfma_f32_16x16x32_bf16 v[56:59], v[148:151], v[88:91], v[56:59]
    v_mfma_f32_16x16x32_bf16 v[28:31], v[144:147], v[92:95], v[28:31]
    v_mfma_f32_16x16x32_bf16 v[60:63], v[148:151], v[92:95], v[60:63]
    v_mfma_f32_16x16x32_bf16 v[32:35], v[144:147], v[96:99], v[32:35]
    v_mfma_f32_16x16x32_bf16 v[64:67], v[148:151], v[96:99], v[64:67]
    v_mfma_f32_16x16x32_bf16 v[36:39], v[144:147], v[100:103], v[36:39]
    v_mfma_f32_16x16x32_bf16 v[68:71], v[148:151], v[100:103], v[68:71]
    v_mfma_f32_16x16x32_bf16 v[40:43], v[144:147], v[104:107], v[40:43]
    v_mfma_f32_16x16x32_bf16 v[72:75], v[148:151], v[104:107], v[72:75]
    v_mfma_f32_16x16x32_bf16 v[44:47], v[144:147], v[108:111], v[44:47]
    v_mfma_f32_16x16x32_bf16 v[76:79], v[148:151], v[108:111], v[76:79]
    s_add_u32 s19, s22, 6144
    buffer_load_dwordx4 v[144:147], v7, s[8:11], s19 offen
    s_add_u32 s19, s22, 22528
    buffer_load_dwordx4 v[148:151], v7, s[8:11], s19 offen
    ds_read_b128 v[80:83], v8 offset:384
    ds_read_b128 v[84:87], v8 offset:17024
    ds_read_b128 v[88:91], v8 offset:33664
    ds_read_b128 v[92:95], v8 offset:50304
    ds_read_b128 v[96:99], v9 offset:384
    ds_read_b128 v[100:103], v9 offset:17024
    ds_read_b128 v[104:107], v9 offset:33664
    ds_read_b128 v[108:111], v9 offset:50304
    s_waitcnt vmcnt(2) lgkmcnt(8)
    v_mfma_f32_16x16x32_bf16 v[16:19], v[152:155], v[112:115], v[16:19]
    v_mfma_f32_16x16x32_bf16 v[48:51], v[156:159], v[112:115], v[48:51]
    v_mfma_f32_16x16x32_bf16 v[20:23], v[152:155], v[116:119], v[20:23]
    v_mfma_f32_16x16x32_bf16 v[52:55], v[156:159], v[116:119], v[52:55]
    v_mfma_f32_16x16x32_bf16 v[24:27], v[152:155], v[120:123], v[24:27]
    v_mfma_f32_16x16x32_bf16 v[56:59], v[156:159], v[120:123], v[56:59]
    v_mfma_f32_16x16x32_bf16 v[28:31], v[152:155], v[124:127], v[28:31]
    v_mfma_f32_16x16x32_bf16 v[60:63], v[156:159], v[124:127], v[60:63]
    v_mfma_f32_16x16x32_bf16 v[32:35], v[152:155], v[128:131], v[32:35]
    v_mfma_f32_16x16x32_bf16 v[64:67], v[156:159], v[128:131], v[64:67]
    v_mfma_f32_16x16x32_bf16 v[36:39], v[152:155], v[132:135], v[36:39]
    v_mfma_f32_16x16x32_bf16 v[68:71], v[156:159], v[132:135], v[68:71]
    v_mfma_f32_16x16x32_bf16 v[40:43], v[152:155], v[136:139], v[40:43]
    v_mfma_f32_16x16x32_bf16 v[72:75], v[156:159], v[136:139], v[72:75]
    v_mfma_f32_16x16x32_bf16 v[44:47], v[152:155], v[140:143], v[44:47]
    v_mfma_f32_16x16x32_bf16 v[76:79], v[156:159], v[140:143], v[76:79]
    s_add_u32 s19, s22, 7168
    buffer_load_dwordx4 v[152:155], v7, s[8:11], s19 offen
    s_add_u32 s19, s22, 23552
    buffer_load_dwordx4 v[156:159], v7, s[8:11], s19 offen
    ds_read_b128 v[112:115], v8 offset:448
    ds_read_b128 v[116:119], v8 offset:17088
    ds_read_b128 v[120:123], v8 offset:33728
    ds_read_b128 v[124:127], v8 offset:50368
    ds_read_b128 v[128:131], v9 offset:448
    ds_read_b128 v[132:135], v9 offset:17088
    ds_read_b128 v[136:139], v9 offset:33728
    ds_read_b128 v[140:143], v9 offset:50368
    s_waitcnt vmcnt(2) lgkmcnt(8)
    v_mfma_f32_16x16x32_bf16 v[16:19], v[144:147], v[80:83], v[16:19]
    v_mfma_f32_16x16x32_bf16 v[48:51], v[148:151], v[80:83], v[48:51]
    v_mfma_f32_16x16x32_bf16 v[20:23], v[144:147], v[84:87], v[20:23]
    v_mfma_f32_16x16x32_bf16 v[52:55], v[148:151], v[84:87], v[52:55]
    v_mfma_f32_16x16x32_bf16 v[24:27], v[144:147], v[88:91], v[24:27]
    v_mfma_f32_16x16x32_bf16 v[56:59], v[148:151], v[88:91], v[56:59]
    v_mfma_f32_16x16x32_bf16 v[28:31], v[144:147], v[92:95], v[28:31]
    v_mfma_f32_16x16x32_bf16 v[60:63], v[148:151], v[92:95], v[60:63]
    v_mfma_f32_16x16x32_bf16 v[32:35], v[144:147], v[96:99], v[32:35]
    v_mfma_f32_16x16x32_bf16 v[64:67], v[148:151], v[96:99], v[64:67]
    v_mfma_f32_16x16x32_bf16 v[36:39], v[144:147], v[100:103], v[36:39]
    v_mfma_f32_16x16x32_bf16 v[68:71], v[148:151], v[100:103], v[68:71]
    v_mfma_f32_16x16x32_bf16 v[40:43], v[144:147], v[104:107], v[40:43]
    v_mfma_f32_16x16x32_bf16 v[72:75], v[148:151], v[104:107], v[72:75]
    v_mfma_f32_16x16x32_bf16 v[44:47], v[144:147], v[108:111], v[44:47]
    v_mfma_f32_16x16x32_bf16 v[76:79], v[148:151], v[108:111], v[76:79]
    s_add_u32 s19, s22, 8192
    buffer_load_dwordx4 v[144:147], v7, s[8:11], s19 offen
    s_add_u32 s19, s22, 24576
    buffer_load_dwordx4 v[148:151], v7, s[8:11], s19 offen
    ds_read_b128 v[80:83], v8 offset:512
    ds_read_b128 v[84:87], v8 offset:17152
    ds_read_b128 v[88:91], v8 offset:33792
    ds_read_b128 v[92:95], v8 offset:50432
    ds_read_b128 v[96:99], v9 offset:512
    ds_read_b128 v[100:103], v9 offset:17152
    ds_read_b128 v[104:107], v9 offset:33792
    ds_read_b128 v[108:111], v9 offset:50432
    s_waitcnt vmcnt(2) lgkmcnt(8)
    v_mfma_f32_16x16x32_bf16 v[16:19], v[152:155], v[112:115], v[16:19]
    v_mfma_f32_16x16x32_bf16 v[48:51], v[156:159], v[112:115], v[48:51]
    v_mfma_f32_16x16x32_bf16 v[20:23], v[152:155], v[116:119], v[20:23]
    v_mfma_f32_16x16x32_bf16 v[52:55], v[156:159], v[116:119], v[52:55]
    v_mfma_f32_16x16x32_bf16 v[24:27], v[152:155], v[120:123], v[24:27]
    v_mfma_f32_16x16x32_bf16 v[56:59], v[156:159], v[120:123], v[56:59]
    v_mfma_f32_16x16x32_bf16 v[28:31], v[152:155], v[124:127], v[28:31]
    v_mfma_f32_16x16x32_bf16 v[60:63], v[156:159], v[124:127], v[60:63]
    v_mfma_f32_16x16x32_bf16 v[32:35], v[152:155], v[128:131], v[32:35]
    v_mfma_f32_16x16x32_bf16 v[64:67], v[156:159], v[128:131], v[64:67]
    v_mfma_f32_16x16x32_bf16 v[36:39], v[152:155], v[132:135], v[36:39]
    v_mfma_f32_16x16x32_bf16 v[68:71], v[156:159], v[132:135], v[68:71]
    v_mfma_f32_16x16x32_bf16 v[40:43], v[152:155], v[136:139], v[40:43]
    v_mfma_f32_16x16x32_bf16 v[72:75], v[156:159], v[136:139], v[72:75]
    v_mfma_f32_16x16x32_bf16 v[44:47], v[152:155], v[140:143], v[44:47]
    v_mfma_f32_16x16x32_bf16 v[76:79], v[156:159], v[140:143], v[76:79]
    s_add_u32 s19, s22, 9216
    buffer_load_dwordx4 v[152:155], v7, s[8:11], s19 offen
    s_add_u32 s19, s22, 25600
    buffer_load_dwordx4 v[156:159], v7, s[8:11], s19 offen
    ds_read_b128 v[112:115], v8 offset:576
    ds_read_b128 v[116:119], v8 offset:17216
    ds_read_b128 v[120:123], v8 offset:33856
    ds_read_b128 v[124:127], v8 offset:50496
    ds_read_b128 v[128:131], v9 offset:576
    ds_read_b128 v[132:135], v9 offset:17216
    ds_read_b128 v[136:139], v9 offset:33856
    ds_read_b128 v[140:143], v9 offset:50496
    s_waitcnt vmcnt(2) lgkmcnt(8)
    v_mfma_f32_16x16x32_bf16 v[16:19], v[144:147], v[80:83], v[16:19]
    v_mfma_f32_16x16x32_bf16 v[48:51], v[148:151], v[80:83], v[48:51]
    v_mfma_f32_16x16x32_bf16 v[20:23], v[144:147], v[84:87], v[20:23]
    v_mfma_f32_16x16x32_bf16 v[52:55], v[148:151], v[84:87], v[52:55]
    v_mfma_f32_16x16x32_bf16 v[24:27], v[144:147], v[88:91], v[24:27]
    v_mfma_f32_16x16x32_bf16 v[56:59], v[148:151], v[88:91], v[56:59]
    v_mfma_f32_16x16x32_bf16 v[28:31], v[144:147], v[92:95], v[28:31]
    v_mfma_f32_16x16x32_bf16 v[60:63], v[148:151], v[92:95], v[60:63]
    v_mfma_f32_16x16x32_bf16 v[32:35], v[144:147], v[96:99], v[32:35]
    v_mfma_f32_16x16x32_bf16 v[64:67], v[148:151], v[96:99], v[64:67]
    v_mfma_f32_16x16x32_bf16 v[36:39], v[144:147], v[100:103], v[36:39]
    v_mfma_f32_16x16x32_bf16 v[68:71], v[148:151], v[100:103], v[68:71]
    v_mfma_f32_16x16x32_bf16 v[40:43], v[144:147], v[104:107], v[40:43]
    v_mfma_f32_16x16x32_bf16 v[72:75], v[148:151], v[104:107], v[72:75]
    v_mfma_f32_16x16x32_bf16 v[44:47], v[144:147], v[108:111], v[44:47]
    v_mfma_f32_16x16x32_bf16 v[76:79], v[148:151], v[108:111], v[76:79]
    s_add_u32 s19, s22, 10240
    buffer_load_dwordx4 v[144:147], v7, s[8:11], s19 offen
    s_add_u32 s19, s22, 26624
    buffer_load_dwordx4 v[148:151], v7, s[8:11], s19 offen
    ds_read_b128 v[80:83], v8 offset:640
    ds_read_b128 v[84:87], v8 offset:17280
    ds_read_b128 v[88:91], v8 offset:33920
    ds_read_b128 v[92:95], v8 offset:50560
    ds_read_b128 v[96:99], v9 offset:640
    ds_read_b128 v[100:103], v9 offset:17280
    ds_read_b128 v[104:107], v9 offset:33920
    ds_read_b128 v[108:111], v9 offset:50560
    s_waitcnt vmcnt(2) lgkmcnt(8)
    v_mfma_f32_16x16x32_bf16 v[16:19], v[152:155], v[112:115], v[16:19]
    v_mfma_f32_16x16x32_bf16 v[48:51], v[156:159], v[112:115], v[48:51]
    v_mfma_f32_16x16x32_bf16 v[20:23], v[152:155], v[116:119], v[20:23]
    v_mfma_f32_16x16x32_bf16 v[52:55], v[156:159], v[116:119], v[52:55]
    v_mfma_f32_16x16x32_bf16 v[24:27], v[152:155], v[120:123], v[24:27]
    v_mfma_f32_16x16x32_bf16 v[56:59], v[156:159], v[120:123], v[56:59]
    v_mfma_f32_16x16x32_bf16 v[28:31], v[152:155], v[124:127], v[28:31]
    v_mfma_f32_16x16x32_bf16 v[60:63], v[156:159], v[124:127], v[60:63]
    v_mfma_f32_16x16x32_bf16 v[32:35], v[152:155], v[128:131], v[32:35]
    v_mfma_f32_16x16x32_bf16 v[64:67], v[156:159], v[128:131], v[64:67]
    v_mfma_f32_16x16x32_bf16 v[36:39], v[152:155], v[132:135], v[36:39]
    v_mfma_f32_16x16x32_bf16 v[68:71], v[156:159], v[132:135], v[68:71]
    v_mfma_f32_16x16x32_bf16 v[40:43], v[152:155], v[136:139], v[40:43]
    v_mfma_f32_16x16x32_bf16 v[72:75], v[156:159], v[136:139], v[72:75]
    v_mfma_f32_16x16x32_bf16 v[44:47], v[152:155], v[140:143], v[44:47]
    v_mfma_f32_16x16x32_bf16 v[76:79], v[156:159], v[140:143], v[76:79]
    s_add_u32 s19, s22, 11264
    buffer_load_dwordx4 v[152:155], v7, s[8:11], s19 offen
    s_add_u32 s19, s22, 27648
    buffer_load_dwordx4 v[156:159], v7, s[8:11], s19 offen
    ds_read_b128 v[112:115], v8 offset:704
    ds_read_b128 v[116:119], v8 offset:17344
    ds_read_b128 v[120:123], v8 offset:33984
    ds_read_b128 v[124:127], v8 offset:50624
    ds_read_b128 v[128:131], v9 offset:704
    ds_read_b128 v[132:135], v9 offset:17344
    ds_read_b128 v[136:139], v9 offset:33984
    ds_read_b128 v[140:143], v9 offset:50624
    s_waitcnt vmcnt(2) lgkmcnt(8)
    v_mfma_f32_16x16x32_bf16 v[16:19], v[144:147], v[80:83], v[16:19]
    v_mfma_f32_16x16x32_bf16 v[48:51], v[148:151], v[80:83], v[48:51]
    v_mfma_f32_16x16x32_bf16 v[20:23], v[144:147], v[84:87], v[20:23]
    v_mfma_f32_16x16x32_bf16 v[52:55], v[148:151], v[84:87], v[52:55]
    v_mfma_f32_16x16x32_bf16 v[24:27], v[144:147], v[88:91], v[24:27]
    v_mfma_f32_16x16x32_bf16 v[56:59], v[148:151], v[88:91], v[56:59]
    v_mfma_f32_16x16x32_bf16 v[28:31], v[144:147], v[92:95], v[28:31]
    v_mfma_f32_16x16x32_bf16 v[60:63], v[148:151], v[92:95], v[60:63]
    v_mfma_f32_16x16x32_bf16 v[32:35], v[144:147], v[96:99], v[32:35]
    v_mfma_f32_16x16x32_bf16 v[64:67], v[148:151], v[96:99], v[64:67]
    v_mfma_f32_16x16x32_bf16 v[36:39], v[144:147], v[100:103], v[36:39]
    v_mfma_f32_16x16x32_bf16 v[68:71], v[148:151], v[100:103], v[68:71]
    v_mfma_f32_16x16x32_bf16 v[40:43], v[144:147], v[104:107], v[40:43]
    v_mfma_f32_16x16x32_bf16 v[72:75], v[148:151], v[104:107], v[72:75]
    v_mfma_f32_16x16x32_bf16 v[44:47], v[144:147], v[108:111], v[44:47]
    v_mfma_f32_16x16x32_bf16 v[76:79], v[148:151], v[108:111], v[76:79]
    s_add_u32 s19, s22, 12288
    buffer_load_dwordx4 v[144:147], v7, s[8:11], s19 offen
    s_add_u32 s19, s22, 28672
    buffer_load_dwordx4 v[148:151], v7, s[8:11], s19 offen
    ds_read_b128 v[80:83], v8 offset:768
    ds_read_b128 v[84:87], v8 offset:17408
    ds_read_b128 v[88:91], v8 offset:34048
    ds_read_b128 v[92:95], v8 offset:50688
    ds_read_b128 v[96:99], v9 offset:768
    ds_read_b128 v[100:103], v9 offset:17408
    ds_read_b128 v[104:107], v9 offset:34048
    ds_read_b128 v[108:111], v9 offset:50688
    s_waitcnt vmcnt(2) lgkmcnt(8)
    v_mfma_f32_16x16x32_bf16 v[16:19], v[152:155], v[112:115], v[16:19]
    v_mfma_f32_16x16x32_bf16 v[48:51], v[156:159], v[112:115], v[48:51]
    v_mfma_f32_16x16x32_bf16 v[20:23], v[152:155], v[116:119], v[20:23]
    v_mfma_f32_16x16x32_bf16 v[52:55], v[156:159], v[116:119], v[52:55]
    v_mfma_f32_16x16x32_bf16 v[24:27], v[152:155], v[120:123], v[24:27]
    v_mfma_f32_16x16x32_bf16 v[56:59], v[156:159], v[120:123], v[56:59]
    v_mfma_f32_16x16x32_bf16 v[28:31], v[152:155], v[124:127], v[28:31]
    v_mfma_f32_16x16x32_bf16 v[60:63], v[156:159], v[124:127], v[60:63]
    v_mfma_f32_16x16x32_bf16 v[32:35], v[152:155], v[128:131], v[32:35]
    v_mfma_f32_16x16x32_bf16 v[64:67], v[156:159], v[128:131], v[64:67]
    v_mfma_f32_16x16x32_bf16 v[36:39], v[152:155], v[132:135], v[36:39]
    v_mfma_f32_16x16x32_bf16 v[68:71], v[156:159], v[132:135], v[68:71]
    v_mfma_f32_16x16x32_bf16 v[40:43], v[152:155], v[136:139], v[40:43]
    v_mfma_f32_16x16x32_bf16 v[72:75], v[156:159], v[136:139], v[72:75]
    v_mfma_f32_16x16x32_bf16 v[44:47], v[152:155], v[140:143], v[44:47]
    v_mfma_f32_16x16x32_bf16 v[76:79], v[156:159], v[140:143], v[76:79]
    s_add_u32 s19, s22, 13312
    buffer_load_dwordx4 v[152:155], v7, s[8:11], s19 offen
    s_add_u32 s19, s22, 29696
    buffer_load_dwordx4 v[156:159], v7, s[8:11], s19 offen
    ds_read_b128 v[112:115], v8 offset:832
    ds_read_b128 v[116:119], v8 offset:17472
    ds_read_b128 v[120:123], v8 offset:34112
    ds_read_b128 v[124:127], v8 offset:50752
    ds_read_b128 v[128:131], v9 offset:832
    ds_read_b128 v[132:135], v9 offset:17472
    ds_read_b128 v[136:139], v9 offset:34112
    ds_read_b128 v[140:143], v9 offset:50752
    s_waitcnt vmcnt(2) lgkmcnt(8)
    v_mfma_f32_16x16x32_bf16 v[16:19], v[144:147], v[80:83], v[16:19]
    v_mfma_f32_16x16x32_bf16 v[48:51], v[148:151], v[80:83], v[48:51]
    v_mfma_f32_16x16x32_bf16 v[20:23], v[144:147], v[84:87], v[20:23]
    v_mfma_f32_16x16x32_bf16 v[52:55], v[148:151], v[84:87], v[52:55]
    v_mfma_f32_16x16x32_bf16 v[24:27], v[144:147], v[88:91], v[24:27]
    v_mfma_f32_16x16x32_bf16 v[56:59], v[148:151], v[88:91], v[56:59]
    v_mfma_f32_16x16x32_bf16 v[28:31], v[144:147], v[92:95], v[28:31]
    v_mfma_f32_16x16x32_bf16 v[60:63], v[148:151], v[92:95], v[60:63]
    v_mfma_f32_16x16x32_bf16 v[32:35], v[144:147], v[96:99], v[32:35]
    v_mfma_f32_16x16x32_bf16 v[64:67], v[148:151], v[96:99], v[64:67]
    v_mfma_f32_16x16x32_bf16 v[36:39], v[144:147], v[100:103], v[36:39]
    v_mfma_f32_16x16x32_bf16 v[68:71], v[148:151], v[100:103], v[68:71]
    v_mfma_f32_16x16x32_bf16 v[40:43], v[144:147], v[104:107], v[40:43]
    v_mfma_f32_16x16x32_bf16 v[72:75], v[148:151], v[104:107], v[72:75]
    v_mfma_f32_16x16x32_bf16 v[44:47], v[144:147], v[108:111], v[44:47]
    v_mfma_f32_16x16x32_bf16 v[76:79], v[148:151], v[108:111], v[76:79]
    s_add_u32 s19, s22, 14336
    buffer_load_dwordx4 v[144:147], v7, s[8:11], s19 offen
    s_add_u32 s19, s22, 30720
    buffer_load_dwordx4 v[148:151], v7, s[8:11], s19 offen
    ds_read_b128 v[80:83], v8 offset:896
    ds_read_b128 v[84:87], v8 offset:17536
    ds_read_b128 v[88:91], v8 offset:34176
    ds_read_b128 v[92:95], v8 offset:50816
    ds_read_b128 v[96:99], v9 offset:896
    ds_read_b128 v[100:103], v9 offset:17536
    ds_read_b128 v[104:107], v9 offset:34176
    ds_read_b128 v[108:111], v9 offset:50816
    s_waitcnt vmcnt(2) lgkmcnt(8)
    v_mfma_f32_16x16x32_bf16 v[16:19], v[152:155], v[112:115], v[16:19]
    v_mfma_f32_16x16x32_bf16 v[48:51], v[156:159], v[112:115], v[48:51]
    v_mfma_f32_16x16x32_bf16 v[20:23], v[152:155], v[116:119], v[20:23]
    v_mfma_f32_16x16x32_bf16 v[52:55], v[156:159], v[116:119], v[52:55]
    v_mfma_f32_16x16x32_bf16 v[24:27], v[152:155], v[120:123], v[24:27]
    v_mfma_f32_16x16x32_bf16 v[56:59], v[156:159], v[120:123], v[56:59]
    v_mfma_f32_16x16x32_bf16 v[28:31], v[152:155], v[124:127], v[28:31]
    v_mfma_f32_16x16x32_bf16 v[60:63], v[156:159], v[124:127], v[60:63]
    v_mfma_f32_16x16x32_bf16 v[32:35], v[152:155], v[128:131], v[32:35]
    v_mfma_f32_16x16x32_bf16 v[64:67], v[156:159], v[128:131], v[64:67]
    v_mfma_f32_16x16x32_bf16 v[36:39], v[152:155], v[132:135], v[36:39]
    v_mfma_f32_16x16x32_bf16 v[68:71], v[156:159], v[132:135], v[68:71]
    v_mfma_f32_16x16x32_bf16 v[40:43], v[152:155], v[136:139], v[40:43]
    v_mfma_f32_16x16x32_bf16 v[72:75], v[156:159], v[136:139], v[72:75]
    v_mfma_f32_16x16x32_bf16 v[44:47], v[152:155], v[140:143], v[44:47]
    v_mfma_f32_16x16x32_bf16 v[76:79], v[156:159], v[140:143], v[76:79]
    s_add_u32 s19, s22, 15360
    buffer_load_dwordx4 v[152:155], v7, s[8:11], s19 offen
    s_add_u32 s19, s22, 31744
    buffer_load_dwordx4 v[156:159], v7, s[8:11], s19 offen
    ds_read_b128 v[112:115], v8 offset:960
    ds_read_b128 v[116:119], v8 offset:17600
    ds_read_b128 v[120:123], v8 offset:34240
    ds_read_b128 v[124:127], v8 offset:50880
    ds_read_b128 v[128:131], v9 offset:960
    ds_read_b128 v[132:135], v9 offset:17600
    ds_read_b128 v[136:139], v9 offset:34240
    ds_read_b128 v[140:143], v9 offset:50880
    s_waitcnt vmcnt(2) lgkmcnt(8)
    v_mfma_f32_16x16x32_bf16 v[16:19], v[144:147], v[80:83], v[16:19]
    v_mfma_f32_16x16x32_bf16 v[48:51], v[148:151], v[80:83], v[48:51]
    v_mfma_f32_16x16x32_bf16 v[20:23], v[144:147], v[84:87], v[20:23]
    v_mfma_f32_16x16x32_bf16 v[52:55], v[148:151], v[84:87], v[52:55]
    v_mfma_f32_16x16x32_bf16 v[24:27], v[144:147], v[88:91], v[24:27]
    v_mfma_f32_16x16x32_bf16 v[56:59], v[148:151], v[88:91], v[56:59]
    v_mfma_f32_16x16x32_bf16 v[28:31], v[144:147], v[92:95], v[28:31]
    v_mfma_f32_16x16x32_bf16 v[60:63], v[148:151], v[92:95], v[60:63]
    v_mfma_f32_16x16x32_bf16 v[32:35], v[144:147], v[96:99], v[32:35]
    v_mfma_f32_16x16x32_bf16 v[64:67], v[148:151], v[96:99], v[64:67]
    v_mfma_f32_16x16x32_bf16 v[36:39], v[144:147], v[100:103], v[36:39]
    v_mfma_f32_16x16x32_bf16 v[68:71], v[148:151], v[100:103], v[68:71]
    v_mfma_f32_16x16x32_bf16 v[40:43], v[144:147], v[104:107], v[40:43]
    v_mfma_f32_16x16x32_bf16 v[72:75], v[148:151], v[104:107], v[72:75]
    v_mfma_f32_16x16x32_bf16 v[44:47], v[144:147], v[108:111], v[44:47]
    v_mfma_f32_16x16x32_bf16 v[76:79], v[148:151], v[108:111], v[76:79]
    s_waitcnt vmcnt(0) lgkmcnt(0)
    v_mfma_f32_16x16x32_bf16 v[16:19], v[152:155], v[112:115], v[16:19]
    v_mfma_f32_16x16x32_bf16 v[48:51], v[156:159], v[112:115], v[48:51]
    v_mfma_f32_16x16x32_bf16 v[20:23], v[152:155], v[116:119], v[20:23]
    v_mfma_f32_16x16x32_bf16 v[52:55], v[156:159], v[116:119], v[52:55]
    v_mfma_f32_16x16x32_bf16 v[24:27], v[152:155], v[120:123], v[24:27]
    v_mfma_f32_16x16x32_bf16 v[56:59], v[156:159], v[120:123], v[56:59]
    v_mfma_f32_16x16x32_bf16 v[28:31], v[152:155], v[124:127], v[28:31]
    v_mfma_f32_16x16x32_bf16 v[60:63], v[156:159], v[124:127], v[60:63]
    v_mfma_f32_16x16x32_bf16 v[32:35], v[152:155], v[128:131], v[32:35]
    v_mfma_f32_16x16x32_bf16 v[64:67], v[156:159], v[128:131], v[64:67]
    v_mfma_f32_16x16x32_bf16 v[36:39], v[152:155], v[132:135], v[36:39]
    v_mfma_f32_16x16x32_bf16 v[68:71], v[156:159], v[132:135], v[68:71]
    v_mfma_f32_16x16x32_bf16 v[40:43], v[152:155], v[136:139], v[40:43]
    v_mfma_f32_16x16x32_bf16 v[72:75], v[156:159], v[136:139], v[72:75]
    v_mfma_f32_16x16x32_bf16 v[44:47], v[152:155], v[140:143], v[44:47]
    v_mfma_f32_16x16x32_bf16 v[76:79], v[156:159], v[140:143], v[76:79]
    s_nop 7
    s_lshl_b32 s23, s3, 2
    s_lshl_b32 s23, s23, 5
    s_add_u32 s23, s23, s6
    s_lshl_b32 s23, s23, 13
    s_lshl_b32 s19, s16, 11
    s_add_u32 s23, s23, s19
    s_add_u32 s23, s23, 83886080
    v_cvt_pk_bf16_f32 v80, v16, v17
    v_cvt_pk_bf16_f32 v81, v18, v19
    v_cvt_pk_bf16_f32 v82, v48, v49
    v_cvt_pk_bf16_f32 v83, v50, v51
    s_add_u32 s19, s23, 0
    buffer_store_dwordx4 v[80:83], v7, s[8:11], s19 offen sc1
    s_nop 1
    v_cvt_pk_bf16_f32 v84, v20, v21
    v_cvt_pk_bf16_f32 v85, v22, v23
    v_cvt_pk_bf16_f32 v86, v52, v53
    v_cvt_pk_bf16_f32 v87, v54, v55
    s_add_u32 s19, s23, 1024
    buffer_store_dwordx4 v[84:87], v7, s[8:11], s19 offen sc1
    s_nop 1
    v_cvt_pk_bf16_f32 v80, v24, v25
    v_cvt_pk_bf16_f32 v81, v26, v27
    v_cvt_pk_bf16_f32 v82, v56, v57
    v_cvt_pk_bf16_f32 v83, v58, v59
    s_add_u32 s19, s23, 262144
    buffer_store_dwordx4 v[80:83], v7, s[8:11], s19 offen sc1
    s_nop 1
    v_cvt_pk_bf16_f32 v84, v28, v29
    v_cvt_pk_bf16_f32 v85, v30, v31
    v_cvt_pk_bf16_f32 v86, v60, v61
    v_cvt_pk_bf16_f32 v87, v62, v63
    s_add_u32 s19, s23, 263168
    buffer_store_dwordx4 v[84:87], v7, s[8:11], s19 offen sc1
    s_nop 1
    v_cvt_pk_bf16_f32 v80, v32, v33
    v_cvt_pk_bf16_f32 v81, v34, v35
    v_cvt_pk_bf16_f32 v82, v64, v65
    v_cvt_pk_bf16_f32 v83, v66, v67
    s_add_u32 s19, s23, 524288
    buffer_store_dwordx4 v[80:83], v7, s[8:11], s19 offen sc1
    s_nop 1
    v_cvt_pk_bf16_f32 v84, v36, v37
    v_cvt_pk_bf16_f32 v85, v38, v39
    v_cvt_pk_bf16_f32 v86, v68, v69
    v_cvt_pk_bf16_f32 v87, v70, v71
    s_add_u32 s19, s23, 525312
    buffer_store_dwordx4 v[84:87], v7, s[8:11], s19 offen sc1
    s_nop 1
    v_cvt_pk_bf16_f32 v80, v40, v41
    v_cvt_pk_bf16_f32 v81, v42, v43
    v_cvt_pk_bf16_f32 v82, v72, v73
    v_cvt_pk_bf16_f32 v83, v74, v75
    s_add_u32 s19, s23, 786432
    buffer_store_dwordx4 v[80:83], v7, s[8:11], s19 offen sc1
    s_nop 1
    v_cvt_pk_bf16_f32 v84, v44, v45
    v_cvt_pk_bf16_f32 v85, v46, v47
    v_cvt_pk_bf16_f32 v86, v76, v77
    v_cvt_pk_bf16_f32 v87, v78, v79
    s_add_u32 s19, s23, 787456
    buffer_store_dwordx4 v[84:87], v7, s[8:11], s19 offen sc1
    s_nop 1
    s_lshl_b32 s6, s26, 1
    s_add_u32 s6, s6, 1
    s_lshl_b32 s22, s6, 17
    s_lshl_b32 s19, s16, 15
    s_add_u32 s22, s22, s19
    s_add_u32 s22, s22, 4194304
    s_add_u32 s19, s22, 0
    buffer_load_dwordx4 v[144:147], v7, s[8:11], s19 offen
    s_add_u32 s19, s22, 16384
    buffer_load_dwordx4 v[148:151], v7, s[8:11], s19 offen
    ds_read_b128 v[80:83], v8 offset:0
    ds_read_b128 v[84:87], v8 offset:16640
    ds_read_b128 v[88:91], v8 offset:33280
    ds_read_b128 v[92:95], v8 offset:49920
    ds_read_b128 v[96:99], v9 offset:0
    ds_read_b128 v[100:103], v9 offset:16640
    ds_read_b128 v[104:107], v9 offset:33280
    ds_read_b128 v[108:111], v9 offset:49920
    s_add_u32 s19, s22, 1024
    buffer_load_dwordx4 v[152:155], v7, s[8:11], s19 offen
    s_add_u32 s19, s22, 17408
    buffer_load_dwordx4 v[156:159], v7, s[8:11], s19 offen
    ds_read_b128 v[112:115], v8 offset:64
    ds_read_b128 v[116:119], v8 offset:16704
    ds_read_b128 v[120:123], v8 offset:33344
    ds_read_b128 v[124:127], v8 offset:49984
    ds_read_b128 v[128:131], v9 offset:64
    ds_read_b128 v[132:135], v9 offset:16704
    ds_read_b128 v[136:139], v9 offset:33344
    ds_read_b128 v[140:143], v9 offset:49984
    s_waitcnt vmcnt(2) lgkmcnt(8)
    v_mfma_f32_16x16x32_bf16 v[16:19], v[144:147], v[80:83], 0
    v_mfma_f32_16x16x32_bf16 v[48:51], v[148:151], v[80:83], 0
    v_mfma_f32_16x16x32_bf16 v[20:23], v[144:147], v[84:87], 0
    v_mfma_f32_16x16x32_bf16 v[52:55], v[148:151], v[84:87], 0
    v_mfma_f32_16x16x32_bf16 v[24:27], v[144:147], v[88:91], 0
    v_mfma_f32_16x16x32_bf16 v[56:59], v[148:151], v[88:91], 0
    v_mfma_f32_16x16x32_bf16 v[28:31], v[144:147], v[92:95], 0
    v_mfma_f32_16x16x32_bf16 v[60:63], v[148:151], v[92:95], 0
    v_mfma_f32_16x16x32_bf16 v[32:35], v[144:147], v[96:99], 0
    v_mfma_f32_16x16x32_bf16 v[64:67], v[148:151], v[96:99], 0
    v_mfma_f32_16x16x32_bf16 v[36:39], v[144:147], v[100:103], 0
    v_mfma_f32_16x16x32_bf16 v[68:71], v[148:151], v[100:103], 0
    v_mfma_f32_16x16x32_bf16 v[40:43], v[144:147], v[104:107], 0
    v_mfma_f32_16x16x32_bf16 v[72:75], v[148:151], v[104:107], 0
    v_mfma_f32_16x16x32_bf16 v[44:47], v[144:147], v[108:111], 0
    v_mfma_f32_16x16x32_bf16 v[76:79], v[148:151], v[108:111], 0
    s_add_u32 s19, s22, 2048
    buffer_load_dwordx4 v[144:147], v7, s[8:11], s19 offen
    s_add_u32 s19, s22, 18432
    buffer_load_dwordx4 v[148:151], v7, s[8:11], s19 offen
    ds_read_b128 v[80:83], v8 offset:128
    ds_read_b128 v[84:87], v8 offset:16768
    ds_read_b128 v[88:91], v8 offset:33408
    ds_read_b128 v[92:95], v8 offset:50048
    ds_read_b128 v[96:99], v9 offset:128
    ds_read_b128 v[100:103], v9 offset:16768
    ds_read_b128 v[104:107], v9 offset:33408
    ds_read_b128 v[108:111], v9 offset:50048
    s_waitcnt vmcnt(2) lgkmcnt(8)
    v_mfma_f32_16x16x32_bf16 v[16:19], v[152:155], v[112:115], v[16:19]
    v_mfma_f32_16x16x32_bf16 v[48:51], v[156:159], v[112:115], v[48:51]
    v_mfma_f32_16x16x32_bf16 v[20:23], v[152:155], v[116:119], v[20:23]
    v_mfma_f32_16x16x32_bf16 v[52:55], v[156:159], v[116:119], v[52:55]
    v_mfma_f32_16x16x32_bf16 v[24:27], v[152:155], v[120:123], v[24:27]
    v_mfma_f32_16x16x32_bf16 v[56:59], v[156:159], v[120:123], v[56:59]
    v_mfma_f32_16x16x32_bf16 v[28:31], v[152:155], v[124:127], v[28:31]
    v_mfma_f32_16x16x32_bf16 v[60:63], v[156:159], v[124:127], v[60:63]
    v_mfma_f32_16x16x32_bf16 v[32:35], v[152:155], v[128:131], v[32:35]
    v_mfma_f32_16x16x32_bf16 v[64:67], v[156:159], v[128:131], v[64:67]
    v_mfma_f32_16x16x32_bf16 v[36:39], v[152:155], v[132:135], v[36:39]
    v_mfma_f32_16x16x32_bf16 v[68:71], v[156:159], v[132:135], v[68:71]
    v_mfma_f32_16x16x32_bf16 v[40:43], v[152:155], v[136:139], v[40:43]
    v_mfma_f32_16x16x32_bf16 v[72:75], v[156:159], v[136:139], v[72:75]
    v_mfma_f32_16x16x32_bf16 v[44:47], v[152:155], v[140:143], v[44:47]
    v_mfma_f32_16x16x32_bf16 v[76:79], v[156:159], v[140:143], v[76:79]
    s_add_u32 s19, s22, 3072
    buffer_load_dwordx4 v[152:155], v7, s[8:11], s19 offen
    s_add_u32 s19, s22, 19456
    buffer_load_dwordx4 v[156:159], v7, s[8:11], s19 offen
    ds_read_b128 v[112:115], v8 offset:192
    ds_read_b128 v[116:119], v8 offset:16832
    ds_read_b128 v[120:123], v8 offset:33472
    ds_read_b128 v[124:127], v8 offset:50112
    ds_read_b128 v[128:131], v9 offset:192
    ds_read_b128 v[132:135], v9 offset:16832
    ds_read_b128 v[136:139], v9 offset:33472
    ds_read_b128 v[140:143], v9 offset:50112
    s_waitcnt vmcnt(2) lgkmcnt(8)
    v_mfma_f32_16x16x32_bf16 v[16:19], v[144:147], v[80:83], v[16:19]
    v_mfma_f32_16x16x32_bf16 v[48:51], v[148:151], v[80:83], v[48:51]
    v_mfma_f32_16x16x32_bf16 v[20:23], v[144:147], v[84:87], v[20:23]
    v_mfma_f32_16x16x32_bf16 v[52:55], v[148:151], v[84:87], v[52:55]
    v_mfma_f32_16x16x32_bf16 v[24:27], v[144:147], v[88:91], v[24:27]
    v_mfma_f32_16x16x32_bf16 v[56:59], v[148:151], v[88:91], v[56:59]
    v_mfma_f32_16x16x32_bf16 v[28:31], v[144:147], v[92:95], v[28:31]
    v_mfma_f32_16x16x32_bf16 v[60:63], v[148:151], v[92:95], v[60:63]
    v_mfma_f32_16x16x32_bf16 v[32:35], v[144:147], v[96:99], v[32:35]
    v_mfma_f32_16x16x32_bf16 v[64:67], v[148:151], v[96:99], v[64:67]
    v_mfma_f32_16x16x32_bf16 v[36:39], v[144:147], v[100:103], v[36:39]
    v_mfma_f32_16x16x32_bf16 v[68:71], v[148:151], v[100:103], v[68:71]
    v_mfma_f32_16x16x32_bf16 v[40:43], v[144:147], v[104:107], v[40:43]
    v_mfma_f32_16x16x32_bf16 v[72:75], v[148:151], v[104:107], v[72:75]
    v_mfma_f32_16x16x32_bf16 v[44:47], v[144:147], v[108:111], v[44:47]
    v_mfma_f32_16x16x32_bf16 v[76:79], v[148:151], v[108:111], v[76:79]
    s_add_u32 s19, s22, 4096
    buffer_load_dwordx4 v[144:147], v7, s[8:11], s19 offen
    s_add_u32 s19, s22, 20480
    buffer_load_dwordx4 v[148:151], v7, s[8:11], s19 offen
    ds_read_b128 v[80:83], v8 offset:256
    ds_read_b128 v[84:87], v8 offset:16896
    ds_read_b128 v[88:91], v8 offset:33536
    ds_read_b128 v[92:95], v8 offset:50176
    ds_read_b128 v[96:99], v9 offset:256
    ds_read_b128 v[100:103], v9 offset:16896
    ds_read_b128 v[104:107], v9 offset:33536
    ds_read_b128 v[108:111], v9 offset:50176
    s_waitcnt vmcnt(2) lgkmcnt(8)
    v_mfma_f32_16x16x32_bf16 v[16:19], v[152:155], v[112:115], v[16:19]
    v_mfma_f32_16x16x32_bf16 v[48:51], v[156:159], v[112:115], v[48:51]
    v_mfma_f32_16x16x32_bf16 v[20:23], v[152:155], v[116:119], v[20:23]
    v_mfma_f32_16x16x32_bf16 v[52:55], v[156:159], v[116:119], v[52:55]
    v_mfma_f32_16x16x32_bf16 v[24:27], v[152:155], v[120:123], v[24:27]
    v_mfma_f32_16x16x32_bf16 v[56:59], v[156:159], v[120:123], v[56:59]
    v_mfma_f32_16x16x32_bf16 v[28:31], v[152:155], v[124:127], v[28:31]
    v_mfma_f32_16x16x32_bf16 v[60:63], v[156:159], v[124:127], v[60:63]
    v_mfma_f32_16x16x32_bf16 v[32:35], v[152:155], v[128:131], v[32:35]
    v_mfma_f32_16x16x32_bf16 v[64:67], v[156:159], v[128:131], v[64:67]
    v_mfma_f32_16x16x32_bf16 v[36:39], v[152:155], v[132:135], v[36:39]
    v_mfma_f32_16x16x32_bf16 v[68:71], v[156:159], v[132:135], v[68:71]
    v_mfma_f32_16x16x32_bf16 v[40:43], v[152:155], v[136:139], v[40:43]
    v_mfma_f32_16x16x32_bf16 v[72:75], v[156:159], v[136:139], v[72:75]
    v_mfma_f32_16x16x32_bf16 v[44:47], v[152:155], v[140:143], v[44:47]
    v_mfma_f32_16x16x32_bf16 v[76:79], v[156:159], v[140:143], v[76:79]
    s_add_u32 s19, s22, 5120
    buffer_load_dwordx4 v[152:155], v7, s[8:11], s19 offen
    s_add_u32 s19, s22, 21504
    buffer_load_dwordx4 v[156:159], v7, s[8:11], s19 offen
    ds_read_b128 v[112:115], v8 offset:320
    ds_read_b128 v[116:119], v8 offset:16960
    ds_read_b128 v[120:123], v8 offset:33600
    ds_read_b128 v[124:127], v8 offset:50240
    ds_read_b128 v[128:131], v9 offset:320
    ds_read_b128 v[132:135], v9 offset:16960
    ds_read_b128 v[136:139], v9 offset:33600
    ds_read_b128 v[140:143], v9 offset:50240
    s_waitcnt vmcnt(2) lgkmcnt(8)
    v_mfma_f32_16x16x32_bf16 v[16:19], v[144:147], v[80:83], v[16:19]
    v_mfma_f32_16x16x32_bf16 v[48:51], v[148:151], v[80:83], v[48:51]
    v_mfma_f32_16x16x32_bf16 v[20:23], v[144:147], v[84:87], v[20:23]
    v_mfma_f32_16x16x32_bf16 v[52:55], v[148:151], v[84:87], v[52:55]
    v_mfma_f32_16x16x32_bf16 v[24:27], v[144:147], v[88:91], v[24:27]
    v_mfma_f32_16x16x32_bf16 v[56:59], v[148:151], v[88:91], v[56:59]
    v_mfma_f32_16x16x32_bf16 v[28:31], v[144:147], v[92:95], v[28:31]
    v_mfma_f32_16x16x32_bf16 v[60:63], v[148:151], v[92:95], v[60:63]
    v_mfma_f32_16x16x32_bf16 v[32:35], v[144:147], v[96:99], v[32:35]
    v_mfma_f32_16x16x32_bf16 v[64:67], v[148:151], v[96:99], v[64:67]
    v_mfma_f32_16x16x32_bf16 v[36:39], v[144:147], v[100:103], v[36:39]
    v_mfma_f32_16x16x32_bf16 v[68:71], v[148:151], v[100:103], v[68:71]
    v_mfma_f32_16x16x32_bf16 v[40:43], v[144:147], v[104:107], v[40:43]
    v_mfma_f32_16x16x32_bf16 v[72:75], v[148:151], v[104:107], v[72:75]
    v_mfma_f32_16x16x32_bf16 v[44:47], v[144:147], v[108:111], v[44:47]
    v_mfma_f32_16x16x32_bf16 v[76:79], v[148:151], v[108:111], v[76:79]
    s_add_u32 s19, s22, 6144
    buffer_load_dwordx4 v[144:147], v7, s[8:11], s19 offen
    s_add_u32 s19, s22, 22528
    buffer_load_dwordx4 v[148:151], v7, s[8:11], s19 offen
    ds_read_b128 v[80:83], v8 offset:384
    ds_read_b128 v[84:87], v8 offset:17024
    ds_read_b128 v[88:91], v8 offset:33664
    ds_read_b128 v[92:95], v8 offset:50304
    ds_read_b128 v[96:99], v9 offset:384
    ds_read_b128 v[100:103], v9 offset:17024
    ds_read_b128 v[104:107], v9 offset:33664
    ds_read_b128 v[108:111], v9 offset:50304
    s_waitcnt vmcnt(2) lgkmcnt(8)
    v_mfma_f32_16x16x32_bf16 v[16:19], v[152:155], v[112:115], v[16:19]
    v_mfma_f32_16x16x32_bf16 v[48:51], v[156:159], v[112:115], v[48:51]
    v_mfma_f32_16x16x32_bf16 v[20:23], v[152:155], v[116:119], v[20:23]
    v_mfma_f32_16x16x32_bf16 v[52:55], v[156:159], v[116:119], v[52:55]
    v_mfma_f32_16x16x32_bf16 v[24:27], v[152:155], v[120:123], v[24:27]
    v_mfma_f32_16x16x32_bf16 v[56:59], v[156:159], v[120:123], v[56:59]
    v_mfma_f32_16x16x32_bf16 v[28:31], v[152:155], v[124:127], v[28:31]
    v_mfma_f32_16x16x32_bf16 v[60:63], v[156:159], v[124:127], v[60:63]
    v_mfma_f32_16x16x32_bf16 v[32:35], v[152:155], v[128:131], v[32:35]
    v_mfma_f32_16x16x32_bf16 v[64:67], v[156:159], v[128:131], v[64:67]
    v_mfma_f32_16x16x32_bf16 v[36:39], v[152:155], v[132:135], v[36:39]
    v_mfma_f32_16x16x32_bf16 v[68:71], v[156:159], v[132:135], v[68:71]
    v_mfma_f32_16x16x32_bf16 v[40:43], v[152:155], v[136:139], v[40:43]
    v_mfma_f32_16x16x32_bf16 v[72:75], v[156:159], v[136:139], v[72:75]
    v_mfma_f32_16x16x32_bf16 v[44:47], v[152:155], v[140:143], v[44:47]
    v_mfma_f32_16x16x32_bf16 v[76:79], v[156:159], v[140:143], v[76:79]
    s_add_u32 s19, s22, 7168
    buffer_load_dwordx4 v[152:155], v7, s[8:11], s19 offen
    s_add_u32 s19, s22, 23552
    buffer_load_dwordx4 v[156:159], v7, s[8:11], s19 offen
    ds_read_b128 v[112:115], v8 offset:448
    ds_read_b128 v[116:119], v8 offset:17088
    ds_read_b128 v[120:123], v8 offset:33728
    ds_read_b128 v[124:127], v8 offset:50368
    ds_read_b128 v[128:131], v9 offset:448
    ds_read_b128 v[132:135], v9 offset:17088
    ds_read_b128 v[136:139], v9 offset:33728
    ds_read_b128 v[140:143], v9 offset:50368
    s_waitcnt vmcnt(2) lgkmcnt(8)
    v_mfma_f32_16x16x32_bf16 v[16:19], v[144:147], v[80:83], v[16:19]
    v_mfma_f32_16x16x32_bf16 v[48:51], v[148:151], v[80:83], v[48:51]
    v_mfma_f32_16x16x32_bf16 v[20:23], v[144:147], v[84:87], v[20:23]
    v_mfma_f32_16x16x32_bf16 v[52:55], v[148:151], v[84:87], v[52:55]
    v_mfma_f32_16x16x32_bf16 v[24:27], v[144:147], v[88:91], v[24:27]
    v_mfma_f32_16x16x32_bf16 v[56:59], v[148:151], v[88:91], v[56:59]
    v_mfma_f32_16x16x32_bf16 v[28:31], v[144:147], v[92:95], v[28:31]
    v_mfma_f32_16x16x32_bf16 v[60:63], v[148:151], v[92:95], v[60:63]
    v_mfma_f32_16x16x32_bf16 v[32:35], v[144:147], v[96:99], v[32:35]
    v_mfma_f32_16x16x32_bf16 v[64:67], v[148:151], v[96:99], v[64:67]
    v_mfma_f32_16x16x32_bf16 v[36:39], v[144:147], v[100:103], v[36:39]
    v_mfma_f32_16x16x32_bf16 v[68:71], v[148:151], v[100:103], v[68:71]
    v_mfma_f32_16x16x32_bf16 v[40:43], v[144:147], v[104:107], v[40:43]
    v_mfma_f32_16x16x32_bf16 v[72:75], v[148:151], v[104:107], v[72:75]
    v_mfma_f32_16x16x32_bf16 v[44:47], v[144:147], v[108:111], v[44:47]
    v_mfma_f32_16x16x32_bf16 v[76:79], v[148:151], v[108:111], v[76:79]
    s_add_u32 s19, s22, 8192
    buffer_load_dwordx4 v[144:147], v7, s[8:11], s19 offen
    s_add_u32 s19, s22, 24576
    buffer_load_dwordx4 v[148:151], v7, s[8:11], s19 offen
    ds_read_b128 v[80:83], v8 offset:512
    ds_read_b128 v[84:87], v8 offset:17152
    ds_read_b128 v[88:91], v8 offset:33792
    ds_read_b128 v[92:95], v8 offset:50432
    ds_read_b128 v[96:99], v9 offset:512
    ds_read_b128 v[100:103], v9 offset:17152
    ds_read_b128 v[104:107], v9 offset:33792
    ds_read_b128 v[108:111], v9 offset:50432
    s_waitcnt vmcnt(2) lgkmcnt(8)
    v_mfma_f32_16x16x32_bf16 v[16:19], v[152:155], v[112:115], v[16:19]
    v_mfma_f32_16x16x32_bf16 v[48:51], v[156:159], v[112:115], v[48:51]
    v_mfma_f32_16x16x32_bf16 v[20:23], v[152:155], v[116:119], v[20:23]
    v_mfma_f32_16x16x32_bf16 v[52:55], v[156:159], v[116:119], v[52:55]
    v_mfma_f32_16x16x32_bf16 v[24:27], v[152:155], v[120:123], v[24:27]
    v_mfma_f32_16x16x32_bf16 v[56:59], v[156:159], v[120:123], v[56:59]
    v_mfma_f32_16x16x32_bf16 v[28:31], v[152:155], v[124:127], v[28:31]
    v_mfma_f32_16x16x32_bf16 v[60:63], v[156:159], v[124:127], v[60:63]
    v_mfma_f32_16x16x32_bf16 v[32:35], v[152:155], v[128:131], v[32:35]
    v_mfma_f32_16x16x32_bf16 v[64:67], v[156:159], v[128:131], v[64:67]
    v_mfma_f32_16x16x32_bf16 v[36:39], v[152:155], v[132:135], v[36:39]
    v_mfma_f32_16x16x32_bf16 v[68:71], v[156:159], v[132:135], v[68:71]
    v_mfma_f32_16x16x32_bf16 v[40:43], v[152:155], v[136:139], v[40:43]
    v_mfma_f32_16x16x32_bf16 v[72:75], v[156:159], v[136:139], v[72:75]
    v_mfma_f32_16x16x32_bf16 v[44:47], v[152:155], v[140:143], v[44:47]
    v_mfma_f32_16x16x32_bf16 v[76:79], v[156:159], v[140:143], v[76:79]
    s_add_u32 s19, s22, 9216
    buffer_load_dwordx4 v[152:155], v7, s[8:11], s19 offen
    s_add_u32 s19, s22, 25600
    buffer_load_dwordx4 v[156:159], v7, s[8:11], s19 offen
    ds_read_b128 v[112:115], v8 offset:576
    ds_read_b128 v[116:119], v8 offset:17216
    ds_read_b128 v[120:123], v8 offset:33856
    ds_read_b128 v[124:127], v8 offset:50496
    ds_read_b128 v[128:131], v9 offset:576
    ds_read_b128 v[132:135], v9 offset:17216
    ds_read_b128 v[136:139], v9 offset:33856
    ds_read_b128 v[140:143], v9 offset:50496
    s_waitcnt vmcnt(2) lgkmcnt(8)
    v_mfma_f32_16x16x32_bf16 v[16:19], v[144:147], v[80:83], v[16:19]
    v_mfma_f32_16x16x32_bf16 v[48:51], v[148:151], v[80:83], v[48:51]
    v_mfma_f32_16x16x32_bf16 v[20:23], v[144:147], v[84:87], v[20:23]
    v_mfma_f32_16x16x32_bf16 v[52:55], v[148:151], v[84:87], v[52:55]
    v_mfma_f32_16x16x32_bf16 v[24:27], v[144:147], v[88:91], v[24:27]
    v_mfma_f32_16x16x32_bf16 v[56:59], v[148:151], v[88:91], v[56:59]
    v_mfma_f32_16x16x32_bf16 v[28:31], v[144:147], v[92:95], v[28:31]
    v_mfma_f32_16x16x32_bf16 v[60:63], v[148:151], v[92:95], v[60:63]
    v_mfma_f32_16x16x32_bf16 v[32:35], v[144:147], v[96:99], v[32:35]
    v_mfma_f32_16x16x32_bf16 v[64:67], v[148:151], v[96:99], v[64:67]
    v_mfma_f32_16x16x32_bf16 v[36:39], v[144:147], v[100:103], v[36:39]
    v_mfma_f32_16x16x32_bf16 v[68:71], v[148:151], v[100:103], v[68:71]
    v_mfma_f32_16x16x32_bf16 v[40:43], v[144:147], v[104:107], v[40:43]
    v_mfma_f32_16x16x32_bf16 v[72:75], v[148:151], v[104:107], v[72:75]
    v_mfma_f32_16x16x32_bf16 v[44:47], v[144:147], v[108:111], v[44:47]
    v_mfma_f32_16x16x32_bf16 v[76:79], v[148:151], v[108:111], v[76:79]
    s_add_u32 s19, s22, 10240
    buffer_load_dwordx4 v[144:147], v7, s[8:11], s19 offen
    s_add_u32 s19, s22, 26624
    buffer_load_dwordx4 v[148:151], v7, s[8:11], s19 offen
    ds_read_b128 v[80:83], v8 offset:640
    ds_read_b128 v[84:87], v8 offset:17280
    ds_read_b128 v[88:91], v8 offset:33920
    ds_read_b128 v[92:95], v8 offset:50560
    ds_read_b128 v[96:99], v9 offset:640
    ds_read_b128 v[100:103], v9 offset:17280
    ds_read_b128 v[104:107], v9 offset:33920
    ds_read_b128 v[108:111], v9 offset:50560
    s_waitcnt vmcnt(2) lgkmcnt(8)
    v_mfma_f32_16x16x32_bf16 v[16:19], v[152:155], v[112:115], v[16:19]
    v_mfma_f32_16x16x32_bf16 v[48:51], v[156:159], v[112:115], v[48:51]
    v_mfma_f32_16x16x32_bf16 v[20:23], v[152:155], v[116:119], v[20:23]
    v_mfma_f32_16x16x32_bf16 v[52:55], v[156:159], v[116:119], v[52:55]
    v_mfma_f32_16x16x32_bf16 v[24:27], v[152:155], v[120:123], v[24:27]
    v_mfma_f32_16x16x32_bf16 v[56:59], v[156:159], v[120:123], v[56:59]
    v_mfma_f32_16x16x32_bf16 v[28:31], v[152:155], v[124:127], v[28:31]
    v_mfma_f32_16x16x32_bf16 v[60:63], v[156:159], v[124:127], v[60:63]
    v_mfma_f32_16x16x32_bf16 v[32:35], v[152:155], v[128:131], v[32:35]
    v_mfma_f32_16x16x32_bf16 v[64:67], v[156:159], v[128:131], v[64:67]
    v_mfma_f32_16x16x32_bf16 v[36:39], v[152:155], v[132:135], v[36:39]
    v_mfma_f32_16x16x32_bf16 v[68:71], v[156:159], v[132:135], v[68:71]
    v_mfma_f32_16x16x32_bf16 v[40:43], v[152:155], v[136:139], v[40:43]
    v_mfma_f32_16x16x32_bf16 v[72:75], v[156:159], v[136:139], v[72:75]
    v_mfma_f32_16x16x32_bf16 v[44:47], v[152:155], v[140:143], v[44:47]
    v_mfma_f32_16x16x32_bf16 v[76:79], v[156:159], v[140:143], v[76:79]
    s_add_u32 s19, s22, 11264
    buffer_load_dwordx4 v[152:155], v7, s[8:11], s19 offen
    s_add_u32 s19, s22, 27648
    buffer_load_dwordx4 v[156:159], v7, s[8:11], s19 offen
    ds_read_b128 v[112:115], v8 offset:704
    ds_read_b128 v[116:119], v8 offset:17344
    ds_read_b128 v[120:123], v8 offset:33984
    ds_read_b128 v[124:127], v8 offset:50624
    ds_read_b128 v[128:131], v9 offset:704
    ds_read_b128 v[132:135], v9 offset:17344
    ds_read_b128 v[136:139], v9 offset:33984
    ds_read_b128 v[140:143], v9 offset:50624
    s_waitcnt vmcnt(2) lgkmcnt(8)
    v_mfma_f32_16x16x32_bf16 v[16:19], v[144:147], v[80:83], v[16:19]
    v_mfma_f32_16x16x32_bf16 v[48:51], v[148:151], v[80:83], v[48:51]
    v_mfma_f32_16x16x32_bf16 v[20:23], v[144:147], v[84:87], v[20:23]
    v_mfma_f32_16x16x32_bf16 v[52:55], v[148:151], v[84:87], v[52:55]
    v_mfma_f32_16x16x32_bf16 v[24:27], v[144:147], v[88:91], v[24:27]
    v_mfma_f32_16x16x32_bf16 v[56:59], v[148:151], v[88:91], v[56:59]
    v_mfma_f32_16x16x32_bf16 v[28:31], v[144:147], v[92:95], v[28:31]
    v_mfma_f32_16x16x32_bf16 v[60:63], v[148:151], v[92:95], v[60:63]
    v_mfma_f32_16x16x32_bf16 v[32:35], v[144:147], v[96:99], v[32:35]
    v_mfma_f32_16x16x32_bf16 v[64:67], v[148:151], v[96:99], v[64:67]
    v_mfma_f32_16x16x32_bf16 v[36:39], v[144:147], v[100:103], v[36:39]
    v_mfma_f32_16x16x32_bf16 v[68:71], v[148:151], v[100:103], v[68:71]
    v_mfma_f32_16x16x32_bf16 v[40:43], v[144:147], v[104:107], v[40:43]
    v_mfma_f32_16x16x32_bf16 v[72:75], v[148:151], v[104:107], v[72:75]
    v_mfma_f32_16x16x32_bf16 v[44:47], v[144:147], v[108:111], v[44:47]
    v_mfma_f32_16x16x32_bf16 v[76:79], v[148:151], v[108:111], v[76:79]
    s_add_u32 s19, s22, 12288
    buffer_load_dwordx4 v[144:147], v7, s[8:11], s19 offen
    s_add_u32 s19, s22, 28672
    buffer_load_dwordx4 v[148:151], v7, s[8:11], s19 offen
    ds_read_b128 v[80:83], v8 offset:768
    ds_read_b128 v[84:87], v8 offset:17408
    ds_read_b128 v[88:91], v8 offset:34048
    ds_read_b128 v[92:95], v8 offset:50688
    ds_read_b128 v[96:99], v9 offset:768
    ds_read_b128 v[100:103], v9 offset:17408
    ds_read_b128 v[104:107], v9 offset:34048
    ds_read_b128 v[108:111], v9 offset:50688
    s_waitcnt vmcnt(2) lgkmcnt(8)
    v_mfma_f32_16x16x32_bf16 v[16:19], v[152:155], v[112:115], v[16:19]
    v_mfma_f32_16x16x32_bf16 v[48:51], v[156:159], v[112:115], v[48:51]
    v_mfma_f32_16x16x32_bf16 v[20:23], v[152:155], v[116:119], v[20:23]
    v_mfma_f32_16x16x32_bf16 v[52:55], v[156:159], v[116:119], v[52:55]
    v_mfma_f32_16x16x32_bf16 v[24:27], v[152:155], v[120:123], v[24:27]
    v_mfma_f32_16x16x32_bf16 v[56:59], v[156:159], v[120:123], v[56:59]
    v_mfma_f32_16x16x32_bf16 v[28:31], v[152:155], v[124:127], v[28:31]
    v_mfma_f32_16x16x32_bf16 v[60:63], v[156:159], v[124:127], v[60:63]
    v_mfma_f32_16x16x32_bf16 v[32:35], v[152:155], v[128:131], v[32:35]
    v_mfma_f32_16x16x32_bf16 v[64:67], v[156:159], v[128:131], v[64:67]
    v_mfma_f32_16x16x32_bf16 v[36:39], v[152:155], v[132:135], v[36:39]
    v_mfma_f32_16x16x32_bf16 v[68:71], v[156:159], v[132:135], v[68:71]
    v_mfma_f32_16x16x32_bf16 v[40:43], v[152:155], v[136:139], v[40:43]
    v_mfma_f32_16x16x32_bf16 v[72:75], v[156:159], v[136:139], v[72:75]
    v_mfma_f32_16x16x32_bf16 v[44:47], v[152:155], v[140:143], v[44:47]
    v_mfma_f32_16x16x32_bf16 v[76:79], v[156:159], v[140:143], v[76:79]
    s_add_u32 s19, s22, 13312
    buffer_load_dwordx4 v[152:155], v7, s[8:11], s19 offen
    s_add_u32 s19, s22, 29696
    buffer_load_dwordx4 v[156:159], v7, s[8:11], s19 offen
    ds_read_b128 v[112:115], v8 offset:832
    ds_read_b128 v[116:119], v8 offset:17472
    ds_read_b128 v[120:123], v8 offset:34112
    ds_read_b128 v[124:127], v8 offset:50752
    ds_read_b128 v[128:131], v9 offset:832
    ds_read_b128 v[132:135], v9 offset:17472
    ds_read_b128 v[136:139], v9 offset:34112
    ds_read_b128 v[140:143], v9 offset:50752
    s_waitcnt vmcnt(2) lgkmcnt(8)
    v_mfma_f32_16x16x32_bf16 v[16:19], v[144:147], v[80:83], v[16:19]
    v_mfma_f32_16x16x32_bf16 v[48:51], v[148:151], v[80:83], v[48:51]
    v_mfma_f32_16x16x32_bf16 v[20:23], v[144:147], v[84:87], v[20:23]
    v_mfma_f32_16x16x32_bf16 v[52:55], v[148:151], v[84:87], v[52:55]
    v_mfma_f32_16x16x32_bf16 v[24:27], v[144:147], v[88:91], v[24:27]
    v_mfma_f32_16x16x32_bf16 v[56:59], v[148:151], v[88:91], v[56:59]
    v_mfma_f32_16x16x32_bf16 v[28:31], v[144:147], v[92:95], v[28:31]
    v_mfma_f32_16x16x32_bf16 v[60:63], v[148:151], v[92:95], v[60:63]
    v_mfma_f32_16x16x32_bf16 v[32:35], v[144:147], v[96:99], v[32:35]
    v_mfma_f32_16x16x32_bf16 v[64:67], v[148:151], v[96:99], v[64:67]
    v_mfma_f32_16x16x32_bf16 v[36:39], v[144:147], v[100:103], v[36:39]
    v_mfma_f32_16x16x32_bf16 v[68:71], v[148:151], v[100:103], v[68:71]
    v_mfma_f32_16x16x32_bf16 v[40:43], v[144:147], v[104:107], v[40:43]
    v_mfma_f32_16x16x32_bf16 v[72:75], v[148:151], v[104:107], v[72:75]
    v_mfma_f32_16x16x32_bf16 v[44:47], v[144:147], v[108:111], v[44:47]
    v_mfma_f32_16x16x32_bf16 v[76:79], v[148:151], v[108:111], v[76:79]
    s_add_u32 s19, s22, 14336
    buffer_load_dwordx4 v[144:147], v7, s[8:11], s19 offen
    s_add_u32 s19, s22, 30720
    buffer_load_dwordx4 v[148:151], v7, s[8:11], s19 offen
    ds_read_b128 v[80:83], v8 offset:896
    ds_read_b128 v[84:87], v8 offset:17536
    ds_read_b128 v[88:91], v8 offset:34176
    ds_read_b128 v[92:95], v8 offset:50816
    ds_read_b128 v[96:99], v9 offset:896
    ds_read_b128 v[100:103], v9 offset:17536
    ds_read_b128 v[104:107], v9 offset:34176
    ds_read_b128 v[108:111], v9 offset:50816
    s_waitcnt vmcnt(2) lgkmcnt(8)
    v_mfma_f32_16x16x32_bf16 v[16:19], v[152:155], v[112:115], v[16:19]
    v_mfma_f32_16x16x32_bf16 v[48:51], v[156:159], v[112:115], v[48:51]
    v_mfma_f32_16x16x32_bf16 v[20:23], v[152:155], v[116:119], v[20:23]
    v_mfma_f32_16x16x32_bf16 v[52:55], v[156:159], v[116:119], v[52:55]
    v_mfma_f32_16x16x32_bf16 v[24:27], v[152:155], v[120:123], v[24:27]
    v_mfma_f32_16x16x32_bf16 v[56:59], v[156:159], v[120:123], v[56:59]
    v_mfma_f32_16x16x32_bf16 v[28:31], v[152:155], v[124:127], v[28:31]
    v_mfma_f32_16x16x32_bf16 v[60:63], v[156:159], v[124:127], v[60:63]
    v_mfma_f32_16x16x32_bf16 v[32:35], v[152:155], v[128:131], v[32:35]
    v_mfma_f32_16x16x32_bf16 v[64:67], v[156:159], v[128:131], v[64:67]
    v_mfma_f32_16x16x32_bf16 v[36:39], v[152:155], v[132:135], v[36:39]
    v_mfma_f32_16x16x32_bf16 v[68:71], v[156:159], v[132:135], v[68:71]
    v_mfma_f32_16x16x32_bf16 v[40:43], v[152:155], v[136:139], v[40:43]
    v_mfma_f32_16x16x32_bf16 v[72:75], v[156:159], v[136:139], v[72:75]
    v_mfma_f32_16x16x32_bf16 v[44:47], v[152:155], v[140:143], v[44:47]
    v_mfma_f32_16x16x32_bf16 v[76:79], v[156:159], v[140:143], v[76:79]
    s_add_u32 s19, s22, 15360
    buffer_load_dwordx4 v[152:155], v7, s[8:11], s19 offen
    s_add_u32 s19, s22, 31744
    buffer_load_dwordx4 v[156:159], v7, s[8:11], s19 offen
    ds_read_b128 v[112:115], v8 offset:960
    ds_read_b128 v[116:119], v8 offset:17600
    ds_read_b128 v[120:123], v8 offset:34240
    ds_read_b128 v[124:127], v8 offset:50880
    ds_read_b128 v[128:131], v9 offset:960
    ds_read_b128 v[132:135], v9 offset:17600
    ds_read_b128 v[136:139], v9 offset:34240
    ds_read_b128 v[140:143], v9 offset:50880
    s_waitcnt vmcnt(2) lgkmcnt(8)
    v_mfma_f32_16x16x32_bf16 v[16:19], v[144:147], v[80:83], v[16:19]
    v_mfma_f32_16x16x32_bf16 v[48:51], v[148:151], v[80:83], v[48:51]
    v_mfma_f32_16x16x32_bf16 v[20:23], v[144:147], v[84:87], v[20:23]
    v_mfma_f32_16x16x32_bf16 v[52:55], v[148:151], v[84:87], v[52:55]
    v_mfma_f32_16x16x32_bf16 v[24:27], v[144:147], v[88:91], v[24:27]
    v_mfma_f32_16x16x32_bf16 v[56:59], v[148:151], v[88:91], v[56:59]
    v_mfma_f32_16x16x32_bf16 v[28:31], v[144:147], v[92:95], v[28:31]
    v_mfma_f32_16x16x32_bf16 v[60:63], v[148:151], v[92:95], v[60:63]
    v_mfma_f32_16x16x32_bf16 v[32:35], v[144:147], v[96:99], v[32:35]
    v_mfma_f32_16x16x32_bf16 v[64:67], v[148:151], v[96:99], v[64:67]
    v_mfma_f32_16x16x32_bf16 v[36:39], v[144:147], v[100:103], v[36:39]
    v_mfma_f32_16x16x32_bf16 v[68:71], v[148:151], v[100:103], v[68:71]
    v_mfma_f32_16x16x32_bf16 v[40:43], v[144:147], v[104:107], v[40:43]
    v_mfma_f32_16x16x32_bf16 v[72:75], v[148:151], v[104:107], v[72:75]
    v_mfma_f32_16x16x32_bf16 v[44:47], v[144:147], v[108:111], v[44:47]
    v_mfma_f32_16x16x32_bf16 v[76:79], v[148:151], v[108:111], v[76:79]
    s_waitcnt vmcnt(0) lgkmcnt(0)
    v_mfma_f32_16x16x32_bf16 v[16:19], v[152:155], v[112:115], v[16:19]
    v_mfma_f32_16x16x32_bf16 v[48:51], v[156:159], v[112:115], v[48:51]
    v_mfma_f32_16x16x32_bf16 v[20:23], v[152:155], v[116:119], v[20:23]
    v_mfma_f32_16x16x32_bf16 v[52:55], v[156:159], v[116:119], v[52:55]
    v_mfma_f32_16x16x32_bf16 v[24:27], v[152:155], v[120:123], v[24:27]
    v_mfma_f32_16x16x32_bf16 v[56:59], v[156:159], v[120:123], v[56:59]
    v_mfma_f32_16x16x32_bf16 v[28:31], v[152:155], v[124:127], v[28:31]
    v_mfma_f32_16x16x32_bf16 v[60:63], v[156:159], v[124:127], v[60:63]
    v_mfma_f32_16x16x32_bf16 v[32:35], v[152:155], v[128:131], v[32:35]
    v_mfma_f32_16x16x32_bf16 v[64:67], v[156:159], v[128:131], v[64:67]
    v_mfma_f32_16x16x32_bf16 v[36:39], v[152:155], v[132:135], v[36:39]
    v_mfma_f32_16x16x32_bf16 v[68:71], v[156:159], v[132:135], v[68:71]
    v_mfma_f32_16x16x32_bf16 v[40:43], v[152:155], v[136:139], v[40:43]
    v_mfma_f32_16x16x32_bf16 v[72:75], v[156:159], v[136:139], v[72:75]
    v_mfma_f32_16x16x32_bf16 v[44:47], v[152:155], v[140:143], v[44:47]
    v_mfma_f32_16x16x32_bf16 v[76:79], v[156:159], v[140:143], v[76:79]
    s_nop 7
    s_lshl_b32 s23, s3, 2
    s_lshl_b32 s23, s23, 5
    s_add_u32 s23, s23, s6
    s_lshl_b32 s23, s23, 13
    s_lshl_b32 s19, s16, 11
    s_add_u32 s23, s23, s19
    s_add_u32 s23, s23, 50331648
    v_cvt_pk_bf16_f32 v80, v16, v17
    v_cvt_pk_bf16_f32 v81, v18, v19
    v_cvt_pk_bf16_f32 v82, v48, v49
    v_cvt_pk_bf16_f32 v83, v50, v51
    s_add_u32 s19, s23, 0
    buffer_store_dwordx4 v[80:83], v7, s[8:11], s19 offen sc1
    s_nop 1
    v_cvt_pk_bf16_f32 v84, v20, v21
    v_cvt_pk_bf16_f32 v85, v22, v23
    v_cvt_pk_bf16_f32 v86, v52, v53
    v_cvt_pk_bf16_f32 v87, v54, v55
    s_add_u32 s19, s23, 1024
    buffer_store_dwordx4 v[84:87], v7, s[8:11], s19 offen sc1
    s_nop 1
    v_cvt_pk_bf16_f32 v80, v24, v25
    v_cvt_pk_bf16_f32 v81, v26, v27
    v_cvt_pk_bf16_f32 v82, v56, v57
    v_cvt_pk_bf16_f32 v83, v58, v59
    s_add_u32 s19, s23, 262144
    buffer_store_dwordx4 v[80:83], v7, s[8:11], s19 offen sc1
    s_nop 1
    v_cvt_pk_bf16_f32 v84, v28, v29
    v_cvt_pk_bf16_f32 v85, v30, v31
    v_cvt_pk_bf16_f32 v86, v60, v61
    v_cvt_pk_bf16_f32 v87, v62, v63
    s_add_u32 s19, s23, 263168
    buffer_store_dwordx4 v[84:87], v7, s[8:11], s19 offen sc1
    s_nop 1
    v_cvt_pk_bf16_f32 v80, v32, v33
    v_cvt_pk_bf16_f32 v81, v34, v35
    v_cvt_pk_bf16_f32 v82, v64, v65
    v_cvt_pk_bf16_f32 v83, v66, v67
    s_add_u32 s19, s23, 524288
    buffer_store_dwordx4 v[80:83], v7, s[8:11], s19 offen sc1
    s_nop 1
    v_cvt_pk_bf16_f32 v84, v36, v37
    v_cvt_pk_bf16_f32 v85, v38, v39
    v_cvt_pk_bf16_f32 v86, v68, v69
    v_cvt_pk_bf16_f32 v87, v70, v71
    s_add_u32 s19, s23, 525312
    buffer_store_dwordx4 v[84:87], v7, s[8:11], s19 offen sc1
    s_nop 1
    v_cvt_pk_bf16_f32 v80, v40, v41
    v_cvt_pk_bf16_f32 v81, v42, v43
    v_cvt_pk_bf16_f32 v82, v72, v73
    v_cvt_pk_bf16_f32 v83, v74, v75
    s_add_u32 s19, s23, 786432
    buffer_store_dwordx4 v[80:83], v7, s[8:11], s19 offen sc1
    s_nop 1
    v_cvt_pk_bf16_f32 v84, v44, v45
    v_cvt_pk_bf16_f32 v85, v46, v47
    v_cvt_pk_bf16_f32 v86, v76, v77
    v_cvt_pk_bf16_f32 v87, v78, v79
    s_add_u32 s19, s23, 787456
    buffer_store_dwordx4 v[84:87], v7, s[8:11], s19 offen sc1
    s_nop 1
    s_lshl_b32 s6, s26, 1
    s_add_u32 s6, s6, 1
    s_lshl_b32 s22, s6, 17
    s_lshl_b32 s19, s16, 15
    s_add_u32 s22, s22, s19
    s_add_u32 s22, s22, 8388608
    s_add_u32 s19, s22, 0
    buffer_load_dwordx4 v[144:147], v7, s[8:11], s19 offen
    s_add_u32 s19, s22, 16384
    buffer_load_dwordx4 v[148:151], v7, s[8:11], s19 offen
    ds_read_b128 v[80:83], v8 offset:0
    ds_read_b128 v[84:87], v8 offset:16640
    ds_read_b128 v[88:91], v8 offset:33280
    ds_read_b128 v[92:95], v8 offset:49920
    ds_read_b128 v[96:99], v9 offset:0
    ds_read_b128 v[100:103], v9 offset:16640
    ds_read_b128 v[104:107], v9 offset:33280
    ds_read_b128 v[108:111], v9 offset:49920
    s_add_u32 s19, s22, 1024
    buffer_load_dwordx4 v[152:155], v7, s[8:11], s19 offen
    s_add_u32 s19, s22, 17408
    buffer_load_dwordx4 v[156:159], v7, s[8:11], s19 offen
    ds_read_b128 v[112:115], v8 offset:64
    ds_read_b128 v[116:119], v8 offset:16704
    ds_read_b128 v[120:123], v8 offset:33344
    ds_read_b128 v[124:127], v8 offset:49984
    ds_read_b128 v[128:131], v9 offset:64
    ds_read_b128 v[132:135], v9 offset:16704
    ds_read_b128 v[136:139], v9 offset:33344
    ds_read_b128 v[140:143], v9 offset:49984
    s_waitcnt vmcnt(2) lgkmcnt(8)
    v_mfma_f32_16x16x32_bf16 v[16:19], v[80:83], v[144:147], 0
    v_mfma_f32_16x16x32_bf16 v[48:51], v[80:83], v[148:151], 0
    v_mfma_f32_16x16x32_bf16 v[20:23], v[84:87], v[144:147], 0
    v_mfma_f32_16x16x32_bf16 v[52:55], v[84:87], v[148:151], 0
    v_mfma_f32_16x16x32_bf16 v[24:27], v[88:91], v[144:147], 0
    v_mfma_f32_16x16x32_bf16 v[56:59], v[88:91], v[148:151], 0
    v_mfma_f32_16x16x32_bf16 v[28:31], v[92:95], v[144:147], 0
    v_mfma_f32_16x16x32_bf16 v[60:63], v[92:95], v[148:151], 0
    v_mfma_f32_16x16x32_bf16 v[32:35], v[96:99], v[144:147], 0
    v_mfma_f32_16x16x32_bf16 v[64:67], v[96:99], v[148:151], 0
    v_mfma_f32_16x16x32_bf16 v[36:39], v[100:103], v[144:147], 0
    v_mfma_f32_16x16x32_bf16 v[68:71], v[100:103], v[148:151], 0
    v_mfma_f32_16x16x32_bf16 v[40:43], v[104:107], v[144:147], 0
    v_mfma_f32_16x16x32_bf16 v[72:75], v[104:107], v[148:151], 0
    v_mfma_f32_16x16x32_bf16 v[44:47], v[108:111], v[144:147], 0
    v_mfma_f32_16x16x32_bf16 v[76:79], v[108:111], v[148:151], 0
    s_add_u32 s19, s22, 2048
    buffer_load_dwordx4 v[144:147], v7, s[8:11], s19 offen
    s_add_u32 s19, s22, 18432
    buffer_load_dwordx4 v[148:151], v7, s[8:11], s19 offen
    ds_read_b128 v[80:83], v8 offset:128
    ds_read_b128 v[84:87], v8 offset:16768
    ds_read_b128 v[88:91], v8 offset:33408
    ds_read_b128 v[92:95], v8 offset:50048
    ds_read_b128 v[96:99], v9 offset:128
    ds_read_b128 v[100:103], v9 offset:16768
    ds_read_b128 v[104:107], v9 offset:33408
    ds_read_b128 v[108:111], v9 offset:50048
    s_waitcnt vmcnt(2) lgkmcnt(8)
    v_mfma_f32_16x16x32_bf16 v[16:19], v[112:115], v[152:155], v[16:19]
    v_mfma_f32_16x16x32_bf16 v[48:51], v[112:115], v[156:159], v[48:51]
    v_mfma_f32_16x16x32_bf16 v[20:23], v[116:119], v[152:155], v[20:23]
    v_mfma_f32_16x16x32_bf16 v[52:55], v[116:119], v[156:159], v[52:55]
    v_mfma_f32_16x16x32_bf16 v[24:27], v[120:123], v[152:155], v[24:27]
    v_mfma_f32_16x16x32_bf16 v[56:59], v[120:123], v[156:159], v[56:59]
    v_mfma_f32_16x16x32_bf16 v[28:31], v[124:127], v[152:155], v[28:31]
    v_mfma_f32_16x16x32_bf16 v[60:63], v[124:127], v[156:159], v[60:63]
    v_mfma_f32_16x16x32_bf16 v[32:35], v[128:131], v[152:155], v[32:35]
    v_mfma_f32_16x16x32_bf16 v[64:67], v[128:131], v[156:159], v[64:67]
    v_mfma_f32_16x16x32_bf16 v[36:39], v[132:135], v[152:155], v[36:39]
    v_mfma_f32_16x16x32_bf16 v[68:71], v[132:135], v[156:159], v[68:71]
    v_mfma_f32_16x16x32_bf16 v[40:43], v[136:139], v[152:155], v[40:43]
    v_mfma_f32_16x16x32_bf16 v[72:75], v[136:139], v[156:159], v[72:75]
    v_mfma_f32_16x16x32_bf16 v[44:47], v[140:143], v[152:155], v[44:47]
    v_mfma_f32_16x16x32_bf16 v[76:79], v[140:143], v[156:159], v[76:79]
    s_add_u32 s19, s22, 3072
    buffer_load_dwordx4 v[152:155], v7, s[8:11], s19 offen
    s_add_u32 s19, s22, 19456
    buffer_load_dwordx4 v[156:159], v7, s[8:11], s19 offen
    ds_read_b128 v[112:115], v8 offset:192
    ds_read_b128 v[116:119], v8 offset:16832
    ds_read_b128 v[120:123], v8 offset:33472
    ds_read_b128 v[124:127], v8 offset:50112
    ds_read_b128 v[128:131], v9 offset:192
    ds_read_b128 v[132:135], v9 offset:16832
    ds_read_b128 v[136:139], v9 offset:33472
    ds_read_b128 v[140:143], v9 offset:50112
    s_waitcnt vmcnt(2) lgkmcnt(8)
    v_mfma_f32_16x16x32_bf16 v[16:19], v[80:83], v[144:147], v[16:19]
    v_mfma_f32_16x16x32_bf16 v[48:51], v[80:83], v[148:151], v[48:51]
    v_mfma_f32_16x16x32_bf16 v[20:23], v[84:87], v[144:147], v[20:23]
    v_mfma_f32_16x16x32_bf16 v[52:55], v[84:87], v[148:151], v[52:55]
    v_mfma_f32_16x16x32_bf16 v[24:27], v[88:91], v[144:147], v[24:27]
    v_mfma_f32_16x16x32_bf16 v[56:59], v[88:91], v[148:151], v[56:59]
    v_mfma_f32_16x16x32_bf16 v[28:31], v[92:95], v[144:147], v[28:31]
    v_mfma_f32_16x16x32_bf16 v[60:63], v[92:95], v[148:151], v[60:63]
    v_mfma_f32_16x16x32_bf16 v[32:35], v[96:99], v[144:147], v[32:35]
    v_mfma_f32_16x16x32_bf16 v[64:67], v[96:99], v[148:151], v[64:67]
    v_mfma_f32_16x16x32_bf16 v[36:39], v[100:103], v[144:147], v[36:39]
    v_mfma_f32_16x16x32_bf16 v[68:71], v[100:103], v[148:151], v[68:71]
    v_mfma_f32_16x16x32_bf16 v[40:43], v[104:107], v[144:147], v[40:43]
    v_mfma_f32_16x16x32_bf16 v[72:75], v[104:107], v[148:151], v[72:75]
    v_mfma_f32_16x16x32_bf16 v[44:47], v[108:111], v[144:147], v[44:47]
    v_mfma_f32_16x16x32_bf16 v[76:79], v[108:111], v[148:151], v[76:79]
    s_add_u32 s19, s22, 4096
    buffer_load_dwordx4 v[144:147], v7, s[8:11], s19 offen
    s_add_u32 s19, s22, 20480
    buffer_load_dwordx4 v[148:151], v7, s[8:11], s19 offen
    ds_read_b128 v[80:83], v8 offset:256
    ds_read_b128 v[84:87], v8 offset:16896
    ds_read_b128 v[88:91], v8 offset:33536
    ds_read_b128 v[92:95], v8 offset:50176
    ds_read_b128 v[96:99], v9 offset:256
    ds_read_b128 v[100:103], v9 offset:16896
    ds_read_b128 v[104:107], v9 offset:33536
    ds_read_b128 v[108:111], v9 offset:50176
    s_waitcnt vmcnt(2) lgkmcnt(8)
    v_mfma_f32_16x16x32_bf16 v[16:19], v[112:115], v[152:155], v[16:19]
    v_mfma_f32_16x16x32_bf16 v[48:51], v[112:115], v[156:159], v[48:51]
    v_mfma_f32_16x16x32_bf16 v[20:23], v[116:119], v[152:155], v[20:23]
    v_mfma_f32_16x16x32_bf16 v[52:55], v[116:119], v[156:159], v[52:55]
    v_mfma_f32_16x16x32_bf16 v[24:27], v[120:123], v[152:155], v[24:27]
    v_mfma_f32_16x16x32_bf16 v[56:59], v[120:123], v[156:159], v[56:59]
    v_mfma_f32_16x16x32_bf16 v[28:31], v[124:127], v[152:155], v[28:31]
    v_mfma_f32_16x16x32_bf16 v[60:63], v[124:127], v[156:159], v[60:63]
    v_mfma_f32_16x16x32_bf16 v[32:35], v[128:131], v[152:155], v[32:35]
    v_mfma_f32_16x16x32_bf16 v[64:67], v[128:131], v[156:159], v[64:67]
    v_mfma_f32_16x16x32_bf16 v[36:39], v[132:135], v[152:155], v[36:39]
    v_mfma_f32_16x16x32_bf16 v[68:71], v[132:135], v[156:159], v[68:71]
    v_mfma_f32_16x16x32_bf16 v[40:43], v[136:139], v[152:155], v[40:43]
    v_mfma_f32_16x16x32_bf16 v[72:75], v[136:139], v[156:159], v[72:75]
    v_mfma_f32_16x16x32_bf16 v[44:47], v[140:143], v[152:155], v[44:47]
    v_mfma_f32_16x16x32_bf16 v[76:79], v[140:143], v[156:159], v[76:79]
    s_add_u32 s19, s22, 5120
    buffer_load_dwordx4 v[152:155], v7, s[8:11], s19 offen
    s_add_u32 s19, s22, 21504
    buffer_load_dwordx4 v[156:159], v7, s[8:11], s19 offen
    ds_read_b128 v[112:115], v8 offset:320
    ds_read_b128 v[116:119], v8 offset:16960
    ds_read_b128 v[120:123], v8 offset:33600
    ds_read_b128 v[124:127], v8 offset:50240
    ds_read_b128 v[128:131], v9 offset:320
    ds_read_b128 v[132:135], v9 offset:16960
    ds_read_b128 v[136:139], v9 offset:33600
    ds_read_b128 v[140:143], v9 offset:50240
    s_waitcnt vmcnt(2) lgkmcnt(8)
    v_mfma_f32_16x16x32_bf16 v[16:19], v[80:83], v[144:147], v[16:19]
    v_mfma_f32_16x16x32_bf16 v[48:51], v[80:83], v[148:151], v[48:51]
    v_mfma_f32_16x16x32_bf16 v[20:23], v[84:87], v[144:147], v[20:23]
    v_mfma_f32_16x16x32_bf16 v[52:55], v[84:87], v[148:151], v[52:55]
    v_mfma_f32_16x16x32_bf16 v[24:27], v[88:91], v[144:147], v[24:27]
    v_mfma_f32_16x16x32_bf16 v[56:59], v[88:91], v[148:151], v[56:59]
    v_mfma_f32_16x16x32_bf16 v[28:31], v[92:95], v[144:147], v[28:31]
    v_mfma_f32_16x16x32_bf16 v[60:63], v[92:95], v[148:151], v[60:63]
    v_mfma_f32_16x16x32_bf16 v[32:35], v[96:99], v[144:147], v[32:35]
    v_mfma_f32_16x16x32_bf16 v[64:67], v[96:99], v[148:151], v[64:67]
    v_mfma_f32_16x16x32_bf16 v[36:39], v[100:103], v[144:147], v[36:39]
    v_mfma_f32_16x16x32_bf16 v[68:71], v[100:103], v[148:151], v[68:71]
    v_mfma_f32_16x16x32_bf16 v[40:43], v[104:107], v[144:147], v[40:43]
    v_mfma_f32_16x16x32_bf16 v[72:75], v[104:107], v[148:151], v[72:75]
    v_mfma_f32_16x16x32_bf16 v[44:47], v[108:111], v[144:147], v[44:47]
    v_mfma_f32_16x16x32_bf16 v[76:79], v[108:111], v[148:151], v[76:79]
    s_add_u32 s19, s22, 6144
    buffer_load_dwordx4 v[144:147], v7, s[8:11], s19 offen
    s_add_u32 s19, s22, 22528
    buffer_load_dwordx4 v[148:151], v7, s[8:11], s19 offen
    ds_read_b128 v[80:83], v8 offset:384
    ds_read_b128 v[84:87], v8 offset:17024
    ds_read_b128 v[88:91], v8 offset:33664
    ds_read_b128 v[92:95], v8 offset:50304
    ds_read_b128 v[96:99], v9 offset:384
    ds_read_b128 v[100:103], v9 offset:17024
    ds_read_b128 v[104:107], v9 offset:33664
    ds_read_b128 v[108:111], v9 offset:50304
    s_waitcnt vmcnt(2) lgkmcnt(8)
    v_mfma_f32_16x16x32_bf16 v[16:19], v[112:115], v[152:155], v[16:19]
    v_mfma_f32_16x16x32_bf16 v[48:51], v[112:115], v[156:159], v[48:51]
    v_mfma_f32_16x16x32_bf16 v[20:23], v[116:119], v[152:155], v[20:23]
    v_mfma_f32_16x16x32_bf16 v[52:55], v[116:119], v[156:159], v[52:55]
    v_mfma_f32_16x16x32_bf16 v[24:27], v[120:123], v[152:155], v[24:27]
    v_mfma_f32_16x16x32_bf16 v[56:59], v[120:123], v[156:159], v[56:59]
    v_mfma_f32_16x16x32_bf16 v[28:31], v[124:127], v[152:155], v[28:31]
    v_mfma_f32_16x16x32_bf16 v[60:63], v[124:127], v[156:159], v[60:63]
    v_mfma_f32_16x16x32_bf16 v[32:35], v[128:131], v[152:155], v[32:35]
    v_mfma_f32_16x16x32_bf16 v[64:67], v[128:131], v[156:159], v[64:67]
    v_mfma_f32_16x16x32_bf16 v[36:39], v[132:135], v[152:155], v[36:39]
    v_mfma_f32_16x16x32_bf16 v[68:71], v[132:135], v[156:159], v[68:71]
    v_mfma_f32_16x16x32_bf16 v[40:43], v[136:139], v[152:155], v[40:43]
    v_mfma_f32_16x16x32_bf16 v[72:75], v[136:139], v[156:159], v[72:75]
    v_mfma_f32_16x16x32_bf16 v[44:47], v[140:143], v[152:155], v[44:47]
    v_mfma_f32_16x16x32_bf16 v[76:79], v[140:143], v[156:159], v[76:79]
    s_add_u32 s19, s22, 7168
    buffer_load_dwordx4 v[152:155], v7, s[8:11], s19 offen
    s_add_u32 s19, s22, 23552
    buffer_load_dwordx4 v[156:159], v7, s[8:11], s19 offen
    ds_read_b128 v[112:115], v8 offset:448
    ds_read_b128 v[116:119], v8 offset:17088
    ds_read_b128 v[120:123], v8 offset:33728
    ds_read_b128 v[124:127], v8 offset:50368
    ds_read_b128 v[128:131], v9 offset:448
    ds_read_b128 v[132:135], v9 offset:17088
    ds_read_b128 v[136:139], v9 offset:33728
    ds_read_b128 v[140:143], v9 offset:50368
    s_waitcnt vmcnt(2) lgkmcnt(8)
    v_mfma_f32_16x16x32_bf16 v[16:19], v[80:83], v[144:147], v[16:19]
    v_mfma_f32_16x16x32_bf16 v[48:51], v[80:83], v[148:151], v[48:51]
    v_mfma_f32_16x16x32_bf16 v[20:23], v[84:87], v[144:147], v[20:23]
    v_mfma_f32_16x16x32_bf16 v[52:55], v[84:87], v[148:151], v[52:55]
    v_mfma_f32_16x16x32_bf16 v[24:27], v[88:91], v[144:147], v[24:27]
    v_mfma_f32_16x16x32_bf16 v[56:59], v[88:91], v[148:151], v[56:59]
    v_mfma_f32_16x16x32_bf16 v[28:31], v[92:95], v[144:147], v[28:31]
    v_mfma_f32_16x16x32_bf16 v[60:63], v[92:95], v[148:151], v[60:63]
    v_mfma_f32_16x16x32_bf16 v[32:35], v[96:99], v[144:147], v[32:35]
    v_mfma_f32_16x16x32_bf16 v[64:67], v[96:99], v[148:151], v[64:67]
    v_mfma_f32_16x16x32_bf16 v[36:39], v[100:103], v[144:147], v[36:39]
    v_mfma_f32_16x16x32_bf16 v[68:71], v[100:103], v[148:151], v[68:71]
    v_mfma_f32_16x16x32_bf16 v[40:43], v[104:107], v[144:147], v[40:43]
    v_mfma_f32_16x16x32_bf16 v[72:75], v[104:107], v[148:151], v[72:75]
    v_mfma_f32_16x16x32_bf16 v[44:47], v[108:111], v[144:147], v[44:47]
    v_mfma_f32_16x16x32_bf16 v[76:79], v[108:111], v[148:151], v[76:79]
    s_add_u32 s19, s22, 8192
    buffer_load_dwordx4 v[144:147], v7, s[8:11], s19 offen
    s_add_u32 s19, s22, 24576
    buffer_load_dwordx4 v[148:151], v7, s[8:11], s19 offen
    ds_read_b128 v[80:83], v8 offset:512
    ds_read_b128 v[84:87], v8 offset:17152
    ds_read_b128 v[88:91], v8 offset:33792
    ds_read_b128 v[92:95], v8 offset:50432
    ds_read_b128 v[96:99], v9 offset:512
    ds_read_b128 v[100:103], v9 offset:17152
    ds_read_b128 v[104:107], v9 offset:33792
    ds_read_b128 v[108:111], v9 offset:50432
    s_waitcnt vmcnt(2) lgkmcnt(8)
    v_mfma_f32_16x16x32_bf16 v[16:19], v[112:115], v[152:155], v[16:19]
    v_mfma_f32_16x16x32_bf16 v[48:51], v[112:115], v[156:159], v[48:51]
    v_mfma_f32_16x16x32_bf16 v[20:23], v[116:119], v[152:155], v[20:23]
    v_mfma_f32_16x16x32_bf16 v[52:55], v[116:119], v[156:159], v[52:55]
    v_mfma_f32_16x16x32_bf16 v[24:27], v[120:123], v[152:155], v[24:27]
    v_mfma_f32_16x16x32_bf16 v[56:59], v[120:123], v[156:159], v[56:59]
    v_mfma_f32_16x16x32_bf16 v[28:31], v[124:127], v[152:155], v[28:31]
    v_mfma_f32_16x16x32_bf16 v[60:63], v[124:127], v[156:159], v[60:63]
    v_mfma_f32_16x16x32_bf16 v[32:35], v[128:131], v[152:155], v[32:35]
    v_mfma_f32_16x16x32_bf16 v[64:67], v[128:131], v[156:159], v[64:67]
    v_mfma_f32_16x16x32_bf16 v[36:39], v[132:135], v[152:155], v[36:39]
    v_mfma_f32_16x16x32_bf16 v[68:71], v[132:135], v[156:159], v[68:71]
    v_mfma_f32_16x16x32_bf16 v[40:43], v[136:139], v[152:155], v[40:43]
    v_mfma_f32_16x16x32_bf16 v[72:75], v[136:139], v[156:159], v[72:75]
    v_mfma_f32_16x16x32_bf16 v[44:47], v[140:143], v[152:155], v[44:47]
    v_mfma_f32_16x16x32_bf16 v[76:79], v[140:143], v[156:159], v[76:79]
    s_add_u32 s19, s22, 9216
    buffer_load_dwordx4 v[152:155], v7, s[8:11], s19 offen
    s_add_u32 s19, s22, 25600
    buffer_load_dwordx4 v[156:159], v7, s[8:11], s19 offen
    ds_read_b128 v[112:115], v8 offset:576
    ds_read_b128 v[116:119], v8 offset:17216
    ds_read_b128 v[120:123], v8 offset:33856
    ds_read_b128 v[124:127], v8 offset:50496
    ds_read_b128 v[128:131], v9 offset:576
    ds_read_b128 v[132:135], v9 offset:17216
    ds_read_b128 v[136:139], v9 offset:33856
    ds_read_b128 v[140:143], v9 offset:50496
    s_waitcnt vmcnt(2) lgkmcnt(8)
    v_mfma_f32_16x16x32_bf16 v[16:19], v[80:83], v[144:147], v[16:19]
    v_mfma_f32_16x16x32_bf16 v[48:51], v[80:83], v[148:151], v[48:51]
    v_mfma_f32_16x16x32_bf16 v[20:23], v[84:87], v[144:147], v[20:23]
    v_mfma_f32_16x16x32_bf16 v[52:55], v[84:87], v[148:151], v[52:55]
    v_mfma_f32_16x16x32_bf16 v[24:27], v[88:91], v[144:147], v[24:27]
    v_mfma_f32_16x16x32_bf16 v[56:59], v[88:91], v[148:151], v[56:59]
    v_mfma_f32_16x16x32_bf16 v[28:31], v[92:95], v[144:147], v[28:31]
    v_mfma_f32_16x16x32_bf16 v[60:63], v[92:95], v[148:151], v[60:63]
    v_mfma_f32_16x16x32_bf16 v[32:35], v[96:99], v[144:147], v[32:35]
    v_mfma_f32_16x16x32_bf16 v[64:67], v[96:99], v[148:151], v[64:67]
    v_mfma_f32_16x16x32_bf16 v[36:39], v[100:103], v[144:147], v[36:39]
    v_mfma_f32_16x16x32_bf16 v[68:71], v[100:103], v[148:151], v[68:71]
    v_mfma_f32_16x16x32_bf16 v[40:43], v[104:107], v[144:147], v[40:43]
    v_mfma_f32_16x16x32_bf16 v[72:75], v[104:107], v[148:151], v[72:75]
    v_mfma_f32_16x16x32_bf16 v[44:47], v[108:111], v[144:147], v[44:47]
    v_mfma_f32_16x16x32_bf16 v[76:79], v[108:111], v[148:151], v[76:79]
    s_add_u32 s19, s22, 10240
    buffer_load_dwordx4 v[144:147], v7, s[8:11], s19 offen
    s_add_u32 s19, s22, 26624
    buffer_load_dwordx4 v[148:151], v7, s[8:11], s19 offen
    ds_read_b128 v[80:83], v8 offset:640
    ds_read_b128 v[84:87], v8 offset:17280
    ds_read_b128 v[88:91], v8 offset:33920
    ds_read_b128 v[92:95], v8 offset:50560
    ds_read_b128 v[96:99], v9 offset:640
    ds_read_b128 v[100:103], v9 offset:17280
    ds_read_b128 v[104:107], v9 offset:33920
    ds_read_b128 v[108:111], v9 offset:50560
    s_waitcnt vmcnt(2) lgkmcnt(8)
    v_mfma_f32_16x16x32_bf16 v[16:19], v[112:115], v[152:155], v[16:19]
    v_mfma_f32_16x16x32_bf16 v[48:51], v[112:115], v[156:159], v[48:51]
    v_mfma_f32_16x16x32_bf16 v[20:23], v[116:119], v[152:155], v[20:23]
    v_mfma_f32_16x16x32_bf16 v[52:55], v[116:119], v[156:159], v[52:55]
    v_mfma_f32_16x16x32_bf16 v[24:27], v[120:123], v[152:155], v[24:27]
    v_mfma_f32_16x16x32_bf16 v[56:59], v[120:123], v[156:159], v[56:59]
    v_mfma_f32_16x16x32_bf16 v[28:31], v[124:127], v[152:155], v[28:31]
    v_mfma_f32_16x16x32_bf16 v[60:63], v[124:127], v[156:159], v[60:63]
    v_mfma_f32_16x16x32_bf16 v[32:35], v[128:131], v[152:155], v[32:35]
    v_mfma_f32_16x16x32_bf16 v[64:67], v[128:131], v[156:159], v[64:67]
    v_mfma_f32_16x16x32_bf16 v[36:39], v[132:135], v[152:155], v[36:39]
    v_mfma_f32_16x16x32_bf16 v[68:71], v[132:135], v[156:159], v[68:71]
    v_mfma_f32_16x16x32_bf16 v[40:43], v[136:139], v[152:155], v[40:43]
    v_mfma_f32_16x16x32_bf16 v[72:75], v[136:139], v[156:159], v[72:75]
    v_mfma_f32_16x16x32_bf16 v[44:47], v[140:143], v[152:155], v[44:47]
    v_mfma_f32_16x16x32_bf16 v[76:79], v[140:143], v[156:159], v[76:79]
    s_add_u32 s19, s22, 11264
    buffer_load_dwordx4 v[152:155], v7, s[8:11], s19 offen
    s_add_u32 s19, s22, 27648
    buffer_load_dwordx4 v[156:159], v7, s[8:11], s19 offen
    ds_read_b128 v[112:115], v8 offset:704
    ds_read_b128 v[116:119], v8 offset:17344
    ds_read_b128 v[120:123], v8 offset:33984
    ds_read_b128 v[124:127], v8 offset:50624
    ds_read_b128 v[128:131], v9 offset:704
    ds_read_b128 v[132:135], v9 offset:17344
    ds_read_b128 v[136:139], v9 offset:33984
    ds_read_b128 v[140:143], v9 offset:50624
    s_waitcnt vmcnt(2) lgkmcnt(8)
    v_mfma_f32_16x16x32_bf16 v[16:19], v[80:83], v[144:147], v[16:19]
    v_mfma_f32_16x16x32_bf16 v[48:51], v[80:83], v[148:151], v[48:51]
    v_mfma_f32_16x16x32_bf16 v[20:23], v[84:87], v[144:147], v[20:23]
    v_mfma_f32_16x16x32_bf16 v[52:55], v[84:87], v[148:151], v[52:55]
    v_mfma_f32_16x16x32_bf16 v[24:27], v[88:91], v[144:147], v[24:27]
    v_mfma_f32_16x16x32_bf16 v[56:59], v[88:91], v[148:151], v[56:59]
    v_mfma_f32_16x16x32_bf16 v[28:31], v[92:95], v[144:147], v[28:31]
    v_mfma_f32_16x16x32_bf16 v[60:63], v[92:95], v[148:151], v[60:63]
    v_mfma_f32_16x16x32_bf16 v[32:35], v[96:99], v[144:147], v[32:35]
    v_mfma_f32_16x16x32_bf16 v[64:67], v[96:99], v[148:151], v[64:67]
    v_mfma_f32_16x16x32_bf16 v[36:39], v[100:103], v[144:147], v[36:39]
    v_mfma_f32_16x16x32_bf16 v[68:71], v[100:103], v[148:151], v[68:71]
    v_mfma_f32_16x16x32_bf16 v[40:43], v[104:107], v[144:147], v[40:43]
    v_mfma_f32_16x16x32_bf16 v[72:75], v[104:107], v[148:151], v[72:75]
    v_mfma_f32_16x16x32_bf16 v[44:47], v[108:111], v[144:147], v[44:47]
    v_mfma_f32_16x16x32_bf16 v[76:79], v[108:111], v[148:151], v[76:79]
    s_add_u32 s19, s22, 12288
    buffer_load_dwordx4 v[144:147], v7, s[8:11], s19 offen
    s_add_u32 s19, s22, 28672
    buffer_load_dwordx4 v[148:151], v7, s[8:11], s19 offen
    ds_read_b128 v[80:83], v8 offset:768
    ds_read_b128 v[84:87], v8 offset:17408
    ds_read_b128 v[88:91], v8 offset:34048
    ds_read_b128 v[92:95], v8 offset:50688
    ds_read_b128 v[96:99], v9 offset:768
    ds_read_b128 v[100:103], v9 offset:17408
    ds_read_b128 v[104:107], v9 offset:34048
    ds_read_b128 v[108:111], v9 offset:50688
    s_waitcnt vmcnt(2) lgkmcnt(8)
    v_mfma_f32_16x16x32_bf16 v[16:19], v[112:115], v[152:155], v[16:19]
    v_mfma_f32_16x16x32_bf16 v[48:51], v[112:115], v[156:159], v[48:51]
    v_mfma_f32_16x16x32_bf16 v[20:23], v[116:119], v[152:155], v[20:23]
    v_mfma_f32_16x16x32_bf16 v[52:55], v[116:119], v[156:159], v[52:55]
    v_mfma_f32_16x16x32_bf16 v[24:27], v[120:123], v[152:155], v[24:27]
    v_mfma_f32_16x16x32_bf16 v[56:59], v[120:123], v[156:159], v[56:59]
    v_mfma_f32_16x16x32_bf16 v[28:31], v[124:127], v[152:155], v[28:31]
    v_mfma_f32_16x16x32_bf16 v[60:63], v[124:127], v[156:159], v[60:63]
    v_mfma_f32_16x16x32_bf16 v[32:35], v[128:131], v[152:155], v[32:35]
    v_mfma_f32_16x16x32_bf16 v[64:67], v[128:131], v[156:159], v[64:67]
    v_mfma_f32_16x16x32_bf16 v[36:39], v[132:135], v[152:155], v[36:39]
    v_mfma_f32_16x16x32_bf16 v[68:71], v[132:135], v[156:159], v[68:71]
    v_mfma_f32_16x16x32_bf16 v[40:43], v[136:139], v[152:155], v[40:43]
    v_mfma_f32_16x16x32_bf16 v[72:75], v[136:139], v[156:159], v[72:75]
    v_mfma_f32_16x16x32_bf16 v[44:47], v[140:143], v[152:155], v[44:47]
    v_mfma_f32_16x16x32_bf16 v[76:79], v[140:143], v[156:159], v[76:79]
    s_add_u32 s19, s22, 13312
    buffer_load_dwordx4 v[152:155], v7, s[8:11], s19 offen
    s_add_u32 s19, s22, 29696
    buffer_load_dwordx4 v[156:159], v7, s[8:11], s19 offen
    ds_read_b128 v[112:115], v8 offset:832
    ds_read_b128 v[116:119], v8 offset:17472
    ds_read_b128 v[120:123], v8 offset:34112
    ds_read_b128 v[124:127], v8 offset:50752
    ds_read_b128 v[128:131], v9 offset:832
    ds_read_b128 v[132:135], v9 offset:17472
    ds_read_b128 v[136:139], v9 offset:34112
    ds_read_b128 v[140:143], v9 offset:50752
    s_waitcnt vmcnt(2) lgkmcnt(8)
    v_mfma_f32_16x16x32_bf16 v[16:19], v[80:83], v[144:147], v[16:19]
    v_mfma_f32_16x16x32_bf16 v[48:51], v[80:83], v[148:151], v[48:51]
    v_mfma_f32_16x16x32_bf16 v[20:23], v[84:87], v[144:147], v[20:23]
    v_mfma_f32_16x16x32_bf16 v[52:55], v[84:87], v[148:151], v[52:55]
    v_mfma_f32_16x16x32_bf16 v[24:27], v[88:91], v[144:147], v[24:27]
    v_mfma_f32_16x16x32_bf16 v[56:59], v[88:91], v[148:151], v[56:59]
    v_mfma_f32_16x16x32_bf16 v[28:31], v[92:95], v[144:147], v[28:31]
    v_mfma_f32_16x16x32_bf16 v[60:63], v[92:95], v[148:151], v[60:63]
    v_mfma_f32_16x16x32_bf16 v[32:35], v[96:99], v[144:147], v[32:35]
    v_mfma_f32_16x16x32_bf16 v[64:67], v[96:99], v[148:151], v[64:67]
    v_mfma_f32_16x16x32_bf16 v[36:39], v[100:103], v[144:147], v[36:39]
    v_mfma_f32_16x16x32_bf16 v[68:71], v[100:103], v[148:151], v[68:71]
    v_mfma_f32_16x16x32_bf16 v[40:43], v[104:107], v[144:147], v[40:43]
    v_mfma_f32_16x16x32_bf16 v[72:75], v[104:107], v[148:151], v[72:75]
    v_mfma_f32_16x16x32_bf16 v[44:47], v[108:111], v[144:147], v[44:47]
    v_mfma_f32_16x16x32_bf16 v[76:79], v[108:111], v[148:151], v[76:79]
    s_add_u32 s19, s22, 14336
    buffer_load_dwordx4 v[144:147], v7, s[8:11], s19 offen
    s_add_u32 s19, s22, 30720
    buffer_load_dwordx4 v[148:151], v7, s[8:11], s19 offen
    ds_read_b128 v[80:83], v8 offset:896
    ds_read_b128 v[84:87], v8 offset:17536
    ds_read_b128 v[88:91], v8 offset:34176
    ds_read_b128 v[92:95], v8 offset:50816
    ds_read_b128 v[96:99], v9 offset:896
    ds_read_b128 v[100:103], v9 offset:17536
    ds_read_b128 v[104:107], v9 offset:34176
    ds_read_b128 v[108:111], v9 offset:50816
    s_waitcnt vmcnt(2) lgkmcnt(8)
    v_mfma_f32_16x16x32_bf16 v[16:19], v[112:115], v[152:155], v[16:19]
    v_mfma_f32_16x16x32_bf16 v[48:51], v[112:115], v[156:159], v[48:51]
    v_mfma_f32_16x16x32_bf16 v[20:23], v[116:119], v[152:155], v[20:23]
    v_mfma_f32_16x16x32_bf16 v[52:55], v[116:119], v[156:159], v[52:55]
    v_mfma_f32_16x16x32_bf16 v[24:27], v[120:123], v[152:155], v[24:27]
    v_mfma_f32_16x16x32_bf16 v[56:59], v[120:123], v[156:159], v[56:59]
    v_mfma_f32_16x16x32_bf16 v[28:31], v[124:127], v[152:155], v[28:31]
    v_mfma_f32_16x16x32_bf16 v[60:63], v[124:127], v[156:159], v[60:63]
    v_mfma_f32_16x16x32_bf16 v[32:35], v[128:131], v[152:155], v[32:35]
    v_mfma_f32_16x16x32_bf16 v[64:67], v[128:131], v[156:159], v[64:67]
    v_mfma_f32_16x16x32_bf16 v[36:39], v[132:135], v[152:155], v[36:39]
    v_mfma_f32_16x16x32_bf16 v[68:71], v[132:135], v[156:159], v[68:71]
    v_mfma_f32_16x16x32_bf16 v[40:43], v[136:139], v[152:155], v[40:43]
    v_mfma_f32_16x16x32_bf16 v[72:75], v[136:139], v[156:159], v[72:75]
    v_mfma_f32_16x16x32_bf16 v[44:47], v[140:143], v[152:155], v[44:47]
    v_mfma_f32_16x16x32_bf16 v[76:79], v[140:143], v[156:159], v[76:79]
    s_add_u32 s19, s22, 15360
    buffer_load_dwordx4 v[152:155], v7, s[8:11], s19 offen
    s_add_u32 s19, s22, 31744
    buffer_load_dwordx4 v[156:159], v7, s[8:11], s19 offen
    ds_read_b128 v[112:115], v8 offset:960
    ds_read_b128 v[116:119], v8 offset:17600
    ds_read_b128 v[120:123], v8 offset:34240
    ds_read_b128 v[124:127], v8 offset:50880
    ds_read_b128 v[128:131], v9 offset:960
    ds_read_b128 v[132:135], v9 offset:17600
    ds_read_b128 v[136:139], v9 offset:34240
    ds_read_b128 v[140:143], v9 offset:50880
    s_waitcnt vmcnt(2) lgkmcnt(8)
    v_mfma_f32_16x16x32_bf16 v[16:19], v[80:83], v[144:147], v[16:19]
    v_mfma_f32_16x16x32_bf16 v[48:51], v[80:83], v[148:151], v[48:51]
    v_mfma_f32_16x16x32_bf16 v[20:23], v[84:87], v[144:147], v[20:23]
    v_mfma_f32_16x16x32_bf16 v[52:55], v[84:87], v[148:151], v[52:55]
    v_mfma_f32_16x16x32_bf16 v[24:27], v[88:91], v[144:147], v[24:27]
    v_mfma_f32_16x16x32_bf16 v[56:59], v[88:91], v[148:151], v[56:59]
    v_mfma_f32_16x16x32_bf16 v[28:31], v[92:95], v[144:147], v[28:31]
    v_mfma_f32_16x16x32_bf16 v[60:63], v[92:95], v[148:151], v[60:63]
    v_mfma_f32_16x16x32_bf16 v[32:35], v[96:99], v[144:147], v[32:35]
    v_mfma_f32_16x16x32_bf16 v[64:67], v[96:99], v[148:151], v[64:67]
    v_mfma_f32_16x16x32_bf16 v[36:39], v[100:103], v[144:147], v[36:39]
    v_mfma_f32_16x16x32_bf16 v[68:71], v[100:103], v[148:151], v[68:71]
    v_mfma_f32_16x16x32_bf16 v[40:43], v[104:107], v[144:147], v[40:43]
    v_mfma_f32_16x16x32_bf16 v[72:75], v[104:107], v[148:151], v[72:75]
    v_mfma_f32_16x16x32_bf16 v[44:47], v[108:111], v[144:147], v[44:47]
    v_mfma_f32_16x16x32_bf16 v[76:79], v[108:111], v[148:151], v[76:79]
    s_waitcnt vmcnt(0) lgkmcnt(0)
    v_mfma_f32_16x16x32_bf16 v[16:19], v[112:115], v[152:155], v[16:19]
    v_mfma_f32_16x16x32_bf16 v[48:51], v[112:115], v[156:159], v[48:51]
    v_mfma_f32_16x16x32_bf16 v[20:23], v[116:119], v[152:155], v[20:23]
    v_mfma_f32_16x16x32_bf16 v[52:55], v[116:119], v[156:159], v[52:55]
    v_mfma_f32_16x16x32_bf16 v[24:27], v[120:123], v[152:155], v[24:27]
    v_mfma_f32_16x16x32_bf16 v[56:59], v[120:123], v[156:159], v[56:59]
    v_mfma_f32_16x16x32_bf16 v[28:31], v[124:127], v[152:155], v[28:31]
    v_mfma_f32_16x16x32_bf16 v[60:63], v[124:127], v[156:159], v[60:63]
    v_mfma_f32_16x16x32_bf16 v[32:35], v[128:131], v[152:155], v[32:35]
    v_mfma_f32_16x16x32_bf16 v[64:67], v[128:131], v[156:159], v[64:67]
    v_mfma_f32_16x16x32_bf16 v[36:39], v[132:135], v[152:155], v[36:39]
    v_mfma_f32_16x16x32_bf16 v[68:71], v[132:135], v[156:159], v[68:71]
    v_mfma_f32_16x16x32_bf16 v[40:43], v[136:139], v[152:155], v[40:43]
    v_mfma_f32_16x16x32_bf16 v[72:75], v[136:139], v[156:159], v[72:75]
    v_mfma_f32_16x16x32_bf16 v[44:47], v[140:143], v[152:155], v[44:47]
    v_mfma_f32_16x16x32_bf16 v[76:79], v[140:143], v[156:159], v[76:79]
    s_nop 7
    s_lshl_b32 s23, s3, 2
    s_lshl_b32 s23, s23, 5
    s_add_u32 s23, s23, s6
    s_lshl_b32 s23, s23, 13
    s_lshl_b32 s19, s16, 11
    s_add_u32 s23, s23, s19
    s_add_u32 s23, s23, 67108864
    v_cvt_pk_bf16_f32 v80, v16, v17
    v_cvt_pk_bf16_f32 v81, v18, v19
    v_cvt_pk_bf16_f32 v82, v20, v21
    v_cvt_pk_bf16_f32 v83, v22, v23
    s_add_u32 s19, s23, 0
    buffer_store_dwordx4 v[80:83], v7, s[8:11], s19 offen sc1
    s_nop 1
    v_cvt_pk_bf16_f32 v84, v48, v49
    v_cvt_pk_bf16_f32 v85, v50, v51
    v_cvt_pk_bf16_f32 v86, v52, v53
    v_cvt_pk_bf16_f32 v87, v54, v55
    s_add_u32 s19, s23, 1024
    buffer_store_dwordx4 v[84:87], v7, s[8:11], s19 offen sc1
    s_nop 1
    v_cvt_pk_bf16_f32 v80, v24, v25
    v_cvt_pk_bf16_f32 v81, v26, v27
    v_cvt_pk_bf16_f32 v82, v28, v29
    v_cvt_pk_bf16_f32 v83, v30, v31
    s_add_u32 s19, s23, 262144
    buffer_store_dwordx4 v[80:83], v7, s[8:11], s19 offen sc1
    s_nop 1
    v_cvt_pk_bf16_f32 v84, v56, v57
    v_cvt_pk_bf16_f32 v85, v58, v59
    v_cvt_pk_bf16_f32 v86, v60, v61
    v_cvt_pk_bf16_f32 v87, v62, v63
    s_add_u32 s19, s23, 263168
    buffer_store_dwordx4 v[84:87], v7, s[8:11], s19 offen sc1
    s_nop 1
    v_cvt_pk_bf16_f32 v80, v32, v33
    v_cvt_pk_bf16_f32 v81, v34, v35
    v_cvt_pk_bf16_f32 v82, v36, v37
    v_cvt_pk_bf16_f32 v83, v38, v39
    s_add_u32 s19, s23, 524288
    buffer_store_dwordx4 v[80:83], v7, s[8:11], s19 offen sc1
    s_nop 1
    v_cvt_pk_bf16_f32 v84, v64, v65
    v_cvt_pk_bf16_f32 v85, v66, v67
    v_cvt_pk_bf16_f32 v86, v68, v69
    v_cvt_pk_bf16_f32 v87, v70, v71
    s_add_u32 s19, s23, 525312
    buffer_store_dwordx4 v[84:87], v7, s[8:11], s19 offen sc1
    s_nop 1
    v_cvt_pk_bf16_f32 v80, v40, v41
    v_cvt_pk_bf16_f32 v81, v42, v43
    v_cvt_pk_bf16_f32 v82, v44, v45
    v_cvt_pk_bf16_f32 v83, v46, v47
    s_add_u32 s19, s23, 786432
    buffer_store_dwordx4 v[80:83], v7, s[8:11], s19 offen sc1
    s_nop 1
    v_cvt_pk_bf16_f32 v84, v72, v73
    v_cvt_pk_bf16_f32 v85, v74, v75
    v_cvt_pk_bf16_f32 v86, v76, v77
    v_cvt_pk_bf16_f32 v87, v78, v79
    s_add_u32 s19, s23, 787456
    buffer_store_dwordx4 v[84:87], v7, s[8:11], s19 offen sc1
    s_nop 1
    s_waitcnt vmcnt(0)
    s_barrier
    s_lshl_b32 s19, s27, 2
    s_add_u32 s19, s19, 19415296
    v_mov_b32 v80, 1
    v_mov_b32 v81, 0
    v_cmp_eq_u32 vcc, 0, v0
    s_and_saveexec_b64 s[30:31], vcc
    buffer_store_dword v80, v81, s[8:11], s19 offen sc1
    s_mov_b64 exec, s[30:31]
L_kb1_end_54:
    s_cmp_ge_u32 s36, 32
    s_cbranch_scc1 L_mega_wdone_55
    s_cmp_ge_u32 s27, 224
    s_cbranch_scc1 L_mega_wdone_55
    s_add_u32 s27, s36, 224
    s_barrier
    s_branch L_mega_tloop_53
L_mega_wdone_55:
L_mega_exit_19:
    s_endpgm
.section .rodata,"a"
.p2align 6
.amdhsa_kernel mega0_kernel
  .amdhsa_next_free_vgpr 512
  .amdhsa_next_free_sgpr 102
  .amdhsa_accum_offset 256
  .amdhsa_group_segment_fixed_size 0
  .amdhsa_kernarg_size 120
  .amdhsa_user_sgpr_count 2
  .amdhsa_user_sgpr_kernarg_segment_ptr 1
  .amdhsa_system_sgpr_workgroup_id_x 1
.end_amdhsa_kernel
.text

.p2align 8
.globl mega1_kernel
.type mega1_kernel,@function
mega1_kernel:
    s_cmp_ge_u32 s2, 256
    s_cbranch_scc1 L_mega_exit_56
    s_and_b32 s3, s2, 7
    s_cmp_lg_u32 s3, 0
    s_cbranch_scc1 L_mega_work_57
    s_lshr_b32 s3, s2, 3
    s_load_dwordx2 s[4:5], s[0:1], 48
    s_load_dwordx2 s[6:7], s[0:1], 112
    v_and_b32 v12, 63, v0
    v_lshrrev_b32 v13, 6, v0
    s_nop 0
    v_readfirstlane_b32 s16, v13
    s_waitcnt lgkmcnt(0)
    s_mov_b32 s8, s6
    s_and_b32 s9, s7, 0xffff
    s_mov_b32 s10, 268435456
    s_mov_b32 s11, 0x00020000
    s_mov_b32 s12, s4
    s_and_b32 s13, s5, 0xffff
    s_mov_b32 s14, 8192
    s_mov_b32 s15, 0x00020000
    s_getreg_b32 s19, hwreg(HW_REG_XCC_ID)
    s_and_b32 s19, s19, 0xf
    s_add_u32 s19, s19, 1
    v_mov_b32 v11, s19
    v_mov_b32 v12, 0
    s_lshl_b32 s19, s3, 2
    s_add_u32 s19, s19, 20463616
    s_cmp_lg_u32 s16, 0
    s_cbranch_scc1 L_chain_skipx_61
    buffer_store_dword v11, v12, s[8:11], s19 offen sc1
L_chain_skipx_61:
    v_and_b32 v12, 63, v0
    s_mov_b32 s20, 0x07060302
    s_mov_b32 s21, 0x3e0293ee
    s_mov_b32 s29, 4194304
    v_lshlrev_b32 v1, 4, v12
    v_lshrrev_b32 v13, 4, v12
    v_and_b32 v14, 15, v12
    v_lshlrev_b32 v2, 8, v13
    v_lshl_add_u32 v2, v14, 4, v2
    v_add_u32 v2, 131072, v2
    s_lshl_b32 s19, s16, 10
    s_add_u32 s19, s19, 147456
    v_add_u32 v3, s19, v1
    v_add_u32 v15, 147456, v1
    s_lshl_b32 s19, s16, 15
    v_add_u32 v4, s19, v1
    v_and_b32 v16, 7, v12
    v_bfe_u32 v17, v12, 3, 1
    v_lshlrev_b32 v5, 8, v13
    v_lshl_add_u32 v5, v16, 4, v5
    v_lshl_add_u32 v5, v17, 3, v5
    s_lshl_b32 s19, s16, 12
    s_add_u32 s19, s19, 131072
    v_add_u32 v5, s19, v5
    v_lshlrev_b32 v6, 6, v16
    v_lshrrev_b32 v18, 1, v13
    v_lshl_add_u32 v6, v18, 9, v6
    v_and_b32 v18, 1, v13
    v_lshl_add_u32 v6, v18, 5, v6
    v_lshl_add_u32 v6, v17, 4, v6
    s_lshl_b32 s19, s16, 12
    s_add_u32 s19, s19, 20447232
    v_add_u32 v6, s19, v6
    v_lshlrev_b32 v18, 10, v16
    v_lshl_add_u32 v18, v13, 4, v18
    v_lshl_add_u32 v18, v17, 3, v18
    s_lshl_b32 s19, s16, 8
    v_add_u32 v18, s19, v18
    v_lshlrev_b32 v7, 6, v14
    v_lshl_add_u32 v7, v13, 4, v7
    s_lshl_b32 s19, s16, 17
    s_lshl_b32 s22, s3, 9
    s_add_u32 s19, s19, s22
    s_add_u32 s19, s19, 19922944
    v_add_u32 v7, s19, v7
    v_mov_b32 v19, 1073741824
    v_cmp_gt_u32 vcc, 8, v14
    s_nop 1
    v_cndmask_b32 v7, v19, v7, vcc
    v_lshrrev_b32 v8, 3, v12
    v_lshlrev_b32 v8, 9, v8
    v_and_b32 v9, 7, v12
    v_lshl_add_u32 v8, v9, 4, v8
    s_lshl_b32 s19, s3, 14
    s_lshl_b32 s22, s16, 7
    s_add_u32 s19, s19, s22
    s_add_u32 s19, s19, 19922944
    v_add_u32 v8, s19, v8
    s_mov_b32 s32, 0
    s_mov_b32 s33, 4096
    s_mov_b32 s34, 8192
    s_mov_b32 s35, 12288
    v_lshlrev_b32 v10, 4, v9
    s_lshl_b32 s19, s3, 9
    s_lshl_b32 s22, s16, 7
    s_add_u32 s19, s19, s22
    s_add_u32 s19, s19, 20447232
    v_add_u32 v10, s19, v10
    v_cmp_gt_u32 vcc, 8, v12
    s_nop 1
    v_cndmask_b32 v10, v19, v10, vcc
    v_mov_b32 v11, 0xf149f2ca
    v_cmp_le_u32 vcc, 2, v13
    s_nop 1
    v_cndmask_b32 v16, 0, v11, vcc
    v_mov_b32 v17, v16
    v_mov_b32 v18, v18
    v_mov_b32 v20, 0
    v_mov_b32 v21, 0
    v_mov_b32 v22, 0
    v_mov_b32 v23, 0
    v_lshlrev_b32 v11, 4, v0
    v_add_u32 v11, 131072, v11
    ds_write_b128 v11, v[20:23] offset:0
    ds_write_b128 v11, v[20:23] offset:4096
    ds_write_b128 v11, v[20:23] offset:8192
    ds_write_b128 v11, v[20:23] offset:12288
    buffer_load_dwordx2 v[96:97], v18, s[12:15], 0 offen offset:0
    buffer_load_dwordx2 v[98:99], v18, s[12:15], 0 offen offset:64
    buffer_load_dwordx2 v[100:101], v18, s[12:15], 0 offen offset:128
    buffer_load_dwordx2 v[102:103], v18, s[12:15], 0 offen offset:192
    v_lshlrev_b32 v11, 4, v0
    s_lshl_b32 s22, s3, 17
    s_add_u32 s22, s22, 8388608
    s_add_u32 s19, s22, 0
    buffer_load_dwordx4 v[32:35], v11, s[8:11], s19 offen
    s_add_u32 s19, s22, 4096
    buffer_load_dwordx4 v[36:39], v11, s[8:11], s19 offen
    s_add_u32 s19, s22, 8192
    buffer_load_dwordx4 v[40:43], v11, s[8:11], s19 offen
    s_add_u32 s19, s22, 12288
    buffer_load_dwordx4 v[44:47], v11, s[8:11], s19 offen
    s_add_u32 s19, s22, 16384
    buffer_load_dwordx4 v[48:51], v11, s[8:11], s19 offen
    s_add_u32 s19, s22, 20480
    buffer_load_dwordx4 v[52:55], v11, s[8:11], s19 offen
    s_add_u32 s19, s22, 24576
    buffer_load_dwordx4 v[56:59], v11, s[8:11], s19 offen
    s_add_u32 s19, s22, 28672
    buffer_load_dwordx4 v[60:63], v11, s[8:11], s19 offen
    v_add_u32 v12, 0, v11
    s_waitcnt vmcnt(7)
    ds_write_b128 v12, v[32:35] offset:0
    s_waitcnt vmcnt(6)
    ds_write_b128 v12, v[36:39] offset:4096
    s_waitcnt vmcnt(5)
    ds_write_b128 v12, v[40:43] offset:8192
    s_waitcnt vmcnt(4)
    ds_write_b128 v12, v[44:47] offset:12288
    s_waitcnt vmcnt(3)
    ds_write_b128 v12, v[48:51] offset:16384
    s_waitcnt vmcnt(2)
    ds_write_b128 v12, v[52:55] offset:20480
    s_waitcnt vmcnt(1)
    ds_write_b128 v12, v[56:59] offset:24576
    s_waitcnt vmcnt(0)
    ds_write_b128 v12, v[60:63] offset:28672
    s_add_u32 s19, s22, 32768
    buffer_load_dwordx4 v[32:35], v11, s[8:11], s19 offen
    s_add_u32 s19, s22, 36864
    buffer_load_dwordx4 v[36:39], v11, s[8:11], s19 offen
    s_add_u32 s19, s22, 40960
    buffer_load_dwordx4 v[40:43], v11, s[8:11], s19 offen
    s_add_u32 s19, s22, 45056
    buffer_load_dwordx4 v[44:47], v11, s[8:11], s19 offen
    s_add_u32 s19, s22, 49152
    buffer_load_dwordx4 v[48:51], v11, s[8:11], s19 offen
    s_add_u32 s19, s22, 53248
    buffer_load_dwordx4 v[52:55], v11, s[8:11], s19 offen
    s_add_u32 s19, s22, 57344
    buffer_load_dwordx4 v[56:59], v11, s[8:11], s19 offen
    s_add_u32 s19, s22, 61440
    buffer_load_dwordx4 v[60:63], v11, s[8:11], s19 offen
    v_add_u32 v12, 32768, v11
    s_waitcnt vmcnt(7)
    ds_write_b128 v12, v[32:35] offset:0
    s_waitcnt vmcnt(6)
    ds_write_b128 v12, v[36:39] offset:4096
    s_waitcnt vmcnt(5)
    ds_write_b128 v12, v[40:43] offset:8192
    s_waitcnt vmcnt(4)
    ds_write_b128 v12, v[44:47] offset:12288
    s_waitcnt vmcnt(3)
    ds_write_b128 v12, v[48:51] offset:16384
    s_waitcnt vmcnt(2)
    ds_write_b128 v12, v[52:55] offset:20480
    s_waitcnt vmcnt(1)
    ds_write_b128 v12, v[56:59] offset:24576
    s_waitcnt vmcnt(0)
    ds_write_b128 v12, v[60:63] offset:28672
    s_add_u32 s19, s22, 65536
    buffer_load_dwordx4 v[32:35], v11, s[8:11], s19 offen
    s_add_u32 s19, s22, 69632
    buffer_load_dwordx4 v[36:39], v11, s[8:11], s19 offen
    s_add_u32 s19, s22, 73728
    buffer_load_dwordx4 v[40:43], v11, s[8:11], s19 offen
    s_add_u32 s19, s22, 77824
    buffer_load_dwordx4 v[44:47], v11, s[8:11], s19 offen
    s_add_u32 s19, s22, 81920
    buffer_load_dwordx4 v[48:51], v11, s[8:11], s19 offen
    s_add_u32 s19, s22, 86016
    buffer_load_dwordx4 v[52:55], v11, s[8:11], s19 offen
    s_add_u32 s19, s22, 90112
    buffer_load_dwordx4 v[56:59], v11, s[8:11], s19 offen
    s_add_u32 s19, s22, 94208
    buffer_load_dwordx4 v[60:63], v11, s[8:11], s19 offen
    v_add_u32 v12, 65536, v11
    s_waitcnt vmcnt(7)
    ds_write_b128 v12, v[32:35] offset:0
    s_waitcnt vmcnt(6)
    ds_write_b128 v12, v[36:39] offset:4096
    s_waitcnt vmcnt(5)
    ds_write_b128 v12, v[40:43] offset:8192
    s_waitcnt vmcnt(4)
    ds_write_b128 v12, v[44:47] offset:12288
    s_waitcnt vmcnt(3)
    ds_write_b128 v12, v[48:51] offset:16384
    s_waitcnt vmcnt(2)
    ds_write_b128 v12, v[52:55] offset:20480
    s_waitcnt vmcnt(1)
    ds_write_b128 v12, v[56:59] offset:24576
    s_waitcnt vmcnt(0)
    ds_write_b128 v12, v[60:63] offset:28672
    s_add_u32 s19, s22, 98304
    buffer_load_dwordx4 v[32:35], v11, s[8:11], s19 offen
    s_add_u32 s19, s22, 102400
    buffer_load_dwordx4 v[36:39], v11, s[8:11], s19 offen
    s_add_u32 s19, s22, 106496
    buffer_load_dwordx4 v[40:43], v11, s[8:11], s19 offen
    s_add_u32 s19, s22, 110592
    buffer_load_dwordx4 v[44:47], v11, s[8:11], s19 offen
    s_add_u32 s19, s22, 114688
    buffer_load_dwordx4 v[48:51], v11, s[8:11], s19 offen
    s_add_u32 s19, s22, 118784
    buffer_load_dwordx4 v[52:55], v11, s[8:11], s19 offen
    s_add_u32 s19, s22, 122880
    buffer_load_dwordx4 v[56:59], v11, s[8:11], s19 offen
    s_add_u32 s19, s22, 126976
    buffer_load_dwordx4 v[60:63], v11, s[8:11], s19 offen
    v_add_u32 v12, 98304, v11
    s_waitcnt vmcnt(7)
    ds_write_b128 v12, v[32:35] offset:0
    s_waitcnt vmcnt(6)
    ds_write_b128 v12, v[36:39] offset:4096
    s_waitcnt vmcnt(5)
    ds_write_b128 v12, v[40:43] offset:8192
    s_waitcnt vmcnt(4)
    ds_write_b128 v12, v[44:47] offset:12288
    s_waitcnt vmcnt(3)
    ds_write_b128 v12, v[48:51] offset:16384
    s_waitcnt vmcnt(2)
    ds_write_b128 v12, v[52:55] offset:20480
    s_waitcnt vmcnt(1)
    ds_write_b128 v12, v[56:59] offset:24576
    s_waitcnt vmcnt(0)
    ds_write_b128 v12, v[60:63] offset:28672
    s_waitcnt vmcnt(0)
    ds_write_b64 v5, v[96:97] offset:0
    ds_write_b64 v5, v[98:99] offset:1024
    ds_write_b64 v5, v[100:101] offset:2048
    ds_write_b64 v5, v[102:103] offset:3072
    s_lshl_b32 s22, s3, 17
    s_lshl_b32 s19, s16, 15
    s_add_u32 s22, s22, s19
    s_add_u32 s19, s22, 0
    buffer_load_dwordx4 a[0:3], v1, s[8:11], s19 offen offset:0
    buffer_load_dwordx4 a[4:7], v1, s[8:11], s19 offen offset:1024
    buffer_load_dwordx4 a[8:11], v1, s[8:11], s19 offen offset:2048
    buffer_load_dwordx4 a[12:15], v1, s[8:11], s19 offen offset:3072
    s_add_u32 s19, s22, 4096
    buffer_load_dwordx4 a[16:19], v1, s[8:11], s19 offen offset:0
    buffer_load_dwordx4 a[20:23], v1, s[8:11], s19 offen offset:1024
    buffer_load_dwordx4 a[24:27], v1, s[8:11], s19 offen offset:2048
    buffer_load_dwordx4 a[28:31], v1, s[8:11], s19 offen offset:3072
    s_add_u32 s19, s22, 8192
    buffer_load_dwordx4 a[32:35], v1, s[8:11], s19 offen offset:0
    buffer_load_dwordx4 a[36:39], v1, s[8:11], s19 offen offset:1024
    buffer_load_dwordx4 a[40:43], v1, s[8:11], s19 offen offset:2048
    buffer_load_dwordx4 a[44:47], v1, s[8:11], s19 offen offset:3072
    s_add_u32 s19, s22, 12288
    buffer_load_dwordx4 a[48:51], v1, s[8:11], s19 offen offset:0
    buffer_load_dwordx4 a[52:55], v1, s[8:11], s19 offen offset:1024
    buffer_load_dwordx4 a[56:59], v1, s[8:11], s19 offen offset:2048
    buffer_load_dwordx4 a[60:63], v1, s[8:11], s19 offen offset:3072
    s_add_u32 s19, s22, 16384
    buffer_load_dwordx4 a[64:67], v1, s[8:11], s19 offen offset:0
    buffer_load_dwordx4 a[68:71], v1, s[8:11], s19 offen offset:1024
    buffer_load_dwordx4 a[72:75], v1, s[8:11], s19 offen offset:2048
    buffer_load_dwordx4 a[76:79], v1, s[8:11], s19 offen offset:3072
    s_add_u32 s19, s22, 20480
    buffer_load_dwordx4 a[80:83], v1, s[8:11], s19 offen offset:0
    buffer_load_dwordx4 a[84:87], v1, s[8:11], s19 offen offset:1024
    buffer_load_dwordx4 a[88:91], v1, s[8:11], s19 offen offset:2048
    buffer_load_dwordx4 a[92:95], v1, s[8:11], s19 offen offset:3072
    s_add_u32 s19, s22, 24576
    buffer_load_dwordx4 a[96:99], v1, s[8:11], s19 offen offset:0
    buffer_load_dwordx4 a[100:103], v1, s[8:11], s19 offen offset:1024
    buffer_load_dwordx4 a[104:107], v1, s[8:11], s19 offen offset:2048
    buffer_load_dwordx4 a[108:111], v1, s[8:11], s19 offen offset:3072
    s_add_u32 s19, s22, 28672
    buffer_load_dwordx4 a[112:115], v1, s[8:11], s19 offen offset:0
    buffer_load_dwordx4 a[116:119], v1, s[8:11], s19 offen offset:1024
    buffer_load_dwordx4 a[120:123], v1, s[8:11], s19 offen offset:2048
    buffer_load_dwordx4 a[124:127], v1, s[8:11], s19 offen offset:3072
    s_add_u32 s19, s22, 4194304
    buffer_load_dwordx4 a[128:131], v1, s[8:11], s19 offen offset:0
    buffer_load_dwordx4 a[132:135], v1, s[8:11], s19 offen offset:1024
    buffer_load_dwordx4 a[136:139], v1, s[8:11], s19 offen offset:2048
    buffer_load_dwordx4 a[140:143], v1, s[8:11], s19 offen offset:3072
    s_add_u32 s19, s22, 4198400
    buffer_load_dwordx4 a[144:147], v1, s[8:11], s19 offen offset:0
    buffer_load_dwordx4 a[148:151], v1, s[8:11], s19 offen offset:1024
    buffer_load_dwordx4 a[152:155], v1, s[8:11], s19 offen offset:2048
    buffer_load_dwordx4 a[156:159], v1, s[8:11], s19 offen offset:3072
    s_add_u32 s19, s22, 4202496
    buffer_load_dwordx4 a[160:163], v1, s[8:11], s19 offen offset:0
    buffer_load_dwordx4 a[164:167], v1, s[8:11], s19 offen offset:1024
    buffer_load_dwordx4 a[168:171], v1, s[8:11], s19 offen offset:2048
    buffer_load_dwordx4 a[172:175], v1, s[8:11], s19 offen offset:3072
    s_add_u32 s19, s22, 4206592
    buffer_load_dwordx4 a[176:179], v1, s[8:11], s19 offen offset:0
    buffer_load_dwordx4 a[180:183], v1, s[8:11], s19 offen offset:1024
    buffer_load_dwordx4 a[184:187], v1, s[8:11], s19 offen offset:2048
    buffer_load_dwordx4 a[188:191], v1, s[8:11], s19 offen offset:3072
    s_add_u32 s19, s22, 4210688
    buffer_load_dwordx4 a[192:195], v1, s[8:11], s19 offen offset:0
    buffer_load_dwordx4 a[196:199], v1, s[8:11], s19 offen offset:1024
    buffer_load_dwordx4 a[200:203], v1, s[8:11], s19 offen offset:2048
    buffer_load_dwordx4 a[204:207], v1, s[8:11], s19 offen offset:3072
    s_add_u32 s19, s22, 4214784
    buffer_load_dwordx4 a[208:211], v1, s[8:11], s19 offen offset:0
    buffer_load_dwordx4 a[212:215], v1, s[8:11], s19 offen offset:1024
    buffer_load_dwordx4 a[216:219], v1, s[8:11], s19 offen offset:2048
    buffer_load_dwordx4 a[220:223], v1, s[8:11], s19 offen offset:3072
    s_add_u32 s19, s22, 4218880
    buffer_load_dwordx4 a[224:227], v1, s[8:11], s19 offen offset:0
    buffer_load_dwordx4 a[228:231], v1, s[8:11], s19 offen offset:1024
    buffer_load_dwordx4 a[232:235], v1, s[8:11], s19 offen offset:2048
    buffer_load_dwordx4 a[236:239], v1, s[8:11], s19 offen offset:3072
    s_add_u32 s19, s22, 4222976
    buffer_load_dwordx4 a[240:243], v1, s[8:11], s19 offen offset:0
    buffer_load_dwordx4 a[244:247], v1, s[8:11], s19 offen offset:1024
    buffer_load_dwordx4 a[248:251], v1, s[8:11], s19 offen offset:2048
    buffer_load_dwordx4 a[252:255], v1, s[8:11], s19 offen offset:3072
    s_add_u32 s19, s22, 8388608
    s_add_u32 s19, s22, 8392704
    s_add_u32 s19, s22, 8396800
    s_add_u32 s19, s22, 8400896
    s_add_u32 s19, s22, 8404992
    s_add_u32 s19, s22, 8409088
    s_add_u32 s19, s22, 8413184
    s_add_u32 s19, s22, 8417280
    s_lshl_b32 s22, s3, 17
    s_lshl_b32 s19, s16, 15
    s_add_u32 s22, s22, s19
    s_add_u32 s22, s22, 12582912
    s_add_u32 s19, s22, 0
    buffer_load_dwordx4 v[128:131], v1, s[8:11], s19 offen offset:0
    buffer_load_dwordx4 v[132:135], v1, s[8:11], s19 offen offset:1024
    buffer_load_dwordx4 v[136:139], v1, s[8:11], s19 offen offset:2048
    buffer_load_dwordx4 v[140:143], v1, s[8:11], s19 offen offset:3072
    s_add_u32 s19, s22, 4096
    buffer_load_dwordx4 v[144:147], v1, s[8:11], s19 offen offset:0
    buffer_load_dwordx4 v[148:151], v1, s[8:11], s19 offen offset:1024
    buffer_load_dwordx4 v[152:155], v1, s[8:11], s19 offen offset:2048
    buffer_load_dwordx4 v[156:159], v1, s[8:11], s19 offen offset:3072
    s_add_u32 s19, s22, 8192
    buffer_load_dwordx4 v[160:163], v1, s[8:11], s19 offen offset:0
    buffer_load_dwordx4 v[164:167], v1, s[8:11], s19 offen offset:1024
    buffer_load_dwordx4 v[168:171], v1, s[8:11], s19 offen offset:2048
    buffer_load_dwordx4 v[172:175], v1, s[8:11], s19 offen offset:3072
    s_add_u32 s19, s22, 12288
    buffer_load_dwordx4 v[176:179], v1, s[8:11], s19 offen offset:0
    buffer_load_dwordx4 v[180:183], v1, s[8:11], s19 offen offset:1024
    buffer_load_dwordx4 v[184:187], v1, s[8:11], s19 offen offset:2048
    buffer_load_dwordx4 v[188:191], v1, s[8:11], s19 offen offset:3072
    s_add_u32 s19, s22, 16384
    buffer_load_dwordx4 v[192:195], v1, s[8:11], s19 offen offset:0
    buffer_load_dwordx4 v[196:199], v1, s[8:11], s19 offen offset:1024
    buffer_load_dwordx4 v[200:203], v1, s[8:11], s19 offen offset:2048
    buffer_load_dwordx4 v[204:207], v1, s[8:11], s19 offen offset:3072
    s_add_u32 s19, s22, 20480
    buffer_load_dwordx4 v[208:211], v1, s[8:11], s19 offen offset:0
    buffer_load_dwordx4 v[212:215], v1, s[8:11], s19 offen offset:1024
    buffer_load_dwordx4 v[216:219], v1, s[8:11], s19 offen offset:2048
    buffer_load_dwordx4 v[220:223], v1, s[8:11], s19 offen offset:3072
    s_add_u32 s19, s22, 24576
    buffer_load_dwordx4 v[224:227], v1, s[8:11], s19 offen offset:0
    buffer_load_dwordx4 v[228:231], v1, s[8:11], s19 offen offset:1024
    buffer_load_dwordx4 v[232:235], v1, s[8:11], s19 offen offset:2048
    buffer_load_dwordx4 v[236:239], v1, s[8:11], s19 offen offset:3072
    s_add_u32 s19, s22, 28672
    buffer_load_dwordx4 v[240:243], v1, s[8:11], s19 offen offset:0
    buffer_load_dwordx4 v[244:247], v1, s[8:11], s19 offen offset:1024
    buffer_load_dwordx4 v[248:251], v1, s[8:11], s19 offen offset:2048
    buffer_load_dwordx4 v[252:255], v1, s[8:11], s19 offen offset:3072
    v_mov_b32 v18, v16
    v_mov_b32 v19, v16
    v_mov_b32 v22, 0
    v_mov_b32 v23, 0
    v_mov_b32 v26, 0
    v_mov_b32 v27, 0
    v_mov_b32 v30, 0
    v_mov_b32 v31, 0
    s_mov_b32 s17, 0
    s_and_b32 s25, s17, 3
    s_cmp_lg_u32 s25, 0
    s_cbranch_scc1 L_chain_t1skip_62
    s_lshr_b32 s25, s17, 2
    s_lshl_b32 s25, s25, 6
    s_lshr_b32 s26, s3, 1
    s_lshl_b32 s26, s26, 2
    s_add_u32 s25, s25, s26
    s_add_u32 s25, s25, 20463872
    v_mov_b32 v124, 0
L_chain_t1wait_63:
    s_sub_u32 s29, s29, 1
    s_cbranch_scc1 L_chain_bail_60
    buffer_load_dword v125, v124, s[8:11], s25 offen sc1
    s_waitcnt vmcnt(0)
    v_cmp_eq_u32 vcc, 0, v125
    s_cbranch_vccnz L_chain_t1wait_63
L_chain_t1skip_62:
    s_lshl_b32 s23, s3, 13
    s_add_u32 s19, s23, 142606336
    s_add_u32 s22, s19, 4096
    buffer_load_dwordx4 v[32:35], v1, s[8:11], s19 offen offset:0 sc1
    buffer_load_dwordx4 v[36:39], v1, s[8:11], s19 offen offset:1024 sc1
    buffer_load_dwordx4 v[40:43], v1, s[8:11], s19 offen offset:2048 sc1
    buffer_load_dwordx4 v[44:47], v1, s[8:11], s19 offen offset:3072 sc1
    buffer_load_dwordx4 v[48:51], v1, s[8:11], s22 offen offset:0 sc1
    buffer_load_dwordx4 v[52:55], v1, s[8:11], s22 offen offset:1024 sc1
    buffer_load_dwordx4 v[56:59], v1, s[8:11], s22 offen offset:2048 sc1
    buffer_load_dwordx4 v[60:63], v1, s[8:11], s22 offen offset:3072 sc1
    s_lshl_b32 s19, s16, 11
    s_add_u32 s19, s19, s23
    s_add_u32 s19, s19, 159383552
    buffer_load_dwordx4 v[64:67], v1, s[8:11], s19 offen offset:0 sc1
    buffer_load_dwordx4 v[68:71], v1, s[8:11], s19 offen offset:1024 sc1
    v_lshrrev_b32 v11, 0, v1
    v_and_b32 v11, 0x1f0, v1
    v_lshrrev_b32 v11, 2, v11
    v_add_u32 v11, 20463616, v11
L_chain_xpoll_64:
    s_sub_u32 s29, s29, 1
    s_cbranch_scc1 L_chain_bail_60
    buffer_load_dword v12, v11, s[8:11], 0 offen sc1
    s_waitcnt vmcnt(0)
    v_cmp_eq_u32 vcc, 0, v12
    s_cbranch_vccnz L_chain_xpoll_64
    v_readfirstlane_b32 s19, v12
    s_nop 3
    v_cmp_ne_u32 vcc, s19, v12
    s_mov_b32 s28, 1
    s_cbranch_vccz L_chain_xq_65
    s_mov_b32 s28, 0
L_chain_xq_65:
    s_waitcnt vmcnt(0) lgkmcnt(0)
    s_barrier
L_chain_step_66:
    s_add_u32 s18, s17, 1
    s_and_b32 s18, s18, 3
    v_mov_b32 v11, s18
    ds_read_b128 v[96:99], v2 offset:0
    ds_read_b128 v[100:103], v2 offset:1024
    ds_read_b128 v[104:107], v2 offset:2048
    s_waitcnt lgkmcnt(2)
    v_mfma_f32_16x16x32_bf16 v[72:75], a[0:3], v[96:99], 0
    v_mfma_f32_16x16x32_bf16 v[76:79], a[64:67], v[96:99], 0
    v_mfma_f32_16x16x32_bf16 v[80:83], a[128:131], v[96:99], 0
    v_mfma_f32_16x16x32_bf16 v[84:87], a[192:195], v[96:99], 0
    ds_read_b128 v[96:99], v2 offset:3072
    s_waitcnt lgkmcnt(2)
    v_mfma_f32_16x16x32_bf16 v[72:75], a[4:7], v[100:103], v[72:75]
    v_mfma_f32_16x16x32_bf16 v[76:79], a[68:71], v[100:103], v[76:79]
    v_mfma_f32_16x16x32_bf16 v[80:83], a[132:135], v[100:103], v[80:83]
    v_mfma_f32_16x16x32_bf16 v[84:87], a[196:199], v[100:103], v[84:87]
    ds_read_b128 v[100:103], v2 offset:4096
    s_waitcnt lgkmcnt(2)
    v_mfma_f32_16x16x32_bf16 v[72:75], a[8:11], v[104:107], v[72:75]
    v_mfma_f32_16x16x32_bf16 v[76:79], a[72:75], v[104:107], v[76:79]
    v_mfma_f32_16x16x32_bf16 v[80:83], a[136:139], v[104:107], v[80:83]
    v_mfma_f32_16x16x32_bf16 v[84:87], a[200:203], v[104:107], v[84:87]
    ds_read_b128 v[104:107], v2 offset:5120
    s_waitcnt lgkmcnt(2)
    v_mfma_f32_16x16x32_bf16 v[72:75], a[12:15], v[96:99], v[72:75]
    v_mfma_f32_16x16x32_bf16 v[76:79], a[76:79], v[96:99], v[76:79]
    v_mfma_f32_16x16x32_bf16 v[80:83], a[140:143], v[96:99], v[80:83]
    v_mfma_f32_16x16x32_bf16 v[84:87], a[204:207], v[96:99], v[84:87]
    ds_read_b128 v[96:99], v2 offset:6144
    s_waitcnt lgkmcnt(2)
    v_mfma_f32_16x16x32_bf16 v[72:75], a[16:19], v[100:103], v[72:75]
    v_mfma_f32_16x16x32_bf16 v[76:79], a[80:83], v[100:103], v[76:79]
    v_mfma_f32_16x16x32_bf16 v[80:83], a[144:147], v[100:103], v[80:83]
    v_mfma_f32_16x16x32_bf16 v[84:87], a[208:211], v[100:103], v[84:87]
    ds_read_b128 v[100:103], v2 offset:7168
    s_waitcnt lgkmcnt(2)
    v_mfma_f32_16x16x32_bf16 v[72:75], a[20:23], v[104:107], v[72:75]
    v_mfma_f32_16x16x32_bf16 v[76:79], a[84:87], v[104:107], v[76:79]
    v_mfma_f32_16x16x32_bf16 v[80:83], a[148:151], v[104:107], v[80:83]
    v_mfma_f32_16x16x32_bf16 v[84:87], a[212:215], v[104:107], v[84:87]
    ds_read_b128 v[104:107], v2 offset:8192
    s_waitcnt lgkmcnt(2)
    v_mfma_f32_16x16x32_bf16 v[72:75], a[24:27], v[96:99], v[72:75]
    v_mfma_f32_16x16x32_bf16 v[76:79], a[88:91], v[96:99], v[76:79]
    v_mfma_f32_16x16x32_bf16 v[80:83], a[152:155], v[96:99], v[80:83]
    v_mfma_f32_16x16x32_bf16 v[84:87], a[216:219], v[96:99], v[84:87]
    ds_read_b128 v[96:99], v2 offset:9216
    s_waitcnt lgkmcnt(2)
    v_mfma_f32_16x16x32_bf16 v[72:75], a[28:31], v[100:103], v[72:75]
    v_mfma_f32_16x16x32_bf16 v[76:79], a[92:95], v[100:103], v[76:79]
    v_mfma_f32_16x16x32_bf16 v[80:83], a[156:159], v[100:103], v[80:83]
    v_mfma_f32_16x16x32_bf16 v[84:87], a[220:223], v[100:103], v[84:87]
    ds_read_b128 v[100:103], v2 offset:10240
    s_waitcnt lgkmcnt(2)
    v_mfma_f32_16x16x32_bf16 v[72:75], a[32:35], v[104:107], v[72:75]
    v_mfma_f32_16x16x32_bf16 v[76:79], a[96:99], v[104:107], v[76:79]
    v_mfma_f32_16x16x32_bf16 v[80:83], a[160:163], v[104:107], v[80:83]
    v_mfma_f32_16x16x32_bf16 v[84:87], a[224:227], v[104:107], v[84:87]
    ds_read_b128 v[104:107], v2 offset:11264
    s_waitcnt lgkmcnt(2)
    v_mfma_f32_16x16x32_bf16 v[72:75], a[36:39], v[96:99], v[72:75]
    v_mfma_f32_16x16x32_bf16 v[76:79], a[100:103], v[96:99], v[76:79]
    v_mfma_f32_16x16x32_bf16 v[80:83], a[164:167], v[96:99], v[80:83]
    v_mfma_f32_16x16x32_bf16 v[84:87], a[228:231], v[96:99], v[84:87]
    ds_read_b128 v[96:99], v2 offset:12288
    s_waitcnt lgkmcnt(2)
    v_mfma_f32_16x16x32_bf16 v[72:75], a[40:43], v[100:103], v[72:75]
    v_mfma_f32_16x16x32_bf16 v[76:79], a[104:107], v[100:103], v[76:79]
    v_mfma_f32_16x16x32_bf16 v[80:83], a[168:171], v[100:103], v[80:83]
    v_mfma_f32_16x16x32_bf16 v[84:87], a[232:235], v[100:103], v[84:87]
    ds_read_b128 v[100:103], v2 offset:13312
    s_waitcnt lgkmcnt(2)
    v_mfma_f32_16x16x32_bf16 v[72:75], a[44:47], v[104:107], v[72:75]
    v_mfma_f32_16x16x32_bf16 v[76:79], a[108:111], v[104:107], v[76:79]
    v_mfma_f32_16x16x32_bf16 v[80:83], a[172:175], v[104:107], v[80:83]
    v_mfma_f32_16x16x32_bf16 v[84:87], a[236:239], v[104:107], v[84:87]
    ds_read_b128 v[104:107], v2 offset:14336
    s_waitcnt lgkmcnt(2)
    v_mfma_f32_16x16x32_bf16 v[72:75], a[48:51], v[96:99], v[72:75]
    v_mfma_f32_16x16x32_bf16 v[76:79], a[112:115], v[96:99], v[76:79]
    v_mfma_f32_16x16x32_bf16 v[80:83], a[176:179], v[96:99], v[80:83]
    v_mfma_f32_16x16x32_bf16 v[84:87], a[240:243], v[96:99], v[84:87]
    ds_read_b128 v[96:99], v2 offset:15360
    s_waitcnt lgkmcnt(2)
    v_mfma_f32_16x16x32_bf16 v[72:75], a[52:55], v[100:103], v[72:75]
    v_mfma_f32_16x16x32_bf16 v[76:79], a[116:119], v[100:103], v[76:79]
    v_mfma_f32_16x16x32_bf16 v[80:83], a[180:183], v[100:103], v[80:83]
    v_mfma_f32_16x16x32_bf16 v[84:87], a[244:247], v[100:103], v[84:87]
    s_waitcnt lgkmcnt(1)
    v_mfma_f32_16x16x32_bf16 v[72:75], a[56:59], v[104:107], v[72:75]
    v_mfma_f32_16x16x32_bf16 v[76:79], a[120:123], v[104:107], v[76:79]
    v_mfma_f32_16x16x32_bf16 v[80:83], a[184:187], v[104:107], v[80:83]
    v_mfma_f32_16x16x32_bf16 v[84:87], a[248:251], v[104:107], v[84:87]
    s_waitcnt lgkmcnt(0)
    v_mfma_f32_16x16x32_bf16 v[72:75], a[60:63], v[96:99], v[72:75]
    v_mfma_f32_16x16x32_bf16 v[76:79], a[124:127], v[96:99], v[76:79]
    v_mfma_f32_16x16x32_bf16 v[80:83], a[188:191], v[96:99], v[80:83]
    v_mfma_f32_16x16x32_bf16 v[84:87], a[252:255], v[96:99], v[84:87]
    s_nop 7
    v_cvt_pk_bf16_f32 v108, v72, v73
    v_cvt_pk_bf16_f32 v109, v74, v75
    v_cvt_pk_bf16_f32 v110, v76, v77
    v_cvt_pk_bf16_f32 v111, v78, v79
    v_cvt_pk_bf16_f32 v112, v80, v81
    v_cvt_pk_bf16_f32 v113, v82, v83
    v_cvt_pk_bf16_f32 v114, v84, v85
    v_cvt_pk_bf16_f32 v115, v86, v87
    ds_write_b128 v3, v[108:111]
    ds_write_b128 v3, v[112:115] offset:4096
    s_lshl_b32 s23, s17, 5
    s_add_u32 s23, s23, s3
    s_lshl_b32 s19, s23, 12
    s_lshl_b32 s22, s16, 10
    s_add_u32 s19, s19, s22
    s_add_u32 s19, s19, 192937984
    buffer_store_dwordx4 v[112:115], v1, s[8:11], s19 offen sc1
    s_waitcnt lgkmcnt(0)
    s_barrier
    ds_read_b128 v[72:75], v15 offset:4096
    ds_read_b128 v[76:79], v15 offset:0
    ds_read_b128 v[96:99], v2 offset:0
    ds_read_b128 v[80:83], v15 offset:5120
    ds_read_b128 v[84:87], v15 offset:1024
    ds_read_b128 v[100:103], v2 offset:1024
    ds_read_b128 v[104:107], v2 offset:2048
    s_waitcnt lgkmcnt(5)
    v_mfma_f32_16x16x32_bf16 v[112:115], v[72:75], v[76:79], v[16:19]
    v_mfma_f32_16x16x32_bf16 v[116:119], v[32:35], v[76:79], 0
    v_mfma_f32_16x16x32_bf16 v[120:123], v[36:39], v[76:79], 0
    ds_read_b128 v[72:75], v15 offset:6144
    ds_read_b128 v[76:79], v15 offset:2048
    s_waitcnt lgkmcnt(4)
    v_mfma_f32_16x16x32_bf16 v[112:115], v[80:83], v[84:87], v[112:115]
    v_mfma_f32_16x16x32_bf16 v[116:119], v[40:43], v[84:87], v[116:119]
    v_mfma_f32_16x16x32_bf16 v[120:123], v[44:47], v[84:87], v[120:123]
    ds_read_b128 v[80:83], v15 offset:7168
    ds_read_b128 v[84:87], v15 offset:3072
    s_waitcnt lgkmcnt(2)
    v_mfma_f32_16x16x32_bf16 v[112:115], v[72:75], v[76:79], v[112:115]
    v_mfma_f32_16x16x32_bf16 v[116:119], v[48:51], v[76:79], v[116:119]
    v_mfma_f32_16x16x32_bf16 v[120:123], v[52:55], v[76:79], v[120:123]
    s_waitcnt lgkmcnt(0)
    v_mfma_f32_16x16x32_bf16 v[112:115], v[80:83], v[84:87], v[112:115]
    v_mfma_f32_16x16x32_bf16 v[116:119], v[56:59], v[84:87], v[116:119]
    v_mfma_f32_16x16x32_bf16 v[120:123], v[60:63], v[84:87], v[120:123]
    ds_read_b128 v[32:35], v4 offset:0
    ds_read_b128 v[36:39], v4 offset:16384
    ds_read_b128 v[40:43], v4 offset:1024
    ds_read_b128 v[44:47], v4 offset:17408
    ds_read_b128 v[48:51], v4 offset:2048
    ds_read_b128 v[52:55], v4 offset:18432
    s_nop 3
    v_max3_f32 v124, v112, v113, v114
    v_max3_f32 v125, v115, v116, v117
    v_max3_f32 v126, v118, v119, v120
    v_max3_f32 v127, v121, v122, v123
    v_max3_f32 v124, v124, v125, v126
    v_max_f32 v124, v124, v127
    s_waitcnt lgkmcnt(4)
    v_mfma_f32_16x16x32_bf16 v[88:91], v[96:99], v[32:35], 0
    v_mfma_f32_16x16x32_bf16 v[92:95], v[96:99], v[36:39], 0
    ds_read_b128 v[96:99], v2 offset:3072
    ds_read_b128 v[32:35], v4 offset:3072
    ds_read_b128 v[36:39], v4 offset:19456
    v_mov_b32 v125, v124
    s_nop 1
    v_permlane16_swap_b32 v124, v125
    s_nop 0
    v_max_f32 v124, v124, v125
    s_waitcnt lgkmcnt(5)
    v_mfma_f32_16x16x32_bf16 v[88:91], v[100:103], v[40:43], v[88:91]
    v_mfma_f32_16x16x32_bf16 v[92:95], v[100:103], v[44:47], v[92:95]
    ds_read_b128 v[100:103], v2 offset:4096
    ds_read_b128 v[40:43], v4 offset:4096
    ds_read_b128 v[44:47], v4 offset:20480
    v_mov_b32 v125, v124
    s_nop 1
    v_permlane32_swap_b32 v124, v125
    s_nop 0
    v_max_f32 v124, v124, v125
    s_waitcnt lgkmcnt(6)
    v_mfma_f32_16x16x32_bf16 v[88:91], v[104:107], v[48:51], v[88:91]
    v_mfma_f32_16x16x32_bf16 v[92:95], v[104:107], v[52:55], v[92:95]
    ds_read_b128 v[104:107], v2 offset:5120
    ds_read_b128 v[48:51], v4 offset:5120
    ds_read_b128 v[52:55], v4 offset:21504
    v_mul_f32 v124, s21, v124
    s_waitcnt lgkmcnt(8)
    s_waitcnt lgkmcnt(6)
    v_mfma_f32_16x16x32_bf16 v[88:91], v[96:99], v[32:35], v[88:91]
    v_mfma_f32_16x16x32_bf16 v[92:95], v[96:99], v[36:39], v[92:95]
    ds_read_b128 v[96:99], v2 offset:6144
    ds_read_b128 v[32:35], v4 offset:6144
    ds_read_b128 v[36:39], v4 offset:22528
    v_fma_f32 v112, v112, s21, -v124
    v_fma_f32 v113, v113, s21, -v124
    v_fma_f32 v114, v114, s21, -v124
    v_fma_f32 v115, v115, s21, -v124
    s_waitcnt lgkmcnt(8)
    s_waitcnt lgkmcnt(6)
    v_mfma_f32_16x16x32_bf16 v[88:91], v[100:103], v[40:43], v[88:91]
    v_mfma_f32_16x16x32_bf16 v[92:95], v[100:103], v[44:47], v[92:95]
    ds_read_b128 v[100:103], v2 offset:7168
    ds_read_b128 v[40:43], v4 offset:7168
    ds_read_b128 v[44:47], v4 offset:23552
    v_fma_f32 v116, v116, s21, -v124
    v_fma_f32 v117, v117, s21, -v124
    v_fma_f32 v118, v118, s21, -v124
    v_fma_f32 v119, v119, s21, -v124
    s_waitcnt lgkmcnt(8)
    s_waitcnt lgkmcnt(6)
    v_mfma_f32_16x16x32_bf16 v[88:91], v[104:107], v[48:51], v[88:91]
    v_mfma_f32_16x16x32_bf16 v[92:95], v[104:107], v[52:55], v[92:95]
    ds_read_b128 v[104:107], v2 offset:8192
    ds_read_b128 v[48:51], v4 offset:8192
    ds_read_b128 v[52:55], v4 offset:24576
    v_fma_f32 v120, v120, s21, -v124
    v_fma_f32 v121, v121, s21, -v124
    v_fma_f32 v122, v122, s21, -v124
    v_fma_f32 v123, v123, s21, -v124
    s_waitcnt lgkmcnt(8)
    s_waitcnt lgkmcnt(6)
    v_mfma_f32_16x16x32_bf16 v[88:91], v[96:99], v[32:35], v[88:91]
    v_mfma_f32_16x16x32_bf16 v[92:95], v[96:99], v[36:39], v[92:95]
    ds_read_b128 v[96:99], v2 offset:9216
    ds_read_b128 v[32:35], v4 offset:9216
    ds_read_b128 v[36:39], v4 offset:25600
    v_exp_f32 v112, v112
    v_exp_f32 v113, v113
    v_exp_f32 v114, v114
    s_waitcnt lgkmcnt(8)
    s_waitcnt lgkmcnt(6)
    v_mfma_f32_16x16x32_bf16 v[88:91], v[100:103], v[40:43], v[88:91]
    v_mfma_f32_16x16x32_bf16 v[92:95], v[100:103], v[44:47], v[92:95]
    ds_read_b128 v[100:103], v2 offset:10240
    ds_read_b128 v[40:43], v4 offset:10240
    ds_read_b128 v[44:47], v4 offset:26624
    v_exp_f32 v115, v115
    v_exp_f32 v116, v116
    v_exp_f32 v117, v117
    s_waitcnt lgkmcnt(8)
    s_waitcnt lgkmcnt(6)
    v_mfma_f32_16x16x32_bf16 v[88:91], v[104:107], v[48:51], v[88:91]
    v_mfma_f32_16x16x32_bf16 v[92:95], v[104:107], v[52:55], v[92:95]
    ds_read_b128 v[104:107], v2 offset:11264
    ds_read_b128 v[48:51], v4 offset:11264
    ds_read_b128 v[52:55], v4 offset:27648
    v_exp_f32 v118, v118
    v_exp_f32 v119, v119
    v_exp_f32 v120, v120
    s_waitcnt lgkmcnt(8)
    s_waitcnt lgkmcnt(6)
    v_mfma_f32_16x16x32_bf16 v[88:91], v[96:99], v[32:35], v[88:91]
    v_mfma_f32_16x16x32_bf16 v[92:95], v[96:99], v[36:39], v[92:95]
    ds_read_b128 v[96:99], v2 offset:12288
    ds_read_b128 v[32:35], v4 offset:12288
    ds_read_b128 v[36:39], v4 offset:28672
    v_exp_f32 v121, v121
    v_exp_f32 v122, v122
    v_exp_f32 v123, v123
    s_waitcnt lgkmcnt(8)
    s_waitcnt lgkmcnt(6)
    v_mfma_f32_16x16x32_bf16 v[88:91], v[100:103], v[40:43], v[88:91]
    v_mfma_f32_16x16x32_bf16 v[92:95], v[100:103], v[44:47], v[92:95]
    ds_read_b128 v[100:103], v2 offset:13312
    ds_read_b128 v[40:43], v4 offset:13312
    ds_read_b128 v[44:47], v4 offset:29696
    s_nop 0
    v_add_f32 v125, v112, v113
    v_add_f32 v126, v114, v115
    v_add_f32 v127, v116, v117
    v_add_f32 v108, v118, v119
    v_add_f32 v109, v120, v121
    v_add_f32 v110, v122, v123
    s_waitcnt lgkmcnt(8)
    s_waitcnt lgkmcnt(6)
    v_mfma_f32_16x16x32_bf16 v[88:91], v[104:107], v[48:51], v[88:91]
    v_mfma_f32_16x16x32_bf16 v[92:95], v[104:107], v[52:55], v[92:95]
    ds_read_b128 v[104:107], v2 offset:14336
    ds_read_b128 v[48:51], v4 offset:14336
    ds_read_b128 v[52:55], v4 offset:30720
    v_add_f32 v125, v125, v126
    v_add_f32 v127, v127, v108
    v_add_f32 v109, v109, v110
    v_add_f32 v125, v125, v127
    v_add_f32 v125, v125, v109
    s_waitcnt lgkmcnt(8)
    s_waitcnt lgkmcnt(6)
    v_mfma_f32_16x16x32_bf16 v[88:91], v[96:99], v[32:35], v[88:91]
    v_mfma_f32_16x16x32_bf16 v[92:95], v[96:99], v[36:39], v[92:95]
    ds_read_b128 v[96:99], v2 offset:15360
    ds_read_b128 v[32:35], v4 offset:15360
    ds_read_b128 v[36:39], v4 offset:31744
    v_mov_b32 v126, v125
    s_nop 1
    v_permlane16_swap_b32 v125, v126
    s_nop 0
    v_add_f32 v125, v125, v126
    s_waitcnt lgkmcnt(8)
    s_waitcnt lgkmcnt(6)
    v_mfma_f32_16x16x32_bf16 v[88:91], v[100:103], v[40:43], v[88:91]
    v_mfma_f32_16x16x32_bf16 v[92:95], v[100:103], v[44:47], v[92:95]
    v_mov_b32 v126, v125
    s_nop 1
    v_permlane32_swap_b32 v125, v126
    s_nop 0
    v_add_f32 v125, v125, v126
    s_waitcnt lgkmcnt(5)
    s_waitcnt lgkmcnt(3)
    v_mfma_f32_16x16x32_bf16 v[88:91], v[104:107], v[48:51], v[88:91]
    v_mfma_f32_16x16x32_bf16 v[92:95], v[104:107], v[52:55], v[92:95]
    v_rcp_f32 v125, v125
    s_nop 0
    s_waitcnt lgkmcnt(2)
    s_waitcnt lgkmcnt(0)
    v_mfma_f32_16x16x32_bf16 v[88:91], v[96:99], v[32:35], v[88:91]
    v_mfma_f32_16x16x32_bf16 v[92:95], v[96:99], v[36:39], v[92:95]
    v_mul_f32 v112, v125, v112
    v_mul_f32 v113, v125, v113
    v_mul_f32 v114, v125, v114
    v_mul_f32 v115, v125, v115
    v_mul_f32 v116, v125, v116
    v_mul_f32 v117, v125, v117
    v_mul_f32 v118, v125, v118
    v_mul_f32 v119, v125, v119
    v_mul_f32 v120, v125, v120
    v_mul_f32 v121, v125, v121
    v_mul_f32 v122, v125, v122
    v_mul_f32 v123, v125, v123
    v_cvt_pk_bf16_f32 v28, v112, v113
    v_cvt_pk_bf16_f32 v29, v114, v115
    v_cvt_pk_bf16_f32 v108, v116, v117
    v_cvt_pk_bf16_f32 v109, v118, v119
    v_cvt_pk_bf16_f32 v110, v120, v121
    v_cvt_pk_bf16_f32 v111, v122, v123
    s_add_u32 s23, s17, 1
    s_lshl_b32 s23, s23, 5
    s_add_u32 s23, s23, s3
    s_lshl_b32 s23, s23, 13
    s_add_u32 s19, s23, 142606336
    s_add_u32 s22, s19, 4096
    s_cmp_eq_u32 s17, 63
    s_cbranch_scc1 L_chain_nopf_67
    s_add_u32 s24, s17, 1
    s_and_b32 s25, s24, 3
    s_cmp_lg_u32 s25, 0
    s_cbranch_scc1 L_chain_t1skip_68
    s_lshr_b32 s25, s24, 2
    s_lshl_b32 s25, s25, 6
    s_lshr_b32 s26, s3, 1
    s_lshl_b32 s26, s26, 2
    s_add_u32 s25, s25, s26
    s_add_u32 s25, s25, 20463872
    v_mov_b32 v124, 0
L_chain_t1wait_69:
    s_sub_u32 s29, s29, 1
    s_cbranch_scc1 L_chain_bail_60
    buffer_load_dword v125, v124, s[8:11], s25 offen sc1
    s_waitcnt vmcnt(0)
    v_cmp_eq_u32 vcc, 0, v125
    s_cbranch_vccnz L_chain_t1wait_69
L_chain_t1skip_68:
    buffer_load_dwordx4 v[32:35], v1, s[8:11], s19 offen offset:0 sc1
    buffer_load_dwordx4 v[36:39], v1, s[8:11], s19 offen offset:1024 sc1
    buffer_load_dwordx4 v[40:43], v1, s[8:11], s19 offen offset:2048 sc1
    buffer_load_dwordx4 v[44:47], v1, s[8:11], s19 offen offset:3072 sc1
    buffer_load_dwordx4 v[48:51], v1, s[8:11], s22 offen offset:0 sc1
    buffer_load_dwordx4 v[52:55], v1, s[8:11], s22 offen offset:1024 sc1
    buffer_load_dwordx4 v[56:59], v1, s[8:11], s22 offen offset:2048 sc1
    buffer_load_dwordx4 v[60:63], v1, s[8:11], s22 offen offset:3072 sc1
L_chain_nopf_67:
    s_nop 7
    v_cvt_pk_bf16_f32 v20, v88, v89
    v_cvt_pk_bf16_f32 v21, v90, v91
    v_cvt_pk_bf16_f32 v24, v92, v93
    v_cvt_pk_bf16_f32 v25, v94, v95
    s_lshl_b32 s22, s17, 5
    s_add_u32 s22, s22, s3
    s_lshl_b32 s19, s22, 13
    s_lshl_b32 s22, s16, 11
    s_add_u32 s19, s19, s22
    s_add_u32 s19, s19, 201326592
    buffer_store_dwordx4 v[20:23], v1, s[8:11], s19 offen sc1
    buffer_store_dwordx4 v[24:27], v1, s[8:11], s19 offen offset:1024 sc1
    s_cmp_eq_u32 s17, 63
    s_cbranch_scc1 L_chain_end_58
    v_mfma_f32_16x16x32_bf16 v[72:75], v[64:67], v[108:111], 0
    v_mfma_f32_16x16x32_bf16 v[76:79], v[68:71], v[108:111], 0
    v_mfma_f32_16x16x32_bf16 v[72:75], v[20:23], v[28:31], v[72:75]
    v_mfma_f32_16x16x32_bf16 v[76:79], v[24:27], v[28:31], v[76:79]
    s_lshl_b32 s19, s16, 11
    s_add_u32 s19, s19, s23
    s_add_u32 s19, s19, 159383552
    buffer_load_dwordx4 v[64:67], v1, s[8:11], s19 offen offset:0 sc1
    buffer_load_dwordx4 v[68:71], v1, s[8:11], s19 offen offset:1024 sc1
    s_nop 5
    v_cvt_pk_bf16_f32 v92, v72, v73
    v_cvt_pk_bf16_f32 v93, v74, v75
    v_cvt_pk_bf16_f32 v94, v76, v77
    v_cvt_pk_bf16_f32 v95, v78, v79
    ds_write_b128 v3, v[92:95] offset:8192
    s_waitcnt lgkmcnt(0)
    s_barrier
    ds_read_b128 v[96:99], v15 offset:8192
    ds_read_b128 v[100:103], v15 offset:9216
    ds_read_b128 v[104:107], v15 offset:10240
    ds_read_b128 v[108:111], v15 offset:11264
    s_waitcnt lgkmcnt(0)
    v_mfma_f32_16x16x32_bf16 v[112:115], v[128:131], v[96:99], 0
    v_mfma_f32_16x16x32_bf16 v[116:119], v[144:147], v[96:99], 0
    v_mfma_f32_16x16x32_bf16 v[120:123], v[160:163], v[96:99], 0
    v_mfma_f32_16x16x32_bf16 v[124:127], v[176:179], v[96:99], 0
    v_mfma_f32_16x16x32_bf16 v[112:115], v[132:135], v[100:103], v[112:115]
    v_mfma_f32_16x16x32_bf16 v[116:119], v[148:151], v[100:103], v[116:119]
    v_mfma_f32_16x16x32_bf16 v[120:123], v[164:167], v[100:103], v[120:123]
    v_mfma_f32_16x16x32_bf16 v[124:127], v[180:183], v[100:103], v[124:127]
    v_mfma_f32_16x16x32_bf16 v[112:115], v[136:139], v[104:107], v[112:115]
    v_mfma_f32_16x16x32_bf16 v[116:119], v[152:155], v[104:107], v[116:119]
    v_mfma_f32_16x16x32_bf16 v[120:123], v[168:171], v[104:107], v[120:123]
    v_mfma_f32_16x16x32_bf16 v[124:127], v[184:187], v[104:107], v[124:127]
    v_mfma_f32_16x16x32_bf16 v[112:115], v[140:143], v[108:111], v[112:115]
    v_mfma_f32_16x16x32_bf16 v[116:119], v[156:159], v[108:111], v[116:119]
    v_mfma_f32_16x16x32_bf16 v[120:123], v[172:175], v[108:111], v[120:123]
    v_mfma_f32_16x16x32_bf16 v[124:127], v[188:191], v[108:111], v[124:127]
    s_nop 7
    v_and_or_b32 v112, v112, -4, v11
    v_and_or_b32 v113, v113, -4, v11
    v_and_or_b32 v114, v114, -4, v11
    v_and_or_b32 v115, v115, -4, v11
    s_mov_b32 s19, 0
    s_cmp_eq_u32 s28, 1
    s_cbranch_scc1 L_chain_plain_70
    buffer_store_dwordx4 v[112:115], v7, s[8:11], s19 offen sc1
    s_branch L_chain_sdone_71
L_chain_plain_70:
    buffer_store_dwordx4 v[112:115], v7, s[8:11], s19 offen
L_chain_sdone_71:
    v_and_or_b32 v116, v116, -4, v11
    v_and_or_b32 v117, v117, -4, v11
    v_and_or_b32 v118, v118, -4, v11
    v_and_or_b32 v119, v119, -4, v11
    s_mov_b32 s19, 16384
    s_cmp_eq_u32 s28, 1
    s_cbranch_scc1 L_chain_plain_72
    buffer_store_dwordx4 v[116:119], v7, s[8:11], s19 offen sc1
    s_branch L_chain_sdone_73
L_chain_plain_72:
    buffer_store_dwordx4 v[116:119], v7, s[8:11], s19 offen
L_chain_sdone_73:
    v_and_or_b32 v120, v120, -4, v11
    v_and_or_b32 v121, v121, -4, v11
    v_and_or_b32 v122, v122, -4, v11
    v_and_or_b32 v123, v123, -4, v11
    s_mov_b32 s19, 32768
    s_cmp_eq_u32 s28, 1
    s_cbranch_scc1 L_chain_plain_74
    buffer_store_dwordx4 v[120:123], v7, s[8:11], s19 offen sc1
    s_branch L_chain_sdone_75
L_chain_plain_74:
    buffer_store_dwordx4 v[120:123], v7, s[8:11], s19 offen
L_chain_sdone_75:
    v_and_or_b32 v124, v124, -4, v11
    v_and_or_b32 v125, v125, -4, v11
    v_and_or_b32 v126, v126, -4, v11
    v_and_or_b32 v127, v127, -4, v11
    s_mov_b32 s19, 49152
    s_cmp_eq_u32 s28, 1
    s_cbranch_scc1 L_chain_plain_76
    buffer_store_dwordx4 v[124:127], v7, s[8:11], s19 offen sc1
    s_branch L_chain_sdone_77
L_chain_plain_76:
    buffer_store_dwordx4 v[124:127], v7, s[8:11], s19 offen
L_chain_sdone_77:
    s_nop 1
    v_mfma_f32_16x16x32_bf16 v[112:115], v[192:195], v[96:99], 0
    v_mfma_f32_16x16x32_bf16 v[116:119], v[208:211], v[96:99], 0
    v_mfma_f32_16x16x32_bf16 v[120:123], v[224:227], v[96:99], 0
    v_mfma_f32_16x16x32_bf16 v[124:127], v[240:243], v[96:99], 0
    v_mfma_f32_16x16x32_bf16 v[112:115], v[196:199], v[100:103], v[112:115]
    v_mfma_f32_16x16x32_bf16 v[116:119], v[212:215], v[100:103], v[116:119]
    v_mfma_f32_16x16x32_bf16 v[120:123], v[228:231], v[100:103], v[120:123]
    v_mfma_f32_16x16x32_bf16 v[124:127], v[244:247], v[100:103], v[124:127]
    v_mfma_f32_16x16x32_bf16 v[112:115], v[200:203], v[104:107], v[112:115]
    v_mfma_f32_16x16x32_bf16 v[116:119], v[216:219], v[104:107], v[116:119]
    v_mfma_f32_16x16x32_bf16 v[120:123], v[232:235], v[104:107], v[120:123]
    v_mfma_f32_16x16x32_bf16 v[124:127], v[248:251], v[104:107], v[124:127]
    v_mfma_f32_16x16x32_bf16 v[112:115], v[204:207], v[108:111], v[112:115]
    v_mfma_f32_16x16x32_bf16 v[116:119], v[220:223], v[108:111], v[116:119]
    v_mfma_f32_16x16x32_bf16 v[120:123], v[236:239], v[108:111], v[120:123]
    v_mfma_f32_16x16x32_bf16 v[124:127], v[252:255], v[108:111], v[124:127]
    s_nop 7
    v_and_or_b32 v112, v112, -4, v11
    v_and_or_b32 v113, v113, -4, v11
    v_and_or_b32 v114, v114, -4, v11
    v_and_or_b32 v115, v115, -4, v11
    s_mov_b32 s19, 65536
    s_cmp_eq_u32 s28, 1
    s_cbranch_scc1 L_chain_plain_78
    buffer_store_dwordx4 v[112:115], v7, s[8:11], s19 offen sc1
    s_branch L_chain_sdone_79
L_chain_plain_78:
    buffer_store_dwordx4 v[112:115], v7, s[8:11], s19 offen
L_chain_sdone_79:
    v_and_or_b32 v116, v116, -4, v11
    v_and_or_b32 v117, v117, -4, v11
    v_and_or_b32 v118, v118, -4, v11
    v_and_or_b32 v119, v119, -4, v11
    s_mov_b32 s19, 81920
    s_cmp_eq_u32 s28, 1
    s_cbranch_scc1 L_chain_plain_80
    buffer_store_dwordx4 v[116:119], v7, s[8:11], s19 offen sc1
    s_branch L_chain_sdone_81
L_chain_plain_80:
    buffer_store_dwordx4 v[116:119], v7, s[8:11], s19 offen
L_chain_sdone_81:
    v_and_or_b32 v120, v120, -4, v11
    v_and_or_b32 v121, v121, -4, v11
    v_and_or_b32 v122, v122, -4, v11
    v_and_or_b32 v123, v123, -4, v11
    s_mov_b32 s19, 98304
    s_cmp_eq_u32 s28, 1
    s_cbranch_scc1 L_chain_plain_82
    buffer_store_dwordx4 v[120:123], v7, s[8:11], s19 offen sc1
    s_branch L_chain_sdone_83
L_chain_plain_82:
    buffer_store_dwordx4 v[120:123], v7, s[8:11], s19 offen
L_chain_sdone_83:
    s_nop 1
    v_and_or_b32 v124, v124, -4, v11
    v_and_or_b32 v125, v125, -4, v11
    v_and_or_b32 v126, v126, -4, v11
    v_and_or_b32 v127, v127, -4, v11
    s_mov_b32 s19, 114688
    s_cmp_eq_u32 s28, 1
    s_cbranch_scc1 L_chain_plain_84
    buffer_store_dwordx4 v[124:127], v7, s[8:11], s19 offen sc1
    s_branch L_chain_sdone_85
L_chain_plain_84:
    buffer_store_dwordx4 v[124:127], v7, s[8:11], s19 offen
L_chain_sdone_85:
L_chain_poll1_86:
    s_sub_u32 s29, s29, 1
    s_cbranch_scc1 L_chain_bail_60
    buffer_load_dwordx4 v[72:75], v8, s[8:11], s32 offen sc1
    buffer_load_dwordx4 v[76:79], v8, s[8:11], s33 offen sc1
    buffer_load_dwordx4 v[80:83], v8, s[8:11], s34 offen sc1
    buffer_load_dwordx4 v[84:87], v8, s[8:11], s35 offen sc1
    s_waitcnt vmcnt(0)
    v_xor_b32 v124, v72, v11
    v_xor_b32 v125, v73, v11
    v_xor_b32 v126, v74, v11
    v_or3_b32 v124, v124, v125, v126
    v_xor_b32 v125, v75, v11
    v_xor_b32 v126, v76, v11
    v_or3_b32 v124, v124, v125, v126
    v_xor_b32 v125, v77, v11
    v_xor_b32 v126, v78, v11
    v_or3_b32 v124, v124, v125, v126
    v_xor_b32 v125, v79, v11
    v_xor_b32 v126, v80, v11
    v_or3_b32 v124, v124, v125, v126
    v_xor_b32 v125, v81, v11
    v_xor_b32 v126, v82, v11
    v_or3_b32 v124, v124, v125, v126
    v_xor_b32 v125, v83, v11
    v_xor_b32 v126, v84, v11
    v_or3_b32 v124, v124, v125, v126
    v_xor_b32 v125, v85, v11
    v_xor_b32 v126, v86, v11
    v_or3_b32 v124, v124, v125, v126
    v_xor_b32 v125, v87, v11
    v_or_b32 v124, v124, v125
    v_and_b32 v124, 3, v124
    v_cmp_ne_u32 vcc, 0, v124
    s_cbranch_vccnz L_chain_poll1_86
    v_add_f32 v88, v72, v76
    v_add_f32 v92, v80, v84
    v_add_f32 v89, v73, v77
    v_add_f32 v93, v81, v85
    v_add_f32 v90, v74, v78
    v_add_f32 v94, v82, v86
    v_add_f32 v91, v75, v79
    v_add_f32 v95, v83, v87
    v_add_f32 v88, v88, v92
    v_add_f32 v89, v89, v93
    v_add_f32 v90, v90, v94
    v_add_f32 v91, v91, v95
    s_nop 1
    v_add_f32_dpp v88, v88, v88 row_ror:8 row_mask:0xf bank_mask:0xf
    v_add_f32_dpp v89, v89, v89 row_ror:8 row_mask:0xf bank_mask:0xf
    v_add_f32_dpp v90, v90, v90 row_ror:8 row_mask:0xf bank_mask:0xf
    v_add_f32_dpp v91, v91, v91 row_ror:8 row_mask:0xf bank_mask:0xf
    v_mov_b32 v92, v88
    v_mov_b32 v93, v89
    v_mov_b32 v94, v90
    v_mov_b32 v95, v91
    s_nop 0
    v_permlane16_swap_b32 v88, v92
    v_permlane16_swap_b32 v89, v93
    v_permlane16_swap_b32 v90, v94
    v_permlane16_swap_b32 v91, v95
    s_nop 0
    v_add_f32 v88, v88, v92
    v_add_f32 v89, v89, v93
    v_add_f32 v90, v90, v94
    v_add_f32 v91, v91, v95
    v_mov_b32 v92, v88
    v_mov_b32 v93, v89
    v_mov_b32 v94, v90
    v_mov_b32 v95, v91
    s_nop 0
    v_permlane32_swap_b32 v88, v92
    v_permlane32_swap_b32 v89, v93
    v_permlane32_swap_b32 v90, v94
    v_permlane32_swap_b32 v91, v95
    s_nop 0
    v_add_f32 v88, v88, v92
    v_add_f32 v89, v89, v93
    v_add_f32 v90, v90, v94
    v_add_f32 v91, v91, v95
    v_cvt_pk_bf16_f32 v92, v88, v89
    v_cvt_pk_bf16_f32 v93, v90, v91
    s_mov_b32 s19, 0xffff0000
    v_lshl_or_b32 v112, v92, 16, v11
    v_and_or_b32 v113, v92, s19, v11
    v_lshl_or_b32 v114, v93, 16, v11
    v_and_or_b32 v115, v93, s19, v11
    s_cmp_eq_u32 s28, 1
    s_cbranch_scc1 L_chain_plain_87
    buffer_store_dwordx4 v[112:115], v10, s[8:11], 0 offen sc1
    s_branch L_chain_sdone_88
L_chain_plain_87:
    buffer_store_dwordx4 v[112:115], v10, s[8:11], 0 offen
L_chain_sdone_88:
L_chain_pollm_89:
    s_sub_u32 s29, s29, 1
    s_cbranch_scc1 L_chain_bail_60
    buffer_load_dwordx4 v[72:75], v6, s[8:11], 0 offen offset:0 sc1
    buffer_load_dwordx4 v[76:79], v6, s[8:11], 0 offen offset:1024 sc1
    buffer_load_dwordx4 v[80:83], v6, s[8:11], 0 offen offset:2048 sc1
    buffer_load_dwordx4 v[84:87], v6, s[8:11], 0 offen offset:3072 sc1
    s_waitcnt vmcnt(0)
    v_xor_b32 v124, v72, v11
    v_xor_b32 v125, v73, v11
    v_xor_b32 v126, v74, v11
    v_or3_b32 v124, v124, v125, v126
    v_xor_b32 v125, v75, v11
    v_xor_b32 v126, v76, v11
    v_or3_b32 v124, v124, v125, v126
    v_xor_b32 v125, v77, v11
    v_xor_b32 v126, v78, v11
    v_or3_b32 v124, v124, v125, v126
    v_xor_b32 v125, v79, v11
    v_xor_b32 v126, v80, v11
    v_or3_b32 v124, v124, v125, v126
    v_xor_b32 v125, v81, v11
    v_xor_b32 v126, v82, v11
    v_or3_b32 v124, v124, v125, v126
    v_xor_b32 v125, v83, v11
    v_xor_b32 v126, v84, v11
    v_or3_b32 v124, v124, v125, v126
    v_xor_b32 v125, v85, v11
    v_xor_b32 v126, v86, v11
    v_or3_b32 v124, v124, v125, v126
    v_xor_b32 v125, v87, v11
    v_or_b32 v124, v124, v125
    v_and_b32 v124, 3, v124
    v_cmp_ne_u32 vcc, 0, v124
    s_cbranch_vccnz L_chain_pollm_89
    v_perm_b32 v88, v73, v72, s20
    v_perm_b32 v89, v75, v74, s20
    v_perm_b32 v90, v77, v76, s20
    v_perm_b32 v91, v79, v78, s20
    v_perm_b32 v92, v81, v80, s20
    v_perm_b32 v93, v83, v82, s20
    v_perm_b32 v94, v85, v84, s20
    v_perm_b32 v95, v87, v86, s20
    ds_write_b64 v5, v[88:89] offset:0
    ds_write_b64 v5, v[90:91] offset:1024
    ds_write_b64 v5, v[92:93] offset:2048
    ds_write_b64 v5, v[94:95] offset:3072
    s_waitcnt lgkmcnt(0)
    s_barrier
    s_add_u32 s17, s17, 1
    s_branch L_chain_step_66
L_chain_bail_60:
L_chain_end_58:
L_chain_exit_59:
    s_endpgm
L_mega_work_57:
    s_lshr_b32 s3, s2, 3
    s_sub_u32 s27, s2, s3
    s_sub_u32 s27, s27, 1
    s_mov_b32 s36, s27
L_mega_tloop_90:
    s_load_dwordx2 s[4:5], s[0:1], 112
    v_and_b32 v1, 63, v0
    v_lshrrev_b32 v2, 6, v0
    s_nop 0
    v_readfirstlane_b32 s16, v2
    v_lshrrev_b32 v2, 4, v1
    v_and_b32 v3, 15, v1
    s_lshr_b32 s3, s27, 4
    s_and_b32 s26, s27, 15
    s_waitcnt lgkmcnt(0)
    s_mov_b32 s8, s4
    s_and_b32 s9, s5, 0xffff
    s_mov_b32 s10, 268435456
    s_mov_b32 s11, 0x00020000
    v_lshlrev_b32 v7, 4, v1
    s_lshl_b32 s5, s3, 17
    s_lshl_b32 s19, s16, 10
    s_add_u32 s5, s5, s19
    s_add_u32 s5, s5, 27262976
    s_mul_i32 s19, s16, 1040
    v_add_u32 v4, s19, v7
    v_add_u32 v5, 66560, v4
    s_add_u32 s19, s5, 0
    buffer_load_dwordx4 v[16:19], v7, s[8:11], s19 offen
    s_add_u32 s19, s5, 4096
    buffer_load_dwordx4 v[20:23], v7, s[8:11], s19 offen
    s_add_u32 s19, s5, 8192
    buffer_load_dwordx4 v[24:27], v7, s[8:11], s19 offen
    s_add_u32 s19, s5, 12288
    buffer_load_dwordx4 v[28:31], v7, s[8:11], s19 offen
    s_add_u32 s19, s5, 16384
    buffer_load_dwordx4 v[32:35], v7, s[8:11], s19 offen
    s_add_u32 s19, s5, 20480
    buffer_load_dwordx4 v[36:39], v7, s[8:11], s19 offen
    s_add_u32 s19, s5, 24576
    buffer_load_dwordx4 v[40:43], v7, s[8:11], s19 offen
    s_add_u32 s19, s5, 28672
    buffer_load_dwordx4 v[44:47], v7, s[8:11], s19 offen
    s_waitcnt vmcnt(7)
    ds_write_b128 v4, v[16:19] offset:0
    s_waitcnt vmcnt(6)
    ds_write_b128 v4, v[20:23] offset:4160
    s_waitcnt vmcnt(5)
    ds_write_b128 v4, v[24:27] offset:8320
    s_waitcnt vmcnt(4)
    ds_write_b128 v4, v[28:31] offset:12480
    s_waitcnt vmcnt(3)
    ds_write_b128 v4, v[32:35] offset:16640
    s_waitcnt vmcnt(2)
    ds_write_b128 v4, v[36:39] offset:20800
    s_waitcnt vmcnt(1)
    ds_write_b128 v4, v[40:43] offset:24960
    s_waitcnt vmcnt(0)
    ds_write_b128 v4, v[44:47] offset:29120
    s_add_u32 s19, s5, 32768
    buffer_load_dwordx4 v[16:19], v7, s[8:11], s19 offen
    s_add_u32 s19, s5, 36864
    buffer_load_dwordx4 v[20:23], v7, s[8:11], s19 offen
    s_add_u32 s19, s5, 40960
    buffer_load_dwordx4 v[24:27], v7, s[8:11], s19 offen
    s_add_u32 s19, s5, 45056
    buffer_load_dwordx4 v[28:31], v7, s[8:11], s19 offen
    s_add_u32 s19, s5, 49152
    buffer_load_dwordx4 v[32:35], v7, s[8:11], s19 offen
    s_add_u32 s19, s5, 53248
    buffer_load_dwordx4 v[36:39], v7, s[8:11], s19 offen
    s_add_u32 s19, s5, 57344
    buffer_load_dwordx4 v[40:43], v7, s[8:11], s19 offen
    s_add_u32 s19, s5, 61440
    buffer_load_dwordx4 v[44:47], v7, s[8:11], s19 offen
    s_waitcnt vmcnt(7)
    ds_write_b128 v4, v[16:19] offset:33280
    s_waitcnt vmcnt(6)
    ds_write_b128 v4, v[20:23] offset:37440
    s_waitcnt vmcnt(5)
    ds_write_b128 v4, v[24:27] offset:41600
    s_waitcnt vmcnt(4)
    ds_write_b128 v4, v[28:31] offset:45760
    s_waitcnt vmcnt(3)
    ds_write_b128 v4, v[32:35] offset:49920
    s_waitcnt vmcnt(2)
    ds_write_b128 v4, v[36:39] offset:54080
    s_waitcnt vmcnt(1)
    ds_write_b128 v4, v[40:43] offset:58240
    s_waitcnt vmcnt(0)
    ds_write_b128 v4, v[44:47] offset:62400
    s_add_u32 s19, s5, 65536
    buffer_load_dwordx4 v[16:19], v7, s[8:11], s19 offen
    s_add_u32 s19, s5, 69632
    buffer_load_dwordx4 v[20:23], v7, s[8:11], s19 offen
    s_add_u32 s19, s5, 73728
    buffer_load_dwordx4 v[24:27], v7, s[8:11], s19 offen
    s_add_u32 s19, s5, 77824
    buffer_load_dwordx4 v[28:31], v7, s[8:11], s19 offen
    s_add_u32 s19, s5, 81920
    buffer_load_dwordx4 v[32:35], v7, s[8:11], s19 offen
    s_add_u32 s19, s5, 86016
    buffer_load_dwordx4 v[36:39], v7, s[8:11], s19 offen
    s_add_u32 s19, s5, 90112
    buffer_load_dwordx4 v[40:43], v7, s[8:11], s19 offen
    s_add_u32 s19, s5, 94208
    buffer_load_dwordx4 v[44:47], v7, s[8:11], s19 offen
    s_waitcnt vmcnt(7)
    ds_write_b128 v5, v[16:19] offset:0
    s_waitcnt vmcnt(6)
    ds_write_b128 v5, v[20:23] offset:4160
    s_waitcnt vmcnt(5)
    ds_write_b128 v5, v[24:27] offset:8320
    s_waitcnt vmcnt(4)
    ds_write_b128 v5, v[28:31] offset:12480
    s_waitcnt vmcnt(3)
    ds_write_b128 v5, v[32:35] offset:16640
    s_waitcnt vmcnt(2)
    ds_write_b128 v5, v[36:39] offset:20800
    s_waitcnt vmcnt(1)
    ds_write_b128 v5, v[40:43] offset:24960
    s_waitcnt vmcnt(0)
    ds_write_b128 v5, v[44:47] offset:29120
    s_add_u32 s19, s5, 98304
    buffer_load_dwordx4 v[16:19], v7, s[8:11], s19 offen
    s_add_u32 s19, s5, 102400
    buffer_load_dwordx4 v[20:23], v7, s[8:11], s19 offen
    s_add_u32 s19, s5, 106496
    buffer_load_dwordx4 v[24:27], v7, s[8:11], s19 offen
    s_add_u32 s19, s5, 110592
    buffer_load_dwordx4 v[28:31], v7, s[8:11], s19 offen
    s_add_u32 s19, s5, 114688
    buffer_load_dwordx4 v[32:35], v7, s[8:11], s19 offen
    s_add_u32 s19, s5, 118784
    buffer_load_dwordx4 v[36:39], v7, s[8:11], s19 offen
    s_add_u32 s19, s5, 122880
    buffer_load_dwordx4 v[40:43], v7, s[8:11], s19 offen
    s_add_u32 s19, s5, 126976
    buffer_load_dwordx4 v[44:47], v7, s[8:11], s19 offen
    s_waitcnt vmcnt(7)
    ds_write_b128 v5, v[16:19] offset:33280
    s_waitcnt vmcnt(6)
    ds_write_b128 v5, v[20:23] offset:37440
    s_waitcnt vmcnt(5)
    ds_write_b128 v5, v[24:27] offset:41600
    s_waitcnt vmcnt(4)
    ds_write_b128 v5, v[28:31] offset:45760
    s_waitcnt vmcnt(3)
    ds_write_b128 v5, v[32:35] offset:49920
    s_waitcnt vmcnt(2)
    ds_write_b128 v5, v[36:39] offset:54080
    s_waitcnt vmcnt(1)
    ds_write_b128 v5, v[40:43] offset:58240
    s_waitcnt vmcnt(0)
    ds_write_b128 v5, v[44:47] offset:62400
    v_mul_u32_u24 v8, 1040, v3
    v_lshl_add_u32 v8, v2, 4, v8
    v_add_u32 v9, 66560, v8
    s_waitcnt lgkmcnt(0)
    s_barrier
    s_lshl_b32 s6, s26, 1
    s_add_u32 s6, s6, 0
    s_lshl_b32 s22, s6, 17
    s_lshl_b32 s19, s16, 15
    s_add_u32 s22, s22, s19
    s_add_u32 s22, s22, 0
    s_add_u32 s19, s22, 0
    buffer_load_dwordx4 v[144:147], v7, s[8:11], s19 offen
    s_add_u32 s19, s22, 16384
    buffer_load_dwordx4 v[148:151], v7, s[8:11], s19 offen
    ds_read_b128 v[80:83], v8 offset:0
    ds_read_b128 v[84:87], v8 offset:16640
    ds_read_b128 v[88:91], v8 offset:33280
    ds_read_b128 v[92:95], v8 offset:49920
    ds_read_b128 v[96:99], v9 offset:0
    ds_read_b128 v[100:103], v9 offset:16640
    ds_read_b128 v[104:107], v9 offset:33280
    ds_read_b128 v[108:111], v9 offset:49920
    s_add_u32 s19, s22, 1024
    buffer_load_dwordx4 v[152:155], v7, s[8:11], s19 offen
    s_add_u32 s19, s22, 17408
    buffer_load_dwordx4 v[156:159], v7, s[8:11], s19 offen
    ds_read_b128 v[112:115], v8 offset:64
    ds_read_b128 v[116:119], v8 offset:16704
    ds_read_b128 v[120:123], v8 offset:33344
    ds_read_b128 v[124:127], v8 offset:49984
    ds_read_b128 v[128:131], v9 offset:64
    ds_read_b128 v[132:135], v9 offset:16704
    ds_read_b128 v[136:139], v9 offset:33344
    ds_read_b128 v[140:143], v9 offset:49984
    s_waitcnt vmcnt(2) lgkmcnt(8)
    v_mfma_f32_16x16x32_bf16 v[16:19], v[144:147], v[80:83], 0
    v_mfma_f32_16x16x32_bf16 v[48:51], v[148:151], v[80:83], 0
    v_mfma_f32_16x16x32_bf16 v[20:23], v[144:147], v[84:87], 0
    v_mfma_f32_16x16x32_bf16 v[52:55], v[148:151], v[84:87], 0
    v_mfma_f32_16x16x32_bf16 v[24:27], v[144:147], v[88:91], 0
    v_mfma_f32_16x16x32_bf16 v[56:59], v[148:151], v[88:91], 0
    v_mfma_f32_16x16x32_bf16 v[28:31], v[144:147], v[92:95], 0
    v_mfma_f32_16x16x32_bf16 v[60:63], v[148:151], v[92:95], 0
    v_mfma_f32_16x16x32_bf16 v[32:35], v[144:147], v[96:99], 0
    v_mfma_f32_16x16x32_bf16 v[64:67], v[148:151], v[96:99], 0
    v_mfma_f32_16x16x32_bf16 v[36:39], v[144:147], v[100:103], 0
    v_mfma_f32_16x16x32_bf16 v[68:71], v[148:151], v[100:103], 0
    v_mfma_f32_16x16x32_bf16 v[40:43], v[144:147], v[104:107], 0
    v_mfma_f32_16x16x32_bf16 v[72:75], v[148:151], v[104:107], 0
    v_mfma_f32_16x16x32_bf16 v[44:47], v[144:147], v[108:111], 0
    v_mfma_f32_16x16x32_bf16 v[76:79], v[148:151], v[108:111], 0
    s_add_u32 s19, s22, 2048
    buffer_load_dwordx4 v[144:147], v7, s[8:11], s19 offen
    s_add_u32 s19, s22, 18432
    buffer_load_dwordx4 v[148:151], v7, s[8:11], s19 offen
    ds_read_b128 v[80:83], v8 offset:128
    ds_read_b128 v[84:87], v8 offset:16768
    ds_read_b128 v[88:91], v8 offset:33408
    ds_read_b128 v[92:95], v8 offset:50048
    ds_read_b128 v[96:99], v9 offset:128
    ds_read_b128 v[100:103], v9 offset:16768
    ds_read_b128 v[104:107], v9 offset:33408
    ds_read_b128 v[108:111], v9 offset:50048
    s_waitcnt vmcnt(2) lgkmcnt(8)
    v_mfma_f32_16x16x32_bf16 v[16:19], v[152:155], v[112:115], v[16:19]
    v_mfma_f32_16x16x32_bf16 v[48:51], v[156:159], v[112:115], v[48:51]
    v_mfma_f32_16x16x32_bf16 v[20:23], v[152:155], v[116:119], v[20:23]
    v_mfma_f32_16x16x32_bf16 v[52:55], v[156:159], v[116:119], v[52:55]
    v_mfma_f32_16x16x32_bf16 v[24:27], v[152:155], v[120:123], v[24:27]
    v_mfma_f32_16x16x32_bf16 v[56:59], v[156:159], v[120:123], v[56:59]
    v_mfma_f32_16x16x32_bf16 v[28:31], v[152:155], v[124:127], v[28:31]
    v_mfma_f32_16x16x32_bf16 v[60:63], v[156:159], v[124:127], v[60:63]
    v_mfma_f32_16x16x32_bf16 v[32:35], v[152:155], v[128:131], v[32:35]
    v_mfma_f32_16x16x32_bf16 v[64:67], v[156:159], v[128:131], v[64:67]
    v_mfma_f32_16x16x32_bf16 v[36:39], v[152:155], v[132:135], v[36:39]
    v_mfma_f32_16x16x32_bf16 v[68:71], v[156:159], v[132:135], v[68:71]
    v_mfma_f32_16x16x32_bf16 v[40:43], v[152:155], v[136:139], v[40:43]
    v_mfma_f32_16x16x32_bf16 v[72:75], v[156:159], v[136:139], v[72:75]
    v_mfma_f32_16x16x32_bf16 v[44:47], v[152:155], v[140:143], v[44:47]
    v_mfma_f32_16x16x32_bf16 v[76:79], v[156:159], v[140:143], v[76:79]
    s_add_u32 s19, s22, 3072
    buffer_load_dwordx4 v[152:155], v7, s[8:11], s19 offen
    s_add_u32 s19, s22, 19456
    buffer_load_dwordx4 v[156:159], v7, s[8:11], s19 offen
    ds_read_b128 v[112:115], v8 offset:192
    ds_read_b128 v[116:119], v8 offset:16832
    ds_read_b128 v[120:123], v8 offset:33472
    ds_read_b128 v[124:127], v8 offset:50112
    ds_read_b128 v[128:131], v9 offset:192
    ds_read_b128 v[132:135], v9 offset:16832
    ds_read_b128 v[136:139], v9 offset:33472
    ds_read_b128 v[140:143], v9 offset:50112
    s_waitcnt vmcnt(2) lgkmcnt(8)
    v_mfma_f32_16x16x32_bf16 v[16:19], v[144:147], v[80:83], v[16:19]
    v_mfma_f32_16x16x32_bf16 v[48:51], v[148:151], v[80:83], v[48:51]
    v_mfma_f32_16x16x32_bf16 v[20:23], v[144:147], v[84:87], v[20:23]
    v_mfma_f32_16x16x32_bf16 v[52:55], v[148:151], v[84:87], v[52:55]
    v_mfma_f32_16x16x32_bf16 v[24:27], v[144:147], v[88:91], v[24:27]
    v_mfma_f32_16x16x32_bf16 v[56:59], v[148:151], v[88:91], v[56:59]
    v_mfma_f32_16x16x32_bf16 v[28:31], v[144:147], v[92:95], v[28:31]
    v_mfma_f32_16x16x32_bf16 v[60:63], v[148:151], v[92:95], v[60:63]
    v_mfma_f32_16x16x32_bf16 v[32:35], v[144:147], v[96:99], v[32:35]
    v_mfma_f32_16x16x32_bf16 v[64:67], v[148:151], v[96:99], v[64:67]
    v_mfma_f32_16x16x32_bf16 v[36:39], v[144:147], v[100:103], v[36:39]
    v_mfma_f32_16x16x32_bf16 v[68:71], v[148:151], v[100:103], v[68:71]
    v_mfma_f32_16x16x32_bf16 v[40:43], v[144:147], v[104:107], v[40:43]
    v_mfma_f32_16x16x32_bf16 v[72:75], v[148:151], v[104:107], v[72:75]
    v_mfma_f32_16x16x32_bf16 v[44:47], v[144:147], v[108:111], v[44:47]
    v_mfma_f32_16x16x32_bf16 v[76:79], v[148:151], v[108:111], v[76:79]
    s_add_u32 s19, s22, 4096
    buffer_load_dwordx4 v[144:147], v7, s[8:11], s19 offen
    s_add_u32 s19, s22, 20480
    buffer_load_dwordx4 v[148:151], v7, s[8:11], s19 offen
    ds_read_b128 v[80:83], v8 offset:256
    ds_read_b128 v[84:87], v8 offset:16896
    ds_read_b128 v[88:91], v8 offset:33536
    ds_read_b128 v[92:95], v8 offset:50176
    ds_read_b128 v[96:99], v9 offset:256
    ds_read_b128 v[100:103], v9 offset:16896
    ds_read_b128 v[104:107], v9 offset:33536
    ds_read_b128 v[108:111], v9 offset:50176
    s_waitcnt vmcnt(2) lgkmcnt(8)
    v_mfma_f32_16x16x32_bf16 v[16:19], v[152:155], v[112:115], v[16:19]
    v_mfma_f32_16x16x32_bf16 v[48:51], v[156:159], v[112:115], v[48:51]
    v_mfma_f32_16x16x32_bf16 v[20:23], v[152:155], v[116:119], v[20:23]
    v_mfma_f32_16x16x32_bf16 v[52:55], v[156:159], v[116:119], v[52:55]
    v_mfma_f32_16x16x32_bf16 v[24:27], v[152:155], v[120:123], v[24:27]
    v_mfma_f32_16x16x32_bf16 v[56:59], v[156:159], v[120:123], v[56:59]
    v_mfma_f32_16x16x32_bf16 v[28:31], v[152:155], v[124:127], v[28:31]
    v_mfma_f32_16x16x32_bf16 v[60:63], v[156:159], v[124:127], v[60:63]
    v_mfma_f32_16x16x32_bf16 v[32:35], v[152:155], v[128:131], v[32:35]
    v_mfma_f32_16x16x32_bf16 v[64:67], v[156:159], v[128:131], v[64:67]
    v_mfma_f32_16x16x32_bf16 v[36:39], v[152:155], v[132:135], v[36:39]
    v_mfma_f32_16x16x32_bf16 v[68:71], v[156:159], v[132:135], v[68:71]
    v_mfma_f32_16x16x32_bf16 v[40:43], v[152:155], v[136:139], v[40:43]
    v_mfma_f32_16x16x32_bf16 v[72:75], v[156:159], v[136:139], v[72:75]
    v_mfma_f32_16x16x32_bf16 v[44:47], v[152:155], v[140:143], v[44:47]
    v_mfma_f32_16x16x32_bf16 v[76:79], v[156:159], v[140:143], v[76:79]
    s_add_u32 s19, s22, 5120
    buffer_load_dwordx4 v[152:155], v7, s[8:11], s19 offen
    s_add_u32 s19, s22, 21504
    buffer_load_dwordx4 v[156:159], v7, s[8:11], s19 offen
    ds_read_b128 v[112:115], v8 offset:320
    ds_read_b128 v[116:119], v8 offset:16960
    ds_read_b128 v[120:123], v8 offset:33600
    ds_read_b128 v[124:127], v8 offset:50240
    ds_read_b128 v[128:131], v9 offset:320
    ds_read_b128 v[132:135], v9 offset:16960
    ds_read_b128 v[136:139], v9 offset:33600
    ds_read_b128 v[140:143], v9 offset:50240
    s_waitcnt vmcnt(2) lgkmcnt(8)
    v_mfma_f32_16x16x32_bf16 v[16:19], v[144:147], v[80:83], v[16:19]
    v_mfma_f32_16x16x32_bf16 v[48:51], v[148:151], v[80:83], v[48:51]
    v_mfma_f32_16x16x32_bf16 v[20:23], v[144:147], v[84:87], v[20:23]
    v_mfma_f32_16x16x32_bf16 v[52:55], v[148:151], v[84:87], v[52:55]
    v_mfma_f32_16x16x32_bf16 v[24:27], v[144:147], v[88:91], v[24:27]
    v_mfma_f32_16x16x32_bf16 v[56:59], v[148:151], v[88:91], v[56:59]
    v_mfma_f32_16x16x32_bf16 v[28:31], v[144:147], v[92:95], v[28:31]
    v_mfma_f32_16x16x32_bf16 v[60:63], v[148:151], v[92:95], v[60:63]
    v_mfma_f32_16x16x32_bf16 v[32:35], v[144:147], v[96:99], v[32:35]
    v_mfma_f32_16x16x32_bf16 v[64:67], v[148:151], v[96:99], v[64:67]
    v_mfma_f32_16x16x32_bf16 v[36:39], v[144:147], v[100:103], v[36:39]
    v_mfma_f32_16x16x32_bf16 v[68:71], v[148:151], v[100:103], v[68:71]
    v_mfma_f32_16x16x32_bf16 v[40:43], v[144:147], v[104:107], v[40:43]
    v_mfma_f32_16x16x32_bf16 v[72:75], v[148:151], v[104:107], v[72:75]
    v_mfma_f32_16x16x32_bf16 v[44:47], v[144:147], v[108:111], v[44:47]
    v_mfma_f32_16x16x32_bf16 v[76:79], v[148:151], v[108:111], v[76:79]
    s_add_u32 s19, s22, 6144
    buffer_load_dwordx4 v[144:147], v7, s[8:11], s19 offen
    s_add_u32 s19, s22, 22528
    buffer_load_dwordx4 v[148:151], v7, s[8:11], s19 offen
    ds_read_b128 v[80:83], v8 offset:384
    ds_read_b128 v[84:87], v8 offset:17024
    ds_read_b128 v[88:91], v8 offset:33664
    ds_read_b128 v[92:95], v8 offset:50304
    ds_read_b128 v[96:99], v9 offset:384
    ds_read_b128 v[100:103], v9 offset:17024
    ds_read_b128 v[104:107], v9 offset:33664
    ds_read_b128 v[108:111], v9 offset:50304
    s_waitcnt vmcnt(2) lgkmcnt(8)
    v_mfma_f32_16x16x32_bf16 v[16:19], v[152:155], v[112:115], v[16:19]
    v_mfma_f32_16x16x32_bf16 v[48:51], v[156:159], v[112:115], v[48:51]
    v_mfma_f32_16x16x32_bf16 v[20:23], v[152:155], v[116:119], v[20:23]
    v_mfma_f32_16x16x32_bf16 v[52:55], v[156:159], v[116:119], v[52:55]
    v_mfma_f32_16x16x32_bf16 v[24:27], v[152:155], v[120:123], v[24:27]
    v_mfma_f32_16x16x32_bf16 v[56:59], v[156:159], v[120:123], v[56:59]
    v_mfma_f32_16x16x32_bf16 v[28:31], v[152:155], v[124:127], v[28:31]
    v_mfma_f32_16x16x32_bf16 v[60:63], v[156:159], v[124:127], v[60:63]
    v_mfma_f32_16x16x32_bf16 v[32:35], v[152:155], v[128:131], v[32:35]
    v_mfma_f32_16x16x32_bf16 v[64:67], v[156:159], v[128:131], v[64:67]
    v_mfma_f32_16x16x32_bf16 v[36:39], v[152:155], v[132:135], v[36:39]
    v_mfma_f32_16x16x32_bf16 v[68:71], v[156:159], v[132:135], v[68:71]
    v_mfma_f32_16x16x32_bf16 v[40:43], v[152:155], v[136:139], v[40:43]
    v_mfma_f32_16x16x32_bf16 v[72:75], v[156:159], v[136:139], v[72:75]
    v_mfma_f32_16x16x32_bf16 v[44:47], v[152:155], v[140:143], v[44:47]
    v_mfma_f32_16x16x32_bf16 v[76:79], v[156:159], v[140:143], v[76:79]
    s_add_u32 s19, s22, 7168
    buffer_load_dwordx4 v[152:155], v7, s[8:11], s19 offen
    s_add_u32 s19, s22, 23552
    buffer_load_dwordx4 v[156:159], v7, s[8:11], s19 offen
    ds_read_b128 v[112:115], v8 offset:448
    ds_read_b128 v[116:119], v8 offset:17088
    ds_read_b128 v[120:123], v8 offset:33728
    ds_read_b128 v[124:127], v8 offset:50368
    ds_read_b128 v[128:131], v9 offset:448
    ds_read_b128 v[132:135], v9 offset:17088
    ds_read_b128 v[136:139], v9 offset:33728
    ds_read_b128 v[140:143], v9 offset:50368
    s_waitcnt vmcnt(2) lgkmcnt(8)
    v_mfma_f32_16x16x32_bf16 v[16:19], v[144:147], v[80:83], v[16:19]
    v_mfma_f32_16x16x32_bf16 v[48:51], v[148:151], v[80:83], v[48:51]
    v_mfma_f32_16x16x32_bf16 v[20:23], v[144:147], v[84:87], v[20:23]
    v_mfma_f32_16x16x32_bf16 v[52:55], v[148:151], v[84:87], v[52:55]
    v_mfma_f32_16x16x32_bf16 v[24:27], v[144:147], v[88:91], v[24:27]
    v_mfma_f32_16x16x32_bf16 v[56:59], v[148:151], v[88:91], v[56:59]
    v_mfma_f32_16x16x32_bf16 v[28:31], v[144:147], v[92:95], v[28:31]
    v_mfma_f32_16x16x32_bf16 v[60:63], v[148:151], v[92:95], v[60:63]
    v_mfma_f32_16x16x32_bf16 v[32:35], v[144:147], v[96:99], v[32:35]
    v_mfma_f32_16x16x32_bf16 v[64:67], v[148:151], v[96:99], v[64:67]
    v_mfma_f32_16x16x32_bf16 v[36:39], v[144:147], v[100:103], v[36:39]
    v_mfma_f32_16x16x32_bf16 v[68:71], v[148:151], v[100:103], v[68:71]
    v_mfma_f32_16x16x32_bf16 v[40:43], v[144:147], v[104:107], v[40:43]
    v_mfma_f32_16x16x32_bf16 v[72:75], v[148:151], v[104:107], v[72:75]
    v_mfma_f32_16x16x32_bf16 v[44:47], v[144:147], v[108:111], v[44:47]
    v_mfma_f32_16x16x32_bf16 v[76:79], v[148:151], v[108:111], v[76:79]
    s_add_u32 s19, s22, 8192
    buffer_load_dwordx4 v[144:147], v7, s[8:11], s19 offen
    s_add_u32 s19, s22, 24576
    buffer_load_dwordx4 v[148:151], v7, s[8:11], s19 offen
    ds_read_b128 v[80:83], v8 offset:512
    ds_read_b128 v[84:87], v8 offset:17152
    ds_read_b128 v[88:91], v8 offset:33792
    ds_read_b128 v[92:95], v8 offset:50432
    ds_read_b128 v[96:99], v9 offset:512
    ds_read_b128 v[100:103], v9 offset:17152
    ds_read_b128 v[104:107], v9 offset:33792
    ds_read_b128 v[108:111], v9 offset:50432
    s_waitcnt vmcnt(2) lgkmcnt(8)
    v_mfma_f32_16x16x32_bf16 v[16:19], v[152:155], v[112:115], v[16:19]
    v_mfma_f32_16x16x32_bf16 v[48:51], v[156:159], v[112:115], v[48:51]
    v_mfma_f32_16x16x32_bf16 v[20:23], v[152:155], v[116:119], v[20:23]
    v_mfma_f32_16x16x32_bf16 v[52:55], v[156:159], v[116:119], v[52:55]
    v_mfma_f32_16x16x32_bf16 v[24:27], v[152:155], v[120:123], v[24:27]
    v_mfma_f32_16x16x32_bf16 v[56:59], v[156:159], v[120:123], v[56:59]
    v_mfma_f32_16x16x32_bf16 v[28:31], v[152:155], v[124:127], v[28:31]
    v_mfma_f32_16x16x32_bf16 v[60:63], v[156:159], v[124:127], v[60:63]
    v_mfma_f32_16x16x32_bf16 v[32:35], v[152:155], v[128:131], v[32:35]
    v_mfma_f32_16x16x32_bf16 v[64:67], v[156:159], v[128:131], v[64:67]
    v_mfma_f32_16x16x32_bf16 v[36:39], v[152:155], v[132:135], v[36:39]
    v_mfma_f32_16x16x32_bf16 v[68:71], v[156:159], v[132:135], v[68:71]
    v_mfma_f32_16x16x32_bf16 v[40:43], v[152:155], v[136:139], v[40:43]
    v_mfma_f32_16x16x32_bf16 v[72:75], v[156:159], v[136:139], v[72:75]
    v_mfma_f32_16x16x32_bf16 v[44:47], v[152:155], v[140:143], v[44:47]
    v_mfma_f32_16x16x32_bf16 v[76:79], v[156:159], v[140:143], v[76:79]
    s_add_u32 s19, s22, 9216
    buffer_load_dwordx4 v[152:155], v7, s[8:11], s19 offen
    s_add_u32 s19, s22, 25600
    buffer_load_dwordx4 v[156:159], v7, s[8:11], s19 offen
    ds_read_b128 v[112:115], v8 offset:576
    ds_read_b128 v[116:119], v8 offset:17216
    ds_read_b128 v[120:123], v8 offset:33856
    ds_read_b128 v[124:127], v8 offset:50496
    ds_read_b128 v[128:131], v9 offset:576
    ds_read_b128 v[132:135], v9 offset:17216
    ds_read_b128 v[136:139], v9 offset:33856
    ds_read_b128 v[140:143], v9 offset:50496
    s_waitcnt vmcnt(2) lgkmcnt(8)
    v_mfma_f32_16x16x32_bf16 v[16:19], v[144:147], v[80:83], v[16:19]
    v_mfma_f32_16x16x32_bf16 v[48:51], v[148:151], v[80:83], v[48:51]
    v_mfma_f32_16x16x32_bf16 v[20:23], v[144:147], v[84:87], v[20:23]
    v_mfma_f32_16x16x32_bf16 v[52:55], v[148:151], v[84:87], v[52:55]
    v_mfma_f32_16x16x32_bf16 v[24:27], v[144:147], v[88:91], v[24:27]
    v_mfma_f32_16x16x32_bf16 v[56:59], v[148:151], v[88:91], v[56:59]
    v_mfma_f32_16x16x32_bf16 v[28:31], v[144:147], v[92:95], v[28:31]
    v_mfma_f32_16x16x32_bf16 v[60:63], v[148:151], v[92:95], v[60:63]
    v_mfma_f32_16x16x32_bf16 v[32:35], v[144:147], v[96:99], v[32:35]
    v_mfma_f32_16x16x32_bf16 v[64:67], v[148:151], v[96:99], v[64:67]
    v_mfma_f32_16x16x32_bf16 v[36:39], v[144:147], v[100:103], v[36:39]
    v_mfma_f32_16x16x32_bf16 v[68:71], v[148:151], v[100:103], v[68:71]
    v_mfma_f32_16x16x32_bf16 v[40:43], v[144:147], v[104:107], v[40:43]
    v_mfma_f32_16x16x32_bf16 v[72:75], v[148:151], v[104:107], v[72:75]
    v_mfma_f32_16x16x32_bf16 v[44:47], v[144:147], v[108:111], v[44:47]
    v_mfma_f32_16x16x32_bf16 v[76:79], v[148:151], v[108:111], v[76:79]
    s_add_u32 s19, s22, 10240
    buffer_load_dwordx4 v[144:147], v7, s[8:11], s19 offen
    s_add_u32 s19, s22, 26624
    buffer_load_dwordx4 v[148:151], v7, s[8:11], s19 offen
    ds_read_b128 v[80:83], v8 offset:640
    ds_read_b128 v[84:87], v8 offset:17280
    ds_read_b128 v[88:91], v8 offset:33920
    ds_read_b128 v[92:95], v8 offset:50560
    ds_read_b128 v[96:99], v9 offset:640
    ds_read_b128 v[100:103], v9 offset:17280
    ds_read_b128 v[104:107], v9 offset:33920
    ds_read_b128 v[108:111], v9 offset:50560
    s_waitcnt vmcnt(2) lgkmcnt(8)
    v_mfma_f32_16x16x32_bf16 v[16:19], v[152:155], v[112:115], v[16:19]
    v_mfma_f32_16x16x32_bf16 v[48:51], v[156:159], v[112:115], v[48:51]
    v_mfma_f32_16x16x32_bf16 v[20:23], v[152:155], v[116:119], v[20:23]
    v_mfma_f32_16x16x32_bf16 v[52:55], v[156:159], v[116:119], v[52:55]
    v_mfma_f32_16x16x32_bf16 v[24:27], v[152:155], v[120:123], v[24:27]
    v_mfma_f32_16x16x32_bf16 v[56:59], v[156:159], v[120:123], v[56:59]
    v_mfma_f32_16x16x32_bf16 v[28:31], v[152:155], v[124:127], v[28:31]
    v_mfma_f32_16x16x32_bf16 v[60:63], v[156:159], v[124:127], v[60:63]
    v_mfma_f32_16x16x32_bf16 v[32:35], v[152:155], v[128:131], v[32:35]
    v_mfma_f32_16x16x32_bf16 v[64:67], v[156:159], v[128:131], v[64:67]
    v_mfma_f32_16x16x32_bf16 v[36:39], v[152:155], v[132:135], v[36:39]
    v_mfma_f32_16x16x32_bf16 v[68:71], v[156:159], v[132:135], v[68:71]
    v_mfma_f32_16x16x32_bf16 v[40:43], v[152:155], v[136:139], v[40:43]
    v_mfma_f32_16x16x32_bf16 v[72:75], v[156:159], v[136:139], v[72:75]
    v_mfma_f32_16x16x32_bf16 v[44:47], v[152:155], v[140:143], v[44:47]
    v_mfma_f32_16x16x32_bf16 v[76:79], v[156:159], v[140:143], v[76:79]
    s_add_u32 s19, s22, 11264
    buffer_load_dwordx4 v[152:155], v7, s[8:11], s19 offen
    s_add_u32 s19, s22, 27648
    buffer_load_dwordx4 v[156:159], v7, s[8:11], s19 offen
    ds_read_b128 v[112:115], v8 offset:704
    ds_read_b128 v[116:119], v8 offset:17344
    ds_read_b128 v[120:123], v8 offset:33984
    ds_read_b128 v[124:127], v8 offset:50624
    ds_read_b128 v[128:131], v9 offset:704
    ds_read_b128 v[132:135], v9 offset:17344
    ds_read_b128 v[136:139], v9 offset:33984
    ds_read_b128 v[140:143], v9 offset:50624
    s_waitcnt vmcnt(2) lgkmcnt(8)
    v_mfma_f32_16x16x32_bf16 v[16:19], v[144:147], v[80:83], v[16:19]
    v_mfma_f32_16x16x32_bf16 v[48:51], v[148:151], v[80:83], v[48:51]
    v_mfma_f32_16x16x32_bf16 v[20:23], v[144:147], v[84:87], v[20:23]
    v_mfma_f32_16x16x32_bf16 v[52:55], v[148:151], v[84:87], v[52:55]
    v_mfma_f32_16x16x32_bf16 v[24:27], v[144:147], v[88:91], v[24:27]
    v_mfma_f32_16x16x32_bf16 v[56:59], v[148:151], v[88:91], v[56:59]
    v_mfma_f32_16x16x32_bf16 v[28:31], v[144:147], v[92:95], v[28:31]
    v_mfma_f32_16x16x32_bf16 v[60:63], v[148:151], v[92:95], v[60:63]
    v_mfma_f32_16x16x32_bf16 v[32:35], v[144:147], v[96:99], v[32:35]
    v_mfma_f32_16x16x32_bf16 v[64:67], v[148:151], v[96:99], v[64:67]
    v_mfma_f32_16x16x32_bf16 v[36:39], v[144:147], v[100:103], v[36:39]
    v_mfma_f32_16x16x32_bf16 v[68:71], v[148:151], v[100:103], v[68:71]
    v_mfma_f32_16x16x32_bf16 v[40:43], v[144:147], v[104:107], v[40:43]
    v_mfma_f32_16x16x32_bf16 v[72:75], v[148:151], v[104:107], v[72:75]
    v_mfma_f32_16x16x32_bf16 v[44:47], v[144:147], v[108:111], v[44:47]
    v_mfma_f32_16x16x32_bf16 v[76:79], v[148:151], v[108:111], v[76:79]
    s_add_u32 s19, s22, 12288
    buffer_load_dwordx4 v[144:147], v7, s[8:11], s19 offen
    s_add_u32 s19, s22, 28672
    buffer_load_dwordx4 v[148:151], v7, s[8:11], s19 offen
    ds_read_b128 v[80:83], v8 offset:768
    ds_read_b128 v[84:87], v8 offset:17408
    ds_read_b128 v[88:91], v8 offset:34048
    ds_read_b128 v[92:95], v8 offset:50688
    ds_read_b128 v[96:99], v9 offset:768
    ds_read_b128 v[100:103], v9 offset:17408
    ds_read_b128 v[104:107], v9 offset:34048
    ds_read_b128 v[108:111], v9 offset:50688
    s_waitcnt vmcnt(2) lgkmcnt(8)
    v_mfma_f32_16x16x32_bf16 v[16:19], v[152:155], v[112:115], v[16:19]
    v_mfma_f32_16x16x32_bf16 v[48:51], v[156:159], v[112:115], v[48:51]
    v_mfma_f32_16x16x32_bf16 v[20:23], v[152:155], v[116:119], v[20:23]
    v_mfma_f32_16x16x32_bf16 v[52:55], v[156:159], v[116:119], v[52:55]
    v_mfma_f32_16x16x32_bf16 v[24:27], v[152:155], v[120:123], v[24:27]
    v_mfma_f32_16x16x32_bf16 v[56:59], v[156:159], v[120:123], v[56:59]
    v_mfma_f32_16x16x32_bf16 v[28:31], v[152:155], v[124:127], v[28:31]
    v_mfma_f32_16x16x32_bf16 v[60:63], v[156:159], v[124:127], v[60:63]
    v_mfma_f32_16x16x32_bf16 v[32:35], v[152:155], v[128:131], v[32:35]
    v_mfma_f32_16x16x32_bf16 v[64:67], v[156:159], v[128:131], v[64:67]
    v_mfma_f32_16x16x32_bf16 v[36:39], v[152:155], v[132:135], v[36:39]
    v_mfma_f32_16x16x32_bf16 v[68:71], v[156:159], v[132:135], v[68:71]
    v_mfma_f32_16x16x32_bf16 v[40:43], v[152:155], v[136:139], v[40:43]
    v_mfma_f32_16x16x32_bf16 v[72:75], v[156:159], v[136:139], v[72:75]
    v_mfma_f32_16x16x32_bf16 v[44:47], v[152:155], v[140:143], v[44:47]
    v_mfma_f32_16x16x32_bf16 v[76:79], v[156:159], v[140:143], v[76:79]
    s_add_u32 s19, s22, 13312
    buffer_load_dwordx4 v[152:155], v7, s[8:11], s19 offen
    s_add_u32 s19, s22, 29696
    buffer_load_dwordx4 v[156:159], v7, s[8:11], s19 offen
    ds_read_b128 v[112:115], v8 offset:832
    ds_read_b128 v[116:119], v8 offset:17472
    ds_read_b128 v[120:123], v8 offset:34112
    ds_read_b128 v[124:127], v8 offset:50752
    ds_read_b128 v[128:131], v9 offset:832
    ds_read_b128 v[132:135], v9 offset:17472
    ds_read_b128 v[136:139], v9 offset:34112
    ds_read_b128 v[140:143], v9 offset:50752
    s_waitcnt vmcnt(2) lgkmcnt(8)
    v_mfma_f32_16x16x32_bf16 v[16:19], v[144:147], v[80:83], v[16:19]
    v_mfma_f32_16x16x32_bf16 v[48:51], v[148:151], v[80:83], v[48:51]
    v_mfma_f32_16x16x32_bf16 v[20:23], v[144:147], v[84:87], v[20:23]
    v_mfma_f32_16x16x32_bf16 v[52:55], v[148:151], v[84:87], v[52:55]
    v_mfma_f32_16x16x32_bf16 v[24:27], v[144:147], v[88:91], v[24:27]
    v_mfma_f32_16x16x32_bf16 v[56:59], v[148:151], v[88:91], v[56:59]
    v_mfma_f32_16x16x32_bf16 v[28:31], v[144:147], v[92:95], v[28:31]
    v_mfma_f32_16x16x32_bf16 v[60:63], v[148:151], v[92:95], v[60:63]
    v_mfma_f32_16x16x32_bf16 v[32:35], v[144:147], v[96:99], v[32:35]
    v_mfma_f32_16x16x32_bf16 v[64:67], v[148:151], v[96:99], v[64:67]
    v_mfma_f32_16x16x32_bf16 v[36:39], v[144:147], v[100:103], v[36:39]
    v_mfma_f32_16x16x32_bf16 v[68:71], v[148:151], v[100:103], v[68:71]
    v_mfma_f32_16x16x32_bf16 v[40:43], v[144:147], v[104:107], v[40:43]
    v_mfma_f32_16x16x32_bf16 v[72:75], v[148:151], v[104:107], v[72:75]
    v_mfma_f32_16x16x32_bf16 v[44:47], v[144:147], v[108:111], v[44:47]
    v_mfma_f32_16x16x32_bf16 v[76:79], v[148:151], v[108:111], v[76:79]
    s_add_u32 s19, s22, 14336
    buffer_load_dwordx4 v[144:147], v7, s[8:11], s19 offen
    s_add_u32 s19, s22, 30720
    buffer_load_dwordx4 v[148:151], v7, s[8:11], s19 offen
    ds_read_b128 v[80:83], v8 offset:896
    ds_read_b128 v[84:87], v8 offset:17536
    ds_read_b128 v[88:91], v8 offset:34176
    ds_read_b128 v[92:95], v8 offset:50816
    ds_read_b128 v[96:99], v9 offset:896
    ds_read_b128 v[100:103], v9 offset:17536
    ds_read_b128 v[104:107], v9 offset:34176
    ds_read_b128 v[108:111], v9 offset:50816
    s_waitcnt vmcnt(2) lgkmcnt(8)
    v_mfma_f32_16x16x32_bf16 v[16:19], v[152:155], v[112:115], v[16:19]
    v_mfma_f32_16x16x32_bf16 v[48:51], v[156:159], v[112:115], v[48:51]
    v_mfma_f32_16x16x32_bf16 v[20:23], v[152:155], v[116:119], v[20:23]
    v_mfma_f32_16x16x32_bf16 v[52:55], v[156:159], v[116:119], v[52:55]
    v_mfma_f32_16x16x32_bf16 v[24:27], v[152:155], v[120:123], v[24:27]
    v_mfma_f32_16x16x32_bf16 v[56:59], v[156:159], v[120:123], v[56:59]
    v_mfma_f32_16x16x32_bf16 v[28:31], v[152:155], v[124:127], v[28:31]
    v_mfma_f32_16x16x32_bf16 v[60:63], v[156:159], v[124:127], v[60:63]
    v_mfma_f32_16x16x32_bf16 v[32:35], v[152:155], v[128:131], v[32:35]
    v_mfma_f32_16x16x32_bf16 v[64:67], v[156:159], v[128:131], v[64:67]
    v_mfma_f32_16x16x32_bf16 v[36:39], v[152:155], v[132:135], v[36:39]
    v_mfma_f32_16x16x32_bf16 v[68:71], v[156:159], v[132:135], v[68:71]
    v_mfma_f32_16x16x32_bf16 v[40:43], v[152:155], v[136:139], v[40:43]
    v_mfma_f32_16x16x32_bf16 v[72:75], v[156:159], v[136:139], v[72:75]
    v_mfma_f32_16x16x32_bf16 v[44:47], v[152:155], v[140:143], v[44:47]
    v_mfma_f32_16x16x32_bf16 v[76:79], v[156:159], v[140:143], v[76:79]
    s_add_u32 s19, s22, 15360
    buffer_load_dwordx4 v[152:155], v7, s[8:11], s19 offen
    s_add_u32 s19, s22, 31744
    buffer_load_dwordx4 v[156:159], v7, s[8:11], s19 offen
    ds_read_b128 v[112:115], v8 offset:960
    ds_read_b128 v[116:119], v8 offset:17600
    ds_read_b128 v[120:123], v8 offset:34240
    ds_read_b128 v[124:127], v8 offset:50880
    ds_read_b128 v[128:131], v9 offset:960
    ds_read_b128 v[132:135], v9 offset:17600
    ds_read_b128 v[136:139], v9 offset:34240
    ds_read_b128 v[140:143], v9 offset:50880
    s_waitcnt vmcnt(2) lgkmcnt(8)
    v_mfma_f32_16x16x32_bf16 v[16:19], v[144:147], v[80:83], v[16:19]
    v_mfma_f32_16x16x32_bf16 v[48:51], v[148:151], v[80:83], v[48:51]
    v_mfma_f32_16x16x32_bf16 v[20:23], v[144:147], v[84:87], v[20:23]
    v_mfma_f32_16x16x32_bf16 v[52:55], v[148:151], v[84:87], v[52:55]
    v_mfma_f32_16x16x32_bf16 v[24:27], v[144:147], v[88:91], v[24:27]
    v_mfma_f32_16x16x32_bf16 v[56:59], v[148:151], v[88:91], v[56:59]
    v_mfma_f32_16x16x32_bf16 v[28:31], v[144:147], v[92:95], v[28:31]
    v_mfma_f32_16x16x32_bf16 v[60:63], v[148:151], v[92:95], v[60:63]
    v_mfma_f32_16x16x32_bf16 v[32:35], v[144:147], v[96:99], v[32:35]
    v_mfma_f32_16x16x32_bf16 v[64:67], v[148:151], v[96:99], v[64:67]
    v_mfma_f32_16x16x32_bf16 v[36:39], v[144:147], v[100:103], v[36:39]
    v_mfma_f32_16x16x32_bf16 v[68:71], v[148:151], v[100:103], v[68:71]
    v_mfma_f32_16x16x32_bf16 v[40:43], v[144:147], v[104:107], v[40:43]
    v_mfma_f32_16x16x32_bf16 v[72:75], v[148:151], v[104:107], v[72:75]
    v_mfma_f32_16x16x32_bf16 v[44:47], v[144:147], v[108:111], v[44:47]
    v_mfma_f32_16x16x32_bf16 v[76:79], v[148:151], v[108:111], v[76:79]
    s_waitcnt vmcnt(0) lgkmcnt(0)
    v_mfma_f32_16x16x32_bf16 v[16:19], v[152:155], v[112:115], v[16:19]
    v_mfma_f32_16x16x32_bf16 v[48:51], v[156:159], v[112:115], v[48:51]
    v_mfma_f32_16x16x32_bf16 v[20:23], v[152:155], v[116:119], v[20:23]
    v_mfma_f32_16x16x32_bf16 v[52:55], v[156:159], v[116:119], v[52:55]
    v_mfma_f32_16x16x32_bf16 v[24:27], v[152:155], v[120:123], v[24:27]
    v_mfma_f32_16x16x32_bf16 v[56:59], v[156:159], v[120:123], v[56:59]
    v_mfma_f32_16x16x32_bf16 v[28:31], v[152:155], v[124:127], v[28:31]
    v_mfma_f32_16x16x32_bf16 v[60:63], v[156:159], v[124:127], v[60:63]
    v_mfma_f32_16x16x32_bf16 v[32:35], v[152:155], v[128:131], v[32:35]
    v_mfma_f32_16x16x32_bf16 v[64:67], v[156:159], v[128:131], v[64:67]
    v_mfma_f32_16x16x32_bf16 v[36:39], v[152:155], v[132:135], v[36:39]
    v_mfma_f32_16x16x32_bf16 v[68:71], v[156:159], v[132:135], v[68:71]
    v_mfma_f32_16x16x32_bf16 v[40:43], v[152:155], v[136:139], v[40:43]
    v_mfma_f32_16x16x32_bf16 v[72:75], v[156:159], v[136:139], v[72:75]
    v_mfma_f32_16x16x32_bf16 v[44:47], v[152:155], v[140:143], v[44:47]
    v_mfma_f32_16x16x32_bf16 v[76:79], v[156:159], v[140:143], v[76:79]
    s_nop 7
    s_lshl_b32 s23, s3, 2
    s_lshl_b32 s23, s23, 5
    s_add_u32 s23, s23, s6
    s_lshl_b32 s23, s23, 13
    s_lshl_b32 s19, s16, 11
    s_add_u32 s23, s23, s19
    s_add_u32 s23, s23, 176160768
    v_cvt_pk_bf16_f32 v80, v16, v17
    v_cvt_pk_bf16_f32 v81, v18, v19
    v_cvt_pk_bf16_f32 v82, v48, v49
    v_cvt_pk_bf16_f32 v83, v50, v51
    s_add_u32 s19, s23, 0
    buffer_store_dwordx4 v[80:83], v7, s[8:11], s19 offen sc1
    s_nop 1
    v_cvt_pk_bf16_f32 v84, v20, v21
    v_cvt_pk_bf16_f32 v85, v22, v23
    v_cvt_pk_bf16_f32 v86, v52, v53
    v_cvt_pk_bf16_f32 v87, v54, v55
    s_add_u32 s19, s23, 1024
    buffer_store_dwordx4 v[84:87], v7, s[8:11], s19 offen sc1
    s_nop 1
    v_cvt_pk_bf16_f32 v80, v24, v25
    v_cvt_pk_bf16_f32 v81, v26, v27
    v_cvt_pk_bf16_f32 v82, v56, v57
    v_cvt_pk_bf16_f32 v83, v58, v59
    s_add_u32 s19, s23, 262144
    buffer_store_dwordx4 v[80:83], v7, s[8:11], s19 offen sc1
    s_nop 1
    v_cvt_pk_bf16_f32 v84, v28, v29
    v_cvt_pk_bf16_f32 v85, v30, v31
    v_cvt_pk_bf16_f32 v86, v60, v61
    v_cvt_pk_bf16_f32 v87, v62, v63
    s_add_u32 s19, s23, 263168
    buffer_store_dwordx4 v[84:87], v7, s[8:11], s19 offen sc1
    s_nop 1
    v_cvt_pk_bf16_f32 v80, v32, v33
    v_cvt_pk_bf16_f32 v81, v34, v35
    v_cvt_pk_bf16_f32 v82, v64, v65
    v_cvt_pk_bf16_f32 v83, v66, v67
    s_add_u32 s19, s23, 524288
    buffer_store_dwordx4 v[80:83], v7, s[8:11], s19 offen sc1
    s_nop 1
    v_cvt_pk_bf16_f32 v84, v36, v37
    v_cvt_pk_bf16_f32 v85, v38, v39
    v_cvt_pk_bf16_f32 v86, v68, v69
    v_cvt_pk_bf16_f32 v87, v70, v71
    s_add_u32 s19, s23, 525312
    buffer_store_dwordx4 v[84:87], v7, s[8:11], s19 offen sc1
    s_nop 1
    v_cvt_pk_bf16_f32 v80, v40, v41
    v_cvt_pk_bf16_f32 v81, v42, v43
    v_cvt_pk_bf16_f32 v82, v72, v73
    v_cvt_pk_bf16_f32 v83, v74, v75
    s_add_u32 s19, s23, 786432
    buffer_store_dwordx4 v[80:83], v7, s[8:11], s19 offen sc1
    s_nop 1
    v_cvt_pk_bf16_f32 v84, v44, v45
    v_cvt_pk_bf16_f32 v85, v46, v47
    v_cvt_pk_bf16_f32 v86, v76, v77
    v_cvt_pk_bf16_f32 v87, v78, v79
    s_add_u32 s19, s23, 787456
    buffer_store_dwordx4 v[84:87], v7, s[8:11], s19 offen sc1
    s_nop 1
    s_lshl_b32 s6, s26, 1
    s_add_u32 s6, s6, 0
    s_lshl_b32 s22, s6, 17
    s_lshl_b32 s19, s16, 15
    s_add_u32 s22, s22, s19
    s_add_u32 s22, s22, 4194304
    s_add_u32 s19, s22, 0
    buffer_load_dwordx4 v[144:147], v7, s[8:11], s19 offen
    s_add_u32 s19, s22, 16384
    buffer_load_dwordx4 v[148:151], v7, s[8:11], s19 offen
    ds_read_b128 v[80:83], v8 offset:0
    ds_read_b128 v[84:87], v8 offset:16640
    ds_read_b128 v[88:91], v8 offset:33280
    ds_read_b128 v[92:95], v8 offset:49920
    ds_read_b128 v[96:99], v9 offset:0
    ds_read_b128 v[100:103], v9 offset:16640
    ds_read_b128 v[104:107], v9 offset:33280
    ds_read_b128 v[108:111], v9 offset:49920
    s_add_u32 s19, s22, 1024
    buffer_load_dwordx4 v[152:155], v7, s[8:11], s19 offen
    s_add_u32 s19, s22, 17408
    buffer_load_dwordx4 v[156:159], v7, s[8:11], s19 offen
    ds_read_b128 v[112:115], v8 offset:64
    ds_read_b128 v[116:119], v8 offset:16704
    ds_read_b128 v[120:123], v8 offset:33344
    ds_read_b128 v[124:127], v8 offset:49984
    ds_read_b128 v[128:131], v9 offset:64
    ds_read_b128 v[132:135], v9 offset:16704
    ds_read_b128 v[136:139], v9 offset:33344
    ds_read_b128 v[140:143], v9 offset:49984
    s_waitcnt vmcnt(2) lgkmcnt(8)
    v_mfma_f32_16x16x32_bf16 v[16:19], v[144:147], v[80:83], 0
    v_mfma_f32_16x16x32_bf16 v[48:51], v[148:151], v[80:83], 0
    v_mfma_f32_16x16x32_bf16 v[20:23], v[144:147], v[84:87], 0
    v_mfma_f32_16x16x32_bf16 v[52:55], v[148:151], v[84:87], 0
    v_mfma_f32_16x16x32_bf16 v[24:27], v[144:147], v[88:91], 0
    v_mfma_f32_16x16x32_bf16 v[56:59], v[148:151], v[88:91], 0
    v_mfma_f32_16x16x32_bf16 v[28:31], v[144:147], v[92:95], 0
    v_mfma_f32_16x16x32_bf16 v[60:63], v[148:151], v[92:95], 0
    v_mfma_f32_16x16x32_bf16 v[32:35], v[144:147], v[96:99], 0
    v_mfma_f32_16x16x32_bf16 v[64:67], v[148:151], v[96:99], 0
    v_mfma_f32_16x16x32_bf16 v[36:39], v[144:147], v[100:103], 0
    v_mfma_f32_16x16x32_bf16 v[68:71], v[148:151], v[100:103], 0
    v_mfma_f32_16x16x32_bf16 v[40:43], v[144:147], v[104:107], 0
    v_mfma_f32_16x16x32_bf16 v[72:75], v[148:151], v[104:107], 0
    v_mfma_f32_16x16x32_bf16 v[44:47], v[144:147], v[108:111], 0
    v_mfma_f32_16x16x32_bf16 v[76:79], v[148:151], v[108:111], 0
    s_add_u32 s19, s22, 2048
    buffer_load_dwordx4 v[144:147], v7, s[8:11], s19 offen
    s_add_u32 s19, s22, 18432
    buffer_load_dwordx4 v[148:151], v7, s[8:11], s19 offen
    ds_read_b128 v[80:83], v8 offset:128
    ds_read_b128 v[84:87], v8 offset:16768
    ds_read_b128 v[88:91], v8 offset:33408
    ds_read_b128 v[92:95], v8 offset:50048
    ds_read_b128 v[96:99], v9 offset:128
    ds_read_b128 v[100:103], v9 offset:16768
    ds_read_b128 v[104:107], v9 offset:33408
    ds_read_b128 v[108:111], v9 offset:50048
    s_waitcnt vmcnt(2) lgkmcnt(8)
    v_mfma_f32_16x16x32_bf16 v[16:19], v[152:155], v[112:115], v[16:19]
    v_mfma_f32_16x16x32_bf16 v[48:51], v[156:159], v[112:115], v[48:51]
    v_mfma_f32_16x16x32_bf16 v[20:23], v[152:155], v[116:119], v[20:23]
    v_mfma_f32_16x16x32_bf16 v[52:55], v[156:159], v[116:119], v[52:55]
    v_mfma_f32_16x16x32_bf16 v[24:27], v[152:155], v[120:123], v[24:27]
    v_mfma_f32_16x16x32_bf16 v[56:59], v[156:159], v[120:123], v[56:59]
    v_mfma_f32_16x16x32_bf16 v[28:31], v[152:155], v[124:127], v[28:31]
    v_mfma_f32_16x16x32_bf16 v[60:63], v[156:159], v[124:127], v[60:63]
    v_mfma_f32_16x16x32_bf16 v[32:35], v[152:155], v[128:131], v[32:35]
    v_mfma_f32_16x16x32_bf16 v[64:67], v[156:159], v[128:131], v[64:67]
    v_mfma_f32_16x16x32_bf16 v[36:39], v[152:155], v[132:135], v[36:39]
    v_mfma_f32_16x16x32_bf16 v[68:71], v[156:159], v[132:135], v[68:71]
    v_mfma_f32_16x16x32_bf16 v[40:43], v[152:155], v[136:139], v[40:43]
    v_mfma_f32_16x16x32_bf16 v[72:75], v[156:159], v[136:139], v[72:75]
    v_mfma_f32_16x16x32_bf16 v[44:47], v[152:155], v[140:143], v[44:47]
    v_mfma_f32_16x16x32_bf16 v[76:79], v[156:159], v[140:143], v[76:79]
    s_add_u32 s19, s22, 3072
    buffer_load_dwordx4 v[152:155], v7, s[8:11], s19 offen
    s_add_u32 s19, s22, 19456
    buffer_load_dwordx4 v[156:159], v7, s[8:11], s19 offen
    ds_read_b128 v[112:115], v8 offset:192
    ds_read_b128 v[116:119], v8 offset:16832
    ds_read_b128 v[120:123], v8 offset:33472
    ds_read_b128 v[124:127], v8 offset:50112
    ds_read_b128 v[128:131], v9 offset:192
    ds_read_b128 v[132:135], v9 offset:16832
    ds_read_b128 v[136:139], v9 offset:33472
    ds_read_b128 v[140:143], v9 offset:50112
    s_waitcnt vmcnt(2) lgkmcnt(8)
    v_mfma_f32_16x16x32_bf16 v[16:19], v[144:147], v[80:83], v[16:19]
    v_mfma_f32_16x16x32_bf16 v[48:51], v[148:151], v[80:83], v[48:51]
    v_mfma_f32_16x16x32_bf16 v[20:23], v[144:147], v[84:87], v[20:23]
    v_mfma_f32_16x16x32_bf16 v[52:55], v[148:151], v[84:87], v[52:55]
    v_mfma_f32_16x16x32_bf16 v[24:27], v[144:147], v[88:91], v[24:27]
    v_mfma_f32_16x16x32_bf16 v[56:59], v[148:151], v[88:91], v[56:59]
    v_mfma_f32_16x16x32_bf16 v[28:31], v[144:147], v[92:95], v[28:31]
    v_mfma_f32_16x16x32_bf16 v[60:63], v[148:151], v[92:95], v[60:63]
    v_mfma_f32_16x16x32_bf16 v[32:35], v[144:147], v[96:99], v[32:35]
    v_mfma_f32_16x16x32_bf16 v[64:67], v[148:151], v[96:99], v[64:67]
    v_mfma_f32_16x16x32_bf16 v[36:39], v[144:147], v[100:103], v[36:39]
    v_mfma_f32_16x16x32_bf16 v[68:71], v[148:151], v[100:103], v[68:71]
    v_mfma_f32_16x16x32_bf16 v[40:43], v[144:147], v[104:107], v[40:43]
    v_mfma_f32_16x16x32_bf16 v[72:75], v[148:151], v[104:107], v[72:75]
    v_mfma_f32_16x16x32_bf16 v[44:47], v[144:147], v[108:111], v[44:47]
    v_mfma_f32_16x16x32_bf16 v[76:79], v[148:151], v[108:111], v[76:79]
    s_add_u32 s19, s22, 4096
    buffer_load_dwordx4 v[144:147], v7, s[8:11], s19 offen
    s_add_u32 s19, s22, 20480
    buffer_load_dwordx4 v[148:151], v7, s[8:11], s19 offen
    ds_read_b128 v[80:83], v8 offset:256
    ds_read_b128 v[84:87], v8 offset:16896
    ds_read_b128 v[88:91], v8 offset:33536
    ds_read_b128 v[92:95], v8 offset:50176
    ds_read_b128 v[96:99], v9 offset:256
    ds_read_b128 v[100:103], v9 offset:16896
    ds_read_b128 v[104:107], v9 offset:33536
    ds_read_b128 v[108:111], v9 offset:50176
    s_waitcnt vmcnt(2) lgkmcnt(8)
    v_mfma_f32_16x16x32_bf16 v[16:19], v[152:155], v[112:115], v[16:19]
    v_mfma_f32_16x16x32_bf16 v[48:51], v[156:159], v[112:115], v[48:51]
    v_mfma_f32_16x16x32_bf16 v[20:23], v[152:155], v[116:119], v[20:23]
    v_mfma_f32_16x16x32_bf16 v[52:55], v[156:159], v[116:119], v[52:55]
    v_mfma_f32_16x16x32_bf16 v[24:27], v[152:155], v[120:123], v[24:27]
    v_mfma_f32_16x16x32_bf16 v[56:59], v[156:159], v[120:123], v[56:59]
    v_mfma_f32_16x16x32_bf16 v[28:31], v[152:155], v[124:127], v[28:31]
    v_mfma_f32_16x16x32_bf16 v[60:63], v[156:159], v[124:127], v[60:63]
    v_mfma_f32_16x16x32_bf16 v[32:35], v[152:155], v[128:131], v[32:35]
    v_mfma_f32_16x16x32_bf16 v[64:67], v[156:159], v[128:131], v[64:67]
    v_mfma_f32_16x16x32_bf16 v[36:39], v[152:155], v[132:135], v[36:39]
    v_mfma_f32_16x16x32_bf16 v[68:71], v[156:159], v[132:135], v[68:71]
    v_mfma_f32_16x16x32_bf16 v[40:43], v[152:155], v[136:139], v[40:43]
    v_mfma_f32_16x16x32_bf16 v[72:75], v[156:159], v[136:139], v[72:75]
    v_mfma_f32_16x16x32_bf16 v[44:47], v[152:155], v[140:143], v[44:47]
    v_mfma_f32_16x16x32_bf16 v[76:79], v[156:159], v[140:143], v[76:79]
    s_add_u32 s19, s22, 5120
    buffer_load_dwordx4 v[152:155], v7, s[8:11], s19 offen
    s_add_u32 s19, s22, 21504
    buffer_load_dwordx4 v[156:159], v7, s[8:11], s19 offen
    ds_read_b128 v[112:115], v8 offset:320
    ds_read_b128 v[116:119], v8 offset:16960
    ds_read_b128 v[120:123], v8 offset:33600
    ds_read_b128 v[124:127], v8 offset:50240
    ds_read_b128 v[128:131], v9 offset:320
    ds_read_b128 v[132:135], v9 offset:16960
    ds_read_b128 v[136:139], v9 offset:33600
    ds_read_b128 v[140:143], v9 offset:50240
    s_waitcnt vmcnt(2) lgkmcnt(8)
    v_mfma_f32_16x16x32_bf16 v[16:19], v[144:147], v[80:83], v[16:19]
    v_mfma_f32_16x16x32_bf16 v[48:51], v[148:151], v[80:83], v[48:51]
    v_mfma_f32_16x16x32_bf16 v[20:23], v[144:147], v[84:87], v[20:23]
    v_mfma_f32_16x16x32_bf16 v[52:55], v[148:151], v[84:87], v[52:55]
    v_mfma_f32_16x16x32_bf16 v[24:27], v[144:147], v[88:91], v[24:27]
    v_mfma_f32_16x16x32_bf16 v[56:59], v[148:151], v[88:91], v[56:59]
    v_mfma_f32_16x16x32_bf16 v[28:31], v[144:147], v[92:95], v[28:31]
    v_mfma_f32_16x16x32_bf16 v[60:63], v[148:151], v[92:95], v[60:63]
    v_mfma_f32_16x16x32_bf16 v[32:35], v[144:147], v[96:99], v[32:35]
    v_mfma_f32_16x16x32_bf16 v[64:67], v[148:151], v[96:99], v[64:67]
    v_mfma_f32_16x16x32_bf16 v[36:39], v[144:147], v[100:103], v[36:39]
    v_mfma_f32_16x16x32_bf16 v[68:71], v[148:151], v[100:103], v[68:71]
    v_mfma_f32_16x16x32_bf16 v[40:43], v[144:147], v[104:107], v[40:43]
    v_mfma_f32_16x16x32_bf16 v[72:75], v[148:151], v[104:107], v[72:75]
    v_mfma_f32_16x16x32_bf16 v[44:47], v[144:147], v[108:111], v[44:47]
    v_mfma_f32_16x16x32_bf16 v[76:79], v[148:151], v[108:111], v[76:79]
    s_add_u32 s19, s22, 6144
    buffer_load_dwordx4 v[144:147], v7, s[8:11], s19 offen
    s_add_u32 s19, s22, 22528
    buffer_load_dwordx4 v[148:151], v7, s[8:11], s19 offen
    ds_read_b128 v[80:83], v8 offset:384
    ds_read_b128 v[84:87], v8 offset:17024
    ds_read_b128 v[88:91], v8 offset:33664
    ds_read_b128 v[92:95], v8 offset:50304
    ds_read_b128 v[96:99], v9 offset:384
    ds_read_b128 v[100:103], v9 offset:17024
    ds_read_b128 v[104:107], v9 offset:33664
    ds_read_b128 v[108:111], v9 offset:50304
    s_waitcnt vmcnt(2) lgkmcnt(8)
    v_mfma_f32_16x16x32_bf16 v[16:19], v[152:155], v[112:115], v[16:19]
    v_mfma_f32_16x16x32_bf16 v[48:51], v[156:159], v[112:115], v[48:51]
    v_mfma_f32_16x16x32_bf16 v[20:23], v[152:155], v[116:119], v[20:23]
    v_mfma_f32_16x16x32_bf16 v[52:55], v[156:159], v[116:119], v[52:55]
    v_mfma_f32_16x16x32_bf16 v[24:27], v[152:155], v[120:123], v[24:27]
    v_mfma_f32_16x16x32_bf16 v[56:59], v[156:159], v[120:123], v[56:59]
    v_mfma_f32_16x16x32_bf16 v[28:31], v[152:155], v[124:127], v[28:31]
    v_mfma_f32_16x16x32_bf16 v[60:63], v[156:159], v[124:127], v[60:63]
    v_mfma_f32_16x16x32_bf16 v[32:35], v[152:155], v[128:131], v[32:35]
    v_mfma_f32_16x16x32_bf16 v[64:67], v[156:159], v[128:131], v[64:67]
    v_mfma_f32_16x16x32_bf16 v[36:39], v[152:155], v[132:135], v[36:39]
    v_mfma_f32_16x16x32_bf16 v[68:71], v[156:159], v[132:135], v[68:71]
    v_mfma_f32_16x16x32_bf16 v[40:43], v[152:155], v[136:139], v[40:43]
    v_mfma_f32_16x16x32_bf16 v[72:75], v[156:159], v[136:139], v[72:75]
    v_mfma_f32_16x16x32_bf16 v[44:47], v[152:155], v[140:143], v[44:47]
    v_mfma_f32_16x16x32_bf16 v[76:79], v[156:159], v[140:143], v[76:79]
    s_add_u32 s19, s22, 7168
    buffer_load_dwordx4 v[152:155], v7, s[8:11], s19 offen
    s_add_u32 s19, s22, 23552
    buffer_load_dwordx4 v[156:159], v7, s[8:11], s19 offen
    ds_read_b128 v[112:115], v8 offset:448
    ds_read_b128 v[116:119], v8 offset:17088
    ds_read_b128 v[120:123], v8 offset:33728
    ds_read_b128 v[124:127], v8 offset:50368
    ds_read_b128 v[128:131], v9 offset:448
    ds_read_b128 v[132:135], v9 offset:17088
    ds_read_b128 v[136:139], v9 offset:33728
    ds_read_b128 v[140:143], v9 offset:50368
    s_waitcnt vmcnt(2) lgkmcnt(8)
    v_mfma_f32_16x16x32_bf16 v[16:19], v[144:147], v[80:83], v[16:19]
    v_mfma_f32_16x16x32_bf16 v[48:51], v[148:151], v[80:83], v[48:51]
    v_mfma_f32_16x16x32_bf16 v[20:23], v[144:147], v[84:87], v[20:23]
    v_mfma_f32_16x16x32_bf16 v[52:55], v[148:151], v[84:87], v[52:55]
    v_mfma_f32_16x16x32_bf16 v[24:27], v[144:147], v[88:91], v[24:27]
    v_mfma_f32_16x16x32_bf16 v[56:59], v[148:151], v[88:91], v[56:59]
    v_mfma_f32_16x16x32_bf16 v[28:31], v[144:147], v[92:95], v[28:31]
    v_mfma_f32_16x16x32_bf16 v[60:63], v[148:151], v[92:95], v[60:63]
    v_mfma_f32_16x16x32_bf16 v[32:35], v[144:147], v[96:99], v[32:35]
    v_mfma_f32_16x16x32_bf16 v[64:67], v[148:151], v[96:99], v[64:67]
    v_mfma_f32_16x16x32_bf16 v[36:39], v[144:147], v[100:103], v[36:39]
    v_mfma_f32_16x16x32_bf16 v[68:71], v[148:151], v[100:103], v[68:71]
    v_mfma_f32_16x16x32_bf16 v[40:43], v[144:147], v[104:107], v[40:43]
    v_mfma_f32_16x16x32_bf16 v[72:75], v[148:151], v[104:107], v[72:75]
    v_mfma_f32_16x16x32_bf16 v[44:47], v[144:147], v[108:111], v[44:47]
    v_mfma_f32_16x16x32_bf16 v[76:79], v[148:151], v[108:111], v[76:79]
    s_add_u32 s19, s22, 8192
    buffer_load_dwordx4 v[144:147], v7, s[8:11], s19 offen
    s_add_u32 s19, s22, 24576
    buffer_load_dwordx4 v[148:151], v7, s[8:11], s19 offen
    ds_read_b128 v[80:83], v8 offset:512
    ds_read_b128 v[84:87], v8 offset:17152
    ds_read_b128 v[88:91], v8 offset:33792
    ds_read_b128 v[92:95], v8 offset:50432
    ds_read_b128 v[96:99], v9 offset:512
    ds_read_b128 v[100:103], v9 offset:17152
    ds_read_b128 v[104:107], v9 offset:33792
    ds_read_b128 v[108:111], v9 offset:50432
    s_waitcnt vmcnt(2) lgkmcnt(8)
    v_mfma_f32_16x16x32_bf16 v[16:19], v[152:155], v[112:115], v[16:19]
    v_mfma_f32_16x16x32_bf16 v[48:51], v[156:159], v[112:115], v[48:51]
    v_mfma_f32_16x16x32_bf16 v[20:23], v[152:155], v[116:119], v[20:23]
    v_mfma_f32_16x16x32_bf16 v[52:55], v[156:159], v[116:119], v[52:55]
    v_mfma_f32_16x16x32_bf16 v[24:27], v[152:155], v[120:123], v[24:27]
    v_mfma_f32_16x16x32_bf16 v[56:59], v[156:159], v[120:123], v[56:59]
    v_mfma_f32_16x16x32_bf16 v[28:31], v[152:155], v[124:127], v[28:31]
    v_mfma_f32_16x16x32_bf16 v[60:63], v[156:159], v[124:127], v[60:63]
    v_mfma_f32_16x16x32_bf16 v[32:35], v[152:155], v[128:131], v[32:35]
    v_mfma_f32_16x16x32_bf16 v[64:67], v[156:159], v[128:131], v[64:67]
    v_mfma_f32_16x16x32_bf16 v[36:39], v[152:155], v[132:135], v[36:39]
    v_mfma_f32_16x16x32_bf16 v[68:71], v[156:159], v[132:135], v[68:71]
    v_mfma_f32_16x16x32_bf16 v[40:43], v[152:155], v[136:139], v[40:43]
    v_mfma_f32_16x16x32_bf16 v[72:75], v[156:159], v[136:139], v[72:75]
    v_mfma_f32_16x16x32_bf16 v[44:47], v[152:155], v[140:143], v[44:47]
    v_mfma_f32_16x16x32_bf16 v[76:79], v[156:159], v[140:143], v[76:79]
    s_add_u32 s19, s22, 9216
    buffer_load_dwordx4 v[152:155], v7, s[8:11], s19 offen
    s_add_u32 s19, s22, 25600
    buffer_load_dwordx4 v[156:159], v7, s[8:11], s19 offen
    ds_read_b128 v[112:115], v8 offset:576
    ds_read_b128 v[116:119], v8 offset:17216
    ds_read_b128 v[120:123], v8 offset:33856
    ds_read_b128 v[124:127], v8 offset:50496
    ds_read_b128 v[128:131], v9 offset:576
    ds_read_b128 v[132:135], v9 offset:17216
    ds_read_b128 v[136:139], v9 offset:33856
    ds_read_b128 v[140:143], v9 offset:50496
    s_waitcnt vmcnt(2) lgkmcnt(8)
    v_mfma_f32_16x16x32_bf16 v[16:19], v[144:147], v[80:83], v[16:19]
    v_mfma_f32_16x16x32_bf16 v[48:51], v[148:151], v[80:83], v[48:51]
    v_mfma_f32_16x16x32_bf16 v[20:23], v[144:147], v[84:87], v[20:23]
    v_mfma_f32_16x16x32_bf16 v[52:55], v[148:151], v[84:87], v[52:55]
    v_mfma_f32_16x16x32_bf16 v[24:27], v[144:147], v[88:91], v[24:27]
    v_mfma_f32_16x16x32_bf16 v[56:59], v[148:151], v[88:91], v[56:59]
    v_mfma_f32_16x16x32_bf16 v[28:31], v[144:147], v[92:95], v[28:31]
    v_mfma_f32_16x16x32_bf16 v[60:63], v[148:151], v[92:95], v[60:63]
    v_mfma_f32_16x16x32_bf16 v[32:35], v[144:147], v[96:99], v[32:35]
    v_mfma_f32_16x16x32_bf16 v[64:67], v[148:151], v[96:99], v[64:67]
    v_mfma_f32_16x16x32_bf16 v[36:39], v[144:147], v[100:103], v[36:39]
    v_mfma_f32_16x16x32_bf16 v[68:71], v[148:151], v[100:103], v[68:71]
    v_mfma_f32_16x16x32_bf16 v[40:43], v[144:147], v[104:107], v[40:43]
    v_mfma_f32_16x16x32_bf16 v[72:75], v[148:151], v[104:107], v[72:75]
    v_mfma_f32_16x16x32_bf16 v[44:47], v[144:147], v[108:111], v[44:47]
    v_mfma_f32_16x16x32_bf16 v[76:79], v[148:151], v[108:111], v[76:79]
    s_add_u32 s19, s22, 10240
    buffer_load_dwordx4 v[144:147], v7, s[8:11], s19 offen
    s_add_u32 s19, s22, 26624
    buffer_load_dwordx4 v[148:151], v7, s[8:11], s19 offen
    ds_read_b128 v[80:83], v8 offset:640
    ds_read_b128 v[84:87], v8 offset:17280
    ds_read_b128 v[88:91], v8 offset:33920
    ds_read_b128 v[92:95], v8 offset:50560
    ds_read_b128 v[96:99], v9 offset:640
    ds_read_b128 v[100:103], v9 offset:17280
    ds_read_b128 v[104:107], v9 offset:33920
    ds_read_b128 v[108:111], v9 offset:50560
    s_waitcnt vmcnt(2) lgkmcnt(8)
    v_mfma_f32_16x16x32_bf16 v[16:19], v[152:155], v[112:115], v[16:19]
    v_mfma_f32_16x16x32_bf16 v[48:51], v[156:159], v[112:115], v[48:51]
    v_mfma_f32_16x16x32_bf16 v[20:23], v[152:155], v[116:119], v[20:23]
    v_mfma_f32_16x16x32_bf16 v[52:55], v[156:159], v[116:119], v[52:55]
    v_mfma_f32_16x16x32_bf16 v[24:27], v[152:155], v[120:123], v[24:27]
    v_mfma_f32_16x16x32_bf16 v[56:59], v[156:159], v[120:123], v[56:59]
    v_mfma_f32_16x16x32_bf16 v[28:31], v[152:155], v[124:127], v[28:31]
    v_mfma_f32_16x16x32_bf16 v[60:63], v[156:159], v[124:127], v[60:63]
    v_mfma_f32_16x16x32_bf16 v[32:35], v[152:155], v[128:131], v[32:35]
    v_mfma_f32_16x16x32_bf16 v[64:67], v[156:159], v[128:131], v[64:67]
    v_mfma_f32_16x16x32_bf16 v[36:39], v[152:155], v[132:135], v[36:39]
    v_mfma_f32_16x16x32_bf16 v[68:71], v[156:159], v[132:135], v[68:71]
    v_mfma_f32_16x16x32_bf16 v[40:43], v[152:155], v[136:139], v[40:43]
    v_mfma_f32_16x16x32_bf16 v[72:75], v[156:159], v[136:139], v[72:75]
    v_mfma_f32_16x16x32_bf16 v[44:47], v[152:155], v[140:143], v[44:47]
    v_mfma_f32_16x16x32_bf16 v[76:79], v[156:159], v[140:143], v[76:79]
    s_add_u32 s19, s22, 11264
    buffer_load_dwordx4 v[152:155], v7, s[8:11], s19 offen
    s_add_u32 s19, s22, 27648
    buffer_load_dwordx4 v[156:159], v7, s[8:11], s19 offen
    ds_read_b128 v[112:115], v8 offset:704
    ds_read_b128 v[116:119], v8 offset:17344
    ds_read_b128 v[120:123], v8 offset:33984
    ds_read_b128 v[124:127], v8 offset:50624
    ds_read_b128 v[128:131], v9 offset:704
    ds_read_b128 v[132:135], v9 offset:17344
    ds_read_b128 v[136:139], v9 offset:33984
    ds_read_b128 v[140:143], v9 offset:50624
    s_waitcnt vmcnt(2) lgkmcnt(8)
    v_mfma_f32_16x16x32_bf16 v[16:19], v[144:147], v[80:83], v[16:19]
    v_mfma_f32_16x16x32_bf16 v[48:51], v[148:151], v[80:83], v[48:51]
    v_mfma_f32_16x16x32_bf16 v[20:23], v[144:147], v[84:87], v[20:23]
    v_mfma_f32_16x16x32_bf16 v[52:55], v[148:151], v[84:87], v[52:55]
    v_mfma_f32_16x16x32_bf16 v[24:27], v[144:147], v[88:91], v[24:27]
    v_mfma_f32_16x16x32_bf16 v[56:59], v[148:151], v[88:91], v[56:59]
    v_mfma_f32_16x16x32_bf16 v[28:31], v[144:147], v[92:95], v[28:31]
    v_mfma_f32_16x16x32_bf16 v[60:63], v[148:151], v[92:95], v[60:63]
    v_mfma_f32_16x16x32_bf16 v[32:35], v[144:147], v[96:99], v[32:35]
    v_mfma_f32_16x16x32_bf16 v[64:67], v[148:151], v[96:99], v[64:67]
    v_mfma_f32_16x16x32_bf16 v[36:39], v[144:147], v[100:103], v[36:39]
    v_mfma_f32_16x16x32_bf16 v[68:71], v[148:151], v[100:103], v[68:71]
    v_mfma_f32_16x16x32_bf16 v[40:43], v[144:147], v[104:107], v[40:43]
    v_mfma_f32_16x16x32_bf16 v[72:75], v[148:151], v[104:107], v[72:75]
    v_mfma_f32_16x16x32_bf16 v[44:47], v[144:147], v[108:111], v[44:47]
    v_mfma_f32_16x16x32_bf16 v[76:79], v[148:151], v[108:111], v[76:79]
    s_add_u32 s19, s22, 12288
    buffer_load_dwordx4 v[144:147], v7, s[8:11], s19 offen
    s_add_u32 s19, s22, 28672
    buffer_load_dwordx4 v[148:151], v7, s[8:11], s19 offen
    ds_read_b128 v[80:83], v8 offset:768
    ds_read_b128 v[84:87], v8 offset:17408
    ds_read_b128 v[88:91], v8 offset:34048
    ds_read_b128 v[92:95], v8 offset:50688
    ds_read_b128 v[96:99], v9 offset:768
    ds_read_b128 v[100:103], v9 offset:17408
    ds_read_b128 v[104:107], v9 offset:34048
    ds_read_b128 v[108:111], v9 offset:50688
    s_waitcnt vmcnt(2) lgkmcnt(8)
    v_mfma_f32_16x16x32_bf16 v[16:19], v[152:155], v[112:115], v[16:19]
    v_mfma_f32_16x16x32_bf16 v[48:51], v[156:159], v[112:115], v[48:51]
    v_mfma_f32_16x16x32_bf16 v[20:23], v[152:155], v[116:119], v[20:23]
    v_mfma_f32_16x16x32_bf16 v[52:55], v[156:159], v[116:119], v[52:55]
    v_mfma_f32_16x16x32_bf16 v[24:27], v[152:155], v[120:123], v[24:27]
    v_mfma_f32_16x16x32_bf16 v[56:59], v[156:159], v[120:123], v[56:59]
    v_mfma_f32_16x16x32_bf16 v[28:31], v[152:155], v[124:127], v[28:31]
    v_mfma_f32_16x16x32_bf16 v[60:63], v[156:159], v[124:127], v[60:63]
    v_mfma_f32_16x16x32_bf16 v[32:35], v[152:155], v[128:131], v[32:35]
    v_mfma_f32_16x16x32_bf16 v[64:67], v[156:159], v[128:131], v[64:67]
    v_mfma_f32_16x16x32_bf16 v[36:39], v[152:155], v[132:135], v[36:39]
    v_mfma_f32_16x16x32_bf16 v[68:71], v[156:159], v[132:135], v[68:71]
    v_mfma_f32_16x16x32_bf16 v[40:43], v[152:155], v[136:139], v[40:43]
    v_mfma_f32_16x16x32_bf16 v[72:75], v[156:159], v[136:139], v[72:75]
    v_mfma_f32_16x16x32_bf16 v[44:47], v[152:155], v[140:143], v[44:47]
    v_mfma_f32_16x16x32_bf16 v[76:79], v[156:159], v[140:143], v[76:79]
    s_add_u32 s19, s22, 13312
    buffer_load_dwordx4 v[152:155], v7, s[8:11], s19 offen
    s_add_u32 s19, s22, 29696
    buffer_load_dwordx4 v[156:159], v7, s[8:11], s19 offen
    ds_read_b128 v[112:115], v8 offset:832
    ds_read_b128 v[116:119], v8 offset:17472
    ds_read_b128 v[120:123], v8 offset:34112
    ds_read_b128 v[124:127], v8 offset:50752
    ds_read_b128 v[128:131], v9 offset:832
    ds_read_b128 v[132:135], v9 offset:17472
    ds_read_b128 v[136:139], v9 offset:34112
    ds_read_b128 v[140:143], v9 offset:50752
    s_waitcnt vmcnt(2) lgkmcnt(8)
    v_mfma_f32_16x16x32_bf16 v[16:19], v[144:147], v[80:83], v[16:19]
    v_mfma_f32_16x16x32_bf16 v[48:51], v[148:151], v[80:83], v[48:51]
    v_mfma_f32_16x16x32_bf16 v[20:23], v[144:147], v[84:87], v[20:23]
    v_mfma_f32_16x16x32_bf16 v[52:55], v[148:151], v[84:87], v[52:55]
    v_mfma_f32_16x16x32_bf16 v[24:27], v[144:147], v[88:91], v[24:27]
    v_mfma_f32_16x16x32_bf16 v[56:59], v[148:151], v[88:91], v[56:59]
    v_mfma_f32_16x16x32_bf16 v[28:31], v[144:147], v[92:95], v[28:31]
    v_mfma_f32_16x16x32_bf16 v[60:63], v[148:151], v[92:95], v[60:63]
    v_mfma_f32_16x16x32_bf16 v[32:35], v[144:147], v[96:99], v[32:35]
    v_mfma_f32_16x16x32_bf16 v[64:67], v[148:151], v[96:99], v[64:67]
    v_mfma_f32_16x16x32_bf16 v[36:39], v[144:147], v[100:103], v[36:39]
    v_mfma_f32_16x16x32_bf16 v[68:71], v[148:151], v[100:103], v[68:71]
    v_mfma_f32_16x16x32_bf16 v[40:43], v[144:147], v[104:107], v[40:43]
    v_mfma_f32_16x16x32_bf16 v[72:75], v[148:151], v[104:107], v[72:75]
    v_mfma_f32_16x16x32_bf16 v[44:47], v[144:147], v[108:111], v[44:47]
    v_mfma_f32_16x16x32_bf16 v[76:79], v[148:151], v[108:111], v[76:79]
    s_add_u32 s19, s22, 14336
    buffer_load_dwordx4 v[144:147], v7, s[8:11], s19 offen
    s_add_u32 s19, s22, 30720
    buffer_load_dwordx4 v[148:151], v7, s[8:11], s19 offen
    ds_read_b128 v[80:83], v8 offset:896
    ds_read_b128 v[84:87], v8 offset:17536
    ds_read_b128 v[88:91], v8 offset:34176
    ds_read_b128 v[92:95], v8 offset:50816
    ds_read_b128 v[96:99], v9 offset:896
    ds_read_b128 v[100:103], v9 offset:17536
    ds_read_b128 v[104:107], v9 offset:34176
    ds_read_b128 v[108:111], v9 offset:50816
    s_waitcnt vmcnt(2) lgkmcnt(8)
    v_mfma_f32_16x16x32_bf16 v[16:19], v[152:155], v[112:115], v[16:19]
    v_mfma_f32_16x16x32_bf16 v[48:51], v[156:159], v[112:115], v[48:51]
    v_mfma_f32_16x16x32_bf16 v[20:23], v[152:155], v[116:119], v[20:23]
    v_mfma_f32_16x16x32_bf16 v[52:55], v[156:159], v[116:119], v[52:55]
    v_mfma_f32_16x16x32_bf16 v[24:27], v[152:155], v[120:123], v[24:27]
    v_mfma_f32_16x16x32_bf16 v[56:59], v[156:159], v[120:123], v[56:59]
    v_mfma_f32_16x16x32_bf16 v[28:31], v[152:155], v[124:127], v[28:31]
    v_mfma_f32_16x16x32_bf16 v[60:63], v[156:159], v[124:127], v[60:63]
    v_mfma_f32_16x16x32_bf16 v[32:35], v[152:155], v[128:131], v[32:35]
    v_mfma_f32_16x16x32_bf16 v[64:67], v[156:159], v[128:131], v[64:67]
    v_mfma_f32_16x16x32_bf16 v[36:39], v[152:155], v[132:135], v[36:39]
    v_mfma_f32_16x16x32_bf16 v[68:71], v[156:159], v[132:135], v[68:71]
    v_mfma_f32_16x16x32_bf16 v[40:43], v[152:155], v[136:139], v[40:43]
    v_mfma_f32_16x16x32_bf16 v[72:75], v[156:159], v[136:139], v[72:75]
    v_mfma_f32_16x16x32_bf16 v[44:47], v[152:155], v[140:143], v[44:47]
    v_mfma_f32_16x16x32_bf16 v[76:79], v[156:159], v[140:143], v[76:79]
    s_add_u32 s19, s22, 15360
    buffer_load_dwordx4 v[152:155], v7, s[8:11], s19 offen
    s_add_u32 s19, s22, 31744
    buffer_load_dwordx4 v[156:159], v7, s[8:11], s19 offen
    ds_read_b128 v[112:115], v8 offset:960
    ds_read_b128 v[116:119], v8 offset:17600
    ds_read_b128 v[120:123], v8 offset:34240
    ds_read_b128 v[124:127], v8 offset:50880
    ds_read_b128 v[128:131], v9 offset:960
    ds_read_b128 v[132:135], v9 offset:17600
    ds_read_b128 v[136:139], v9 offset:34240
    ds_read_b128 v[140:143], v9 offset:50880
    s_waitcnt vmcnt(2) lgkmcnt(8)
    v_mfma_f32_16x16x32_bf16 v[16:19], v[144:147], v[80:83], v[16:19]
    v_mfma_f32_16x16x32_bf16 v[48:51], v[148:151], v[80:83], v[48:51]
    v_mfma_f32_16x16x32_bf16 v[20:23], v[144:147], v[84:87], v[20:23]
    v_mfma_f32_16x16x32_bf16 v[52:55], v[148:151], v[84:87], v[52:55]
    v_mfma_f32_16x16x32_bf16 v[24:27], v[144:147], v[88:91], v[24:27]
    v_mfma_f32_16x16x32_bf16 v[56:59], v[148:151], v[88:91], v[56:59]
    v_mfma_f32_16x16x32_bf16 v[28:31], v[144:147], v[92:95], v[28:31]
    v_mfma_f32_16x16x32_bf16 v[60:63], v[148:151], v[92:95], v[60:63]
    v_mfma_f32_16x16x32_bf16 v[32:35], v[144:147], v[96:99], v[32:35]
    v_mfma_f32_16x16x32_bf16 v[64:67], v[148:151], v[96:99], v[64:67]
    v_mfma_f32_16x16x32_bf16 v[36:39], v[144:147], v[100:103], v[36:39]
    v_mfma_f32_16x16x32_bf16 v[68:71], v[148:151], v[100:103], v[68:71]
    v_mfma_f32_16x16x32_bf16 v[40:43], v[144:147], v[104:107], v[40:43]
    v_mfma_f32_16x16x32_bf16 v[72:75], v[148:151], v[104:107], v[72:75]
    v_mfma_f32_16x16x32_bf16 v[44:47], v[144:147], v[108:111], v[44:47]
    v_mfma_f32_16x16x32_bf16 v[76:79], v[148:151], v[108:111], v[76:79]
    s_waitcnt vmcnt(0) lgkmcnt(0)
    v_mfma_f32_16x16x32_bf16 v[16:19], v[152:155], v[112:115], v[16:19]
    v_mfma_f32_16x16x32_bf16 v[48:51], v[156:159], v[112:115], v[48:51]
    v_mfma_f32_16x16x32_bf16 v[20:23], v[152:155], v[116:119], v[20:23]
    v_mfma_f32_16x16x32_bf16 v[52:55], v[156:159], v[116:119], v[52:55]
    v_mfma_f32_16x16x32_bf16 v[24:27], v[152:155], v[120:123], v[24:27]
    v_mfma_f32_16x16x32_bf16 v[56:59], v[156:159], v[120:123], v[56:59]
    v_mfma_f32_16x16x32_bf16 v[28:31], v[152:155], v[124:127], v[28:31]
    v_mfma_f32_16x16x32_bf16 v[60:63], v[156:159], v[124:127], v[60:63]
    v_mfma_f32_16x16x32_bf16 v[32:35], v[152:155], v[128:131], v[32:35]
    v_mfma_f32_16x16x32_bf16 v[64:67], v[156:159], v[128:131], v[64:67]
    v_mfma_f32_16x16x32_bf16 v[36:39], v[152:155], v[132:135], v[36:39]
    v_mfma_f32_16x16x32_bf16 v[68:71], v[156:159], v[132:135], v[68:71]
    v_mfma_f32_16x16x32_bf16 v[40:43], v[152:155], v[136:139], v[40:43]
    v_mfma_f32_16x16x32_bf16 v[72:75], v[156:159], v[136:139], v[72:75]
    v_mfma_f32_16x16x32_bf16 v[44:47], v[152:155], v[140:143], v[44:47]
    v_mfma_f32_16x16x32_bf16 v[76:79], v[156:159], v[140:143], v[76:79]
    s_nop 7
    s_lshl_b32 s23, s3, 2
    s_lshl_b32 s23, s23, 5
    s_add_u32 s23, s23, s6
    s_lshl_b32 s23, s23, 13
    s_lshl_b32 s19, s16, 11
    s_add_u32 s23, s23, s19
    s_add_u32 s23, s23, 142606336
    v_cvt_pk_bf16_f32 v80, v16, v17
    v_cvt_pk_bf16_f32 v81, v18, v19
    v_cvt_pk_bf16_f32 v82, v48, v49
    v_cvt_pk_bf16_f32 v83, v50, v51
    s_add_u32 s19, s23, 0
    buffer_store_dwordx4 v[80:83], v7, s[8:11], s19 offen sc1
    s_nop 1
    v_cvt_pk_bf16_f32 v84, v20, v21
    v_cvt_pk_bf16_f32 v85, v22, v23
    v_cvt_pk_bf16_f32 v86, v52, v53
    v_cvt_pk_bf16_f32 v87, v54, v55
    s_add_u32 s19, s23, 1024
    buffer_store_dwordx4 v[84:87], v7, s[8:11], s19 offen sc1
    s_nop 1
    v_cvt_pk_bf16_f32 v80, v24, v25
    v_cvt_pk_bf16_f32 v81, v26, v27
    v_cvt_pk_bf16_f32 v82, v56, v57
    v_cvt_pk_bf16_f32 v83, v58, v59
    s_add_u32 s19, s23, 262144
    buffer_store_dwordx4 v[80:83], v7, s[8:11], s19 offen sc1
    s_nop 1
    v_cvt_pk_bf16_f32 v84, v28, v29
    v_cvt_pk_bf16_f32 v85, v30, v31
    v_cvt_pk_bf16_f32 v86, v60, v61
    v_cvt_pk_bf16_f32 v87, v62, v63
    s_add_u32 s19, s23, 263168
    buffer_store_dwordx4 v[84:87], v7, s[8:11], s19 offen sc1
    s_nop 1
    v_cvt_pk_bf16_f32 v80, v32, v33
    v_cvt_pk_bf16_f32 v81, v34, v35
    v_cvt_pk_bf16_f32 v82, v64, v65
    v_cvt_pk_bf16_f32 v83, v66, v67
    s_add_u32 s19, s23, 524288
    buffer_store_dwordx4 v[80:83], v7, s[8:11], s19 offen sc1
    s_nop 1
    v_cvt_pk_bf16_f32 v84, v36, v37
    v_cvt_pk_bf16_f32 v85, v38, v39
    v_cvt_pk_bf16_f32 v86, v68, v69
    v_cvt_pk_bf16_f32 v87, v70, v71
    s_add_u32 s19, s23, 525312
    buffer_store_dwordx4 v[84:87], v7, s[8:11], s19 offen sc1
    s_nop 1
    v_cvt_pk_bf16_f32 v80, v40, v41
    v_cvt_pk_bf16_f32 v81, v42, v43
    v_cvt_pk_bf16_f32 v82, v72, v73
    v_cvt_pk_bf16_f32 v83, v74, v75
    s_add_u32 s19, s23, 786432
    buffer_store_dwordx4 v[80:83], v7, s[8:11], s19 offen sc1
    s_nop 1
    v_cvt_pk_bf16_f32 v84, v44, v45
    v_cvt_pk_bf16_f32 v85, v46, v47
    v_cvt_pk_bf16_f32 v86, v76, v77
    v_cvt_pk_bf16_f32 v87, v78, v79
    s_add_u32 s19, s23, 787456
    buffer_store_dwordx4 v[84:87], v7, s[8:11], s19 offen sc1
    s_nop 1
    s_lshl_b32 s6, s26, 1
    s_add_u32 s6, s6, 0
    s_lshl_b32 s22, s6, 17
    s_lshl_b32 s19, s16, 15
    s_add_u32 s22, s22, s19
    s_add_u32 s22, s22, 8388608
    s_add_u32 s19, s22, 0
    buffer_load_dwordx4 v[144:147], v7, s[8:11], s19 offen
    s_add_u32 s19, s22, 16384
    buffer_load_dwordx4 v[148:151], v7, s[8:11], s19 offen
    ds_read_b128 v[80:83], v8 offset:0
    ds_read_b128 v[84:87], v8 offset:16640
    ds_read_b128 v[88:91], v8 offset:33280
    ds_read_b128 v[92:95], v8 offset:49920
    ds_read_b128 v[96:99], v9 offset:0
    ds_read_b128 v[100:103], v9 offset:16640
    ds_read_b128 v[104:107], v9 offset:33280
    ds_read_b128 v[108:111], v9 offset:49920
    s_add_u32 s19, s22, 1024
    buffer_load_dwordx4 v[152:155], v7, s[8:11], s19 offen
    s_add_u32 s19, s22, 17408
    buffer_load_dwordx4 v[156:159], v7, s[8:11], s19 offen
    ds_read_b128 v[112:115], v8 offset:64
    ds_read_b128 v[116:119], v8 offset:16704
    ds_read_b128 v[120:123], v8 offset:33344
    ds_read_b128 v[124:127], v8 offset:49984
    ds_read_b128 v[128:131], v9 offset:64
    ds_read_b128 v[132:135], v9 offset:16704
    ds_read_b128 v[136:139], v9 offset:33344
    ds_read_b128 v[140:143], v9 offset:49984
    s_waitcnt vmcnt(2) lgkmcnt(8)
    v_mfma_f32_16x16x32_bf16 v[16:19], v[80:83], v[144:147], 0
    v_mfma_f32_16x16x32_bf16 v[48:51], v[80:83], v[148:151], 0
    v_mfma_f32_16x16x32_bf16 v[20:23], v[84:87], v[144:147], 0
    v_mfma_f32_16x16x32_bf16 v[52:55], v[84:87], v[148:151], 0
    v_mfma_f32_16x16x32_bf16 v[24:27], v[88:91], v[144:147], 0
    v_mfma_f32_16x16x32_bf16 v[56:59], v[88:91], v[148:151], 0
    v_mfma_f32_16x16x32_bf16 v[28:31], v[92:95], v[144:147], 0
    v_mfma_f32_16x16x32_bf16 v[60:63], v[92:95], v[148:151], 0
    v_mfma_f32_16x16x32_bf16 v[32:35], v[96:99], v[144:147], 0
    v_mfma_f32_16x16x32_bf16 v[64:67], v[96:99], v[148:151], 0
    v_mfma_f32_16x16x32_bf16 v[36:39], v[100:103], v[144:147], 0
    v_mfma_f32_16x16x32_bf16 v[68:71], v[100:103], v[148:151], 0
    v_mfma_f32_16x16x32_bf16 v[40:43], v[104:107], v[144:147], 0
    v_mfma_f32_16x16x32_bf16 v[72:75], v[104:107], v[148:151], 0
    v_mfma_f32_16x16x32_bf16 v[44:47], v[108:111], v[144:147], 0
    v_mfma_f32_16x16x32_bf16 v[76:79], v[108:111], v[148:151], 0
    s_add_u32 s19, s22, 2048
    buffer_load_dwordx4 v[144:147], v7, s[8:11], s19 offen
    s_add_u32 s19, s22, 18432
    buffer_load_dwordx4 v[148:151], v7, s[8:11], s19 offen
    ds_read_b128 v[80:83], v8 offset:128
    ds_read_b128 v[84:87], v8 offset:16768
    ds_read_b128 v[88:91], v8 offset:33408
    ds_read_b128 v[92:95], v8 offset:50048
    ds_read_b128 v[96:99], v9 offset:128
    ds_read_b128 v[100:103], v9 offset:16768
    ds_read_b128 v[104:107], v9 offset:33408
    ds_read_b128 v[108:111], v9 offset:50048
    s_waitcnt vmcnt(2) lgkmcnt(8)
    v_mfma_f32_16x16x32_bf16 v[16:19], v[112:115], v[152:155], v[16:19]
    v_mfma_f32_16x16x32_bf16 v[48:51], v[112:115], v[156:159], v[48:51]
    v_mfma_f32_16x16x32_bf16 v[20:23], v[116:119], v[152:155], v[20:23]
    v_mfma_f32_16x16x32_bf16 v[52:55], v[116:119], v[156:159], v[52:55]
    v_mfma_f32_16x16x32_bf16 v[24:27], v[120:123], v[152:155], v[24:27]
    v_mfma_f32_16x16x32_bf16 v[56:59], v[120:123], v[156:159], v[56:59]
    v_mfma_f32_16x16x32_bf16 v[28:31], v[124:127], v[152:155], v[28:31]
    v_mfma_f32_16x16x32_bf16 v[60:63], v[124:127], v[156:159], v[60:63]
    v_mfma_f32_16x16x32_bf16 v[32:35], v[128:131], v[152:155], v[32:35]
    v_mfma_f32_16x16x32_bf16 v[64:67], v[128:131], v[156:159], v[64:67]
    v_mfma_f32_16x16x32_bf16 v[36:39], v[132:135], v[152:155], v[36:39]
    v_mfma_f32_16x16x32_bf16 v[68:71], v[132:135], v[156:159], v[68:71]
    v_mfma_f32_16x16x32_bf16 v[40:43], v[136:139], v[152:155], v[40:43]
    v_mfma_f32_16x16x32_bf16 v[72:75], v[136:139], v[156:159], v[72:75]
    v_mfma_f32_16x16x32_bf16 v[44:47], v[140:143], v[152:155], v[44:47]
    v_mfma_f32_16x16x32_bf16 v[76:79], v[140:143], v[156:159], v[76:79]
    s_add_u32 s19, s22, 3072
    buffer_load_dwordx4 v[152:155], v7, s[8:11], s19 offen
    s_add_u32 s19, s22, 19456
    buffer_load_dwordx4 v[156:159], v7, s[8:11], s19 offen
    ds_read_b128 v[112:115], v8 offset:192
    ds_read_b128 v[116:119], v8 offset:16832
    ds_read_b128 v[120:123], v8 offset:33472
    ds_read_b128 v[124:127], v8 offset:50112
    ds_read_b128 v[128:131], v9 offset:192
    ds_read_b128 v[132:135], v9 offset:16832
    ds_read_b128 v[136:139], v9 offset:33472
    ds_read_b128 v[140:143], v9 offset:50112
    s_waitcnt vmcnt(2) lgkmcnt(8)
    v_mfma_f32_16x16x32_bf16 v[16:19], v[80:83], v[144:147], v[16:19]
    v_mfma_f32_16x16x32_bf16 v[48:51], v[80:83], v[148:151], v[48:51]
    v_mfma_f32_16x16x32_bf16 v[20:23], v[84:87], v[144:147], v[20:23]
    v_mfma_f32_16x16x32_bf16 v[52:55], v[84:87], v[148:151], v[52:55]
    v_mfma_f32_16x16x32_bf16 v[24:27], v[88:91], v[144:147], v[24:27]
    v_mfma_f32_16x16x32_bf16 v[56:59], v[88:91], v[148:151], v[56:59]
    v_mfma_f32_16x16x32_bf16 v[28:31], v[92:95], v[144:147], v[28:31]
    v_mfma_f32_16x16x32_bf16 v[60:63], v[92:95], v[148:151], v[60:63]
    v_mfma_f32_16x16x32_bf16 v[32:35], v[96:99], v[144:147], v[32:35]
    v_mfma_f32_16x16x32_bf16 v[64:67], v[96:99], v[148:151], v[64:67]
    v_mfma_f32_16x16x32_bf16 v[36:39], v[100:103], v[144:147], v[36:39]
    v_mfma_f32_16x16x32_bf16 v[68:71], v[100:103], v[148:151], v[68:71]
    v_mfma_f32_16x16x32_bf16 v[40:43], v[104:107], v[144:147], v[40:43]
    v_mfma_f32_16x16x32_bf16 v[72:75], v[104:107], v[148:151], v[72:75]
    v_mfma_f32_16x16x32_bf16 v[44:47], v[108:111], v[144:147], v[44:47]
    v_mfma_f32_16x16x32_bf16 v[76:79], v[108:111], v[148:151], v[76:79]
    s_add_u32 s19, s22, 4096
    buffer_load_dwordx4 v[144:147], v7, s[8:11], s19 offen
    s_add_u32 s19, s22, 20480
    buffer_load_dwordx4 v[148:151], v7, s[8:11], s19 offen
    ds_read_b128 v[80:83], v8 offset:256
    ds_read_b128 v[84:87], v8 offset:16896
    ds_read_b128 v[88:91], v8 offset:33536
    ds_read_b128 v[92:95], v8 offset:50176
    ds_read_b128 v[96:99], v9 offset:256
    ds_read_b128 v[100:103], v9 offset:16896
    ds_read_b128 v[104:107], v9 offset:33536
    ds_read_b128 v[108:111], v9 offset:50176
    s_waitcnt vmcnt(2) lgkmcnt(8)
    v_mfma_f32_16x16x32_bf16 v[16:19], v[112:115], v[152:155], v[16:19]
    v_mfma_f32_16x16x32_bf16 v[48:51], v[112:115], v[156:159], v[48:51]
    v_mfma_f32_16x16x32_bf16 v[20:23], v[116:119], v[152:155], v[20:23]
    v_mfma_f32_16x16x32_bf16 v[52:55], v[116:119], v[156:159], v[52:55]
    v_mfma_f32_16x16x32_bf16 v[24:27], v[120:123], v[152:155], v[24:27]
    v_mfma_f32_16x16x32_bf16 v[56:59], v[120:123], v[156:159], v[56:59]
    v_mfma_f32_16x16x32_bf16 v[28:31], v[124:127], v[152:155], v[28:31]
    v_mfma_f32_16x16x32_bf16 v[60:63], v[124:127], v[156:159], v[60:63]
    v_mfma_f32_16x16x32_bf16 v[32:35], v[128:131], v[152:155], v[32:35]
    v_mfma_f32_16x16x32_bf16 v[64:67], v[128:131], v[156:159], v[64:67]
    v_mfma_f32_16x16x32_bf16 v[36:39], v[132:135], v[152:155], v[36:39]
    v_mfma_f32_16x16x32_bf16 v[68:71], v[132:135], v[156:159], v[68:71]
    v_mfma_f32_16x16x32_bf16 v[40:43], v[136:139], v[152:155], v[40:43]
    v_mfma_f32_16x16x32_bf16 v[72:75], v[136:139], v[156:159], v[72:75]
    v_mfma_f32_16x16x32_bf16 v[44:47], v[140:143], v[152:155], v[44:47]
    v_mfma_f32_16x16x32_bf16 v[76:79], v[140:143], v[156:159], v[76:79]
    s_add_u32 s19, s22, 5120
    buffer_load_dwordx4 v[152:155], v7, s[8:11], s19 offen
    s_add_u32 s19, s22, 21504
    buffer_load_dwordx4 v[156:159], v7, s[8:11], s19 offen
    ds_read_b128 v[112:115], v8 offset:320
    ds_read_b128 v[116:119], v8 offset:16960
    ds_read_b128 v[120:123], v8 offset:33600
    ds_read_b128 v[124:127], v8 offset:50240
    ds_read_b128 v[128:131], v9 offset:320
    ds_read_b128 v[132:135], v9 offset:16960
    ds_read_b128 v[136:139], v9 offset:33600
    ds_read_b128 v[140:143], v9 offset:50240
    s_waitcnt vmcnt(2) lgkmcnt(8)
    v_mfma_f32_16x16x32_bf16 v[16:19], v[80:83], v[144:147], v[16:19]
    v_mfma_f32_16x16x32_bf16 v[48:51], v[80:83], v[148:151], v[48:51]
    v_mfma_f32_16x16x32_bf16 v[20:23], v[84:87], v[144:147], v[20:23]
    v_mfma_f32_16x16x32_bf16 v[52:55], v[84:87], v[148:151], v[52:55]
    v_mfma_f32_16x16x32_bf16 v[24:27], v[88:91], v[144:147], v[24:27]
    v_mfma_f32_16x16x32_bf16 v[56:59], v[88:91], v[148:151], v[56:59]
    v_mfma_f32_16x16x32_bf16 v[28:31], v[92:95], v[144:147], v[28:31]
    v_mfma_f32_16x16x32_bf16 v[60:63], v[92:95], v[148:151], v[60:63]
    v_mfma_f32_16x16x32_bf16 v[32:35], v[96:99], v[144:147], v[32:35]
    v_mfma_f32_16x16x32_bf16 v[64:67], v[96:99], v[148:151], v[64:67]
    v_mfma_f32_16x16x32_bf16 v[36:39], v[100:103], v[144:147], v[36:39]
    v_mfma_f32_16x16x32_bf16 v[68:71], v[100:103], v[148:151], v[68:71]
    v_mfma_f32_16x16x32_bf16 v[40:43], v[104:107], v[144:147], v[40:43]
    v_mfma_f32_16x16x32_bf16 v[72:75], v[104:107], v[148:151], v[72:75]
    v_mfma_f32_16x16x32_bf16 v[44:47], v[108:111], v[144:147], v[44:47]
    v_mfma_f32_16x16x32_bf16 v[76:79], v[108:111], v[148:151], v[76:79]
    s_add_u32 s19, s22, 6144
    buffer_load_dwordx4 v[144:147], v7, s[8:11], s19 offen
    s_add_u32 s19, s22, 22528
    buffer_load_dwordx4 v[148:151], v7, s[8:11], s19 offen
    ds_read_b128 v[80:83], v8 offset:384
    ds_read_b128 v[84:87], v8 offset:17024
    ds_read_b128 v[88:91], v8 offset:33664
    ds_read_b128 v[92:95], v8 offset:50304
    ds_read_b128 v[96:99], v9 offset:384
    ds_read_b128 v[100:103], v9 offset:17024
    ds_read_b128 v[104:107], v9 offset:33664
    ds_read_b128 v[108:111], v9 offset:50304
    s_waitcnt vmcnt(2) lgkmcnt(8)
    v_mfma_f32_16x16x32_bf16 v[16:19], v[112:115], v[152:155], v[16:19]
    v_mfma_f32_16x16x32_bf16 v[48:51], v[112:115], v[156:159], v[48:51]
    v_mfma_f32_16x16x32_bf16 v[20:23], v[116:119], v[152:155], v[20:23]
    v_mfma_f32_16x16x32_bf16 v[52:55], v[116:119], v[156:159], v[52:55]
    v_mfma_f32_16x16x32_bf16 v[24:27], v[120:123], v[152:155], v[24:27]
    v_mfma_f32_16x16x32_bf16 v[56:59], v[120:123], v[156:159], v[56:59]
    v_mfma_f32_16x16x32_bf16 v[28:31], v[124:127], v[152:155], v[28:31]
    v_mfma_f32_16x16x32_bf16 v[60:63], v[124:127], v[156:159], v[60:63]
    v_mfma_f32_16x16x32_bf16 v[32:35], v[128:131], v[152:155], v[32:35]
    v_mfma_f32_16x16x32_bf16 v[64:67], v[128:131], v[156:159], v[64:67]
    v_mfma_f32_16x16x32_bf16 v[36:39], v[132:135], v[152:155], v[36:39]
    v_mfma_f32_16x16x32_bf16 v[68:71], v[132:135], v[156:159], v[68:71]
    v_mfma_f32_16x16x32_bf16 v[40:43], v[136:139], v[152:155], v[40:43]
    v_mfma_f32_16x16x32_bf16 v[72:75], v[136:139], v[156:159], v[72:75]
    v_mfma_f32_16x16x32_bf16 v[44:47], v[140:143], v[152:155], v[44:47]
    v_mfma_f32_16x16x32_bf16 v[76:79], v[140:143], v[156:159], v[76:79]
    s_add_u32 s19, s22, 7168
    buffer_load_dwordx4 v[152:155], v7, s[8:11], s19 offen
    s_add_u32 s19, s22, 23552
    buffer_load_dwordx4 v[156:159], v7, s[8:11], s19 offen
    ds_read_b128 v[112:115], v8 offset:448
    ds_read_b128 v[116:119], v8 offset:17088
    ds_read_b128 v[120:123], v8 offset:33728
    ds_read_b128 v[124:127], v8 offset:50368
    ds_read_b128 v[128:131], v9 offset:448
    ds_read_b128 v[132:135], v9 offset:17088
    ds_read_b128 v[136:139], v9 offset:33728
    ds_read_b128 v[140:143], v9 offset:50368
    s_waitcnt vmcnt(2) lgkmcnt(8)
    v_mfma_f32_16x16x32_bf16 v[16:19], v[80:83], v[144:147], v[16:19]
    v_mfma_f32_16x16x32_bf16 v[48:51], v[80:83], v[148:151], v[48:51]
    v_mfma_f32_16x16x32_bf16 v[20:23], v[84:87], v[144:147], v[20:23]
    v_mfma_f32_16x16x32_bf16 v[52:55], v[84:87], v[148:151], v[52:55]
    v_mfma_f32_16x16x32_bf16 v[24:27], v[88:91], v[144:147], v[24:27]
    v_mfma_f32_16x16x32_bf16 v[56:59], v[88:91], v[148:151], v[56:59]
    v_mfma_f32_16x16x32_bf16 v[28:31], v[92:95], v[144:147], v[28:31]
    v_mfma_f32_16x16x32_bf16 v[60:63], v[92:95], v[148:151], v[60:63]
    v_mfma_f32_16x16x32_bf16 v[32:35], v[96:99], v[144:147], v[32:35]
    v_mfma_f32_16x16x32_bf16 v[64:67], v[96:99], v[148:151], v[64:67]
    v_mfma_f32_16x16x32_bf16 v[36:39], v[100:103], v[144:147], v[36:39]
    v_mfma_f32_16x16x32_bf16 v[68:71], v[100:103], v[148:151], v[68:71]
    v_mfma_f32_16x16x32_bf16 v[40:43], v[104:107], v[144:147], v[40:43]
    v_mfma_f32_16x16x32_bf16 v[72:75], v[104:107], v[148:151], v[72:75]
    v_mfma_f32_16x16x32_bf16 v[44:47], v[108:111], v[144:147], v[44:47]
    v_mfma_f32_16x16x32_bf16 v[76:79], v[108:111], v[148:151], v[76:79]
    s_add_u32 s19, s22, 8192
    buffer_load_dwordx4 v[144:147], v7, s[8:11], s19 offen
    s_add_u32 s19, s22, 24576
    buffer_load_dwordx4 v[148:151], v7, s[8:11], s19 offen
    ds_read_b128 v[80:83], v8 offset:512
    ds_read_b128 v[84:87], v8 offset:17152
    ds_read_b128 v[88:91], v8 offset:33792
    ds_read_b128 v[92:95], v8 offset:50432
    ds_read_b128 v[96:99], v9 offset:512
    ds_read_b128 v[100:103], v9 offset:17152
    ds_read_b128 v[104:107], v9 offset:33792
    ds_read_b128 v[108:111], v9 offset:50432
    s_waitcnt vmcnt(2) lgkmcnt(8)
    v_mfma_f32_16x16x32_bf16 v[16:19], v[112:115], v[152:155], v[16:19]
    v_mfma_f32_16x16x32_bf16 v[48:51], v[112:115], v[156:159], v[48:51]
    v_mfma_f32_16x16x32_bf16 v[20:23], v[116:119], v[152:155], v[20:23]
    v_mfma_f32_16x16x32_bf16 v[52:55], v[116:119], v[156:159], v[52:55]
    v_mfma_f32_16x16x32_bf16 v[24:27], v[120:123], v[152:155], v[24:27]
    v_mfma_f32_16x16x32_bf16 v[56:59], v[120:123], v[156:159], v[56:59]
    v_mfma_f32_16x16x32_bf16 v[28:31], v[124:127], v[152:155], v[28:31]
    v_mfma_f32_16x16x32_bf16 v[60:63], v[124:127], v[156:159], v[60:63]
    v_mfma_f32_16x16x32_bf16 v[32:35], v[128:131], v[152:155], v[32:35]
    v_mfma_f32_16x16x32_bf16 v[64:67], v[128:131], v[156:159], v[64:67]
    v_mfma_f32_16x16x32_bf16 v[36:39], v[132:135], v[152:155], v[36:39]
    v_mfma_f32_16x16x32_bf16 v[68:71], v[132:135], v[156:159], v[68:71]
    v_mfma_f32_16x16x32_bf16 v[40:43], v[136:139], v[152:155], v[40:43]
    v_mfma_f32_16x16x32_bf16 v[72:75], v[136:139], v[156:159], v[72:75]
    v_mfma_f32_16x16x32_bf16 v[44:47], v[140:143], v[152:155], v[44:47]
    v_mfma_f32_16x16x32_bf16 v[76:79], v[140:143], v[156:159], v[76:79]
    s_add_u32 s19, s22, 9216
    buffer_load_dwordx4 v[152:155], v7, s[8:11], s19 offen
    s_add_u32 s19, s22, 25600
    buffer_load_dwordx4 v[156:159], v7, s[8:11], s19 offen
    ds_read_b128 v[112:115], v8 offset:576
    ds_read_b128 v[116:119], v8 offset:17216
    ds_read_b128 v[120:123], v8 offset:33856
    ds_read_b128 v[124:127], v8 offset:50496
    ds_read_b128 v[128:131], v9 offset:576
    ds_read_b128 v[132:135], v9 offset:17216
    ds_read_b128 v[136:139], v9 offset:33856
    ds_read_b128 v[140:143], v9 offset:50496
    s_waitcnt vmcnt(2) lgkmcnt(8)
    v_mfma_f32_16x16x32_bf16 v[16:19], v[80:83], v[144:147], v[16:19]
    v_mfma_f32_16x16x32_bf16 v[48:51], v[80:83], v[148:151], v[48:51]
    v_mfma_f32_16x16x32_bf16 v[20:23], v[84:87], v[144:147], v[20:23]
    v_mfma_f32_16x16x32_bf16 v[52:55], v[84:87], v[148:151], v[52:55]
    v_mfma_f32_16x16x32_bf16 v[24:27], v[88:91], v[144:147], v[24:27]
    v_mfma_f32_16x16x32_bf16 v[56:59], v[88:91], v[148:151], v[56:59]
    v_mfma_f32_16x16x32_bf16 v[28:31], v[92:95], v[144:147], v[28:31]
    v_mfma_f32_16x16x32_bf16 v[60:63], v[92:95], v[148:151], v[60:63]
    v_mfma_f32_16x16x32_bf16 v[32:35], v[96:99], v[144:147], v[32:35]
    v_mfma_f32_16x16x32_bf16 v[64:67], v[96:99], v[148:151], v[64:67]
    v_mfma_f32_16x16x32_bf16 v[36:39], v[100:103], v[144:147], v[36:39]
    v_mfma_f32_16x16x32_bf16 v[68:71], v[100:103], v[148:151], v[68:71]
    v_mfma_f32_16x16x32_bf16 v[40:43], v[104:107], v[144:147], v[40:43]
    v_mfma_f32_16x16x32_bf16 v[72:75], v[104:107], v[148:151], v[72:75]
    v_mfma_f32_16x16x32_bf16 v[44:47], v[108:111], v[144:147], v[44:47]
    v_mfma_f32_16x16x32_bf16 v[76:79], v[108:111], v[148:151], v[76:79]
    s_add_u32 s19, s22, 10240
    buffer_load_dwordx4 v[144:147], v7, s[8:11], s19 offen
    s_add_u32 s19, s22, 26624
    buffer_load_dwordx4 v[148:151], v7, s[8:11], s19 offen
    ds_read_b128 v[80:83], v8 offset:640
    ds_read_b128 v[84:87], v8 offset:17280
    ds_read_b128 v[88:91], v8 offset:33920
    ds_read_b128 v[92:95], v8 offset:50560
    ds_read_b128 v[96:99], v9 offset:640
    ds_read_b128 v[100:103], v9 offset:17280
    ds_read_b128 v[104:107], v9 offset:33920
    ds_read_b128 v[108:111], v9 offset:50560
    s_waitcnt vmcnt(2) lgkmcnt(8)
    v_mfma_f32_16x16x32_bf16 v[16:19], v[112:115], v[152:155], v[16:19]
    v_mfma_f32_16x16x32_bf16 v[48:51], v[112:115], v[156:159], v[48:51]
    v_mfma_f32_16x16x32_bf16 v[20:23], v[116:119], v[152:155], v[20:23]
    v_mfma_f32_16x16x32_bf16 v[52:55], v[116:119], v[156:159], v[52:55]
    v_mfma_f32_16x16x32_bf16 v[24:27], v[120:123], v[152:155], v[24:27]
    v_mfma_f32_16x16x32_bf16 v[56:59], v[120:123], v[156:159], v[56:59]
    v_mfma_f32_16x16x32_bf16 v[28:31], v[124:127], v[152:155], v[28:31]
    v_mfma_f32_16x16x32_bf16 v[60:63], v[124:127], v[156:159], v[60:63]
    v_mfma_f32_16x16x32_bf16 v[32:35], v[128:131], v[152:155], v[32:35]
    v_mfma_f32_16x16x32_bf16 v[64:67], v[128:131], v[156:159], v[64:67]
    v_mfma_f32_16x16x32_bf16 v[36:39], v[132:135], v[152:155], v[36:39]
    v_mfma_f32_16x16x32_bf16 v[68:71], v[132:135], v[156:159], v[68:71]
    v_mfma_f32_16x16x32_bf16 v[40:43], v[136:139], v[152:155], v[40:43]
    v_mfma_f32_16x16x32_bf16 v[72:75], v[136:139], v[156:159], v[72:75]
    v_mfma_f32_16x16x32_bf16 v[44:47], v[140:143], v[152:155], v[44:47]
    v_mfma_f32_16x16x32_bf16 v[76:79], v[140:143], v[156:159], v[76:79]
    s_add_u32 s19, s22, 11264
    buffer_load_dwordx4 v[152:155], v7, s[8:11], s19 offen
    s_add_u32 s19, s22, 27648
    buffer_load_dwordx4 v[156:159], v7, s[8:11], s19 offen
    ds_read_b128 v[112:115], v8 offset:704
    ds_read_b128 v[116:119], v8 offset:17344
    ds_read_b128 v[120:123], v8 offset:33984
    ds_read_b128 v[124:127], v8 offset:50624
    ds_read_b128 v[128:131], v9 offset:704
    ds_read_b128 v[132:135], v9 offset:17344
    ds_read_b128 v[136:139], v9 offset:33984
    ds_read_b128 v[140:143], v9 offset:50624
    s_waitcnt vmcnt(2) lgkmcnt(8)
    v_mfma_f32_16x16x32_bf16 v[16:19], v[80:83], v[144:147], v[16:19]
    v_mfma_f32_16x16x32_bf16 v[48:51], v[80:83], v[148:151], v[48:51]
    v_mfma_f32_16x16x32_bf16 v[20:23], v[84:87], v[144:147], v[20:23]
    v_mfma_f32_16x16x32_bf16 v[52:55], v[84:87], v[148:151], v[52:55]
    v_mfma_f32_16x16x32_bf16 v[24:27], v[88:91], v[144:147], v[24:27]
    v_mfma_f32_16x16x32_bf16 v[56:59], v[88:91], v[148:151], v[56:59]
    v_mfma_f32_16x16x32_bf16 v[28:31], v[92:95], v[144:147], v[28:31]
    v_mfma_f32_16x16x32_bf16 v[60:63], v[92:95], v[148:151], v[60:63]
    v_mfma_f32_16x16x32_bf16 v[32:35], v[96:99], v[144:147], v[32:35]
    v_mfma_f32_16x16x32_bf16 v[64:67], v[96:99], v[148:151], v[64:67]
    v_mfma_f32_16x16x32_bf16 v[36:39], v[100:103], v[144:147], v[36:39]
    v_mfma_f32_16x16x32_bf16 v[68:71], v[100:103], v[148:151], v[68:71]
    v_mfma_f32_16x16x32_bf16 v[40:43], v[104:107], v[144:147], v[40:43]
    v_mfma_f32_16x16x32_bf16 v[72:75], v[104:107], v[148:151], v[72:75]
    v_mfma_f32_16x16x32_bf16 v[44:47], v[108:111], v[144:147], v[44:47]
    v_mfma_f32_16x16x32_bf16 v[76:79], v[108:111], v[148:151], v[76:79]
    s_add_u32 s19, s22, 12288
    buffer_load_dwordx4 v[144:147], v7, s[8:11], s19 offen
    s_add_u32 s19, s22, 28672
    buffer_load_dwordx4 v[148:151], v7, s[8:11], s19 offen
    ds_read_b128 v[80:83], v8 offset:768
    ds_read_b128 v[84:87], v8 offset:17408
    ds_read_b128 v[88:91], v8 offset:34048
    ds_read_b128 v[92:95], v8 offset:50688
    ds_read_b128 v[96:99], v9 offset:768
    ds_read_b128 v[100:103], v9 offset:17408
    ds_read_b128 v[104:107], v9 offset:34048
    ds_read_b128 v[108:111], v9 offset:50688
    s_waitcnt vmcnt(2) lgkmcnt(8)
    v_mfma_f32_16x16x32_bf16 v[16:19], v[112:115], v[152:155], v[16:19]
    v_mfma_f32_16x16x32_bf16 v[48:51], v[112:115], v[156:159], v[48:51]
    v_mfma_f32_16x16x32_bf16 v[20:23], v[116:119], v[152:155], v[20:23]
    v_mfma_f32_16x16x32_bf16 v[52:55], v[116:119], v[156:159], v[52:55]
    v_mfma_f32_16x16x32_bf16 v[24:27], v[120:123], v[152:155], v[24:27]
    v_mfma_f32_16x16x32_bf16 v[56:59], v[120:123], v[156:159], v[56:59]
    v_mfma_f32_16x16x32_bf16 v[28:31], v[124:127], v[152:155], v[28:31]
    v_mfma_f32_16x16x32_bf16 v[60:63], v[124:127], v[156:159], v[60:63]
    v_mfma_f32_16x16x32_bf16 v[32:35], v[128:131], v[152:155], v[32:35]
    v_mfma_f32_16x16x32_bf16 v[64:67], v[128:131], v[156:159], v[64:67]
    v_mfma_f32_16x16x32_bf16 v[36:39], v[132:135], v[152:155], v[36:39]
    v_mfma_f32_16x16x32_bf16 v[68:71], v[132:135], v[156:159], v[68:71]
    v_mfma_f32_16x16x32_bf16 v[40:43], v[136:139], v[152:155], v[40:43]
    v_mfma_f32_16x16x32_bf16 v[72:75], v[136:139], v[156:159], v[72:75]
    v_mfma_f32_16x16x32_bf16 v[44:47], v[140:143], v[152:155], v[44:47]
    v_mfma_f32_16x16x32_bf16 v[76:79], v[140:143], v[156:159], v[76:79]
    s_add_u32 s19, s22, 13312
    buffer_load_dwordx4 v[152:155], v7, s[8:11], s19 offen
    s_add_u32 s19, s22, 29696
    buffer_load_dwordx4 v[156:159], v7, s[8:11], s19 offen
    ds_read_b128 v[112:115], v8 offset:832
    ds_read_b128 v[116:119], v8 offset:17472
    ds_read_b128 v[120:123], v8 offset:34112
    ds_read_b128 v[124:127], v8 offset:50752
    ds_read_b128 v[128:131], v9 offset:832
    ds_read_b128 v[132:135], v9 offset:17472
    ds_read_b128 v[136:139], v9 offset:34112
    ds_read_b128 v[140:143], v9 offset:50752
    s_waitcnt vmcnt(2) lgkmcnt(8)
    v_mfma_f32_16x16x32_bf16 v[16:19], v[80:83], v[144:147], v[16:19]
    v_mfma_f32_16x16x32_bf16 v[48:51], v[80:83], v[148:151], v[48:51]
    v_mfma_f32_16x16x32_bf16 v[20:23], v[84:87], v[144:147], v[20:23]
    v_mfma_f32_16x16x32_bf16 v[52:55], v[84:87], v[148:151], v[52:55]
    v_mfma_f32_16x16x32_bf16 v[24:27], v[88:91], v[144:147], v[24:27]
    v_mfma_f32_16x16x32_bf16 v[56:59], v[88:91], v[148:151], v[56:59]
    v_mfma_f32_16x16x32_bf16 v[28:31], v[92:95], v[144:147], v[28:31]
    v_mfma_f32_16x16x32_bf16 v[60:63], v[92:95], v[148:151], v[60:63]
    v_mfma_f32_16x16x32_bf16 v[32:35], v[96:99], v[144:147], v[32:35]
    v_mfma_f32_16x16x32_bf16 v[64:67], v[96:99], v[148:151], v[64:67]
    v_mfma_f32_16x16x32_bf16 v[36:39], v[100:103], v[144:147], v[36:39]
    v_mfma_f32_16x16x32_bf16 v[68:71], v[100:103], v[148:151], v[68:71]
    v_mfma_f32_16x16x32_bf16 v[40:43], v[104:107], v[144:147], v[40:43]
    v_mfma_f32_16x16x32_bf16 v[72:75], v[104:107], v[148:151], v[72:75]
    v_mfma_f32_16x16x32_bf16 v[44:47], v[108:111], v[144:147], v[44:47]
    v_mfma_f32_16x16x32_bf16 v[76:79], v[108:111], v[148:151], v[76:79]
    s_add_u32 s19, s22, 14336
    buffer_load_dwordx4 v[144:147], v7, s[8:11], s19 offen
    s_add_u32 s19, s22, 30720
    buffer_load_dwordx4 v[148:151], v7, s[8:11], s19 offen
    ds_read_b128 v[80:83], v8 offset:896
    ds_read_b128 v[84:87], v8 offset:17536
    ds_read_b128 v[88:91], v8 offset:34176
    ds_read_b128 v[92:95], v8 offset:50816
    ds_read_b128 v[96:99], v9 offset:896
    ds_read_b128 v[100:103], v9 offset:17536
    ds_read_b128 v[104:107], v9 offset:34176
    ds_read_b128 v[108:111], v9 offset:50816
    s_waitcnt vmcnt(2) lgkmcnt(8)
    v_mfma_f32_16x16x32_bf16 v[16:19], v[112:115], v[152:155], v[16:19]
    v_mfma_f32_16x16x32_bf16 v[48:51], v[112:115], v[156:159], v[48:51]
    v_mfma_f32_16x16x32_bf16 v[20:23], v[116:119], v[152:155], v[20:23]
    v_mfma_f32_16x16x32_bf16 v[52:55], v[116:119], v[156:159], v[52:55]
    v_mfma_f32_16x16x32_bf16 v[24:27], v[120:123], v[152:155], v[24:27]
    v_mfma_f32_16x16x32_bf16 v[56:59], v[120:123], v[156:159], v[56:59]
    v_mfma_f32_16x16x32_bf16 v[28:31], v[124:127], v[152:155], v[28:31]
    v_mfma_f32_16x16x32_bf16 v[60:63], v[124:127], v[156:159], v[60:63]
    v_mfma_f32_16x16x32_bf16 v[32:35], v[128:131], v[152:155], v[32:35]
    v_mfma_f32_16x16x32_bf16 v[64:67], v[128:131], v[156:159], v[64:67]
    v_mfma_f32_16x16x32_bf16 v[36:39], v[132:135], v[152:155], v[36:39]
    v_mfma_f32_16x16x32_bf16 v[68:71], v[132:135], v[156:159], v[68:71]
    v_mfma_f32_16x16x32_bf16 v[40:43], v[136:139], v[152:155], v[40:43]
    v_mfma_f32_16x16x32_bf16 v[72:75], v[136:139], v[156:159], v[72:75]
    v_mfma_f32_16x16x32_bf16 v[44:47], v[140:143], v[152:155], v[44:47]
    v_mfma_f32_16x16x32_bf16 v[76:79], v[140:143], v[156:159], v[76:79]
    s_add_u32 s19, s22, 15360
    buffer_load_dwordx4 v[152:155], v7, s[8:11], s19 offen
    s_add_u32 s19, s22, 31744
    buffer_load_dwordx4 v[156:159], v7, s[8:11], s19 offen
    ds_read_b128 v[112:115], v8 offset:960
    ds_read_b128 v[116:119], v8 offset:17600
    ds_read_b128 v[120:123], v8 offset:34240
    ds_read_b128 v[124:127], v8 offset:50880
    ds_read_b128 v[128:131], v9 offset:960
    ds_read_b128 v[132:135], v9 offset:17600
    ds_read_b128 v[136:139], v9 offset:34240
    ds_read_b128 v[140:143], v9 offset:50880
    s_waitcnt vmcnt(2) lgkmcnt(8)
    v_mfma_f32_16x16x32_bf16 v[16:19], v[80:83], v[144:147], v[16:19]
    v_mfma_f32_16x16x32_bf16 v[48:51], v[80:83], v[148:151], v[48:51]
    v_mfma_f32_16x16x32_bf16 v[20:23], v[84:87], v[144:147], v[20:23]
    v_mfma_f32_16x16x32_bf16 v[52:55], v[84:87], v[148:151], v[52:55]
    v_mfma_f32_16x16x32_bf16 v[24:27], v[88:91], v[144:147], v[24:27]
    v_mfma_f32_16x16x32_bf16 v[56:59], v[88:91], v[148:151], v[56:59]
    v_mfma_f32_16x16x32_bf16 v[28:31], v[92:95], v[144:147], v[28:31]
    v_mfma_f32_16x16x32_bf16 v[60:63], v[92:95], v[148:151], v[60:63]
    v_mfma_f32_16x16x32_bf16 v[32:35], v[96:99], v[144:147], v[32:35]
    v_mfma_f32_16x16x32_bf16 v[64:67], v[96:99], v[148:151], v[64:67]
    v_mfma_f32_16x16x32_bf16 v[36:39], v[100:103], v[144:147], v[36:39]
    v_mfma_f32_16x16x32_bf16 v[68:71], v[100:103], v[148:151], v[68:71]
    v_mfma_f32_16x16x32_bf16 v[40:43], v[104:107], v[144:147], v[40:43]
    v_mfma_f32_16x16x32_bf16 v[72:75], v[104:107], v[148:151], v[72:75]
    v_mfma_f32_16x16x32_bf16 v[44:47], v[108:111], v[144:147], v[44:47]
    v_mfma_f32_16x16x32_bf16 v[76:79], v[108:111], v[148:151], v[76:79]
    s_waitcnt vmcnt(0) lgkmcnt(0)
    v_mfma_f32_16x16x32_bf16 v[16:19], v[112:115], v[152:155], v[16:19]
    v_mfma_f32_16x16x32_bf16 v[48:51], v[112:115], v[156:159], v[48:51]
    v_mfma_f32_16x16x32_bf16 v[20:23], v[116:119], v[152:155], v[20:23]
    v_mfma_f32_16x16x32_bf16 v[52:55], v[116:119], v[156:159], v[52:55]
    v_mfma_f32_16x16x32_bf16 v[24:27], v[120:123], v[152:155], v[24:27]
    v_mfma_f32_16x16x32_bf16 v[56:59], v[120:123], v[156:159], v[56:59]
    v_mfma_f32_16x16x32_bf16 v[28:31], v[124:127], v[152:155], v[28:31]
    v_mfma_f32_16x16x32_bf16 v[60:63], v[124:127], v[156:159], v[60:63]
    v_mfma_f32_16x16x32_bf16 v[32:35], v[128:131], v[152:155], v[32:35]
    v_mfma_f32_16x16x32_bf16 v[64:67], v[128:131], v[156:159], v[64:67]
    v_mfma_f32_16x16x32_bf16 v[36:39], v[132:135], v[152:155], v[36:39]
    v_mfma_f32_16x16x32_bf16 v[68:71], v[132:135], v[156:159], v[68:71]
    v_mfma_f32_16x16x32_bf16 v[40:43], v[136:139], v[152:155], v[40:43]
    v_mfma_f32_16x16x32_bf16 v[72:75], v[136:139], v[156:159], v[72:75]
    v_mfma_f32_16x16x32_bf16 v[44:47], v[140:143], v[152:155], v[44:47]
    v_mfma_f32_16x16x32_bf16 v[76:79], v[140:143], v[156:159], v[76:79]
    s_nop 7
    s_lshl_b32 s23, s3, 2
    s_lshl_b32 s23, s23, 5
    s_add_u32 s23, s23, s6
    s_lshl_b32 s23, s23, 13
    s_lshl_b32 s19, s16, 11
    s_add_u32 s23, s23, s19
    s_add_u32 s23, s23, 159383552
    v_cvt_pk_bf16_f32 v80, v16, v17
    v_cvt_pk_bf16_f32 v81, v18, v19
    v_cvt_pk_bf16_f32 v82, v20, v21
    v_cvt_pk_bf16_f32 v83, v22, v23
    s_add_u32 s19, s23, 0
    buffer_store_dwordx4 v[80:83], v7, s[8:11], s19 offen sc1
    s_nop 1
    v_cvt_pk_bf16_f32 v84, v48, v49
    v_cvt_pk_bf16_f32 v85, v50, v51
    v_cvt_pk_bf16_f32 v86, v52, v53
    v_cvt_pk_bf16_f32 v87, v54, v55
    s_add_u32 s19, s23, 1024
    buffer_store_dwordx4 v[84:87], v7, s[8:11], s19 offen sc1
    s_nop 1
    v_cvt_pk_bf16_f32 v80, v24, v25
    v_cvt_pk_bf16_f32 v81, v26, v27
    v_cvt_pk_bf16_f32 v82, v28, v29
    v_cvt_pk_bf16_f32 v83, v30, v31
    s_add_u32 s19, s23, 262144
    buffer_store_dwordx4 v[80:83], v7, s[8:11], s19 offen sc1
    s_nop 1
    v_cvt_pk_bf16_f32 v84, v56, v57
    v_cvt_pk_bf16_f32 v85, v58, v59
    v_cvt_pk_bf16_f32 v86, v60, v61
    v_cvt_pk_bf16_f32 v87, v62, v63
    s_add_u32 s19, s23, 263168
    buffer_store_dwordx4 v[84:87], v7, s[8:11], s19 offen sc1
    s_nop 1
    v_cvt_pk_bf16_f32 v80, v32, v33
    v_cvt_pk_bf16_f32 v81, v34, v35
    v_cvt_pk_bf16_f32 v82, v36, v37
    v_cvt_pk_bf16_f32 v83, v38, v39
    s_add_u32 s19, s23, 524288
    buffer_store_dwordx4 v[80:83], v7, s[8:11], s19 offen sc1
    s_nop 1
    v_cvt_pk_bf16_f32 v84, v64, v65
    v_cvt_pk_bf16_f32 v85, v66, v67
    v_cvt_pk_bf16_f32 v86, v68, v69
    v_cvt_pk_bf16_f32 v87, v70, v71
    s_add_u32 s19, s23, 525312
    buffer_store_dwordx4 v[84:87], v7, s[8:11], s19 offen sc1
    s_nop 1
    v_cvt_pk_bf16_f32 v80, v40, v41
    v_cvt_pk_bf16_f32 v81, v42, v43
    v_cvt_pk_bf16_f32 v82, v44, v45
    v_cvt_pk_bf16_f32 v83, v46, v47
    s_add_u32 s19, s23, 786432
    buffer_store_dwordx4 v[80:83], v7, s[8:11], s19 offen sc1
    s_nop 1
    v_cvt_pk_bf16_f32 v84, v72, v73
    v_cvt_pk_bf16_f32 v85, v74, v75
    v_cvt_pk_bf16_f32 v86, v76, v77
    v_cvt_pk_bf16_f32 v87, v78, v79
    s_add_u32 s19, s23, 787456
    buffer_store_dwordx4 v[84:87], v7, s[8:11], s19 offen sc1
    s_nop 1
    s_lshl_b32 s6, s26, 1
    s_add_u32 s6, s6, 1
    s_lshl_b32 s22, s6, 17
    s_lshl_b32 s19, s16, 15
    s_add_u32 s22, s22, s19
    s_add_u32 s22, s22, 0
    s_add_u32 s19, s22, 0
    buffer_load_dwordx4 v[144:147], v7, s[8:11], s19 offen
    s_add_u32 s19, s22, 16384
    buffer_load_dwordx4 v[148:151], v7, s[8:11], s19 offen
    ds_read_b128 v[80:83], v8 offset:0
    ds_read_b128 v[84:87], v8 offset:16640
    ds_read_b128 v[88:91], v8 offset:33280
    ds_read_b128 v[92:95], v8 offset:49920
    ds_read_b128 v[96:99], v9 offset:0
    ds_read_b128 v[100:103], v9 offset:16640
    ds_read_b128 v[104:107], v9 offset:33280
    ds_read_b128 v[108:111], v9 offset:49920
    s_add_u32 s19, s22, 1024
    buffer_load_dwordx4 v[152:155], v7, s[8:11], s19 offen
    s_add_u32 s19, s22, 17408
    buffer_load_dwordx4 v[156:159], v7, s[8:11], s19 offen
    ds_read_b128 v[112:115], v8 offset:64
    ds_read_b128 v[116:119], v8 offset:16704
    ds_read_b128 v[120:123], v8 offset:33344
    ds_read_b128 v[124:127], v8 offset:49984
    ds_read_b128 v[128:131], v9 offset:64
    ds_read_b128 v[132:135], v9 offset:16704
    ds_read_b128 v[136:139], v9 offset:33344
    ds_read_b128 v[140:143], v9 offset:49984
    s_waitcnt vmcnt(2) lgkmcnt(8)
    v_mfma_f32_16x16x32_bf16 v[16:19], v[144:147], v[80:83], 0
    v_mfma_f32_16x16x32_bf16 v[48:51], v[148:151], v[80:83], 0
    v_mfma_f32_16x16x32_bf16 v[20:23], v[144:147], v[84:87], 0
    v_mfma_f32_16x16x32_bf16 v[52:55], v[148:151], v[84:87], 0
    v_mfma_f32_16x16x32_bf16 v[24:27], v[144:147], v[88:91], 0
    v_mfma_f32_16x16x32_bf16 v[56:59], v[148:151], v[88:91], 0
    v_mfma_f32_16x16x32_bf16 v[28:31], v[144:147], v[92:95], 0
    v_mfma_f32_16x16x32_bf16 v[60:63], v[148:151], v[92:95], 0
    v_mfma_f32_16x16x32_bf16 v[32:35], v[144:147], v[96:99], 0
    v_mfma_f32_16x16x32_bf16 v[64:67], v[148:151], v[96:99], 0
    v_mfma_f32_16x16x32_bf16 v[36:39], v[144:147], v[100:103], 0
    v_mfma_f32_16x16x32_bf16 v[68:71], v[148:151], v[100:103], 0
    v_mfma_f32_16x16x32_bf16 v[40:43], v[144:147], v[104:107], 0
    v_mfma_f32_16x16x32_bf16 v[72:75], v[148:151], v[104:107], 0
    v_mfma_f32_16x16x32_bf16 v[44:47], v[144:147], v[108:111], 0
    v_mfma_f32_16x16x32_bf16 v[76:79], v[148:151], v[108:111], 0
    s_add_u32 s19, s22, 2048
    buffer_load_dwordx4 v[144:147], v7, s[8:11], s19 offen
    s_add_u32 s19, s22, 18432
    buffer_load_dwordx4 v[148:151], v7, s[8:11], s19 offen
    ds_read_b128 v[80:83], v8 offset:128
    ds_read_b128 v[84:87], v8 offset:16768
    ds_read_b128 v[88:91], v8 offset:33408
    ds_read_b128 v[92:95], v8 offset:50048
    ds_read_b128 v[96:99], v9 offset:128
    ds_read_b128 v[100:103], v9 offset:16768
    ds_read_b128 v[104:107], v9 offset:33408
    ds_read_b128 v[108:111], v9 offset:50048
    s_waitcnt vmcnt(2) lgkmcnt(8)
    v_mfma_f32_16x16x32_bf16 v[16:19], v[152:155], v[112:115], v[16:19]
    v_mfma_f32_16x16x32_bf16 v[48:51], v[156:159], v[112:115], v[48:51]
    v_mfma_f32_16x16x32_bf16 v[20:23], v[152:155], v[116:119], v[20:23]
    v_mfma_f32_16x16x32_bf16 v[52:55], v[156:159], v[116:119], v[52:55]
    v_mfma_f32_16x16x32_bf16 v[24:27], v[152:155], v[120:123], v[24:27]
    v_mfma_f32_16x16x32_bf16 v[56:59], v[156:159], v[120:123], v[56:59]
    v_mfma_f32_16x16x32_bf16 v[28:31], v[152:155], v[124:127], v[28:31]
    v_mfma_f32_16x16x32_bf16 v[60:63], v[156:159], v[124:127], v[60:63]
    v_mfma_f32_16x16x32_bf16 v[32:35], v[152:155], v[128:131], v[32:35]
    v_mfma_f32_16x16x32_bf16 v[64:67], v[156:159], v[128:131], v[64:67]
    v_mfma_f32_16x16x32_bf16 v[36:39], v[152:155], v[132:135], v[36:39]
    v_mfma_f32_16x16x32_bf16 v[68:71], v[156:159], v[132:135], v[68:71]
    v_mfma_f32_16x16x32_bf16 v[40:43], v[152:155], v[136:139], v[40:43]
    v_mfma_f32_16x16x32_bf16 v[72:75], v[156:159], v[136:139], v[72:75]
    v_mfma_f32_16x16x32_bf16 v[44:47], v[152:155], v[140:143], v[44:47]
    v_mfma_f32_16x16x32_bf16 v[76:79], v[156:159], v[140:143], v[76:79]
    s_add_u32 s19, s22, 3072
    buffer_load_dwordx4 v[152:155], v7, s[8:11], s19 offen
    s_add_u32 s19, s22, 19456
    buffer_load_dwordx4 v[156:159], v7, s[8:11], s19 offen
    ds_read_b128 v[112:115], v8 offset:192
    ds_read_b128 v[116:119], v8 offset:16832
    ds_read_b128 v[120:123], v8 offset:33472
    ds_read_b128 v[124:127], v8 offset:50112
    ds_read_b128 v[128:131], v9 offset:192
    ds_read_b128 v[132:135], v9 offset:16832
    ds_read_b128 v[136:139], v9 offset:33472
    ds_read_b128 v[140:143], v9 offset:50112
    s_waitcnt vmcnt(2) lgkmcnt(8)
    v_mfma_f32_16x16x32_bf16 v[16:19], v[144:147], v[80:83], v[16:19]
    v_mfma_f32_16x16x32_bf16 v[48:51], v[148:151], v[80:83], v[48:51]
    v_mfma_f32_16x16x32_bf16 v[20:23], v[144:147], v[84:87], v[20:23]
    v_mfma_f32_16x16x32_bf16 v[52:55], v[148:151], v[84:87], v[52:55]
    v_mfma_f32_16x16x32_bf16 v[24:27], v[144:147], v[88:91], v[24:27]
    v_mfma_f32_16x16x32_bf16 v[56:59], v[148:151], v[88:91], v[56:59]
    v_mfma_f32_16x16x32_bf16 v[28:31], v[144:147], v[92:95], v[28:31]
    v_mfma_f32_16x16x32_bf16 v[60:63], v[148:151], v[92:95], v[60:63]
    v_mfma_f32_16x16x32_bf16 v[32:35], v[144:147], v[96:99], v[32:35]
    v_mfma_f32_16x16x32_bf16 v[64:67], v[148:151], v[96:99], v[64:67]
    v_mfma_f32_16x16x32_bf16 v[36:39], v[144:147], v[100:103], v[36:39]
    v_mfma_f32_16x16x32_bf16 v[68:71], v[148:151], v[100:103], v[68:71]
    v_mfma_f32_16x16x32_bf16 v[40:43], v[144:147], v[104:107], v[40:43]
    v_mfma_f32_16x16x32_bf16 v[72:75], v[148:151], v[104:107], v[72:75]
    v_mfma_f32_16x16x32_bf16 v[44:47], v[144:147], v[108:111], v[44:47]
    v_mfma_f32_16x16x32_bf16 v[76:79], v[148:151], v[108:111], v[76:79]
    s_add_u32 s19, s22, 4096
    buffer_load_dwordx4 v[144:147], v7, s[8:11], s19 offen
    s_add_u32 s19, s22, 20480
    buffer_load_dwordx4 v[148:151], v7, s[8:11], s19 offen
    ds_read_b128 v[80:83], v8 offset:256
    ds_read_b128 v[84:87], v8 offset:16896
    ds_read_b128 v[88:91], v8 offset:33536
    ds_read_b128 v[92:95], v8 offset:50176
    ds_read_b128 v[96:99], v9 offset:256
    ds_read_b128 v[100:103], v9 offset:16896
    ds_read_b128 v[104:107], v9 offset:33536
    ds_read_b128 v[108:111], v9 offset:50176
    s_waitcnt vmcnt(2) lgkmcnt(8)
    v_mfma_f32_16x16x32_bf16 v[16:19], v[152:155], v[112:115], v[16:19]
    v_mfma_f32_16x16x32_bf16 v[48:51], v[156:159], v[112:115], v[48:51]
    v_mfma_f32_16x16x32_bf16 v[20:23], v[152:155], v[116:119], v[20:23]
    v_mfma_f32_16x16x32_bf16 v[52:55], v[156:159], v[116:119], v[52:55]
    v_mfma_f32_16x16x32_bf16 v[24:27], v[152:155], v[120:123], v[24:27]
    v_mfma_f32_16x16x32_bf16 v[56:59], v[156:159], v[120:123], v[56:59]
    v_mfma_f32_16x16x32_bf16 v[28:31], v[152:155], v[124:127], v[28:31]
    v_mfma_f32_16x16x32_bf16 v[60:63], v[156:159], v[124:127], v[60:63]
    v_mfma_f32_16x16x32_bf16 v[32:35], v[152:155], v[128:131], v[32:35]
    v_mfma_f32_16x16x32_bf16 v[64:67], v[156:159], v[128:131], v[64:67]
    v_mfma_f32_16x16x32_bf16 v[36:39], v[152:155], v[132:135], v[36:39]
    v_mfma_f32_16x16x32_bf16 v[68:71], v[156:159], v[132:135], v[68:71]
    v_mfma_f32_16x16x32_bf16 v[40:43], v[152:155], v[136:139], v[40:43]
    v_mfma_f32_16x16x32_bf16 v[72:75], v[156:159], v[136:139], v[72:75]
    v_mfma_f32_16x16x32_bf16 v[44:47], v[152:155], v[140:143], v[44:47]
    v_mfma_f32_16x16x32_bf16 v[76:79], v[156:159], v[140:143], v[76:79]
    s_add_u32 s19, s22, 5120
    buffer_load_dwordx4 v[152:155], v7, s[8:11], s19 offen
    s_add_u32 s19, s22, 21504
    buffer_load_dwordx4 v[156:159], v7, s[8:11], s19 offen
    ds_read_b128 v[112:115], v8 offset:320
    ds_read_b128 v[116:119], v8 offset:16960
    ds_read_b128 v[120:123], v8 offset:33600
    ds_read_b128 v[124:127], v8 offset:50240
    ds_read_b128 v[128:131], v9 offset:320
    ds_read_b128 v[132:135], v9 offset:16960
    ds_read_b128 v[136:139], v9 offset:33600
    ds_read_b128 v[140:143], v9 offset:50240
    s_waitcnt vmcnt(2) lgkmcnt(8)
    v_mfma_f32_16x16x32_bf16 v[16:19], v[144:147], v[80:83], v[16:19]
    v_mfma_f32_16x16x32_bf16 v[48:51], v[148:151], v[80:83], v[48:51]
    v_mfma_f32_16x16x32_bf16 v[20:23], v[144:147], v[84:87], v[20:23]
    v_mfma_f32_16x16x32_bf16 v[52:55], v[148:151], v[84:87], v[52:55]
    v_mfma_f32_16x16x32_bf16 v[24:27], v[144:147], v[88:91], v[24:27]
    v_mfma_f32_16x16x32_bf16 v[56:59], v[148:151], v[88:91], v[56:59]
    v_mfma_f32_16x16x32_bf16 v[28:31], v[144:147], v[92:95], v[28:31]
    v_mfma_f32_16x16x32_bf16 v[60:63], v[148:151], v[92:95], v[60:63]
    v_mfma_f32_16x16x32_bf16 v[32:35], v[144:147], v[96:99], v[32:35]
    v_mfma_f32_16x16x32_bf16 v[64:67], v[148:151], v[96:99], v[64:67]
    v_mfma_f32_16x16x32_bf16 v[36:39], v[144:147], v[100:103], v[36:39]
    v_mfma_f32_16x16x32_bf16 v[68:71], v[148:151], v[100:103], v[68:71]
    v_mfma_f32_16x16x32_bf16 v[40:43], v[144:147], v[104:107], v[40:43]
    v_mfma_f32_16x16x32_bf16 v[72:75], v[148:151], v[104:107], v[72:75]
    v_mfma_f32_16x16x32_bf16 v[44:47], v[144:147], v[108:111], v[44:47]
    v_mfma_f32_16x16x32_bf16 v[76:79], v[148:151], v[108:111], v[76:79]
    s_add_u32 s19, s22, 6144
    buffer_load_dwordx4 v[144:147], v7, s[8:11], s19 offen
    s_add_u32 s19, s22, 22528
    buffer_load_dwordx4 v[148:151], v7, s[8:11], s19 offen
    ds_read_b128 v[80:83], v8 offset:384
    ds_read_b128 v[84:87], v8 offset:17024
    ds_read_b128 v[88:91], v8 offset:33664
    ds_read_b128 v[92:95], v8 offset:50304
    ds_read_b128 v[96:99], v9 offset:384
    ds_read_b128 v[100:103], v9 offset:17024
    ds_read_b128 v[104:107], v9 offset:33664
    ds_read_b128 v[108:111], v9 offset:50304
    s_waitcnt vmcnt(2) lgkmcnt(8)
    v_mfma_f32_16x16x32_bf16 v[16:19], v[152:155], v[112:115], v[16:19]
    v_mfma_f32_16x16x32_bf16 v[48:51], v[156:159], v[112:115], v[48:51]
    v_mfma_f32_16x16x32_bf16 v[20:23], v[152:155], v[116:119], v[20:23]
    v_mfma_f32_16x16x32_bf16 v[52:55], v[156:159], v[116:119], v[52:55]
    v_mfma_f32_16x16x32_bf16 v[24:27], v[152:155], v[120:123], v[24:27]
    v_mfma_f32_16x16x32_bf16 v[56:59], v[156:159], v[120:123], v[56:59]
    v_mfma_f32_16x16x32_bf16 v[28:31], v[152:155], v[124:127], v[28:31]
    v_mfma_f32_16x16x32_bf16 v[60:63], v[156:159], v[124:127], v[60:63]
    v_mfma_f32_16x16x32_bf16 v[32:35], v[152:155], v[128:131], v[32:35]
    v_mfma_f32_16x16x32_bf16 v[64:67], v[156:159], v[128:131], v[64:67]
    v_mfma_f32_16x16x32_bf16 v[36:39], v[152:155], v[132:135], v[36:39]
    v_mfma_f32_16x16x32_bf16 v[68:71], v[156:159], v[132:135], v[68:71]
    v_mfma_f32_16x16x32_bf16 v[40:43], v[152:155], v[136:139], v[40:43]
    v_mfma_f32_16x16x32_bf16 v[72:75], v[156:159], v[136:139], v[72:75]
    v_mfma_f32_16x16x32_bf16 v[44:47], v[152:155], v[140:143], v[44:47]
    v_mfma_f32_16x16x32_bf16 v[76:79], v[156:159], v[140:143], v[76:79]
    s_add_u32 s19, s22, 7168
    buffer_load_dwordx4 v[152:155], v7, s[8:11], s19 offen
    s_add_u32 s19, s22, 23552
    buffer_load_dwordx4 v[156:159], v7, s[8:11], s19 offen
    ds_read_b128 v[112:115], v8 offset:448
    ds_read_b128 v[116:119], v8 offset:17088
    ds_read_b128 v[120:123], v8 offset:33728
    ds_read_b128 v[124:127], v8 offset:50368
    ds_read_b128 v[128:131], v9 offset:448
    ds_read_b128 v[132:135], v9 offset:17088
    ds_read_b128 v[136:139], v9 offset:33728
    ds_read_b128 v[140:143], v9 offset:50368
    s_waitcnt vmcnt(2) lgkmcnt(8)
    v_mfma_f32_16x16x32_bf16 v[16:19], v[144:147], v[80:83], v[16:19]
    v_mfma_f32_16x16x32_bf16 v[48:51], v[148:151], v[80:83], v[48:51]
    v_mfma_f32_16x16x32_bf16 v[20:23], v[144:147], v[84:87], v[20:23]
    v_mfma_f32_16x16x32_bf16 v[52:55], v[148:151], v[84:87], v[52:55]
    v_mfma_f32_16x16x32_bf16 v[24:27], v[144:147], v[88:91], v[24:27]
    v_mfma_f32_16x16x32_bf16 v[56:59], v[148:151], v[88:91], v[56:59]
    v_mfma_f32_16x16x32_bf16 v[28:31], v[144:147], v[92:95], v[28:31]
    v_mfma_f32_16x16x32_bf16 v[60:63], v[148:151], v[92:95], v[60:63]
    v_mfma_f32_16x16x32_bf16 v[32:35], v[144:147], v[96:99], v[32:35]
    v_mfma_f32_16x16x32_bf16 v[64:67], v[148:151], v[96:99], v[64:67]
    v_mfma_f32_16x16x32_bf16 v[36:39], v[144:147], v[100:103], v[36:39]
    v_mfma_f32_16x16x32_bf16 v[68:71], v[148:151], v[100:103], v[68:71]
    v_mfma_f32_16x16x32_bf16 v[40:43], v[144:147], v[104:107], v[40:43]
    v_mfma_f32_16x16x32_bf16 v[72:75], v[148:151], v[104:107], v[72:75]
    v_mfma_f32_16x16x32_bf16 v[44:47], v[144:147], v[108:111], v[44:47]
    v_mfma_f32_16x16x32_bf16 v[76:79], v[148:151], v[108:111], v[76:79]
    s_add_u32 s19, s22, 8192
    buffer_load_dwordx4 v[144:147], v7, s[8:11], s19 offen
    s_add_u32 s19, s22, 24576
    buffer_load_dwordx4 v[148:151], v7, s[8:11], s19 offen
    ds_read_b128 v[80:83], v8 offset:512
    ds_read_b128 v[84:87], v8 offset:17152
    ds_read_b128 v[88:91], v8 offset:33792
    ds_read_b128 v[92:95], v8 offset:50432
    ds_read_b128 v[96:99], v9 offset:512
    ds_read_b128 v[100:103], v9 offset:17152
    ds_read_b128 v[104:107], v9 offset:33792
    ds_read_b128 v[108:111], v9 offset:50432
    s_waitcnt vmcnt(2) lgkmcnt(8)
    v_mfma_f32_16x16x32_bf16 v[16:19], v[152:155], v[112:115], v[16:19]
    v_mfma_f32_16x16x32_bf16 v[48:51], v[156:159], v[112:115], v[48:51]
    v_mfma_f32_16x16x32_bf16 v[20:23], v[152:155], v[116:119], v[20:23]
    v_mfma_f32_16x16x32_bf16 v[52:55], v[156:159], v[116:119], v[52:55]
    v_mfma_f32_16x16x32_bf16 v[24:27], v[152:155], v[120:123], v[24:27]
    v_mfma_f32_16x16x32_bf16 v[56:59], v[156:159], v[120:123], v[56:59]
    v_mfma_f32_16x16x32_bf16 v[28:31], v[152:155], v[124:127], v[28:31]
    v_mfma_f32_16x16x32_bf16 v[60:63], v[156:159], v[124:127], v[60:63]
    v_mfma_f32_16x16x32_bf16 v[32:35], v[152:155], v[128:131], v[32:35]
    v_mfma_f32_16x16x32_bf16 v[64:67], v[156:159], v[128:131], v[64:67]
    v_mfma_f32_16x16x32_bf16 v[36:39], v[152:155], v[132:135], v[36:39]
    v_mfma_f32_16x16x32_bf16 v[68:71], v[156:159], v[132:135], v[68:71]
    v_mfma_f32_16x16x32_bf16 v[40:43], v[152:155], v[136:139], v[40:43]
    v_mfma_f32_16x16x32_bf16 v[72:75], v[156:159], v[136:139], v[72:75]
    v_mfma_f32_16x16x32_bf16 v[44:47], v[152:155], v[140:143], v[44:47]
    v_mfma_f32_16x16x32_bf16 v[76:79], v[156:159], v[140:143], v[76:79]
    s_add_u32 s19, s22, 9216
    buffer_load_dwordx4 v[152:155], v7, s[8:11], s19 offen
    s_add_u32 s19, s22, 25600
    buffer_load_dwordx4 v[156:159], v7, s[8:11], s19 offen
    ds_read_b128 v[112:115], v8 offset:576
    ds_read_b128 v[116:119], v8 offset:17216
    ds_read_b128 v[120:123], v8 offset:33856
    ds_read_b128 v[124:127], v8 offset:50496
    ds_read_b128 v[128:131], v9 offset:576
    ds_read_b128 v[132:135], v9 offset:17216
    ds_read_b128 v[136:139], v9 offset:33856
    ds_read_b128 v[140:143], v9 offset:50496
    s_waitcnt vmcnt(2) lgkmcnt(8)
    v_mfma_f32_16x16x32_bf16 v[16:19], v[144:147], v[80:83], v[16:19]
    v_mfma_f32_16x16x32_bf16 v[48:51], v[148:151], v[80:83], v[48:51]
    v_mfma_f32_16x16x32_bf16 v[20:23], v[144:147], v[84:87], v[20:23]
    v_mfma_f32_16x16x32_bf16 v[52:55], v[148:151], v[84:87], v[52:55]
    v_mfma_f32_16x16x32_bf16 v[24:27], v[144:147], v[88:91], v[24:27]
    v_mfma_f32_16x16x32_bf16 v[56:59], v[148:151], v[88:91], v[56:59]
    v_mfma_f32_16x16x32_bf16 v[28:31], v[144:147], v[92:95], v[28:31]
    v_mfma_f32_16x16x32_bf16 v[60:63], v[148:151], v[92:95], v[60:63]
    v_mfma_f32_16x16x32_bf16 v[32:35], v[144:147], v[96:99], v[32:35]
    v_mfma_f32_16x16x32_bf16 v[64:67], v[148:151], v[96:99], v[64:67]
    v_mfma_f32_16x16x32_bf16 v[36:39], v[144:147], v[100:103], v[36:39]
    v_mfma_f32_16x16x32_bf16 v[68:71], v[148:151], v[100:103], v[68:71]
    v_mfma_f32_16x16x32_bf16 v[40:43], v[144:147], v[104:107], v[40:43]
    v_mfma_f32_16x16x32_bf16 v[72:75], v[148:151], v[104:107], v[72:75]
    v_mfma_f32_16x16x32_bf16 v[44:47], v[144:147], v[108:111], v[44:47]
    v_mfma_f32_16x16x32_bf16 v[76:79], v[148:151], v[108:111], v[76:79]
    s_add_u32 s19, s22, 10240
    buffer_load_dwordx4 v[144:147], v7, s[8:11], s19 offen
    s_add_u32 s19, s22, 26624
    buffer_load_dwordx4 v[148:151], v7, s[8:11], s19 offen
    ds_read_b128 v[80:83], v8 offset:640
    ds_read_b128 v[84:87], v8 offset:17280
    ds_read_b128 v[88:91], v8 offset:33920
    ds_read_b128 v[92:95], v8 offset:50560
    ds_read_b128 v[96:99], v9 offset:640
    ds_read_b128 v[100:103], v9 offset:17280
    ds_read_b128 v[104:107], v9 offset:33920
    ds_read_b128 v[108:111], v9 offset:50560
    s_waitcnt vmcnt(2) lgkmcnt(8)
    v_mfma_f32_16x16x32_bf16 v[16:19], v[152:155], v[112:115], v[16:19]
    v_mfma_f32_16x16x32_bf16 v[48:51], v[156:159], v[112:115], v[48:51]
    v_mfma_f32_16x16x32_bf16 v[20:23], v[152:155], v[116:119], v[20:23]
    v_mfma_f32_16x16x32_bf16 v[52:55], v[156:159], v[116:119], v[52:55]
    v_mfma_f32_16x16x32_bf16 v[24:27], v[152:155], v[120:123], v[24:27]
    v_mfma_f32_16x16x32_bf16 v[56:59], v[156:159], v[120:123], v[56:59]
    v_mfma_f32_16x16x32_bf16 v[28:31], v[152:155], v[124:127], v[28:31]
    v_mfma_f32_16x16x32_bf16 v[60:63], v[156:159], v[124:127], v[60:63]
    v_mfma_f32_16x16x32_bf16 v[32:35], v[152:155], v[128:131], v[32:35]
    v_mfma_f32_16x16x32_bf16 v[64:67], v[156:159], v[128:131], v[64:67]
    v_mfma_f32_16x16x32_bf16 v[36:39], v[152:155], v[132:135], v[36:39]
    v_mfma_f32_16x16x32_bf16 v[68:71], v[156:159], v[132:135], v[68:71]
    v_mfma_f32_16x16x32_bf16 v[40:43], v[152:155], v[136:139], v[40:43]
    v_mfma_f32_16x16x32_bf16 v[72:75], v[156:159], v[136:139], v[72:75]
    v_mfma_f32_16x16x32_bf16 v[44:47], v[152:155], v[140:143], v[44:47]
    v_mfma_f32_16x16x32_bf16 v[76:79], v[156:159], v[140:143], v[76:79]
    s_add_u32 s19, s22, 11264
    buffer_load_dwordx4 v[152:155], v7, s[8:11], s19 offen
    s_add_u32 s19, s22, 27648
    buffer_load_dwordx4 v[156:159], v7, s[8:11], s19 offen
    ds_read_b128 v[112:115], v8 offset:704
    ds_read_b128 v[116:119], v8 offset:17344
    ds_read_b128 v[120:123], v8 offset:33984
    ds_read_b128 v[124:127], v8 offset:50624
    ds_read_b128 v[128:131], v9 offset:704
    ds_read_b128 v[132:135], v9 offset:17344
    ds_read_b128 v[136:139], v9 offset:33984
    ds_read_b128 v[140:143], v9 offset:50624
    s_waitcnt vmcnt(2) lgkmcnt(8)
    v_mfma_f32_16x16x32_bf16 v[16:19], v[144:147], v[80:83], v[16:19]
    v_mfma_f32_16x16x32_bf16 v[48:51], v[148:151], v[80:83], v[48:51]
    v_mfma_f32_16x16x32_bf16 v[20:23], v[144:147], v[84:87], v[20:23]
    v_mfma_f32_16x16x32_bf16 v[52:55], v[148:151], v[84:87], v[52:55]
    v_mfma_f32_16x16x32_bf16 v[24:27], v[144:147], v[88:91], v[24:27]
    v_mfma_f32_16x16x32_bf16 v[56:59], v[148:151], v[88:91], v[56:59]
    v_mfma_f32_16x16x32_bf16 v[28:31], v[144:147], v[92:95], v[28:31]
    v_mfma_f32_16x16x32_bf16 v[60:63], v[148:151], v[92:95], v[60:63]
    v_mfma_f32_16x16x32_bf16 v[32:35], v[144:147], v[96:99], v[32:35]
    v_mfma_f32_16x16x32_bf16 v[64:67], v[148:151], v[96:99], v[64:67]
    v_mfma_f32_16x16x32_bf16 v[36:39], v[144:147], v[100:103], v[36:39]
    v_mfma_f32_16x16x32_bf16 v[68:71], v[148:151], v[100:103], v[68:71]
    v_mfma_f32_16x16x32_bf16 v[40:43], v[144:147], v[104:107], v[40:43]
    v_mfma_f32_16x16x32_bf16 v[72:75], v[148:151], v[104:107], v[72:75]
    v_mfma_f32_16x16x32_bf16 v[44:47], v[144:147], v[108:111], v[44:47]
    v_mfma_f32_16x16x32_bf16 v[76:79], v[148:151], v[108:111], v[76:79]
    s_add_u32 s19, s22, 12288
    buffer_load_dwordx4 v[144:147], v7, s[8:11], s19 offen
    s_add_u32 s19, s22, 28672
    buffer_load_dwordx4 v[148:151], v7, s[8:11], s19 offen
    ds_read_b128 v[80:83], v8 offset:768
    ds_read_b128 v[84:87], v8 offset:17408
    ds_read_b128 v[88:91], v8 offset:34048
    ds_read_b128 v[92:95], v8 offset:50688
    ds_read_b128 v[96:99], v9 offset:768
    ds_read_b128 v[100:103], v9 offset:17408
    ds_read_b128 v[104:107], v9 offset:34048
    ds_read_b128 v[108:111], v9 offset:50688
    s_waitcnt vmcnt(2) lgkmcnt(8)
    v_mfma_f32_16x16x32_bf16 v[16:19], v[152:155], v[112:115], v[16:19]
    v_mfma_f32_16x16x32_bf16 v[48:51], v[156:159], v[112:115], v[48:51]
    v_mfma_f32_16x16x32_bf16 v[20:23], v[152:155], v[116:119], v[20:23]
    v_mfma_f32_16x16x32_bf16 v[52:55], v[156:159], v[116:119], v[52:55]
    v_mfma_f32_16x16x32_bf16 v[24:27], v[152:155], v[120:123], v[24:27]
    v_mfma_f32_16x16x32_bf16 v[56:59], v[156:159], v[120:123], v[56:59]
    v_mfma_f32_16x16x32_bf16 v[28:31], v[152:155], v[124:127], v[28:31]
    v_mfma_f32_16x16x32_bf16 v[60:63], v[156:159], v[124:127], v[60:63]
    v_mfma_f32_16x16x32_bf16 v[32:35], v[152:155], v[128:131], v[32:35]
    v_mfma_f32_16x16x32_bf16 v[64:67], v[156:159], v[128:131], v[64:67]
    v_mfma_f32_16x16x32_bf16 v[36:39], v[152:155], v[132:135], v[36:39]
    v_mfma_f32_16x16x32_bf16 v[68:71], v[156:159], v[132:135], v[68:71]
    v_mfma_f32_16x16x32_bf16 v[40:43], v[152:155], v[136:139], v[40:43]
    v_mfma_f32_16x16x32_bf16 v[72:75], v[156:159], v[136:139], v[72:75]
    v_mfma_f32_16x16x32_bf16 v[44:47], v[152:155], v[140:143], v[44:47]
    v_mfma_f32_16x16x32_bf16 v[76:79], v[156:159], v[140:143], v[76:79]
    s_add_u32 s19, s22, 13312
    buffer_load_dwordx4 v[152:155], v7, s[8:11], s19 offen
    s_add_u32 s19, s22, 29696
    buffer_load_dwordx4 v[156:159], v7, s[8:11], s19 offen
    ds_read_b128 v[112:115], v8 offset:832
    ds_read_b128 v[116:119], v8 offset:17472
    ds_read_b128 v[120:123], v8 offset:34112
    ds_read_b128 v[124:127], v8 offset:50752
    ds_read_b128 v[128:131], v9 offset:832
    ds_read_b128 v[132:135], v9 offset:17472
    ds_read_b128 v[136:139], v9 offset:34112
    ds_read_b128 v[140:143], v9 offset:50752
    s_waitcnt vmcnt(2) lgkmcnt(8)
    v_mfma_f32_16x16x32_bf16 v[16:19], v[144:147], v[80:83], v[16:19]
    v_mfma_f32_16x16x32_bf16 v[48:51], v[148:151], v[80:83], v[48:51]
    v_mfma_f32_16x16x32_bf16 v[20:23], v[144:147], v[84:87], v[20:23]
    v_mfma_f32_16x16x32_bf16 v[52:55], v[148:151], v[84:87], v[52:55]
    v_mfma_f32_16x16x32_bf16 v[24:27], v[144:147], v[88:91], v[24:27]
    v_mfma_f32_16x16x32_bf16 v[56:59], v[148:151], v[88:91], v[56:59]
    v_mfma_f32_16x16x32_bf16 v[28:31], v[144:147], v[92:95], v[28:31]
    v_mfma_f32_16x16x32_bf16 v[60:63], v[148:151], v[92:95], v[60:63]
    v_mfma_f32_16x16x32_bf16 v[32:35], v[144:147], v[96:99], v[32:35]
    v_mfma_f32_16x16x32_bf16 v[64:67], v[148:151], v[96:99], v[64:67]
    v_mfma_f32_16x16x32_bf16 v[36:39], v[144:147], v[100:103], v[36:39]
    v_mfma_f32_16x16x32_bf16 v[68:71], v[148:151], v[100:103], v[68:71]
    v_mfma_f32_16x16x32_bf16 v[40:43], v[144:147], v[104:107], v[40:43]
    v_mfma_f32_16x16x32_bf16 v[72:75], v[148:151], v[104:107], v[72:75]
    v_mfma_f32_16x16x32_bf16 v[44:47], v[144:147], v[108:111], v[44:47]
    v_mfma_f32_16x16x32_bf16 v[76:79], v[148:151], v[108:111], v[76:79]
    s_add_u32 s19, s22, 14336
    buffer_load_dwordx4 v[144:147], v7, s[8:11], s19 offen
    s_add_u32 s19, s22, 30720
    buffer_load_dwordx4 v[148:151], v7, s[8:11], s19 offen
    ds_read_b128 v[80:83], v8 offset:896
    ds_read_b128 v[84:87], v8 offset:17536
    ds_read_b128 v[88:91], v8 offset:34176
    ds_read_b128 v[92:95], v8 offset:50816
    ds_read_b128 v[96:99], v9 offset:896
    ds_read_b128 v[100:103], v9 offset:17536
    ds_read_b128 v[104:107], v9 offset:34176
    ds_read_b128 v[108:111], v9 offset:50816
    s_waitcnt vmcnt(2) lgkmcnt(8)
    v_mfma_f32_16x16x32_bf16 v[16:19], v[152:155], v[112:115], v[16:19]
    v_mfma_f32_16x16x32_bf16 v[48:51], v[156:159], v[112:115], v[48:51]
    v_mfma_f32_16x16x32_bf16 v[20:23], v[152:155], v[116:119], v[20:23]
    v_mfma_f32_16x16x32_bf16 v[52:55], v[156:159], v[116:119], v[52:55]
    v_mfma_f32_16x16x32_bf16 v[24:27], v[152:155], v[120:123], v[24:27]
    v_mfma_f32_16x16x32_bf16 v[56:59], v[156:159], v[120:123], v[56:59]
    v_mfma_f32_16x16x32_bf16 v[28:31], v[152:155], v[124:127], v[28:31]
    v_mfma_f32_16x16x32_bf16 v[60:63], v[156:159], v[124:127], v[60:63]
    v_mfma_f32_16x16x32_bf16 v[32:35], v[152:155], v[128:131], v[32:35]
    v_mfma_f32_16x16x32_bf16 v[64:67], v[156:159], v[128:131], v[64:67]
    v_mfma_f32_16x16x32_bf16 v[36:39], v[152:155], v[132:135], v[36:39]
    v_mfma_f32_16x16x32_bf16 v[68:71], v[156:159], v[132:135], v[68:71]
    v_mfma_f32_16x16x32_bf16 v[40:43], v[152:155], v[136:139], v[40:43]
    v_mfma_f32_16x16x32_bf16 v[72:75], v[156:159], v[136:139], v[72:75]
    v_mfma_f32_16x16x32_bf16 v[44:47], v[152:155], v[140:143], v[44:47]
    v_mfma_f32_16x16x32_bf16 v[76:79], v[156:159], v[140:143], v[76:79]
    s_add_u32 s19, s22, 15360
    buffer_load_dwordx4 v[152:155], v7, s[8:11], s19 offen
    s_add_u32 s19, s22, 31744
    buffer_load_dwordx4 v[156:159], v7, s[8:11], s19 offen
    ds_read_b128 v[112:115], v8 offset:960
    ds_read_b128 v[116:119], v8 offset:17600
    ds_read_b128 v[120:123], v8 offset:34240
    ds_read_b128 v[124:127], v8 offset:50880
    ds_read_b128 v[128:131], v9 offset:960
    ds_read_b128 v[132:135], v9 offset:17600
    ds_read_b128 v[136:139], v9 offset:34240
    ds_read_b128 v[140:143], v9 offset:50880
    s_waitcnt vmcnt(2) lgkmcnt(8)
    v_mfma_f32_16x16x32_bf16 v[16:19], v[144:147], v[80:83], v[16:19]
    v_mfma_f32_16x16x32_bf16 v[48:51], v[148:151], v[80:83], v[48:51]
    v_mfma_f32_16x16x32_bf16 v[20:23], v[144:147], v[84:87], v[20:23]
    v_mfma_f32_16x16x32_bf16 v[52:55], v[148:151], v[84:87], v[52:55]
    v_mfma_f32_16x16x32_bf16 v[24:27], v[144:147], v[88:91], v[24:27]
    v_mfma_f32_16x16x32_bf16 v[56:59], v[148:151], v[88:91], v[56:59]
    v_mfma_f32_16x16x32_bf16 v[28:31], v[144:147], v[92:95], v[28:31]
    v_mfma_f32_16x16x32_bf16 v[60:63], v[148:151], v[92:95], v[60:63]
    v_mfma_f32_16x16x32_bf16 v[32:35], v[144:147], v[96:99], v[32:35]
    v_mfma_f32_16x16x32_bf16 v[64:67], v[148:151], v[96:99], v[64:67]
    v_mfma_f32_16x16x32_bf16 v[36:39], v[144:147], v[100:103], v[36:39]
    v_mfma_f32_16x16x32_bf16 v[68:71], v[148:151], v[100:103], v[68:71]
    v_mfma_f32_16x16x32_bf16 v[40:43], v[144:147], v[104:107], v[40:43]
    v_mfma_f32_16x16x32_bf16 v[72:75], v[148:151], v[104:107], v[72:75]
    v_mfma_f32_16x16x32_bf16 v[44:47], v[144:147], v[108:111], v[44:47]
    v_mfma_f32_16x16x32_bf16 v[76:79], v[148:151], v[108:111], v[76:79]
    s_waitcnt vmcnt(0) lgkmcnt(0)
    v_mfma_f32_16x16x32_bf16 v[16:19], v[152:155], v[112:115], v[16:19]
    v_mfma_f32_16x16x32_bf16 v[48:51], v[156:159], v[112:115], v[48:51]
    v_mfma_f32_16x16x32_bf16 v[20:23], v[152:155], v[116:119], v[20:23]
    v_mfma_f32_16x16x32_bf16 v[52:55], v[156:159], v[116:119], v[52:55]
    v_mfma_f32_16x16x32_bf16 v[24:27], v[152:155], v[120:123], v[24:27]
    v_mfma_f32_16x16x32_bf16 v[56:59], v[156:159], v[120:123], v[56:59]
    v_mfma_f32_16x16x32_bf16 v[28:31], v[152:155], v[124:127], v[28:31]
    v_mfma_f32_16x16x32_bf16 v[60:63], v[156:159], v[124:127], v[60:63]
    v_mfma_f32_16x16x32_bf16 v[32:35], v[152:155], v[128:131], v[32:35]
    v_mfma_f32_16x16x32_bf16 v[64:67], v[156:159], v[128:131], v[64:67]
    v_mfma_f32_16x16x32_bf16 v[36:39], v[152:155], v[132:135], v[36:39]
    v_mfma_f32_16x16x32_bf16 v[68:71], v[156:159], v[132:135], v[68:71]
    v_mfma_f32_16x16x32_bf16 v[40:43], v[152:155], v[136:139], v[40:43]
    v_mfma_f32_16x16x32_bf16 v[72:75], v[156:159], v[136:139], v[72:75]
    v_mfma_f32_16x16x32_bf16 v[44:47], v[152:155], v[140:143], v[44:47]
    v_mfma_f32_16x16x32_bf16 v[76:79], v[156:159], v[140:143], v[76:79]
    s_nop 7
    s_lshl_b32 s23, s3, 2
    s_lshl_b32 s23, s23, 5
    s_add_u32 s23, s23, s6
    s_lshl_b32 s23, s23, 13
    s_lshl_b32 s19, s16, 11
    s_add_u32 s23, s23, s19
    s_add_u32 s23, s23, 176160768
    v_cvt_pk_bf16_f32 v80, v16, v17
    v_cvt_pk_bf16_f32 v81, v18, v19
    v_cvt_pk_bf16_f32 v82, v48, v49
    v_cvt_pk_bf16_f32 v83, v50, v51
    s_add_u32 s19, s23, 0
    buffer_store_dwordx4 v[80:83], v7, s[8:11], s19 offen sc1
    s_nop 1
    v_cvt_pk_bf16_f32 v84, v20, v21
    v_cvt_pk_bf16_f32 v85, v22, v23
    v_cvt_pk_bf16_f32 v86, v52, v53
    v_cvt_pk_bf16_f32 v87, v54, v55
    s_add_u32 s19, s23, 1024
    buffer_store_dwordx4 v[84:87], v7, s[8:11], s19 offen sc1
    s_nop 1
    v_cvt_pk_bf16_f32 v80, v24, v25
    v_cvt_pk_bf16_f32 v81, v26, v27
    v_cvt_pk_bf16_f32 v82, v56, v57
    v_cvt_pk_bf16_f32 v83, v58, v59
    s_add_u32 s19, s23, 262144
    buffer_store_dwordx4 v[80:83], v7, s[8:11], s19 offen sc1
    s_nop 1
    v_cvt_pk_bf16_f32 v84, v28, v29
    v_cvt_pk_bf16_f32 v85, v30, v31
    v_cvt_pk_bf16_f32 v86, v60, v61
    v_cvt_pk_bf16_f32 v87, v62, v63
    s_add_u32 s19, s23, 263168
    buffer_store_dwordx4 v[84:87], v7, s[8:11], s19 offen sc1
    s_nop 1
    v_cvt_pk_bf16_f32 v80, v32, v33
    v_cvt_pk_bf16_f32 v81, v34, v35
    v_cvt_pk_bf16_f32 v82, v64, v65
    v_cvt_pk_bf16_f32 v83, v66, v67
    s_add_u32 s19, s23, 524288
    buffer_store_dwordx4 v[80:83], v7, s[8:11], s19 offen sc1
    s_nop 1
    v_cvt_pk_bf16_f32 v84, v36, v37
    v_cvt_pk_bf16_f32 v85, v38, v39
    v_cvt_pk_bf16_f32 v86, v68, v69
    v_cvt_pk_bf16_f32 v87, v70, v71
    s_add_u32 s19, s23, 525312
    buffer_store_dwordx4 v[84:87], v7, s[8:11], s19 offen sc1
    s_nop 1
    v_cvt_pk_bf16_f32 v80, v40, v41
    v_cvt_pk_bf16_f32 v81, v42, v43
    v_cvt_pk_bf16_f32 v82, v72, v73
    v_cvt_pk_bf16_f32 v83, v74, v75
    s_add_u32 s19, s23, 786432
    buffer_store_dwordx4 v[80:83], v7, s[8:11], s19 offen sc1
    s_nop 1
    v_cvt_pk_bf16_f32 v84, v44, v45
    v_cvt_pk_bf16_f32 v85, v46, v47
    v_cvt_pk_bf16_f32 v86, v76, v77
    v_cvt_pk_bf16_f32 v87, v78, v79
    s_add_u32 s19, s23, 787456
    buffer_store_dwordx4 v[84:87], v7, s[8:11], s19 offen sc1
    s_nop 1
    s_lshl_b32 s6, s26, 1
    s_add_u32 s6, s6, 1
    s_lshl_b32 s22, s6, 17
    s_lshl_b32 s19, s16, 15
    s_add_u32 s22, s22, s19
    s_add_u32 s22, s22, 4194304
    s_add_u32 s19, s22, 0
    buffer_load_dwordx4 v[144:147], v7, s[8:11], s19 offen
    s_add_u32 s19, s22, 16384
    buffer_load_dwordx4 v[148:151], v7, s[8:11], s19 offen
    ds_read_b128 v[80:83], v8 offset:0
    ds_read_b128 v[84:87], v8 offset:16640
    ds_read_b128 v[88:91], v8 offset:33280
    ds_read_b128 v[92:95], v8 offset:49920
    ds_read_b128 v[96:99], v9 offset:0
    ds_read_b128 v[100:103], v9 offset:16640
    ds_read_b128 v[104:107], v9 offset:33280
    ds_read_b128 v[108:111], v9 offset:49920
    s_add_u32 s19, s22, 1024
    buffer_load_dwordx4 v[152:155], v7, s[8:11], s19 offen
    s_add_u32 s19, s22, 17408
    buffer_load_dwordx4 v[156:159], v7, s[8:11], s19 offen
    ds_read_b128 v[112:115], v8 offset:64
    ds_read_b128 v[116:119], v8 offset:16704
    ds_read_b128 v[120:123], v8 offset:33344
    ds_read_b128 v[124:127], v8 offset:49984
    ds_read_b128 v[128:131], v9 offset:64
    ds_read_b128 v[132:135], v9 offset:16704
    ds_read_b128 v[136:139], v9 offset:33344
    ds_read_b128 v[140:143], v9 offset:49984
    s_waitcnt vmcnt(2) lgkmcnt(8)
    v_mfma_f32_16x16x32_bf16 v[16:19], v[144:147], v[80:83], 0
    v_mfma_f32_16x16x32_bf16 v[48:51], v[148:151], v[80:83], 0
    v_mfma_f32_16x16x32_bf16 v[20:23], v[144:147], v[84:87], 0
    v_mfma_f32_16x16x32_bf16 v[52:55], v[148:151], v[84:87], 0
    v_mfma_f32_16x16x32_bf16 v[24:27], v[144:147], v[88:91], 0
    v_mfma_f32_16x16x32_bf16 v[56:59], v[148:151], v[88:91], 0
    v_mfma_f32_16x16x32_bf16 v[28:31], v[144:147], v[92:95], 0
    v_mfma_f32_16x16x32_bf16 v[60:63], v[148:151], v[92:95], 0
    v_mfma_f32_16x16x32_bf16 v[32:35], v[144:147], v[96:99], 0
    v_mfma_f32_16x16x32_bf16 v[64:67], v[148:151], v[96:99], 0
    v_mfma_f32_16x16x32_bf16 v[36:39], v[144:147], v[100:103], 0
    v_mfma_f32_16x16x32_bf16 v[68:71], v[148:151], v[100:103], 0
    v_mfma_f32_16x16x32_bf16 v[40:43], v[144:147], v[104:107], 0
    v_mfma_f32_16x16x32_bf16 v[72:75], v[148:151], v[104:107], 0
    v_mfma_f32_16x16x32_bf16 v[44:47], v[144:147], v[108:111], 0
    v_mfma_f32_16x16x32_bf16 v[76:79], v[148:151], v[108:111], 0
    s_add_u32 s19, s22, 2048
    buffer_load_dwordx4 v[144:147], v7, s[8:11], s19 offen
    s_add_u32 s19, s22, 18432
    buffer_load_dwordx4 v[148:151], v7, s[8:11], s19 offen
    ds_read_b128 v[80:83], v8 offset:128
    ds_read_b128 v[84:87], v8 offset:16768
    ds_read_b128 v[88:91], v8 offset:33408
    ds_read_b128 v[92:95], v8 offset:50048
    ds_read_b128 v[96:99], v9 offset:128
    ds_read_b128 v[100:103], v9 offset:16768
    ds_read_b128 v[104:107], v9 offset:33408
    ds_read_b128 v[108:111], v9 offset:50048
    s_waitcnt vmcnt(2) lgkmcnt(8)
    v_mfma_f32_16x16x32_bf16 v[16:19], v[152:155], v[112:115], v[16:19]
    v_mfma_f32_16x16x32_bf16 v[48:51], v[156:159], v[112:115], v[48:51]
    v_mfma_f32_16x16x32_bf16 v[20:23], v[152:155], v[116:119], v[20:23]
    v_mfma_f32_16x16x32_bf16 v[52:55], v[156:159], v[116:119], v[52:55]
    v_mfma_f32_16x16x32_bf16 v[24:27], v[152:155], v[120:123], v[24:27]
    v_mfma_f32_16x16x32_bf16 v[56:59], v[156:159], v[120:123], v[56:59]
    v_mfma_f32_16x16x32_bf16 v[28:31], v[152:155], v[124:127], v[28:31]
    v_mfma_f32_16x16x32_bf16 v[60:63], v[156:159], v[124:127], v[60:63]
    v_mfma_f32_16x16x32_bf16 v[32:35], v[152:155], v[128:131], v[32:35]
    v_mfma_f32_16x16x32_bf16 v[64:67], v[156:159], v[128:131], v[64:67]
    v_mfma_f32_16x16x32_bf16 v[36:39], v[152:155], v[132:135], v[36:39]
    v_mfma_f32_16x16x32_bf16 v[68:71], v[156:159], v[132:135], v[68:71]
    v_mfma_f32_16x16x32_bf16 v[40:43], v[152:155], v[136:139], v[40:43]
    v_mfma_f32_16x16x32_bf16 v[72:75], v[156:159], v[136:139], v[72:75]
    v_mfma_f32_16x16x32_bf16 v[44:47], v[152:155], v[140:143], v[44:47]
    v_mfma_f32_16x16x32_bf16 v[76:79], v[156:159], v[140:143], v[76:79]
    s_add_u32 s19, s22, 3072
    buffer_load_dwordx4 v[152:155], v7, s[8:11], s19 offen
    s_add_u32 s19, s22, 19456
    buffer_load_dwordx4 v[156:159], v7, s[8:11], s19 offen
    ds_read_b128 v[112:115], v8 offset:192
    ds_read_b128 v[116:119], v8 offset:16832
    ds_read_b128 v[120:123], v8 offset:33472
    ds_read_b128 v[124:127], v8 offset:50112
    ds_read_b128 v[128:131], v9 offset:192
    ds_read_b128 v[132:135], v9 offset:16832
    ds_read_b128 v[136:139], v9 offset:33472
    ds_read_b128 v[140:143], v9 offset:50112
    s_waitcnt vmcnt(2) lgkmcnt(8)
    v_mfma_f32_16x16x32_bf16 v[16:19], v[144:147], v[80:83], v[16:19]
    v_mfma_f32_16x16x32_bf16 v[48:51], v[148:151], v[80:83], v[48:51]
    v_mfma_f32_16x16x32_bf16 v[20:23], v[144:147], v[84:87], v[20:23]
    v_mfma_f32_16x16x32_bf16 v[52:55], v[148:151], v[84:87], v[52:55]
    v_mfma_f32_16x16x32_bf16 v[24:27], v[144:147], v[88:91], v[24:27]
    v_mfma_f32_16x16x32_bf16 v[56:59], v[148:151], v[88:91], v[56:59]
    v_mfma_f32_16x16x32_bf16 v[28:31], v[144:147], v[92:95], v[28:31]
    v_mfma_f32_16x16x32_bf16 v[60:63], v[148:151], v[92:95], v[60:63]
    v_mfma_f32_16x16x32_bf16 v[32:35], v[144:147], v[96:99], v[32:35]
    v_mfma_f32_16x16x32_bf16 v[64:67], v[148:151], v[96:99], v[64:67]
    v_mfma_f32_16x16x32_bf16 v[36:39], v[144:147], v[100:103], v[36:39]
    v_mfma_f32_16x16x32_bf16 v[68:71], v[148:151], v[100:103], v[68:71]
    v_mfma_f32_16x16x32_bf16 v[40:43], v[144:147], v[104:107], v[40:43]
    v_mfma_f32_16x16x32_bf16 v[72:75], v[148:151], v[104:107], v[72:75]
    v_mfma_f32_16x16x32_bf16 v[44:47], v[144:147], v[108:111], v[44:47]
    v_mfma_f32_16x16x32_bf16 v[76:79], v[148:151], v[108:111], v[76:79]
    s_add_u32 s19, s22, 4096
    buffer_load_dwordx4 v[144:147], v7, s[8:11], s19 offen
    s_add_u32 s19, s22, 20480
    buffer_load_dwordx4 v[148:151], v7, s[8:11], s19 offen
    ds_read_b128 v[80:83], v8 offset:256
    ds_read_b128 v[84:87], v8 offset:16896
    ds_read_b128 v[88:91], v8 offset:33536
    ds_read_b128 v[92:95], v8 offset:50176
    ds_read_b128 v[96:99], v9 offset:256
    ds_read_b128 v[100:103], v9 offset:16896
    ds_read_b128 v[104:107], v9 offset:33536
    ds_read_b128 v[108:111], v9 offset:50176
    s_waitcnt vmcnt(2) lgkmcnt(8)
    v_mfma_f32_16x16x32_bf16 v[16:19], v[152:155], v[112:115], v[16:19]
    v_mfma_f32_16x16x32_bf16 v[48:51], v[156:159], v[112:115], v[48:51]
    v_mfma_f32_16x16x32_bf16 v[20:23], v[152:155], v[116:119], v[20:23]
    v_mfma_f32_16x16x32_bf16 v[52:55], v[156:159], v[116:119], v[52:55]
    v_mfma_f32_16x16x32_bf16 v[24:27], v[152:155], v[120:123], v[24:27]
    v_mfma_f32_16x16x32_bf16 v[56:59], v[156:159], v[120:123], v[56:59]
    v_mfma_f32_16x16x32_bf16 v[28:31], v[152:155], v[124:127], v[28:31]
    v_mfma_f32_16x16x32_bf16 v[60:63], v[156:159], v[124:127], v[60:63]
    v_mfma_f32_16x16x32_bf16 v[32:35], v[152:155], v[128:131], v[32:35]
    v_mfma_f32_16x16x32_bf16 v[64:67], v[156:159], v[128:131], v[64:67]
    v_mfma_f32_16x16x32_bf16 v[36:39], v[152:155], v[132:135], v[36:39]
    v_mfma_f32_16x16x32_bf16 v[68:71], v[156:159], v[132:135], v[68:71]
    v_mfma_f32_16x16x32_bf16 v[40:43], v[152:155], v[136:139], v[40:43]
    v_mfma_f32_16x16x32_bf16 v[72:75], v[156:159], v[136:139], v[72:75]
    v_mfma_f32_16x16x32_bf16 v[44:47], v[152:155], v[140:143], v[44:47]
    v_mfma_f32_16x16x32_bf16 v[76:79], v[156:159], v[140:143], v[76:79]
    s_add_u32 s19, s22, 5120
    buffer_load_dwordx4 v[152:155], v7, s[8:11], s19 offen
    s_add_u32 s19, s22, 21504
    buffer_load_dwordx4 v[156:159], v7, s[8:11], s19 offen
    ds_read_b128 v[112:115], v8 offset:320
    ds_read_b128 v[116:119], v8 offset:16960
    ds_read_b128 v[120:123], v8 offset:33600
    ds_read_b128 v[124:127], v8 offset:50240
    ds_read_b128 v[128:131], v9 offset:320
    ds_read_b128 v[132:135], v9 offset:16960
    ds_read_b128 v[136:139], v9 offset:33600
    ds_read_b128 v[140:143], v9 offset:50240
    s_waitcnt vmcnt(2) lgkmcnt(8)
    v_mfma_f32_16x16x32_bf16 v[16:19], v[144:147], v[80:83], v[16:19]
    v_mfma_f32_16x16x32_bf16 v[48:51], v[148:151], v[80:83], v[48:51]
    v_mfma_f32_16x16x32_bf16 v[20:23], v[144:147], v[84:87], v[20:23]
    v_mfma_f32_16x16x32_bf16 v[52:55], v[148:151], v[84:87], v[52:55]
    v_mfma_f32_16x16x32_bf16 v[24:27], v[144:147], v[88:91], v[24:27]
    v_mfma_f32_16x16x32_bf16 v[56:59], v[148:151], v[88:91], v[56:59]
    v_mfma_f32_16x16x32_bf16 v[28:31], v[144:147], v[92:95], v[28:31]
    v_mfma_f32_16x16x32_bf16 v[60:63], v[148:151], v[92:95], v[60:63]
    v_mfma_f32_16x16x32_bf16 v[32:35], v[144:147], v[96:99], v[32:35]
    v_mfma_f32_16x16x32_bf16 v[64:67], v[148:151], v[96:99], v[64:67]
    v_mfma_f32_16x16x32_bf16 v[36:39], v[144:147], v[100:103], v[36:39]
    v_mfma_f32_16x16x32_bf16 v[68:71], v[148:151], v[100:103], v[68:71]
    v_mfma_f32_16x16x32_bf16 v[40:43], v[144:147], v[104:107], v[40:43]
    v_mfma_f32_16x16x32_bf16 v[72:75], v[148:151], v[104:107], v[72:75]
    v_mfma_f32_16x16x32_bf16 v[44:47], v[144:147], v[108:111], v[44:47]
    v_mfma_f32_16x16x32_bf16 v[76:79], v[148:151], v[108:111], v[76:79]
    s_add_u32 s19, s22, 6144
    buffer_load_dwordx4 v[144:147], v7, s[8:11], s19 offen
    s_add_u32 s19, s22, 22528
    buffer_load_dwordx4 v[148:151], v7, s[8:11], s19 offen
    ds_read_b128 v[80:83], v8 offset:384
    ds_read_b128 v[84:87], v8 offset:17024
    ds_read_b128 v[88:91], v8 offset:33664
    ds_read_b128 v[92:95], v8 offset:50304
    ds_read_b128 v[96:99], v9 offset:384
    ds_read_b128 v[100:103], v9 offset:17024
    ds_read_b128 v[104:107], v9 offset:33664
    ds_read_b128 v[108:111], v9 offset:50304
    s_waitcnt vmcnt(2) lgkmcnt(8)
    v_mfma_f32_16x16x32_bf16 v[16:19], v[152:155], v[112:115], v[16:19]
    v_mfma_f32_16x16x32_bf16 v[48:51], v[156:159], v[112:115], v[48:51]
    v_mfma_f32_16x16x32_bf16 v[20:23], v[152:155], v[116:119], v[20:23]
    v_mfma_f32_16x16x32_bf16 v[52:55], v[156:159], v[116:119], v[52:55]
    v_mfma_f32_16x16x32_bf16 v[24:27], v[152:155], v[120:123], v[24:27]
    v_mfma_f32_16x16x32_bf16 v[56:59], v[156:159], v[120:123], v[56:59]
    v_mfma_f32_16x16x32_bf16 v[28:31], v[152:155], v[124:127], v[28:31]
    v_mfma_f32_16x16x32_bf16 v[60:63], v[156:159], v[124:127], v[60:63]
    v_mfma_f32_16x16x32_bf16 v[32:35], v[152:155], v[128:131], v[32:35]
    v_mfma_f32_16x16x32_bf16 v[64:67], v[156:159], v[128:131], v[64:67]
    v_mfma_f32_16x16x32_bf16 v[36:39], v[152:155], v[132:135], v[36:39]
    v_mfma_f32_16x16x32_bf16 v[68:71], v[156:159], v[132:135], v[68:71]
    v_mfma_f32_16x16x32_bf16 v[40:43], v[152:155], v[136:139], v[40:43]
    v_mfma_f32_16x16x32_bf16 v[72:75], v[156:159], v[136:139], v[72:75]
    v_mfma_f32_16x16x32_bf16 v[44:47], v[152:155], v[140:143], v[44:47]
    v_mfma_f32_16x16x32_bf16 v[76:79], v[156:159], v[140:143], v[76:79]
    s_add_u32 s19, s22, 7168
    buffer_load_dwordx4 v[152:155], v7, s[8:11], s19 offen
    s_add_u32 s19, s22, 23552
    buffer_load_dwordx4 v[156:159], v7, s[8:11], s19 offen
    ds_read_b128 v[112:115], v8 offset:448
    ds_read_b128 v[116:119], v8 offset:17088
    ds_read_b128 v[120:123], v8 offset:33728
    ds_read_b128 v[124:127], v8 offset:50368
    ds_read_b128 v[128:131], v9 offset:448
    ds_read_b128 v[132:135], v9 offset:17088
    ds_read_b128 v[136:139], v9 offset:33728
    ds_read_b128 v[140:143], v9 offset:50368
    s_waitcnt vmcnt(2) lgkmcnt(8)
    v_mfma_f32_16x16x32_bf16 v[16:19], v[144:147], v[80:83], v[16:19]
    v_mfma_f32_16x16x32_bf16 v[48:51], v[148:151], v[80:83], v[48:51]
    v_mfma_f32_16x16x32_bf16 v[20:23], v[144:147], v[84:87], v[20:23]
    v_mfma_f32_16x16x32_bf16 v[52:55], v[148:151], v[84:87], v[52:55]
    v_mfma_f32_16x16x32_bf16 v[24:27], v[144:147], v[88:91], v[24:27]
    v_mfma_f32_16x16x32_bf16 v[56:59], v[148:151], v[88:91], v[56:59]
    v_mfma_f32_16x16x32_bf16 v[28:31], v[144:147], v[92:95], v[28:31]
    v_mfma_f32_16x16x32_bf16 v[60:63], v[148:151], v[92:95], v[60:63]
    v_mfma_f32_16x16x32_bf16 v[32:35], v[144:147], v[96:99], v[32:35]
    v_mfma_f32_16x16x32_bf16 v[64:67], v[148:151], v[96:99], v[64:67]
    v_mfma_f32_16x16x32_bf16 v[36:39], v[144:147], v[100:103], v[36:39]
    v_mfma_f32_16x16x32_bf16 v[68:71], v[148:151], v[100:103], v[68:71]
    v_mfma_f32_16x16x32_bf16 v[40:43], v[144:147], v[104:107], v[40:43]
    v_mfma_f32_16x16x32_bf16 v[72:75], v[148:151], v[104:107], v[72:75]
    v_mfma_f32_16x16x32_bf16 v[44:47], v[144:147], v[108:111], v[44:47]
    v_mfma_f32_16x16x32_bf16 v[76:79], v[148:151], v[108:111], v[76:79]
    s_add_u32 s19, s22, 8192
    buffer_load_dwordx4 v[144:147], v7, s[8:11], s19 offen
    s_add_u32 s19, s22, 24576
    buffer_load_dwordx4 v[148:151], v7, s[8:11], s19 offen
    ds_read_b128 v[80:83], v8 offset:512
    ds_read_b128 v[84:87], v8 offset:17152
    ds_read_b128 v[88:91], v8 offset:33792
    ds_read_b128 v[92:95], v8 offset:50432
    ds_read_b128 v[96:99], v9 offset:512
    ds_read_b128 v[100:103], v9 offset:17152
    ds_read_b128 v[104:107], v9 offset:33792
    ds_read_b128 v[108:111], v9 offset:50432
    s_waitcnt vmcnt(2) lgkmcnt(8)
    v_mfma_f32_16x16x32_bf16 v[16:19], v[152:155], v[112:115], v[16:19]
    v_mfma_f32_16x16x32_bf16 v[48:51], v[156:159], v[112:115], v[48:51]
    v_mfma_f32_16x16x32_bf16 v[20:23], v[152:155], v[116:119], v[20:23]
    v_mfma_f32_16x16x32_bf16 v[52:55], v[156:159], v[116:119], v[52:55]
    v_mfma_f32_16x16x32_bf16 v[24:27], v[152:155], v[120:123], v[24:27]
    v_mfma_f32_16x16x32_bf16 v[56:59], v[156:159], v[120:123], v[56:59]
    v_mfma_f32_16x16x32_bf16 v[28:31], v[152:155], v[124:127], v[28:31]
    v_mfma_f32_16x16x32_bf16 v[60:63], v[156:159], v[124:127], v[60:63]
    v_mfma_f32_16x16x32_bf16 v[32:35], v[152:155], v[128:131], v[32:35]
    v_mfma_f32_16x16x32_bf16 v[64:67], v[156:159], v[128:131], v[64:67]
    v_mfma_f32_16x16x32_bf16 v[36:39], v[152:155], v[132:135], v[36:39]
    v_mfma_f32_16x16x32_bf16 v[68:71], v[156:159], v[132:135], v[68:71]
    v_mfma_f32_16x16x32_bf16 v[40:43], v[152:155], v[136:139], v[40:43]
    v_mfma_f32_16x16x32_bf16 v[72:75], v[156:159], v[136:139], v[72:75]
    v_mfma_f32_16x16x32_bf16 v[44:47], v[152:155], v[140:143], v[44:47]
    v_mfma_f32_16x16x32_bf16 v[76:79], v[156:159], v[140:143], v[76:79]
    s_add_u32 s19, s22, 9216
    buffer_load_dwordx4 v[152:155], v7, s[8:11], s19 offen
    s_add_u32 s19, s22, 25600
    buffer_load_dwordx4 v[156:159], v7, s[8:11], s19 offen
    ds_read_b128 v[112:115], v8 offset:576
    ds_read_b128 v[116:119], v8 offset:17216
    ds_read_b128 v[120:123], v8 offset:33856
    ds_read_b128 v[124:127], v8 offset:50496
    ds_read_b128 v[128:131], v9 offset:576
    ds_read_b128 v[132:135], v9 offset:17216
    ds_read_b128 v[136:139], v9 offset:33856
    ds_read_b128 v[140:143], v9 offset:50496
    s_waitcnt vmcnt(2) lgkmcnt(8)
    v_mfma_f32_16x16x32_bf16 v[16:19], v[144:147], v[80:83], v[16:19]
    v_mfma_f32_16x16x32_bf16 v[48:51], v[148:151], v[80:83], v[48:51]
    v_mfma_f32_16x16x32_bf16 v[20:23], v[144:147], v[84:87], v[20:23]
    v_mfma_f32_16x16x32_bf16 v[52:55], v[148:151], v[84:87], v[52:55]
    v_mfma_f32_16x16x32_bf16 v[24:27], v[144:147], v[88:91], v[24:27]
    v_mfma_f32_16x16x32_bf16 v[56:59], v[148:151], v[88:91], v[56:59]
    v_mfma_f32_16x16x32_bf16 v[28:31], v[144:147], v[92:95], v[28:31]
    v_mfma_f32_16x16x32_bf16 v[60:63], v[148:151], v[92:95], v[60:63]
    v_mfma_f32_16x16x32_bf16 v[32:35], v[144:147], v[96:99], v[32:35]
    v_mfma_f32_16x16x32_bf16 v[64:67], v[148:151], v[96:99], v[64:67]
    v_mfma_f32_16x16x32_bf16 v[36:39], v[144:147], v[100:103], v[36:39]
    v_mfma_f32_16x16x32_bf16 v[68:71], v[148:151], v[100:103], v[68:71]
    v_mfma_f32_16x16x32_bf16 v[40:43], v[144:147], v[104:107], v[40:43]
    v_mfma_f32_16x16x32_bf16 v[72:75], v[148:151], v[104:107], v[72:75]
    v_mfma_f32_16x16x32_bf16 v[44:47], v[144:147], v[108:111], v[44:47]
    v_mfma_f32_16x16x32_bf16 v[76:79], v[148:151], v[108:111], v[76:79]
    s_add_u32 s19, s22, 10240
    buffer_load_dwordx4 v[144:147], v7, s[8:11], s19 offen
    s_add_u32 s19, s22, 26624
    buffer_load_dwordx4 v[148:151], v7, s[8:11], s19 offen
    ds_read_b128 v[80:83], v8 offset:640
    ds_read_b128 v[84:87], v8 offset:17280
    ds_read_b128 v[88:91], v8 offset:33920
    ds_read_b128 v[92:95], v8 offset:50560
    ds_read_b128 v[96:99], v9 offset:640
    ds_read_b128 v[100:103], v9 offset:17280
    ds_read_b128 v[104:107], v9 offset:33920
    ds_read_b128 v[108:111], v9 offset:50560
    s_waitcnt vmcnt(2) lgkmcnt(8)
    v_mfma_f32_16x16x32_bf16 v[16:19], v[152:155], v[112:115], v[16:19]
    v_mfma_f32_16x16x32_bf16 v[48:51], v[156:159], v[112:115], v[48:51]
    v_mfma_f32_16x16x32_bf16 v[20:23], v[152:155], v[116:119], v[20:23]
    v_mfma_f32_16x16x32_bf16 v[52:55], v[156:159], v[116:119], v[52:55]
    v_mfma_f32_16x16x32_bf16 v[24:27], v[152:155], v[120:123], v[24:27]
    v_mfma_f32_16x16x32_bf16 v[56:59], v[156:159], v[120:123], v[56:59]
    v_mfma_f32_16x16x32_bf16 v[28:31], v[152:155], v[124:127], v[28:31]
    v_mfma_f32_16x16x32_bf16 v[60:63], v[156:159], v[124:127], v[60:63]
    v_mfma_f32_16x16x32_bf16 v[32:35], v[152:155], v[128:131], v[32:35]
    v_mfma_f32_16x16x32_bf16 v[64:67], v[156:159], v[128:131], v[64:67]
    v_mfma_f32_16x16x32_bf16 v[36:39], v[152:155], v[132:135], v[36:39]
    v_mfma_f32_16x16x32_bf16 v[68:71], v[156:159], v[132:135], v[68:71]
    v_mfma_f32_16x16x32_bf16 v[40:43], v[152:155], v[136:139], v[40:43]
    v_mfma_f32_16x16x32_bf16 v[72:75], v[156:159], v[136:139], v[72:75]
    v_mfma_f32_16x16x32_bf16 v[44:47], v[152:155], v[140:143], v[44:47]
    v_mfma_f32_16x16x32_bf16 v[76:79], v[156:159], v[140:143], v[76:79]
    s_add_u32 s19, s22, 11264
    buffer_load_dwordx4 v[152:155], v7, s[8:11], s19 offen
    s_add_u32 s19, s22, 27648
    buffer_load_dwordx4 v[156:159], v7, s[8:11], s19 offen
    ds_read_b128 v[112:115], v8 offset:704
    ds_read_b128 v[116:119], v8 offset:17344
    ds_read_b128 v[120:123], v8 offset:33984
    ds_read_b128 v[124:127], v8 offset:50624
    ds_read_b128 v[128:131], v9 offset:704
    ds_read_b128 v[132:135], v9 offset:17344
    ds_read_b128 v[136:139], v9 offset:33984
    ds_read_b128 v[140:143], v9 offset:50624
    s_waitcnt vmcnt(2) lgkmcnt(8)
    v_mfma_f32_16x16x32_bf16 v[16:19], v[144:147], v[80:83], v[16:19]
    v_mfma_f32_16x16x32_bf16 v[48:51], v[148:151], v[80:83], v[48:51]
    v_mfma_f32_16x16x32_bf16 v[20:23], v[144:147], v[84:87], v[20:23]
    v_mfma_f32_16x16x32_bf16 v[52:55], v[148:151], v[84:87], v[52:55]
    v_mfma_f32_16x16x32_bf16 v[24:27], v[144:147], v[88:91], v[24:27]
    v_mfma_f32_16x16x32_bf16 v[56:59], v[148:151], v[88:91], v[56:59]
    v_mfma_f32_16x16x32_bf16 v[28:31], v[144:147], v[92:95], v[28:31]
    v_mfma_f32_16x16x32_bf16 v[60:63], v[148:151], v[92:95], v[60:63]
    v_mfma_f32_16x16x32_bf16 v[32:35], v[144:147], v[96:99], v[32:35]
    v_mfma_f32_16x16x32_bf16 v[64:67], v[148:151], v[96:99], v[64:67]
    v_mfma_f32_16x16x32_bf16 v[36:39], v[144:147], v[100:103], v[36:39]
    v_mfma_f32_16x16x32_bf16 v[68:71], v[148:151], v[100:103], v[68:71]
    v_mfma_f32_16x16x32_bf16 v[40:43], v[144:147], v[104:107], v[40:43]
    v_mfma_f32_16x16x32_bf16 v[72:75], v[148:151], v[104:107], v[72:75]
    v_mfma_f32_16x16x32_bf16 v[44:47], v[144:147], v[108:111], v[44:47]
    v_mfma_f32_16x16x32_bf16 v[76:79], v[148:151], v[108:111], v[76:79]
    s_add_u32 s19, s22, 12288
    buffer_load_dwordx4 v[144:147], v7, s[8:11], s19 offen
    s_add_u32 s19, s22, 28672
    buffer_load_dwordx4 v[148:151], v7, s[8:11], s19 offen
    ds_read_b128 v[80:83], v8 offset:768
    ds_read_b128 v[84:87], v8 offset:17408
    ds_read_b128 v[88:91], v8 offset:34048
    ds_read_b128 v[92:95], v8 offset:50688
    ds_read_b128 v[96:99], v9 offset:768
    ds_read_b128 v[100:103], v9 offset:17408
    ds_read_b128 v[104:107], v9 offset:34048
    ds_read_b128 v[108:111], v9 offset:50688
    s_waitcnt vmcnt(2) lgkmcnt(8)
    v_mfma_f32_16x16x32_bf16 v[16:19], v[152:155], v[112:115], v[16:19]
    v_mfma_f32_16x16x32_bf16 v[48:51], v[156:159], v[112:115], v[48:51]
    v_mfma_f32_16x16x32_bf16 v[20:23], v[152:155], v[116:119], v[20:23]
    v_mfma_f32_16x16x32_bf16 v[52:55], v[156:159], v[116:119], v[52:55]
    v_mfma_f32_16x16x32_bf16 v[24:27], v[152:155], v[120:123], v[24:27]
    v_mfma_f32_16x16x32_bf16 v[56:59], v[156:159], v[120:123], v[56:59]
    v_mfma_f32_16x16x32_bf16 v[28:31], v[152:155], v[124:127], v[28:31]
    v_mfma_f32_16x16x32_bf16 v[60:63], v[156:159], v[124:127], v[60:63]
    v_mfma_f32_16x16x32_bf16 v[32:35], v[152:155], v[128:131], v[32:35]
    v_mfma_f32_16x16x32_bf16 v[64:67], v[156:159], v[128:131], v[64:67]
    v_mfma_f32_16x16x32_bf16 v[36:39], v[152:155], v[132:135], v[36:39]
    v_mfma_f32_16x16x32_bf16 v[68:71], v[156:159], v[132:135], v[68:71]
    v_mfma_f32_16x16x32_bf16 v[40:43], v[152:155], v[136:139], v[40:43]
    v_mfma_f32_16x16x32_bf16 v[72:75], v[156:159], v[136:139], v[72:75]
    v_mfma_f32_16x16x32_bf16 v[44:47], v[152:155], v[140:143], v[44:47]
    v_mfma_f32_16x16x32_bf16 v[76:79], v[156:159], v[140:143], v[76:79]
    s_add_u32 s19, s22, 13312
    buffer_load_dwordx4 v[152:155], v7, s[8:11], s19 offen
    s_add_u32 s19, s22, 29696
    buffer_load_dwordx4 v[156:159], v7, s[8:11], s19 offen
    ds_read_b128 v[112:115], v8 offset:832
    ds_read_b128 v[116:119], v8 offset:17472
    ds_read_b128 v[120:123], v8 offset:34112
    ds_read_b128 v[124:127], v8 offset:50752
    ds_read_b128 v[128:131], v9 offset:832
    ds_read_b128 v[132:135], v9 offset:17472
    ds_read_b128 v[136:139], v9 offset:34112
    ds_read_b128 v[140:143], v9 offset:50752
    s_waitcnt vmcnt(2) lgkmcnt(8)
    v_mfma_f32_16x16x32_bf16 v[16:19], v[144:147], v[80:83], v[16:19]
    v_mfma_f32_16x16x32_bf16 v[48:51], v[148:151], v[80:83], v[48:51]
    v_mfma_f32_16x16x32_bf16 v[20:23], v[144:147], v[84:87], v[20:23]
    v_mfma_f32_16x16x32_bf16 v[52:55], v[148:151], v[84:87], v[52:55]
    v_mfma_f32_16x16x32_bf16 v[24:27], v[144:147], v[88:91], v[24:27]
    v_mfma_f32_16x16x32_bf16 v[56:59], v[148:151], v[88:91], v[56:59]
    v_mfma_f32_16x16x32_bf16 v[28:31], v[144:147], v[92:95], v[28:31]
    v_mfma_f32_16x16x32_bf16 v[60:63], v[148:151], v[92:95], v[60:63]
    v_mfma_f32_16x16x32_bf16 v[32:35], v[144:147], v[96:99], v[32:35]
    v_mfma_f32_16x16x32_bf16 v[64:67], v[148:151], v[96:99], v[64:67]
    v_mfma_f32_16x16x32_bf16 v[36:39], v[144:147], v[100:103], v[36:39]
    v_mfma_f32_16x16x32_bf16 v[68:71], v[148:151], v[100:103], v[68:71]
    v_mfma_f32_16x16x32_bf16 v[40:43], v[144:147], v[104:107], v[40:43]
    v_mfma_f32_16x16x32_bf16 v[72:75], v[148:151], v[104:107], v[72:75]
    v_mfma_f32_16x16x32_bf16 v[44:47], v[144:147], v[108:111], v[44:47]
    v_mfma_f32_16x16x32_bf16 v[76:79], v[148:151], v[108:111], v[76:79]
    s_add_u32 s19, s22, 14336
    buffer_load_dwordx4 v[144:147], v7, s[8:11], s19 offen
    s_add_u32 s19, s22, 30720
    buffer_load_dwordx4 v[148:151], v7, s[8:11], s19 offen
    ds_read_b128 v[80:83], v8 offset:896
    ds_read_b128 v[84:87], v8 offset:17536
    ds_read_b128 v[88:91], v8 offset:34176
    ds_read_b128 v[92:95], v8 offset:50816
    ds_read_b128 v[96:99], v9 offset:896
    ds_read_b128 v[100:103], v9 offset:17536
    ds_read_b128 v[104:107], v9 offset:34176
    ds_read_b128 v[108:111], v9 offset:50816
    s_waitcnt vmcnt(2) lgkmcnt(8)
    v_mfma_f32_16x16x32_bf16 v[16:19], v[152:155], v[112:115], v[16:19]
    v_mfma_f32_16x16x32_bf16 v[48:51], v[156:159], v[112:115], v[48:51]
    v_mfma_f32_16x16x32_bf16 v[20:23], v[152:155], v[116:119], v[20:23]
    v_mfma_f32_16x16x32_bf16 v[52:55], v[156:159], v[116:119], v[52:55]
    v_mfma_f32_16x16x32_bf16 v[24:27], v[152:155], v[120:123], v[24:27]
    v_mfma_f32_16x16x32_bf16 v[56:59], v[156:159], v[120:123], v[56:59]
    v_mfma_f32_16x16x32_bf16 v[28:31], v[152:155], v[124:127], v[28:31]
    v_mfma_f32_16x16x32_bf16 v[60:63], v[156:159], v[124:127], v[60:63]
    v_mfma_f32_16x16x32_bf16 v[32:35], v[152:155], v[128:131], v[32:35]
    v_mfma_f32_16x16x32_bf16 v[64:67], v[156:159], v[128:131], v[64:67]
    v_mfma_f32_16x16x32_bf16 v[36:39], v[152:155], v[132:135], v[36:39]
    v_mfma_f32_16x16x32_bf16 v[68:71], v[156:159], v[132:135], v[68:71]
    v_mfma_f32_16x16x32_bf16 v[40:43], v[152:155], v[136:139], v[40:43]
    v_mfma_f32_16x16x32_bf16 v[72:75], v[156:159], v[136:139], v[72:75]
    v_mfma_f32_16x16x32_bf16 v[44:47], v[152:155], v[140:143], v[44:47]
    v_mfma_f32_16x16x32_bf16 v[76:79], v[156:159], v[140:143], v[76:79]
    s_add_u32 s19, s22, 15360
    buffer_load_dwordx4 v[152:155], v7, s[8:11], s19 offen
    s_add_u32 s19, s22, 31744
    buffer_load_dwordx4 v[156:159], v7, s[8:11], s19 offen
    ds_read_b128 v[112:115], v8 offset:960
    ds_read_b128 v[116:119], v8 offset:17600
    ds_read_b128 v[120:123], v8 offset:34240
    ds_read_b128 v[124:127], v8 offset:50880
    ds_read_b128 v[128:131], v9 offset:960
    ds_read_b128 v[132:135], v9 offset:17600
    ds_read_b128 v[136:139], v9 offset:34240
    ds_read_b128 v[140:143], v9 offset:50880
    s_waitcnt vmcnt(2) lgkmcnt(8)
    v_mfma_f32_16x16x32_bf16 v[16:19], v[144:147], v[80:83], v[16:19]
    v_mfma_f32_16x16x32_bf16 v[48:51], v[148:151], v[80:83], v[48:51]
    v_mfma_f32_16x16x32_bf16 v[20:23], v[144:147], v[84:87], v[20:23]
    v_mfma_f32_16x16x32_bf16 v[52:55], v[148:151], v[84:87], v[52:55]
    v_mfma_f32_16x16x32_bf16 v[24:27], v[144:147], v[88:91], v[24:27]
    v_mfma_f32_16x16x32_bf16 v[56:59], v[148:151], v[88:91], v[56:59]
    v_mfma_f32_16x16x32_bf16 v[28:31], v[144:147], v[92:95], v[28:31]
    v_mfma_f32_16x16x32_bf16 v[60:63], v[148:151], v[92:95], v[60:63]
    v_mfma_f32_16x16x32_bf16 v[32:35], v[144:147], v[96:99], v[32:35]
    v_mfma_f32_16x16x32_bf16 v[64:67], v[148:151], v[96:99], v[64:67]
    v_mfma_f32_16x16x32_bf16 v[36:39], v[144:147], v[100:103], v[36:39]
    v_mfma_f32_16x16x32_bf16 v[68:71], v[148:151], v[100:103], v[68:71]
    v_mfma_f32_16x16x32_bf16 v[40:43], v[144:147], v[104:107], v[40:43]
    v_mfma_f32_16x16x32_bf16 v[72:75], v[148:151], v[104:107], v[72:75]
    v_mfma_f32_16x16x32_bf16 v[44:47], v[144:147], v[108:111], v[44:47]
    v_mfma_f32_16x16x32_bf16 v[76:79], v[148:151], v[108:111], v[76:79]
    s_waitcnt vmcnt(0) lgkmcnt(0)
    v_mfma_f32_16x16x32_bf16 v[16:19], v[152:155], v[112:115], v[16:19]
    v_mfma_f32_16x16x32_bf16 v[48:51], v[156:159], v[112:115], v[48:51]
    v_mfma_f32_16x16x32_bf16 v[20:23], v[152:155], v[116:119], v[20:23]
    v_mfma_f32_16x16x32_bf16 v[52:55], v[156:159], v[116:119], v[52:55]
    v_mfma_f32_16x16x32_bf16 v[24:27], v[152:155], v[120:123], v[24:27]
    v_mfma_f32_16x16x32_bf16 v[56:59], v[156:159], v[120:123], v[56:59]
    v_mfma_f32_16x16x32_bf16 v[28:31], v[152:155], v[124:127], v[28:31]
    v_mfma_f32_16x16x32_bf16 v[60:63], v[156:159], v[124:127], v[60:63]
    v_mfma_f32_16x16x32_bf16 v[32:35], v[152:155], v[128:131], v[32:35]
    v_mfma_f32_16x16x32_bf16 v[64:67], v[156:159], v[128:131], v[64:67]
    v_mfma_f32_16x16x32_bf16 v[36:39], v[152:155], v[132:135], v[36:39]
    v_mfma_f32_16x16x32_bf16 v[68:71], v[156:159], v[132:135], v[68:71]
    v_mfma_f32_16x16x32_bf16 v[40:43], v[152:155], v[136:139], v[40:43]
    v_mfma_f32_16x16x32_bf16 v[72:75], v[156:159], v[136:139], v[72:75]
    v_mfma_f32_16x16x32_bf16 v[44:47], v[152:155], v[140:143], v[44:47]
    v_mfma_f32_16x16x32_bf16 v[76:79], v[156:159], v[140:143], v[76:79]
    s_nop 7
    s_lshl_b32 s23, s3, 2
    s_lshl_b32 s23, s23, 5
    s_add_u32 s23, s23, s6
    s_lshl_b32 s23, s23, 13
    s_lshl_b32 s19, s16, 11
    s_add_u32 s23, s23, s19
    s_add_u32 s23, s23, 142606336
    v_cvt_pk_bf16_f32 v80, v16, v17
    v_cvt_pk_bf16_f32 v81, v18, v19
    v_cvt_pk_bf16_f32 v82, v48, v49
    v_cvt_pk_bf16_f32 v83, v50, v51
    s_add_u32 s19, s23, 0
    buffer_store_dwordx4 v[80:83], v7, s[8:11], s19 offen sc1
    s_nop 1
    v_cvt_pk_bf16_f32 v84, v20, v21
    v_cvt_pk_bf16_f32 v85, v22, v23
    v_cvt_pk_bf16_f32 v86, v52, v53
    v_cvt_pk_bf16_f32 v87, v54, v55
    s_add_u32 s19, s23, 1024
    buffer_store_dwordx4 v[84:87], v7, s[8:11], s19 offen sc1
    s_nop 1
    v_cvt_pk_bf16_f32 v80, v24, v25
    v_cvt_pk_bf16_f32 v81, v26, v27
    v_cvt_pk_bf16_f32 v82, v56, v57
    v_cvt_pk_bf16_f32 v83, v58, v59
    s_add_u32 s19, s23, 262144
    buffer_store_dwordx4 v[80:83], v7, s[8:11], s19 offen sc1
    s_nop 1
    v_cvt_pk_bf16_f32 v84, v28, v29
    v_cvt_pk_bf16_f32 v85, v30, v31
    v_cvt_pk_bf16_f32 v86, v60, v61
    v_cvt_pk_bf16_f32 v87, v62, v63
    s_add_u32 s19, s23, 263168
    buffer_store_dwordx4 v[84:87], v7, s[8:11], s19 offen sc1
    s_nop 1
    v_cvt_pk_bf16_f32 v80, v32, v33
    v_cvt_pk_bf16_f32 v81, v34, v35
    v_cvt_pk_bf16_f32 v82, v64, v65
    v_cvt_pk_bf16_f32 v83, v66, v67
    s_add_u32 s19, s23, 524288
    buffer_store_dwordx4 v[80:83], v7, s[8:11], s19 offen sc1
    s_nop 1
    v_cvt_pk_bf16_f32 v84, v36, v37
    v_cvt_pk_bf16_f32 v85, v38, v39
    v_cvt_pk_bf16_f32 v86, v68, v69
    v_cvt_pk_bf16_f32 v87, v70, v71
    s_add_u32 s19, s23, 525312
    buffer_store_dwordx4 v[84:87], v7, s[8:11], s19 offen sc1
    s_nop 1
    v_cvt_pk_bf16_f32 v80, v40, v41
    v_cvt_pk_bf16_f32 v81, v42, v43
    v_cvt_pk_bf16_f32 v82, v72, v73
    v_cvt_pk_bf16_f32 v83, v74, v75
    s_add_u32 s19, s23, 786432
    buffer_store_dwordx4 v[80:83], v7, s[8:11], s19 offen sc1
    s_nop 1
    v_cvt_pk_bf16_f32 v84, v44, v45
    v_cvt_pk_bf16_f32 v85, v46, v47
    v_cvt_pk_bf16_f32 v86, v76, v77
    v_cvt_pk_bf16_f32 v87, v78, v79
    s_add_u32 s19, s23, 787456
    buffer_store_dwordx4 v[84:87], v7, s[8:11], s19 offen sc1
    s_nop 1
    s_lshl_b32 s6, s26, 1
    s_add_u32 s6, s6, 1
    s_lshl_b32 s22, s6, 17
    s_lshl_b32 s19, s16, 15
    s_add_u32 s22, s22, s19
    s_add_u32 s22, s22, 8388608
    s_add_u32 s19, s22, 0
    buffer_load_dwordx4 v[144:147], v7, s[8:11], s19 offen
    s_add_u32 s19, s22, 16384
    buffer_load_dwordx4 v[148:151], v7, s[8:11], s19 offen
    ds_read_b128 v[80:83], v8 offset:0
    ds_read_b128 v[84:87], v8 offset:16640
    ds_read_b128 v[88:91], v8 offset:33280
    ds_read_b128 v[92:95], v8 offset:49920
    ds_read_b128 v[96:99], v9 offset:0
    ds_read_b128 v[100:103], v9 offset:16640
    ds_read_b128 v[104:107], v9 offset:33280
    ds_read_b128 v[108:111], v9 offset:49920
    s_add_u32 s19, s22, 1024
    buffer_load_dwordx4 v[152:155], v7, s[8:11], s19 offen
    s_add_u32 s19, s22, 17408
    buffer_load_dwordx4 v[156:159], v7, s[8:11], s19 offen
    ds_read_b128 v[112:115], v8 offset:64
    ds_read_b128 v[116:119], v8 offset:16704
    ds_read_b128 v[120:123], v8 offset:33344
    ds_read_b128 v[124:127], v8 offset:49984
    ds_read_b128 v[128:131], v9 offset:64
    ds_read_b128 v[132:135], v9 offset:16704
    ds_read_b128 v[136:139], v9 offset:33344
    ds_read_b128 v[140:143], v9 offset:49984
    s_waitcnt vmcnt(2) lgkmcnt(8)
    v_mfma_f32_16x16x32_bf16 v[16:19], v[80:83], v[144:147], 0
    v_mfma_f32_16x16x32_bf16 v[48:51], v[80:83], v[148:151], 0
    v_mfma_f32_16x16x32_bf16 v[20:23], v[84:87], v[144:147], 0
    v_mfma_f32_16x16x32_bf16 v[52:55], v[84:87], v[148:151], 0
    v_mfma_f32_16x16x32_bf16 v[24:27], v[88:91], v[144:147], 0
    v_mfma_f32_16x16x32_bf16 v[56:59], v[88:91], v[148:151], 0
    v_mfma_f32_16x16x32_bf16 v[28:31], v[92:95], v[144:147], 0
    v_mfma_f32_16x16x32_bf16 v[60:63], v[92:95], v[148:151], 0
    v_mfma_f32_16x16x32_bf16 v[32:35], v[96:99], v[144:147], 0
    v_mfma_f32_16x16x32_bf16 v[64:67], v[96:99], v[148:151], 0
    v_mfma_f32_16x16x32_bf16 v[36:39], v[100:103], v[144:147], 0
    v_mfma_f32_16x16x32_bf16 v[68:71], v[100:103], v[148:151], 0
    v_mfma_f32_16x16x32_bf16 v[40:43], v[104:107], v[144:147], 0
    v_mfma_f32_16x16x32_bf16 v[72:75], v[104:107], v[148:151], 0
    v_mfma_f32_16x16x32_bf16 v[44:47], v[108:111], v[144:147], 0
    v_mfma_f32_16x16x32_bf16 v[76:79], v[108:111], v[148:151], 0
    s_add_u32 s19, s22, 2048
    buffer_load_dwordx4 v[144:147], v7, s[8:11], s19 offen
    s_add_u32 s19, s22, 18432
    buffer_load_dwordx4 v[148:151], v7, s[8:11], s19 offen
    ds_read_b128 v[80:83], v8 offset:128
    ds_read_b128 v[84:87], v8 offset:16768
    ds_read_b128 v[88:91], v8 offset:33408
    ds_read_b128 v[92:95], v8 offset:50048
    ds_read_b128 v[96:99], v9 offset:128
    ds_read_b128 v[100:103], v9 offset:16768
    ds_read_b128 v[104:107], v9 offset:33408
    ds_read_b128 v[108:111], v9 offset:50048
    s_waitcnt vmcnt(2) lgkmcnt(8)
    v_mfma_f32_16x16x32_bf16 v[16:19], v[112:115], v[152:155], v[16:19]
    v_mfma_f32_16x16x32_bf16 v[48:51], v[112:115], v[156:159], v[48:51]
    v_mfma_f32_16x16x32_bf16 v[20:23], v[116:119], v[152:155], v[20:23]
    v_mfma_f32_16x16x32_bf16 v[52:55], v[116:119], v[156:159], v[52:55]
    v_mfma_f32_16x16x32_bf16 v[24:27], v[120:123], v[152:155], v[24:27]
    v_mfma_f32_16x16x32_bf16 v[56:59], v[120:123], v[156:159], v[56:59]
    v_mfma_f32_16x16x32_bf16 v[28:31], v[124:127], v[152:155], v[28:31]
    v_mfma_f32_16x16x32_bf16 v[60:63], v[124:127], v[156:159], v[60:63]
    v_mfma_f32_16x16x32_bf16 v[32:35], v[128:131], v[152:155], v[32:35]
    v_mfma_f32_16x16x32_bf16 v[64:67], v[128:131], v[156:159], v[64:67]
    v_mfma_f32_16x16x32_bf16 v[36:39], v[132:135], v[152:155], v[36:39]
    v_mfma_f32_16x16x32_bf16 v[68:71], v[132:135], v[156:159], v[68:71]
    v_mfma_f32_16x16x32_bf16 v[40:43], v[136:139], v[152:155], v[40:43]
    v_mfma_f32_16x16x32_bf16 v[72:75], v[136:139], v[156:159], v[72:75]
    v_mfma_f32_16x16x32_bf16 v[44:47], v[140:143], v[152:155], v[44:47]
    v_mfma_f32_16x16x32_bf16 v[76:79], v[140:143], v[156:159], v[76:79]
    s_add_u32 s19, s22, 3072
    buffer_load_dwordx4 v[152:155], v7, s[8:11], s19 offen
    s_add_u32 s19, s22, 19456
    buffer_load_dwordx4 v[156:159], v7, s[8:11], s19 offen
    ds_read_b128 v[112:115], v8 offset:192
    ds_read_b128 v[116:119], v8 offset:16832
    ds_read_b128 v[120:123], v8 offset:33472
    ds_read_b128 v[124:127], v8 offset:50112
    ds_read_b128 v[128:131], v9 offset:192
    ds_read_b128 v[132:135], v9 offset:16832
    ds_read_b128 v[136:139], v9 offset:33472
    ds_read_b128 v[140:143], v9 offset:50112
    s_waitcnt vmcnt(2) lgkmcnt(8)
    v_mfma_f32_16x16x32_bf16 v[16:19], v[80:83], v[144:147], v[16:19]
    v_mfma_f32_16x16x32_bf16 v[48:51], v[80:83], v[148:151], v[48:51]
    v_mfma_f32_16x16x32_bf16 v[20:23], v[84:87], v[144:147], v[20:23]
    v_mfma_f32_16x16x32_bf16 v[52:55], v[84:87], v[148:151], v[52:55]
    v_mfma_f32_16x16x32_bf16 v[24:27], v[88:91], v[144:147], v[24:27]
    v_mfma_f32_16x16x32_bf16 v[56:59], v[88:91], v[148:151], v[56:59]
    v_mfma_f32_16x16x32_bf16 v[28:31], v[92:95], v[144:147], v[28:31]
    v_mfma_f32_16x16x32_bf16 v[60:63], v[92:95], v[148:151], v[60:63]
    v_mfma_f32_16x16x32_bf16 v[32:35], v[96:99], v[144:147], v[32:35]
    v_mfma_f32_16x16x32_bf16 v[64:67], v[96:99], v[148:151], v[64:67]
    v_mfma_f32_16x16x32_bf16 v[36:39], v[100:103], v[144:147], v[36:39]
    v_mfma_f32_16x16x32_bf16 v[68:71], v[100:103], v[148:151], v[68:71]
    v_mfma_f32_16x16x32_bf16 v[40:43], v[104:107], v[144:147], v[40:43]
    v_mfma_f32_16x16x32_bf16 v[72:75], v[104:107], v[148:151], v[72:75]
    v_mfma_f32_16x16x32_bf16 v[44:47], v[108:111], v[144:147], v[44:47]
    v_mfma_f32_16x16x32_bf16 v[76:79], v[108:111], v[148:151], v[76:79]
    s_add_u32 s19, s22, 4096
    buffer_load_dwordx4 v[144:147], v7, s[8:11], s19 offen
    s_add_u32 s19, s22, 20480
    buffer_load_dwordx4 v[148:151], v7, s[8:11], s19 offen
    ds_read_b128 v[80:83], v8 offset:256
    ds_read_b128 v[84:87], v8 offset:16896
    ds_read_b128 v[88:91], v8 offset:33536
    ds_read_b128 v[92:95], v8 offset:50176
    ds_read_b128 v[96:99], v9 offset:256
    ds_read_b128 v[100:103], v9 offset:16896
    ds_read_b128 v[104:107], v9 offset:33536
    ds_read_b128 v[108:111], v9 offset:50176
    s_waitcnt vmcnt(2) lgkmcnt(8)
    v_mfma_f32_16x16x32_bf16 v[16:19], v[112:115], v[152:155], v[16:19]
    v_mfma_f32_16x16x32_bf16 v[48:51], v[112:115], v[156:159], v[48:51]
    v_mfma_f32_16x16x32_bf16 v[20:23], v[116:119], v[152:155], v[20:23]
    v_mfma_f32_16x16x32_bf16 v[52:55], v[116:119], v[156:159], v[52:55]
    v_mfma_f32_16x16x32_bf16 v[24:27], v[120:123], v[152:155], v[24:27]
    v_mfma_f32_16x16x32_bf16 v[56:59], v[120:123], v[156:159], v[56:59]
    v_mfma_f32_16x16x32_bf16 v[28:31], v[124:127], v[152:155], v[28:31]
    v_mfma_f32_16x16x32_bf16 v[60:63], v[124:127], v[156:159], v[60:63]
    v_mfma_f32_16x16x32_bf16 v[32:35], v[128:131], v[152:155], v[32:35]
    v_mfma_f32_16x16x32_bf16 v[64:67], v[128:131], v[156:159], v[64:67]
    v_mfma_f32_16x16x32_bf16 v[36:39], v[132:135], v[152:155], v[36:39]
    v_mfma_f32_16x16x32_bf16 v[68:71], v[132:135], v[156:159], v[68:71]
    v_mfma_f32_16x16x32_bf16 v[40:43], v[136:139], v[152:155], v[40:43]
    v_mfma_f32_16x16x32_bf16 v[72:75], v[136:139], v[156:159], v[72:75]
    v_mfma_f32_16x16x32_bf16 v[44:47], v[140:143], v[152:155], v[44:47]
    v_mfma_f32_16x16x32_bf16 v[76:79], v[140:143], v[156:159], v[76:79]
    s_add_u32 s19, s22, 5120
    buffer_load_dwordx4 v[152:155], v7, s[8:11], s19 offen
    s_add_u32 s19, s22, 21504
    buffer_load_dwordx4 v[156:159], v7, s[8:11], s19 offen
    ds_read_b128 v[112:115], v8 offset:320
    ds_read_b128 v[116:119], v8 offset:16960
    ds_read_b128 v[120:123], v8 offset:33600
    ds_read_b128 v[124:127], v8 offset:50240
    ds_read_b128 v[128:131], v9 offset:320
    ds_read_b128 v[132:135], v9 offset:16960
    ds_read_b128 v[136:139], v9 offset:33600
    ds_read_b128 v[140:143], v9 offset:50240
    s_waitcnt vmcnt(2) lgkmcnt(8)
    v_mfma_f32_16x16x32_bf16 v[16:19], v[80:83], v[144:147], v[16:19]
    v_mfma_f32_16x16x32_bf16 v[48:51], v[80:83], v[148:151], v[48:51]
    v_mfma_f32_16x16x32_bf16 v[20:23], v[84:87], v[144:147], v[20:23]
    v_mfma_f32_16x16x32_bf16 v[52:55], v[84:87], v[148:151], v[52:55]
    v_mfma_f32_16x16x32_bf16 v[24:27], v[88:91], v[144:147], v[24:27]
    v_mfma_f32_16x16x32_bf16 v[56:59], v[88:91], v[148:151], v[56:59]
    v_mfma_f32_16x16x32_bf16 v[28:31], v[92:95], v[144:147], v[28:31]
    v_mfma_f32_16x16x32_bf16 v[60:63], v[92:95], v[148:151], v[60:63]
    v_mfma_f32_16x16x32_bf16 v[32:35], v[96:99], v[144:147], v[32:35]
    v_mfma_f32_16x16x32_bf16 v[64:67], v[96:99], v[148:151], v[64:67]
    v_mfma_f32_16x16x32_bf16 v[36:39], v[100:103], v[144:147], v[36:39]
    v_mfma_f32_16x16x32_bf16 v[68:71], v[100:103], v[148:151], v[68:71]
    v_mfma_f32_16x16x32_bf16 v[40:43], v[104:107], v[144:147], v[40:43]
    v_mfma_f32_16x16x32_bf16 v[72:75], v[104:107], v[148:151], v[72:75]
    v_mfma_f32_16x16x32_bf16 v[44:47], v[108:111], v[144:147], v[44:47]
    v_mfma_f32_16x16x32_bf16 v[76:79], v[108:111], v[148:151], v[76:79]
    s_add_u32 s19, s22, 6144
    buffer_load_dwordx4 v[144:147], v7, s[8:11], s19 offen
    s_add_u32 s19, s22, 22528
    buffer_load_dwordx4 v[148:151], v7, s[8:11], s19 offen
    ds_read_b128 v[80:83], v8 offset:384
    ds_read_b128 v[84:87], v8 offset:17024
    ds_read_b128 v[88:91], v8 offset:33664
    ds_read_b128 v[92:95], v8 offset:50304
    ds_read_b128 v[96:99], v9 offset:384
    ds_read_b128 v[100:103], v9 offset:17024
    ds_read_b128 v[104:107], v9 offset:33664
    ds_read_b128 v[108:111], v9 offset:50304
    s_waitcnt vmcnt(2) lgkmcnt(8)
    v_mfma_f32_16x16x32_bf16 v[16:19], v[112:115], v[152:155], v[16:19]
    v_mfma_f32_16x16x32_bf16 v[48:51], v[112:115], v[156:159], v[48:51]
    v_mfma_f32_16x16x32_bf16 v[20:23], v[116:119], v[152:155], v[20:23]
    v_mfma_f32_16x16x32_bf16 v[52:55], v[116:119], v[156:159], v[52:55]
    v_mfma_f32_16x16x32_bf16 v[24:27], v[120:123], v[152:155], v[24:27]
    v_mfma_f32_16x16x32_bf16 v[56:59], v[120:123], v[156:159], v[56:59]
    v_mfma_f32_16x16x32_bf16 v[28:31], v[124:127], v[152:155], v[28:31]
    v_mfma_f32_16x16x32_bf16 v[60:63], v[124:127], v[156:159], v[60:63]
    v_mfma_f32_16x16x32_bf16 v[32:35], v[128:131], v[152:155], v[32:35]
    v_mfma_f32_16x16x32_bf16 v[64:67], v[128:131], v[156:159], v[64:67]
    v_mfma_f32_16x16x32_bf16 v[36:39], v[132:135], v[152:155], v[36:39]
    v_mfma_f32_16x16x32_bf16 v[68:71], v[132:135], v[156:159], v[68:71]
    v_mfma_f32_16x16x32_bf16 v[40:43], v[136:139], v[152:155], v[40:43]
    v_mfma_f32_16x16x32_bf16 v[72:75], v[136:139], v[156:159], v[72:75]
    v_mfma_f32_16x16x32_bf16 v[44:47], v[140:143], v[152:155], v[44:47]
    v_mfma_f32_16x16x32_bf16 v[76:79], v[140:143], v[156:159], v[76:79]
    s_add_u32 s19, s22, 7168
    buffer_load_dwordx4 v[152:155], v7, s[8:11], s19 offen
    s_add_u32 s19, s22, 23552
    buffer_load_dwordx4 v[156:159], v7, s[8:11], s19 offen
    ds_read_b128 v[112:115], v8 offset:448
    ds_read_b128 v[116:119], v8 offset:17088
    ds_read_b128 v[120:123], v8 offset:33728
    ds_read_b128 v[124:127], v8 offset:50368
    ds_read_b128 v[128:131], v9 offset:448
    ds_read_b128 v[132:135], v9 offset:17088
    ds_read_b128 v[136:139], v9 offset:33728
    ds_read_b128 v[140:143], v9 offset:50368
    s_waitcnt vmcnt(2) lgkmcnt(8)
    v_mfma_f32_16x16x32_bf16 v[16:19], v[80:83], v[144:147], v[16:19]
    v_mfma_f32_16x16x32_bf16 v[48:51], v[80:83], v[148:151], v[48:51]
    v_mfma_f32_16x16x32_bf16 v[20:23], v[84:87], v[144:147], v[20:23]
    v_mfma_f32_16x16x32_bf16 v[52:55], v[84:87], v[148:151], v[52:55]
    v_mfma_f32_16x16x32_bf16 v[24:27], v[88:91], v[144:147], v[24:27]
    v_mfma_f32_16x16x32_bf16 v[56:59], v[88:91], v[148:151], v[56:59]
    v_mfma_f32_16x16x32_bf16 v[28:31], v[92:95], v[144:147], v[28:31]
    v_mfma_f32_16x16x32_bf16 v[60:63], v[92:95], v[148:151], v[60:63]
    v_mfma_f32_16x16x32_bf16 v[32:35], v[96:99], v[144:147], v[32:35]
    v_mfma_f32_16x16x32_bf16 v[64:67], v[96:99], v[148:151], v[64:67]
    v_mfma_f32_16x16x32_bf16 v[36:39], v[100:103], v[144:147], v[36:39]
    v_mfma_f32_16x16x32_bf16 v[68:71], v[100:103], v[148:151], v[68:71]
    v_mfma_f32_16x16x32_bf16 v[40:43], v[104:107], v[144:147], v[40:43]
    v_mfma_f32_16x16x32_bf16 v[72:75], v[104:107], v[148:151], v[72:75]
    v_mfma_f32_16x16x32_bf16 v[44:47], v[108:111], v[144:147], v[44:47]
    v_mfma_f32_16x16x32_bf16 v[76:79], v[108:111], v[148:151], v[76:79]
    s_add_u32 s19, s22, 8192
    buffer_load_dwordx4 v[144:147], v7, s[8:11], s19 offen
    s_add_u32 s19, s22, 24576
    buffer_load_dwordx4 v[148:151], v7, s[8:11], s19 offen
    ds_read_b128 v[80:83], v8 offset:512
    ds_read_b128 v[84:87], v8 offset:17152
    ds_read_b128 v[88:91], v8 offset:33792
    ds_read_b128 v[92:95], v8 offset:50432
    ds_read_b128 v[96:99], v9 offset:512
    ds_read_b128 v[100:103], v9 offset:17152
    ds_read_b128 v[104:107], v9 offset:33792
    ds_read_b128 v[108:111], v9 offset:50432
    s_waitcnt vmcnt(2) lgkmcnt(8)
    v_mfma_f32_16x16x32_bf16 v[16:19], v[112:115], v[152:155], v[16:19]
    v_mfma_f32_16x16x32_bf16 v[48:51], v[112:115], v[156:159], v[48:51]
    v_mfma_f32_16x16x32_bf16 v[20:23], v[116:119], v[152:155], v[20:23]
    v_mfma_f32_16x16x32_bf16 v[52:55], v[116:119], v[156:159], v[52:55]
    v_mfma_f32_16x16x32_bf16 v[24:27], v[120:123], v[152:155], v[24:27]
    v_mfma_f32_16x16x32_bf16 v[56:59], v[120:123], v[156:159], v[56:59]
    v_mfma_f32_16x16x32_bf16 v[28:31], v[124:127], v[152:155], v[28:31]
    v_mfma_f32_16x16x32_bf16 v[60:63], v[124:127], v[156:159], v[60:63]
    v_mfma_f32_16x16x32_bf16 v[32:35], v[128:131], v[152:155], v[32:35]
    v_mfma_f32_16x16x32_bf16 v[64:67], v[128:131], v[156:159], v[64:67]
    v_mfma_f32_16x16x32_bf16 v[36:39], v[132:135], v[152:155], v[36:39]
    v_mfma_f32_16x16x32_bf16 v[68:71], v[132:135], v[156:159], v[68:71]
    v_mfma_f32_16x16x32_bf16 v[40:43], v[136:139], v[152:155], v[40:43]
    v_mfma_f32_16x16x32_bf16 v[72:75], v[136:139], v[156:159], v[72:75]
    v_mfma_f32_16x16x32_bf16 v[44:47], v[140:143], v[152:155], v[44:47]
    v_mfma_f32_16x16x32_bf16 v[76:79], v[140:143], v[156:159], v[76:79]
    s_add_u32 s19, s22, 9216
    buffer_load_dwordx4 v[152:155], v7, s[8:11], s19 offen
    s_add_u32 s19, s22, 25600
    buffer_load_dwordx4 v[156:159], v7, s[8:11], s19 offen
    ds_read_b128 v[112:115], v8 offset:576
    ds_read_b128 v[116:119], v8 offset:17216
    ds_read_b128 v[120:123], v8 offset:33856
    ds_read_b128 v[124:127], v8 offset:50496
    ds_read_b128 v[128:131], v9 offset:576
    ds_read_b128 v[132:135], v9 offset:17216
    ds_read_b128 v[136:139], v9 offset:33856
    ds_read_b128 v[140:143], v9 offset:50496
    s_waitcnt vmcnt(2) lgkmcnt(8)
    v_mfma_f32_16x16x32_bf16 v[16:19], v[80:83], v[144:147], v[16:19]
    v_mfma_f32_16x16x32_bf16 v[48:51], v[80:83], v[148:151], v[48:51]
    v_mfma_f32_16x16x32_bf16 v[20:23], v[84:87], v[144:147], v[20:23]
    v_mfma_f32_16x16x32_bf16 v[52:55], v[84:87], v[148:151], v[52:55]
    v_mfma_f32_16x16x32_bf16 v[24:27], v[88:91], v[144:147], v[24:27]
    v_mfma_f32_16x16x32_bf16 v[56:59], v[88:91], v[148:151], v[56:59]
    v_mfma_f32_16x16x32_bf16 v[28:31], v[92:95], v[144:147], v[28:31]
    v_mfma_f32_16x16x32_bf16 v[60:63], v[92:95], v[148:151], v[60:63]
    v_mfma_f32_16x16x32_bf16 v[32:35], v[96:99], v[144:147], v[32:35]
    v_mfma_f32_16x16x32_bf16 v[64:67], v[96:99], v[148:151], v[64:67]
    v_mfma_f32_16x16x32_bf16 v[36:39], v[100:103], v[144:147], v[36:39]
    v_mfma_f32_16x16x32_bf16 v[68:71], v[100:103], v[148:151], v[68:71]
    v_mfma_f32_16x16x32_bf16 v[40:43], v[104:107], v[144:147], v[40:43]
    v_mfma_f32_16x16x32_bf16 v[72:75], v[104:107], v[148:151], v[72:75]
    v_mfma_f32_16x16x32_bf16 v[44:47], v[108:111], v[144:147], v[44:47]
    v_mfma_f32_16x16x32_bf16 v[76:79], v[108:111], v[148:151], v[76:79]
    s_add_u32 s19, s22, 10240
    buffer_load_dwordx4 v[144:147], v7, s[8:11], s19 offen
    s_add_u32 s19, s22, 26624
    buffer_load_dwordx4 v[148:151], v7, s[8:11], s19 offen
    ds_read_b128 v[80:83], v8 offset:640
    ds_read_b128 v[84:87], v8 offset:17280
    ds_read_b128 v[88:91], v8 offset:33920
    ds_read_b128 v[92:95], v8 offset:50560
    ds_read_b128 v[96:99], v9 offset:640
    ds_read_b128 v[100:103], v9 offset:17280
    ds_read_b128 v[104:107], v9 offset:33920
    ds_read_b128 v[108:111], v9 offset:50560
    s_waitcnt vmcnt(2) lgkmcnt(8)
    v_mfma_f32_16x16x32_bf16 v[16:19], v[112:115], v[152:155], v[16:19]
    v_mfma_f32_16x16x32_bf16 v[48:51], v[112:115], v[156:159], v[48:51]
    v_mfma_f32_16x16x32_bf16 v[20:23], v[116:119], v[152:155], v[20:23]
    v_mfma_f32_16x16x32_bf16 v[52:55], v[116:119], v[156:159], v[52:55]
    v_mfma_f32_16x16x32_bf16 v[24:27], v[120:123], v[152:155], v[24:27]
    v_mfma_f32_16x16x32_bf16 v[56:59], v[120:123], v[156:159], v[56:59]
    v_mfma_f32_16x16x32_bf16 v[28:31], v[124:127], v[152:155], v[28:31]
    v_mfma_f32_16x16x32_bf16 v[60:63], v[124:127], v[156:159], v[60:63]
    v_mfma_f32_16x16x32_bf16 v[32:35], v[128:131], v[152:155], v[32:35]
    v_mfma_f32_16x16x32_bf16 v[64:67], v[128:131], v[156:159], v[64:67]
    v_mfma_f32_16x16x32_bf16 v[36:39], v[132:135], v[152:155], v[36:39]
    v_mfma_f32_16x16x32_bf16 v[68:71], v[132:135], v[156:159], v[68:71]
    v_mfma_f32_16x16x32_bf16 v[40:43], v[136:139], v[152:155], v[40:43]
    v_mfma_f32_16x16x32_bf16 v[72:75], v[136:139], v[156:159], v[72:75]
    v_mfma_f32_16x16x32_bf16 v[44:47], v[140:143], v[152:155], v[44:47]
    v_mfma_f32_16x16x32_bf16 v[76:79], v[140:143], v[156:159], v[76:79]
    s_add_u32 s19, s22, 11264
    buffer_load_dwordx4 v[152:155], v7, s[8:11], s19 offen
    s_add_u32 s19, s22, 27648
    buffer_load_dwordx4 v[156:159], v7, s[8:11], s19 offen
    ds_read_b128 v[112:115], v8 offset:704
    ds_read_b128 v[116:119], v8 offset:17344
    ds_read_b128 v[120:123], v8 offset:33984
    ds_read_b128 v[124:127], v8 offset:50624
    ds_read_b128 v[128:131], v9 offset:704
    ds_read_b128 v[132:135], v9 offset:17344
    ds_read_b128 v[136:139], v9 offset:33984
    ds_read_b128 v[140:143], v9 offset:50624
    s_waitcnt vmcnt(2) lgkmcnt(8)
    v_mfma_f32_16x16x32_bf16 v[16:19], v[80:83], v[144:147], v[16:19]
    v_mfma_f32_16x16x32_bf16 v[48:51], v[80:83], v[148:151], v[48:51]
    v_mfma_f32_16x16x32_bf16 v[20:23], v[84:87], v[144:147], v[20:23]
    v_mfma_f32_16x16x32_bf16 v[52:55], v[84:87], v[148:151], v[52:55]
    v_mfma_f32_16x16x32_bf16 v[24:27], v[88:91], v[144:147], v[24:27]
    v_mfma_f32_16x16x32_bf16 v[56:59], v[88:91], v[148:151], v[56:59]
    v_mfma_f32_16x16x32_bf16 v[28:31], v[92:95], v[144:147], v[28:31]
    v_mfma_f32_16x16x32_bf16 v[60:63], v[92:95], v[148:151], v[60:63]
    v_mfma_f32_16x16x32_bf16 v[32:35], v[96:99], v[144:147], v[32:35]
    v_mfma_f32_16x16x32_bf16 v[64:67], v[96:99], v[148:151], v[64:67]
    v_mfma_f32_16x16x32_bf16 v[36:39], v[100:103], v[144:147], v[36:39]
    v_mfma_f32_16x16x32_bf16 v[68:71], v[100:103], v[148:151], v[68:71]
    v_mfma_f32_16x16x32_bf16 v[40:43], v[104:107], v[144:147], v[40:43]
    v_mfma_f32_16x16x32_bf16 v[72:75], v[104:107], v[148:151], v[72:75]
    v_mfma_f32_16x16x32_bf16 v[44:47], v[108:111], v[144:147], v[44:47]
    v_mfma_f32_16x16x32_bf16 v[76:79], v[108:111], v[148:151], v[76:79]
    s_add_u32 s19, s22, 12288
    buffer_load_dwordx4 v[144:147], v7, s[8:11], s19 offen
    s_add_u32 s19, s22, 28672
    buffer_load_dwordx4 v[148:151], v7, s[8:11], s19 offen
    ds_read_b128 v[80:83], v8 offset:768
    ds_read_b128 v[84:87], v8 offset:17408
    ds_read_b128 v[88:91], v8 offset:34048
    ds_read_b128 v[92:95], v8 offset:50688
    ds_read_b128 v[96:99], v9 offset:768
    ds_read_b128 v[100:103], v9 offset:17408
    ds_read_b128 v[104:107], v9 offset:34048
    ds_read_b128 v[108:111], v9 offset:50688
    s_waitcnt vmcnt(2) lgkmcnt(8)
    v_mfma_f32_16x16x32_bf16 v[16:19], v[112:115], v[152:155], v[16:19]
    v_mfma_f32_16x16x32_bf16 v[48:51], v[112:115], v[156:159], v[48:51]
    v_mfma_f32_16x16x32_bf16 v[20:23], v[116:119], v[152:155], v[20:23]
    v_mfma_f32_16x16x32_bf16 v[52:55], v[116:119], v[156:159], v[52:55]
    v_mfma_f32_16x16x32_bf16 v[24:27], v[120:123], v[152:155], v[24:27]
    v_mfma_f32_16x16x32_bf16 v[56:59], v[120:123], v[156:159], v[56:59]
    v_mfma_f32_16x16x32_bf16 v[28:31], v[124:127], v[152:155], v[28:31]
    v_mfma_f32_16x16x32_bf16 v[60:63], v[124:127], v[156:159], v[60:63]
    v_mfma_f32_16x16x32_bf16 v[32:35], v[128:131], v[152:155], v[32:35]
    v_mfma_f32_16x16x32_bf16 v[64:67], v[128:131], v[156:159], v[64:67]
    v_mfma_f32_16x16x32_bf16 v[36:39], v[132:135], v[152:155], v[36:39]
    v_mfma_f32_16x16x32_bf16 v[68:71], v[132:135], v[156:159], v[68:71]
    v_mfma_f32_16x16x32_bf16 v[40:43], v[136:139], v[152:155], v[40:43]
    v_mfma_f32_16x16x32_bf16 v[72:75], v[136:139], v[156:159], v[72:75]
    v_mfma_f32_16x16x32_bf16 v[44:47], v[140:143], v[152:155], v[44:47]
    v_mfma_f32_16x16x32_bf16 v[76:79], v[140:143], v[156:159], v[76:79]
    s_add_u32 s19, s22, 13312
    buffer_load_dwordx4 v[152:155], v7, s[8:11], s19 offen
    s_add_u32 s19, s22, 29696
    buffer_load_dwordx4 v[156:159], v7, s[8:11], s19 offen
    ds_read_b128 v[112:115], v8 offset:832
    ds_read_b128 v[116:119], v8 offset:17472
    ds_read_b128 v[120:123], v8 offset:34112
    ds_read_b128 v[124:127], v8 offset:50752
    ds_read_b128 v[128:131], v9 offset:832
    ds_read_b128 v[132:135], v9 offset:17472
    ds_read_b128 v[136:139], v9 offset:34112
    ds_read_b128 v[140:143], v9 offset:50752
    s_waitcnt vmcnt(2) lgkmcnt(8)
    v_mfma_f32_16x16x32_bf16 v[16:19], v[80:83], v[144:147], v[16:19]
    v_mfma_f32_16x16x32_bf16 v[48:51], v[80:83], v[148:151], v[48:51]
    v_mfma_f32_16x16x32_bf16 v[20:23], v[84:87], v[144:147], v[20:23]
    v_mfma_f32_16x16x32_bf16 v[52:55], v[84:87], v[148:151], v[52:55]
    v_mfma_f32_16x16x32_bf16 v[24:27], v[88:91], v[144:147], v[24:27]
    v_mfma_f32_16x16x32_bf16 v[56:59], v[88:91], v[148:151], v[56:59]
    v_mfma_f32_16x16x32_bf16 v[28:31], v[92:95], v[144:147], v[28:31]
    v_mfma_f32_16x16x32_bf16 v[60:63], v[92:95], v[148:151], v[60:63]
    v_mfma_f32_16x16x32_bf16 v[32:35], v[96:99], v[144:147], v[32:35]
    v_mfma_f32_16x16x32_bf16 v[64:67], v[96:99], v[148:151], v[64:67]
    v_mfma_f32_16x16x32_bf16 v[36:39], v[100:103], v[144:147], v[36:39]
    v_mfma_f32_16x16x32_bf16 v[68:71], v[100:103], v[148:151], v[68:71]
    v_mfma_f32_16x16x32_bf16 v[40:43], v[104:107], v[144:147], v[40:43]
    v_mfma_f32_16x16x32_bf16 v[72:75], v[104:107], v[148:151], v[72:75]
    v_mfma_f32_16x16x32_bf16 v[44:47], v[108:111], v[144:147], v[44:47]
    v_mfma_f32_16x16x32_bf16 v[76:79], v[108:111], v[148:151], v[76:79]
    s_add_u32 s19, s22, 14336
    buffer_load_dwordx4 v[144:147], v7, s[8:11], s19 offen
    s_add_u32 s19, s22, 30720
    buffer_load_dwordx4 v[148:151], v7, s[8:11], s19 offen
    ds_read_b128 v[80:83], v8 offset:896
    ds_read_b128 v[84:87], v8 offset:17536
    ds_read_b128 v[88:91], v8 offset:34176
    ds_read_b128 v[92:95], v8 offset:50816
    ds_read_b128 v[96:99], v9 offset:896
    ds_read_b128 v[100:103], v9 offset:17536
    ds_read_b128 v[104:107], v9 offset:34176
    ds_read_b128 v[108:111], v9 offset:50816
    s_waitcnt vmcnt(2) lgkmcnt(8)
    v_mfma_f32_16x16x32_bf16 v[16:19], v[112:115], v[152:155], v[16:19]
    v_mfma_f32_16x16x32_bf16 v[48:51], v[112:115], v[156:159], v[48:51]
    v_mfma_f32_16x16x32_bf16 v[20:23], v[116:119], v[152:155], v[20:23]
    v_mfma_f32_16x16x32_bf16 v[52:55], v[116:119], v[156:159], v[52:55]
    v_mfma_f32_16x16x32_bf16 v[24:27], v[120:123], v[152:155], v[24:27]
    v_mfma_f32_16x16x32_bf16 v[56:59], v[120:123], v[156:159], v[56:59]
    v_mfma_f32_16x16x32_bf16 v[28:31], v[124:127], v[152:155], v[28:31]
    v_mfma_f32_16x16x32_bf16 v[60:63], v[124:127], v[156:159], v[60:63]
    v_mfma_f32_16x16x32_bf16 v[32:35], v[128:131], v[152:155], v[32:35]
    v_mfma_f32_16x16x32_bf16 v[64:67], v[128:131], v[156:159], v[64:67]
    v_mfma_f32_16x16x32_bf16 v[36:39], v[132:135], v[152:155], v[36:39]
    v_mfma_f32_16x16x32_bf16 v[68:71], v[132:135], v[156:159], v[68:71]
    v_mfma_f32_16x16x32_bf16 v[40:43], v[136:139], v[152:155], v[40:43]
    v_mfma_f32_16x16x32_bf16 v[72:75], v[136:139], v[156:159], v[72:75]
    v_mfma_f32_16x16x32_bf16 v[44:47], v[140:143], v[152:155], v[44:47]
    v_mfma_f32_16x16x32_bf16 v[76:79], v[140:143], v[156:159], v[76:79]
    s_add_u32 s19, s22, 15360
    buffer_load_dwordx4 v[152:155], v7, s[8:11], s19 offen
    s_add_u32 s19, s22, 31744
    buffer_load_dwordx4 v[156:159], v7, s[8:11], s19 offen
    ds_read_b128 v[112:115], v8 offset:960
    ds_read_b128 v[116:119], v8 offset:17600
    ds_read_b128 v[120:123], v8 offset:34240
    ds_read_b128 v[124:127], v8 offset:50880
    ds_read_b128 v[128:131], v9 offset:960
    ds_read_b128 v[132:135], v9 offset:17600
    ds_read_b128 v[136:139], v9 offset:34240
    ds_read_b128 v[140:143], v9 offset:50880
    s_waitcnt vmcnt(2) lgkmcnt(8)
    v_mfma_f32_16x16x32_bf16 v[16:19], v[80:83], v[144:147], v[16:19]
    v_mfma_f32_16x16x32_bf16 v[48:51], v[80:83], v[148:151], v[48:51]
    v_mfma_f32_16x16x32_bf16 v[20:23], v[84:87], v[144:147], v[20:23]
    v_mfma_f32_16x16x32_bf16 v[52:55], v[84:87], v[148:151], v[52:55]
    v_mfma_f32_16x16x32_bf16 v[24:27], v[88:91], v[144:147], v[24:27]
    v_mfma_f32_16x16x32_bf16 v[56:59], v[88:91], v[148:151], v[56:59]
    v_mfma_f32_16x16x32_bf16 v[28:31], v[92:95], v[144:147], v[28:31]
    v_mfma_f32_16x16x32_bf16 v[60:63], v[92:95], v[148:151], v[60:63]
    v_mfma_f32_16x16x32_bf16 v[32:35], v[96:99], v[144:147], v[32:35]
    v_mfma_f32_16x16x32_bf16 v[64:67], v[96:99], v[148:151], v[64:67]
    v_mfma_f32_16x16x32_bf16 v[36:39], v[100:103], v[144:147], v[36:39]
    v_mfma_f32_16x16x32_bf16 v[68:71], v[100:103], v[148:151], v[68:71]
    v_mfma_f32_16x16x32_bf16 v[40:43], v[104:107], v[144:147], v[40:43]
    v_mfma_f32_16x16x32_bf16 v[72:75], v[104:107], v[148:151], v[72:75]
    v_mfma_f32_16x16x32_bf16 v[44:47], v[108:111], v[144:147], v[44:47]
    v_mfma_f32_16x16x32_bf16 v[76:79], v[108:111], v[148:151], v[76:79]
    s_waitcnt vmcnt(0) lgkmcnt(0)
    v_mfma_f32_16x16x32_bf16 v[16:19], v[112:115], v[152:155], v[16:19]
    v_mfma_f32_16x16x32_bf16 v[48:51], v[112:115], v[156:159], v[48:51]
    v_mfma_f32_16x16x32_bf16 v[20:23], v[116:119], v[152:155], v[20:23]
    v_mfma_f32_16x16x32_bf16 v[52:55], v[116:119], v[156:159], v[52:55]
    v_mfma_f32_16x16x32_bf16 v[24:27], v[120:123], v[152:155], v[24:27]
    v_mfma_f32_16x16x32_bf16 v[56:59], v[120:123], v[156:159], v[56:59]
    v_mfma_f32_16x16x32_bf16 v[28:31], v[124:127], v[152:155], v[28:31]
    v_mfma_f32_16x16x32_bf16 v[60:63], v[124:127], v[156:159], v[60:63]
    v_mfma_f32_16x16x32_bf16 v[32:35], v[128:131], v[152:155], v[32:35]
    v_mfma_f32_16x16x32_bf16 v[64:67], v[128:131], v[156:159], v[64:67]
    v_mfma_f32_16x16x32_bf16 v[36:39], v[132:135], v[152:155], v[36:39]
    v_mfma_f32_16x16x32_bf16 v[68:71], v[132:135], v[156:159], v[68:71]
    v_mfma_f32_16x16x32_bf16 v[40:43], v[136:139], v[152:155], v[40:43]
    v_mfma_f32_16x16x32_bf16 v[72:75], v[136:139], v[156:159], v[72:75]
    v_mfma_f32_16x16x32_bf16 v[44:47], v[140:143], v[152:155], v[44:47]
    v_mfma_f32_16x16x32_bf16 v[76:79], v[140:143], v[156:159], v[76:79]
    s_nop 7
    s_lshl_b32 s23, s3, 2
    s_lshl_b32 s23, s23, 5
    s_add_u32 s23, s23, s6
    s_lshl_b32 s23, s23, 13
    s_lshl_b32 s19, s16, 11
    s_add_u32 s23, s23, s19
    s_add_u32 s23, s23, 159383552
    v_cvt_pk_bf16_f32 v80, v16, v17
    v_cvt_pk_bf16_f32 v81, v18, v19
    v_cvt_pk_bf16_f32 v82, v20, v21
    v_cvt_pk_bf16_f32 v83, v22, v23
    s_add_u32 s19, s23, 0
    buffer_store_dwordx4 v[80:83], v7, s[8:11], s19 offen sc1
    s_nop 1
    v_cvt_pk_bf16_f32 v84, v48, v49
    v_cvt_pk_bf16_f32 v85, v50, v51
    v_cvt_pk_bf16_f32 v86, v52, v53
    v_cvt_pk_bf16_f32 v87, v54, v55
    s_add_u32 s19, s23, 1024
    buffer_store_dwordx4 v[84:87], v7, s[8:11], s19 offen sc1
    s_nop 1
    v_cvt_pk_bf16_f32 v80, v24, v25
    v_cvt_pk_bf16_f32 v81, v26, v27
    v_cvt_pk_bf16_f32 v82, v28, v29
    v_cvt_pk_bf16_f32 v83, v30, v31
    s_add_u32 s19, s23, 262144
    buffer_store_dwordx4 v[80:83], v7, s[8:11], s19 offen sc1
    s_nop 1
    v_cvt_pk_bf16_f32 v84, v56, v57
    v_cvt_pk_bf16_f32 v85, v58, v59
    v_cvt_pk_bf16_f32 v86, v60, v61
    v_cvt_pk_bf16_f32 v87, v62, v63
    s_add_u32 s19, s23, 263168
    buffer_store_dwordx4 v[84:87], v7, s[8:11], s19 offen sc1
    s_nop 1
    v_cvt_pk_bf16_f32 v80, v32, v33
    v_cvt_pk_bf16_f32 v81, v34, v35
    v_cvt_pk_bf16_f32 v82, v36, v37
    v_cvt_pk_bf16_f32 v83, v38, v39
    s_add_u32 s19, s23, 524288
    buffer_store_dwordx4 v[80:83], v7, s[8:11], s19 offen sc1
    s_nop 1
    v_cvt_pk_bf16_f32 v84, v64, v65
    v_cvt_pk_bf16_f32 v85, v66, v67
    v_cvt_pk_bf16_f32 v86, v68, v69
    v_cvt_pk_bf16_f32 v87, v70, v71
    s_add_u32 s19, s23, 525312
    buffer_store_dwordx4 v[84:87], v7, s[8:11], s19 offen sc1
    s_nop 1
    v_cvt_pk_bf16_f32 v80, v40, v41
    v_cvt_pk_bf16_f32 v81, v42, v43
    v_cvt_pk_bf16_f32 v82, v44, v45
    v_cvt_pk_bf16_f32 v83, v46, v47
    s_add_u32 s19, s23, 786432
    buffer_store_dwordx4 v[80:83], v7, s[8:11], s19 offen sc1
    s_nop 1
    v_cvt_pk_bf16_f32 v84, v72, v73
    v_cvt_pk_bf16_f32 v85, v74, v75
    v_cvt_pk_bf16_f32 v86, v76, v77
    v_cvt_pk_bf16_f32 v87, v78, v79
    s_add_u32 s19, s23, 787456
    buffer_store_dwordx4 v[84:87], v7, s[8:11], s19 offen sc1
    s_nop 1
    s_waitcnt vmcnt(0)
    s_barrier
    s_lshl_b32 s19, s27, 2
    s_add_u32 s19, s19, 20463872
    v_mov_b32 v80, 1
    v_mov_b32 v81, 0
    v_cmp_eq_u32 vcc, 0, v0
    s_and_saveexec_b64 s[30:31], vcc
    buffer_store_dword v80, v81, s[8:11], s19 offen sc1
    s_mov_b64 exec, s[30:31]
L_kb1_end_91:
    s_cmp_ge_u32 s36, 32
    s_cbranch_scc1 L_mega_wdone_92
    s_cmp_ge_u32 s27, 224
    s_cbranch_scc1 L_mega_wdone_92
    s_add_u32 s27, s36, 224
    s_barrier
    s_branch L_mega_tloop_90
L_mega_wdone_92:
L_mega_exit_56:
    s_endpgm
.section .rodata,"a"
.p2align 6
.amdhsa_kernel mega1_kernel
  .amdhsa_next_free_vgpr 512
  .amdhsa_next_free_sgpr 102
  .amdhsa_accum_offset 256
  .amdhsa_group_segment_fixed_size 0
  .amdhsa_kernarg_size 120
  .amdhsa_user_sgpr_count 2
  .amdhsa_user_sgpr_kernarg_segment_ptr 1
  .amdhsa_system_sgpr_workgroup_id_x 1
.end_amdhsa_kernel
.text

.p2align 8
.globl kb4_0_kernel
.type kb4_0_kernel,@function
kb4_0_kernel:
    s_cmp_ge_u32 s2, 256
    s_cbranch_scc1 L_kb4_end_93
    s_load_dwordx2 s[4:5], s[0:1], 112
    s_load_dwordx2 s[6:7], s[0:1], 96
    v_and_b32 v1, 63, v0
    v_lshrrev_b32 v2, 6, v0
    s_nop 0
    v_readfirstlane_b32 s16, v2
    v_lshrrev_b32 v2, 4, v1
    v_and_b32 v3, 15, v1
    s_lshr_b32 s3, s2, 3
    s_and_b32 s26, s2, 7
    s_waitcnt lgkmcnt(0)
    s_mov_b32 s8, s4
    s_and_b32 s9, s5, 0xffff
    s_mov_b32 s10, 268435456
    s_mov_b32 s11, 0x00020000
    s_mov_b32 s12, s6
    s_and_b32 s13, s7, 0xffff
    s_mov_b32 s14, 2097152
    s_mov_b32 s15, 0x00020000
    v_lshlrev_b32 v7, 4, v1
    s_lshl_b32 s5, s26, 2
    s_add_u32 s5, s5, s16
    s_lshl_b32 s5, s5, 12
    s_add_u32 s5, s5, 12582912
    s_lshl_b32 s17, s3, 19
    s_add_u32 s17, s17, 125829120
    s_add_u32 s19, s5, 0
    buffer_load_dwordx4 v[32:35], v7, s[8:11], s19 offen
    s_add_u32 s19, s17, 0
    buffer_load_dwordx4 v[48:51], v7, s[8:11], s19 offen
    s_add_u32 s19, s17, 1024
    buffer_load_dwordx4 v[52:55], v7, s[8:11], s19 offen
    s_add_u32 s19, s17, 262144
    buffer_load_dwordx4 v[56:59], v7, s[8:11], s19 offen
    s_add_u32 s19, s17, 263168
    buffer_load_dwordx4 v[60:63], v7, s[8:11], s19 offen
    s_add_u32 s19, s5, 1024
    buffer_load_dwordx4 v[36:39], v7, s[8:11], s19 offen
    s_add_u32 s19, s17, 2048
    buffer_load_dwordx4 v[64:67], v7, s[8:11], s19 offen
    s_add_u32 s19, s17, 3072
    buffer_load_dwordx4 v[68:71], v7, s[8:11], s19 offen
    s_add_u32 s19, s17, 264192
    buffer_load_dwordx4 v[72:75], v7, s[8:11], s19 offen
    s_add_u32 s19, s17, 265216
    buffer_load_dwordx4 v[76:79], v7, s[8:11], s19 offen
    s_add_u32 s19, s5, 2048
    buffer_load_dwordx4 v[40:43], v7, s[8:11], s19 offen
    s_add_u32 s19, s17, 4096
    buffer_load_dwordx4 v[80:83], v7, s[8:11], s19 offen
    s_add_u32 s19, s17, 5120
    buffer_load_dwordx4 v[84:87], v7, s[8:11], s19 offen
    s_add_u32 s19, s17, 266240
    buffer_load_dwordx4 v[88:91], v7, s[8:11], s19 offen
    s_add_u32 s19, s17, 267264
    buffer_load_dwordx4 v[92:95], v7, s[8:11], s19 offen
    s_waitcnt vmcnt(10)
    v_mfma_f32_16x16x32_bf16 v[16:19], v[32:35], v[48:51], 0
    v_mfma_f32_16x16x32_bf16 v[20:23], v[32:35], v[52:55], 0
    v_mfma_f32_16x16x32_bf16 v[24:27], v[32:35], v[56:59], 0
    v_mfma_f32_16x16x32_bf16 v[28:31], v[32:35], v[60:63], 0
    s_add_u32 s19, s5, 3072
    buffer_load_dwordx4 v[32:35], v7, s[8:11], s19 offen
    s_add_u32 s19, s17, 6144
    buffer_load_dwordx4 v[48:51], v7, s[8:11], s19 offen
    s_add_u32 s19, s17, 7168
    buffer_load_dwordx4 v[52:55], v7, s[8:11], s19 offen
    s_add_u32 s19, s17, 268288
    buffer_load_dwordx4 v[56:59], v7, s[8:11], s19 offen
    s_add_u32 s19, s17, 269312
    buffer_load_dwordx4 v[60:63], v7, s[8:11], s19 offen
    s_waitcnt vmcnt(10)
    v_mfma_f32_16x16x32_bf16 v[16:19], v[36:39], v[64:67], v[16:19]
    v_mfma_f32_16x16x32_bf16 v[20:23], v[36:39], v[68:71], v[20:23]
    v_mfma_f32_16x16x32_bf16 v[24:27], v[36:39], v[72:75], v[24:27]
    v_mfma_f32_16x16x32_bf16 v[28:31], v[36:39], v[76:79], v[28:31]
    s_add_u32 s19, s5, 131072
    buffer_load_dwordx4 v[36:39], v7, s[8:11], s19 offen
    s_add_u32 s19, s17, 8192
    buffer_load_dwordx4 v[64:67], v7, s[8:11], s19 offen
    s_add_u32 s19, s17, 9216
    buffer_load_dwordx4 v[68:71], v7, s[8:11], s19 offen
    s_add_u32 s19, s17, 270336
    buffer_load_dwordx4 v[72:75], v7, s[8:11], s19 offen
    s_add_u32 s19, s17, 271360
    buffer_load_dwordx4 v[76:79], v7, s[8:11], s19 offen
    s_waitcnt vmcnt(10)
    v_mfma_f32_16x16x32_bf16 v[16:19], v[40:43], v[80:83], v[16:19]
    v_mfma_f32_16x16x32_bf16 v[20:23], v[40:43], v[84:87], v[20:23]
    v_mfma_f32_16x16x32_bf16 v[24:27], v[40:43], v[88:91], v[24:27]
    v_mfma_f32_16x16x32_bf16 v[28:31], v[40:43], v[92:95], v[28:31]
    s_add_u32 s19, s5, 132096
    buffer_load_dwordx4 v[40:43], v7, s[8:11], s19 offen
    s_add_u32 s19, s17, 10240
    buffer_load_dwordx4 v[80:83], v7, s[8:11], s19 offen
    s_add_u32 s19, s17, 11264
    buffer_load_dwordx4 v[84:87], v7, s[8:11], s19 offen
    s_add_u32 s19, s17, 272384
    buffer_load_dwordx4 v[88:91], v7, s[8:11], s19 offen
    s_add_u32 s19, s17, 273408
    buffer_load_dwordx4 v[92:95], v7, s[8:11], s19 offen
    s_waitcnt vmcnt(10)
    v_mfma_f32_16x16x32_bf16 v[16:19], v[32:35], v[48:51], v[16:19]
    v_mfma_f32_16x16x32_bf16 v[20:23], v[32:35], v[52:55], v[20:23]
    v_mfma_f32_16x16x32_bf16 v[24:27], v[32:35], v[56:59], v[24:27]
    v_mfma_f32_16x16x32_bf16 v[28:31], v[32:35], v[60:63], v[28:31]
    s_add_u32 s19, s5, 133120
    buffer_load_dwordx4 v[32:35], v7, s[8:11], s19 offen
    s_add_u32 s19, s17, 12288
    buffer_load_dwordx4 v[48:51], v7, s[8:11], s19 offen
    s_add_u32 s19, s17, 13312
    buffer_load_dwordx4 v[52:55], v7, s[8:11], s19 offen
    s_add_u32 s19, s17, 274432
    buffer_load_dwordx4 v[56:59], v7, s[8:11], s19 offen
    s_add_u32 s19, s17, 275456
    buffer_load_dwordx4 v[60:63], v7, s[8:11], s19 offen
    s_waitcnt vmcnt(10)
    v_mfma_f32_16x16x32_bf16 v[16:19], v[36:39], v[64:67], v[16:19]
    v_mfma_f32_16x16x32_bf16 v[20:23], v[36:39], v[68:71], v[20:23]
    v_mfma_f32_16x16x32_bf16 v[24:27], v[36:39], v[72:75], v[24:27]
    v_mfma_f32_16x16x32_bf16 v[28:31], v[36:39], v[76:79], v[28:31]
    s_add_u32 s19, s5, 134144
    buffer_load_dwordx4 v[36:39], v7, s[8:11], s19 offen
    s_add_u32 s19, s17, 14336
    buffer_load_dwordx4 v[64:67], v7, s[8:11], s19 offen
    s_add_u32 s19, s17, 15360
    buffer_load_dwordx4 v[68:71], v7, s[8:11], s19 offen
    s_add_u32 s19, s17, 276480
    buffer_load_dwordx4 v[72:75], v7, s[8:11], s19 offen
    s_add_u32 s19, s17, 277504
    buffer_load_dwordx4 v[76:79], v7, s[8:11], s19 offen
    s_waitcnt vmcnt(10)
    v_mfma_f32_16x16x32_bf16 v[16:19], v[40:43], v[80:83], v[16:19]
    v_mfma_f32_16x16x32_bf16 v[20:23], v[40:43], v[84:87], v[20:23]
    v_mfma_f32_16x16x32_bf16 v[24:27], v[40:43], v[88:91], v[24:27]
    v_mfma_f32_16x16x32_bf16 v[28:31], v[40:43], v[92:95], v[28:31]
    s_add_u32 s19, s5, 262144
    buffer_load_dwordx4 v[40:43], v7, s[8:11], s19 offen
    s_add_u32 s19, s17, 16384
    buffer_load_dwordx4 v[80:83], v7, s[8:11], s19 offen
    s_add_u32 s19, s17, 17408
    buffer_load_dwordx4 v[84:87], v7, s[8:11], s19 offen
    s_add_u32 s19, s17, 278528
    buffer_load_dwordx4 v[88:91], v7, s[8:11], s19 offen
    s_add_u32 s19, s17, 279552
    buffer_load_dwordx4 v[92:95], v7, s[8:11], s19 offen
    s_waitcnt vmcnt(10)
    v_mfma_f32_16x16x32_bf16 v[16:19], v[32:35], v[48:51], v[16:19]
    v_mfma_f32_16x16x32_bf16 v[20:23], v[32:35], v[52:55], v[20:23]
    v_mfma_f32_16x16x32_bf16 v[24:27], v[32:35], v[56:59], v[24:27]
    v_mfma_f32_16x16x32_bf16 v[28:31], v[32:35], v[60:63], v[28:31]
    s_add_u32 s19, s5, 263168
    buffer_load_dwordx4 v[32:35], v7, s[8:11], s19 offen
    s_add_u32 s19, s17, 18432
    buffer_load_dwordx4 v[48:51], v7, s[8:11], s19 offen
    s_add_u32 s19, s17, 19456
    buffer_load_dwordx4 v[52:55], v7, s[8:11], s19 offen
    s_add_u32 s19, s17, 280576
    buffer_load_dwordx4 v[56:59], v7, s[8:11], s19 offen
    s_add_u32 s19, s17, 281600
    buffer_load_dwordx4 v[60:63], v7, s[8:11], s19 offen
    s_waitcnt vmcnt(10)
    v_mfma_f32_16x16x32_bf16 v[16:19], v[36:39], v[64:67], v[16:19]
    v_mfma_f32_16x16x32_bf16 v[20:23], v[36:39], v[68:71], v[20:23]
    v_mfma_f32_16x16x32_bf16 v[24:27], v[36:39], v[72:75], v[24:27]
    v_mfma_f32_16x16x32_bf16 v[28:31], v[36:39], v[76:79], v[28:31]
    s_add_u32 s19, s5, 264192
    buffer_load_dwordx4 v[36:39], v7, s[8:11], s19 offen
    s_add_u32 s19, s17, 20480
    buffer_load_dwordx4 v[64:67], v7, s[8:11], s19 offen
    s_add_u32 s19, s17, 21504
    buffer_load_dwordx4 v[68:71], v7, s[8:11], s19 offen
    s_add_u32 s19, s17, 282624
    buffer_load_dwordx4 v[72:75], v7, s[8:11], s19 offen
    s_add_u32 s19, s17, 283648
    buffer_load_dwordx4 v[76:79], v7, s[8:11], s19 offen
    s_waitcnt vmcnt(10)
    v_mfma_f32_16x16x32_bf16 v[16:19], v[40:43], v[80:83], v[16:19]
    v_mfma_f32_16x16x32_bf16 v[20:23], v[40:43], v[84:87], v[20:23]
    v_mfma_f32_16x16x32_bf16 v[24:27], v[40:43], v[88:91], v[24:27]
    v_mfma_f32_16x16x32_bf16 v[28:31], v[40:43], v[92:95], v[28:31]
    s_add_u32 s19, s5, 265216
    buffer_load_dwordx4 v[40:43], v7, s[8:11], s19 offen
    s_add_u32 s19, s17, 22528
    buffer_load_dwordx4 v[80:83], v7, s[8:11], s19 offen
    s_add_u32 s19, s17, 23552
    buffer_load_dwordx4 v[84:87], v7, s[8:11], s19 offen
    s_add_u32 s19, s17, 284672
    buffer_load_dwordx4 v[88:91], v7, s[8:11], s19 offen
    s_add_u32 s19, s17, 285696
    buffer_load_dwordx4 v[92:95], v7, s[8:11], s19 offen
    s_waitcnt vmcnt(10)
    v_mfma_f32_16x16x32_bf16 v[16:19], v[32:35], v[48:51], v[16:19]
    v_mfma_f32_16x16x32_bf16 v[20:23], v[32:35], v[52:55], v[20:23]
    v_mfma_f32_16x16x32_bf16 v[24:27], v[32:35], v[56:59], v[24:27]
    v_mfma_f32_16x16x32_bf16 v[28:31], v[32:35], v[60:63], v[28:31]
    s_add_u32 s19, s5, 393216
    buffer_load_dwordx4 v[32:35], v7, s[8:11], s19 offen
    s_add_u32 s19, s17, 24576
    buffer_load_dwordx4 v[48:51], v7, s[8:11], s19 offen
    s_add_u32 s19, s17, 25600
    buffer_load_dwordx4 v[52:55], v7, s[8:11], s19 offen
    s_add_u32 s19, s17, 286720
    buffer_load_dwordx4 v[56:59], v7, s[8:11], s19 offen
    s_add_u32 s19, s17, 287744
    buffer_load_dwordx4 v[60:63], v7, s[8:11], s19 offen
    s_waitcnt vmcnt(10)
    v_mfma_f32_16x16x32_bf16 v[16:19], v[36:39], v[64:67], v[16:19]
    v_mfma_f32_16x16x32_bf16 v[20:23], v[36:39], v[68:71], v[20:23]
    v_mfma_f32_16x16x32_bf16 v[24:27], v[36:39], v[72:75], v[24:27]
    v_mfma_f32_16x16x32_bf16 v[28:31], v[36:39], v[76:79], v[28:31]
    s_add_u32 s19, s5, 394240
    buffer_load_dwordx4 v[36:39], v7, s[8:11], s19 offen
    s_add_u32 s19, s17, 26624
    buffer_load_dwordx4 v[64:67], v7, s[8:11], s19 offen
    s_add_u32 s19, s17, 27648
    buffer_load_dwordx4 v[68:71], v7, s[8:11], s19 offen
    s_add_u32 s19, s17, 288768
    buffer_load_dwordx4 v[72:75], v7, s[8:11], s19 offen
    s_add_u32 s19, s17, 289792
    buffer_load_dwordx4 v[76:79], v7, s[8:11], s19 offen
    s_waitcnt vmcnt(10)
    v_mfma_f32_16x16x32_bf16 v[16:19], v[40:43], v[80:83], v[16:19]
    v_mfma_f32_16x16x32_bf16 v[20:23], v[40:43], v[84:87], v[20:23]
    v_mfma_f32_16x16x32_bf16 v[24:27], v[40:43], v[88:91], v[24:27]
    v_mfma_f32_16x16x32_bf16 v[28:31], v[40:43], v[92:95], v[28:31]
    s_add_u32 s19, s5, 395264
    buffer_load_dwordx4 v[40:43], v7, s[8:11], s19 offen
    s_add_u32 s19, s17, 28672
    buffer_load_dwordx4 v[80:83], v7, s[8:11], s19 offen
    s_add_u32 s19, s17, 29696
    buffer_load_dwordx4 v[84:87], v7, s[8:11], s19 offen
    s_add_u32 s19, s17, 290816
    buffer_load_dwordx4 v[88:91], v7, s[8:11], s19 offen
    s_add_u32 s19, s17, 291840
    buffer_load_dwordx4 v[92:95], v7, s[8:11], s19 offen
    s_waitcnt vmcnt(10)
    v_mfma_f32_16x16x32_bf16 v[16:19], v[32:35], v[48:51], v[16:19]
    v_mfma_f32_16x16x32_bf16 v[20:23], v[32:35], v[52:55], v[20:23]
    v_mfma_f32_16x16x32_bf16 v[24:27], v[32:35], v[56:59], v[24:27]
    v_mfma_f32_16x16x32_bf16 v[28:31], v[32:35], v[60:63], v[28:31]
    s_add_u32 s19, s5, 396288
    buffer_load_dwordx4 v[32:35], v7, s[8:11], s19 offen
    s_add_u32 s19, s17, 30720
    buffer_load_dwordx4 v[48:51], v7, s[8:11], s19 offen
    s_add_u32 s19, s17, 31744
    buffer_load_dwordx4 v[52:55], v7, s[8:11], s19 offen
    s_add_u32 s19, s17, 292864
    buffer_load_dwordx4 v[56:59], v7, s[8:11], s19 offen
    s_add_u32 s19, s17, 293888
    buffer_load_dwordx4 v[60:63], v7, s[8:11], s19 offen
    s_waitcnt vmcnt(10)
    v_mfma_f32_16x16x32_bf16 v[16:19], v[36:39], v[64:67], v[16:19]
    v_mfma_f32_16x16x32_bf16 v[20:23], v[36:39], v[68:71], v[20:23]
    v_mfma_f32_16x16x32_bf16 v[24:27], v[36:39], v[72:75], v[24:27]
    v_mfma_f32_16x16x32_bf16 v[28:31], v[36:39], v[76:79], v[28:31]
    s_add_u32 s19, s5, 524288
    buffer_load_dwordx4 v[36:39], v7, s[8:11], s19 offen
    s_add_u32 s19, s17, 32768
    buffer_load_dwordx4 v[64:67], v7, s[8:11], s19 offen
    s_add_u32 s19, s17, 33792
    buffer_load_dwordx4 v[68:71], v7, s[8:11], s19 offen
    s_add_u32 s19, s17, 294912
    buffer_load_dwordx4 v[72:75], v7, s[8:11], s19 offen
    s_add_u32 s19, s17, 295936
    buffer_load_dwordx4 v[76:79], v7, s[8:11], s19 offen
    s_waitcnt vmcnt(10)
    v_mfma_f32_16x16x32_bf16 v[16:19], v[40:43], v[80:83], v[16:19]
    v_mfma_f32_16x16x32_bf16 v[20:23], v[40:43], v[84:87], v[20:23]
    v_mfma_f32_16x16x32_bf16 v[24:27], v[40:43], v[88:91], v[24:27]
    v_mfma_f32_16x16x32_bf16 v[28:31], v[40:43], v[92:95], v[28:31]
    s_add_u32 s19, s5, 525312
    buffer_load_dwordx4 v[40:43], v7, s[8:11], s19 offen
    s_add_u32 s19, s17, 34816
    buffer_load_dwordx4 v[80:83], v7, s[8:11], s19 offen
    s_add_u32 s19, s17, 35840
    buffer_load_dwordx4 v[84:87], v7, s[8:11], s19 offen
    s_add_u32 s19, s17, 296960
    buffer_load_dwordx4 v[88:91], v7, s[8:11], s19 offen
    s_add_u32 s19, s17, 297984
    buffer_load_dwordx4 v[92:95], v7, s[8:11], s19 offen
    s_waitcnt vmcnt(10)
    v_mfma_f32_16x16x32_bf16 v[16:19], v[32:35], v[48:51], v[16:19]
    v_mfma_f32_16x16x32_bf16 v[20:23], v[32:35], v[52:55], v[20:23]
    v_mfma_f32_16x16x32_bf16 v[24:27], v[32:35], v[56:59], v[24:27]
    v_mfma_f32_16x16x32_bf16 v[28:31], v[32:35], v[60:63], v[28:31]
    s_add_u32 s19, s5, 526336
    buffer_load_dwordx4 v[32:35], v7, s[8:11], s19 offen
    s_add_u32 s19, s17, 36864
    buffer_load_dwordx4 v[48:51], v7, s[8:11], s19 offen
    s_add_u32 s19, s17, 37888
    buffer_load_dwordx4 v[52:55], v7, s[8:11], s19 offen
    s_add_u32 s19, s17, 299008
    buffer_load_dwordx4 v[56:59], v7, s[8:11], s19 offen
    s_add_u32 s19, s17, 300032
    buffer_load_dwordx4 v[60:63], v7, s[8:11], s19 offen
    s_waitcnt vmcnt(10)
    v_mfma_f32_16x16x32_bf16 v[16:19], v[36:39], v[64:67], v[16:19]
    v_mfma_f32_16x16x32_bf16 v[20:23], v[36:39], v[68:71], v[20:23]
    v_mfma_f32_16x16x32_bf16 v[24:27], v[36:39], v[72:75], v[24:27]
    v_mfma_f32_16x16x32_bf16 v[28:31], v[36:39], v[76:79], v[28:31]
    s_add_u32 s19, s5, 527360
    buffer_load_dwordx4 v[36:39], v7, s[8:11], s19 offen
    s_add_u32 s19, s17, 38912
    buffer_load_dwordx4 v[64:67], v7, s[8:11], s19 offen
    s_add_u32 s19, s17, 39936
    buffer_load_dwordx4 v[68:71], v7, s[8:11], s19 offen
    s_add_u32 s19, s17, 301056
    buffer_load_dwordx4 v[72:75], v7, s[8:11], s19 offen
    s_add_u32 s19, s17, 302080
    buffer_load_dwordx4 v[76:79], v7, s[8:11], s19 offen
    s_waitcnt vmcnt(10)
    v_mfma_f32_16x16x32_bf16 v[16:19], v[40:43], v[80:83], v[16:19]
    v_mfma_f32_16x16x32_bf16 v[20:23], v[40:43], v[84:87], v[20:23]
    v_mfma_f32_16x16x32_bf16 v[24:27], v[40:43], v[88:91], v[24:27]
    v_mfma_f32_16x16x32_bf16 v[28:31], v[40:43], v[92:95], v[28:31]
    s_add_u32 s19, s5, 655360
    buffer_load_dwordx4 v[40:43], v7, s[8:11], s19 offen
    s_add_u32 s19, s17, 40960
    buffer_load_dwordx4 v[80:83], v7, s[8:11], s19 offen
    s_add_u32 s19, s17, 41984
    buffer_load_dwordx4 v[84:87], v7, s[8:11], s19 offen
    s_add_u32 s19, s17, 303104
    buffer_load_dwordx4 v[88:91], v7, s[8:11], s19 offen
    s_add_u32 s19, s17, 304128
    buffer_load_dwordx4 v[92:95], v7, s[8:11], s19 offen
    s_waitcnt vmcnt(10)
    v_mfma_f32_16x16x32_bf16 v[16:19], v[32:35], v[48:51], v[16:19]
    v_mfma_f32_16x16x32_bf16 v[20:23], v[32:35], v[52:55], v[20:23]
    v_mfma_f32_16x16x32_bf16 v[24:27], v[32:35], v[56:59], v[24:27]
    v_mfma_f32_16x16x32_bf16 v[28:31], v[32:35], v[60:63], v[28:31]
    s_add_u32 s19, s5, 656384
    buffer_load_dwordx4 v[32:35], v7, s[8:11], s19 offen
    s_add_u32 s19, s17, 43008
    buffer_load_dwordx4 v[48:51], v7, s[8:11], s19 offen
    s_add_u32 s19, s17, 44032
    buffer_load_dwordx4 v[52:55], v7, s[8:11], s19 offen
    s_add_u32 s19, s17, 305152
    buffer_load_dwordx4 v[56:59], v7, s[8:11], s19 offen
    s_add_u32 s19, s17, 306176
    buffer_load_dwordx4 v[60:63], v7, s[8:11], s19 offen
    s_waitcnt vmcnt(10)
    v_mfma_f32_16x16x32_bf16 v[16:19], v[36:39], v[64:67], v[16:19]
    v_mfma_f32_16x16x32_bf16 v[20:23], v[36:39], v[68:71], v[20:23]
    v_mfma_f32_16x16x32_bf16 v[24:27], v[36:39], v[72:75], v[24:27]
    v_mfma_f32_16x16x32_bf16 v[28:31], v[36:39], v[76:79], v[28:31]
    s_add_u32 s19, s5, 657408
    buffer_load_dwordx4 v[36:39], v7, s[8:11], s19 offen
    s_add_u32 s19, s17, 45056
    buffer_load_dwordx4 v[64:67], v7, s[8:11], s19 offen
    s_add_u32 s19, s17, 46080
    buffer_load_dwordx4 v[68:71], v7, s[8:11], s19 offen
    s_add_u32 s19, s17, 307200
    buffer_load_dwordx4 v[72:75], v7, s[8:11], s19 offen
    s_add_u32 s19, s17, 308224
    buffer_load_dwordx4 v[76:79], v7, s[8:11], s19 offen
    s_waitcnt vmcnt(10)
    v_mfma_f32_16x16x32_bf16 v[16:19], v[40:43], v[80:83], v[16:19]
    v_mfma_f32_16x16x32_bf16 v[20:23], v[40:43], v[84:87], v[20:23]
    v_mfma_f32_16x16x32_bf16 v[24:27], v[40:43], v[88:91], v[24:27]
    v_mfma_f32_16x16x32_bf16 v[28:31], v[40:43], v[92:95], v[28:31]
    s_add_u32 s19, s5, 658432
    buffer_load_dwordx4 v[40:43], v7, s[8:11], s19 offen
    s_add_u32 s19, s17, 47104
    buffer_load_dwordx4 v[80:83], v7, s[8:11], s19 offen
    s_add_u32 s19, s17, 48128
    buffer_load_dwordx4 v[84:87], v7, s[8:11], s19 offen
    s_add_u32 s19, s17, 309248
    buffer_load_dwordx4 v[88:91], v7, s[8:11], s19 offen
    s_add_u32 s19, s17, 310272
    buffer_load_dwordx4 v[92:95], v7, s[8:11], s19 offen
    s_waitcnt vmcnt(10)
    v_mfma_f32_16x16x32_bf16 v[16:19], v[32:35], v[48:51], v[16:19]
    v_mfma_f32_16x16x32_bf16 v[20:23], v[32:35], v[52:55], v[20:23]
    v_mfma_f32_16x16x32_bf16 v[24:27], v[32:35], v[56:59], v[24:27]
    v_mfma_f32_16x16x32_bf16 v[28:31], v[32:35], v[60:63], v[28:31]
    s_add_u32 s19, s5, 786432
    buffer_load_dwordx4 v[32:35], v7, s[8:11], s19 offen
    s_add_u32 s19, s17, 49152
    buffer_load_dwordx4 v[48:51], v7, s[8:11], s19 offen
    s_add_u32 s19, s17, 50176
    buffer_load_dwordx4 v[52:55], v7, s[8:11], s19 offen
    s_add_u32 s19, s17, 311296
    buffer_load_dwordx4 v[56:59], v7, s[8:11], s19 offen
    s_add_u32 s19, s17, 312320
    buffer_load_dwordx4 v[60:63], v7, s[8:11], s19 offen
    s_waitcnt vmcnt(10)
    v_mfma_f32_16x16x32_bf16 v[16:19], v[36:39], v[64:67], v[16:19]
    v_mfma_f32_16x16x32_bf16 v[20:23], v[36:39], v[68:71], v[20:23]
    v_mfma_f32_16x16x32_bf16 v[24:27], v[36:39], v[72:75], v[24:27]
    v_mfma_f32_16x16x32_bf16 v[28:31], v[36:39], v[76:79], v[28:31]
    s_add_u32 s19, s5, 787456
    buffer_load_dwordx4 v[36:39], v7, s[8:11], s19 offen
    s_add_u32 s19, s17, 51200
    buffer_load_dwordx4 v[64:67], v7, s[8:11], s19 offen
    s_add_u32 s19, s17, 52224
    buffer_load_dwordx4 v[68:71], v7, s[8:11], s19 offen
    s_add_u32 s19, s17, 313344
    buffer_load_dwordx4 v[72:75], v7, s[8:11], s19 offen
    s_add_u32 s19, s17, 314368
    buffer_load_dwordx4 v[76:79], v7, s[8:11], s19 offen
    s_waitcnt vmcnt(10)
    v_mfma_f32_16x16x32_bf16 v[16:19], v[40:43], v[80:83], v[16:19]
    v_mfma_f32_16x16x32_bf16 v[20:23], v[40:43], v[84:87], v[20:23]
    v_mfma_f32_16x16x32_bf16 v[24:27], v[40:43], v[88:91], v[24:27]
    v_mfma_f32_16x16x32_bf16 v[28:31], v[40:43], v[92:95], v[28:31]
    s_add_u32 s19, s5, 788480
    buffer_load_dwordx4 v[40:43], v7, s[8:11], s19 offen
    s_add_u32 s19, s17, 53248
    buffer_load_dwordx4 v[80:83], v7, s[8:11], s19 offen
    s_add_u32 s19, s17, 54272
    buffer_load_dwordx4 v[84:87], v7, s[8:11], s19 offen
    s_add_u32 s19, s17, 315392
    buffer_load_dwordx4 v[88:91], v7, s[8:11], s19 offen
    s_add_u32 s19, s17, 316416
    buffer_load_dwordx4 v[92:95], v7, s[8:11], s19 offen
    s_waitcnt vmcnt(10)
    v_mfma_f32_16x16x32_bf16 v[16:19], v[32:35], v[48:51], v[16:19]
    v_mfma_f32_16x16x32_bf16 v[20:23], v[32:35], v[52:55], v[20:23]
    v_mfma_f32_16x16x32_bf16 v[24:27], v[32:35], v[56:59], v[24:27]
    v_mfma_f32_16x16x32_bf16 v[28:31], v[32:35], v[60:63], v[28:31]
    s_add_u32 s19, s5, 789504
    buffer_load_dwordx4 v[32:35], v7, s[8:11], s19 offen
    s_add_u32 s19, s17, 55296
    buffer_load_dwordx4 v[48:51], v7, s[8:11], s19 offen
    s_add_u32 s19, s17, 56320
    buffer_load_dwordx4 v[52:55], v7, s[8:11], s19 offen
    s_add_u32 s19, s17, 317440
    buffer_load_dwordx4 v[56:59], v7, s[8:11], s19 offen
    s_add_u32 s19, s17, 318464
    buffer_load_dwordx4 v[60:63], v7, s[8:11], s19 offen
    s_waitcnt vmcnt(10)
    v_mfma_f32_16x16x32_bf16 v[16:19], v[36:39], v[64:67], v[16:19]
    v_mfma_f32_16x16x32_bf16 v[20:23], v[36:39], v[68:71], v[20:23]
    v_mfma_f32_16x16x32_bf16 v[24:27], v[36:39], v[72:75], v[24:27]
    v_mfma_f32_16x16x32_bf16 v[28:31], v[36:39], v[76:79], v[28:31]
    s_add_u32 s19, s5, 917504
    buffer_load_dwordx4 v[36:39], v7, s[8:11], s19 offen
    s_add_u32 s19, s17, 57344
    buffer_load_dwordx4 v[64:67], v7, s[8:11], s19 offen
    s_add_u32 s19, s17, 58368
    buffer_load_dwordx4 v[68:71], v7, s[8:11], s19 offen
    s_add_u32 s19, s17, 319488
    buffer_load_dwordx4 v[72:75], v7, s[8:11], s19 offen
    s_add_u32 s19, s17, 320512
    buffer_load_dwordx4 v[76:79], v7, s[8:11], s19 offen
    s_waitcnt vmcnt(10)
    v_mfma_f32_16x16x32_bf16 v[16:19], v[40:43], v[80:83], v[16:19]
    v_mfma_f32_16x16x32_bf16 v[20:23], v[40:43], v[84:87], v[20:23]
    v_mfma_f32_16x16x32_bf16 v[24:27], v[40:43], v[88:91], v[24:27]
    v_mfma_f32_16x16x32_bf16 v[28:31], v[40:43], v[92:95], v[28:31]
    s_add_u32 s19, s5, 918528
    buffer_load_dwordx4 v[40:43], v7, s[8:11], s19 offen
    s_add_u32 s19, s17, 59392
    buffer_load_dwordx4 v[80:83], v7, s[8:11], s19 offen
    s_add_u32 s19, s17, 60416
    buffer_load_dwordx4 v[84:87], v7, s[8:11], s19 offen
    s_add_u32 s19, s17, 321536
    buffer_load_dwordx4 v[88:91], v7, s[8:11], s19 offen
    s_add_u32 s19, s17, 322560
    buffer_load_dwordx4 v[92:95], v7, s[8:11], s19 offen
    s_waitcnt vmcnt(10)
    v_mfma_f32_16x16x32_bf16 v[16:19], v[32:35], v[48:51], v[16:19]
    v_mfma_f32_16x16x32_bf16 v[20:23], v[32:35], v[52:55], v[20:23]
    v_mfma_f32_16x16x32_bf16 v[24:27], v[32:35], v[56:59], v[24:27]
    v_mfma_f32_16x16x32_bf16 v[28:31], v[32:35], v[60:63], v[28:31]
    s_add_u32 s19, s5, 919552
    buffer_load_dwordx4 v[32:35], v7, s[8:11], s19 offen
    s_add_u32 s19, s17, 61440
    buffer_load_dwordx4 v[48:51], v7, s[8:11], s19 offen
    s_add_u32 s19, s17, 62464
    buffer_load_dwordx4 v[52:55], v7, s[8:11], s19 offen
    s_add_u32 s19, s17, 323584
    buffer_load_dwordx4 v[56:59], v7, s[8:11], s19 offen
    s_add_u32 s19, s17, 324608
    buffer_load_dwordx4 v[60:63], v7, s[8:11], s19 offen
    s_waitcnt vmcnt(10)
    v_mfma_f32_16x16x32_bf16 v[16:19], v[36:39], v[64:67], v[16:19]
    v_mfma_f32_16x16x32_bf16 v[20:23], v[36:39], v[68:71], v[20:23]
    v_mfma_f32_16x16x32_bf16 v[24:27], v[36:39], v[72:75], v[24:27]
    v_mfma_f32_16x16x32_bf16 v[28:31], v[36:39], v[76:79], v[28:31]
    s_add_u32 s19, s5, 920576
    buffer_load_dwordx4 v[36:39], v7, s[8:11], s19 offen
    s_add_u32 s19, s17, 63488
    buffer_load_dwordx4 v[64:67], v7, s[8:11], s19 offen
    s_add_u32 s19, s17, 64512
    buffer_load_dwordx4 v[68:71], v7, s[8:11], s19 offen
    s_add_u32 s19, s17, 325632
    buffer_load_dwordx4 v[72:75], v7, s[8:11], s19 offen
    s_add_u32 s19, s17, 326656
    buffer_load_dwordx4 v[76:79], v7, s[8:11], s19 offen
    s_waitcnt vmcnt(10)
    v_mfma_f32_16x16x32_bf16 v[16:19], v[40:43], v[80:83], v[16:19]
    v_mfma_f32_16x16x32_bf16 v[20:23], v[40:43], v[84:87], v[20:23]
    v_mfma_f32_16x16x32_bf16 v[24:27], v[40:43], v[88:91], v[24:27]
    v_mfma_f32_16x16x32_bf16 v[28:31], v[40:43], v[92:95], v[28:31]
    s_add_u32 s19, s5, 1048576
    buffer_load_dwordx4 v[40:43], v7, s[8:11], s19 offen
    s_add_u32 s19, s17, 65536
    buffer_load_dwordx4 v[80:83], v7, s[8:11], s19 offen
    s_add_u32 s19, s17, 66560
    buffer_load_dwordx4 v[84:87], v7, s[8:11], s19 offen
    s_add_u32 s19, s17, 327680
    buffer_load_dwordx4 v[88:91], v7, s[8:11], s19 offen
    s_add_u32 s19, s17, 328704
    buffer_load_dwordx4 v[92:95], v7, s[8:11], s19 offen
    s_waitcnt vmcnt(10)
    v_mfma_f32_16x16x32_bf16 v[16:19], v[32:35], v[48:51], v[16:19]
    v_mfma_f32_16x16x32_bf16 v[20:23], v[32:35], v[52:55], v[20:23]
    v_mfma_f32_16x16x32_bf16 v[24:27], v[32:35], v[56:59], v[24:27]
    v_mfma_f32_16x16x32_bf16 v[28:31], v[32:35], v[60:63], v[28:31]
    s_add_u32 s19, s5, 1049600
    buffer_load_dwordx4 v[32:35], v7, s[8:11], s19 offen
    s_add_u32 s19, s17, 67584
    buffer_load_dwordx4 v[48:51], v7, s[8:11], s19 offen
    s_add_u32 s19, s17, 68608
    buffer_load_dwordx4 v[52:55], v7, s[8:11], s19 offen
    s_add_u32 s19, s17, 329728
    buffer_load_dwordx4 v[56:59], v7, s[8:11], s19 offen
    s_add_u32 s19, s17, 330752
    buffer_load_dwordx4 v[60:63], v7, s[8:11], s19 offen
    s_waitcnt vmcnt(10)
    v_mfma_f32_16x16x32_bf16 v[16:19], v[36:39], v[64:67], v[16:19]
    v_mfma_f32_16x16x32_bf16 v[20:23], v[36:39], v[68:71], v[20:23]
    v_mfma_f32_16x16x32_bf16 v[24:27], v[36:39], v[72:75], v[24:27]
    v_mfma_f32_16x16x32_bf16 v[28:31], v[36:39], v[76:79], v[28:31]
    s_add_u32 s19, s5, 1050624
    buffer_load_dwordx4 v[36:39], v7, s[8:11], s19 offen
    s_add_u32 s19, s17, 69632
    buffer_load_dwordx4 v[64:67], v7, s[8:11], s19 offen
    s_add_u32 s19, s17, 70656
    buffer_load_dwordx4 v[68:71], v7, s[8:11], s19 offen
    s_add_u32 s19, s17, 331776
    buffer_load_dwordx4 v[72:75], v7, s[8:11], s19 offen
    s_add_u32 s19, s17, 332800
    buffer_load_dwordx4 v[76:79], v7, s[8:11], s19 offen
    s_waitcnt vmcnt(10)
    v_mfma_f32_16x16x32_bf16 v[16:19], v[40:43], v[80:83], v[16:19]
    v_mfma_f32_16x16x32_bf16 v[20:23], v[40:43], v[84:87], v[20:23]
    v_mfma_f32_16x16x32_bf16 v[24:27], v[40:43], v[88:91], v[24:27]
    v_mfma_f32_16x16x32_bf16 v[28:31], v[40:43], v[92:95], v[28:31]
    s_add_u32 s19, s5, 1051648
    buffer_load_dwordx4 v[40:43], v7, s[8:11], s19 offen
    s_add_u32 s19, s17, 71680
    buffer_load_dwordx4 v[80:83], v7, s[8:11], s19 offen
    s_add_u32 s19, s17, 72704
    buffer_load_dwordx4 v[84:87], v7, s[8:11], s19 offen
    s_add_u32 s19, s17, 333824
    buffer_load_dwordx4 v[88:91], v7, s[8:11], s19 offen
    s_add_u32 s19, s17, 334848
    buffer_load_dwordx4 v[92:95], v7, s[8:11], s19 offen
    s_waitcnt vmcnt(10)
    v_mfma_f32_16x16x32_bf16 v[16:19], v[32:35], v[48:51], v[16:19]
    v_mfma_f32_16x16x32_bf16 v[20:23], v[32:35], v[52:55], v[20:23]
    v_mfma_f32_16x16x32_bf16 v[24:27], v[32:35], v[56:59], v[24:27]
    v_mfma_f32_16x16x32_bf16 v[28:31], v[32:35], v[60:63], v[28:31]
    s_add_u32 s19, s5, 1179648
    buffer_load_dwordx4 v[32:35], v7, s[8:11], s19 offen
    s_add_u32 s19, s17, 73728
    buffer_load_dwordx4 v[48:51], v7, s[8:11], s19 offen
    s_add_u32 s19, s17, 74752
    buffer_load_dwordx4 v[52:55], v7, s[8:11], s19 offen
    s_add_u32 s19, s17, 335872
    buffer_load_dwordx4 v[56:59], v7, s[8:11], s19 offen
    s_add_u32 s19, s17, 336896
    buffer_load_dwordx4 v[60:63], v7, s[8:11], s19 offen
    s_waitcnt vmcnt(10)
    v_mfma_f32_16x16x32_bf16 v[16:19], v[36:39], v[64:67], v[16:19]
    v_mfma_f32_16x16x32_bf16 v[20:23], v[36:39], v[68:71], v[20:23]
    v_mfma_f32_16x16x32_bf16 v[24:27], v[36:39], v[72:75], v[24:27]
    v_mfma_f32_16x16x32_bf16 v[28:31], v[36:39], v[76:79], v[28:31]
    s_add_u32 s19, s5, 1180672
    buffer_load_dwordx4 v[36:39], v7, s[8:11], s19 offen
    s_add_u32 s19, s17, 75776
    buffer_load_dwordx4 v[64:67], v7, s[8:11], s19 offen
    s_add_u32 s19, s17, 76800
    buffer_load_dwordx4 v[68:71], v7, s[8:11], s19 offen
    s_add_u32 s19, s17, 337920
    buffer_load_dwordx4 v[72:75], v7, s[8:11], s19 offen
    s_add_u32 s19, s17, 338944
    buffer_load_dwordx4 v[76:79], v7, s[8:11], s19 offen
    s_waitcnt vmcnt(10)
    v_mfma_f32_16x16x32_bf16 v[16:19], v[40:43], v[80:83], v[16:19]
    v_mfma_f32_16x16x32_bf16 v[20:23], v[40:43], v[84:87], v[20:23]
    v_mfma_f32_16x16x32_bf16 v[24:27], v[40:43], v[88:91], v[24:27]
    v_mfma_f32_16x16x32_bf16 v[28:31], v[40:43], v[92:95], v[28:31]
    s_add_u32 s19, s5, 1181696
    buffer_load_dwordx4 v[40:43], v7, s[8:11], s19 offen
    s_add_u32 s19, s17, 77824
    buffer_load_dwordx4 v[80:83], v7, s[8:11], s19 offen
    s_add_u32 s19, s17, 78848
    buffer_load_dwordx4 v[84:87], v7, s[8:11], s19 offen
    s_add_u32 s19, s17, 339968
    buffer_load_dwordx4 v[88:91], v7, s[8:11], s19 offen
    s_add_u32 s19, s17, 340992
    buffer_load_dwordx4 v[92:95], v7, s[8:11], s19 offen
    s_waitcnt vmcnt(10)
    v_mfma_f32_16x16x32_bf16 v[16:19], v[32:35], v[48:51], v[16:19]
    v_mfma_f32_16x16x32_bf16 v[20:23], v[32:35], v[52:55], v[20:23]
    v_mfma_f32_16x16x32_bf16 v[24:27], v[32:35], v[56:59], v[24:27]
    v_mfma_f32_16x16x32_bf16 v[28:31], v[32:35], v[60:63], v[28:31]
    s_add_u32 s19, s5, 1182720
    buffer_load_dwordx4 v[32:35], v7, s[8:11], s19 offen
    s_add_u32 s19, s17, 79872
    buffer_load_dwordx4 v[48:51], v7, s[8:11], s19 offen
    s_add_u32 s19, s17, 80896
    buffer_load_dwordx4 v[52:55], v7, s[8:11], s19 offen
    s_add_u32 s19, s17, 342016
    buffer_load_dwordx4 v[56:59], v7, s[8:11], s19 offen
    s_add_u32 s19, s17, 343040
    buffer_load_dwordx4 v[60:63], v7, s[8:11], s19 offen
    s_waitcnt vmcnt(10)
    v_mfma_f32_16x16x32_bf16 v[16:19], v[36:39], v[64:67], v[16:19]
    v_mfma_f32_16x16x32_bf16 v[20:23], v[36:39], v[68:71], v[20:23]
    v_mfma_f32_16x16x32_bf16 v[24:27], v[36:39], v[72:75], v[24:27]
    v_mfma_f32_16x16x32_bf16 v[28:31], v[36:39], v[76:79], v[28:31]
    s_add_u32 s19, s5, 1310720
    buffer_load_dwordx4 v[36:39], v7, s[8:11], s19 offen
    s_add_u32 s19, s17, 81920
    buffer_load_dwordx4 v[64:67], v7, s[8:11], s19 offen
    s_add_u32 s19, s17, 82944
    buffer_load_dwordx4 v[68:71], v7, s[8:11], s19 offen
    s_add_u32 s19, s17, 344064
    buffer_load_dwordx4 v[72:75], v7, s[8:11], s19 offen
    s_add_u32 s19, s17, 345088
    buffer_load_dwordx4 v[76:79], v7, s[8:11], s19 offen
    s_waitcnt vmcnt(10)
    v_mfma_f32_16x16x32_bf16 v[16:19], v[40:43], v[80:83], v[16:19]
    v_mfma_f32_16x16x32_bf16 v[20:23], v[40:43], v[84:87], v[20:23]
    v_mfma_f32_16x16x32_bf16 v[24:27], v[40:43], v[88:91], v[24:27]
    v_mfma_f32_16x16x32_bf16 v[28:31], v[40:43], v[92:95], v[28:31]
    s_add_u32 s19, s5, 1311744
    buffer_load_dwordx4 v[40:43], v7, s[8:11], s19 offen
    s_add_u32 s19, s17, 83968
    buffer_load_dwordx4 v[80:83], v7, s[8:11], s19 offen
    s_add_u32 s19, s17, 84992
    buffer_load_dwordx4 v[84:87], v7, s[8:11], s19 offen
    s_add_u32 s19, s17, 346112
    buffer_load_dwordx4 v[88:91], v7, s[8:11], s19 offen
    s_add_u32 s19, s17, 347136
    buffer_load_dwordx4 v[92:95], v7, s[8:11], s19 offen
    s_waitcnt vmcnt(10)
    v_mfma_f32_16x16x32_bf16 v[16:19], v[32:35], v[48:51], v[16:19]
    v_mfma_f32_16x16x32_bf16 v[20:23], v[32:35], v[52:55], v[20:23]
    v_mfma_f32_16x16x32_bf16 v[24:27], v[32:35], v[56:59], v[24:27]
    v_mfma_f32_16x16x32_bf16 v[28:31], v[32:35], v[60:63], v[28:31]
    s_add_u32 s19, s5, 1312768
    buffer_load_dwordx4 v[32:35], v7, s[8:11], s19 offen
    s_add_u32 s19, s17, 86016
    buffer_load_dwordx4 v[48:51], v7, s[8:11], s19 offen
    s_add_u32 s19, s17, 87040
    buffer_load_dwordx4 v[52:55], v7, s[8:11], s19 offen
    s_add_u32 s19, s17, 348160
    buffer_load_dwordx4 v[56:59], v7, s[8:11], s19 offen
    s_add_u32 s19, s17, 349184
    buffer_load_dwordx4 v[60:63], v7, s[8:11], s19 offen
    s_waitcnt vmcnt(10)
    v_mfma_f32_16x16x32_bf16 v[16:19], v[36:39], v[64:67], v[16:19]
    v_mfma_f32_16x16x32_bf16 v[20:23], v[36:39], v[68:71], v[20:23]
    v_mfma_f32_16x16x32_bf16 v[24:27], v[36:39], v[72:75], v[24:27]
    v_mfma_f32_16x16x32_bf16 v[28:31], v[36:39], v[76:79], v[28:31]
    s_add_u32 s19, s5, 1313792
    buffer_load_dwordx4 v[36:39], v7, s[8:11], s19 offen
    s_add_u32 s19, s17, 88064
    buffer_load_dwordx4 v[64:67], v7, s[8:11], s19 offen
    s_add_u32 s19, s17, 89088
    buffer_load_dwordx4 v[68:71], v7, s[8:11], s19 offen
    s_add_u32 s19, s17, 350208
    buffer_load_dwordx4 v[72:75], v7, s[8:11], s19 offen
    s_add_u32 s19, s17, 351232
    buffer_load_dwordx4 v[76:79], v7, s[8:11], s19 offen
    s_waitcnt vmcnt(10)
    v_mfma_f32_16x16x32_bf16 v[16:19], v[40:43], v[80:83], v[16:19]
    v_mfma_f32_16x16x32_bf16 v[20:23], v[40:43], v[84:87], v[20:23]
    v_mfma_f32_16x16x32_bf16 v[24:27], v[40:43], v[88:91], v[24:27]
    v_mfma_f32_16x16x32_bf16 v[28:31], v[40:43], v[92:95], v[28:31]
    s_add_u32 s19, s5, 1441792
    buffer_load_dwordx4 v[40:43], v7, s[8:11], s19 offen
    s_add_u32 s19, s17, 90112
    buffer_load_dwordx4 v[80:83], v7, s[8:11], s19 offen
    s_add_u32 s19, s17, 91136
    buffer_load_dwordx4 v[84:87], v7, s[8:11], s19 offen
    s_add_u32 s19, s17, 352256
    buffer_load_dwordx4 v[88:91], v7, s[8:11], s19 offen
    s_add_u32 s19, s17, 353280
    buffer_load_dwordx4 v[92:95], v7, s[8:11], s19 offen
    s_waitcnt vmcnt(10)
    v_mfma_f32_16x16x32_bf16 v[16:19], v[32:35], v[48:51], v[16:19]
    v_mfma_f32_16x16x32_bf16 v[20:23], v[32:35], v[52:55], v[20:23]
    v_mfma_f32_16x16x32_bf16 v[24:27], v[32:35], v[56:59], v[24:27]
    v_mfma_f32_16x16x32_bf16 v[28:31], v[32:35], v[60:63], v[28:31]
    s_add_u32 s19, s5, 1442816
    buffer_load_dwordx4 v[32:35], v7, s[8:11], s19 offen
    s_add_u32 s19, s17, 92160
    buffer_load_dwordx4 v[48:51], v7, s[8:11], s19 offen
    s_add_u32 s19, s17, 93184
    buffer_load_dwordx4 v[52:55], v7, s[8:11], s19 offen
    s_add_u32 s19, s17, 354304
    buffer_load_dwordx4 v[56:59], v7, s[8:11], s19 offen
    s_add_u32 s19, s17, 355328
    buffer_load_dwordx4 v[60:63], v7, s[8:11], s19 offen
    s_waitcnt vmcnt(10)
    v_mfma_f32_16x16x32_bf16 v[16:19], v[36:39], v[64:67], v[16:19]
    v_mfma_f32_16x16x32_bf16 v[20:23], v[36:39], v[68:71], v[20:23]
    v_mfma_f32_16x16x32_bf16 v[24:27], v[36:39], v[72:75], v[24:27]
    v_mfma_f32_16x16x32_bf16 v[28:31], v[36:39], v[76:79], v[28:31]
    s_add_u32 s19, s5, 1443840
    buffer_load_dwordx4 v[36:39], v7, s[8:11], s19 offen
    s_add_u32 s19, s17, 94208
    buffer_load_dwordx4 v[64:67], v7, s[8:11], s19 offen
    s_add_u32 s19, s17, 95232
    buffer_load_dwordx4 v[68:71], v7, s[8:11], s19 offen
    s_add_u32 s19, s17, 356352
    buffer_load_dwordx4 v[72:75], v7, s[8:11], s19 offen
    s_add_u32 s19, s17, 357376
    buffer_load_dwordx4 v[76:79], v7, s[8:11], s19 offen
    s_waitcnt vmcnt(10)
    v_mfma_f32_16x16x32_bf16 v[16:19], v[40:43], v[80:83], v[16:19]
    v_mfma_f32_16x16x32_bf16 v[20:23], v[40:43], v[84:87], v[20:23]
    v_mfma_f32_16x16x32_bf16 v[24:27], v[40:43], v[88:91], v[24:27]
    v_mfma_f32_16x16x32_bf16 v[28:31], v[40:43], v[92:95], v[28:31]
    s_add_u32 s19, s5, 1444864
    buffer_load_dwordx4 v[40:43], v7, s[8:11], s19 offen
    s_add_u32 s19, s17, 96256
    buffer_load_dwordx4 v[80:83], v7, s[8:11], s19 offen
    s_add_u32 s19, s17, 97280
    buffer_load_dwordx4 v[84:87], v7, s[8:11], s19 offen
    s_add_u32 s19, s17, 358400
    buffer_load_dwordx4 v[88:91], v7, s[8:11], s19 offen
    s_add_u32 s19, s17, 359424
    buffer_load_dwordx4 v[92:95], v7, s[8:11], s19 offen
    s_waitcnt vmcnt(10)
    v_mfma_f32_16x16x32_bf16 v[16:19], v[32:35], v[48:51], v[16:19]
    v_mfma_f32_16x16x32_bf16 v[20:23], v[32:35], v[52:55], v[20:23]
    v_mfma_f32_16x16x32_bf16 v[24:27], v[32:35], v[56:59], v[24:27]
    v_mfma_f32_16x16x32_bf16 v[28:31], v[32:35], v[60:63], v[28:31]
    s_add_u32 s19, s5, 1572864
    buffer_load_dwordx4 v[32:35], v7, s[8:11], s19 offen
    s_add_u32 s19, s17, 98304
    buffer_load_dwordx4 v[48:51], v7, s[8:11], s19 offen
    s_add_u32 s19, s17, 99328
    buffer_load_dwordx4 v[52:55], v7, s[8:11], s19 offen
    s_add_u32 s19, s17, 360448
    buffer_load_dwordx4 v[56:59], v7, s[8:11], s19 offen
    s_add_u32 s19, s17, 361472
    buffer_load_dwordx4 v[60:63], v7, s[8:11], s19 offen
    s_waitcnt vmcnt(10)
    v_mfma_f32_16x16x32_bf16 v[16:19], v[36:39], v[64:67], v[16:19]
    v_mfma_f32_16x16x32_bf16 v[20:23], v[36:39], v[68:71], v[20:23]
    v_mfma_f32_16x16x32_bf16 v[24:27], v[36:39], v[72:75], v[24:27]
    v_mfma_f32_16x16x32_bf16 v[28:31], v[36:39], v[76:79], v[28:31]
    s_add_u32 s19, s5, 1573888
    buffer_load_dwordx4 v[36:39], v7, s[8:11], s19 offen
    s_add_u32 s19, s17, 100352
    buffer_load_dwordx4 v[64:67], v7, s[8:11], s19 offen
    s_add_u32 s19, s17, 101376
    buffer_load_dwordx4 v[68:71], v7, s[8:11], s19 offen
    s_add_u32 s19, s17, 362496
    buffer_load_dwordx4 v[72:75], v7, s[8:11], s19 offen
    s_add_u32 s19, s17, 363520
    buffer_load_dwordx4 v[76:79], v7, s[8:11], s19 offen
    s_waitcnt vmcnt(10)
    v_mfma_f32_16x16x32_bf16 v[16:19], v[40:43], v[80:83], v[16:19]
    v_mfma_f32_16x16x32_bf16 v[20:23], v[40:43], v[84:87], v[20:23]
    v_mfma_f32_16x16x32_bf16 v[24:27], v[40:43], v[88:91], v[24:27]
    v_mfma_f32_16x16x32_bf16 v[28:31], v[40:43], v[92:95], v[28:31]
    s_add_u32 s19, s5, 1574912
    buffer_load_dwordx4 v[40:43], v7, s[8:11], s19 offen
    s_add_u32 s19, s17, 102400
    buffer_load_dwordx4 v[80:83], v7, s[8:11], s19 offen
    s_add_u32 s19, s17, 103424
    buffer_load_dwordx4 v[84:87], v7, s[8:11], s19 offen
    s_add_u32 s19, s17, 364544
    buffer_load_dwordx4 v[88:91], v7, s[8:11], s19 offen
    s_add_u32 s19, s17, 365568
    buffer_load_dwordx4 v[92:95], v7, s[8:11], s19 offen
    s_waitcnt vmcnt(10)
    v_mfma_f32_16x16x32_bf16 v[16:19], v[32:35], v[48:51], v[16:19]
    v_mfma_f32_16x16x32_bf16 v[20:23], v[32:35], v[52:55], v[20:23]
    v_mfma_f32_16x16x32_bf16 v[24:27], v[32:35], v[56:59], v[24:27]
    v_mfma_f32_16x16x32_bf16 v[28:31], v[32:35], v[60:63], v[28:31]
    s_add_u32 s19, s5, 1575936
    buffer_load_dwordx4 v[32:35], v7, s[8:11], s19 offen
    s_add_u32 s19, s17, 104448
    buffer_load_dwordx4 v[48:51], v7, s[8:11], s19 offen
    s_add_u32 s19, s17, 105472
    buffer_load_dwordx4 v[52:55], v7, s[8:11], s19 offen
    s_add_u32 s19, s17, 366592
    buffer_load_dwordx4 v[56:59], v7, s[8:11], s19 offen
    s_add_u32 s19, s17, 367616
    buffer_load_dwordx4 v[60:63], v7, s[8:11], s19 offen
    s_waitcnt vmcnt(10)
    v_mfma_f32_16x16x32_bf16 v[16:19], v[36:39], v[64:67], v[16:19]
    v_mfma_f32_16x16x32_bf16 v[20:23], v[36:39], v[68:71], v[20:23]
    v_mfma_f32_16x16x32_bf16 v[24:27], v[36:39], v[72:75], v[24:27]
    v_mfma_f32_16x16x32_bf16 v[28:31], v[36:39], v[76:79], v[28:31]
    s_add_u32 s19, s5, 1703936
    buffer_load_dwordx4 v[36:39], v7, s[8:11], s19 offen
    s_add_u32 s19, s17, 106496
    buffer_load_dwordx4 v[64:67], v7, s[8:11], s19 offen
    s_add_u32 s19, s17, 107520
    buffer_load_dwordx4 v[68:71], v7, s[8:11], s19 offen
    s_add_u32 s19, s17, 368640
    buffer_load_dwordx4 v[72:75], v7, s[8:11], s19 offen
    s_add_u32 s19, s17, 369664
    buffer_load_dwordx4 v[76:79], v7, s[8:11], s19 offen
    s_waitcnt vmcnt(10)
    v_mfma_f32_16x16x32_bf16 v[16:19], v[40:43], v[80:83], v[16:19]
    v_mfma_f32_16x16x32_bf16 v[20:23], v[40:43], v[84:87], v[20:23]
    v_mfma_f32_16x16x32_bf16 v[24:27], v[40:43], v[88:91], v[24:27]
    v_mfma_f32_16x16x32_bf16 v[28:31], v[40:43], v[92:95], v[28:31]
    s_add_u32 s19, s5, 1704960
    buffer_load_dwordx4 v[40:43], v7, s[8:11], s19 offen
    s_add_u32 s19, s17, 108544
    buffer_load_dwordx4 v[80:83], v7, s[8:11], s19 offen
    s_add_u32 s19, s17, 109568
    buffer_load_dwordx4 v[84:87], v7, s[8:11], s19 offen
    s_add_u32 s19, s17, 370688
    buffer_load_dwordx4 v[88:91], v7, s[8:11], s19 offen
    s_add_u32 s19, s17, 371712
    buffer_load_dwordx4 v[92:95], v7, s[8:11], s19 offen
    s_waitcnt vmcnt(10)
    v_mfma_f32_16x16x32_bf16 v[16:19], v[32:35], v[48:51], v[16:19]
    v_mfma_f32_16x16x32_bf16 v[20:23], v[32:35], v[52:55], v[20:23]
    v_mfma_f32_16x16x32_bf16 v[24:27], v[32:35], v[56:59], v[24:27]
    v_mfma_f32_16x16x32_bf16 v[28:31], v[32:35], v[60:63], v[28:31]
    s_add_u32 s19, s5, 1705984
    buffer_load_dwordx4 v[32:35], v7, s[8:11], s19 offen
    s_add_u32 s19, s17, 110592
    buffer_load_dwordx4 v[48:51], v7, s[8:11], s19 offen
    s_add_u32 s19, s17, 111616
    buffer_load_dwordx4 v[52:55], v7, s[8:11], s19 offen
    s_add_u32 s19, s17, 372736
    buffer_load_dwordx4 v[56:59], v7, s[8:11], s19 offen
    s_add_u32 s19, s17, 373760
    buffer_load_dwordx4 v[60:63], v7, s[8:11], s19 offen
    s_waitcnt vmcnt(10)
    v_mfma_f32_16x16x32_bf16 v[16:19], v[36:39], v[64:67], v[16:19]
    v_mfma_f32_16x16x32_bf16 v[20:23], v[36:39], v[68:71], v[20:23]
    v_mfma_f32_16x16x32_bf16 v[24:27], v[36:39], v[72:75], v[24:27]
    v_mfma_f32_16x16x32_bf16 v[28:31], v[36:39], v[76:79], v[28:31]
    s_add_u32 s19, s5, 1707008
    buffer_load_dwordx4 v[36:39], v7, s[8:11], s19 offen
    s_add_u32 s19, s17, 112640
    buffer_load_dwordx4 v[64:67], v7, s[8:11], s19 offen
    s_add_u32 s19, s17, 113664
    buffer_load_dwordx4 v[68:71], v7, s[8:11], s19 offen
    s_add_u32 s19, s17, 374784
    buffer_load_dwordx4 v[72:75], v7, s[8:11], s19 offen
    s_add_u32 s19, s17, 375808
    buffer_load_dwordx4 v[76:79], v7, s[8:11], s19 offen
    s_waitcnt vmcnt(10)
    v_mfma_f32_16x16x32_bf16 v[16:19], v[40:43], v[80:83], v[16:19]
    v_mfma_f32_16x16x32_bf16 v[20:23], v[40:43], v[84:87], v[20:23]
    v_mfma_f32_16x16x32_bf16 v[24:27], v[40:43], v[88:91], v[24:27]
    v_mfma_f32_16x16x32_bf16 v[28:31], v[40:43], v[92:95], v[28:31]
    s_add_u32 s19, s5, 1835008
    buffer_load_dwordx4 v[40:43], v7, s[8:11], s19 offen
    s_add_u32 s19, s17, 114688
    buffer_load_dwordx4 v[80:83], v7, s[8:11], s19 offen
    s_add_u32 s19, s17, 115712
    buffer_load_dwordx4 v[84:87], v7, s[8:11], s19 offen
    s_add_u32 s19, s17, 376832
    buffer_load_dwordx4 v[88:91], v7, s[8:11], s19 offen
    s_add_u32 s19, s17, 377856
    buffer_load_dwordx4 v[92:95], v7, s[8:11], s19 offen
    s_waitcnt vmcnt(10)
    v_mfma_f32_16x16x32_bf16 v[16:19], v[32:35], v[48:51], v[16:19]
    v_mfma_f32_16x16x32_bf16 v[20:23], v[32:35], v[52:55], v[20:23]
    v_mfma_f32_16x16x32_bf16 v[24:27], v[32:35], v[56:59], v[24:27]
    v_mfma_f32_16x16x32_bf16 v[28:31], v[32:35], v[60:63], v[28:31]
    s_add_u32 s19, s5, 1836032
    buffer_load_dwordx4 v[32:35], v7, s[8:11], s19 offen
    s_add_u32 s19, s17, 116736
    buffer_load_dwordx4 v[48:51], v7, s[8:11], s19 offen
    s_add_u32 s19, s17, 117760
    buffer_load_dwordx4 v[52:55], v7, s[8:11], s19 offen
    s_add_u32 s19, s17, 378880
    buffer_load_dwordx4 v[56:59], v7, s[8:11], s19 offen
    s_add_u32 s19, s17, 379904
    buffer_load_dwordx4 v[60:63], v7, s[8:11], s19 offen
    s_waitcnt vmcnt(10)
    v_mfma_f32_16x16x32_bf16 v[16:19], v[36:39], v[64:67], v[16:19]
    v_mfma_f32_16x16x32_bf16 v[20:23], v[36:39], v[68:71], v[20:23]
    v_mfma_f32_16x16x32_bf16 v[24:27], v[36:39], v[72:75], v[24:27]
    v_mfma_f32_16x16x32_bf16 v[28:31], v[36:39], v[76:79], v[28:31]
    s_add_u32 s19, s5, 1837056
    buffer_load_dwordx4 v[36:39], v7, s[8:11], s19 offen
    s_add_u32 s19, s17, 118784
    buffer_load_dwordx4 v[64:67], v7, s[8:11], s19 offen
    s_add_u32 s19, s17, 119808
    buffer_load_dwordx4 v[68:71], v7, s[8:11], s19 offen
    s_add_u32 s19, s17, 380928
    buffer_load_dwordx4 v[72:75], v7, s[8:11], s19 offen
    s_add_u32 s19, s17, 381952
    buffer_load_dwordx4 v[76:79], v7, s[8:11], s19 offen
    s_waitcnt vmcnt(10)
    v_mfma_f32_16x16x32_bf16 v[16:19], v[40:43], v[80:83], v[16:19]
    v_mfma_f32_16x16x32_bf16 v[20:23], v[40:43], v[84:87], v[20:23]
    v_mfma_f32_16x16x32_bf16 v[24:27], v[40:43], v[88:91], v[24:27]
    v_mfma_f32_16x16x32_bf16 v[28:31], v[40:43], v[92:95], v[28:31]
    s_add_u32 s19, s5, 1838080
    buffer_load_dwordx4 v[40:43], v7, s[8:11], s19 offen
    s_add_u32 s19, s17, 120832
    buffer_load_dwordx4 v[80:83], v7, s[8:11], s19 offen
    s_add_u32 s19, s17, 121856
    buffer_load_dwordx4 v[84:87], v7, s[8:11], s19 offen
    s_add_u32 s19, s17, 382976
    buffer_load_dwordx4 v[88:91], v7, s[8:11], s19 offen
    s_add_u32 s19, s17, 384000
    buffer_load_dwordx4 v[92:95], v7, s[8:11], s19 offen
    s_waitcnt vmcnt(10)
    v_mfma_f32_16x16x32_bf16 v[16:19], v[32:35], v[48:51], v[16:19]
    v_mfma_f32_16x16x32_bf16 v[20:23], v[32:35], v[52:55], v[20:23]
    v_mfma_f32_16x16x32_bf16 v[24:27], v[32:35], v[56:59], v[24:27]
    v_mfma_f32_16x16x32_bf16 v[28:31], v[32:35], v[60:63], v[28:31]
    s_add_u32 s19, s5, 1966080
    buffer_load_dwordx4 v[32:35], v7, s[8:11], s19 offen
    s_add_u32 s19, s17, 122880
    buffer_load_dwordx4 v[48:51], v7, s[8:11], s19 offen
    s_add_u32 s19, s17, 123904
    buffer_load_dwordx4 v[52:55], v7, s[8:11], s19 offen
    s_add_u32 s19, s17, 385024
    buffer_load_dwordx4 v[56:59], v7, s[8:11], s19 offen
    s_add_u32 s19, s17, 386048
    buffer_load_dwordx4 v[60:63], v7, s[8:11], s19 offen
    s_waitcnt vmcnt(10)
    v_mfma_f32_16x16x32_bf16 v[16:19], v[36:39], v[64:67], v[16:19]
    v_mfma_f32_16x16x32_bf16 v[20:23], v[36:39], v[68:71], v[20:23]
    v_mfma_f32_16x16x32_bf16 v[24:27], v[36:39], v[72:75], v[24:27]
    v_mfma_f32_16x16x32_bf16 v[28:31], v[36:39], v[76:79], v[28:31]
    s_add_u32 s19, s5, 1967104
    buffer_load_dwordx4 v[36:39], v7, s[8:11], s19 offen
    s_add_u32 s19, s17, 124928
    buffer_load_dwordx4 v[64:67], v7, s[8:11], s19 offen
    s_add_u32 s19, s17, 125952
    buffer_load_dwordx4 v[68:71], v7, s[8:11], s19 offen
    s_add_u32 s19, s17, 387072
    buffer_load_dwordx4 v[72:75], v7, s[8:11], s19 offen
    s_add_u32 s19, s17, 388096
    buffer_load_dwordx4 v[76:79], v7, s[8:11], s19 offen
    s_waitcnt vmcnt(10)
    v_mfma_f32_16x16x32_bf16 v[16:19], v[40:43], v[80:83], v[16:19]
    v_mfma_f32_16x16x32_bf16 v[20:23], v[40:43], v[84:87], v[20:23]
    v_mfma_f32_16x16x32_bf16 v[24:27], v[40:43], v[88:91], v[24:27]
    v_mfma_f32_16x16x32_bf16 v[28:31], v[40:43], v[92:95], v[28:31]
    s_add_u32 s19, s5, 1968128
    buffer_load_dwordx4 v[40:43], v7, s[8:11], s19 offen
    s_add_u32 s19, s17, 126976
    buffer_load_dwordx4 v[80:83], v7, s[8:11], s19 offen
    s_add_u32 s19, s17, 128000
    buffer_load_dwordx4 v[84:87], v7, s[8:11], s19 offen
    s_add_u32 s19, s17, 389120
    buffer_load_dwordx4 v[88:91], v7, s[8:11], s19 offen
    s_add_u32 s19, s17, 390144
    buffer_load_dwordx4 v[92:95], v7, s[8:11], s19 offen
    s_waitcnt vmcnt(10)
    v_mfma_f32_16x16x32_bf16 v[16:19], v[32:35], v[48:51], v[16:19]
    v_mfma_f32_16x16x32_bf16 v[20:23], v[32:35], v[52:55], v[20:23]
    v_mfma_f32_16x16x32_bf16 v[24:27], v[32:35], v[56:59], v[24:27]
    v_mfma_f32_16x16x32_bf16 v[28:31], v[32:35], v[60:63], v[28:31]
    s_add_u32 s19, s5, 1969152
    buffer_load_dwordx4 v[32:35], v7, s[8:11], s19 offen
    s_add_u32 s19, s17, 129024
    buffer_load_dwordx4 v[48:51], v7, s[8:11], s19 offen
    s_add_u32 s19, s17, 130048
    buffer_load_dwordx4 v[52:55], v7, s[8:11], s19 offen
    s_add_u32 s19, s17, 391168
    buffer_load_dwordx4 v[56:59], v7, s[8:11], s19 offen
    s_add_u32 s19, s17, 392192
    buffer_load_dwordx4 v[60:63], v7, s[8:11], s19 offen
    s_waitcnt vmcnt(10)
    v_mfma_f32_16x16x32_bf16 v[16:19], v[36:39], v[64:67], v[16:19]
    v_mfma_f32_16x16x32_bf16 v[20:23], v[36:39], v[68:71], v[20:23]
    v_mfma_f32_16x16x32_bf16 v[24:27], v[36:39], v[72:75], v[24:27]
    v_mfma_f32_16x16x32_bf16 v[28:31], v[36:39], v[76:79], v[28:31]
    s_add_u32 s19, s5, 2097152
    buffer_load_dwordx4 v[36:39], v7, s[8:11], s19 offen
    s_add_u32 s19, s17, 131072
    buffer_load_dwordx4 v[64:67], v7, s[8:11], s19 offen
    s_add_u32 s19, s17, 132096
    buffer_load_dwordx4 v[68:71], v7, s[8:11], s19 offen
    s_add_u32 s19, s17, 393216
    buffer_load_dwordx4 v[72:75], v7, s[8:11], s19 offen
    s_add_u32 s19, s17, 394240
    buffer_load_dwordx4 v[76:79], v7, s[8:11], s19 offen
    s_waitcnt vmcnt(10)
    v_mfma_f32_16x16x32_bf16 v[16:19], v[40:43], v[80:83], v[16:19]
    v_mfma_f32_16x16x32_bf16 v[20:23], v[40:43], v[84:87], v[20:23]
    v_mfma_f32_16x16x32_bf16 v[24:27], v[40:43], v[88:91], v[24:27]
    v_mfma_f32_16x16x32_bf16 v[28:31], v[40:43], v[92:95], v[28:31]
    s_add_u32 s19, s5, 2098176
    buffer_load_dwordx4 v[40:43], v7, s[8:11], s19 offen
    s_add_u32 s19, s17, 133120
    buffer_load_dwordx4 v[80:83], v7, s[8:11], s19 offen
    s_add_u32 s19, s17, 134144
    buffer_load_dwordx4 v[84:87], v7, s[8:11], s19 offen
    s_add_u32 s19, s17, 395264
    buffer_load_dwordx4 v[88:91], v7, s[8:11], s19 offen
    s_add_u32 s19, s17, 396288
    buffer_load_dwordx4 v[92:95], v7, s[8:11], s19 offen
    s_waitcnt vmcnt(10)
    v_mfma_f32_16x16x32_bf16 v[16:19], v[32:35], v[48:51], v[16:19]
    v_mfma_f32_16x16x32_bf16 v[20:23], v[32:35], v[52:55], v[20:23]
    v_mfma_f32_16x16x32_bf16 v[24:27], v[32:35], v[56:59], v[24:27]
    v_mfma_f32_16x16x32_bf16 v[28:31], v[32:35], v[60:63], v[28:31]
    s_add_u32 s19, s5, 2099200
    buffer_load_dwordx4 v[32:35], v7, s[8:11], s19 offen
    s_add_u32 s19, s17, 135168
    buffer_load_dwordx4 v[48:51], v7, s[8:11], s19 offen
    s_add_u32 s19, s17, 136192
    buffer_load_dwordx4 v[52:55], v7, s[8:11], s19 offen
    s_add_u32 s19, s17, 397312
    buffer_load_dwordx4 v[56:59], v7, s[8:11], s19 offen
    s_add_u32 s19, s17, 398336
    buffer_load_dwordx4 v[60:63], v7, s[8:11], s19 offen
    s_waitcnt vmcnt(10)
    v_mfma_f32_16x16x32_bf16 v[16:19], v[36:39], v[64:67], v[16:19]
    v_mfma_f32_16x16x32_bf16 v[20:23], v[36:39], v[68:71], v[20:23]
    v_mfma_f32_16x16x32_bf16 v[24:27], v[36:39], v[72:75], v[24:27]
    v_mfma_f32_16x16x32_bf16 v[28:31], v[36:39], v[76:79], v[28:31]
    s_add_u32 s19, s5, 2100224
    buffer_load_dwordx4 v[36:39], v7, s[8:11], s19 offen
    s_add_u32 s19, s17, 137216
    buffer_load_dwordx4 v[64:67], v7, s[8:11], s19 offen
    s_add_u32 s19, s17, 138240
    buffer_load_dwordx4 v[68:71], v7, s[8:11], s19 offen
    s_add_u32 s19, s17, 399360
    buffer_load_dwordx4 v[72:75], v7, s[8:11], s19 offen
    s_add_u32 s19, s17, 400384
    buffer_load_dwordx4 v[76:79], v7, s[8:11], s19 offen
    s_waitcnt vmcnt(10)
    v_mfma_f32_16x16x32_bf16 v[16:19], v[40:43], v[80:83], v[16:19]
    v_mfma_f32_16x16x32_bf16 v[20:23], v[40:43], v[84:87], v[20:23]
    v_mfma_f32_16x16x32_bf16 v[24:27], v[40:43], v[88:91], v[24:27]
    v_mfma_f32_16x16x32_bf16 v[28:31], v[40:43], v[92:95], v[28:31]
    s_add_u32 s19, s5, 2228224
    buffer_load_dwordx4 v[40:43], v7, s[8:11], s19 offen
    s_add_u32 s19, s17, 139264
    buffer_load_dwordx4 v[80:83], v7, s[8:11], s19 offen
    s_add_u32 s19, s17, 140288
    buffer_load_dwordx4 v[84:87], v7, s[8:11], s19 offen
    s_add_u32 s19, s17, 401408
    buffer_load_dwordx4 v[88:91], v7, s[8:11], s19 offen
    s_add_u32 s19, s17, 402432
    buffer_load_dwordx4 v[92:95], v7, s[8:11], s19 offen
    s_waitcnt vmcnt(10)
    v_mfma_f32_16x16x32_bf16 v[16:19], v[32:35], v[48:51], v[16:19]
    v_mfma_f32_16x16x32_bf16 v[20:23], v[32:35], v[52:55], v[20:23]
    v_mfma_f32_16x16x32_bf16 v[24:27], v[32:35], v[56:59], v[24:27]
    v_mfma_f32_16x16x32_bf16 v[28:31], v[32:35], v[60:63], v[28:31]
    s_add_u32 s19, s5, 2229248
    buffer_load_dwordx4 v[32:35], v7, s[8:11], s19 offen
    s_add_u32 s19, s17, 141312
    buffer_load_dwordx4 v[48:51], v7, s[8:11], s19 offen
    s_add_u32 s19, s17, 142336
    buffer_load_dwordx4 v[52:55], v7, s[8:11], s19 offen
    s_add_u32 s19, s17, 403456
    buffer_load_dwordx4 v[56:59], v7, s[8:11], s19 offen
    s_add_u32 s19, s17, 404480
    buffer_load_dwordx4 v[60:63], v7, s[8:11], s19 offen
    s_waitcnt vmcnt(10)
    v_mfma_f32_16x16x32_bf16 v[16:19], v[36:39], v[64:67], v[16:19]
    v_mfma_f32_16x16x32_bf16 v[20:23], v[36:39], v[68:71], v[20:23]
    v_mfma_f32_16x16x32_bf16 v[24:27], v[36:39], v[72:75], v[24:27]
    v_mfma_f32_16x16x32_bf16 v[28:31], v[36:39], v[76:79], v[28:31]
    s_add_u32 s19, s5, 2230272
    buffer_load_dwordx4 v[36:39], v7, s[8:11], s19 offen
    s_add_u32 s19, s17, 143360
    buffer_load_dwordx4 v[64:67], v7, s[8:11], s19 offen
    s_add_u32 s19, s17, 144384
    buffer_load_dwordx4 v[68:71], v7, s[8:11], s19 offen
    s_add_u32 s19, s17, 405504
    buffer_load_dwordx4 v[72:75], v7, s[8:11], s19 offen
    s_add_u32 s19, s17, 406528
    buffer_load_dwordx4 v[76:79], v7, s[8:11], s19 offen
    s_waitcnt vmcnt(10)
    v_mfma_f32_16x16x32_bf16 v[16:19], v[40:43], v[80:83], v[16:19]
    v_mfma_f32_16x16x32_bf16 v[20:23], v[40:43], v[84:87], v[20:23]
    v_mfma_f32_16x16x32_bf16 v[24:27], v[40:43], v[88:91], v[24:27]
    v_mfma_f32_16x16x32_bf16 v[28:31], v[40:43], v[92:95], v[28:31]
    s_add_u32 s19, s5, 2231296
    buffer_load_dwordx4 v[40:43], v7, s[8:11], s19 offen
    s_add_u32 s19, s17, 145408
    buffer_load_dwordx4 v[80:83], v7, s[8:11], s19 offen
    s_add_u32 s19, s17, 146432
    buffer_load_dwordx4 v[84:87], v7, s[8:11], s19 offen
    s_add_u32 s19, s17, 407552
    buffer_load_dwordx4 v[88:91], v7, s[8:11], s19 offen
    s_add_u32 s19, s17, 408576
    buffer_load_dwordx4 v[92:95], v7, s[8:11], s19 offen
    s_waitcnt vmcnt(10)
    v_mfma_f32_16x16x32_bf16 v[16:19], v[32:35], v[48:51], v[16:19]
    v_mfma_f32_16x16x32_bf16 v[20:23], v[32:35], v[52:55], v[20:23]
    v_mfma_f32_16x16x32_bf16 v[24:27], v[32:35], v[56:59], v[24:27]
    v_mfma_f32_16x16x32_bf16 v[28:31], v[32:35], v[60:63], v[28:31]
    s_add_u32 s19, s5, 2359296
    buffer_load_dwordx4 v[32:35], v7, s[8:11], s19 offen
    s_add_u32 s19, s17, 147456
    buffer_load_dwordx4 v[48:51], v7, s[8:11], s19 offen
    s_add_u32 s19, s17, 148480
    buffer_load_dwordx4 v[52:55], v7, s[8:11], s19 offen
    s_add_u32 s19, s17, 409600
    buffer_load_dwordx4 v[56:59], v7, s[8:11], s19 offen
    s_add_u32 s19, s17, 410624
    buffer_load_dwordx4 v[60:63], v7, s[8:11], s19 offen
    s_waitcnt vmcnt(10)
    v_mfma_f32_16x16x32_bf16 v[16:19], v[36:39], v[64:67], v[16:19]
    v_mfma_f32_16x16x32_bf16 v[20:23], v[36:39], v[68:71], v[20:23]
    v_mfma_f32_16x16x32_bf16 v[24:27], v[36:39], v[72:75], v[24:27]
    v_mfma_f32_16x16x32_bf16 v[28:31], v[36:39], v[76:79], v[28:31]
    s_add_u32 s19, s5, 2360320
    buffer_load_dwordx4 v[36:39], v7, s[8:11], s19 offen
    s_add_u32 s19, s17, 149504
    buffer_load_dwordx4 v[64:67], v7, s[8:11], s19 offen
    s_add_u32 s19, s17, 150528
    buffer_load_dwordx4 v[68:71], v7, s[8:11], s19 offen
    s_add_u32 s19, s17, 411648
    buffer_load_dwordx4 v[72:75], v7, s[8:11], s19 offen
    s_add_u32 s19, s17, 412672
    buffer_load_dwordx4 v[76:79], v7, s[8:11], s19 offen
    s_waitcnt vmcnt(10)
    v_mfma_f32_16x16x32_bf16 v[16:19], v[40:43], v[80:83], v[16:19]
    v_mfma_f32_16x16x32_bf16 v[20:23], v[40:43], v[84:87], v[20:23]
    v_mfma_f32_16x16x32_bf16 v[24:27], v[40:43], v[88:91], v[24:27]
    v_mfma_f32_16x16x32_bf16 v[28:31], v[40:43], v[92:95], v[28:31]
    s_add_u32 s19, s5, 2361344
    buffer_load_dwordx4 v[40:43], v7, s[8:11], s19 offen
    s_add_u32 s19, s17, 151552
    buffer_load_dwordx4 v[80:83], v7, s[8:11], s19 offen
    s_add_u32 s19, s17, 152576
    buffer_load_dwordx4 v[84:87], v7, s[8:11], s19 offen
    s_add_u32 s19, s17, 413696
    buffer_load_dwordx4 v[88:91], v7, s[8:11], s19 offen
    s_add_u32 s19, s17, 414720
    buffer_load_dwordx4 v[92:95], v7, s[8:11], s19 offen
    s_waitcnt vmcnt(10)
    v_mfma_f32_16x16x32_bf16 v[16:19], v[32:35], v[48:51], v[16:19]
    v_mfma_f32_16x16x32_bf16 v[20:23], v[32:35], v[52:55], v[20:23]
    v_mfma_f32_16x16x32_bf16 v[24:27], v[32:35], v[56:59], v[24:27]
    v_mfma_f32_16x16x32_bf16 v[28:31], v[32:35], v[60:63], v[28:31]
    s_add_u32 s19, s5, 2362368
    buffer_load_dwordx4 v[32:35], v7, s[8:11], s19 offen
    s_add_u32 s19, s17, 153600
    buffer_load_dwordx4 v[48:51], v7, s[8:11], s19 offen
    s_add_u32 s19, s17, 154624
    buffer_load_dwordx4 v[52:55], v7, s[8:11], s19 offen
    s_add_u32 s19, s17, 415744
    buffer_load_dwordx4 v[56:59], v7, s[8:11], s19 offen
    s_add_u32 s19, s17, 416768
    buffer_load_dwordx4 v[60:63], v7, s[8:11], s19 offen
    s_waitcnt vmcnt(10)
    v_mfma_f32_16x16x32_bf16 v[16:19], v[36:39], v[64:67], v[16:19]
    v_mfma_f32_16x16x32_bf16 v[20:23], v[36:39], v[68:71], v[20:23]
    v_mfma_f32_16x16x32_bf16 v[24:27], v[36:39], v[72:75], v[24:27]
    v_mfma_f32_16x16x32_bf16 v[28:31], v[36:39], v[76:79], v[28:31]
    s_add_u32 s19, s5, 2490368
    buffer_load_dwordx4 v[36:39], v7, s[8:11], s19 offen
    s_add_u32 s19, s17, 155648
    buffer_load_dwordx4 v[64:67], v7, s[8:11], s19 offen
    s_add_u32 s19, s17, 156672
    buffer_load_dwordx4 v[68:71], v7, s[8:11], s19 offen
    s_add_u32 s19, s17, 417792
    buffer_load_dwordx4 v[72:75], v7, s[8:11], s19 offen
    s_add_u32 s19, s17, 418816
    buffer_load_dwordx4 v[76:79], v7, s[8:11], s19 offen
    s_waitcnt vmcnt(10)
    v_mfma_f32_16x16x32_bf16 v[16:19], v[40:43], v[80:83], v[16:19]
    v_mfma_f32_16x16x32_bf16 v[20:23], v[40:43], v[84:87], v[20:23]
    v_mfma_f32_16x16x32_bf16 v[24:27], v[40:43], v[88:91], v[24:27]
    v_mfma_f32_16x16x32_bf16 v[28:31], v[40:43], v[92:95], v[28:31]
    s_add_u32 s19, s5, 2491392
    buffer_load_dwordx4 v[40:43], v7, s[8:11], s19 offen
    s_add_u32 s19, s17, 157696
    buffer_load_dwordx4 v[80:83], v7, s[8:11], s19 offen
    s_add_u32 s19, s17, 158720
    buffer_load_dwordx4 v[84:87], v7, s[8:11], s19 offen
    s_add_u32 s19, s17, 419840
    buffer_load_dwordx4 v[88:91], v7, s[8:11], s19 offen
    s_add_u32 s19, s17, 420864
    buffer_load_dwordx4 v[92:95], v7, s[8:11], s19 offen
    s_waitcnt vmcnt(10)
    v_mfma_f32_16x16x32_bf16 v[16:19], v[32:35], v[48:51], v[16:19]
    v_mfma_f32_16x16x32_bf16 v[20:23], v[32:35], v[52:55], v[20:23]
    v_mfma_f32_16x16x32_bf16 v[24:27], v[32:35], v[56:59], v[24:27]
    v_mfma_f32_16x16x32_bf16 v[28:31], v[32:35], v[60:63], v[28:31]
    s_add_u32 s19, s5, 2492416
    buffer_load_dwordx4 v[32:35], v7, s[8:11], s19 offen
    s_add_u32 s19, s17, 159744
    buffer_load_dwordx4 v[48:51], v7, s[8:11], s19 offen
    s_add_u32 s19, s17, 160768
    buffer_load_dwordx4 v[52:55], v7, s[8:11], s19 offen
    s_add_u32 s19, s17, 421888
    buffer_load_dwordx4 v[56:59], v7, s[8:11], s19 offen
    s_add_u32 s19, s17, 422912
    buffer_load_dwordx4 v[60:63], v7, s[8:11], s19 offen
    s_waitcnt vmcnt(10)
    v_mfma_f32_16x16x32_bf16 v[16:19], v[36:39], v[64:67], v[16:19]
    v_mfma_f32_16x16x32_bf16 v[20:23], v[36:39], v[68:71], v[20:23]
    v_mfma_f32_16x16x32_bf16 v[24:27], v[36:39], v[72:75], v[24:27]
    v_mfma_f32_16x16x32_bf16 v[28:31], v[36:39], v[76:79], v[28:31]
    s_add_u32 s19, s5, 2493440
    buffer_load_dwordx4 v[36:39], v7, s[8:11], s19 offen
    s_add_u32 s19, s17, 161792
    buffer_load_dwordx4 v[64:67], v7, s[8:11], s19 offen
    s_add_u32 s19, s17, 162816
    buffer_load_dwordx4 v[68:71], v7, s[8:11], s19 offen
    s_add_u32 s19, s17, 423936
    buffer_load_dwordx4 v[72:75], v7, s[8:11], s19 offen
    s_add_u32 s19, s17, 424960
    buffer_load_dwordx4 v[76:79], v7, s[8:11], s19 offen
    s_waitcnt vmcnt(10)
    v_mfma_f32_16x16x32_bf16 v[16:19], v[40:43], v[80:83], v[16:19]
    v_mfma_f32_16x16x32_bf16 v[20:23], v[40:43], v[84:87], v[20:23]
    v_mfma_f32_16x16x32_bf16 v[24:27], v[40:43], v[88:91], v[24:27]
    v_mfma_f32_16x16x32_bf16 v[28:31], v[40:43], v[92:95], v[28:31]
    s_add_u32 s19, s5, 2621440
    buffer_load_dwordx4 v[40:43], v7, s[8:11], s19 offen
    s_add_u32 s19, s17, 163840
    buffer_load_dwordx4 v[80:83], v7, s[8:11], s19 offen
    s_add_u32 s19, s17, 164864
    buffer_load_dwordx4 v[84:87], v7, s[8:11], s19 offen
    s_add_u32 s19, s17, 425984
    buffer_load_dwordx4 v[88:91], v7, s[8:11], s19 offen
    s_add_u32 s19, s17, 427008
    buffer_load_dwordx4 v[92:95], v7, s[8:11], s19 offen
    s_waitcnt vmcnt(10)
    v_mfma_f32_16x16x32_bf16 v[16:19], v[32:35], v[48:51], v[16:19]
    v_mfma_f32_16x16x32_bf16 v[20:23], v[32:35], v[52:55], v[20:23]
    v_mfma_f32_16x16x32_bf16 v[24:27], v[32:35], v[56:59], v[24:27]
    v_mfma_f32_16x16x32_bf16 v[28:31], v[32:35], v[60:63], v[28:31]
    s_add_u32 s19, s5, 2622464
    buffer_load_dwordx4 v[32:35], v7, s[8:11], s19 offen
    s_add_u32 s19, s17, 165888
    buffer_load_dwordx4 v[48:51], v7, s[8:11], s19 offen
    s_add_u32 s19, s17, 166912
    buffer_load_dwordx4 v[52:55], v7, s[8:11], s19 offen
    s_add_u32 s19, s17, 428032
    buffer_load_dwordx4 v[56:59], v7, s[8:11], s19 offen
    s_add_u32 s19, s17, 429056
    buffer_load_dwordx4 v[60:63], v7, s[8:11], s19 offen
    s_waitcnt vmcnt(10)
    v_mfma_f32_16x16x32_bf16 v[16:19], v[36:39], v[64:67], v[16:19]
    v_mfma_f32_16x16x32_bf16 v[20:23], v[36:39], v[68:71], v[20:23]
    v_mfma_f32_16x16x32_bf16 v[24:27], v[36:39], v[72:75], v[24:27]
    v_mfma_f32_16x16x32_bf16 v[28:31], v[36:39], v[76:79], v[28:31]
    s_add_u32 s19, s5, 2623488
    buffer_load_dwordx4 v[36:39], v7, s[8:11], s19 offen
    s_add_u32 s19, s17, 167936
    buffer_load_dwordx4 v[64:67], v7, s[8:11], s19 offen
    s_add_u32 s19, s17, 168960
    buffer_load_dwordx4 v[68:71], v7, s[8:11], s19 offen
    s_add_u32 s19, s17, 430080
    buffer_load_dwordx4 v[72:75], v7, s[8:11], s19 offen
    s_add_u32 s19, s17, 431104
    buffer_load_dwordx4 v[76:79], v7, s[8:11], s19 offen
    s_waitcnt vmcnt(10)
    v_mfma_f32_16x16x32_bf16 v[16:19], v[40:43], v[80:83], v[16:19]
    v_mfma_f32_16x16x32_bf16 v[20:23], v[40:43], v[84:87], v[20:23]
    v_mfma_f32_16x16x32_bf16 v[24:27], v[40:43], v[88:91], v[24:27]
    v_mfma_f32_16x16x32_bf16 v[28:31], v[40:43], v[92:95], v[28:31]
    s_add_u32 s19, s5, 2624512
    buffer_load_dwordx4 v[40:43], v7, s[8:11], s19 offen
    s_add_u32 s19, s17, 169984
    buffer_load_dwordx4 v[80:83], v7, s[8:11], s19 offen
    s_add_u32 s19, s17, 171008
    buffer_load_dwordx4 v[84:87], v7, s[8:11], s19 offen
    s_add_u32 s19, s17, 432128
    buffer_load_dwordx4 v[88:91], v7, s[8:11], s19 offen
    s_add_u32 s19, s17, 433152
    buffer_load_dwordx4 v[92:95], v7, s[8:11], s19 offen
    s_waitcnt vmcnt(10)
    v_mfma_f32_16x16x32_bf16 v[16:19], v[32:35], v[48:51], v[16:19]
    v_mfma_f32_16x16x32_bf16 v[20:23], v[32:35], v[52:55], v[20:23]
    v_mfma_f32_16x16x32_bf16 v[24:27], v[32:35], v[56:59], v[24:27]
    v_mfma_f32_16x16x32_bf16 v[28:31], v[32:35], v[60:63], v[28:31]
    s_add_u32 s19, s5, 2752512
    buffer_load_dwordx4 v[32:35], v7, s[8:11], s19 offen
    s_add_u32 s19, s17, 172032
    buffer_load_dwordx4 v[48:51], v7, s[8:11], s19 offen
    s_add_u32 s19, s17, 173056
    buffer_load_dwordx4 v[52:55], v7, s[8:11], s19 offen
    s_add_u32 s19, s17, 434176
    buffer_load_dwordx4 v[56:59], v7, s[8:11], s19 offen
    s_add_u32 s19, s17, 435200
    buffer_load_dwordx4 v[60:63], v7, s[8:11], s19 offen
    s_waitcnt vmcnt(10)
    v_mfma_f32_16x16x32_bf16 v[16:19], v[36:39], v[64:67], v[16:19]
    v_mfma_f32_16x16x32_bf16 v[20:23], v[36:39], v[68:71], v[20:23]
    v_mfma_f32_16x16x32_bf16 v[24:27], v[36:39], v[72:75], v[24:27]
    v_mfma_f32_16x16x32_bf16 v[28:31], v[36:39], v[76:79], v[28:31]
    s_add_u32 s19, s5, 2753536
    buffer_load_dwordx4 v[36:39], v7, s[8:11], s19 offen
    s_add_u32 s19, s17, 174080
    buffer_load_dwordx4 v[64:67], v7, s[8:11], s19 offen
    s_add_u32 s19, s17, 175104
    buffer_load_dwordx4 v[68:71], v7, s[8:11], s19 offen
    s_add_u32 s19, s17, 436224
    buffer_load_dwordx4 v[72:75], v7, s[8:11], s19 offen
    s_add_u32 s19, s17, 437248
    buffer_load_dwordx4 v[76:79], v7, s[8:11], s19 offen
    s_waitcnt vmcnt(10)
    v_mfma_f32_16x16x32_bf16 v[16:19], v[40:43], v[80:83], v[16:19]
    v_mfma_f32_16x16x32_bf16 v[20:23], v[40:43], v[84:87], v[20:23]
    v_mfma_f32_16x16x32_bf16 v[24:27], v[40:43], v[88:91], v[24:27]
    v_mfma_f32_16x16x32_bf16 v[28:31], v[40:43], v[92:95], v[28:31]
    s_add_u32 s19, s5, 2754560
    buffer_load_dwordx4 v[40:43], v7, s[8:11], s19 offen
    s_add_u32 s19, s17, 176128
    buffer_load_dwordx4 v[80:83], v7, s[8:11], s19 offen
    s_add_u32 s19, s17, 177152
    buffer_load_dwordx4 v[84:87], v7, s[8:11], s19 offen
    s_add_u32 s19, s17, 438272
    buffer_load_dwordx4 v[88:91], v7, s[8:11], s19 offen
    s_add_u32 s19, s17, 439296
    buffer_load_dwordx4 v[92:95], v7, s[8:11], s19 offen
    s_waitcnt vmcnt(10)
    v_mfma_f32_16x16x32_bf16 v[16:19], v[32:35], v[48:51], v[16:19]
    v_mfma_f32_16x16x32_bf16 v[20:23], v[32:35], v[52:55], v[20:23]
    v_mfma_f32_16x16x32_bf16 v[24:27], v[32:35], v[56:59], v[24:27]
    v_mfma_f32_16x16x32_bf16 v[28:31], v[32:35], v[60:63], v[28:31]
    s_add_u32 s19, s5, 2755584
    buffer_load_dwordx4 v[32:35], v7, s[8:11], s19 offen
    s_add_u32 s19, s17, 178176
    buffer_load_dwordx4 v[48:51], v7, s[8:11], s19 offen
    s_add_u32 s19, s17, 179200
    buffer_load_dwordx4 v[52:55], v7, s[8:11], s19 offen
    s_add_u32 s19, s17, 440320
    buffer_load_dwordx4 v[56:59], v7, s[8:11], s19 offen
    s_add_u32 s19, s17, 441344
    buffer_load_dwordx4 v[60:63], v7, s[8:11], s19 offen
    s_waitcnt vmcnt(10)
    v_mfma_f32_16x16x32_bf16 v[16:19], v[36:39], v[64:67], v[16:19]
    v_mfma_f32_16x16x32_bf16 v[20:23], v[36:39], v[68:71], v[20:23]
    v_mfma_f32_16x16x32_bf16 v[24:27], v[36:39], v[72:75], v[24:27]
    v_mfma_f32_16x16x32_bf16 v[28:31], v[36:39], v[76:79], v[28:31]
    s_add_u32 s19, s5, 2883584
    buffer_load_dwordx4 v[36:39], v7, s[8:11], s19 offen
    s_add_u32 s19, s17, 180224
    buffer_load_dwordx4 v[64:67], v7, s[8:11], s19 offen
    s_add_u32 s19, s17, 181248
    buffer_load_dwordx4 v[68:71], v7, s[8:11], s19 offen
    s_add_u32 s19, s17, 442368
    buffer_load_dwordx4 v[72:75], v7, s[8:11], s19 offen
    s_add_u32 s19, s17, 443392
    buffer_load_dwordx4 v[76:79], v7, s[8:11], s19 offen
    s_waitcnt vmcnt(10)
    v_mfma_f32_16x16x32_bf16 v[16:19], v[40:43], v[80:83], v[16:19]
    v_mfma_f32_16x16x32_bf16 v[20:23], v[40:43], v[84:87], v[20:23]
    v_mfma_f32_16x16x32_bf16 v[24:27], v[40:43], v[88:91], v[24:27]
    v_mfma_f32_16x16x32_bf16 v[28:31], v[40:43], v[92:95], v[28:31]
    s_add_u32 s19, s5, 2884608
    buffer_load_dwordx4 v[40:43], v7, s[8:11], s19 offen
    s_add_u32 s19, s17, 182272
    buffer_load_dwordx4 v[80:83], v7, s[8:11], s19 offen
    s_add_u32 s19, s17, 183296
    buffer_load_dwordx4 v[84:87], v7, s[8:11], s19 offen
    s_add_u32 s19, s17, 444416
    buffer_load_dwordx4 v[88:91], v7, s[8:11], s19 offen
    s_add_u32 s19, s17, 445440
    buffer_load_dwordx4 v[92:95], v7, s[8:11], s19 offen
    s_waitcnt vmcnt(10)
    v_mfma_f32_16x16x32_bf16 v[16:19], v[32:35], v[48:51], v[16:19]
    v_mfma_f32_16x16x32_bf16 v[20:23], v[32:35], v[52:55], v[20:23]
    v_mfma_f32_16x16x32_bf16 v[24:27], v[32:35], v[56:59], v[24:27]
    v_mfma_f32_16x16x32_bf16 v[28:31], v[32:35], v[60:63], v[28:31]
    s_add_u32 s19, s5, 2885632
    buffer_load_dwordx4 v[32:35], v7, s[8:11], s19 offen
    s_add_u32 s19, s17, 184320
    buffer_load_dwordx4 v[48:51], v7, s[8:11], s19 offen
    s_add_u32 s19, s17, 185344
    buffer_load_dwordx4 v[52:55], v7, s[8:11], s19 offen
    s_add_u32 s19, s17, 446464
    buffer_load_dwordx4 v[56:59], v7, s[8:11], s19 offen
    s_add_u32 s19, s17, 447488
    buffer_load_dwordx4 v[60:63], v7, s[8:11], s19 offen
    s_waitcnt vmcnt(10)
    v_mfma_f32_16x16x32_bf16 v[16:19], v[36:39], v[64:67], v[16:19]
    v_mfma_f32_16x16x32_bf16 v[20:23], v[36:39], v[68:71], v[20:23]
    v_mfma_f32_16x16x32_bf16 v[24:27], v[36:39], v[72:75], v[24:27]
    v_mfma_f32_16x16x32_bf16 v[28:31], v[36:39], v[76:79], v[28:31]
    s_add_u32 s19, s5, 2886656
    buffer_load_dwordx4 v[36:39], v7, s[8:11], s19 offen
    s_add_u32 s19, s17, 186368
    buffer_load_dwordx4 v[64:67], v7, s[8:11], s19 offen
    s_add_u32 s19, s17, 187392
    buffer_load_dwordx4 v[68:71], v7, s[8:11], s19 offen
    s_add_u32 s19, s17, 448512
    buffer_load_dwordx4 v[72:75], v7, s[8:11], s19 offen
    s_add_u32 s19, s17, 449536
    buffer_load_dwordx4 v[76:79], v7, s[8:11], s19 offen
    s_waitcnt vmcnt(10)
    v_mfma_f32_16x16x32_bf16 v[16:19], v[40:43], v[80:83], v[16:19]
    v_mfma_f32_16x16x32_bf16 v[20:23], v[40:43], v[84:87], v[20:23]
    v_mfma_f32_16x16x32_bf16 v[24:27], v[40:43], v[88:91], v[24:27]
    v_mfma_f32_16x16x32_bf16 v[28:31], v[40:43], v[92:95], v[28:31]
    s_add_u32 s19, s5, 3014656
    buffer_load_dwordx4 v[40:43], v7, s[8:11], s19 offen
    s_add_u32 s19, s17, 188416
    buffer_load_dwordx4 v[80:83], v7, s[8:11], s19 offen
    s_add_u32 s19, s17, 189440
    buffer_load_dwordx4 v[84:87], v7, s[8:11], s19 offen
    s_add_u32 s19, s17, 450560
    buffer_load_dwordx4 v[88:91], v7, s[8:11], s19 offen
    s_add_u32 s19, s17, 451584
    buffer_load_dwordx4 v[92:95], v7, s[8:11], s19 offen
    s_waitcnt vmcnt(10)
    v_mfma_f32_16x16x32_bf16 v[16:19], v[32:35], v[48:51], v[16:19]
    v_mfma_f32_16x16x32_bf16 v[20:23], v[32:35], v[52:55], v[20:23]
    v_mfma_f32_16x16x32_bf16 v[24:27], v[32:35], v[56:59], v[24:27]
    v_mfma_f32_16x16x32_bf16 v[28:31], v[32:35], v[60:63], v[28:31]
    s_add_u32 s19, s5, 3015680
    buffer_load_dwordx4 v[32:35], v7, s[8:11], s19 offen
    s_add_u32 s19, s17, 190464
    buffer_load_dwordx4 v[48:51], v7, s[8:11], s19 offen
    s_add_u32 s19, s17, 191488
    buffer_load_dwordx4 v[52:55], v7, s[8:11], s19 offen
    s_add_u32 s19, s17, 452608
    buffer_load_dwordx4 v[56:59], v7, s[8:11], s19 offen
    s_add_u32 s19, s17, 453632
    buffer_load_dwordx4 v[60:63], v7, s[8:11], s19 offen
    s_waitcnt vmcnt(10)
    v_mfma_f32_16x16x32_bf16 v[16:19], v[36:39], v[64:67], v[16:19]
    v_mfma_f32_16x16x32_bf16 v[20:23], v[36:39], v[68:71], v[20:23]
    v_mfma_f32_16x16x32_bf16 v[24:27], v[36:39], v[72:75], v[24:27]
    v_mfma_f32_16x16x32_bf16 v[28:31], v[36:39], v[76:79], v[28:31]
    s_add_u32 s19, s5, 3016704
    buffer_load_dwordx4 v[36:39], v7, s[8:11], s19 offen
    s_add_u32 s19, s17, 192512
    buffer_load_dwordx4 v[64:67], v7, s[8:11], s19 offen
    s_add_u32 s19, s17, 193536
    buffer_load_dwordx4 v[68:71], v7, s[8:11], s19 offen
    s_add_u32 s19, s17, 454656
    buffer_load_dwordx4 v[72:75], v7, s[8:11], s19 offen
    s_add_u32 s19, s17, 455680
    buffer_load_dwordx4 v[76:79], v7, s[8:11], s19 offen
    s_waitcnt vmcnt(10)
    v_mfma_f32_16x16x32_bf16 v[16:19], v[40:43], v[80:83], v[16:19]
    v_mfma_f32_16x16x32_bf16 v[20:23], v[40:43], v[84:87], v[20:23]
    v_mfma_f32_16x16x32_bf16 v[24:27], v[40:43], v[88:91], v[24:27]
    v_mfma_f32_16x16x32_bf16 v[28:31], v[40:43], v[92:95], v[28:31]
    s_add_u32 s19, s5, 3017728
    buffer_load_dwordx4 v[40:43], v7, s[8:11], s19 offen
    s_add_u32 s19, s17, 194560
    buffer_load_dwordx4 v[80:83], v7, s[8:11], s19 offen
    s_add_u32 s19, s17, 195584
    buffer_load_dwordx4 v[84:87], v7, s[8:11], s19 offen
    s_add_u32 s19, s17, 456704
    buffer_load_dwordx4 v[88:91], v7, s[8:11], s19 offen
    s_add_u32 s19, s17, 457728
    buffer_load_dwordx4 v[92:95], v7, s[8:11], s19 offen
    s_waitcnt vmcnt(10)
    v_mfma_f32_16x16x32_bf16 v[16:19], v[32:35], v[48:51], v[16:19]
    v_mfma_f32_16x16x32_bf16 v[20:23], v[32:35], v[52:55], v[20:23]
    v_mfma_f32_16x16x32_bf16 v[24:27], v[32:35], v[56:59], v[24:27]
    v_mfma_f32_16x16x32_bf16 v[28:31], v[32:35], v[60:63], v[28:31]
    s_add_u32 s19, s5, 3145728
    buffer_load_dwordx4 v[32:35], v7, s[8:11], s19 offen
    s_add_u32 s19, s17, 196608
    buffer_load_dwordx4 v[48:51], v7, s[8:11], s19 offen
    s_add_u32 s19, s17, 197632
    buffer_load_dwordx4 v[52:55], v7, s[8:11], s19 offen
    s_add_u32 s19, s17, 458752
    buffer_load_dwordx4 v[56:59], v7, s[8:11], s19 offen
    s_add_u32 s19, s17, 459776
    buffer_load_dwordx4 v[60:63], v7, s[8:11], s19 offen
    s_waitcnt vmcnt(10)
    v_mfma_f32_16x16x32_bf16 v[16:19], v[36:39], v[64:67], v[16:19]
    v_mfma_f32_16x16x32_bf16 v[20:23], v[36:39], v[68:71], v[20:23]
    v_mfma_f32_16x16x32_bf16 v[24:27], v[36:39], v[72:75], v[24:27]
    v_mfma_f32_16x16x32_bf16 v[28:31], v[36:39], v[76:79], v[28:31]
    s_add_u32 s19, s5, 3146752
    buffer_load_dwordx4 v[36:39], v7, s[8:11], s19 offen
    s_add_u32 s19, s17, 198656
    buffer_load_dwordx4 v[64:67], v7, s[8:11], s19 offen
    s_add_u32 s19, s17, 199680
    buffer_load_dwordx4 v[68:71], v7, s[8:11], s19 offen
    s_add_u32 s19, s17, 460800
    buffer_load_dwordx4 v[72:75], v7, s[8:11], s19 offen
    s_add_u32 s19, s17, 461824
    buffer_load_dwordx4 v[76:79], v7, s[8:11], s19 offen
    s_waitcnt vmcnt(10)
    v_mfma_f32_16x16x32_bf16 v[16:19], v[40:43], v[80:83], v[16:19]
    v_mfma_f32_16x16x32_bf16 v[20:23], v[40:43], v[84:87], v[20:23]
    v_mfma_f32_16x16x32_bf16 v[24:27], v[40:43], v[88:91], v[24:27]
    v_mfma_f32_16x16x32_bf16 v[28:31], v[40:43], v[92:95], v[28:31]
    s_add_u32 s19, s5, 3147776
    buffer_load_dwordx4 v[40:43], v7, s[8:11], s19 offen
    s_add_u32 s19, s17, 200704
    buffer_load_dwordx4 v[80:83], v7, s[8:11], s19 offen
    s_add_u32 s19, s17, 201728
    buffer_load_dwordx4 v[84:87], v7, s[8:11], s19 offen
    s_add_u32 s19, s17, 462848
    buffer_load_dwordx4 v[88:91], v7, s[8:11], s19 offen
    s_add_u32 s19, s17, 463872
    buffer_load_dwordx4 v[92:95], v7, s[8:11], s19 offen
    s_waitcnt vmcnt(10)
    v_mfma_f32_16x16x32_bf16 v[16:19], v[32:35], v[48:51], v[16:19]
    v_mfma_f32_16x16x32_bf16 v[20:23], v[32:35], v[52:55], v[20:23]
    v_mfma_f32_16x16x32_bf16 v[24:27], v[32:35], v[56:59], v[24:27]
    v_mfma_f32_16x16x32_bf16 v[28:31], v[32:35], v[60:63], v[28:31]
    s_add_u32 s19, s5, 3148800
    buffer_load_dwordx4 v[32:35], v7, s[8:11], s19 offen
    s_add_u32 s19, s17, 202752
    buffer_load_dwordx4 v[48:51], v7, s[8:11], s19 offen
    s_add_u32 s19, s17, 203776
    buffer_load_dwordx4 v[52:55], v7, s[8:11], s19 offen
    s_add_u32 s19, s17, 464896
    buffer_load_dwordx4 v[56:59], v7, s[8:11], s19 offen
    s_add_u32 s19, s17, 465920
    buffer_load_dwordx4 v[60:63], v7, s[8:11], s19 offen
    s_waitcnt vmcnt(10)
    v_mfma_f32_16x16x32_bf16 v[16:19], v[36:39], v[64:67], v[16:19]
    v_mfma_f32_16x16x32_bf16 v[20:23], v[36:39], v[68:71], v[20:23]
    v_mfma_f32_16x16x32_bf16 v[24:27], v[36:39], v[72:75], v[24:27]
    v_mfma_f32_16x16x32_bf16 v[28:31], v[36:39], v[76:79], v[28:31]
    s_add_u32 s19, s5, 3276800
    buffer_load_dwordx4 v[36:39], v7, s[8:11], s19 offen
    s_add_u32 s19, s17, 204800
    buffer_load_dwordx4 v[64:67], v7, s[8:11], s19 offen
    s_add_u32 s19, s17, 205824
    buffer_load_dwordx4 v[68:71], v7, s[8:11], s19 offen
    s_add_u32 s19, s17, 466944
    buffer_load_dwordx4 v[72:75], v7, s[8:11], s19 offen
    s_add_u32 s19, s17, 467968
    buffer_load_dwordx4 v[76:79], v7, s[8:11], s19 offen
    s_waitcnt vmcnt(10)
    v_mfma_f32_16x16x32_bf16 v[16:19], v[40:43], v[80:83], v[16:19]
    v_mfma_f32_16x16x32_bf16 v[20:23], v[40:43], v[84:87], v[20:23]
    v_mfma_f32_16x16x32_bf16 v[24:27], v[40:43], v[88:91], v[24:27]
    v_mfma_f32_16x16x32_bf16 v[28:31], v[40:43], v[92:95], v[28:31]
    s_add_u32 s19, s5, 3277824
    buffer_load_dwordx4 v[40:43], v7, s[8:11], s19 offen
    s_add_u32 s19, s17, 206848
    buffer_load_dwordx4 v[80:83], v7, s[8:11], s19 offen
    s_add_u32 s19, s17, 207872
    buffer_load_dwordx4 v[84:87], v7, s[8:11], s19 offen
    s_add_u32 s19, s17, 468992
    buffer_load_dwordx4 v[88:91], v7, s[8:11], s19 offen
    s_add_u32 s19, s17, 470016
    buffer_load_dwordx4 v[92:95], v7, s[8:11], s19 offen
    s_waitcnt vmcnt(10)
    v_mfma_f32_16x16x32_bf16 v[16:19], v[32:35], v[48:51], v[16:19]
    v_mfma_f32_16x16x32_bf16 v[20:23], v[32:35], v[52:55], v[20:23]
    v_mfma_f32_16x16x32_bf16 v[24:27], v[32:35], v[56:59], v[24:27]
    v_mfma_f32_16x16x32_bf16 v[28:31], v[32:35], v[60:63], v[28:31]
    s_add_u32 s19, s5, 3278848
    buffer_load_dwordx4 v[32:35], v7, s[8:11], s19 offen
    s_add_u32 s19, s17, 208896
    buffer_load_dwordx4 v[48:51], v7, s[8:11], s19 offen
    s_add_u32 s19, s17, 209920
    buffer_load_dwordx4 v[52:55], v7, s[8:11], s19 offen
    s_add_u32 s19, s17, 471040
    buffer_load_dwordx4 v[56:59], v7, s[8:11], s19 offen
    s_add_u32 s19, s17, 472064
    buffer_load_dwordx4 v[60:63], v7, s[8:11], s19 offen
    s_waitcnt vmcnt(10)
    v_mfma_f32_16x16x32_bf16 v[16:19], v[36:39], v[64:67], v[16:19]
    v_mfma_f32_16x16x32_bf16 v[20:23], v[36:39], v[68:71], v[20:23]
    v_mfma_f32_16x16x32_bf16 v[24:27], v[36:39], v[72:75], v[24:27]
    v_mfma_f32_16x16x32_bf16 v[28:31], v[36:39], v[76:79], v[28:31]
    s_add_u32 s19, s5, 3279872
    buffer_load_dwordx4 v[36:39], v7, s[8:11], s19 offen
    s_add_u32 s19, s17, 210944
    buffer_load_dwordx4 v[64:67], v7, s[8:11], s19 offen
    s_add_u32 s19, s17, 211968
    buffer_load_dwordx4 v[68:71], v7, s[8:11], s19 offen
    s_add_u32 s19, s17, 473088
    buffer_load_dwordx4 v[72:75], v7, s[8:11], s19 offen
    s_add_u32 s19, s17, 474112
    buffer_load_dwordx4 v[76:79], v7, s[8:11], s19 offen
    s_waitcnt vmcnt(10)
    v_mfma_f32_16x16x32_bf16 v[16:19], v[40:43], v[80:83], v[16:19]
    v_mfma_f32_16x16x32_bf16 v[20:23], v[40:43], v[84:87], v[20:23]
    v_mfma_f32_16x16x32_bf16 v[24:27], v[40:43], v[88:91], v[24:27]
    v_mfma_f32_16x16x32_bf16 v[28:31], v[40:43], v[92:95], v[28:31]
    s_add_u32 s19, s5, 3407872
    buffer_load_dwordx4 v[40:43], v7, s[8:11], s19 offen
    s_add_u32 s19, s17, 212992
    buffer_load_dwordx4 v[80:83], v7, s[8:11], s19 offen
    s_add_u32 s19, s17, 214016
    buffer_load_dwordx4 v[84:87], v7, s[8:11], s19 offen
    s_add_u32 s19, s17, 475136
    buffer_load_dwordx4 v[88:91], v7, s[8:11], s19 offen
    s_add_u32 s19, s17, 476160
    buffer_load_dwordx4 v[92:95], v7, s[8:11], s19 offen
    s_waitcnt vmcnt(10)
    v_mfma_f32_16x16x32_bf16 v[16:19], v[32:35], v[48:51], v[16:19]
    v_mfma_f32_16x16x32_bf16 v[20:23], v[32:35], v[52:55], v[20:23]
    v_mfma_f32_16x16x32_bf16 v[24:27], v[32:35], v[56:59], v[24:27]
    v_mfma_f32_16x16x32_bf16 v[28:31], v[32:35], v[60:63], v[28:31]
    s_add_u32 s19, s5, 3408896
    buffer_load_dwordx4 v[32:35], v7, s[8:11], s19 offen
    s_add_u32 s19, s17, 215040
    buffer_load_dwordx4 v[48:51], v7, s[8:11], s19 offen
    s_add_u32 s19, s17, 216064
    buffer_load_dwordx4 v[52:55], v7, s[8:11], s19 offen
    s_add_u32 s19, s17, 477184
    buffer_load_dwordx4 v[56:59], v7, s[8:11], s19 offen
    s_add_u32 s19, s17, 478208
    buffer_load_dwordx4 v[60:63], v7, s[8:11], s19 offen
    s_waitcnt vmcnt(10)
    v_mfma_f32_16x16x32_bf16 v[16:19], v[36:39], v[64:67], v[16:19]
    v_mfma_f32_16x16x32_bf16 v[20:23], v[36:39], v[68:71], v[20:23]
    v_mfma_f32_16x16x32_bf16 v[24:27], v[36:39], v[72:75], v[24:27]
    v_mfma_f32_16x16x32_bf16 v[28:31], v[36:39], v[76:79], v[28:31]
    s_add_u32 s19, s5, 3409920
    buffer_load_dwordx4 v[36:39], v7, s[8:11], s19 offen
    s_add_u32 s19, s17, 217088
    buffer_load_dwordx4 v[64:67], v7, s[8:11], s19 offen
    s_add_u32 s19, s17, 218112
    buffer_load_dwordx4 v[68:71], v7, s[8:11], s19 offen
    s_add_u32 s19, s17, 479232
    buffer_load_dwordx4 v[72:75], v7, s[8:11], s19 offen
    s_add_u32 s19, s17, 480256
    buffer_load_dwordx4 v[76:79], v7, s[8:11], s19 offen
    s_waitcnt vmcnt(10)
    v_mfma_f32_16x16x32_bf16 v[16:19], v[40:43], v[80:83], v[16:19]
    v_mfma_f32_16x16x32_bf16 v[20:23], v[40:43], v[84:87], v[20:23]
    v_mfma_f32_16x16x32_bf16 v[24:27], v[40:43], v[88:91], v[24:27]
    v_mfma_f32_16x16x32_bf16 v[28:31], v[40:43], v[92:95], v[28:31]
    s_add_u32 s19, s5, 3410944
    buffer_load_dwordx4 v[40:43], v7, s[8:11], s19 offen
    s_add_u32 s19, s17, 219136
    buffer_load_dwordx4 v[80:83], v7, s[8:11], s19 offen
    s_add_u32 s19, s17, 220160
    buffer_load_dwordx4 v[84:87], v7, s[8:11], s19 offen
    s_add_u32 s19, s17, 481280
    buffer_load_dwordx4 v[88:91], v7, s[8:11], s19 offen
    s_add_u32 s19, s17, 482304
    buffer_load_dwordx4 v[92:95], v7, s[8:11], s19 offen
    s_waitcnt vmcnt(10)
    v_mfma_f32_16x16x32_bf16 v[16:19], v[32:35], v[48:51], v[16:19]
    v_mfma_f32_16x16x32_bf16 v[20:23], v[32:35], v[52:55], v[20:23]
    v_mfma_f32_16x16x32_bf16 v[24:27], v[32:35], v[56:59], v[24:27]
    v_mfma_f32_16x16x32_bf16 v[28:31], v[32:35], v[60:63], v[28:31]
    s_add_u32 s19, s5, 3538944
    buffer_load_dwordx4 v[32:35], v7, s[8:11], s19 offen
    s_add_u32 s19, s17, 221184
    buffer_load_dwordx4 v[48:51], v7, s[8:11], s19 offen
    s_add_u32 s19, s17, 222208
    buffer_load_dwordx4 v[52:55], v7, s[8:11], s19 offen
    s_add_u32 s19, s17, 483328
    buffer_load_dwordx4 v[56:59], v7, s[8:11], s19 offen
    s_add_u32 s19, s17, 484352
    buffer_load_dwordx4 v[60:63], v7, s[8:11], s19 offen
    s_waitcnt vmcnt(10)
    v_mfma_f32_16x16x32_bf16 v[16:19], v[36:39], v[64:67], v[16:19]
    v_mfma_f32_16x16x32_bf16 v[20:23], v[36:39], v[68:71], v[20:23]
    v_mfma_f32_16x16x32_bf16 v[24:27], v[36:39], v[72:75], v[24:27]
    v_mfma_f32_16x16x32_bf16 v[28:31], v[36:39], v[76:79], v[28:31]
    s_add_u32 s19, s5, 3539968
    buffer_load_dwordx4 v[36:39], v7, s[8:11], s19 offen
    s_add_u32 s19, s17, 223232
    buffer_load_dwordx4 v[64:67], v7, s[8:11], s19 offen
    s_add_u32 s19, s17, 224256
    buffer_load_dwordx4 v[68:71], v7, s[8:11], s19 offen
    s_add_u32 s19, s17, 485376
    buffer_load_dwordx4 v[72:75], v7, s[8:11], s19 offen
    s_add_u32 s19, s17, 486400
    buffer_load_dwordx4 v[76:79], v7, s[8:11], s19 offen
    s_waitcnt vmcnt(10)
    v_mfma_f32_16x16x32_bf16 v[16:19], v[40:43], v[80:83], v[16:19]
    v_mfma_f32_16x16x32_bf16 v[20:23], v[40:43], v[84:87], v[20:23]
    v_mfma_f32_16x16x32_bf16 v[24:27], v[40:43], v[88:91], v[24:27]
    v_mfma_f32_16x16x32_bf16 v[28:31], v[40:43], v[92:95], v[28:31]
    s_add_u32 s19, s5, 3540992
    buffer_load_dwordx4 v[40:43], v7, s[8:11], s19 offen
    s_add_u32 s19, s17, 225280
    buffer_load_dwordx4 v[80:83], v7, s[8:11], s19 offen
    s_add_u32 s19, s17, 226304
    buffer_load_dwordx4 v[84:87], v7, s[8:11], s19 offen
    s_add_u32 s19, s17, 487424
    buffer_load_dwordx4 v[88:91], v7, s[8:11], s19 offen
    s_add_u32 s19, s17, 488448
    buffer_load_dwordx4 v[92:95], v7, s[8:11], s19 offen
    s_waitcnt vmcnt(10)
    v_mfma_f32_16x16x32_bf16 v[16:19], v[32:35], v[48:51], v[16:19]
    v_mfma_f32_16x16x32_bf16 v[20:23], v[32:35], v[52:55], v[20:23]
    v_mfma_f32_16x16x32_bf16 v[24:27], v[32:35], v[56:59], v[24:27]
    v_mfma_f32_16x16x32_bf16 v[28:31], v[32:35], v[60:63], v[28:31]
    s_add_u32 s19, s5, 3542016
    buffer_load_dwordx4 v[32:35], v7, s[8:11], s19 offen
    s_add_u32 s19, s17, 227328
    buffer_load_dwordx4 v[48:51], v7, s[8:11], s19 offen
    s_add_u32 s19, s17, 228352
    buffer_load_dwordx4 v[52:55], v7, s[8:11], s19 offen
    s_add_u32 s19, s17, 489472
    buffer_load_dwordx4 v[56:59], v7, s[8:11], s19 offen
    s_add_u32 s19, s17, 490496
    buffer_load_dwordx4 v[60:63], v7, s[8:11], s19 offen
    s_waitcnt vmcnt(10)
    v_mfma_f32_16x16x32_bf16 v[16:19], v[36:39], v[64:67], v[16:19]
    v_mfma_f32_16x16x32_bf16 v[20:23], v[36:39], v[68:71], v[20:23]
    v_mfma_f32_16x16x32_bf16 v[24:27], v[36:39], v[72:75], v[24:27]
    v_mfma_f32_16x16x32_bf16 v[28:31], v[36:39], v[76:79], v[28:31]
    s_add_u32 s19, s5, 3670016
    buffer_load_dwordx4 v[36:39], v7, s[8:11], s19 offen
    s_add_u32 s19, s17, 229376
    buffer_load_dwordx4 v[64:67], v7, s[8:11], s19 offen
    s_add_u32 s19, s17, 230400
    buffer_load_dwordx4 v[68:71], v7, s[8:11], s19 offen
    s_add_u32 s19, s17, 491520
    buffer_load_dwordx4 v[72:75], v7, s[8:11], s19 offen
    s_add_u32 s19, s17, 492544
    buffer_load_dwordx4 v[76:79], v7, s[8:11], s19 offen
    s_waitcnt vmcnt(10)
    v_mfma_f32_16x16x32_bf16 v[16:19], v[40:43], v[80:83], v[16:19]
    v_mfma_f32_16x16x32_bf16 v[20:23], v[40:43], v[84:87], v[20:23]
    v_mfma_f32_16x16x32_bf16 v[24:27], v[40:43], v[88:91], v[24:27]
    v_mfma_f32_16x16x32_bf16 v[28:31], v[40:43], v[92:95], v[28:31]
    s_add_u32 s19, s5, 3671040
    buffer_load_dwordx4 v[40:43], v7, s[8:11], s19 offen
    s_add_u32 s19, s17, 231424
    buffer_load_dwordx4 v[80:83], v7, s[8:11], s19 offen
    s_add_u32 s19, s17, 232448
    buffer_load_dwordx4 v[84:87], v7, s[8:11], s19 offen
    s_add_u32 s19, s17, 493568
    buffer_load_dwordx4 v[88:91], v7, s[8:11], s19 offen
    s_add_u32 s19, s17, 494592
    buffer_load_dwordx4 v[92:95], v7, s[8:11], s19 offen
    s_waitcnt vmcnt(10)
    v_mfma_f32_16x16x32_bf16 v[16:19], v[32:35], v[48:51], v[16:19]
    v_mfma_f32_16x16x32_bf16 v[20:23], v[32:35], v[52:55], v[20:23]
    v_mfma_f32_16x16x32_bf16 v[24:27], v[32:35], v[56:59], v[24:27]
    v_mfma_f32_16x16x32_bf16 v[28:31], v[32:35], v[60:63], v[28:31]
    s_add_u32 s19, s5, 3672064
    buffer_load_dwordx4 v[32:35], v7, s[8:11], s19 offen
    s_add_u32 s19, s17, 233472
    buffer_load_dwordx4 v[48:51], v7, s[8:11], s19 offen
    s_add_u32 s19, s17, 234496
    buffer_load_dwordx4 v[52:55], v7, s[8:11], s19 offen
    s_add_u32 s19, s17, 495616
    buffer_load_dwordx4 v[56:59], v7, s[8:11], s19 offen
    s_add_u32 s19, s17, 496640
    buffer_load_dwordx4 v[60:63], v7, s[8:11], s19 offen
    s_waitcnt vmcnt(10)
    v_mfma_f32_16x16x32_bf16 v[16:19], v[36:39], v[64:67], v[16:19]
    v_mfma_f32_16x16x32_bf16 v[20:23], v[36:39], v[68:71], v[20:23]
    v_mfma_f32_16x16x32_bf16 v[24:27], v[36:39], v[72:75], v[24:27]
    v_mfma_f32_16x16x32_bf16 v[28:31], v[36:39], v[76:79], v[28:31]
    s_add_u32 s19, s5, 3673088
    buffer_load_dwordx4 v[36:39], v7, s[8:11], s19 offen
    s_add_u32 s19, s17, 235520
    buffer_load_dwordx4 v[64:67], v7, s[8:11], s19 offen
    s_add_u32 s19, s17, 236544
    buffer_load_dwordx4 v[68:71], v7, s[8:11], s19 offen
    s_add_u32 s19, s17, 497664
    buffer_load_dwordx4 v[72:75], v7, s[8:11], s19 offen
    s_add_u32 s19, s17, 498688
    buffer_load_dwordx4 v[76:79], v7, s[8:11], s19 offen
    s_waitcnt vmcnt(10)
    v_mfma_f32_16x16x32_bf16 v[16:19], v[40:43], v[80:83], v[16:19]
    v_mfma_f32_16x16x32_bf16 v[20:23], v[40:43], v[84:87], v[20:23]
    v_mfma_f32_16x16x32_bf16 v[24:27], v[40:43], v[88:91], v[24:27]
    v_mfma_f32_16x16x32_bf16 v[28:31], v[40:43], v[92:95], v[28:31]
    s_add_u32 s19, s5, 3801088
    buffer_load_dwordx4 v[40:43], v7, s[8:11], s19 offen
    s_add_u32 s19, s17, 237568
    buffer_load_dwordx4 v[80:83], v7, s[8:11], s19 offen
    s_add_u32 s19, s17, 238592
    buffer_load_dwordx4 v[84:87], v7, s[8:11], s19 offen
    s_add_u32 s19, s17, 499712
    buffer_load_dwordx4 v[88:91], v7, s[8:11], s19 offen
    s_add_u32 s19, s17, 500736
    buffer_load_dwordx4 v[92:95], v7, s[8:11], s19 offen
    s_waitcnt vmcnt(10)
    v_mfma_f32_16x16x32_bf16 v[16:19], v[32:35], v[48:51], v[16:19]
    v_mfma_f32_16x16x32_bf16 v[20:23], v[32:35], v[52:55], v[20:23]
    v_mfma_f32_16x16x32_bf16 v[24:27], v[32:35], v[56:59], v[24:27]
    v_mfma_f32_16x16x32_bf16 v[28:31], v[32:35], v[60:63], v[28:31]
    s_add_u32 s19, s5, 3802112
    buffer_load_dwordx4 v[32:35], v7, s[8:11], s19 offen
    s_add_u32 s19, s17, 239616
    buffer_load_dwordx4 v[48:51], v7, s[8:11], s19 offen
    s_add_u32 s19, s17, 240640
    buffer_load_dwordx4 v[52:55], v7, s[8:11], s19 offen
    s_add_u32 s19, s17, 501760
    buffer_load_dwordx4 v[56:59], v7, s[8:11], s19 offen
    s_add_u32 s19, s17, 502784
    buffer_load_dwordx4 v[60:63], v7, s[8:11], s19 offen
    s_waitcnt vmcnt(10)
    v_mfma_f32_16x16x32_bf16 v[16:19], v[36:39], v[64:67], v[16:19]
    v_mfma_f32_16x16x32_bf16 v[20:23], v[36:39], v[68:71], v[20:23]
    v_mfma_f32_16x16x32_bf16 v[24:27], v[36:39], v[72:75], v[24:27]
    v_mfma_f32_16x16x32_bf16 v[28:31], v[36:39], v[76:79], v[28:31]
    s_add_u32 s19, s5, 3803136
    buffer_load_dwordx4 v[36:39], v7, s[8:11], s19 offen
    s_add_u32 s19, s17, 241664
    buffer_load_dwordx4 v[64:67], v7, s[8:11], s19 offen
    s_add_u32 s19, s17, 242688
    buffer_load_dwordx4 v[68:71], v7, s[8:11], s19 offen
    s_add_u32 s19, s17, 503808
    buffer_load_dwordx4 v[72:75], v7, s[8:11], s19 offen
    s_add_u32 s19, s17, 504832
    buffer_load_dwordx4 v[76:79], v7, s[8:11], s19 offen
    s_waitcnt vmcnt(10)
    v_mfma_f32_16x16x32_bf16 v[16:19], v[40:43], v[80:83], v[16:19]
    v_mfma_f32_16x16x32_bf16 v[20:23], v[40:43], v[84:87], v[20:23]
    v_mfma_f32_16x16x32_bf16 v[24:27], v[40:43], v[88:91], v[24:27]
    v_mfma_f32_16x16x32_bf16 v[28:31], v[40:43], v[92:95], v[28:31]
    s_add_u32 s19, s5, 3804160
    buffer_load_dwordx4 v[40:43], v7, s[8:11], s19 offen
    s_add_u32 s19, s17, 243712
    buffer_load_dwordx4 v[80:83], v7, s[8:11], s19 offen
    s_add_u32 s19, s17, 244736
    buffer_load_dwordx4 v[84:87], v7, s[8:11], s19 offen
    s_add_u32 s19, s17, 505856
    buffer_load_dwordx4 v[88:91], v7, s[8:11], s19 offen
    s_add_u32 s19, s17, 506880
    buffer_load_dwordx4 v[92:95], v7, s[8:11], s19 offen
    s_waitcnt vmcnt(10)
    v_mfma_f32_16x16x32_bf16 v[16:19], v[32:35], v[48:51], v[16:19]
    v_mfma_f32_16x16x32_bf16 v[20:23], v[32:35], v[52:55], v[20:23]
    v_mfma_f32_16x16x32_bf16 v[24:27], v[32:35], v[56:59], v[24:27]
    v_mfma_f32_16x16x32_bf16 v[28:31], v[32:35], v[60:63], v[28:31]
    s_add_u32 s19, s5, 3932160
    buffer_load_dwordx4 v[32:35], v7, s[8:11], s19 offen
    s_add_u32 s19, s17, 245760
    buffer_load_dwordx4 v[48:51], v7, s[8:11], s19 offen
    s_add_u32 s19, s17, 246784
    buffer_load_dwordx4 v[52:55], v7, s[8:11], s19 offen
    s_add_u32 s19, s17, 507904
    buffer_load_dwordx4 v[56:59], v7, s[8:11], s19 offen
    s_add_u32 s19, s17, 508928
    buffer_load_dwordx4 v[60:63], v7, s[8:11], s19 offen
    s_waitcnt vmcnt(10)
    v_mfma_f32_16x16x32_bf16 v[16:19], v[36:39], v[64:67], v[16:19]
    v_mfma_f32_16x16x32_bf16 v[20:23], v[36:39], v[68:71], v[20:23]
    v_mfma_f32_16x16x32_bf16 v[24:27], v[36:39], v[72:75], v[24:27]
    v_mfma_f32_16x16x32_bf16 v[28:31], v[36:39], v[76:79], v[28:31]
    s_add_u32 s19, s5, 3933184
    buffer_load_dwordx4 v[36:39], v7, s[8:11], s19 offen
    s_add_u32 s19, s17, 247808
    buffer_load_dwordx4 v[64:67], v7, s[8:11], s19 offen
    s_add_u32 s19, s17, 248832
    buffer_load_dwordx4 v[68:71], v7, s[8:11], s19 offen
    s_add_u32 s19, s17, 509952
    buffer_load_dwordx4 v[72:75], v7, s[8:11], s19 offen
    s_add_u32 s19, s17, 510976
    buffer_load_dwordx4 v[76:79], v7, s[8:11], s19 offen
    s_waitcnt vmcnt(10)
    v_mfma_f32_16x16x32_bf16 v[16:19], v[40:43], v[80:83], v[16:19]
    v_mfma_f32_16x16x32_bf16 v[20:23], v[40:43], v[84:87], v[20:23]
    v_mfma_f32_16x16x32_bf16 v[24:27], v[40:43], v[88:91], v[24:27]
    v_mfma_f32_16x16x32_bf16 v[28:31], v[40:43], v[92:95], v[28:31]
    s_add_u32 s19, s5, 3934208
    buffer_load_dwordx4 v[40:43], v7, s[8:11], s19 offen
    s_add_u32 s19, s17, 249856
    buffer_load_dwordx4 v[80:83], v7, s[8:11], s19 offen
    s_add_u32 s19, s17, 250880
    buffer_load_dwordx4 v[84:87], v7, s[8:11], s19 offen
    s_add_u32 s19, s17, 512000
    buffer_load_dwordx4 v[88:91], v7, s[8:11], s19 offen
    s_add_u32 s19, s17, 513024
    buffer_load_dwordx4 v[92:95], v7, s[8:11], s19 offen
    s_waitcnt vmcnt(10)
    v_mfma_f32_16x16x32_bf16 v[16:19], v[32:35], v[48:51], v[16:19]
    v_mfma_f32_16x16x32_bf16 v[20:23], v[32:35], v[52:55], v[20:23]
    v_mfma_f32_16x16x32_bf16 v[24:27], v[32:35], v[56:59], v[24:27]
    v_mfma_f32_16x16x32_bf16 v[28:31], v[32:35], v[60:63], v[28:31]
    s_add_u32 s19, s5, 3935232
    buffer_load_dwordx4 v[32:35], v7, s[8:11], s19 offen
    s_add_u32 s19, s17, 251904
    buffer_load_dwordx4 v[48:51], v7, s[8:11], s19 offen
    s_add_u32 s19, s17, 252928
    buffer_load_dwordx4 v[52:55], v7, s[8:11], s19 offen
    s_add_u32 s19, s17, 514048
    buffer_load_dwordx4 v[56:59], v7, s[8:11], s19 offen
    s_add_u32 s19, s17, 515072
    buffer_load_dwordx4 v[60:63], v7, s[8:11], s19 offen
    s_waitcnt vmcnt(10)
    v_mfma_f32_16x16x32_bf16 v[16:19], v[36:39], v[64:67], v[16:19]
    v_mfma_f32_16x16x32_bf16 v[20:23], v[36:39], v[68:71], v[20:23]
    v_mfma_f32_16x16x32_bf16 v[24:27], v[36:39], v[72:75], v[24:27]
    v_mfma_f32_16x16x32_bf16 v[28:31], v[36:39], v[76:79], v[28:31]
    s_add_u32 s19, s5, 4063232
    buffer_load_dwordx4 v[36:39], v7, s[8:11], s19 offen
    s_add_u32 s19, s17, 253952
    buffer_load_dwordx4 v[64:67], v7, s[8:11], s19 offen
    s_add_u32 s19, s17, 254976
    buffer_load_dwordx4 v[68:71], v7, s[8:11], s19 offen
    s_add_u32 s19, s17, 516096
    buffer_load_dwordx4 v[72:75], v7, s[8:11], s19 offen
    s_add_u32 s19, s17, 517120
    buffer_load_dwordx4 v[76:79], v7, s[8:11], s19 offen
    s_waitcnt vmcnt(10)
    v_mfma_f32_16x16x32_bf16 v[16:19], v[40:43], v[80:83], v[16:19]
    v_mfma_f32_16x16x32_bf16 v[20:23], v[40:43], v[84:87], v[20:23]
    v_mfma_f32_16x16x32_bf16 v[24:27], v[40:43], v[88:91], v[24:27]
    v_mfma_f32_16x16x32_bf16 v[28:31], v[40:43], v[92:95], v[28:31]
    s_add_u32 s19, s5, 4064256
    buffer_load_dwordx4 v[40:43], v7, s[8:11], s19 offen
    s_add_u32 s19, s17, 256000
    buffer_load_dwordx4 v[80:83], v7, s[8:11], s19 offen
    s_add_u32 s19, s17, 257024
    buffer_load_dwordx4 v[84:87], v7, s[8:11], s19 offen
    s_add_u32 s19, s17, 518144
    buffer_load_dwordx4 v[88:91], v7, s[8:11], s19 offen
    s_add_u32 s19, s17, 519168
    buffer_load_dwordx4 v[92:95], v7, s[8:11], s19 offen
    s_waitcnt vmcnt(10)
    v_mfma_f32_16x16x32_bf16 v[16:19], v[32:35], v[48:51], v[16:19]
    v_mfma_f32_16x16x32_bf16 v[20:23], v[32:35], v[52:55], v[20:23]
    v_mfma_f32_16x16x32_bf16 v[24:27], v[32:35], v[56:59], v[24:27]
    v_mfma_f32_16x16x32_bf16 v[28:31], v[32:35], v[60:63], v[28:31]
    s_add_u32 s19, s5, 4065280
    buffer_load_dwordx4 v[32:35], v7, s[8:11], s19 offen
    s_add_u32 s19, s17, 258048
    buffer_load_dwordx4 v[48:51], v7, s[8:11], s19 offen
    s_add_u32 s19, s17, 259072
    buffer_load_dwordx4 v[52:55], v7, s[8:11], s19 offen
    s_add_u32 s19, s17, 520192
    buffer_load_dwordx4 v[56:59], v7, s[8:11], s19 offen
    s_add_u32 s19, s17, 521216
    buffer_load_dwordx4 v[60:63], v7, s[8:11], s19 offen
    s_waitcnt vmcnt(10)
    v_mfma_f32_16x16x32_bf16 v[16:19], v[36:39], v[64:67], v[16:19]
    v_mfma_f32_16x16x32_bf16 v[20:23], v[36:39], v[68:71], v[20:23]
    v_mfma_f32_16x16x32_bf16 v[24:27], v[36:39], v[72:75], v[24:27]
    v_mfma_f32_16x16x32_bf16 v[28:31], v[36:39], v[76:79], v[28:31]
    s_add_u32 s19, s5, 4066304
    buffer_load_dwordx4 v[36:39], v7, s[8:11], s19 offen
    s_add_u32 s19, s17, 260096
    buffer_load_dwordx4 v[64:67], v7, s[8:11], s19 offen
    s_add_u32 s19, s17, 261120
    buffer_load_dwordx4 v[68:71], v7, s[8:11], s19 offen
    s_add_u32 s19, s17, 522240
    buffer_load_dwordx4 v[72:75], v7, s[8:11], s19 offen
    s_add_u32 s19, s17, 523264
    buffer_load_dwordx4 v[76:79], v7, s[8:11], s19 offen
    s_waitcnt vmcnt(10)
    v_mfma_f32_16x16x32_bf16 v[16:19], v[40:43], v[80:83], v[16:19]
    v_mfma_f32_16x16x32_bf16 v[20:23], v[40:43], v[84:87], v[20:23]
    v_mfma_f32_16x16x32_bf16 v[24:27], v[40:43], v[88:91], v[24:27]
    v_mfma_f32_16x16x32_bf16 v[28:31], v[40:43], v[92:95], v[28:31]
    s_waitcnt vmcnt(5)
    v_mfma_f32_16x16x32_bf16 v[16:19], v[32:35], v[48:51], v[16:19]
    v_mfma_f32_16x16x32_bf16 v[20:23], v[32:35], v[52:55], v[20:23]
    v_mfma_f32_16x16x32_bf16 v[24:27], v[32:35], v[56:59], v[24:27]
    v_mfma_f32_16x16x32_bf16 v[28:31], v[32:35], v[60:63], v[28:31]
    s_waitcnt vmcnt(0)
    v_mfma_f32_16x16x32_bf16 v[16:19], v[36:39], v[64:67], v[16:19]
    v_mfma_f32_16x16x32_bf16 v[20:23], v[36:39], v[68:71], v[20:23]
    v_mfma_f32_16x16x32_bf16 v[24:27], v[36:39], v[72:75], v[24:27]
    v_mfma_f32_16x16x32_bf16 v[28:31], v[36:39], v[76:79], v[28:31]
    s_lshl_b32 s5, s26, 2
    s_add_u32 s5, s5, s16
    s_lshl_b32 s5, s5, 5
    s_lshl_b32 s19, s3, 16
    s_add_u32 s5, s5, s19
    v_lshlrev_b32 v8, 10, v3
    v_lshl_add_u32 v8, v2, 3, v8
    s_add_u32 s18, s5, 20971520
    s_add_u32 s19, s18, 0
    buffer_load_dwordx2 v[32:33], v8, s[8:11], s19 offen
    s_add_u32 s19, s18, 16384
    buffer_load_dwordx2 v[34:35], v8, s[8:11], s19 offen
    s_add_u32 s19, s18, 32768
    buffer_load_dwordx2 v[36:37], v8, s[8:11], s19 offen
    s_add_u32 s19, s18, 49152
    buffer_load_dwordx2 v[38:39], v8, s[8:11], s19 offen
    s_waitcnt vmcnt(0)
    v_cvt_pk_bf16_f32 v16, v16, v17
    v_cvt_pk_bf16_f32 v18, v18, v19
    v_lshlrev_b32 v100, 16, v16
    v_and_b32 v101, 0xffff0000, v16
    v_lshlrev_b32 v102, 16, v18
    v_and_b32 v103, 0xffff0000, v18
    v_lshlrev_b32 v104, 16, v32
    v_and_b32 v105, 0xffff0000, v32
    v_lshlrev_b32 v106, 16, v33
    v_and_b32 v107, 0xffff0000, v33
    v_add_f32 v100, v100, v104
    v_add_f32 v101, v101, v105
    v_add_f32 v102, v102, v106
    v_add_f32 v103, v103, v107
    v_cvt_pk_bf16_f32 v16, v100, v101
    v_cvt_pk_bf16_f32 v17, v102, v103
    s_add_u32 s19, s5, 23068672
    buffer_store_dwordx2 v[16:17], v8, s[8:11], s19 offen
    v_cvt_pk_bf16_f32 v20, v20, v21
    v_cvt_pk_bf16_f32 v22, v22, v23
    v_lshlrev_b32 v100, 16, v20
    v_and_b32 v101, 0xffff0000, v20
    v_lshlrev_b32 v102, 16, v22
    v_and_b32 v103, 0xffff0000, v22
    v_lshlrev_b32 v104, 16, v34
    v_and_b32 v105, 0xffff0000, v34
    v_lshlrev_b32 v106, 16, v35
    v_and_b32 v107, 0xffff0000, v35
    v_add_f32 v100, v100, v104
    v_add_f32 v101, v101, v105
    v_add_f32 v102, v102, v106
    v_add_f32 v103, v103, v107
    v_cvt_pk_bf16_f32 v20, v100, v101
    v_cvt_pk_bf16_f32 v21, v102, v103
    s_add_u32 s19, s5, 23085056
    buffer_store_dwordx2 v[20:21], v8, s[8:11], s19 offen
    v_cvt_pk_bf16_f32 v24, v24, v25
    v_cvt_pk_bf16_f32 v26, v26, v27
    v_lshlrev_b32 v100, 16, v24
    v_and_b32 v101, 0xffff0000, v24
    v_lshlrev_b32 v102, 16, v26
    v_and_b32 v103, 0xffff0000, v26
    v_lshlrev_b32 v104, 16, v36
    v_and_b32 v105, 0xffff0000, v36
    v_lshlrev_b32 v106, 16, v37
    v_and_b32 v107, 0xffff0000, v37
    v_add_f32 v100, v100, v104
    v_add_f32 v101, v101, v105
    v_add_f32 v102, v102, v106
    v_add_f32 v103, v103, v107
    v_cvt_pk_bf16_f32 v24, v100, v101
    v_cvt_pk_bf16_f32 v25, v102, v103
    s_add_u32 s19, s5, 23101440
    buffer_store_dwordx2 v[24:25], v8, s[8:11], s19 offen
    v_cvt_pk_bf16_f32 v28, v28, v29
    v_cvt_pk_bf16_f32 v30, v30, v31
    v_lshlrev_b32 v100, 16, v28
    v_and_b32 v101, 0xffff0000, v28
    v_lshlrev_b32 v102, 16, v30
    v_and_b32 v103, 0xffff0000, v30
    v_lshlrev_b32 v104, 16, v38
    v_and_b32 v105, 0xffff0000, v38
    v_lshlrev_b32 v106, 16, v39
    v_and_b32 v107, 0xffff0000, v39
    v_add_f32 v100, v100, v104
    v_add_f32 v101, v101, v105
    v_add_f32 v102, v102, v106
    v_add_f32 v103, v103, v107
    v_cvt_pk_bf16_f32 v28, v100, v101
    v_cvt_pk_bf16_f32 v29, v102, v103
    s_add_u32 s19, s5, 23117824
    buffer_store_dwordx2 v[28:29], v8, s[8:11], s19 offen
L_kb4_end_93:
    s_endpgm
.section .rodata,"a"
.p2align 6
.amdhsa_kernel kb4_0_kernel
  .amdhsa_next_free_vgpr 112
  .amdhsa_next_free_sgpr 102
  .amdhsa_accum_offset 112
  .amdhsa_group_segment_fixed_size 0
  .amdhsa_kernarg_size 120
  .amdhsa_user_sgpr_count 2
  .amdhsa_user_sgpr_kernarg_segment_ptr 1
  .amdhsa_system_sgpr_workgroup_id_x 1
.end_amdhsa_kernel
.text

.p2align 8
.globl kb4_1_kernel
.type kb4_1_kernel,@function
kb4_1_kernel:
    s_cmp_ge_u32 s2, 256
    s_cbranch_scc1 L_kb4_end_94
    s_load_dwordx2 s[4:5], s[0:1], 112
    s_load_dwordx2 s[6:7], s[0:1], 96
    v_and_b32 v1, 63, v0
    v_lshrrev_b32 v2, 6, v0
    s_nop 0
    v_readfirstlane_b32 s16, v2
    v_lshrrev_b32 v2, 4, v1
    v_and_b32 v3, 15, v1
    s_lshr_b32 s3, s2, 3
    s_and_b32 s26, s2, 7
    s_waitcnt lgkmcnt(0)
    s_mov_b32 s8, s4
    s_and_b32 s9, s5, 0xffff
    s_mov_b32 s10, 268435456
    s_mov_b32 s11, 0x00020000
    s_mov_b32 s12, s6
    s_and_b32 s13, s7, 0xffff
    s_mov_b32 s14, 2097152
    s_mov_b32 s15, 0x00020000
    v_lshlrev_b32 v7, 4, v1
    s_lshl_b32 s5, s26, 2
    s_add_u32 s5, s5, s16
    s_lshl_b32 s5, s5, 12
    s_add_u32 s5, s5, 12582912
    s_lshl_b32 s17, s3, 19
    s_add_u32 s17, s17, 218103808
    s_add_u32 s19, s5, 0
    buffer_load_dwordx4 v[32:35], v7, s[8:11], s19 offen
    s_add_u32 s19, s17, 0
    buffer_load_dwordx4 v[48:51], v7, s[8:11], s19 offen
    s_add_u32 s19, s17, 1024
    buffer_load_dwordx4 v[52:55], v7, s[8:11], s19 offen
    s_add_u32 s19, s17, 262144
    buffer_load_dwordx4 v[56:59], v7, s[8:11], s19 offen
    s_add_u32 s19, s17, 263168
    buffer_load_dwordx4 v[60:63], v7, s[8:11], s19 offen
    s_add_u32 s19, s5, 1024
    buffer_load_dwordx4 v[36:39], v7, s[8:11], s19 offen
    s_add_u32 s19, s17, 2048
    buffer_load_dwordx4 v[64:67], v7, s[8:11], s19 offen
    s_add_u32 s19, s17, 3072
    buffer_load_dwordx4 v[68:71], v7, s[8:11], s19 offen
    s_add_u32 s19, s17, 264192
    buffer_load_dwordx4 v[72:75], v7, s[8:11], s19 offen
    s_add_u32 s19, s17, 265216
    buffer_load_dwordx4 v[76:79], v7, s[8:11], s19 offen
    s_add_u32 s19, s5, 2048
    buffer_load_dwordx4 v[40:43], v7, s[8:11], s19 offen
    s_add_u32 s19, s17, 4096
    buffer_load_dwordx4 v[80:83], v7, s[8:11], s19 offen
    s_add_u32 s19, s17, 5120
    buffer_load_dwordx4 v[84:87], v7, s[8:11], s19 offen
    s_add_u32 s19, s17, 266240
    buffer_load_dwordx4 v[88:91], v7, s[8:11], s19 offen
    s_add_u32 s19, s17, 267264
    buffer_load_dwordx4 v[92:95], v7, s[8:11], s19 offen
    s_waitcnt vmcnt(10)
    v_mfma_f32_16x16x32_bf16 v[16:19], v[32:35], v[48:51], 0
    v_mfma_f32_16x16x32_bf16 v[20:23], v[32:35], v[52:55], 0
    v_mfma_f32_16x16x32_bf16 v[24:27], v[32:35], v[56:59], 0
    v_mfma_f32_16x16x32_bf16 v[28:31], v[32:35], v[60:63], 0
    s_add_u32 s19, s5, 3072
    buffer_load_dwordx4 v[32:35], v7, s[8:11], s19 offen
    s_add_u32 s19, s17, 6144
    buffer_load_dwordx4 v[48:51], v7, s[8:11], s19 offen
    s_add_u32 s19, s17, 7168
    buffer_load_dwordx4 v[52:55], v7, s[8:11], s19 offen
    s_add_u32 s19, s17, 268288
    buffer_load_dwordx4 v[56:59], v7, s[8:11], s19 offen
    s_add_u32 s19, s17, 269312
    buffer_load_dwordx4 v[60:63], v7, s[8:11], s19 offen
    s_waitcnt vmcnt(10)
    v_mfma_f32_16x16x32_bf16 v[16:19], v[36:39], v[64:67], v[16:19]
    v_mfma_f32_16x16x32_bf16 v[20:23], v[36:39], v[68:71], v[20:23]
    v_mfma_f32_16x16x32_bf16 v[24:27], v[36:39], v[72:75], v[24:27]
    v_mfma_f32_16x16x32_bf16 v[28:31], v[36:39], v[76:79], v[28:31]
    s_add_u32 s19, s5, 131072
    buffer_load_dwordx4 v[36:39], v7, s[8:11], s19 offen
    s_add_u32 s19, s17, 8192
    buffer_load_dwordx4 v[64:67], v7, s[8:11], s19 offen
    s_add_u32 s19, s17, 9216
    buffer_load_dwordx4 v[68:71], v7, s[8:11], s19 offen
    s_add_u32 s19, s17, 270336
    buffer_load_dwordx4 v[72:75], v7, s[8:11], s19 offen
    s_add_u32 s19, s17, 271360
    buffer_load_dwordx4 v[76:79], v7, s[8:11], s19 offen
    s_waitcnt vmcnt(10)
    v_mfma_f32_16x16x32_bf16 v[16:19], v[40:43], v[80:83], v[16:19]
    v_mfma_f32_16x16x32_bf16 v[20:23], v[40:43], v[84:87], v[20:23]
    v_mfma_f32_16x16x32_bf16 v[24:27], v[40:43], v[88:91], v[24:27]
    v_mfma_f32_16x16x32_bf16 v[28:31], v[40:43], v[92:95], v[28:31]
    s_add_u32 s19, s5, 132096
    buffer_load_dwordx4 v[40:43], v7, s[8:11], s19 offen
    s_add_u32 s19, s17, 10240
    buffer_load_dwordx4 v[80:83], v7, s[8:11], s19 offen
    s_add_u32 s19, s17, 11264
    buffer_load_dwordx4 v[84:87], v7, s[8:11], s19 offen
    s_add_u32 s19, s17, 272384
    buffer_load_dwordx4 v[88:91], v7, s[8:11], s19 offen
    s_add_u32 s19, s17, 273408
    buffer_load_dwordx4 v[92:95], v7, s[8:11], s19 offen
    s_waitcnt vmcnt(10)
    v_mfma_f32_16x16x32_bf16 v[16:19], v[32:35], v[48:51], v[16:19]
    v_mfma_f32_16x16x32_bf16 v[20:23], v[32:35], v[52:55], v[20:23]
    v_mfma_f32_16x16x32_bf16 v[24:27], v[32:35], v[56:59], v[24:27]
    v_mfma_f32_16x16x32_bf16 v[28:31], v[32:35], v[60:63], v[28:31]
    s_add_u32 s19, s5, 133120
    buffer_load_dwordx4 v[32:35], v7, s[8:11], s19 offen
    s_add_u32 s19, s17, 12288
    buffer_load_dwordx4 v[48:51], v7, s[8:11], s19 offen
    s_add_u32 s19, s17, 13312
    buffer_load_dwordx4 v[52:55], v7, s[8:11], s19 offen
    s_add_u32 s19, s17, 274432
    buffer_load_dwordx4 v[56:59], v7, s[8:11], s19 offen
    s_add_u32 s19, s17, 275456
    buffer_load_dwordx4 v[60:63], v7, s[8:11], s19 offen
    s_waitcnt vmcnt(10)
    v_mfma_f32_16x16x32_bf16 v[16:19], v[36:39], v[64:67], v[16:19]
    v_mfma_f32_16x16x32_bf16 v[20:23], v[36:39], v[68:71], v[20:23]
    v_mfma_f32_16x16x32_bf16 v[24:27], v[36:39], v[72:75], v[24:27]
    v_mfma_f32_16x16x32_bf16 v[28:31], v[36:39], v[76:79], v[28:31]
    s_add_u32 s19, s5, 134144
    buffer_load_dwordx4 v[36:39], v7, s[8:11], s19 offen
    s_add_u32 s19, s17, 14336
    buffer_load_dwordx4 v[64:67], v7, s[8:11], s19 offen
    s_add_u32 s19, s17, 15360
    buffer_load_dwordx4 v[68:71], v7, s[8:11], s19 offen
    s_add_u32 s19, s17, 276480
    buffer_load_dwordx4 v[72:75], v7, s[8:11], s19 offen
    s_add_u32 s19, s17, 277504
    buffer_load_dwordx4 v[76:79], v7, s[8:11], s19 offen
    s_waitcnt vmcnt(10)
    v_mfma_f32_16x16x32_bf16 v[16:19], v[40:43], v[80:83], v[16:19]
    v_mfma_f32_16x16x32_bf16 v[20:23], v[40:43], v[84:87], v[20:23]
    v_mfma_f32_16x16x32_bf16 v[24:27], v[40:43], v[88:91], v[24:27]
    v_mfma_f32_16x16x32_bf16 v[28:31], v[40:43], v[92:95], v[28:31]
    s_add_u32 s19, s5, 262144
    buffer_load_dwordx4 v[40:43], v7, s[8:11], s19 offen
    s_add_u32 s19, s17, 16384
    buffer_load_dwordx4 v[80:83], v7, s[8:11], s19 offen
    s_add_u32 s19, s17, 17408
    buffer_load_dwordx4 v[84:87], v7, s[8:11], s19 offen
    s_add_u32 s19, s17, 278528
    buffer_load_dwordx4 v[88:91], v7, s[8:11], s19 offen
    s_add_u32 s19, s17, 279552
    buffer_load_dwordx4 v[92:95], v7, s[8:11], s19 offen
    s_waitcnt vmcnt(10)
    v_mfma_f32_16x16x32_bf16 v[16:19], v[32:35], v[48:51], v[16:19]
    v_mfma_f32_16x16x32_bf16 v[20:23], v[32:35], v[52:55], v[20:23]
    v_mfma_f32_16x16x32_bf16 v[24:27], v[32:35], v[56:59], v[24:27]
    v_mfma_f32_16x16x32_bf16 v[28:31], v[32:35], v[60:63], v[28:31]
    s_add_u32 s19, s5, 263168
    buffer_load_dwordx4 v[32:35], v7, s[8:11], s19 offen
    s_add_u32 s19, s17, 18432
    buffer_load_dwordx4 v[48:51], v7, s[8:11], s19 offen
    s_add_u32 s19, s17, 19456
    buffer_load_dwordx4 v[52:55], v7, s[8:11], s19 offen
    s_add_u32 s19, s17, 280576
    buffer_load_dwordx4 v[56:59], v7, s[8:11], s19 offen
    s_add_u32 s19, s17, 281600
    buffer_load_dwordx4 v[60:63], v7, s[8:11], s19 offen
    s_waitcnt vmcnt(10)
    v_mfma_f32_16x16x32_bf16 v[16:19], v[36:39], v[64:67], v[16:19]
    v_mfma_f32_16x16x32_bf16 v[20:23], v[36:39], v[68:71], v[20:23]
    v_mfma_f32_16x16x32_bf16 v[24:27], v[36:39], v[72:75], v[24:27]
    v_mfma_f32_16x16x32_bf16 v[28:31], v[36:39], v[76:79], v[28:31]
    s_add_u32 s19, s5, 264192
    buffer_load_dwordx4 v[36:39], v7, s[8:11], s19 offen
    s_add_u32 s19, s17, 20480
    buffer_load_dwordx4 v[64:67], v7, s[8:11], s19 offen
    s_add_u32 s19, s17, 21504
    buffer_load_dwordx4 v[68:71], v7, s[8:11], s19 offen
    s_add_u32 s19, s17, 282624
    buffer_load_dwordx4 v[72:75], v7, s[8:11], s19 offen
    s_add_u32 s19, s17, 283648
    buffer_load_dwordx4 v[76:79], v7, s[8:11], s19 offen
    s_waitcnt vmcnt(10)
    v_mfma_f32_16x16x32_bf16 v[16:19], v[40:43], v[80:83], v[16:19]
    v_mfma_f32_16x16x32_bf16 v[20:23], v[40:43], v[84:87], v[20:23]
    v_mfma_f32_16x16x32_bf16 v[24:27], v[40:43], v[88:91], v[24:27]
    v_mfma_f32_16x16x32_bf16 v[28:31], v[40:43], v[92:95], v[28:31]
    s_add_u32 s19, s5, 265216
    buffer_load_dwordx4 v[40:43], v7, s[8:11], s19 offen
    s_add_u32 s19, s17, 22528
    buffer_load_dwordx4 v[80:83], v7, s[8:11], s19 offen
    s_add_u32 s19, s17, 23552
    buffer_load_dwordx4 v[84:87], v7, s[8:11], s19 offen
    s_add_u32 s19, s17, 284672
    buffer_load_dwordx4 v[88:91], v7, s[8:11], s19 offen
    s_add_u32 s19, s17, 285696
    buffer_load_dwordx4 v[92:95], v7, s[8:11], s19 offen
    s_waitcnt vmcnt(10)
    v_mfma_f32_16x16x32_bf16 v[16:19], v[32:35], v[48:51], v[16:19]
    v_mfma_f32_16x16x32_bf16 v[20:23], v[32:35], v[52:55], v[20:23]
    v_mfma_f32_16x16x32_bf16 v[24:27], v[32:35], v[56:59], v[24:27]
    v_mfma_f32_16x16x32_bf16 v[28:31], v[32:35], v[60:63], v[28:31]
    s_add_u32 s19, s5, 393216
    buffer_load_dwordx4 v[32:35], v7, s[8:11], s19 offen
    s_add_u32 s19, s17, 24576
    buffer_load_dwordx4 v[48:51], v7, s[8:11], s19 offen
    s_add_u32 s19, s17, 25600
    buffer_load_dwordx4 v[52:55], v7, s[8:11], s19 offen
    s_add_u32 s19, s17, 286720
    buffer_load_dwordx4 v[56:59], v7, s[8:11], s19 offen
    s_add_u32 s19, s17, 287744
    buffer_load_dwordx4 v[60:63], v7, s[8:11], s19 offen
    s_waitcnt vmcnt(10)
    v_mfma_f32_16x16x32_bf16 v[16:19], v[36:39], v[64:67], v[16:19]
    v_mfma_f32_16x16x32_bf16 v[20:23], v[36:39], v[68:71], v[20:23]
    v_mfma_f32_16x16x32_bf16 v[24:27], v[36:39], v[72:75], v[24:27]
    v_mfma_f32_16x16x32_bf16 v[28:31], v[36:39], v[76:79], v[28:31]
    s_add_u32 s19, s5, 394240
    buffer_load_dwordx4 v[36:39], v7, s[8:11], s19 offen
    s_add_u32 s19, s17, 26624
    buffer_load_dwordx4 v[64:67], v7, s[8:11], s19 offen
    s_add_u32 s19, s17, 27648
    buffer_load_dwordx4 v[68:71], v7, s[8:11], s19 offen
    s_add_u32 s19, s17, 288768
    buffer_load_dwordx4 v[72:75], v7, s[8:11], s19 offen
    s_add_u32 s19, s17, 289792
    buffer_load_dwordx4 v[76:79], v7, s[8:11], s19 offen
    s_waitcnt vmcnt(10)
    v_mfma_f32_16x16x32_bf16 v[16:19], v[40:43], v[80:83], v[16:19]
    v_mfma_f32_16x16x32_bf16 v[20:23], v[40:43], v[84:87], v[20:23]
    v_mfma_f32_16x16x32_bf16 v[24:27], v[40:43], v[88:91], v[24:27]
    v_mfma_f32_16x16x32_bf16 v[28:31], v[40:43], v[92:95], v[28:31]
    s_add_u32 s19, s5, 395264
    buffer_load_dwordx4 v[40:43], v7, s[8:11], s19 offen
    s_add_u32 s19, s17, 28672
    buffer_load_dwordx4 v[80:83], v7, s[8:11], s19 offen
    s_add_u32 s19, s17, 29696
    buffer_load_dwordx4 v[84:87], v7, s[8:11], s19 offen
    s_add_u32 s19, s17, 290816
    buffer_load_dwordx4 v[88:91], v7, s[8:11], s19 offen
    s_add_u32 s19, s17, 291840
    buffer_load_dwordx4 v[92:95], v7, s[8:11], s19 offen
    s_waitcnt vmcnt(10)
    v_mfma_f32_16x16x32_bf16 v[16:19], v[32:35], v[48:51], v[16:19]
    v_mfma_f32_16x16x32_bf16 v[20:23], v[32:35], v[52:55], v[20:23]
    v_mfma_f32_16x16x32_bf16 v[24:27], v[32:35], v[56:59], v[24:27]
    v_mfma_f32_16x16x32_bf16 v[28:31], v[32:35], v[60:63], v[28:31]
    s_add_u32 s19, s5, 396288
    buffer_load_dwordx4 v[32:35], v7, s[8:11], s19 offen
    s_add_u32 s19, s17, 30720
    buffer_load_dwordx4 v[48:51], v7, s[8:11], s19 offen
    s_add_u32 s19, s17, 31744
    buffer_load_dwordx4 v[52:55], v7, s[8:11], s19 offen
    s_add_u32 s19, s17, 292864
    buffer_load_dwordx4 v[56:59], v7, s[8:11], s19 offen
    s_add_u32 s19, s17, 293888
    buffer_load_dwordx4 v[60:63], v7, s[8:11], s19 offen
    s_waitcnt vmcnt(10)
    v_mfma_f32_16x16x32_bf16 v[16:19], v[36:39], v[64:67], v[16:19]
    v_mfma_f32_16x16x32_bf16 v[20:23], v[36:39], v[68:71], v[20:23]
    v_mfma_f32_16x16x32_bf16 v[24:27], v[36:39], v[72:75], v[24:27]
    v_mfma_f32_16x16x32_bf16 v[28:31], v[36:39], v[76:79], v[28:31]
    s_add_u32 s19, s5, 524288
    buffer_load_dwordx4 v[36:39], v7, s[8:11], s19 offen
    s_add_u32 s19, s17, 32768
    buffer_load_dwordx4 v[64:67], v7, s[8:11], s19 offen
    s_add_u32 s19, s17, 33792
    buffer_load_dwordx4 v[68:71], v7, s[8:11], s19 offen
    s_add_u32 s19, s17, 294912
    buffer_load_dwordx4 v[72:75], v7, s[8:11], s19 offen
    s_add_u32 s19, s17, 295936
    buffer_load_dwordx4 v[76:79], v7, s[8:11], s19 offen
    s_waitcnt vmcnt(10)
    v_mfma_f32_16x16x32_bf16 v[16:19], v[40:43], v[80:83], v[16:19]
    v_mfma_f32_16x16x32_bf16 v[20:23], v[40:43], v[84:87], v[20:23]
    v_mfma_f32_16x16x32_bf16 v[24:27], v[40:43], v[88:91], v[24:27]
    v_mfma_f32_16x16x32_bf16 v[28:31], v[40:43], v[92:95], v[28:31]
    s_add_u32 s19, s5, 525312
    buffer_load_dwordx4 v[40:43], v7, s[8:11], s19 offen
    s_add_u32 s19, s17, 34816
    buffer_load_dwordx4 v[80:83], v7, s[8:11], s19 offen
    s_add_u32 s19, s17, 35840
    buffer_load_dwordx4 v[84:87], v7, s[8:11], s19 offen
    s_add_u32 s19, s17, 296960
    buffer_load_dwordx4 v[88:91], v7, s[8:11], s19 offen
    s_add_u32 s19, s17, 297984
    buffer_load_dwordx4 v[92:95], v7, s[8:11], s19 offen
    s_waitcnt vmcnt(10)
    v_mfma_f32_16x16x32_bf16 v[16:19], v[32:35], v[48:51], v[16:19]
    v_mfma_f32_16x16x32_bf16 v[20:23], v[32:35], v[52:55], v[20:23]
    v_mfma_f32_16x16x32_bf16 v[24:27], v[32:35], v[56:59], v[24:27]
    v_mfma_f32_16x16x32_bf16 v[28:31], v[32:35], v[60:63], v[28:31]
    s_add_u32 s19, s5, 526336
    buffer_load_dwordx4 v[32:35], v7, s[8:11], s19 offen
    s_add_u32 s19, s17, 36864
    buffer_load_dwordx4 v[48:51], v7, s[8:11], s19 offen
    s_add_u32 s19, s17, 37888
    buffer_load_dwordx4 v[52:55], v7, s[8:11], s19 offen
    s_add_u32 s19, s17, 299008
    buffer_load_dwordx4 v[56:59], v7, s[8:11], s19 offen
    s_add_u32 s19, s17, 300032
    buffer_load_dwordx4 v[60:63], v7, s[8:11], s19 offen
    s_waitcnt vmcnt(10)
    v_mfma_f32_16x16x32_bf16 v[16:19], v[36:39], v[64:67], v[16:19]
    v_mfma_f32_16x16x32_bf16 v[20:23], v[36:39], v[68:71], v[20:23]
    v_mfma_f32_16x16x32_bf16 v[24:27], v[36:39], v[72:75], v[24:27]
    v_mfma_f32_16x16x32_bf16 v[28:31], v[36:39], v[76:79], v[28:31]
    s_add_u32 s19, s5, 527360
    buffer_load_dwordx4 v[36:39], v7, s[8:11], s19 offen
    s_add_u32 s19, s17, 38912
    buffer_load_dwordx4 v[64:67], v7, s[8:11], s19 offen
    s_add_u32 s19, s17, 39936
    buffer_load_dwordx4 v[68:71], v7, s[8:11], s19 offen
    s_add_u32 s19, s17, 301056
    buffer_load_dwordx4 v[72:75], v7, s[8:11], s19 offen
    s_add_u32 s19, s17, 302080
    buffer_load_dwordx4 v[76:79], v7, s[8:11], s19 offen
    s_waitcnt vmcnt(10)
    v_mfma_f32_16x16x32_bf16 v[16:19], v[40:43], v[80:83], v[16:19]
    v_mfma_f32_16x16x32_bf16 v[20:23], v[40:43], v[84:87], v[20:23]
    v_mfma_f32_16x16x32_bf16 v[24:27], v[40:43], v[88:91], v[24:27]
    v_mfma_f32_16x16x32_bf16 v[28:31], v[40:43], v[92:95], v[28:31]
    s_add_u32 s19, s5, 655360
    buffer_load_dwordx4 v[40:43], v7, s[8:11], s19 offen
    s_add_u32 s19, s17, 40960
    buffer_load_dwordx4 v[80:83], v7, s[8:11], s19 offen
    s_add_u32 s19, s17, 41984
    buffer_load_dwordx4 v[84:87], v7, s[8:11], s19 offen
    s_add_u32 s19, s17, 303104
    buffer_load_dwordx4 v[88:91], v7, s[8:11], s19 offen
    s_add_u32 s19, s17, 304128
    buffer_load_dwordx4 v[92:95], v7, s[8:11], s19 offen
    s_waitcnt vmcnt(10)
    v_mfma_f32_16x16x32_bf16 v[16:19], v[32:35], v[48:51], v[16:19]
    v_mfma_f32_16x16x32_bf16 v[20:23], v[32:35], v[52:55], v[20:23]
    v_mfma_f32_16x16x32_bf16 v[24:27], v[32:35], v[56:59], v[24:27]
    v_mfma_f32_16x16x32_bf16 v[28:31], v[32:35], v[60:63], v[28:31]
    s_add_u32 s19, s5, 656384
    buffer_load_dwordx4 v[32:35], v7, s[8:11], s19 offen
    s_add_u32 s19, s17, 43008
    buffer_load_dwordx4 v[48:51], v7, s[8:11], s19 offen
    s_add_u32 s19, s17, 44032
    buffer_load_dwordx4 v[52:55], v7, s[8:11], s19 offen
    s_add_u32 s19, s17, 305152
    buffer_load_dwordx4 v[56:59], v7, s[8:11], s19 offen
    s_add_u32 s19, s17, 306176
    buffer_load_dwordx4 v[60:63], v7, s[8:11], s19 offen
    s_waitcnt vmcnt(10)
    v_mfma_f32_16x16x32_bf16 v[16:19], v[36:39], v[64:67], v[16:19]
    v_mfma_f32_16x16x32_bf16 v[20:23], v[36:39], v[68:71], v[20:23]
    v_mfma_f32_16x16x32_bf16 v[24:27], v[36:39], v[72:75], v[24:27]
    v_mfma_f32_16x16x32_bf16 v[28:31], v[36:39], v[76:79], v[28:31]
    s_add_u32 s19, s5, 657408
    buffer_load_dwordx4 v[36:39], v7, s[8:11], s19 offen
    s_add_u32 s19, s17, 45056
    buffer_load_dwordx4 v[64:67], v7, s[8:11], s19 offen
    s_add_u32 s19, s17, 46080
    buffer_load_dwordx4 v[68:71], v7, s[8:11], s19 offen
    s_add_u32 s19, s17, 307200
    buffer_load_dwordx4 v[72:75], v7, s[8:11], s19 offen
    s_add_u32 s19, s17, 308224
    buffer_load_dwordx4 v[76:79], v7, s[8:11], s19 offen
    s_waitcnt vmcnt(10)
    v_mfma_f32_16x16x32_bf16 v[16:19], v[40:43], v[80:83], v[16:19]
    v_mfma_f32_16x16x32_bf16 v[20:23], v[40:43], v[84:87], v[20:23]
    v_mfma_f32_16x16x32_bf16 v[24:27], v[40:43], v[88:91], v[24:27]
    v_mfma_f32_16x16x32_bf16 v[28:31], v[40:43], v[92:95], v[28:31]
    s_add_u32 s19, s5, 658432
    buffer_load_dwordx4 v[40:43], v7, s[8:11], s19 offen
    s_add_u32 s19, s17, 47104
    buffer_load_dwordx4 v[80:83], v7, s[8:11], s19 offen
    s_add_u32 s19, s17, 48128
    buffer_load_dwordx4 v[84:87], v7, s[8:11], s19 offen
    s_add_u32 s19, s17, 309248
    buffer_load_dwordx4 v[88:91], v7, s[8:11], s19 offen
    s_add_u32 s19, s17, 310272
    buffer_load_dwordx4 v[92:95], v7, s[8:11], s19 offen
    s_waitcnt vmcnt(10)
    v_mfma_f32_16x16x32_bf16 v[16:19], v[32:35], v[48:51], v[16:19]
    v_mfma_f32_16x16x32_bf16 v[20:23], v[32:35], v[52:55], v[20:23]
    v_mfma_f32_16x16x32_bf16 v[24:27], v[32:35], v[56:59], v[24:27]
    v_mfma_f32_16x16x32_bf16 v[28:31], v[32:35], v[60:63], v[28:31]
    s_add_u32 s19, s5, 786432
    buffer_load_dwordx4 v[32:35], v7, s[8:11], s19 offen
    s_add_u32 s19, s17, 49152
    buffer_load_dwordx4 v[48:51], v7, s[8:11], s19 offen
    s_add_u32 s19, s17, 50176
    buffer_load_dwordx4 v[52:55], v7, s[8:11], s19 offen
    s_add_u32 s19, s17, 311296
    buffer_load_dwordx4 v[56:59], v7, s[8:11], s19 offen
    s_add_u32 s19, s17, 312320
    buffer_load_dwordx4 v[60:63], v7, s[8:11], s19 offen
    s_waitcnt vmcnt(10)
    v_mfma_f32_16x16x32_bf16 v[16:19], v[36:39], v[64:67], v[16:19]
    v_mfma_f32_16x16x32_bf16 v[20:23], v[36:39], v[68:71], v[20:23]
    v_mfma_f32_16x16x32_bf16 v[24:27], v[36:39], v[72:75], v[24:27]
    v_mfma_f32_16x16x32_bf16 v[28:31], v[36:39], v[76:79], v[28:31]
    s_add_u32 s19, s5, 787456
    buffer_load_dwordx4 v[36:39], v7, s[8:11], s19 offen
    s_add_u32 s19, s17, 51200
    buffer_load_dwordx4 v[64:67], v7, s[8:11], s19 offen
    s_add_u32 s19, s17, 52224
    buffer_load_dwordx4 v[68:71], v7, s[8:11], s19 offen
    s_add_u32 s19, s17, 313344
    buffer_load_dwordx4 v[72:75], v7, s[8:11], s19 offen
    s_add_u32 s19, s17, 314368
    buffer_load_dwordx4 v[76:79], v7, s[8:11], s19 offen
    s_waitcnt vmcnt(10)
    v_mfma_f32_16x16x32_bf16 v[16:19], v[40:43], v[80:83], v[16:19]
    v_mfma_f32_16x16x32_bf16 v[20:23], v[40:43], v[84:87], v[20:23]
    v_mfma_f32_16x16x32_bf16 v[24:27], v[40:43], v[88:91], v[24:27]
    v_mfma_f32_16x16x32_bf16 v[28:31], v[40:43], v[92:95], v[28:31]
    s_add_u32 s19, s5, 788480
    buffer_load_dwordx4 v[40:43], v7, s[8:11], s19 offen
    s_add_u32 s19, s17, 53248
    buffer_load_dwordx4 v[80:83], v7, s[8:11], s19 offen
    s_add_u32 s19, s17, 54272
    buffer_load_dwordx4 v[84:87], v7, s[8:11], s19 offen
    s_add_u32 s19, s17, 315392
    buffer_load_dwordx4 v[88:91], v7, s[8:11], s19 offen
    s_add_u32 s19, s17, 316416
    buffer_load_dwordx4 v[92:95], v7, s[8:11], s19 offen
    s_waitcnt vmcnt(10)
    v_mfma_f32_16x16x32_bf16 v[16:19], v[32:35], v[48:51], v[16:19]
    v_mfma_f32_16x16x32_bf16 v[20:23], v[32:35], v[52:55], v[20:23]
    v_mfma_f32_16x16x32_bf16 v[24:27], v[32:35], v[56:59], v[24:27]
    v_mfma_f32_16x16x32_bf16 v[28:31], v[32:35], v[60:63], v[28:31]
    s_add_u32 s19, s5, 789504
    buffer_load_dwordx4 v[32:35], v7, s[8:11], s19 offen
    s_add_u32 s19, s17, 55296
    buffer_load_dwordx4 v[48:51], v7, s[8:11], s19 offen
    s_add_u32 s19, s17, 56320
    buffer_load_dwordx4 v[52:55], v7, s[8:11], s19 offen
    s_add_u32 s19, s17, 317440
    buffer_load_dwordx4 v[56:59], v7, s[8:11], s19 offen
    s_add_u32 s19, s17, 318464
    buffer_load_dwordx4 v[60:63], v7, s[8:11], s19 offen
    s_waitcnt vmcnt(10)
    v_mfma_f32_16x16x32_bf16 v[16:19], v[36:39], v[64:67], v[16:19]
    v_mfma_f32_16x16x32_bf16 v[20:23], v[36:39], v[68:71], v[20:23]
    v_mfma_f32_16x16x32_bf16 v[24:27], v[36:39], v[72:75], v[24:27]
    v_mfma_f32_16x16x32_bf16 v[28:31], v[36:39], v[76:79], v[28:31]
    s_add_u32 s19, s5, 917504
    buffer_load_dwordx4 v[36:39], v7, s[8:11], s19 offen
    s_add_u32 s19, s17, 57344
    buffer_load_dwordx4 v[64:67], v7, s[8:11], s19 offen
    s_add_u32 s19, s17, 58368
    buffer_load_dwordx4 v[68:71], v7, s[8:11], s19 offen
    s_add_u32 s19, s17, 319488
    buffer_load_dwordx4 v[72:75], v7, s[8:11], s19 offen
    s_add_u32 s19, s17, 320512
    buffer_load_dwordx4 v[76:79], v7, s[8:11], s19 offen
    s_waitcnt vmcnt(10)
    v_mfma_f32_16x16x32_bf16 v[16:19], v[40:43], v[80:83], v[16:19]
    v_mfma_f32_16x16x32_bf16 v[20:23], v[40:43], v[84:87], v[20:23]
    v_mfma_f32_16x16x32_bf16 v[24:27], v[40:43], v[88:91], v[24:27]
    v_mfma_f32_16x16x32_bf16 v[28:31], v[40:43], v[92:95], v[28:31]
    s_add_u32 s19, s5, 918528
    buffer_load_dwordx4 v[40:43], v7, s[8:11], s19 offen
    s_add_u32 s19, s17, 59392
    buffer_load_dwordx4 v[80:83], v7, s[8:11], s19 offen
    s_add_u32 s19, s17, 60416
    buffer_load_dwordx4 v[84:87], v7, s[8:11], s19 offen
    s_add_u32 s19, s17, 321536
    buffer_load_dwordx4 v[88:91], v7, s[8:11], s19 offen
    s_add_u32 s19, s17, 322560
    buffer_load_dwordx4 v[92:95], v7, s[8:11], s19 offen
    s_waitcnt vmcnt(10)
    v_mfma_f32_16x16x32_bf16 v[16:19], v[32:35], v[48:51], v[16:19]
    v_mfma_f32_16x16x32_bf16 v[20:23], v[32:35], v[52:55], v[20:23]
    v_mfma_f32_16x16x32_bf16 v[24:27], v[32:35], v[56:59], v[24:27]
    v_mfma_f32_16x16x32_bf16 v[28:31], v[32:35], v[60:63], v[28:31]
    s_add_u32 s19, s5, 919552
    buffer_load_dwordx4 v[32:35], v7, s[8:11], s19 offen
    s_add_u32 s19, s17, 61440
    buffer_load_dwordx4 v[48:51], v7, s[8:11], s19 offen
    s_add_u32 s19, s17, 62464
    buffer_load_dwordx4 v[52:55], v7, s[8:11], s19 offen
    s_add_u32 s19, s17, 323584
    buffer_load_dwordx4 v[56:59], v7, s[8:11], s19 offen
    s_add_u32 s19, s17, 324608
    buffer_load_dwordx4 v[60:63], v7, s[8:11], s19 offen
    s_waitcnt vmcnt(10)
    v_mfma_f32_16x16x32_bf16 v[16:19], v[36:39], v[64:67], v[16:19]
    v_mfma_f32_16x16x32_bf16 v[20:23], v[36:39], v[68:71], v[20:23]
    v_mfma_f32_16x16x32_bf16 v[24:27], v[36:39], v[72:75], v[24:27]
    v_mfma_f32_16x16x32_bf16 v[28:31], v[36:39], v[76:79], v[28:31]
    s_add_u32 s19, s5, 920576
    buffer_load_dwordx4 v[36:39], v7, s[8:11], s19 offen
    s_add_u32 s19, s17, 63488
    buffer_load_dwordx4 v[64:67], v7, s[8:11], s19 offen
    s_add_u32 s19, s17, 64512
    buffer_load_dwordx4 v[68:71], v7, s[8:11], s19 offen
    s_add_u32 s19, s17, 325632
    buffer_load_dwordx4 v[72:75], v7, s[8:11], s19 offen
    s_add_u32 s19, s17, 326656
    buffer_load_dwordx4 v[76:79], v7, s[8:11], s19 offen
    s_waitcnt vmcnt(10)
    v_mfma_f32_16x16x32_bf16 v[16:19], v[40:43], v[80:83], v[16:19]
    v_mfma_f32_16x16x32_bf16 v[20:23], v[40:43], v[84:87], v[20:23]
    v_mfma_f32_16x16x32_bf16 v[24:27], v[40:43], v[88:91], v[24:27]
    v_mfma_f32_16x16x32_bf16 v[28:31], v[40:43], v[92:95], v[28:31]
    s_add_u32 s19, s5, 1048576
    buffer_load_dwordx4 v[40:43], v7, s[8:11], s19 offen
    s_add_u32 s19, s17, 65536
    buffer_load_dwordx4 v[80:83], v7, s[8:11], s19 offen
    s_add_u32 s19, s17, 66560
    buffer_load_dwordx4 v[84:87], v7, s[8:11], s19 offen
    s_add_u32 s19, s17, 327680
    buffer_load_dwordx4 v[88:91], v7, s[8:11], s19 offen
    s_add_u32 s19, s17, 328704
    buffer_load_dwordx4 v[92:95], v7, s[8:11], s19 offen
    s_waitcnt vmcnt(10)
    v_mfma_f32_16x16x32_bf16 v[16:19], v[32:35], v[48:51], v[16:19]
    v_mfma_f32_16x16x32_bf16 v[20:23], v[32:35], v[52:55], v[20:23]
    v_mfma_f32_16x16x32_bf16 v[24:27], v[32:35], v[56:59], v[24:27]
    v_mfma_f32_16x16x32_bf16 v[28:31], v[32:35], v[60:63], v[28:31]
    s_add_u32 s19, s5, 1049600
    buffer_load_dwordx4 v[32:35], v7, s[8:11], s19 offen
    s_add_u32 s19, s17, 67584
    buffer_load_dwordx4 v[48:51], v7, s[8:11], s19 offen
    s_add_u32 s19, s17, 68608
    buffer_load_dwordx4 v[52:55], v7, s[8:11], s19 offen
    s_add_u32 s19, s17, 329728
    buffer_load_dwordx4 v[56:59], v7, s[8:11], s19 offen
    s_add_u32 s19, s17, 330752
    buffer_load_dwordx4 v[60:63], v7, s[8:11], s19 offen
    s_waitcnt vmcnt(10)
    v_mfma_f32_16x16x32_bf16 v[16:19], v[36:39], v[64:67], v[16:19]
    v_mfma_f32_16x16x32_bf16 v[20:23], v[36:39], v[68:71], v[20:23]
    v_mfma_f32_16x16x32_bf16 v[24:27], v[36:39], v[72:75], v[24:27]
    v_mfma_f32_16x16x32_bf16 v[28:31], v[36:39], v[76:79], v[28:31]
    s_add_u32 s19, s5, 1050624
    buffer_load_dwordx4 v[36:39], v7, s[8:11], s19 offen
    s_add_u32 s19, s17, 69632
    buffer_load_dwordx4 v[64:67], v7, s[8:11], s19 offen
    s_add_u32 s19, s17, 70656
    buffer_load_dwordx4 v[68:71], v7, s[8:11], s19 offen
    s_add_u32 s19, s17, 331776
    buffer_load_dwordx4 v[72:75], v7, s[8:11], s19 offen
    s_add_u32 s19, s17, 332800
    buffer_load_dwordx4 v[76:79], v7, s[8:11], s19 offen
    s_waitcnt vmcnt(10)
    v_mfma_f32_16x16x32_bf16 v[16:19], v[40:43], v[80:83], v[16:19]
    v_mfma_f32_16x16x32_bf16 v[20:23], v[40:43], v[84:87], v[20:23]
    v_mfma_f32_16x16x32_bf16 v[24:27], v[40:43], v[88:91], v[24:27]
    v_mfma_f32_16x16x32_bf16 v[28:31], v[40:43], v[92:95], v[28:31]
    s_add_u32 s19, s5, 1051648
    buffer_load_dwordx4 v[40:43], v7, s[8:11], s19 offen
    s_add_u32 s19, s17, 71680
    buffer_load_dwordx4 v[80:83], v7, s[8:11], s19 offen
    s_add_u32 s19, s17, 72704
    buffer_load_dwordx4 v[84:87], v7, s[8:11], s19 offen
    s_add_u32 s19, s17, 333824
    buffer_load_dwordx4 v[88:91], v7, s[8:11], s19 offen
    s_add_u32 s19, s17, 334848
    buffer_load_dwordx4 v[92:95], v7, s[8:11], s19 offen
    s_waitcnt vmcnt(10)
    v_mfma_f32_16x16x32_bf16 v[16:19], v[32:35], v[48:51], v[16:19]
    v_mfma_f32_16x16x32_bf16 v[20:23], v[32:35], v[52:55], v[20:23]
    v_mfma_f32_16x16x32_bf16 v[24:27], v[32:35], v[56:59], v[24:27]
    v_mfma_f32_16x16x32_bf16 v[28:31], v[32:35], v[60:63], v[28:31]
    s_add_u32 s19, s5, 1179648
    buffer_load_dwordx4 v[32:35], v7, s[8:11], s19 offen
    s_add_u32 s19, s17, 73728
    buffer_load_dwordx4 v[48:51], v7, s[8:11], s19 offen
    s_add_u32 s19, s17, 74752
    buffer_load_dwordx4 v[52:55], v7, s[8:11], s19 offen
    s_add_u32 s19, s17, 335872
    buffer_load_dwordx4 v[56:59], v7, s[8:11], s19 offen
    s_add_u32 s19, s17, 336896
    buffer_load_dwordx4 v[60:63], v7, s[8:11], s19 offen
    s_waitcnt vmcnt(10)
    v_mfma_f32_16x16x32_bf16 v[16:19], v[36:39], v[64:67], v[16:19]
    v_mfma_f32_16x16x32_bf16 v[20:23], v[36:39], v[68:71], v[20:23]
    v_mfma_f32_16x16x32_bf16 v[24:27], v[36:39], v[72:75], v[24:27]
    v_mfma_f32_16x16x32_bf16 v[28:31], v[36:39], v[76:79], v[28:31]
    s_add_u32 s19, s5, 1180672
    buffer_load_dwordx4 v[36:39], v7, s[8:11], s19 offen
    s_add_u32 s19, s17, 75776
    buffer_load_dwordx4 v[64:67], v7, s[8:11], s19 offen
    s_add_u32 s19, s17, 76800
    buffer_load_dwordx4 v[68:71], v7, s[8:11], s19 offen
    s_add_u32 s19, s17, 337920
    buffer_load_dwordx4 v[72:75], v7, s[8:11], s19 offen
    s_add_u32 s19, s17, 338944
    buffer_load_dwordx4 v[76:79], v7, s[8:11], s19 offen
    s_waitcnt vmcnt(10)
    v_mfma_f32_16x16x32_bf16 v[16:19], v[40:43], v[80:83], v[16:19]
    v_mfma_f32_16x16x32_bf16 v[20:23], v[40:43], v[84:87], v[20:23]
    v_mfma_f32_16x16x32_bf16 v[24:27], v[40:43], v[88:91], v[24:27]
    v_mfma_f32_16x16x32_bf16 v[28:31], v[40:43], v[92:95], v[28:31]
    s_add_u32 s19, s5, 1181696
    buffer_load_dwordx4 v[40:43], v7, s[8:11], s19 offen
    s_add_u32 s19, s17, 77824
    buffer_load_dwordx4 v[80:83], v7, s[8:11], s19 offen
    s_add_u32 s19, s17, 78848
    buffer_load_dwordx4 v[84:87], v7, s[8:11], s19 offen
    s_add_u32 s19, s17, 339968
    buffer_load_dwordx4 v[88:91], v7, s[8:11], s19 offen
    s_add_u32 s19, s17, 340992
    buffer_load_dwordx4 v[92:95], v7, s[8:11], s19 offen
    s_waitcnt vmcnt(10)
    v_mfma_f32_16x16x32_bf16 v[16:19], v[32:35], v[48:51], v[16:19]
    v_mfma_f32_16x16x32_bf16 v[20:23], v[32:35], v[52:55], v[20:23]
    v_mfma_f32_16x16x32_bf16 v[24:27], v[32:35], v[56:59], v[24:27]
    v_mfma_f32_16x16x32_bf16 v[28:31], v[32:35], v[60:63], v[28:31]
    s_add_u32 s19, s5, 1182720
    buffer_load_dwordx4 v[32:35], v7, s[8:11], s19 offen
    s_add_u32 s19, s17, 79872
    buffer_load_dwordx4 v[48:51], v7, s[8:11], s19 offen
    s_add_u32 s19, s17, 80896
    buffer_load_dwordx4 v[52:55], v7, s[8:11], s19 offen
    s_add_u32 s19, s17, 342016
    buffer_load_dwordx4 v[56:59], v7, s[8:11], s19 offen
    s_add_u32 s19, s17, 343040
    buffer_load_dwordx4 v[60:63], v7, s[8:11], s19 offen
    s_waitcnt vmcnt(10)
    v_mfma_f32_16x16x32_bf16 v[16:19], v[36:39], v[64:67], v[16:19]
    v_mfma_f32_16x16x32_bf16 v[20:23], v[36:39], v[68:71], v[20:23]
    v_mfma_f32_16x16x32_bf16 v[24:27], v[36:39], v[72:75], v[24:27]
    v_mfma_f32_16x16x32_bf16 v[28:31], v[36:39], v[76:79], v[28:31]
    s_add_u32 s19, s5, 1310720
    buffer_load_dwordx4 v[36:39], v7, s[8:11], s19 offen
    s_add_u32 s19, s17, 81920
    buffer_load_dwordx4 v[64:67], v7, s[8:11], s19 offen
    s_add_u32 s19, s17, 82944
    buffer_load_dwordx4 v[68:71], v7, s[8:11], s19 offen
    s_add_u32 s19, s17, 344064
    buffer_load_dwordx4 v[72:75], v7, s[8:11], s19 offen
    s_add_u32 s19, s17, 345088
    buffer_load_dwordx4 v[76:79], v7, s[8:11], s19 offen
    s_waitcnt vmcnt(10)
    v_mfma_f32_16x16x32_bf16 v[16:19], v[40:43], v[80:83], v[16:19]
    v_mfma_f32_16x16x32_bf16 v[20:23], v[40:43], v[84:87], v[20:23]
    v_mfma_f32_16x16x32_bf16 v[24:27], v[40:43], v[88:91], v[24:27]
    v_mfma_f32_16x16x32_bf16 v[28:31], v[40:43], v[92:95], v[28:31]
    s_add_u32 s19, s5, 1311744
    buffer_load_dwordx4 v[40:43], v7, s[8:11], s19 offen
    s_add_u32 s19, s17, 83968
    buffer_load_dwordx4 v[80:83], v7, s[8:11], s19 offen
    s_add_u32 s19, s17, 84992
    buffer_load_dwordx4 v[84:87], v7, s[8:11], s19 offen
    s_add_u32 s19, s17, 346112
    buffer_load_dwordx4 v[88:91], v7, s[8:11], s19 offen
    s_add_u32 s19, s17, 347136
    buffer_load_dwordx4 v[92:95], v7, s[8:11], s19 offen
    s_waitcnt vmcnt(10)
    v_mfma_f32_16x16x32_bf16 v[16:19], v[32:35], v[48:51], v[16:19]
    v_mfma_f32_16x16x32_bf16 v[20:23], v[32:35], v[52:55], v[20:23]
    v_mfma_f32_16x16x32_bf16 v[24:27], v[32:35], v[56:59], v[24:27]
    v_mfma_f32_16x16x32_bf16 v[28:31], v[32:35], v[60:63], v[28:31]
    s_add_u32 s19, s5, 1312768
    buffer_load_dwordx4 v[32:35], v7, s[8:11], s19 offen
    s_add_u32 s19, s17, 86016
    buffer_load_dwordx4 v[48:51], v7, s[8:11], s19 offen
    s_add_u32 s19, s17, 87040
    buffer_load_dwordx4 v[52:55], v7, s[8:11], s19 offen
    s_add_u32 s19, s17, 348160
    buffer_load_dwordx4 v[56:59], v7, s[8:11], s19 offen
    s_add_u32 s19, s17, 349184
    buffer_load_dwordx4 v[60:63], v7, s[8:11], s19 offen
    s_waitcnt vmcnt(10)
    v_mfma_f32_16x16x32_bf16 v[16:19], v[36:39], v[64:67], v[16:19]
    v_mfma_f32_16x16x32_bf16 v[20:23], v[36:39], v[68:71], v[20:23]
    v_mfma_f32_16x16x32_bf16 v[24:27], v[36:39], v[72:75], v[24:27]
    v_mfma_f32_16x16x32_bf16 v[28:31], v[36:39], v[76:79], v[28:31]
    s_add_u32 s19, s5, 1313792
    buffer_load_dwordx4 v[36:39], v7, s[8:11], s19 offen
    s_add_u32 s19, s17, 88064
    buffer_load_dwordx4 v[64:67], v7, s[8:11], s19 offen
    s_add_u32 s19, s17, 89088
    buffer_load_dwordx4 v[68:71], v7, s[8:11], s19 offen
    s_add_u32 s19, s17, 350208
    buffer_load_dwordx4 v[72:75], v7, s[8:11], s19 offen
    s_add_u32 s19, s17, 351232
    buffer_load_dwordx4 v[76:79], v7, s[8:11], s19 offen
    s_waitcnt vmcnt(10)
    v_mfma_f32_16x16x32_bf16 v[16:19], v[40:43], v[80:83], v[16:19]
    v_mfma_f32_16x16x32_bf16 v[20:23], v[40:43], v[84:87], v[20:23]
    v_mfma_f32_16x16x32_bf16 v[24:27], v[40:43], v[88:91], v[24:27]
    v_mfma_f32_16x16x32_bf16 v[28:31], v[40:43], v[92:95], v[28:31]
    s_add_u32 s19, s5, 1441792
    buffer_load_dwordx4 v[40:43], v7, s[8:11], s19 offen
    s_add_u32 s19, s17, 90112
    buffer_load_dwordx4 v[80:83], v7, s[8:11], s19 offen
    s_add_u32 s19, s17, 91136
    buffer_load_dwordx4 v[84:87], v7, s[8:11], s19 offen
    s_add_u32 s19, s17, 352256
    buffer_load_dwordx4 v[88:91], v7, s[8:11], s19 offen
    s_add_u32 s19, s17, 353280
    buffer_load_dwordx4 v[92:95], v7, s[8:11], s19 offen
    s_waitcnt vmcnt(10)
    v_mfma_f32_16x16x32_bf16 v[16:19], v[32:35], v[48:51], v[16:19]
    v_mfma_f32_16x16x32_bf16 v[20:23], v[32:35], v[52:55], v[20:23]
    v_mfma_f32_16x16x32_bf16 v[24:27], v[32:35], v[56:59], v[24:27]
    v_mfma_f32_16x16x32_bf16 v[28:31], v[32:35], v[60:63], v[28:31]
    s_add_u32 s19, s5, 1442816
    buffer_load_dwordx4 v[32:35], v7, s[8:11], s19 offen
    s_add_u32 s19, s17, 92160
    buffer_load_dwordx4 v[48:51], v7, s[8:11], s19 offen
    s_add_u32 s19, s17, 93184
    buffer_load_dwordx4 v[52:55], v7, s[8:11], s19 offen
    s_add_u32 s19, s17, 354304
    buffer_load_dwordx4 v[56:59], v7, s[8:11], s19 offen
    s_add_u32 s19, s17, 355328
    buffer_load_dwordx4 v[60:63], v7, s[8:11], s19 offen
    s_waitcnt vmcnt(10)
    v_mfma_f32_16x16x32_bf16 v[16:19], v[36:39], v[64:67], v[16:19]
    v_mfma_f32_16x16x32_bf16 v[20:23], v[36:39], v[68:71], v[20:23]
    v_mfma_f32_16x16x32_bf16 v[24:27], v[36:39], v[72:75], v[24:27]
    v_mfma_f32_16x16x32_bf16 v[28:31], v[36:39], v[76:79], v[28:31]
    s_add_u32 s19, s5, 1443840
    buffer_load_dwordx4 v[36:39], v7, s[8:11], s19 offen
    s_add_u32 s19, s17, 94208
    buffer_load_dwordx4 v[64:67], v7, s[8:11], s19 offen
    s_add_u32 s19, s17, 95232
    buffer_load_dwordx4 v[68:71], v7, s[8:11], s19 offen
    s_add_u32 s19, s17, 356352
    buffer_load_dwordx4 v[72:75], v7, s[8:11], s19 offen
    s_add_u32 s19, s17, 357376
    buffer_load_dwordx4 v[76:79], v7, s[8:11], s19 offen
    s_waitcnt vmcnt(10)
    v_mfma_f32_16x16x32_bf16 v[16:19], v[40:43], v[80:83], v[16:19]
    v_mfma_f32_16x16x32_bf16 v[20:23], v[40:43], v[84:87], v[20:23]
    v_mfma_f32_16x16x32_bf16 v[24:27], v[40:43], v[88:91], v[24:27]
    v_mfma_f32_16x16x32_bf16 v[28:31], v[40:43], v[92:95], v[28:31]
    s_add_u32 s19, s5, 1444864
    buffer_load_dwordx4 v[40:43], v7, s[8:11], s19 offen
    s_add_u32 s19, s17, 96256
    buffer_load_dwordx4 v[80:83], v7, s[8:11], s19 offen
    s_add_u32 s19, s17, 97280
    buffer_load_dwordx4 v[84:87], v7, s[8:11], s19 offen
    s_add_u32 s19, s17, 358400
    buffer_load_dwordx4 v[88:91], v7, s[8:11], s19 offen
    s_add_u32 s19, s17, 359424
    buffer_load_dwordx4 v[92:95], v7, s[8:11], s19 offen
    s_waitcnt vmcnt(10)
    v_mfma_f32_16x16x32_bf16 v[16:19], v[32:35], v[48:51], v[16:19]
    v_mfma_f32_16x16x32_bf16 v[20:23], v[32:35], v[52:55], v[20:23]
    v_mfma_f32_16x16x32_bf16 v[24:27], v[32:35], v[56:59], v[24:27]
    v_mfma_f32_16x16x32_bf16 v[28:31], v[32:35], v[60:63], v[28:31]
    s_add_u32 s19, s5, 1572864
    buffer_load_dwordx4 v[32:35], v7, s[8:11], s19 offen
    s_add_u32 s19, s17, 98304
    buffer_load_dwordx4 v[48:51], v7, s[8:11], s19 offen
    s_add_u32 s19, s17, 99328
    buffer_load_dwordx4 v[52:55], v7, s[8:11], s19 offen
    s_add_u32 s19, s17, 360448
    buffer_load_dwordx4 v[56:59], v7, s[8:11], s19 offen
    s_add_u32 s19, s17, 361472
    buffer_load_dwordx4 v[60:63], v7, s[8:11], s19 offen
    s_waitcnt vmcnt(10)
    v_mfma_f32_16x16x32_bf16 v[16:19], v[36:39], v[64:67], v[16:19]
    v_mfma_f32_16x16x32_bf16 v[20:23], v[36:39], v[68:71], v[20:23]
    v_mfma_f32_16x16x32_bf16 v[24:27], v[36:39], v[72:75], v[24:27]
    v_mfma_f32_16x16x32_bf16 v[28:31], v[36:39], v[76:79], v[28:31]
    s_add_u32 s19, s5, 1573888
    buffer_load_dwordx4 v[36:39], v7, s[8:11], s19 offen
    s_add_u32 s19, s17, 100352
    buffer_load_dwordx4 v[64:67], v7, s[8:11], s19 offen
    s_add_u32 s19, s17, 101376
    buffer_load_dwordx4 v[68:71], v7, s[8:11], s19 offen
    s_add_u32 s19, s17, 362496
    buffer_load_dwordx4 v[72:75], v7, s[8:11], s19 offen
    s_add_u32 s19, s17, 363520
    buffer_load_dwordx4 v[76:79], v7, s[8:11], s19 offen
    s_waitcnt vmcnt(10)
    v_mfma_f32_16x16x32_bf16 v[16:19], v[40:43], v[80:83], v[16:19]
    v_mfma_f32_16x16x32_bf16 v[20:23], v[40:43], v[84:87], v[20:23]
    v_mfma_f32_16x16x32_bf16 v[24:27], v[40:43], v[88:91], v[24:27]
    v_mfma_f32_16x16x32_bf16 v[28:31], v[40:43], v[92:95], v[28:31]
    s_add_u32 s19, s5, 1574912
    buffer_load_dwordx4 v[40:43], v7, s[8:11], s19 offen
    s_add_u32 s19, s17, 102400
    buffer_load_dwordx4 v[80:83], v7, s[8:11], s19 offen
    s_add_u32 s19, s17, 103424
    buffer_load_dwordx4 v[84:87], v7, s[8:11], s19 offen
    s_add_u32 s19, s17, 364544
    buffer_load_dwordx4 v[88:91], v7, s[8:11], s19 offen
    s_add_u32 s19, s17, 365568
    buffer_load_dwordx4 v[92:95], v7, s[8:11], s19 offen
    s_waitcnt vmcnt(10)
    v_mfma_f32_16x16x32_bf16 v[16:19], v[32:35], v[48:51], v[16:19]
    v_mfma_f32_16x16x32_bf16 v[20:23], v[32:35], v[52:55], v[20:23]
    v_mfma_f32_16x16x32_bf16 v[24:27], v[32:35], v[56:59], v[24:27]
    v_mfma_f32_16x16x32_bf16 v[28:31], v[32:35], v[60:63], v[28:31]
    s_add_u32 s19, s5, 1575936
    buffer_load_dwordx4 v[32:35], v7, s[8:11], s19 offen
    s_add_u32 s19, s17, 104448
    buffer_load_dwordx4 v[48:51], v7, s[8:11], s19 offen
    s_add_u32 s19, s17, 105472
    buffer_load_dwordx4 v[52:55], v7, s[8:11], s19 offen
    s_add_u32 s19, s17, 366592
    buffer_load_dwordx4 v[56:59], v7, s[8:11], s19 offen
    s_add_u32 s19, s17, 367616
    buffer_load_dwordx4 v[60:63], v7, s[8:11], s19 offen
    s_waitcnt vmcnt(10)
    v_mfma_f32_16x16x32_bf16 v[16:19], v[36:39], v[64:67], v[16:19]
    v_mfma_f32_16x16x32_bf16 v[20:23], v[36:39], v[68:71], v[20:23]
    v_mfma_f32_16x16x32_bf16 v[24:27], v[36:39], v[72:75], v[24:27]
    v_mfma_f32_16x16x32_bf16 v[28:31], v[36:39], v[76:79], v[28:31]
    s_add_u32 s19, s5, 1703936
    buffer_load_dwordx4 v[36:39], v7, s[8:11], s19 offen
    s_add_u32 s19, s17, 106496
    buffer_load_dwordx4 v[64:67], v7, s[8:11], s19 offen
    s_add_u32 s19, s17, 107520
    buffer_load_dwordx4 v[68:71], v7, s[8:11], s19 offen
    s_add_u32 s19, s17, 368640
    buffer_load_dwordx4 v[72:75], v7, s[8:11], s19 offen
    s_add_u32 s19, s17, 369664
    buffer_load_dwordx4 v[76:79], v7, s[8:11], s19 offen
    s_waitcnt vmcnt(10)
    v_mfma_f32_16x16x32_bf16 v[16:19], v[40:43], v[80:83], v[16:19]
    v_mfma_f32_16x16x32_bf16 v[20:23], v[40:43], v[84:87], v[20:23]
    v_mfma_f32_16x16x32_bf16 v[24:27], v[40:43], v[88:91], v[24:27]
    v_mfma_f32_16x16x32_bf16 v[28:31], v[40:43], v[92:95], v[28:31]
    s_add_u32 s19, s5, 1704960
    buffer_load_dwordx4 v[40:43], v7, s[8:11], s19 offen
    s_add_u32 s19, s17, 108544
    buffer_load_dwordx4 v[80:83], v7, s[8:11], s19 offen
    s_add_u32 s19, s17, 109568
    buffer_load_dwordx4 v[84:87], v7, s[8:11], s19 offen
    s_add_u32 s19, s17, 370688
    buffer_load_dwordx4 v[88:91], v7, s[8:11], s19 offen
    s_add_u32 s19, s17, 371712
    buffer_load_dwordx4 v[92:95], v7, s[8:11], s19 offen
    s_waitcnt vmcnt(10)
    v_mfma_f32_16x16x32_bf16 v[16:19], v[32:35], v[48:51], v[16:19]
    v_mfma_f32_16x16x32_bf16 v[20:23], v[32:35], v[52:55], v[20:23]
    v_mfma_f32_16x16x32_bf16 v[24:27], v[32:35], v[56:59], v[24:27]
    v_mfma_f32_16x16x32_bf16 v[28:31], v[32:35], v[60:63], v[28:31]
    s_add_u32 s19, s5, 1705984
    buffer_load_dwordx4 v[32:35], v7, s[8:11], s19 offen
    s_add_u32 s19, s17, 110592
    buffer_load_dwordx4 v[48:51], v7, s[8:11], s19 offen
    s_add_u32 s19, s17, 111616
    buffer_load_dwordx4 v[52:55], v7, s[8:11], s19 offen
    s_add_u32 s19, s17, 372736
    buffer_load_dwordx4 v[56:59], v7, s[8:11], s19 offen
    s_add_u32 s19, s17, 373760
    buffer_load_dwordx4 v[60:63], v7, s[8:11], s19 offen
    s_waitcnt vmcnt(10)
    v_mfma_f32_16x16x32_bf16 v[16:19], v[36:39], v[64:67], v[16:19]
    v_mfma_f32_16x16x32_bf16 v[20:23], v[36:39], v[68:71], v[20:23]
    v_mfma_f32_16x16x32_bf16 v[24:27], v[36:39], v[72:75], v[24:27]
    v_mfma_f32_16x16x32_bf16 v[28:31], v[36:39], v[76:79], v[28:31]
    s_add_u32 s19, s5, 1707008
    buffer_load_dwordx4 v[36:39], v7, s[8:11], s19 offen
    s_add_u32 s19, s17, 112640
    buffer_load_dwordx4 v[64:67], v7, s[8:11], s19 offen
    s_add_u32 s19, s17, 113664
    buffer_load_dwordx4 v[68:71], v7, s[8:11], s19 offen
    s_add_u32 s19, s17, 374784
    buffer_load_dwordx4 v[72:75], v7, s[8:11], s19 offen
    s_add_u32 s19, s17, 375808
    buffer_load_dwordx4 v[76:79], v7, s[8:11], s19 offen
    s_waitcnt vmcnt(10)
    v_mfma_f32_16x16x32_bf16 v[16:19], v[40:43], v[80:83], v[16:19]
    v_mfma_f32_16x16x32_bf16 v[20:23], v[40:43], v[84:87], v[20:23]
    v_mfma_f32_16x16x32_bf16 v[24:27], v[40:43], v[88:91], v[24:27]
    v_mfma_f32_16x16x32_bf16 v[28:31], v[40:43], v[92:95], v[28:31]
    s_add_u32 s19, s5, 1835008
    buffer_load_dwordx4 v[40:43], v7, s[8:11], s19 offen
    s_add_u32 s19, s17, 114688
    buffer_load_dwordx4 v[80:83], v7, s[8:11], s19 offen
    s_add_u32 s19, s17, 115712
    buffer_load_dwordx4 v[84:87], v7, s[8:11], s19 offen
    s_add_u32 s19, s17, 376832
    buffer_load_dwordx4 v[88:91], v7, s[8:11], s19 offen
    s_add_u32 s19, s17, 377856
    buffer_load_dwordx4 v[92:95], v7, s[8:11], s19 offen
    s_waitcnt vmcnt(10)
    v_mfma_f32_16x16x32_bf16 v[16:19], v[32:35], v[48:51], v[16:19]
    v_mfma_f32_16x16x32_bf16 v[20:23], v[32:35], v[52:55], v[20:23]
    v_mfma_f32_16x16x32_bf16 v[24:27], v[32:35], v[56:59], v[24:27]
    v_mfma_f32_16x16x32_bf16 v[28:31], v[32:35], v[60:63], v[28:31]
    s_add_u32 s19, s5, 1836032
    buffer_load_dwordx4 v[32:35], v7, s[8:11], s19 offen
    s_add_u32 s19, s17, 116736
    buffer_load_dwordx4 v[48:51], v7, s[8:11], s19 offen
    s_add_u32 s19, s17, 117760
    buffer_load_dwordx4 v[52:55], v7, s[8:11], s19 offen
    s_add_u32 s19, s17, 378880
    buffer_load_dwordx4 v[56:59], v7, s[8:11], s19 offen
    s_add_u32 s19, s17, 379904
    buffer_load_dwordx4 v[60:63], v7, s[8:11], s19 offen
    s_waitcnt vmcnt(10)
    v_mfma_f32_16x16x32_bf16 v[16:19], v[36:39], v[64:67], v[16:19]
    v_mfma_f32_16x16x32_bf16 v[20:23], v[36:39], v[68:71], v[20:23]
    v_mfma_f32_16x16x32_bf16 v[24:27], v[36:39], v[72:75], v[24:27]
    v_mfma_f32_16x16x32_bf16 v[28:31], v[36:39], v[76:79], v[28:31]
    s_add_u32 s19, s5, 1837056
    buffer_load_dwordx4 v[36:39], v7, s[8:11], s19 offen
    s_add_u32 s19, s17, 118784
    buffer_load_dwordx4 v[64:67], v7, s[8:11], s19 offen
    s_add_u32 s19, s17, 119808
    buffer_load_dwordx4 v[68:71], v7, s[8:11], s19 offen
    s_add_u32 s19, s17, 380928
    buffer_load_dwordx4 v[72:75], v7, s[8:11], s19 offen
    s_add_u32 s19, s17, 381952
    buffer_load_dwordx4 v[76:79], v7, s[8:11], s19 offen
    s_waitcnt vmcnt(10)
    v_mfma_f32_16x16x32_bf16 v[16:19], v[40:43], v[80:83], v[16:19]
    v_mfma_f32_16x16x32_bf16 v[20:23], v[40:43], v[84:87], v[20:23]
    v_mfma_f32_16x16x32_bf16 v[24:27], v[40:43], v[88:91], v[24:27]
    v_mfma_f32_16x16x32_bf16 v[28:31], v[40:43], v[92:95], v[28:31]
    s_add_u32 s19, s5, 1838080
    buffer_load_dwordx4 v[40:43], v7, s[8:11], s19 offen
    s_add_u32 s19, s17, 120832
    buffer_load_dwordx4 v[80:83], v7, s[8:11], s19 offen
    s_add_u32 s19, s17, 121856
    buffer_load_dwordx4 v[84:87], v7, s[8:11], s19 offen
    s_add_u32 s19, s17, 382976
    buffer_load_dwordx4 v[88:91], v7, s[8:11], s19 offen
    s_add_u32 s19, s17, 384000
    buffer_load_dwordx4 v[92:95], v7, s[8:11], s19 offen
    s_waitcnt vmcnt(10)
    v_mfma_f32_16x16x32_bf16 v[16:19], v[32:35], v[48:51], v[16:19]
    v_mfma_f32_16x16x32_bf16 v[20:23], v[32:35], v[52:55], v[20:23]
    v_mfma_f32_16x16x32_bf16 v[24:27], v[32:35], v[56:59], v[24:27]
    v_mfma_f32_16x16x32_bf16 v[28:31], v[32:35], v[60:63], v[28:31]
    s_add_u32 s19, s5, 1966080
    buffer_load_dwordx4 v[32:35], v7, s[8:11], s19 offen
    s_add_u32 s19, s17, 122880
    buffer_load_dwordx4 v[48:51], v7, s[8:11], s19 offen
    s_add_u32 s19, s17, 123904
    buffer_load_dwordx4 v[52:55], v7, s[8:11], s19 offen
    s_add_u32 s19, s17, 385024
    buffer_load_dwordx4 v[56:59], v7, s[8:11], s19 offen
    s_add_u32 s19, s17, 386048
    buffer_load_dwordx4 v[60:63], v7, s[8:11], s19 offen
    s_waitcnt vmcnt(10)
    v_mfma_f32_16x16x32_bf16 v[16:19], v[36:39], v[64:67], v[16:19]
    v_mfma_f32_16x16x32_bf16 v[20:23], v[36:39], v[68:71], v[20:23]
    v_mfma_f32_16x16x32_bf16 v[24:27], v[36:39], v[72:75], v[24:27]
    v_mfma_f32_16x16x32_bf16 v[28:31], v[36:39], v[76:79], v[28:31]
    s_add_u32 s19, s5, 1967104
    buffer_load_dwordx4 v[36:39], v7, s[8:11], s19 offen
    s_add_u32 s19, s17, 124928
    buffer_load_dwordx4 v[64:67], v7, s[8:11], s19 offen
    s_add_u32 s19, s17, 125952
    buffer_load_dwordx4 v[68:71], v7, s[8:11], s19 offen
    s_add_u32 s19, s17, 387072
    buffer_load_dwordx4 v[72:75], v7, s[8:11], s19 offen
    s_add_u32 s19, s17, 388096
    buffer_load_dwordx4 v[76:79], v7, s[8:11], s19 offen
    s_waitcnt vmcnt(10)
    v_mfma_f32_16x16x32_bf16 v[16:19], v[40:43], v[80:83], v[16:19]
    v_mfma_f32_16x16x32_bf16 v[20:23], v[40:43], v[84:87], v[20:23]
    v_mfma_f32_16x16x32_bf16 v[24:27], v[40:43], v[88:91], v[24:27]
    v_mfma_f32_16x16x32_bf16 v[28:31], v[40:43], v[92:95], v[28:31]
    s_add_u32 s19, s5, 1968128
    buffer_load_dwordx4 v[40:43], v7, s[8:11], s19 offen
    s_add_u32 s19, s17, 126976
    buffer_load_dwordx4 v[80:83], v7, s[8:11], s19 offen
    s_add_u32 s19, s17, 128000
    buffer_load_dwordx4 v[84:87], v7, s[8:11], s19 offen
    s_add_u32 s19, s17, 389120
    buffer_load_dwordx4 v[88:91], v7, s[8:11], s19 offen
    s_add_u32 s19, s17, 390144
    buffer_load_dwordx4 v[92:95], v7, s[8:11], s19 offen
    s_waitcnt vmcnt(10)
    v_mfma_f32_16x16x32_bf16 v[16:19], v[32:35], v[48:51], v[16:19]
    v_mfma_f32_16x16x32_bf16 v[20:23], v[32:35], v[52:55], v[20:23]
    v_mfma_f32_16x16x32_bf16 v[24:27], v[32:35], v[56:59], v[24:27]
    v_mfma_f32_16x16x32_bf16 v[28:31], v[32:35], v[60:63], v[28:31]
    s_add_u32 s19, s5, 1969152
    buffer_load_dwordx4 v[32:35], v7, s[8:11], s19 offen
    s_add_u32 s19, s17, 129024
    buffer_load_dwordx4 v[48:51], v7, s[8:11], s19 offen
    s_add_u32 s19, s17, 130048
    buffer_load_dwordx4 v[52:55], v7, s[8:11], s19 offen
    s_add_u32 s19, s17, 391168
    buffer_load_dwordx4 v[56:59], v7, s[8:11], s19 offen
    s_add_u32 s19, s17, 392192
    buffer_load_dwordx4 v[60:63], v7, s[8:11], s19 offen
    s_waitcnt vmcnt(10)
    v_mfma_f32_16x16x32_bf16 v[16:19], v[36:39], v[64:67], v[16:19]
    v_mfma_f32_16x16x32_bf16 v[20:23], v[36:39], v[68:71], v[20:23]
    v_mfma_f32_16x16x32_bf16 v[24:27], v[36:39], v[72:75], v[24:27]
    v_mfma_f32_16x16x32_bf16 v[28:31], v[36:39], v[76:79], v[28:31]
    s_add_u32 s19, s5, 2097152
    buffer_load_dwordx4 v[36:39], v7, s[8:11], s19 offen
    s_add_u32 s19, s17, 131072
    buffer_load_dwordx4 v[64:67], v7, s[8:11], s19 offen
    s_add_u32 s19, s17, 132096
    buffer_load_dwordx4 v[68:71], v7, s[8:11], s19 offen
    s_add_u32 s19, s17, 393216
    buffer_load_dwordx4 v[72:75], v7, s[8:11], s19 offen
    s_add_u32 s19, s17, 394240
    buffer_load_dwordx4 v[76:79], v7, s[8:11], s19 offen
    s_waitcnt vmcnt(10)
    v_mfma_f32_16x16x32_bf16 v[16:19], v[40:43], v[80:83], v[16:19]
    v_mfma_f32_16x16x32_bf16 v[20:23], v[40:43], v[84:87], v[20:23]
    v_mfma_f32_16x16x32_bf16 v[24:27], v[40:43], v[88:91], v[24:27]
    v_mfma_f32_16x16x32_bf16 v[28:31], v[40:43], v[92:95], v[28:31]
    s_add_u32 s19, s5, 2098176
    buffer_load_dwordx4 v[40:43], v7, s[8:11], s19 offen
    s_add_u32 s19, s17, 133120
    buffer_load_dwordx4 v[80:83], v7, s[8:11], s19 offen
    s_add_u32 s19, s17, 134144
    buffer_load_dwordx4 v[84:87], v7, s[8:11], s19 offen
    s_add_u32 s19, s17, 395264
    buffer_load_dwordx4 v[88:91], v7, s[8:11], s19 offen
    s_add_u32 s19, s17, 396288
    buffer_load_dwordx4 v[92:95], v7, s[8:11], s19 offen
    s_waitcnt vmcnt(10)
    v_mfma_f32_16x16x32_bf16 v[16:19], v[32:35], v[48:51], v[16:19]
    v_mfma_f32_16x16x32_bf16 v[20:23], v[32:35], v[52:55], v[20:23]
    v_mfma_f32_16x16x32_bf16 v[24:27], v[32:35], v[56:59], v[24:27]
    v_mfma_f32_16x16x32_bf16 v[28:31], v[32:35], v[60:63], v[28:31]
    s_add_u32 s19, s5, 2099200
    buffer_load_dwordx4 v[32:35], v7, s[8:11], s19 offen
    s_add_u32 s19, s17, 135168
    buffer_load_dwordx4 v[48:51], v7, s[8:11], s19 offen
    s_add_u32 s19, s17, 136192
    buffer_load_dwordx4 v[52:55], v7, s[8:11], s19 offen
    s_add_u32 s19, s17, 397312
    buffer_load_dwordx4 v[56:59], v7, s[8:11], s19 offen
    s_add_u32 s19, s17, 398336
    buffer_load_dwordx4 v[60:63], v7, s[8:11], s19 offen
    s_waitcnt vmcnt(10)
    v_mfma_f32_16x16x32_bf16 v[16:19], v[36:39], v[64:67], v[16:19]
    v_mfma_f32_16x16x32_bf16 v[20:23], v[36:39], v[68:71], v[20:23]
    v_mfma_f32_16x16x32_bf16 v[24:27], v[36:39], v[72:75], v[24:27]
    v_mfma_f32_16x16x32_bf16 v[28:31], v[36:39], v[76:79], v[28:31]
    s_add_u32 s19, s5, 2100224
    buffer_load_dwordx4 v[36:39], v7, s[8:11], s19 offen
    s_add_u32 s19, s17, 137216
    buffer_load_dwordx4 v[64:67], v7, s[8:11], s19 offen
    s_add_u32 s19, s17, 138240
    buffer_load_dwordx4 v[68:71], v7, s[8:11], s19 offen
    s_add_u32 s19, s17, 399360
    buffer_load_dwordx4 v[72:75], v7, s[8:11], s19 offen
    s_add_u32 s19, s17, 400384
    buffer_load_dwordx4 v[76:79], v7, s[8:11], s19 offen
    s_waitcnt vmcnt(10)
    v_mfma_f32_16x16x32_bf16 v[16:19], v[40:43], v[80:83], v[16:19]
    v_mfma_f32_16x16x32_bf16 v[20:23], v[40:43], v[84:87], v[20:23]
    v_mfma_f32_16x16x32_bf16 v[24:27], v[40:43], v[88:91], v[24:27]
    v_mfma_f32_16x16x32_bf16 v[28:31], v[40:43], v[92:95], v[28:31]
    s_add_u32 s19, s5, 2228224
    buffer_load_dwordx4 v[40:43], v7, s[8:11], s19 offen
    s_add_u32 s19, s17, 139264
    buffer_load_dwordx4 v[80:83], v7, s[8:11], s19 offen
    s_add_u32 s19, s17, 140288
    buffer_load_dwordx4 v[84:87], v7, s[8:11], s19 offen
    s_add_u32 s19, s17, 401408
    buffer_load_dwordx4 v[88:91], v7, s[8:11], s19 offen
    s_add_u32 s19, s17, 402432
    buffer_load_dwordx4 v[92:95], v7, s[8:11], s19 offen
    s_waitcnt vmcnt(10)
    v_mfma_f32_16x16x32_bf16 v[16:19], v[32:35], v[48:51], v[16:19]
    v_mfma_f32_16x16x32_bf16 v[20:23], v[32:35], v[52:55], v[20:23]
    v_mfma_f32_16x16x32_bf16 v[24:27], v[32:35], v[56:59], v[24:27]
    v_mfma_f32_16x16x32_bf16 v[28:31], v[32:35], v[60:63], v[28:31]
    s_add_u32 s19, s5, 2229248
    buffer_load_dwordx4 v[32:35], v7, s[8:11], s19 offen
    s_add_u32 s19, s17, 141312
    buffer_load_dwordx4 v[48:51], v7, s[8:11], s19 offen
    s_add_u32 s19, s17, 142336
    buffer_load_dwordx4 v[52:55], v7, s[8:11], s19 offen
    s_add_u32 s19, s17, 403456
    buffer_load_dwordx4 v[56:59], v7, s[8:11], s19 offen
    s_add_u32 s19, s17, 404480
    buffer_load_dwordx4 v[60:63], v7, s[8:11], s19 offen
    s_waitcnt vmcnt(10)
    v_mfma_f32_16x16x32_bf16 v[16:19], v[36:39], v[64:67], v[16:19]
    v_mfma_f32_16x16x32_bf16 v[20:23], v[36:39], v[68:71], v[20:23]
    v_mfma_f32_16x16x32_bf16 v[24:27], v[36:39], v[72:75], v[24:27]
    v_mfma_f32_16x16x32_bf16 v[28:31], v[36:39], v[76:79], v[28:31]
    s_add_u32 s19, s5, 2230272
    buffer_load_dwordx4 v[36:39], v7, s[8:11], s19 offen
    s_add_u32 s19, s17, 143360
    buffer_load_dwordx4 v[64:67], v7, s[8:11], s19 offen
    s_add_u32 s19, s17, 144384
    buffer_load_dwordx4 v[68:71], v7, s[8:11], s19 offen
    s_add_u32 s19, s17, 405504
    buffer_load_dwordx4 v[72:75], v7, s[8:11], s19 offen
    s_add_u32 s19, s17, 406528
    buffer_load_dwordx4 v[76:79], v7, s[8:11], s19 offen
    s_waitcnt vmcnt(10)
    v_mfma_f32_16x16x32_bf16 v[16:19], v[40:43], v[80:83], v[16:19]
    v_mfma_f32_16x16x32_bf16 v[20:23], v[40:43], v[84:87], v[20:23]
    v_mfma_f32_16x16x32_bf16 v[24:27], v[40:43], v[88:91], v[24:27]
    v_mfma_f32_16x16x32_bf16 v[28:31], v[40:43], v[92:95], v[28:31]
    s_add_u32 s19, s5, 2231296
    buffer_load_dwordx4 v[40:43], v7, s[8:11], s19 offen
    s_add_u32 s19, s17, 145408
    buffer_load_dwordx4 v[80:83], v7, s[8:11], s19 offen
    s_add_u32 s19, s17, 146432
    buffer_load_dwordx4 v[84:87], v7, s[8:11], s19 offen
    s_add_u32 s19, s17, 407552
    buffer_load_dwordx4 v[88:91], v7, s[8:11], s19 offen
    s_add_u32 s19, s17, 408576
    buffer_load_dwordx4 v[92:95], v7, s[8:11], s19 offen
    s_waitcnt vmcnt(10)
    v_mfma_f32_16x16x32_bf16 v[16:19], v[32:35], v[48:51], v[16:19]
    v_mfma_f32_16x16x32_bf16 v[20:23], v[32:35], v[52:55], v[20:23]
    v_mfma_f32_16x16x32_bf16 v[24:27], v[32:35], v[56:59], v[24:27]
    v_mfma_f32_16x16x32_bf16 v[28:31], v[32:35], v[60:63], v[28:31]
    s_add_u32 s19, s5, 2359296
    buffer_load_dwordx4 v[32:35], v7, s[8:11], s19 offen
    s_add_u32 s19, s17, 147456
    buffer_load_dwordx4 v[48:51], v7, s[8:11], s19 offen
    s_add_u32 s19, s17, 148480
    buffer_load_dwordx4 v[52:55], v7, s[8:11], s19 offen
    s_add_u32 s19, s17, 409600
    buffer_load_dwordx4 v[56:59], v7, s[8:11], s19 offen
    s_add_u32 s19, s17, 410624
    buffer_load_dwordx4 v[60:63], v7, s[8:11], s19 offen
    s_waitcnt vmcnt(10)
    v_mfma_f32_16x16x32_bf16 v[16:19], v[36:39], v[64:67], v[16:19]
    v_mfma_f32_16x16x32_bf16 v[20:23], v[36:39], v[68:71], v[20:23]
    v_mfma_f32_16x16x32_bf16 v[24:27], v[36:39], v[72:75], v[24:27]
    v_mfma_f32_16x16x32_bf16 v[28:31], v[36:39], v[76:79], v[28:31]
    s_add_u32 s19, s5, 2360320
    buffer_load_dwordx4 v[36:39], v7, s[8:11], s19 offen
    s_add_u32 s19, s17, 149504
    buffer_load_dwordx4 v[64:67], v7, s[8:11], s19 offen
    s_add_u32 s19, s17, 150528
    buffer_load_dwordx4 v[68:71], v7, s[8:11], s19 offen
    s_add_u32 s19, s17, 411648
    buffer_load_dwordx4 v[72:75], v7, s[8:11], s19 offen
    s_add_u32 s19, s17, 412672
    buffer_load_dwordx4 v[76:79], v7, s[8:11], s19 offen
    s_waitcnt vmcnt(10)
    v_mfma_f32_16x16x32_bf16 v[16:19], v[40:43], v[80:83], v[16:19]
    v_mfma_f32_16x16x32_bf16 v[20:23], v[40:43], v[84:87], v[20:23]
    v_mfma_f32_16x16x32_bf16 v[24:27], v[40:43], v[88:91], v[24:27]
    v_mfma_f32_16x16x32_bf16 v[28:31], v[40:43], v[92:95], v[28:31]
    s_add_u32 s19, s5, 2361344
    buffer_load_dwordx4 v[40:43], v7, s[8:11], s19 offen
    s_add_u32 s19, s17, 151552
    buffer_load_dwordx4 v[80:83], v7, s[8:11], s19 offen
    s_add_u32 s19, s17, 152576
    buffer_load_dwordx4 v[84:87], v7, s[8:11], s19 offen
    s_add_u32 s19, s17, 413696
    buffer_load_dwordx4 v[88:91], v7, s[8:11], s19 offen
    s_add_u32 s19, s17, 414720
    buffer_load_dwordx4 v[92:95], v7, s[8:11], s19 offen
    s_waitcnt vmcnt(10)
    v_mfma_f32_16x16x32_bf16 v[16:19], v[32:35], v[48:51], v[16:19]
    v_mfma_f32_16x16x32_bf16 v[20:23], v[32:35], v[52:55], v[20:23]
    v_mfma_f32_16x16x32_bf16 v[24:27], v[32:35], v[56:59], v[24:27]
    v_mfma_f32_16x16x32_bf16 v[28:31], v[32:35], v[60:63], v[28:31]
    s_add_u32 s19, s5, 2362368
    buffer_load_dwordx4 v[32:35], v7, s[8:11], s19 offen
    s_add_u32 s19, s17, 153600
    buffer_load_dwordx4 v[48:51], v7, s[8:11], s19 offen
    s_add_u32 s19, s17, 154624
    buffer_load_dwordx4 v[52:55], v7, s[8:11], s19 offen
    s_add_u32 s19, s17, 415744
    buffer_load_dwordx4 v[56:59], v7, s[8:11], s19 offen
    s_add_u32 s19, s17, 416768
    buffer_load_dwordx4 v[60:63], v7, s[8:11], s19 offen
    s_waitcnt vmcnt(10)
    v_mfma_f32_16x16x32_bf16 v[16:19], v[36:39], v[64:67], v[16:19]
    v_mfma_f32_16x16x32_bf16 v[20:23], v[36:39], v[68:71], v[20:23]
    v_mfma_f32_16x16x32_bf16 v[24:27], v[36:39], v[72:75], v[24:27]
    v_mfma_f32_16x16x32_bf16 v[28:31], v[36:39], v[76:79], v[28:31]
    s_add_u32 s19, s5, 2490368
    buffer_load_dwordx4 v[36:39], v7, s[8:11], s19 offen
    s_add_u32 s19, s17, 155648
    buffer_load_dwordx4 v[64:67], v7, s[8:11], s19 offen
    s_add_u32 s19, s17, 156672
    buffer_load_dwordx4 v[68:71], v7, s[8:11], s19 offen
    s_add_u32 s19, s17, 417792
    buffer_load_dwordx4 v[72:75], v7, s[8:11], s19 offen
    s_add_u32 s19, s17, 418816
    buffer_load_dwordx4 v[76:79], v7, s[8:11], s19 offen
    s_waitcnt vmcnt(10)
    v_mfma_f32_16x16x32_bf16 v[16:19], v[40:43], v[80:83], v[16:19]
    v_mfma_f32_16x16x32_bf16 v[20:23], v[40:43], v[84:87], v[20:23]
    v_mfma_f32_16x16x32_bf16 v[24:27], v[40:43], v[88:91], v[24:27]
    v_mfma_f32_16x16x32_bf16 v[28:31], v[40:43], v[92:95], v[28:31]
    s_add_u32 s19, s5, 2491392
    buffer_load_dwordx4 v[40:43], v7, s[8:11], s19 offen
    s_add_u32 s19, s17, 157696
    buffer_load_dwordx4 v[80:83], v7, s[8:11], s19 offen
    s_add_u32 s19, s17, 158720
    buffer_load_dwordx4 v[84:87], v7, s[8:11], s19 offen
    s_add_u32 s19, s17, 419840
    buffer_load_dwordx4 v[88:91], v7, s[8:11], s19 offen
    s_add_u32 s19, s17, 420864
    buffer_load_dwordx4 v[92:95], v7, s[8:11], s19 offen
    s_waitcnt vmcnt(10)
    v_mfma_f32_16x16x32_bf16 v[16:19], v[32:35], v[48:51], v[16:19]
    v_mfma_f32_16x16x32_bf16 v[20:23], v[32:35], v[52:55], v[20:23]
    v_mfma_f32_16x16x32_bf16 v[24:27], v[32:35], v[56:59], v[24:27]
    v_mfma_f32_16x16x32_bf16 v[28:31], v[32:35], v[60:63], v[28:31]
    s_add_u32 s19, s5, 2492416
    buffer_load_dwordx4 v[32:35], v7, s[8:11], s19 offen
    s_add_u32 s19, s17, 159744
    buffer_load_dwordx4 v[48:51], v7, s[8:11], s19 offen
    s_add_u32 s19, s17, 160768
    buffer_load_dwordx4 v[52:55], v7, s[8:11], s19 offen
    s_add_u32 s19, s17, 421888
    buffer_load_dwordx4 v[56:59], v7, s[8:11], s19 offen
    s_add_u32 s19, s17, 422912
    buffer_load_dwordx4 v[60:63], v7, s[8:11], s19 offen
    s_waitcnt vmcnt(10)
    v_mfma_f32_16x16x32_bf16 v[16:19], v[36:39], v[64:67], v[16:19]
    v_mfma_f32_16x16x32_bf16 v[20:23], v[36:39], v[68:71], v[20:23]
    v_mfma_f32_16x16x32_bf16 v[24:27], v[36:39], v[72:75], v[24:27]
    v_mfma_f32_16x16x32_bf16 v[28:31], v[36:39], v[76:79], v[28:31]
    s_add_u32 s19, s5, 2493440
    buffer_load_dwordx4 v[36:39], v7, s[8:11], s19 offen
    s_add_u32 s19, s17, 161792
    buffer_load_dwordx4 v[64:67], v7, s[8:11], s19 offen
    s_add_u32 s19, s17, 162816
    buffer_load_dwordx4 v[68:71], v7, s[8:11], s19 offen
    s_add_u32 s19, s17, 423936
    buffer_load_dwordx4 v[72:75], v7, s[8:11], s19 offen
    s_add_u32 s19, s17, 424960
    buffer_load_dwordx4 v[76:79], v7, s[8:11], s19 offen
    s_waitcnt vmcnt(10)
    v_mfma_f32_16x16x32_bf16 v[16:19], v[40:43], v[80:83], v[16:19]
    v_mfma_f32_16x16x32_bf16 v[20:23], v[40:43], v[84:87], v[20:23]
    v_mfma_f32_16x16x32_bf16 v[24:27], v[40:43], v[88:91], v[24:27]
    v_mfma_f32_16x16x32_bf16 v[28:31], v[40:43], v[92:95], v[28:31]
    s_add_u32 s19, s5, 2621440
    buffer_load_dwordx4 v[40:43], v7, s[8:11], s19 offen
    s_add_u32 s19, s17, 163840
    buffer_load_dwordx4 v[80:83], v7, s[8:11], s19 offen
    s_add_u32 s19, s17, 164864
    buffer_load_dwordx4 v[84:87], v7, s[8:11], s19 offen
    s_add_u32 s19, s17, 425984
    buffer_load_dwordx4 v[88:91], v7, s[8:11], s19 offen
    s_add_u32 s19, s17, 427008
    buffer_load_dwordx4 v[92:95], v7, s[8:11], s19 offen
    s_waitcnt vmcnt(10)
    v_mfma_f32_16x16x32_bf16 v[16:19], v[32:35], v[48:51], v[16:19]
    v_mfma_f32_16x16x32_bf16 v[20:23], v[32:35], v[52:55], v[20:23]
    v_mfma_f32_16x16x32_bf16 v[24:27], v[32:35], v[56:59], v[24:27]
    v_mfma_f32_16x16x32_bf16 v[28:31], v[32:35], v[60:63], v[28:31]
    s_add_u32 s19, s5, 2622464
    buffer_load_dwordx4 v[32:35], v7, s[8:11], s19 offen
    s_add_u32 s19, s17, 165888
    buffer_load_dwordx4 v[48:51], v7, s[8:11], s19 offen
    s_add_u32 s19, s17, 166912
    buffer_load_dwordx4 v[52:55], v7, s[8:11], s19 offen
    s_add_u32 s19, s17, 428032
    buffer_load_dwordx4 v[56:59], v7, s[8:11], s19 offen
    s_add_u32 s19, s17, 429056
    buffer_load_dwordx4 v[60:63], v7, s[8:11], s19 offen
    s_waitcnt vmcnt(10)
    v_mfma_f32_16x16x32_bf16 v[16:19], v[36:39], v[64:67], v[16:19]
    v_mfma_f32_16x16x32_bf16 v[20:23], v[36:39], v[68:71], v[20:23]
    v_mfma_f32_16x16x32_bf16 v[24:27], v[36:39], v[72:75], v[24:27]
    v_mfma_f32_16x16x32_bf16 v[28:31], v[36:39], v[76:79], v[28:31]
    s_add_u32 s19, s5, 2623488
    buffer_load_dwordx4 v[36:39], v7, s[8:11], s19 offen
    s_add_u32 s19, s17, 167936
    buffer_load_dwordx4 v[64:67], v7, s[8:11], s19 offen
    s_add_u32 s19, s17, 168960
    buffer_load_dwordx4 v[68:71], v7, s[8:11], s19 offen
    s_add_u32 s19, s17, 430080
    buffer_load_dwordx4 v[72:75], v7, s[8:11], s19 offen
    s_add_u32 s19, s17, 431104
    buffer_load_dwordx4 v[76:79], v7, s[8:11], s19 offen
    s_waitcnt vmcnt(10)
    v_mfma_f32_16x16x32_bf16 v[16:19], v[40:43], v[80:83], v[16:19]
    v_mfma_f32_16x16x32_bf16 v[20:23], v[40:43], v[84:87], v[20:23]
    v_mfma_f32_16x16x32_bf16 v[24:27], v[40:43], v[88:91], v[24:27]
    v_mfma_f32_16x16x32_bf16 v[28:31], v[40:43], v[92:95], v[28:31]
    s_add_u32 s19, s5, 2624512
    buffer_load_dwordx4 v[40:43], v7, s[8:11], s19 offen
    s_add_u32 s19, s17, 169984
    buffer_load_dwordx4 v[80:83], v7, s[8:11], s19 offen
    s_add_u32 s19, s17, 171008
    buffer_load_dwordx4 v[84:87], v7, s[8:11], s19 offen
    s_add_u32 s19, s17, 432128
    buffer_load_dwordx4 v[88:91], v7, s[8:11], s19 offen
    s_add_u32 s19, s17, 433152
    buffer_load_dwordx4 v[92:95], v7, s[8:11], s19 offen
    s_waitcnt vmcnt(10)
    v_mfma_f32_16x16x32_bf16 v[16:19], v[32:35], v[48:51], v[16:19]
    v_mfma_f32_16x16x32_bf16 v[20:23], v[32:35], v[52:55], v[20:23]
    v_mfma_f32_16x16x32_bf16 v[24:27], v[32:35], v[56:59], v[24:27]
    v_mfma_f32_16x16x32_bf16 v[28:31], v[32:35], v[60:63], v[28:31]
    s_add_u32 s19, s5, 2752512
    buffer_load_dwordx4 v[32:35], v7, s[8:11], s19 offen
    s_add_u32 s19, s17, 172032
    buffer_load_dwordx4 v[48:51], v7, s[8:11], s19 offen
    s_add_u32 s19, s17, 173056
    buffer_load_dwordx4 v[52:55], v7, s[8:11], s19 offen
    s_add_u32 s19, s17, 434176
    buffer_load_dwordx4 v[56:59], v7, s[8:11], s19 offen
    s_add_u32 s19, s17, 435200
    buffer_load_dwordx4 v[60:63], v7, s[8:11], s19 offen
    s_waitcnt vmcnt(10)
    v_mfma_f32_16x16x32_bf16 v[16:19], v[36:39], v[64:67], v[16:19]
    v_mfma_f32_16x16x32_bf16 v[20:23], v[36:39], v[68:71], v[20:23]
    v_mfma_f32_16x16x32_bf16 v[24:27], v[36:39], v[72:75], v[24:27]
    v_mfma_f32_16x16x32_bf16 v[28:31], v[36:39], v[76:79], v[28:31]
    s_add_u32 s19, s5, 2753536
    buffer_load_dwordx4 v[36:39], v7, s[8:11], s19 offen
    s_add_u32 s19, s17, 174080
    buffer_load_dwordx4 v[64:67], v7, s[8:11], s19 offen
    s_add_u32 s19, s17, 175104
    buffer_load_dwordx4 v[68:71], v7, s[8:11], s19 offen
    s_add_u32 s19, s17, 436224
    buffer_load_dwordx4 v[72:75], v7, s[8:11], s19 offen
    s_add_u32 s19, s17, 437248
    buffer_load_dwordx4 v[76:79], v7, s[8:11], s19 offen
    s_waitcnt vmcnt(10)
    v_mfma_f32_16x16x32_bf16 v[16:19], v[40:43], v[80:83], v[16:19]
    v_mfma_f32_16x16x32_bf16 v[20:23], v[40:43], v[84:87], v[20:23]
    v_mfma_f32_16x16x32_bf16 v[24:27], v[40:43], v[88:91], v[24:27]
    v_mfma_f32_16x16x32_bf16 v[28:31], v[40:43], v[92:95], v[28:31]
    s_add_u32 s19, s5, 2754560
    buffer_load_dwordx4 v[40:43], v7, s[8:11], s19 offen
    s_add_u32 s19, s17, 176128
    buffer_load_dwordx4 v[80:83], v7, s[8:11], s19 offen
    s_add_u32 s19, s17, 177152
    buffer_load_dwordx4 v[84:87], v7, s[8:11], s19 offen
    s_add_u32 s19, s17, 438272
    buffer_load_dwordx4 v[88:91], v7, s[8:11], s19 offen
    s_add_u32 s19, s17, 439296
    buffer_load_dwordx4 v[92:95], v7, s[8:11], s19 offen
    s_waitcnt vmcnt(10)
    v_mfma_f32_16x16x32_bf16 v[16:19], v[32:35], v[48:51], v[16:19]
    v_mfma_f32_16x16x32_bf16 v[20:23], v[32:35], v[52:55], v[20:23]
    v_mfma_f32_16x16x32_bf16 v[24:27], v[32:35], v[56:59], v[24:27]
    v_mfma_f32_16x16x32_bf16 v[28:31], v[32:35], v[60:63], v[28:31]
    s_add_u32 s19, s5, 2755584
    buffer_load_dwordx4 v[32:35], v7, s[8:11], s19 offen
    s_add_u32 s19, s17, 178176
    buffer_load_dwordx4 v[48:51], v7, s[8:11], s19 offen
    s_add_u32 s19, s17, 179200
    buffer_load_dwordx4 v[52:55], v7, s[8:11], s19 offen
    s_add_u32 s19, s17, 440320
    buffer_load_dwordx4 v[56:59], v7, s[8:11], s19 offen
    s_add_u32 s19, s17, 441344
    buffer_load_dwordx4 v[60:63], v7, s[8:11], s19 offen
    s_waitcnt vmcnt(10)
    v_mfma_f32_16x16x32_bf16 v[16:19], v[36:39], v[64:67], v[16:19]
    v_mfma_f32_16x16x32_bf16 v[20:23], v[36:39], v[68:71], v[20:23]
    v_mfma_f32_16x16x32_bf16 v[24:27], v[36:39], v[72:75], v[24:27]
    v_mfma_f32_16x16x32_bf16 v[28:31], v[36:39], v[76:79], v[28:31]
    s_add_u32 s19, s5, 2883584
    buffer_load_dwordx4 v[36:39], v7, s[8:11], s19 offen
    s_add_u32 s19, s17, 180224
    buffer_load_dwordx4 v[64:67], v7, s[8:11], s19 offen
    s_add_u32 s19, s17, 181248
    buffer_load_dwordx4 v[68:71], v7, s[8:11], s19 offen
    s_add_u32 s19, s17, 442368
    buffer_load_dwordx4 v[72:75], v7, s[8:11], s19 offen
    s_add_u32 s19, s17, 443392
    buffer_load_dwordx4 v[76:79], v7, s[8:11], s19 offen
    s_waitcnt vmcnt(10)
    v_mfma_f32_16x16x32_bf16 v[16:19], v[40:43], v[80:83], v[16:19]
    v_mfma_f32_16x16x32_bf16 v[20:23], v[40:43], v[84:87], v[20:23]
    v_mfma_f32_16x16x32_bf16 v[24:27], v[40:43], v[88:91], v[24:27]
    v_mfma_f32_16x16x32_bf16 v[28:31], v[40:43], v[92:95], v[28:31]
    s_add_u32 s19, s5, 2884608
    buffer_load_dwordx4 v[40:43], v7, s[8:11], s19 offen
    s_add_u32 s19, s17, 182272
    buffer_load_dwordx4 v[80:83], v7, s[8:11], s19 offen
    s_add_u32 s19, s17, 183296
    buffer_load_dwordx4 v[84:87], v7, s[8:11], s19 offen
    s_add_u32 s19, s17, 444416
    buffer_load_dwordx4 v[88:91], v7, s[8:11], s19 offen
    s_add_u32 s19, s17, 445440
    buffer_load_dwordx4 v[92:95], v7, s[8:11], s19 offen
    s_waitcnt vmcnt(10)
    v_mfma_f32_16x16x32_bf16 v[16:19], v[32:35], v[48:51], v[16:19]
    v_mfma_f32_16x16x32_bf16 v[20:23], v[32:35], v[52:55], v[20:23]
    v_mfma_f32_16x16x32_bf16 v[24:27], v[32:35], v[56:59], v[24:27]
    v_mfma_f32_16x16x32_bf16 v[28:31], v[32:35], v[60:63], v[28:31]
    s_add_u32 s19, s5, 2885632
    buffer_load_dwordx4 v[32:35], v7, s[8:11], s19 offen
    s_add_u32 s19, s17, 184320
    buffer_load_dwordx4 v[48:51], v7, s[8:11], s19 offen
    s_add_u32 s19, s17, 185344
    buffer_load_dwordx4 v[52:55], v7, s[8:11], s19 offen
    s_add_u32 s19, s17, 446464
    buffer_load_dwordx4 v[56:59], v7, s[8:11], s19 offen
    s_add_u32 s19, s17, 447488
    buffer_load_dwordx4 v[60:63], v7, s[8:11], s19 offen
    s_waitcnt vmcnt(10)
    v_mfma_f32_16x16x32_bf16 v[16:19], v[36:39], v[64:67], v[16:19]
    v_mfma_f32_16x16x32_bf16 v[20:23], v[36:39], v[68:71], v[20:23]
    v_mfma_f32_16x16x32_bf16 v[24:27], v[36:39], v[72:75], v[24:27]
    v_mfma_f32_16x16x32_bf16 v[28:31], v[36:39], v[76:79], v[28:31]
    s_add_u32 s19, s5, 2886656
    buffer_load_dwordx4 v[36:39], v7, s[8:11], s19 offen
    s_add_u32 s19, s17, 186368
    buffer_load_dwordx4 v[64:67], v7, s[8:11], s19 offen
    s_add_u32 s19, s17, 187392
    buffer_load_dwordx4 v[68:71], v7, s[8:11], s19 offen
    s_add_u32 s19, s17, 448512
    buffer_load_dwordx4 v[72:75], v7, s[8:11], s19 offen
    s_add_u32 s19, s17, 449536
    buffer_load_dwordx4 v[76:79], v7, s[8:11], s19 offen
    s_waitcnt vmcnt(10)
    v_mfma_f32_16x16x32_bf16 v[16:19], v[40:43], v[80:83], v[16:19]
    v_mfma_f32_16x16x32_bf16 v[20:23], v[40:43], v[84:87], v[20:23]
    v_mfma_f32_16x16x32_bf16 v[24:27], v[40:43], v[88:91], v[24:27]
    v_mfma_f32_16x16x32_bf16 v[28:31], v[40:43], v[92:95], v[28:31]
    s_add_u32 s19, s5, 3014656
    buffer_load_dwordx4 v[40:43], v7, s[8:11], s19 offen
    s_add_u32 s19, s17, 188416
    buffer_load_dwordx4 v[80:83], v7, s[8:11], s19 offen
    s_add_u32 s19, s17, 189440
    buffer_load_dwordx4 v[84:87], v7, s[8:11], s19 offen
    s_add_u32 s19, s17, 450560
    buffer_load_dwordx4 v[88:91], v7, s[8:11], s19 offen
    s_add_u32 s19, s17, 451584
    buffer_load_dwordx4 v[92:95], v7, s[8:11], s19 offen
    s_waitcnt vmcnt(10)
    v_mfma_f32_16x16x32_bf16 v[16:19], v[32:35], v[48:51], v[16:19]
    v_mfma_f32_16x16x32_bf16 v[20:23], v[32:35], v[52:55], v[20:23]
    v_mfma_f32_16x16x32_bf16 v[24:27], v[32:35], v[56:59], v[24:27]
    v_mfma_f32_16x16x32_bf16 v[28:31], v[32:35], v[60:63], v[28:31]
    s_add_u32 s19, s5, 3015680
    buffer_load_dwordx4 v[32:35], v7, s[8:11], s19 offen
    s_add_u32 s19, s17, 190464
    buffer_load_dwordx4 v[48:51], v7, s[8:11], s19 offen
    s_add_u32 s19, s17, 191488
    buffer_load_dwordx4 v[52:55], v7, s[8:11], s19 offen
    s_add_u32 s19, s17, 452608
    buffer_load_dwordx4 v[56:59], v7, s[8:11], s19 offen
    s_add_u32 s19, s17, 453632
    buffer_load_dwordx4 v[60:63], v7, s[8:11], s19 offen
    s_waitcnt vmcnt(10)
    v_mfma_f32_16x16x32_bf16 v[16:19], v[36:39], v[64:67], v[16:19]
    v_mfma_f32_16x16x32_bf16 v[20:23], v[36:39], v[68:71], v[20:23]
    v_mfma_f32_16x16x32_bf16 v[24:27], v[36:39], v[72:75], v[24:27]
    v_mfma_f32_16x16x32_bf16 v[28:31], v[36:39], v[76:79], v[28:31]
    s_add_u32 s19, s5, 3016704
    buffer_load_dwordx4 v[36:39], v7, s[8:11], s19 offen
    s_add_u32 s19, s17, 192512
    buffer_load_dwordx4 v[64:67], v7, s[8:11], s19 offen
    s_add_u32 s19, s17, 193536
    buffer_load_dwordx4 v[68:71], v7, s[8:11], s19 offen
    s_add_u32 s19, s17, 454656
    buffer_load_dwordx4 v[72:75], v7, s[8:11], s19 offen
    s_add_u32 s19, s17, 455680
    buffer_load_dwordx4 v[76:79], v7, s[8:11], s19 offen
    s_waitcnt vmcnt(10)
    v_mfma_f32_16x16x32_bf16 v[16:19], v[40:43], v[80:83], v[16:19]
    v_mfma_f32_16x16x32_bf16 v[20:23], v[40:43], v[84:87], v[20:23]
    v_mfma_f32_16x16x32_bf16 v[24:27], v[40:43], v[88:91], v[24:27]
    v_mfma_f32_16x16x32_bf16 v[28:31], v[40:43], v[92:95], v[28:31]
    s_add_u32 s19, s5, 3017728
    buffer_load_dwordx4 v[40:43], v7, s[8:11], s19 offen
    s_add_u32 s19, s17, 194560
    buffer_load_dwordx4 v[80:83], v7, s[8:11], s19 offen
    s_add_u32 s19, s17, 195584
    buffer_load_dwordx4 v[84:87], v7, s[8:11], s19 offen
    s_add_u32 s19, s17, 456704
    buffer_load_dwordx4 v[88:91], v7, s[8:11], s19 offen
    s_add_u32 s19, s17, 457728
    buffer_load_dwordx4 v[92:95], v7, s[8:11], s19 offen
    s_waitcnt vmcnt(10)
    v_mfma_f32_16x16x32_bf16 v[16:19], v[32:35], v[48:51], v[16:19]
    v_mfma_f32_16x16x32_bf16 v[20:23], v[32:35], v[52:55], v[20:23]
    v_mfma_f32_16x16x32_bf16 v[24:27], v[32:35], v[56:59], v[24:27]
    v_mfma_f32_16x16x32_bf16 v[28:31], v[32:35], v[60:63], v[28:31]
    s_add_u32 s19, s5, 3145728
    buffer_load_dwordx4 v[32:35], v7, s[8:11], s19 offen
    s_add_u32 s19, s17, 196608
    buffer_load_dwordx4 v[48:51], v7, s[8:11], s19 offen
    s_add_u32 s19, s17, 197632
    buffer_load_dwordx4 v[52:55], v7, s[8:11], s19 offen
    s_add_u32 s19, s17, 458752
    buffer_load_dwordx4 v[56:59], v7, s[8:11], s19 offen
    s_add_u32 s19, s17, 459776
    buffer_load_dwordx4 v[60:63], v7, s[8:11], s19 offen
    s_waitcnt vmcnt(10)
    v_mfma_f32_16x16x32_bf16 v[16:19], v[36:39], v[64:67], v[16:19]
    v_mfma_f32_16x16x32_bf16 v[20:23], v[36:39], v[68:71], v[20:23]
    v_mfma_f32_16x16x32_bf16 v[24:27], v[36:39], v[72:75], v[24:27]
    v_mfma_f32_16x16x32_bf16 v[28:31], v[36:39], v[76:79], v[28:31]
    s_add_u32 s19, s5, 3146752
    buffer_load_dwordx4 v[36:39], v7, s[8:11], s19 offen
    s_add_u32 s19, s17, 198656
    buffer_load_dwordx4 v[64:67], v7, s[8:11], s19 offen
    s_add_u32 s19, s17, 199680
    buffer_load_dwordx4 v[68:71], v7, s[8:11], s19 offen
    s_add_u32 s19, s17, 460800
    buffer_load_dwordx4 v[72:75], v7, s[8:11], s19 offen
    s_add_u32 s19, s17, 461824
    buffer_load_dwordx4 v[76:79], v7, s[8:11], s19 offen
    s_waitcnt vmcnt(10)
    v_mfma_f32_16x16x32_bf16 v[16:19], v[40:43], v[80:83], v[16:19]
    v_mfma_f32_16x16x32_bf16 v[20:23], v[40:43], v[84:87], v[20:23]
    v_mfma_f32_16x16x32_bf16 v[24:27], v[40:43], v[88:91], v[24:27]
    v_mfma_f32_16x16x32_bf16 v[28:31], v[40:43], v[92:95], v[28:31]
    s_add_u32 s19, s5, 3147776
    buffer_load_dwordx4 v[40:43], v7, s[8:11], s19 offen
    s_add_u32 s19, s17, 200704
    buffer_load_dwordx4 v[80:83], v7, s[8:11], s19 offen
    s_add_u32 s19, s17, 201728
    buffer_load_dwordx4 v[84:87], v7, s[8:11], s19 offen
    s_add_u32 s19, s17, 462848
    buffer_load_dwordx4 v[88:91], v7, s[8:11], s19 offen
    s_add_u32 s19, s17, 463872
    buffer_load_dwordx4 v[92:95], v7, s[8:11], s19 offen
    s_waitcnt vmcnt(10)
    v_mfma_f32_16x16x32_bf16 v[16:19], v[32:35], v[48:51], v[16:19]
    v_mfma_f32_16x16x32_bf16 v[20:23], v[32:35], v[52:55], v[20:23]
    v_mfma_f32_16x16x32_bf16 v[24:27], v[32:35], v[56:59], v[24:27]
    v_mfma_f32_16x16x32_bf16 v[28:31], v[32:35], v[60:63], v[28:31]
    s_add_u32 s19, s5, 3148800
    buffer_load_dwordx4 v[32:35], v7, s[8:11], s19 offen
    s_add_u32 s19, s17, 202752
    buffer_load_dwordx4 v[48:51], v7, s[8:11], s19 offen
    s_add_u32 s19, s17, 203776
    buffer_load_dwordx4 v[52:55], v7, s[8:11], s19 offen
    s_add_u32 s19, s17, 464896
    buffer_load_dwordx4 v[56:59], v7, s[8:11], s19 offen
    s_add_u32 s19, s17, 465920
    buffer_load_dwordx4 v[60:63], v7, s[8:11], s19 offen
    s_waitcnt vmcnt(10)
    v_mfma_f32_16x16x32_bf16 v[16:19], v[36:39], v[64:67], v[16:19]
    v_mfma_f32_16x16x32_bf16 v[20:23], v[36:39], v[68:71], v[20:23]
    v_mfma_f32_16x16x32_bf16 v[24:27], v[36:39], v[72:75], v[24:27]
    v_mfma_f32_16x16x32_bf16 v[28:31], v[36:39], v[76:79], v[28:31]
    s_add_u32 s19, s5, 3276800
    buffer_load_dwordx4 v[36:39], v7, s[8:11], s19 offen
    s_add_u32 s19, s17, 204800
    buffer_load_dwordx4 v[64:67], v7, s[8:11], s19 offen
    s_add_u32 s19, s17, 205824
    buffer_load_dwordx4 v[68:71], v7, s[8:11], s19 offen
    s_add_u32 s19, s17, 466944
    buffer_load_dwordx4 v[72:75], v7, s[8:11], s19 offen
    s_add_u32 s19, s17, 467968
    buffer_load_dwordx4 v[76:79], v7, s[8:11], s19 offen
    s_waitcnt vmcnt(10)
    v_mfma_f32_16x16x32_bf16 v[16:19], v[40:43], v[80:83], v[16:19]
    v_mfma_f32_16x16x32_bf16 v[20:23], v[40:43], v[84:87], v[20:23]
    v_mfma_f32_16x16x32_bf16 v[24:27], v[40:43], v[88:91], v[24:27]
    v_mfma_f32_16x16x32_bf16 v[28:31], v[40:43], v[92:95], v[28:31]
    s_add_u32 s19, s5, 3277824
    buffer_load_dwordx4 v[40:43], v7, s[8:11], s19 offen
    s_add_u32 s19, s17, 206848
    buffer_load_dwordx4 v[80:83], v7, s[8:11], s19 offen
    s_add_u32 s19, s17, 207872
    buffer_load_dwordx4 v[84:87], v7, s[8:11], s19 offen
    s_add_u32 s19, s17, 468992
    buffer_load_dwordx4 v[88:91], v7, s[8:11], s19 offen
    s_add_u32 s19, s17, 470016
    buffer_load_dwordx4 v[92:95], v7, s[8:11], s19 offen
    s_waitcnt vmcnt(10)
    v_mfma_f32_16x16x32_bf16 v[16:19], v[32:35], v[48:51], v[16:19]
    v_mfma_f32_16x16x32_bf16 v[20:23], v[32:35], v[52:55], v[20:23]
    v_mfma_f32_16x16x32_bf16 v[24:27], v[32:35], v[56:59], v[24:27]
    v_mfma_f32_16x16x32_bf16 v[28:31], v[32:35], v[60:63], v[28:31]
    s_add_u32 s19, s5, 3278848
    buffer_load_dwordx4 v[32:35], v7, s[8:11], s19 offen
    s_add_u32 s19, s17, 208896
    buffer_load_dwordx4 v[48:51], v7, s[8:11], s19 offen
    s_add_u32 s19, s17, 209920
    buffer_load_dwordx4 v[52:55], v7, s[8:11], s19 offen
    s_add_u32 s19, s17, 471040
    buffer_load_dwordx4 v[56:59], v7, s[8:11], s19 offen
    s_add_u32 s19, s17, 472064
    buffer_load_dwordx4 v[60:63], v7, s[8:11], s19 offen
    s_waitcnt vmcnt(10)
    v_mfma_f32_16x16x32_bf16 v[16:19], v[36:39], v[64:67], v[16:19]
    v_mfma_f32_16x16x32_bf16 v[20:23], v[36:39], v[68:71], v[20:23]
    v_mfma_f32_16x16x32_bf16 v[24:27], v[36:39], v[72:75], v[24:27]
    v_mfma_f32_16x16x32_bf16 v[28:31], v[36:39], v[76:79], v[28:31]
    s_add_u32 s19, s5, 3279872
    buffer_load_dwordx4 v[36:39], v7, s[8:11], s19 offen
    s_add_u32 s19, s17, 210944
    buffer_load_dwordx4 v[64:67], v7, s[8:11], s19 offen
    s_add_u32 s19, s17, 211968
    buffer_load_dwordx4 v[68:71], v7, s[8:11], s19 offen
    s_add_u32 s19, s17, 473088
    buffer_load_dwordx4 v[72:75], v7, s[8:11], s19 offen
    s_add_u32 s19, s17, 474112
    buffer_load_dwordx4 v[76:79], v7, s[8:11], s19 offen
    s_waitcnt vmcnt(10)
    v_mfma_f32_16x16x32_bf16 v[16:19], v[40:43], v[80:83], v[16:19]
    v_mfma_f32_16x16x32_bf16 v[20:23], v[40:43], v[84:87], v[20:23]
    v_mfma_f32_16x16x32_bf16 v[24:27], v[40:43], v[88:91], v[24:27]
    v_mfma_f32_16x16x32_bf16 v[28:31], v[40:43], v[92:95], v[28:31]
    s_add_u32 s19, s5, 3407872
    buffer_load_dwordx4 v[40:43], v7, s[8:11], s19 offen
    s_add_u32 s19, s17, 212992
    buffer_load_dwordx4 v[80:83], v7, s[8:11], s19 offen
    s_add_u32 s19, s17, 214016
    buffer_load_dwordx4 v[84:87], v7, s[8:11], s19 offen
    s_add_u32 s19, s17, 475136
    buffer_load_dwordx4 v[88:91], v7, s[8:11], s19 offen
    s_add_u32 s19, s17, 476160
    buffer_load_dwordx4 v[92:95], v7, s[8:11], s19 offen
    s_waitcnt vmcnt(10)
    v_mfma_f32_16x16x32_bf16 v[16:19], v[32:35], v[48:51], v[16:19]
    v_mfma_f32_16x16x32_bf16 v[20:23], v[32:35], v[52:55], v[20:23]
    v_mfma_f32_16x16x32_bf16 v[24:27], v[32:35], v[56:59], v[24:27]
    v_mfma_f32_16x16x32_bf16 v[28:31], v[32:35], v[60:63], v[28:31]
    s_add_u32 s19, s5, 3408896
    buffer_load_dwordx4 v[32:35], v7, s[8:11], s19 offen
    s_add_u32 s19, s17, 215040
    buffer_load_dwordx4 v[48:51], v7, s[8:11], s19 offen
    s_add_u32 s19, s17, 216064
    buffer_load_dwordx4 v[52:55], v7, s[8:11], s19 offen
    s_add_u32 s19, s17, 477184
    buffer_load_dwordx4 v[56:59], v7, s[8:11], s19 offen
    s_add_u32 s19, s17, 478208
    buffer_load_dwordx4 v[60:63], v7, s[8:11], s19 offen
    s_waitcnt vmcnt(10)
    v_mfma_f32_16x16x32_bf16 v[16:19], v[36:39], v[64:67], v[16:19]
    v_mfma_f32_16x16x32_bf16 v[20:23], v[36:39], v[68:71], v[20:23]
    v_mfma_f32_16x16x32_bf16 v[24:27], v[36:39], v[72:75], v[24:27]
    v_mfma_f32_16x16x32_bf16 v[28:31], v[36:39], v[76:79], v[28:31]
    s_add_u32 s19, s5, 3409920
    buffer_load_dwordx4 v[36:39], v7, s[8:11], s19 offen
    s_add_u32 s19, s17, 217088
    buffer_load_dwordx4 v[64:67], v7, s[8:11], s19 offen
    s_add_u32 s19, s17, 218112
    buffer_load_dwordx4 v[68:71], v7, s[8:11], s19 offen
    s_add_u32 s19, s17, 479232
    buffer_load_dwordx4 v[72:75], v7, s[8:11], s19 offen
    s_add_u32 s19, s17, 480256
    buffer_load_dwordx4 v[76:79], v7, s[8:11], s19 offen
    s_waitcnt vmcnt(10)
    v_mfma_f32_16x16x32_bf16 v[16:19], v[40:43], v[80:83], v[16:19]
    v_mfma_f32_16x16x32_bf16 v[20:23], v[40:43], v[84:87], v[20:23]
    v_mfma_f32_16x16x32_bf16 v[24:27], v[40:43], v[88:91], v[24:27]
    v_mfma_f32_16x16x32_bf16 v[28:31], v[40:43], v[92:95], v[28:31]
    s_add_u32 s19, s5, 3410944
    buffer_load_dwordx4 v[40:43], v7, s[8:11], s19 offen
    s_add_u32 s19, s17, 219136
    buffer_load_dwordx4 v[80:83], v7, s[8:11], s19 offen
    s_add_u32 s19, s17, 220160
    buffer_load_dwordx4 v[84:87], v7, s[8:11], s19 offen
    s_add_u32 s19, s17, 481280
    buffer_load_dwordx4 v[88:91], v7, s[8:11], s19 offen
    s_add_u32 s19, s17, 482304
    buffer_load_dwordx4 v[92:95], v7, s[8:11], s19 offen
    s_waitcnt vmcnt(10)
    v_mfma_f32_16x16x32_bf16 v[16:19], v[32:35], v[48:51], v[16:19]
    v_mfma_f32_16x16x32_bf16 v[20:23], v[32:35], v[52:55], v[20:23]
    v_mfma_f32_16x16x32_bf16 v[24:27], v[32:35], v[56:59], v[24:27]
    v_mfma_f32_16x16x32_bf16 v[28:31], v[32:35], v[60:63], v[28:31]
    s_add_u32 s19, s5, 3538944
    buffer_load_dwordx4 v[32:35], v7, s[8:11], s19 offen
    s_add_u32 s19, s17, 221184
    buffer_load_dwordx4 v[48:51], v7, s[8:11], s19 offen
    s_add_u32 s19, s17, 222208
    buffer_load_dwordx4 v[52:55], v7, s[8:11], s19 offen
    s_add_u32 s19, s17, 483328
    buffer_load_dwordx4 v[56:59], v7, s[8:11], s19 offen
    s_add_u32 s19, s17, 484352
    buffer_load_dwordx4 v[60:63], v7, s[8:11], s19 offen
    s_waitcnt vmcnt(10)
    v_mfma_f32_16x16x32_bf16 v[16:19], v[36:39], v[64:67], v[16:19]
    v_mfma_f32_16x16x32_bf16 v[20:23], v[36:39], v[68:71], v[20:23]
    v_mfma_f32_16x16x32_bf16 v[24:27], v[36:39], v[72:75], v[24:27]
    v_mfma_f32_16x16x32_bf16 v[28:31], v[36:39], v[76:79], v[28:31]
    s_add_u32 s19, s5, 3539968
    buffer_load_dwordx4 v[36:39], v7, s[8:11], s19 offen
    s_add_u32 s19, s17, 223232
    buffer_load_dwordx4 v[64:67], v7, s[8:11], s19 offen
    s_add_u32 s19, s17, 224256
    buffer_load_dwordx4 v[68:71], v7, s[8:11], s19 offen
    s_add_u32 s19, s17, 485376
    buffer_load_dwordx4 v[72:75], v7, s[8:11], s19 offen
    s_add_u32 s19, s17, 486400
    buffer_load_dwordx4 v[76:79], v7, s[8:11], s19 offen
    s_waitcnt vmcnt(10)
    v_mfma_f32_16x16x32_bf16 v[16:19], v[40:43], v[80:83], v[16:19]
    v_mfma_f32_16x16x32_bf16 v[20:23], v[40:43], v[84:87], v[20:23]
    v_mfma_f32_16x16x32_bf16 v[24:27], v[40:43], v[88:91], v[24:27]
    v_mfma_f32_16x16x32_bf16 v[28:31], v[40:43], v[92:95], v[28:31]
    s_add_u32 s19, s5, 3540992
    buffer_load_dwordx4 v[40:43], v7, s[8:11], s19 offen
    s_add_u32 s19, s17, 225280
    buffer_load_dwordx4 v[80:83], v7, s[8:11], s19 offen
    s_add_u32 s19, s17, 226304
    buffer_load_dwordx4 v[84:87], v7, s[8:11], s19 offen
    s_add_u32 s19, s17, 487424
    buffer_load_dwordx4 v[88:91], v7, s[8:11], s19 offen
    s_add_u32 s19, s17, 488448
    buffer_load_dwordx4 v[92:95], v7, s[8:11], s19 offen
    s_waitcnt vmcnt(10)
    v_mfma_f32_16x16x32_bf16 v[16:19], v[32:35], v[48:51], v[16:19]
    v_mfma_f32_16x16x32_bf16 v[20:23], v[32:35], v[52:55], v[20:23]
    v_mfma_f32_16x16x32_bf16 v[24:27], v[32:35], v[56:59], v[24:27]
    v_mfma_f32_16x16x32_bf16 v[28:31], v[32:35], v[60:63], v[28:31]
    s_add_u32 s19, s5, 3542016
    buffer_load_dwordx4 v[32:35], v7, s[8:11], s19 offen
    s_add_u32 s19, s17, 227328
    buffer_load_dwordx4 v[48:51], v7, s[8:11], s19 offen
    s_add_u32 s19, s17, 228352
    buffer_load_dwordx4 v[52:55], v7, s[8:11], s19 offen
    s_add_u32 s19, s17, 489472
    buffer_load_dwordx4 v[56:59], v7, s[8:11], s19 offen
    s_add_u32 s19, s17, 490496
    buffer_load_dwordx4 v[60:63], v7, s[8:11], s19 offen
    s_waitcnt vmcnt(10)
    v_mfma_f32_16x16x32_bf16 v[16:19], v[36:39], v[64:67], v[16:19]
    v_mfma_f32_16x16x32_bf16 v[20:23], v[36:39], v[68:71], v[20:23]
    v_mfma_f32_16x16x32_bf16 v[24:27], v[36:39], v[72:75], v[24:27]
    v_mfma_f32_16x16x32_bf16 v[28:31], v[36:39], v[76:79], v[28:31]
    s_add_u32 s19, s5, 3670016
    buffer_load_dwordx4 v[36:39], v7, s[8:11], s19 offen
    s_add_u32 s19, s17, 229376
    buffer_load_dwordx4 v[64:67], v7, s[8:11], s19 offen
    s_add_u32 s19, s17, 230400
    buffer_load_dwordx4 v[68:71], v7, s[8:11], s19 offen
    s_add_u32 s19, s17, 491520
    buffer_load_dwordx4 v[72:75], v7, s[8:11], s19 offen
    s_add_u32 s19, s17, 492544
    buffer_load_dwordx4 v[76:79], v7, s[8:11], s19 offen
    s_waitcnt vmcnt(10)
    v_mfma_f32_16x16x32_bf16 v[16:19], v[40:43], v[80:83], v[16:19]
    v_mfma_f32_16x16x32_bf16 v[20:23], v[40:43], v[84:87], v[20:23]
    v_mfma_f32_16x16x32_bf16 v[24:27], v[40:43], v[88:91], v[24:27]
    v_mfma_f32_16x16x32_bf16 v[28:31], v[40:43], v[92:95], v[28:31]
    s_add_u32 s19, s5, 3671040
    buffer_load_dwordx4 v[40:43], v7, s[8:11], s19 offen
    s_add_u32 s19, s17, 231424
    buffer_load_dwordx4 v[80:83], v7, s[8:11], s19 offen
    s_add_u32 s19, s17, 232448
    buffer_load_dwordx4 v[84:87], v7, s[8:11], s19 offen
    s_add_u32 s19, s17, 493568
    buffer_load_dwordx4 v[88:91], v7, s[8:11], s19 offen
    s_add_u32 s19, s17, 494592
    buffer_load_dwordx4 v[92:95], v7, s[8:11], s19 offen
    s_waitcnt vmcnt(10)
    v_mfma_f32_16x16x32_bf16 v[16:19], v[32:35], v[48:51], v[16:19]
    v_mfma_f32_16x16x32_bf16 v[20:23], v[32:35], v[52:55], v[20:23]
    v_mfma_f32_16x16x32_bf16 v[24:27], v[32:35], v[56:59], v[24:27]
    v_mfma_f32_16x16x32_bf16 v[28:31], v[32:35], v[60:63], v[28:31]
    s_add_u32 s19, s5, 3672064
    buffer_load_dwordx4 v[32:35], v7, s[8:11], s19 offen
    s_add_u32 s19, s17, 233472
    buffer_load_dwordx4 v[48:51], v7, s[8:11], s19 offen
    s_add_u32 s19, s17, 234496
    buffer_load_dwordx4 v[52:55], v7, s[8:11], s19 offen
    s_add_u32 s19, s17, 495616
    buffer_load_dwordx4 v[56:59], v7, s[8:11], s19 offen
    s_add_u32 s19, s17, 496640
    buffer_load_dwordx4 v[60:63], v7, s[8:11], s19 offen
    s_waitcnt vmcnt(10)
    v_mfma_f32_16x16x32_bf16 v[16:19], v[36:39], v[64:67], v[16:19]
    v_mfma_f32_16x16x32_bf16 v[20:23], v[36:39], v[68:71], v[20:23]
    v_mfma_f32_16x16x32_bf16 v[24:27], v[36:39], v[72:75], v[24:27]
    v_mfma_f32_16x16x32_bf16 v[28:31], v[36:39], v[76:79], v[28:31]
    s_add_u32 s19, s5, 3673088
    buffer_load_dwordx4 v[36:39], v7, s[8:11], s19 offen
    s_add_u32 s19, s17, 235520
    buffer_load_dwordx4 v[64:67], v7, s[8:11], s19 offen
    s_add_u32 s19, s17, 236544
    buffer_load_dwordx4 v[68:71], v7, s[8:11], s19 offen
    s_add_u32 s19, s17, 497664
    buffer_load_dwordx4 v[72:75], v7, s[8:11], s19 offen
    s_add_u32 s19, s17, 498688
    buffer_load_dwordx4 v[76:79], v7, s[8:11], s19 offen
    s_waitcnt vmcnt(10)
    v_mfma_f32_16x16x32_bf16 v[16:19], v[40:43], v[80:83], v[16:19]
    v_mfma_f32_16x16x32_bf16 v[20:23], v[40:43], v[84:87], v[20:23]
    v_mfma_f32_16x16x32_bf16 v[24:27], v[40:43], v[88:91], v[24:27]
    v_mfma_f32_16x16x32_bf16 v[28:31], v[40:43], v[92:95], v[28:31]
    s_add_u32 s19, s5, 3801088
    buffer_load_dwordx4 v[40:43], v7, s[8:11], s19 offen
    s_add_u32 s19, s17, 237568
    buffer_load_dwordx4 v[80:83], v7, s[8:11], s19 offen
    s_add_u32 s19, s17, 238592
    buffer_load_dwordx4 v[84:87], v7, s[8:11], s19 offen
    s_add_u32 s19, s17, 499712
    buffer_load_dwordx4 v[88:91], v7, s[8:11], s19 offen
    s_add_u32 s19, s17, 500736
    buffer_load_dwordx4 v[92:95], v7, s[8:11], s19 offen
    s_waitcnt vmcnt(10)
    v_mfma_f32_16x16x32_bf16 v[16:19], v[32:35], v[48:51], v[16:19]
    v_mfma_f32_16x16x32_bf16 v[20:23], v[32:35], v[52:55], v[20:23]
    v_mfma_f32_16x16x32_bf16 v[24:27], v[32:35], v[56:59], v[24:27]
    v_mfma_f32_16x16x32_bf16 v[28:31], v[32:35], v[60:63], v[28:31]
    s_add_u32 s19, s5, 3802112
    buffer_load_dwordx4 v[32:35], v7, s[8:11], s19 offen
    s_add_u32 s19, s17, 239616
    buffer_load_dwordx4 v[48:51], v7, s[8:11], s19 offen
    s_add_u32 s19, s17, 240640
    buffer_load_dwordx4 v[52:55], v7, s[8:11], s19 offen
    s_add_u32 s19, s17, 501760
    buffer_load_dwordx4 v[56:59], v7, s[8:11], s19 offen
    s_add_u32 s19, s17, 502784
    buffer_load_dwordx4 v[60:63], v7, s[8:11], s19 offen
    s_waitcnt vmcnt(10)
    v_mfma_f32_16x16x32_bf16 v[16:19], v[36:39], v[64:67], v[16:19]
    v_mfma_f32_16x16x32_bf16 v[20:23], v[36:39], v[68:71], v[20:23]
    v_mfma_f32_16x16x32_bf16 v[24:27], v[36:39], v[72:75], v[24:27]
    v_mfma_f32_16x16x32_bf16 v[28:31], v[36:39], v[76:79], v[28:31]
    s_add_u32 s19, s5, 3803136
    buffer_load_dwordx4 v[36:39], v7, s[8:11], s19 offen
    s_add_u32 s19, s17, 241664
    buffer_load_dwordx4 v[64:67], v7, s[8:11], s19 offen
    s_add_u32 s19, s17, 242688
    buffer_load_dwordx4 v[68:71], v7, s[8:11], s19 offen
    s_add_u32 s19, s17, 503808
    buffer_load_dwordx4 v[72:75], v7, s[8:11], s19 offen
    s_add_u32 s19, s17, 504832
    buffer_load_dwordx4 v[76:79], v7, s[8:11], s19 offen
    s_waitcnt vmcnt(10)
    v_mfma_f32_16x16x32_bf16 v[16:19], v[40:43], v[80:83], v[16:19]
    v_mfma_f32_16x16x32_bf16 v[20:23], v[40:43], v[84:87], v[20:23]
    v_mfma_f32_16x16x32_bf16 v[24:27], v[40:43], v[88:91], v[24:27]
    v_mfma_f32_16x16x32_bf16 v[28:31], v[40:43], v[92:95], v[28:31]
    s_add_u32 s19, s5, 3804160
    buffer_load_dwordx4 v[40:43], v7, s[8:11], s19 offen
    s_add_u32 s19, s17, 243712
    buffer_load_dwordx4 v[80:83], v7, s[8:11], s19 offen
    s_add_u32 s19, s17, 244736
    buffer_load_dwordx4 v[84:87], v7, s[8:11], s19 offen
    s_add_u32 s19, s17, 505856
    buffer_load_dwordx4 v[88:91], v7, s[8:11], s19 offen
    s_add_u32 s19, s17, 506880
    buffer_load_dwordx4 v[92:95], v7, s[8:11], s19 offen
    s_waitcnt vmcnt(10)
    v_mfma_f32_16x16x32_bf16 v[16:19], v[32:35], v[48:51], v[16:19]
    v_mfma_f32_16x16x32_bf16 v[20:23], v[32:35], v[52:55], v[20:23]
    v_mfma_f32_16x16x32_bf16 v[24:27], v[32:35], v[56:59], v[24:27]
    v_mfma_f32_16x16x32_bf16 v[28:31], v[32:35], v[60:63], v[28:31]
    s_add_u32 s19, s5, 3932160
    buffer_load_dwordx4 v[32:35], v7, s[8:11], s19 offen
    s_add_u32 s19, s17, 245760
    buffer_load_dwordx4 v[48:51], v7, s[8:11], s19 offen
    s_add_u32 s19, s17, 246784
    buffer_load_dwordx4 v[52:55], v7, s[8:11], s19 offen
    s_add_u32 s19, s17, 507904
    buffer_load_dwordx4 v[56:59], v7, s[8:11], s19 offen
    s_add_u32 s19, s17, 508928
    buffer_load_dwordx4 v[60:63], v7, s[8:11], s19 offen
    s_waitcnt vmcnt(10)
    v_mfma_f32_16x16x32_bf16 v[16:19], v[36:39], v[64:67], v[16:19]
    v_mfma_f32_16x16x32_bf16 v[20:23], v[36:39], v[68:71], v[20:23]
    v_mfma_f32_16x16x32_bf16 v[24:27], v[36:39], v[72:75], v[24:27]
    v_mfma_f32_16x16x32_bf16 v[28:31], v[36:39], v[76:79], v[28:31]
    s_add_u32 s19, s5, 3933184
    buffer_load_dwordx4 v[36:39], v7, s[8:11], s19 offen
    s_add_u32 s19, s17, 247808
    buffer_load_dwordx4 v[64:67], v7, s[8:11], s19 offen
    s_add_u32 s19, s17, 248832
    buffer_load_dwordx4 v[68:71], v7, s[8:11], s19 offen
    s_add_u32 s19, s17, 509952
    buffer_load_dwordx4 v[72:75], v7, s[8:11], s19 offen
    s_add_u32 s19, s17, 510976
    buffer_load_dwordx4 v[76:79], v7, s[8:11], s19 offen
    s_waitcnt vmcnt(10)
    v_mfma_f32_16x16x32_bf16 v[16:19], v[40:43], v[80:83], v[16:19]
    v_mfma_f32_16x16x32_bf16 v[20:23], v[40:43], v[84:87], v[20:23]
    v_mfma_f32_16x16x32_bf16 v[24:27], v[40:43], v[88:91], v[24:27]
    v_mfma_f32_16x16x32_bf16 v[28:31], v[40:43], v[92:95], v[28:31]
    s_add_u32 s19, s5, 3934208
    buffer_load_dwordx4 v[40:43], v7, s[8:11], s19 offen
    s_add_u32 s19, s17, 249856
    buffer_load_dwordx4 v[80:83], v7, s[8:11], s19 offen
    s_add_u32 s19, s17, 250880
    buffer_load_dwordx4 v[84:87], v7, s[8:11], s19 offen
    s_add_u32 s19, s17, 512000
    buffer_load_dwordx4 v[88:91], v7, s[8:11], s19 offen
    s_add_u32 s19, s17, 513024
    buffer_load_dwordx4 v[92:95], v7, s[8:11], s19 offen
    s_waitcnt vmcnt(10)
    v_mfma_f32_16x16x32_bf16 v[16:19], v[32:35], v[48:51], v[16:19]
    v_mfma_f32_16x16x32_bf16 v[20:23], v[32:35], v[52:55], v[20:23]
    v_mfma_f32_16x16x32_bf16 v[24:27], v[32:35], v[56:59], v[24:27]
    v_mfma_f32_16x16x32_bf16 v[28:31], v[32:35], v[60:63], v[28:31]
    s_add_u32 s19, s5, 3935232
    buffer_load_dwordx4 v[32:35], v7, s[8:11], s19 offen
    s_add_u32 s19, s17, 251904
    buffer_load_dwordx4 v[48:51], v7, s[8:11], s19 offen
    s_add_u32 s19, s17, 252928
    buffer_load_dwordx4 v[52:55], v7, s[8:11], s19 offen
    s_add_u32 s19, s17, 514048
    buffer_load_dwordx4 v[56:59], v7, s[8:11], s19 offen
    s_add_u32 s19, s17, 515072
    buffer_load_dwordx4 v[60:63], v7, s[8:11], s19 offen
    s_waitcnt vmcnt(10)
    v_mfma_f32_16x16x32_bf16 v[16:19], v[36:39], v[64:67], v[16:19]
    v_mfma_f32_16x16x32_bf16 v[20:23], v[36:39], v[68:71], v[20:23]
    v_mfma_f32_16x16x32_bf16 v[24:27], v[36:39], v[72:75], v[24:27]
    v_mfma_f32_16x16x32_bf16 v[28:31], v[36:39], v[76:79], v[28:31]
    s_add_u32 s19, s5, 4063232
    buffer_load_dwordx4 v[36:39], v7, s[8:11], s19 offen
    s_add_u32 s19, s17, 253952
    buffer_load_dwordx4 v[64:67], v7, s[8:11], s19 offen
    s_add_u32 s19, s17, 254976
    buffer_load_dwordx4 v[68:71], v7, s[8:11], s19 offen
    s_add_u32 s19, s17, 516096
    buffer_load_dwordx4 v[72:75], v7, s[8:11], s19 offen
    s_add_u32 s19, s17, 517120
    buffer_load_dwordx4 v[76:79], v7, s[8:11], s19 offen
    s_waitcnt vmcnt(10)
    v_mfma_f32_16x16x32_bf16 v[16:19], v[40:43], v[80:83], v[16:19]
    v_mfma_f32_16x16x32_bf16 v[20:23], v[40:43], v[84:87], v[20:23]
    v_mfma_f32_16x16x32_bf16 v[24:27], v[40:43], v[88:91], v[24:27]
    v_mfma_f32_16x16x32_bf16 v[28:31], v[40:43], v[92:95], v[28:31]
    s_add_u32 s19, s5, 4064256
    buffer_load_dwordx4 v[40:43], v7, s[8:11], s19 offen
    s_add_u32 s19, s17, 256000
    buffer_load_dwordx4 v[80:83], v7, s[8:11], s19 offen
    s_add_u32 s19, s17, 257024
    buffer_load_dwordx4 v[84:87], v7, s[8:11], s19 offen
    s_add_u32 s19, s17, 518144
    buffer_load_dwordx4 v[88:91], v7, s[8:11], s19 offen
    s_add_u32 s19, s17, 519168
    buffer_load_dwordx4 v[92:95], v7, s[8:11], s19 offen
    s_waitcnt vmcnt(10)
    v_mfma_f32_16x16x32_bf16 v[16:19], v[32:35], v[48:51], v[16:19]
    v_mfma_f32_16x16x32_bf16 v[20:23], v[32:35], v[52:55], v[20:23]
    v_mfma_f32_16x16x32_bf16 v[24:27], v[32:35], v[56:59], v[24:27]
    v_mfma_f32_16x16x32_bf16 v[28:31], v[32:35], v[60:63], v[28:31]
    s_add_u32 s19, s5, 4065280
    buffer_load_dwordx4 v[32:35], v7, s[8:11], s19 offen
    s_add_u32 s19, s17, 258048
    buffer_load_dwordx4 v[48:51], v7, s[8:11], s19 offen
    s_add_u32 s19, s17, 259072
    buffer_load_dwordx4 v[52:55], v7, s[8:11], s19 offen
    s_add_u32 s19, s17, 520192
    buffer_load_dwordx4 v[56:59], v7, s[8:11], s19 offen
    s_add_u32 s19, s17, 521216
    buffer_load_dwordx4 v[60:63], v7, s[8:11], s19 offen
    s_waitcnt vmcnt(10)
    v_mfma_f32_16x16x32_bf16 v[16:19], v[36:39], v[64:67], v[16:19]
    v_mfma_f32_16x16x32_bf16 v[20:23], v[36:39], v[68:71], v[20:23]
    v_mfma_f32_16x16x32_bf16 v[24:27], v[36:39], v[72:75], v[24:27]
    v_mfma_f32_16x16x32_bf16 v[28:31], v[36:39], v[76:79], v[28:31]
    s_add_u32 s19, s5, 4066304
    buffer_load_dwordx4 v[36:39], v7, s[8:11], s19 offen
    s_add_u32 s19, s17, 260096
    buffer_load_dwordx4 v[64:67], v7, s[8:11], s19 offen
    s_add_u32 s19, s17, 261120
    buffer_load_dwordx4 v[68:71], v7, s[8:11], s19 offen
    s_add_u32 s19, s17, 522240
    buffer_load_dwordx4 v[72:75], v7, s[8:11], s19 offen
    s_add_u32 s19, s17, 523264
    buffer_load_dwordx4 v[76:79], v7, s[8:11], s19 offen
    s_waitcnt vmcnt(10)
    v_mfma_f32_16x16x32_bf16 v[16:19], v[40:43], v[80:83], v[16:19]
    v_mfma_f32_16x16x32_bf16 v[20:23], v[40:43], v[84:87], v[20:23]
    v_mfma_f32_16x16x32_bf16 v[24:27], v[40:43], v[88:91], v[24:27]
    v_mfma_f32_16x16x32_bf16 v[28:31], v[40:43], v[92:95], v[28:31]
    s_waitcnt vmcnt(5)
    v_mfma_f32_16x16x32_bf16 v[16:19], v[32:35], v[48:51], v[16:19]
    v_mfma_f32_16x16x32_bf16 v[20:23], v[32:35], v[52:55], v[20:23]
    v_mfma_f32_16x16x32_bf16 v[24:27], v[32:35], v[56:59], v[24:27]
    v_mfma_f32_16x16x32_bf16 v[28:31], v[32:35], v[60:63], v[28:31]
    s_waitcnt vmcnt(0)
    v_mfma_f32_16x16x32_bf16 v[16:19], v[36:39], v[64:67], v[16:19]
    v_mfma_f32_16x16x32_bf16 v[20:23], v[36:39], v[68:71], v[20:23]
    v_mfma_f32_16x16x32_bf16 v[24:27], v[36:39], v[72:75], v[24:27]
    v_mfma_f32_16x16x32_bf16 v[28:31], v[36:39], v[76:79], v[28:31]
    s_lshl_b32 s5, s26, 2
    s_add_u32 s5, s5, s16
    s_lshl_b32 s5, s5, 5
    s_lshl_b32 s19, s3, 16
    s_add_u32 s5, s5, s19
    v_lshlrev_b32 v8, 10, v3
    v_lshl_add_u32 v8, v2, 3, v8
    s_add_u32 s18, s5, 25165824
    s_add_u32 s19, s18, 0
    buffer_load_dwordx2 v[32:33], v8, s[8:11], s19 offen
    s_add_u32 s19, s18, 16384
    buffer_load_dwordx2 v[34:35], v8, s[8:11], s19 offen
    s_add_u32 s19, s18, 32768
    buffer_load_dwordx2 v[36:37], v8, s[8:11], s19 offen
    s_add_u32 s19, s18, 49152
    buffer_load_dwordx2 v[38:39], v8, s[8:11], s19 offen
    s_waitcnt vmcnt(0)
    v_cvt_pk_bf16_f32 v16, v16, v17
    v_cvt_pk_bf16_f32 v18, v18, v19
    v_lshlrev_b32 v100, 16, v16
    v_and_b32 v101, 0xffff0000, v16
    v_lshlrev_b32 v102, 16, v18
    v_and_b32 v103, 0xffff0000, v18
    v_lshlrev_b32 v104, 16, v32
    v_and_b32 v105, 0xffff0000, v32
    v_lshlrev_b32 v106, 16, v33
    v_and_b32 v107, 0xffff0000, v33
    v_add_f32 v100, v100, v104
    v_add_f32 v101, v101, v105
    v_add_f32 v102, v102, v106
    v_add_f32 v103, v103, v107
    v_cvt_pk_bf16_f32 v16, v100, v101
    v_cvt_pk_bf16_f32 v17, v102, v103
    s_add_u32 s19, s5, 0
    buffer_store_dwordx2 v[16:17], v8, s[12:15], s19 offen
    v_cvt_pk_bf16_f32 v20, v20, v21
    v_cvt_pk_bf16_f32 v22, v22, v23
    v_lshlrev_b32 v100, 16, v20
    v_and_b32 v101, 0xffff0000, v20
    v_lshlrev_b32 v102, 16, v22
    v_and_b32 v103, 0xffff0000, v22
    v_lshlrev_b32 v104, 16, v34
    v_and_b32 v105, 0xffff0000, v34
    v_lshlrev_b32 v106, 16, v35
    v_and_b32 v107, 0xffff0000, v35
    v_add_f32 v100, v100, v104
    v_add_f32 v101, v101, v105
    v_add_f32 v102, v102, v106
    v_add_f32 v103, v103, v107
    v_cvt_pk_bf16_f32 v20, v100, v101
    v_cvt_pk_bf16_f32 v21, v102, v103
    s_add_u32 s19, s5, 16384
    buffer_store_dwordx2 v[20:21], v8, s[12:15], s19 offen
    v_cvt_pk_bf16_f32 v24, v24, v25
    v_cvt_pk_bf16_f32 v26, v26, v27
    v_lshlrev_b32 v100, 16, v24
    v_and_b32 v101, 0xffff0000, v24
    v_lshlrev_b32 v102, 16, v26
    v_and_b32 v103, 0xffff0000, v26
    v_lshlrev_b32 v104, 16, v36
    v_and_b32 v105, 0xffff0000, v36
    v_lshlrev_b32 v106, 16, v37
    v_and_b32 v107, 0xffff0000, v37
    v_add_f32 v100, v100, v104
    v_add_f32 v101, v101, v105
    v_add_f32 v102, v102, v106
    v_add_f32 v103, v103, v107
    v_cvt_pk_bf16_f32 v24, v100, v101
    v_cvt_pk_bf16_f32 v25, v102, v103
    s_add_u32 s19, s5, 32768
    buffer_store_dwordx2 v[24:25], v8, s[12:15], s19 offen
    v_cvt_pk_bf16_f32 v28, v28, v29
    v_cvt_pk_bf16_f32 v30, v30, v31
    v_lshlrev_b32 v100, 16, v28
    v_and_b32 v101, 0xffff0000, v28
    v_lshlrev_b32 v102, 16, v30
    v_and_b32 v103, 0xffff0000, v30
    v_lshlrev_b32 v104, 16, v38
    v_and_b32 v105, 0xffff0000, v38
    v_lshlrev_b32 v106, 16, v39
    v_and_b32 v107, 0xffff0000, v39
    v_add_f32 v100, v100, v104
    v_add_f32 v101, v101, v105
    v_add_f32 v102, v102, v106
    v_add_f32 v103, v103, v107
    v_cvt_pk_bf16_f32 v28, v100, v101
    v_cvt_pk_bf16_f32 v29, v102, v103
    s_add_u32 s19, s5, 49152
    buffer_store_dwordx2 v[28:29], v8, s[12:15], s19 offen
L_kb4_end_94:
    s_endpgm
.section .rodata,"a"
.p2align 6
.amdhsa_kernel kb4_1_kernel
  .amdhsa_next_free_vgpr 112
  .amdhsa_next_free_sgpr 102
  .amdhsa_accum_offset 112
  .amdhsa_group_segment_fixed_size 0
  .amdhsa_kernarg_size 120
  .amdhsa_user_sgpr_count 2
  .amdhsa_user_sgpr_kernarg_segment_ptr 1
  .amdhsa_system_sgpr_workgroup_id_x 1
.end_amdhsa_kernel
.text
```
